```python
import torch

def _softmax(x, axis=-1):
    return torch.softmax(x, dim=axis)
def _gelu(x):
    return torch.nn.functional.gelu(x, approximate="tanh")
def _silu(x):
    return torch.nn.functional.silu(x)
def _sigmoid(x):
    return torch.sigmoid(x)
def _layernorm(x, axis=-1, eps=1e-5):
    m = x.mean(dim=axis, keepdim=True)
    v = x.var(dim=axis, keepdim=True, unbiased=False)
    return (x - m) / torch.sqrt(v + eps)
def _scatter_add(tgt, idx, src, axis=0):
    return tgt.clone().index_add_(axis, idx, src)
def _segment_sum(src, seg, n):
    out = torch.zeros((n,) + src.shape[1:], dtype=src.dtype)
    return out.index_add_(0, seg, src)
def _pad(x, pw):
    flat = tuple(v for pair in reversed(pw) for v in pair)
    return torch.nn.functional.pad(x, flat)

kernel_name = 'standalone__cheap_equivariant_egnn__graph'

def setup_inputs():

    _w = (lambda a: (lambda t: t.to(torch.bfloat16) if t.is_floating_point() else t)(torch.as_tensor(a)))
    N, deg, D, De = 50000, 16, 64, max(16, 1)
    E = N * deg
    return {
        "h": _w((lambda *s: torch.randn(*s, dtype=torch.bfloat16) * 0.2)(N, D)),
        "pos": _w((lambda *s: torch.randn(*s, dtype=torch.bfloat16) * 0.8)(N, 3)),
        "e_attr": _w((lambda *s: torch.randn(*s, dtype=torch.bfloat16) * 0.8)(E, De)),
        "src": _w((lambda lo, hi, *s: torch.randint(lo, hi, s))(0, N, E).to(torch.int64)),
        "dst": _w((lambda lo, hi, *s: torch.randint(lo, hi, s))(0, N, E).to(torch.int64)),
        "w_e": _w(0.1 * (lambda *s: torch.randn(*s, dtype=torch.bfloat16) * 0.8)(2 * D + 1 + De, D)),
        "w_x": _w(0.1 * (lambda *s: torch.randn(*s, dtype=torch.bfloat16) * 0.2)(D, 1)),
        "w_h": _w(0.1 * (lambda *s: torch.randn(*s, dtype=torch.bfloat16) * 0.2)(2 * D, D)),
    }

def reference(h, pos, e_attr, src, dst, w_e, w_x, w_h):
    N, D = h.shape[0], h.shape[1]
    diff = pos[dst] - pos[src]
    dist2 = torch.sum(diff * diff, axis=-1, keepdims=True)
    e_in = torch.concatenate([h[dst], h[src], dist2, e_attr], axis=-1)
    m_ij = _silu(e_in @ w_e)
    coord_scale = m_ij @ w_x
    pos_new = pos + _segment_sum(diff * coord_scale, dst, N)
    m_i = _segment_sum(m_ij, dst, N)
    h_new = h + _silu(torch.concatenate([h, m_i], axis=-1) @ w_h)
    return h_new, pos_new
```

```asm
; @launch kernel=egnn_sort_kernel grid=(250,1,1) block=(896,1,1) lds=27904
; @launch kernel=egnn_main_kernel grid=(256,1,1) block=(512,1,1) lds=162816
.amdgcn_target "amdgcn-amd-amdhsa--gfx950"
.text
.globl egnn_sort_kernel
.p2align 8
.type egnn_sort_kernel,@function
egnn_sort_kernel:
    s_cmp_ge_u32 s2, 250
    s_cbranch_scc1 K1_END
    s_load_dwordx2 s[38:39], s[0:1], 80
    v_lshrrev_b32 v1, 6, v0
    s_nop 0
    v_readfirstlane_b32 s3, v1
    s_cmp_ge_u32 s3, 13
    s_cbranch_scc1 K1_FRAG
    s_load_dwordx4 s[4:7], s[0:1], 24
    s_load_dwordx4 s[8:11], s[0:1], 8
    s_and_b32 s28, s2, 7
    s_min_u32 s29, s28, 2
    s_mul_i32 s28, s28, 31
    s_lshr_b32 s2, s2, 3
    s_add_u32 s2, s2, s28
    s_add_u32 s2, s2, s29
    v_lshlrev_b32 v1, 2, v0
    v_mov_b32 v2, 0
    v_mov_b32 v3, 1
    v_cmp_gt_u32 vcc, 288, v0
    s_mov_b64 exec, vcc
    ds_write_b32 v1, v2 offset:0
    s_mov_b64 exec, -1
    s_mul_i32 s28, s2, 12800
    s_mul_i32 s29, s2, 200
    s_mul_i32 s30, s2, 3200
    s_mov_b32 s31, 85599
    s_movk_i32 s32, -196
    v_add_u32 v12, s29, v0
    v_mul_u32_u24 v13, 6, v12
    v_lshlrev_b32 v14, 4, v0
    v_mov_b32 v15, 800
    v_cmp_gt_u32 s[34:35], v15, v0
    v_mov_b32 v15, 200
    v_cmp_gt_u32 s[36:37], v15, v0
    s_waitcnt lgkmcnt(0)
    s_mov_b32 s12, s4
    s_and_b32 s13, s5, 0xffff
    s_mov_b32 s14, 3200000
    s_mov_b32 s15, 0x20000
    s_mov_b32 s16, s6
    s_and_b32 s17, s7, 0xffff
    s_mov_b32 s18, 3200000
    s_mov_b32 s19, 0x20000
    s_mov_b32 s20, s8
    s_and_b32 s21, s9, 0xffff
    s_mov_b32 s22, 300000
    s_mov_b32 s23, 0x20000
    s_mov_b32 s24, s38
    s_and_b32 s25, s39, 0xffff
    s_mov_b32 s26, 25600000
    s_mov_b32 s27, 0x20000
    s_cmp_ge_u32 s3, 4
    s_cbranch_scc1 K1_NOPOS
    s_mov_b64 exec, s[36:37]
    buffer_load_ushort v16, v13, s[20:23], 0 offen
    buffer_load_ushort v17, v13, s[20:23], 0 offen offset:2
    buffer_load_ushort v18, v13, s[20:23], 0 offen offset:4
K1_NOPOS:
    s_mov_b64 exec, s[34:35]
    buffer_load_dwordx4 v[4:7], v14, s[16:19], s28 offen nt
    v_add_u32 v20, s30, v1
    v_add_u32 v22, 1, v20
    v_add_u32 v24, 2, v20
    v_add_u32 v26, 3, v20
    s_barrier
    s_waitcnt vmcnt(0)
    buffer_load_dwordx4 v[8:11], v14, s[12:15], s28 offen nt
    v_mul_u32_u24 v28, s31, v4
    v_lshrrev_b32 v28, 24, v28
    v_mad_i32_i24 v4, v28, s32, v4
    v_lshlrev_b32 v28, 2, v28
    ds_add_rtn_u32 v32, v28, v3 offset:0
    v_mul_u32_u24 v29, s31, v5
    v_lshrrev_b32 v29, 24, v29
    v_mad_i32_i24 v5, v29, s32, v5
    v_lshlrev_b32 v29, 2, v29
    ds_add_rtn_u32 v33, v29, v3 offset:0
    v_mul_u32_u24 v30, s31, v6
    v_lshrrev_b32 v30, 24, v30
    v_mad_i32_i24 v6, v30, s32, v6
    v_lshlrev_b32 v30, 2, v30
    ds_add_rtn_u32 v34, v30, v3 offset:0
    v_mul_u32_u24 v31, s31, v7
    v_lshrrev_b32 v31, 24, v31
    v_mad_i32_i24 v7, v31, s32, v7
    v_lshlrev_b32 v31, 2, v31
    ds_add_rtn_u32 v35, v31, v3 offset:0
    s_cmp_ge_u32 s3, 4
    s_cbranch_scc1 K1_P3
    s_mov_b64 exec, s[36:37]
    v_lshl_or_b32 v16, v17, 16, v16
    v_lshlrev_b32 v17, 16, v18
    v_lshlrev_b32 v12, 3, v12
    s_mov_b32 s33, 6684672
    buffer_store_dwordx2 v[16:17], v12, s[24:27], s33 offen
    s_mov_b64 exec, s[34:35]
K1_P3:
    s_mov_b64 exec, -1
    v_and_b32 v2, 63, v0
    v_lshlrev_b32 v2, 4, v2
    s_waitcnt lgkmcnt(0)
    s_barrier
    ds_read_b128 v[36:39], v2 offset:0
    s_waitcnt lgkmcnt(0)
    v_add_u32 v42, v36, v37
    v_add_u32 v43, v42, v38
    v_add_u32 v44, v43, v39
    v_mov_b32 v45, v44
    s_nop 1
    v_add_u32_dpp v45, v45, v45 row_shr:1 row_mask:0xf bank_mask:0xf
    s_nop 1
    v_add_u32_dpp v45, v45, v45 row_shr:2 row_mask:0xf bank_mask:0xf
    s_nop 1
    v_add_u32_dpp v45, v45, v45 row_shr:4 row_mask:0xf bank_mask:0xf
    s_nop 1
    v_add_u32_dpp v45, v45, v45 row_shr:8 row_mask:0xf bank_mask:0xf
    s_nop 1
    v_add_u32_dpp v45, v45, v45 row_bcast:15 row_mask:0xa bank_mask:0xf
    s_nop 1
    v_add_u32_dpp v45, v45, v45 row_bcast:31 row_mask:0xc bank_mask:0xf
    v_sub_u32 v40, v45, v44
    v_add_u32 v41, v40, v36
    v_add_u32 v42, v40, v42
    v_add_u32 v43, v40, v43
    v_lshlrev_b32 v48, 3, v40
    v_lshlrev_b32 v49, 3, v41
    v_lshlrev_b32 v50, 3, v42
    v_lshlrev_b32 v51, 3, v43
    ds_write_b128 v2, v[48:51] offset:1280
    s_mov_b64 exec, s[34:35]
    ds_read_b32 v28, v28 offset:1280
    ds_read_b32 v29, v29 offset:1280
    ds_read_b32 v30, v30 offset:1280
    ds_read_b32 v31, v31 offset:1280
    s_cmp_ge_u32 s3, 4
    s_cbranch_scc1 K1_SW0
    s_waitcnt vmcnt(1)
    s_branch K1_SW1
K1_SW0:
    s_waitcnt vmcnt(0)
K1_SW1:
    v_mul_u32_u24 v21, 1342, v8
    v_lshrrev_b32 v21, 24, v21
    v_lshl_or_b32 v4, v4, 2, v21
    v_lshl_or_b32 v21, v4, 18, v8
    v_mul_u32_u24 v23, 1342, v9
    v_lshrrev_b32 v23, 24, v23
    v_lshl_or_b32 v5, v5, 2, v23
    v_lshl_or_b32 v23, v5, 18, v9
    v_mul_u32_u24 v25, 1342, v10
    v_lshrrev_b32 v25, 24, v25
    v_lshl_or_b32 v6, v6, 2, v25
    v_lshl_or_b32 v25, v6, 18, v10
    v_mul_u32_u24 v27, 1342, v11
    v_lshrrev_b32 v27, 24, v27
    v_lshl_or_b32 v7, v7, 2, v27
    v_lshl_or_b32 v27, v7, 18, v11
    s_cmp_lg_u32 s3, 12
    s_cbranch_scc1 K1_NOOFF
    s_mov_b64 exec, -1
    v_lshl_or_b32 v40, v36, 16, v40
    v_lshl_or_b32 v41, v37, 16, v41
    v_lshl_or_b32 v42, v38, 16, v42
    v_lshl_or_b32 v43, v39, 16, v43
    v_lshlrev_b32 v2, 8, v2
    s_lshl_b32 s33, s2, 4
    s_add_u32 s33, s33, 6422528
    buffer_store_dwordx4 v[40:43], v2, s[24:27], s33 offen
    s_mov_b64 exec, s[34:35]
K1_NOOFF:
    s_waitcnt lgkmcnt(3)
    v_lshl_add_u32 v28, v32, 3, v28
    ds_write_b64 v28, v[20:21] offset:2304
    s_waitcnt lgkmcnt(3)
    v_lshl_add_u32 v29, v33, 3, v29
    ds_write_b64 v29, v[22:23] offset:2304
    s_waitcnt lgkmcnt(3)
    v_lshl_add_u32 v30, v34, 3, v30
    ds_write_b64 v30, v[24:25] offset:2304
    s_waitcnt lgkmcnt(3)
    v_lshl_add_u32 v31, v35, 3, v31
    ds_write_b64 v31, v[26:27] offset:2304
    s_mul_i32 s33, s2, 25600
    s_add_u32 s38, s33, 12800
    s_waitcnt lgkmcnt(0)
    s_barrier
    ds_read_b128 v[4:7], v14 offset:2304
    ds_read_b128 v[8:11], v14 offset:15104
    s_waitcnt lgkmcnt(1)
    buffer_store_dwordx4 v[4:7], v14, s[24:27], s33 offen sc1
    s_waitcnt lgkmcnt(0)
    buffer_store_dwordx4 v[8:11], v14, s[24:27], s38 offen sc1
    s_endpgm
K1_FRAG:
    s_cmp_ge_u32 s2, 144
    s_cbranch_scc1 K1_END
    s_load_dwordx4 s[4:7], s[0:1], 40
    s_load_dwordx2 s[8:9], s[0:1], 56
    s_lshr_b32 s28, s2, 2
    s_and_b32 s3, s2, 3
    s_lshl_b32 s3, s3, 6
    v_and_b32 v1, 63, v0
    v_add_u32 v1, s3, v1
    v_lshlrev_b32 v10, 2, v1
    s_lshl_b32 s33, s28, 10
    s_add_u32 s33, s33, 7536640
    s_mov_b32 s34, 0xbfb8aa3b
    s_waitcnt lgkmcnt(0)
    s_mov_b32 s12, s4
    s_and_b32 s13, s5, 0xffff
    s_mov_b32 s14, 18560
    s_mov_b32 s15, 0x20000
    s_mov_b32 s16, s6
    s_and_b32 s17, s7, 0xffff
    s_mov_b32 s18, 128
    s_mov_b32 s19, 0x20000
    s_mov_b32 s20, s8
    s_and_b32 s21, s9, 0xffff
    s_mov_b32 s22, 16384
    s_mov_b32 s23, 0x20000
    s_mov_b32 s24, s38
    s_and_b32 s25, s39, 0xffff
    s_mov_b32 s26, 25427968
    s_mov_b32 s27, 0x20000
    s_cmp_eq_u32 s28, 19
    s_cbranch_scc1 K1_WX
    s_cmp_eq_u32 s28, 18
    s_cbranch_scc1 K1_W3
    v_lshrrev_b32 v2, 2, v1
    v_and_b32 v3, 4, v2
    v_lshlrev_b32 v3, 3, v3
    v_bfe_u32 v4, v2, 3, 2
    v_lshl_add_u32 v3, v4, 2, v3
    v_and_b32 v4, 3, v2
    v_add_u32 v3, v3, v4
    v_lshrrev_b32 v5, 7, v1
    v_and_b32 v6, 3, v1
    s_mov_b32 s35, 32
    s_cmp_ge_u32 s28, 18
    s_cbranch_scc1 K1_FH
    s_cmp_ge_u32 s28, 16
    s_cbranch_scc1 K1_F4
    s_mov_b32 s36, s28
    s_branch K1_FC
K1_FH:
    s_sub_u32 s36, s28, 20
    s_mov_b32 s12, s20
    s_mov_b32 s13, s21
    s_mov_b32 s14, s22
    s_cmp_ge_u32 s36, 8
    s_cselect_b32 s34, 1.0, s34
K1_FC:
    s_lshr_b32 s37, s36, 3
    s_lshl_b32 s37, s37, 6
    s_and_b32 s38, s36, 3
    s_lshl_b32 s38, s38, 3
    s_add_u32 s37, s37, s38
    s_bfe_u32 s38, s36, 0x10002
    s_branch K1_FD
K1_F4:
    s_mov_b32 s35, 8
    s_movk_i32 s37, 129
    s_sub_u32 s38, s28, 16
K1_FD:
    s_lshl_b32 s38, s38, 4
    v_mul_u32_u24 v5, s35, v5
    v_lshl_add_u32 v5, v6, 1, v5
    v_add_u32 v5, s37, v5
    v_add_u32 v3, s38, v3
    v_lshlrev_b32 v3, 1, v3
    v_lshl_add_u32 v3, v5, 7, v3
    buffer_load_ushort v7, v3, s[12:15], 0 offen
    buffer_load_ushort v8, v3, s[12:15], 0 offen offset:128
    s_waitcnt vmcnt(0)
    v_lshlrev_b32 v7, 16, v7
    v_lshlrev_b32 v8, 16, v8
    v_mul_f32 v7, s34, v7
    v_mul_f32 v8, s34, v8
    v_cvt_pk_bf16_f32 v7, v7, v8
    buffer_store_dword v7, v10, s[24:27], s33 offen
    s_endpgm
K1_W3:
    v_and_b32 v2, 31, v1
    v_and_b32 v3, 4, v2
    v_lshlrev_b32 v3, 3, v3
    v_bfe_u32 v4, v2, 3, 2
    v_lshl_add_u32 v3, v4, 2, v3
    v_and_b32 v4, 3, v2
    v_add_u32 v3, v3, v4
    v_bfe_u32 v5, v1, 6, 1
    v_lshl_add_u32 v3, v5, 4, v3
    v_lshlrev_b32 v3, 1, v3
    s_movk_i32 s35, 16384
    buffer_load_ushort v7, v3, s[12:15], s35 offen
    v_and_b32 v6, 32, v1
    v_cmp_eq_u32 vcc, 0, v6
    s_waitcnt vmcnt(0)
    v_lshlrev_b32 v7, 16, v7
    v_mul_f32 v7, s34, v7
    v_cvt_pk_bf16_f32 v8, v7, v7
    v_lshlrev_b32 v8, 16, v8
    v_sub_f32 v9, v7, v8
    v_cvt_pk_bf16_f32 v7, v8, v9
    v_cndmask_b32 v7, 0, v7, vcc
    buffer_store_dword v7, v10, s[24:27], s33 offen
    s_endpgm
K1_WX:
    v_lshlrev_b32 v3, 1, v1
    buffer_load_ushort v7, v3, s[16:19], 0 offen
    s_waitcnt vmcnt(0)
    v_lshlrev_b32 v7, 16, v7
    v_mul_f32 v7, 0xbf317218, v7
    buffer_store_dword v7, v10, s[24:27], s33 offen
K1_END:
    s_endpgm
.globl egnn_main_kernel
.p2align 8
.type egnn_main_kernel,@function
egnn_main_kernel:
    s_cmp_ge_u32 s2, 256
    s_cbranch_scc1 K2_END
    s_load_dwordx2 s[28:29], s[0:1], 0
    s_load_dwordx2 s[30:31], s[0:1], 16
    s_load_dwordx2 s[32:33], s[0:1], 64
    s_load_dwordx2 s[34:35], s[0:1], 80
    v_mov_b32 v250, v0
    v_lshrrev_b32 v220, 6, v0
    s_and_b32 s3, s2, 7
    s_lshl_b32 s3, s3, 5
    v_readfirstlane_b32 s5, v220
    s_lshr_b32 s95, s2, 3
    s_add_u32 s3, s3, s95
    s_mul_i32 s4, s3, 196
    s_sub_u32 s96, 50000, s4
    s_min_u32 s96, s96, 196
    s_mov_b32 s7, 0
    s_mov_b32 s92, 48
    s_sub_u32 s100, 11, s5
    s_cmp_lt_u32 s5, 4
    s_cselect_b32 s100, s5, s100
    s_lshl_b32 s94, s100, 12
    s_add_u32 s94, s94, 34816
    s_waitcnt lgkmcnt(0)
    s_add_u32 s88, s34, 6422528
    s_addc_u32 s89, s35, 0
    s_and_b32 s89, s89, 0xffff
    s_mov_b32 s90, 262144
    s_mov_b32 s91, 0x20000
    s_mov_b32 s8, s28
    s_and_b32 s9, s29, 0xffff
    s_or_b32 s9, s9, 8388608
    s_mov_b32 s10, 50000
    s_mov_b32 s11, 0x20000
    s_mov_b32 s12, s30
    s_and_b32 s13, s31, 0xffff
    s_or_b32 s13, s13, 2097152
    s_mov_b32 s14, 800000
    s_mov_b32 s15, 0x20000
    s_add_u32 s16, s34, 6684672
    s_addc_u32 s17, s35, 0
    s_and_b32 s17, s17, 0xffff
    s_or_b32 s17, s17, 524288
    s_mov_b32 s18, 50000
    s_mov_b32 s19, 0x20000
    s_mov_b32 s20, s34
    s_and_b32 s21, s35, 0xffff
    s_mov_b32 s22, 25427968
    s_mov_b32 s23, 0x20000
    s_mov_b32 s24, s32
    s_and_b32 s25, s33, 0xffff
    s_mov_b32 s26, 6700000
    s_mov_b32 s27, 0x20000
K2_TOP:
    v_bfe_u32 v220, v250, 4, 2
    s_mul_i32 s95, s5, 36
    s_sub_u32 s95, s95, 36
    v_mad_u32_u24 v220, v220, 9, s95
    v_lshlrev_b32 v221, 4, v220
    s_and_b32 s95, s3, 3
    s_mul_i32 s95, s95, 1020
    s_lshl_b32 s99, s3, 10
    s_sub_u32 s95, s99, s95
    s_cmp_eq_u32 s5, 0
    s_cbranch_scc1 K2_NOOF
    buffer_load_dword v172, v221, s[88:91], s95 offen offset:0
    buffer_load_dword v173, v221, s[88:91], s95 offen offset:16
    buffer_load_dword v174, v221, s[88:91], s95 offen offset:32
    buffer_load_dword v175, v221, s[88:91], s95 offen offset:48
    buffer_load_dword v176, v221, s[88:91], s95 offen offset:64
    buffer_load_dword v177, v221, s[88:91], s95 offen offset:80
    buffer_load_dword v178, v221, s[88:91], s95 offen offset:96
    buffer_load_dword v179, v221, s[88:91], s95 offen offset:112
    buffer_load_dword v180, v221, s[88:91], s95 offen offset:128
K2_NOOF:
    v_and_b32 v222, 63, v250
    v_lshlrev_b32 v203, 4, v222
    v_lshrrev_b32 v239, 3, v222
    v_lshrrev_b32 v223, 4, v222
    v_xor_b32 v223, v223, v222
    v_and_b32 v223, 7, v223
    v_lshlrev_b32 v211, 4, v223
    v_xor_b32 v213, 64, v211
    v_mov_b32 v215, v211
    v_mov_b32 v217, v213
    s_lshl_b32 s95, s5, 5
    s_add_u32 s95, s95, s4
    v_add_u32 v210, s95, v239
    v_add_u32 v212, 8, v210
    v_add_u32 v214, 16, v210
    v_add_u32 v216, 24, v210
    s_add_u32 s99, s4, s96
    v_cmp_gt_u32 vcc, s99, v210
    s_nop 1
    v_cndmask_b32 v210, -1, v210, vcc
    v_cmp_gt_u32 vcc, s99, v212
    s_nop 1
    v_cndmask_b32 v212, -1, v212, vcc
    v_cmp_gt_u32 vcc, s99, v214
    s_nop 1
    v_cndmask_b32 v214, -1, v214, vcc
    v_cmp_gt_u32 vcc, s99, v216
    s_nop 1
    v_cndmask_b32 v216, -1, v216, vcc
    s_lshl_b32 s101, s5, 12
    s_add_u32 s101, s101, 100352
    s_barrier
    s_mul_i32 s95, s5, 3072
    s_add_u32 m0, s95, 138240
    s_add_u32 s95, s95, 7536640
    buffer_load_dwordx4 v203, s[20:23], s95 offen offset:0 lds
    buffer_load_dwordx4 v203, s[20:23], s95 offen offset:1024 lds
    buffer_load_dwordx4 v203, s[20:23], s95 offen offset:2048 lds
    v_mov_b32 v228, 0
    v_mov_b32 v229, 0
    v_mov_b32 v230, 0
    v_mov_b32 v231, 0
    s_lshl_b32 s95, s5, 10
    s_cmp_ge_u32 s5, 4
    s_cselect_b32 s99, 30720, 0
    s_add_u32 s95, s95, s99
    v_add_u32 v223, s95, v203
    ds_write_b128 v223, v[228:231]
    v_and_b32 v223, 2047, v223
    ds_write_b128 v223, v[228:231] offset:38912
    v_lshlrev_b32 v239, 2, v239
    v_mov_b32 v41, 0
    v_mov_b32 v43, 0
    v_mov_b32 v209, 0
    v_lshrrev_b32 v219, 5, v222
    v_lshlrev_b32 v219, 4, v219
    v_and_b32 v223, 31, v222
    v_bfe_u32 v251, v222, 1, 3
    v_lshlrev_b32 v251, 4, v251
    v_lshlrev_b32 v252, 2, v219
    v_xor_b32 v251, v251, v252
    v_lshl_add_u32 v251, v223, 7, v251
    v_add_u32 v251, s94, v251
    v_xor_b32 v252, 16, v251
    v_xor_b32 v253, 32, v251
    v_xor_b32 v254, 48, v251
    v_and_b32 v222, 15, v250
    v_cmp_gt_u32 vcc, 243, v220
    v_mul_u32_u24 v220, 3200, v220
    v_add3_u32 v220, v220, v222, s7
    v_add_u32 v221, 16, v222
    v_add_u32 v223, 32, v222
    v_cmp_gt_u32_e64 s[32:33], s92, v221
    v_cmp_gt_u32_e64 s[34:35], s92, v222
    s_nop 0
    v_cndmask_b32_e64 v221, 2.0, v221, s[32:33]
    v_cndmask_b32_e64 v223, 2.0, v223, s[32:33]
    v_cndmask_b32_e64 v222, 2.0, v222, s[34:35]
    s_cmp_eq_u32 s5, 0
    s_waitcnt vmcnt(3)
    s_cbranch_scc0 K2_MK
    s_branch K2_NOREC
K2_MK:
    v_cndmask_b32 v179, 0, v179, vcc
    v_cndmask_b32 v180, 0, v180, vcc
    v_and_b32 v98, 0xffff, v172
    v_lshrrev_b32 v172, 16, v172
    v_subrev_u32 v172, s7, v172
    v_cmp_gt_i32_e64 s[32:33], v172, v222
    v_add_lshl_u32 v98, v98, v220, 3
    s_mov_b32 s95, 0
    v_cndmask_b32_e64 v98, 2.0, v98, s[32:33]
    buffer_load_dwordx2 v[44:45], v98, s[20:23], s95 offen
    v_and_b32 v99, 0xffff, v173
    v_lshrrev_b32 v173, 16, v173
    v_subrev_u32 v173, s7, v173
    v_cmp_gt_i32_e64 s[34:35], v173, v222
    v_add_lshl_u32 v99, v99, v220, 3
    s_mov_b32 s95, 25600
    v_cndmask_b32_e64 v99, 2.0, v99, s[34:35]
    buffer_load_dwordx2 v[46:47], v99, s[20:23], s95 offen
    v_and_b32 v100, 0xffff, v174
    v_lshrrev_b32 v174, 16, v174
    v_subrev_u32 v174, s7, v174
    v_cmp_gt_i32_e64 s[36:37], v174, v222
    v_add_lshl_u32 v100, v100, v220, 3
    s_mov_b32 s95, 51200
    v_cndmask_b32_e64 v100, 2.0, v100, s[36:37]
    buffer_load_dwordx2 v[48:49], v100, s[20:23], s95 offen
    v_and_b32 v101, 0xffff, v175
    v_lshrrev_b32 v175, 16, v175
    v_subrev_u32 v175, s7, v175
    v_cmp_gt_i32_e64 s[38:39], v175, v222
    v_add_lshl_u32 v101, v101, v220, 3
    s_mov_b32 s95, 76800
    v_cndmask_b32_e64 v101, 2.0, v101, s[38:39]
    buffer_load_dwordx2 v[50:51], v101, s[20:23], s95 offen
    v_and_b32 v102, 0xffff, v176
    v_lshrrev_b32 v176, 16, v176
    v_subrev_u32 v176, s7, v176
    v_cmp_gt_i32_e64 s[40:41], v176, v222
    v_add_lshl_u32 v102, v102, v220, 3
    s_mov_b32 s95, 102400
    v_cndmask_b32_e64 v102, 2.0, v102, s[40:41]
    buffer_load_dwordx2 v[52:53], v102, s[20:23], s95 offen
    v_and_b32 v103, 0xffff, v177
    v_lshrrev_b32 v177, 16, v177
    v_subrev_u32 v177, s7, v177
    v_cmp_gt_i32_e64 s[42:43], v177, v222
    v_add_lshl_u32 v103, v103, v220, 3
    s_mov_b32 s95, 128000
    v_cndmask_b32_e64 v103, 2.0, v103, s[42:43]
    buffer_load_dwordx2 v[54:55], v103, s[20:23], s95 offen
    v_and_b32 v104, 0xffff, v178
    v_lshrrev_b32 v178, 16, v178
    v_subrev_u32 v178, s7, v178
    v_cmp_gt_i32_e64 s[44:45], v178, v222
    v_add_lshl_u32 v104, v104, v220, 3
    s_mov_b32 s95, 153600
    v_cndmask_b32_e64 v104, 2.0, v104, s[44:45]
    buffer_load_dwordx2 v[56:57], v104, s[20:23], s95 offen
    v_and_b32 v105, 0xffff, v179
    v_lshrrev_b32 v179, 16, v179
    v_subrev_u32 v179, s7, v179
    v_cmp_gt_i32_e64 s[46:47], v179, v222
    v_add_lshl_u32 v105, v105, v220, 3
    s_mov_b32 s95, 179200
    v_cndmask_b32_e64 v105, 2.0, v105, s[46:47]
    buffer_load_dwordx2 v[58:59], v105, s[20:23], s95 offen
    v_and_b32 v106, 0xffff, v180
    v_lshrrev_b32 v180, 16, v180
    v_subrev_u32 v180, s7, v180
    v_cmp_gt_i32_e64 s[48:49], v180, v222
    v_add_lshl_u32 v106, v106, v220, 3
    s_mov_b32 s95, 204800
    v_cndmask_b32_e64 v106, 2.0, v106, s[48:49]
    buffer_load_dwordx2 v[60:61], v106, s[20:23], s95 offen
    v_cmp_gt_i32_e64 s[50:51], v172, v221
    v_cmp_gt_i32_e64 s[68:69], v172, v223
    v_cmp_gt_i32_e64 s[52:53], v173, v221
    v_cmp_gt_i32_e64 s[70:71], v173, v223
    v_cmp_gt_i32_e64 s[54:55], v174, v221
    v_cmp_gt_i32_e64 s[72:73], v174, v223
    v_cmp_gt_i32_e64 s[56:57], v175, v221
    v_cmp_gt_i32_e64 s[74:75], v175, v223
    v_cmp_gt_i32_e64 s[58:59], v176, v221
    v_cmp_gt_i32_e64 s[76:77], v176, v223
    v_cmp_gt_i32_e64 s[60:61], v177, v221
    v_cmp_gt_i32_e64 s[78:79], v177, v223
    v_cmp_gt_i32_e64 s[62:63], v178, v221
    v_cmp_gt_i32_e64 s[80:81], v178, v223
    v_cmp_gt_i32_e64 s[64:65], v179, v221
    v_cmp_gt_i32_e64 s[82:83], v179, v223
    v_cmp_gt_i32_e64 s[66:67], v180, v221
    v_cmp_gt_i32_e64 s[84:85], v180, v223
    s_mov_b32 s95, 0
    s_mov_b64 exec, s[50:51]
    s_cbranch_execz K2_G1
    buffer_load_dwordx2 v[62:63], v98, s[20:23], s95 offen offset:128
K2_G1:
    s_mov_b32 s95, 25600
    s_mov_b64 exec, s[52:53]
    s_cbranch_execz K2_G2
    buffer_load_dwordx2 v[64:65], v99, s[20:23], s95 offen offset:128
K2_G2:
    s_mov_b32 s95, 51200
    s_mov_b64 exec, s[54:55]
    s_cbranch_execz K2_G3
    buffer_load_dwordx2 v[66:67], v100, s[20:23], s95 offen offset:128
K2_G3:
    s_mov_b32 s95, 76800
    s_mov_b64 exec, s[56:57]
    s_cbranch_execz K2_G4
    buffer_load_dwordx2 v[68:69], v101, s[20:23], s95 offen offset:128
K2_G4:
    s_mov_b32 s95, 102400
    s_mov_b64 exec, s[58:59]
    s_cbranch_execz K2_G5
    buffer_load_dwordx2 v[70:71], v102, s[20:23], s95 offen offset:128
K2_G5:
    s_mov_b32 s95, 128000
    s_mov_b64 exec, s[60:61]
    s_cbranch_execz K2_G6
    buffer_load_dwordx2 v[72:73], v103, s[20:23], s95 offen offset:128
K2_G6:
    s_mov_b32 s95, 153600
    s_mov_b64 exec, s[62:63]
    s_cbranch_execz K2_G7
    buffer_load_dwordx2 v[74:75], v104, s[20:23], s95 offen offset:128
K2_G7:
    s_mov_b32 s95, 179200
    s_mov_b64 exec, s[64:65]
    s_cbranch_execz K2_G8
    buffer_load_dwordx2 v[76:77], v105, s[20:23], s95 offen offset:128
K2_G8:
    s_mov_b32 s95, 204800
    s_mov_b64 exec, s[66:67]
    s_cbranch_execz K2_G9
    buffer_load_dwordx2 v[78:79], v106, s[20:23], s95 offen offset:128
K2_G9:
    s_or_b64 vcc, s[68:69], s[70:71]
    s_or_b64 vcc, vcc, s[72:73]
    s_or_b64 vcc, vcc, s[74:75]
    s_or_b64 vcc, vcc, s[76:77]
    s_or_b64 vcc, vcc, s[78:79]
    s_or_b64 vcc, vcc, s[80:81]
    s_or_b64 vcc, vcc, s[82:83]
    s_or_b64 vcc, vcc, s[84:85]
    s_cselect_b32 s97, 1, 0
    s_cbranch_scc0 K2_NP2A
    s_mov_b32 s95, 0
    s_mov_b64 exec, s[68:69]
    s_cbranch_execz K2_G10
    buffer_load_dwordx2 v[80:81], v98, s[20:23], s95 offen offset:256
K2_G10:
    s_mov_b32 s95, 25600
    s_mov_b64 exec, s[70:71]
    s_cbranch_execz K2_G11
    buffer_load_dwordx2 v[82:83], v99, s[20:23], s95 offen offset:256
K2_G11:
    s_mov_b32 s95, 51200
    s_mov_b64 exec, s[72:73]
    s_cbranch_execz K2_G12
    buffer_load_dwordx2 v[84:85], v100, s[20:23], s95 offen offset:256
K2_G12:
    s_mov_b32 s95, 76800
    s_mov_b64 exec, s[74:75]
    s_cbranch_execz K2_G13
    buffer_load_dwordx2 v[86:87], v101, s[20:23], s95 offen offset:256
K2_G13:
    s_mov_b32 s95, 102400
    s_mov_b64 exec, s[76:77]
    s_cbranch_execz K2_G14
    buffer_load_dwordx2 v[88:89], v102, s[20:23], s95 offen offset:256
K2_G14:
    s_mov_b32 s95, 128000
    s_mov_b64 exec, s[78:79]
    s_cbranch_execz K2_G15
    buffer_load_dwordx2 v[90:91], v103, s[20:23], s95 offen offset:256
K2_G15:
    s_mov_b32 s95, 153600
    s_mov_b64 exec, s[80:81]
    s_cbranch_execz K2_G16
    buffer_load_dwordx2 v[92:93], v104, s[20:23], s95 offen offset:256
K2_G16:
    s_mov_b32 s95, 179200
    s_mov_b64 exec, s[82:83]
    s_cbranch_execz K2_G17
    buffer_load_dwordx2 v[94:95], v105, s[20:23], s95 offen offset:256
K2_G17:
    s_mov_b32 s95, 204800
    s_mov_b64 exec, s[84:85]
    s_cbranch_execz K2_G18
    buffer_load_dwordx2 v[96:97], v106, s[20:23], s95 offen offset:256
K2_G18:
K2_NP2A:
    s_mov_b64 exec, -1
    v_max3_i32 v221, v172, v173, v174
    v_max3_i32 v221, v221, v175, v176
    v_max3_i32 v221, v221, v177, v178
    v_max3_i32 v221, v221, v179, v180
    v_mov_b32 v223, 1
    v_cmp_lt_i32_e64 s[86:87], s92, v221
K2_NOREC:
    s_waitcnt lgkmcnt(0)
    s_barrier
    s_add_u32 s95, s101, 0
    s_cmp_lt_u32 s95, 125952
    s_cselect_b32 m0, s95, 43008
    s_nop 0
    buffer_load_dwordx4 v[210:211], s[8:11], 0 idxen offen lds
    s_add_u32 s95, s101, 1024
    s_cmp_lt_u32 s95, 125952
    s_cselect_b32 m0, s95, 43008
    s_nop 0
    buffer_load_dwordx4 v[212:213], s[8:11], 0 idxen offen lds
    s_add_u32 s95, s101, 2048
    s_cmp_lt_u32 s95, 125952
    s_cselect_b32 m0, s95, 43008
    s_nop 0
    buffer_load_dwordx4 v[214:215], s[8:11], 0 idxen offen lds
    s_add_u32 s95, s101, 3072
    s_cmp_lt_u32 s95, 125952
    s_cselect_b32 m0, s95, 43008
    s_nop 0
    buffer_load_dwordx4 v[216:217], s[8:11], 0 idxen offen lds
    s_cmp_lg_u32 s5, 0
    s_cbranch_scc1 K2_NOPW
    s_lshr_b32 s95, s2, 3
    s_mul_i32 s99, s95, 0
    v_add_u32 v224, s99, v203
    s_mul_i32 s99, s95, 0
    v_add_u32 v225, s99, v250
    v_add_u32 v224, 0, v250
    v_cmp_gt_u32 vcc, s96, v224
    s_nop 1
    v_cndmask_b32_e64 v104, -0.5, 0.5, vcc
    v_add_u32 v224, 64, v250
    v_cmp_gt_u32 vcc, s96, v224
    s_nop 1
    v_cndmask_b32_e64 v105, -0.5, 0.5, vcc
    v_add_u32 v224, 128, v250
    v_cmp_gt_u32 vcc, s96, v224
    s_nop 1
    v_cndmask_b32_e64 v106, -0.5, 0.5, vcc
    v_add_u32 v224, 192, v250
    v_cmp_gt_u32 vcc, s96, v224
    s_nop 1
    v_cndmask_b32_e64 v107, -0.5, 0.5, vcc
    s_branch K2_B1
K2_NOPW:
    s_mov_b64 exec, s[86:87]
    ds_write_b32 v228, v223 offset:96
    s_mov_b64 exec, -1
    s_waitcnt vmcnt(4)
    s_mov_b64 exec, s[32:33]
    v_lshrrev_b32 v172, 16, v45
    ds_add_rtn_u32 v172, v172, v223 offset:34816
    s_mov_b64 exec, s[34:35]
    v_lshrrev_b32 v173, 16, v47
    ds_add_rtn_u32 v173, v173, v223 offset:34816
    s_mov_b64 exec, s[36:37]
    v_lshrrev_b32 v174, 16, v49
    ds_add_rtn_u32 v174, v174, v223 offset:34816
    s_mov_b64 exec, s[38:39]
    v_lshrrev_b32 v175, 16, v51
    ds_add_rtn_u32 v175, v175, v223 offset:34816
    s_mov_b64 exec, s[40:41]
    v_lshrrev_b32 v176, 16, v53
    ds_add_rtn_u32 v176, v176, v223 offset:34816
    s_mov_b64 exec, s[42:43]
    v_lshrrev_b32 v177, 16, v55
    ds_add_rtn_u32 v177, v177, v223 offset:34816
    s_mov_b64 exec, s[44:45]
    v_lshrrev_b32 v178, 16, v57
    ds_add_rtn_u32 v178, v178, v223 offset:34816
    s_mov_b64 exec, s[46:47]
    v_lshrrev_b32 v179, 16, v59
    ds_add_rtn_u32 v179, v179, v223 offset:34816
    s_mov_b64 exec, s[48:49]
    v_lshrrev_b32 v180, 16, v61
    ds_add_rtn_u32 v180, v180, v223 offset:34816
    s_mov_b64 exec, s[50:51]
    s_cbranch_execz K2_G19
    v_lshrrev_b32 v181, 16, v63
    ds_add_rtn_u32 v181, v181, v223 offset:34816
K2_G19:
    s_mov_b64 exec, s[52:53]
    s_cbranch_execz K2_G20
    v_lshrrev_b32 v182, 16, v65
    ds_add_rtn_u32 v182, v182, v223 offset:34816
K2_G20:
    s_mov_b64 exec, s[54:55]
    s_cbranch_execz K2_G21
    v_lshrrev_b32 v183, 16, v67
    ds_add_rtn_u32 v183, v183, v223 offset:34816
K2_G21:
    s_mov_b64 exec, s[56:57]
    s_cbranch_execz K2_G22
    v_lshrrev_b32 v184, 16, v69
    ds_add_rtn_u32 v184, v184, v223 offset:34816
K2_G22:
    s_mov_b64 exec, s[58:59]
    s_cbranch_execz K2_G23
    v_lshrrev_b32 v185, 16, v71
    ds_add_rtn_u32 v185, v185, v223 offset:34816
K2_G23:
    s_mov_b64 exec, s[60:61]
    s_cbranch_execz K2_G24
    v_lshrrev_b32 v186, 16, v73
    ds_add_rtn_u32 v186, v186, v223 offset:34816
K2_G24:
    s_mov_b64 exec, s[62:63]
    s_cbranch_execz K2_G25
    v_lshrrev_b32 v187, 16, v75
    ds_add_rtn_u32 v187, v187, v223 offset:34816
K2_G25:
    s_mov_b64 exec, s[64:65]
    s_cbranch_execz K2_G26
    v_lshrrev_b32 v188, 16, v77
    ds_add_rtn_u32 v188, v188, v223 offset:34816
K2_G26:
    s_mov_b64 exec, s[66:67]
    s_cbranch_execz K2_G27
    v_lshrrev_b32 v189, 16, v79
    ds_add_rtn_u32 v189, v189, v223 offset:34816
K2_G27:
    s_cmp_eq_u32 s97, 0
    s_cbranch_scc1 K2_NP2B
    s_mov_b64 exec, s[68:69]
    s_cbranch_execz K2_G28
    v_lshrrev_b32 v190, 16, v81
    ds_add_rtn_u32 v190, v190, v223 offset:34816
K2_G28:
    s_mov_b64 exec, s[70:71]
    s_cbranch_execz K2_G29
    v_lshrrev_b32 v191, 16, v83
    ds_add_rtn_u32 v191, v191, v223 offset:34816
K2_G29:
    s_mov_b64 exec, s[72:73]
    s_cbranch_execz K2_G30
    v_lshrrev_b32 v192, 16, v85
    ds_add_rtn_u32 v192, v192, v223 offset:34816
K2_G30:
    s_mov_b64 exec, s[74:75]
    s_cbranch_execz K2_G31
    v_lshrrev_b32 v193, 16, v87
    ds_add_rtn_u32 v193, v193, v223 offset:34816
K2_G31:
    s_mov_b64 exec, s[76:77]
    s_cbranch_execz K2_G32
    v_lshrrev_b32 v194, 16, v89
    ds_add_rtn_u32 v194, v194, v223 offset:34816
K2_G32:
    s_mov_b64 exec, s[78:79]
    s_cbranch_execz K2_G33
    v_lshrrev_b32 v195, 16, v91
    ds_add_rtn_u32 v195, v195, v223 offset:34816
K2_G33:
    s_mov_b64 exec, s[80:81]
    s_cbranch_execz K2_G34
    v_lshrrev_b32 v196, 16, v93
    ds_add_rtn_u32 v196, v196, v223 offset:34816
K2_G34:
    s_mov_b64 exec, s[82:83]
    s_cbranch_execz K2_G35
    v_lshrrev_b32 v197, 16, v95
    ds_add_rtn_u32 v197, v197, v223 offset:34816
K2_G35:
    s_mov_b64 exec, s[84:85]
    s_cbranch_execz K2_G36
    v_lshrrev_b32 v198, 16, v97
    ds_add_rtn_u32 v198, v198, v223 offset:34816
K2_G36:
K2_NP2B:
    s_mov_b64 exec, -1
K2_B1:
    s_cmp_lg_u32 s5, 0
    s_waitcnt lgkmcnt(0)
    s_barrier
    s_cbranch_scc1 K2_W2
    ds_read_b128 v[44:47], v203 offset:34816
    ds_read_b128 v[48:51], v203 offset:35840
    ds_read_b128 v[52:55], v203 offset:36864
    ds_read_b128 v[56:59], v203 offset:37888
    s_waitcnt lgkmcnt(3)
    v_add_u32 v76, v44, v45
    v_add3_u32 v76, v76, v46, v47
    s_waitcnt lgkmcnt(2)
    v_add_u32 v77, v48, v49
    v_add3_u32 v77, v77, v50, v51
    s_waitcnt lgkmcnt(1)
    v_add_u32 v78, v52, v53
    v_add3_u32 v78, v78, v54, v55
    s_waitcnt lgkmcnt(0)
    v_add_u32 v79, v56, v57
    v_add3_u32 v79, v79, v58, v59
    v_add_u32 v82, v76, v77
    v_add_u32 v83, v82, v78
    v_add_u32 v220, v83, v79
    v_mov_b32 v221, v220
    s_nop 1
    v_add_u32_dpp v221, v221, v221 row_shr:1 row_mask:0xf bank_mask:0xf
    s_nop 1
    v_add_u32_dpp v221, v221, v221 row_shr:2 row_mask:0xf bank_mask:0xf
    s_nop 1
    v_add_u32_dpp v221, v221, v221 row_shr:4 row_mask:0xf bank_mask:0xf
    s_nop 1
    v_add_u32_dpp v221, v221, v221 row_shr:8 row_mask:0xf bank_mask:0xf
    s_nop 1
    v_add_u32_dpp v221, v221, v221 row_bcast:15 row_mask:0xa bank_mask:0xf
    s_nop 1
    v_add_u32_dpp v221, v221, v221 row_bcast:31 row_mask:0xc bank_mask:0xf
    v_sub_u32 v80, v221, v220
    v_add_u32 v81, v80, v76
    v_add_u32 v82, v80, v82
    v_add_u32 v83, v80, v83
    s_movk_i32 s95, 2560
    v_lshl_add_u32 v60, v80, 3, s95
    v_lshl_add_u32 v61, v44, 3, v60
    v_lshl_add_u32 v62, v45, 3, v61
    v_lshl_add_u32 v63, v46, 3, v62
    ds_write_b128 v203, v[60:63] offset:34816
    v_lshl_add_u32 v64, v81, 3, s95
    v_lshl_add_u32 v65, v48, 3, v64
    v_lshl_add_u32 v66, v49, 3, v65
    v_lshl_add_u32 v67, v50, 3, v66
    ds_write_b128 v203, v[64:67] offset:35840
    v_lshl_add_u32 v68, v82, 3, s95
    v_lshl_add_u32 v69, v52, 3, v68
    v_lshl_add_u32 v70, v53, 3, v69
    v_lshl_add_u32 v71, v54, 3, v70
    ds_write_b128 v203, v[68:71] offset:36864
    v_lshl_add_u32 v72, v83, 3, s95
    v_lshl_add_u32 v73, v56, 3, v72
    v_lshl_add_u32 v74, v57, 3, v73
    v_lshl_add_u32 v75, v58, 3, v74
    ds_write_b128 v203, v[72:75] offset:37888
    s_mov_b32 exec_lo, 0
    s_brev_b32 exec_hi, 1
    ds_write_b32 v228, v221 offset:100
    s_mov_b64 exec, -1
K2_W2:
    s_cmp_ge_u32 s5, 6
    s_cbranch_scc1 K2_NWH
    s_mul_i32 s95, s5, 2048
    s_add_u32 m0, s95, 125952
    s_add_u32 s95, s95, 7561216
    buffer_load_dwordx4 v203, s[20:23], s95 offen offset:0 lds
    buffer_load_dwordx4 v203, s[20:23], s95 offen offset:1024 lds
K2_NWH:
    s_cmp_eq_u32 s5, 0
    s_cbranch_scc1 K2_NFT
    s_mov_b32 s95, 0xc0000
    s_mov_b64 exec, s[32:33]
    v_and_or_b32 v140, v45, s95, v172
    v_lshrrev_b32 v141, 17, v45
    v_cmpx_gt_u32 vcc, 1, v140
    ds_write_b64 v141, v[44:45] offset:38912
    s_mov_b64 exec, s[34:35]
    v_and_or_b32 v142, v47, s95, v173
    v_lshrrev_b32 v143, 17, v47
    v_cmpx_gt_u32 vcc, 1, v142
    ds_write_b64 v143, v[46:47] offset:38912
    s_mov_b64 exec, s[36:37]
    v_and_or_b32 v144, v49, s95, v174
    v_lshrrev_b32 v145, 17, v49
    v_cmpx_gt_u32 vcc, 1, v144
    ds_write_b64 v145, v[48:49] offset:38912
    s_mov_b64 exec, s[38:39]
    v_and_or_b32 v146, v51, s95, v175
    v_lshrrev_b32 v147, 17, v51
    v_cmpx_gt_u32 vcc, 1, v146
    ds_write_b64 v147, v[50:51] offset:38912
    s_mov_b64 exec, s[40:41]
    v_and_or_b32 v148, v53, s95, v176
    v_lshrrev_b32 v149, 17, v53
    v_cmpx_gt_u32 vcc, 1, v148
    ds_write_b64 v149, v[52:53] offset:38912
    s_mov_b64 exec, s[42:43]
    v_and_or_b32 v150, v55, s95, v177
    v_lshrrev_b32 v151, 17, v55
    v_cmpx_gt_u32 vcc, 1, v150
    ds_write_b64 v151, v[54:55] offset:38912
    s_mov_b64 exec, s[44:45]
    v_and_or_b32 v152, v57, s95, v178
    v_lshrrev_b32 v153, 17, v57
    v_cmpx_gt_u32 vcc, 1, v152
    ds_write_b64 v153, v[56:57] offset:38912
    s_mov_b64 exec, s[46:47]
    v_and_or_b32 v154, v59, s95, v179
    v_lshrrev_b32 v155, 17, v59
    v_cmpx_gt_u32 vcc, 1, v154
    ds_write_b64 v155, v[58:59] offset:38912
    s_mov_b64 exec, s[48:49]
    v_and_or_b32 v156, v61, s95, v180
    v_lshrrev_b32 v157, 17, v61
    v_cmpx_gt_u32 vcc, 1, v156
    ds_write_b64 v157, v[60:61] offset:38912
    s_mov_b64 exec, -1
    s_mul_i32 s95, s5, 224
    v_lshrrev_b32 v140, 1, v203
    v_add_u32 v140, s95, v140
K2_NFT:
    s_cmp_eq_u32 s5, 0
    s_waitcnt lgkmcnt(0)
    s_barrier
    ds_read_b64 v[232:233], v228 offset:96
    s_cbranch_scc1 K2_NOS1
    ds_read_b64 v[140:141], v140 offset:38688
    s_mov_b64 exec, s[32:33]
    v_lshrrev_b32 v98, 16, v45
    ds_read_b32 v98, v98 offset:34816
    s_mov_b64 exec, s[34:35]
    v_lshrrev_b32 v99, 16, v47
    ds_read_b32 v99, v99 offset:34816
    s_mov_b64 exec, s[36:37]
    v_lshrrev_b32 v100, 16, v49
    ds_read_b32 v100, v100 offset:34816
    s_mov_b64 exec, s[38:39]
    v_lshrrev_b32 v101, 16, v51
    ds_read_b32 v101, v101 offset:34816
    s_mov_b64 exec, s[40:41]
    v_lshrrev_b32 v102, 16, v53
    ds_read_b32 v102, v102 offset:34816
    s_mov_b64 exec, s[42:43]
    v_lshrrev_b32 v103, 16, v55
    ds_read_b32 v103, v103 offset:34816
    s_mov_b64 exec, s[44:45]
    v_lshrrev_b32 v104, 16, v57
    ds_read_b32 v104, v104 offset:34816
    s_mov_b64 exec, s[46:47]
    v_lshrrev_b32 v105, 16, v59
    ds_read_b32 v105, v105 offset:34816
    s_mov_b64 exec, s[48:49]
    v_lshrrev_b32 v106, 16, v61
    ds_read_b32 v106, v106 offset:34816
    s_mov_b64 exec, -1
    s_waitcnt lgkmcnt(9)
    v_and_b32 v141, 0xffff, v141
    s_mov_b64 exec, 0xfffffff
    buffer_load_dword v202, v140, s[12:15], 0 idxen
    buffer_load_dword v202, v141, s[8:11], 0 idxen
    buffer_load_dword v202, v141, s[16:19], 0 idxen
    s_mov_b64 exec, s[50:51]
    s_cbranch_execz K2_G37
    v_lshrrev_b32 v220, 16, v63
    ds_read_b32 v220, v220 offset:34816
K2_G37:
    s_mov_b64 exec, s[52:53]
    s_cbranch_execz K2_G38
    v_lshrrev_b32 v221, 16, v65
    ds_read_b32 v221, v221 offset:34816
K2_G38:
    s_mov_b64 exec, s[54:55]
    s_cbranch_execz K2_G39
    v_lshrrev_b32 v222, 16, v67
    ds_read_b32 v222, v222 offset:34816
K2_G39:
    s_mov_b64 exec, s[56:57]
    s_cbranch_execz K2_G40
    v_lshrrev_b32 v223, 16, v69
    ds_read_b32 v223, v223 offset:34816
K2_G40:
    s_mov_b64 exec, s[58:59]
    s_cbranch_execz K2_G41
    v_lshrrev_b32 v224, 16, v71
    ds_read_b32 v224, v224 offset:34816
K2_G41:
    s_mov_b64 exec, s[60:61]
    s_cbranch_execz K2_G42
    v_lshrrev_b32 v225, 16, v73
    ds_read_b32 v225, v225 offset:34816
K2_G42:
    s_mov_b64 exec, s[62:63]
    s_cbranch_execz K2_G43
    v_lshrrev_b32 v226, 16, v75
    ds_read_b32 v226, v226 offset:34816
K2_G43:
    s_mov_b64 exec, s[64:65]
    s_cbranch_execz K2_G44
    v_lshrrev_b32 v227, 16, v77
    ds_read_b32 v227, v227 offset:34816
K2_G44:
    s_mov_b64 exec, s[66:67]
    s_cbranch_execz K2_G45
    v_lshrrev_b32 v228, 16, v79
    ds_read_b32 v228, v228 offset:34816
K2_G45:
    s_mov_b64 exec, -1
K2_NOS1:
    s_waitcnt lgkmcnt(0)
    v_readfirstlane_b32 s98, v233
    v_readfirstlane_b32 s93, v232
    s_cmp_le_u32 s98, 3776
    s_cbranch_scc1 K2_FITS
    s_cmp_eq_u32 s92, 15
    s_cbranch_scc1 K2_END0
    s_mov_b32 s92, 15
    s_waitcnt vmcnt(0)
    s_barrier
    s_branch K2_TOP
K2_FITS:
    s_cmp_eq_u32 s5, 0
    s_cbranch_scc1 K2_PLAN
    s_mov_b64 exec, s[32:33]
    v_lshl_add_u32 v98, v172, 3, v98
    ds_write_b64 v98, v[44:45]
    s_mov_b64 exec, s[34:35]
    v_lshl_add_u32 v99, v173, 3, v99
    ds_write_b64 v99, v[46:47]
    s_mov_b64 exec, s[36:37]
    v_lshl_add_u32 v100, v174, 3, v100
    ds_write_b64 v100, v[48:49]
    s_mov_b64 exec, s[38:39]
    v_lshl_add_u32 v101, v175, 3, v101
    ds_write_b64 v101, v[50:51]
    s_mov_b64 exec, s[40:41]
    v_lshl_add_u32 v102, v176, 3, v102
    ds_write_b64 v102, v[52:53]
    s_mov_b64 exec, s[42:43]
    v_lshl_add_u32 v103, v177, 3, v103
    ds_write_b64 v103, v[54:55]
    s_mov_b64 exec, s[44:45]
    v_lshl_add_u32 v104, v178, 3, v104
    ds_write_b64 v104, v[56:57]
    s_mov_b64 exec, s[46:47]
    v_lshl_add_u32 v105, v179, 3, v105
    ds_write_b64 v105, v[58:59]
    s_mov_b64 exec, s[48:49]
    v_lshl_add_u32 v106, v180, 3, v106
    ds_write_b64 v106, v[60:61]
    s_mov_b64 exec, s[50:51]
    s_cbranch_execz K2_G46
    v_lshl_add_u32 v220, v181, 3, v220
    ds_write_b64 v220, v[62:63]
K2_G46:
    s_mov_b64 exec, s[52:53]
    s_cbranch_execz K2_G47
    v_lshl_add_u32 v221, v182, 3, v221
    ds_write_b64 v221, v[64:65]
K2_G47:
    s_mov_b64 exec, s[54:55]
    s_cbranch_execz K2_G48
    v_lshl_add_u32 v222, v183, 3, v222
    ds_write_b64 v222, v[66:67]
K2_G48:
    s_mov_b64 exec, s[56:57]
    s_cbranch_execz K2_G49
    v_lshl_add_u32 v223, v184, 3, v223
    ds_write_b64 v223, v[68:69]
K2_G49:
    s_mov_b64 exec, s[58:59]
    s_cbranch_execz K2_G50
    v_lshl_add_u32 v224, v185, 3, v224
    ds_write_b64 v224, v[70:71]
K2_G50:
    s_mov_b64 exec, s[60:61]
    s_cbranch_execz K2_G51
    v_lshl_add_u32 v225, v186, 3, v225
    ds_write_b64 v225, v[72:73]
K2_G51:
    s_mov_b64 exec, s[62:63]
    s_cbranch_execz K2_G52
    v_lshl_add_u32 v226, v187, 3, v226
    ds_write_b64 v226, v[74:75]
K2_G52:
    s_mov_b64 exec, s[64:65]
    s_cbranch_execz K2_G53
    v_lshl_add_u32 v227, v188, 3, v227
    ds_write_b64 v227, v[76:77]
K2_G53:
    s_mov_b64 exec, s[66:67]
    s_cbranch_execz K2_G54
    v_lshl_add_u32 v228, v189, 3, v228
    ds_write_b64 v228, v[78:79]
K2_G54:
    s_cmp_eq_u32 s97, 0
    s_cbranch_scc1 K2_B3
    s_mov_b64 exec, s[68:69]
    s_cbranch_execz K2_G55
    v_lshrrev_b32 v98, 16, v81
    ds_read_b32 v98, v98 offset:34816
K2_G55:
    s_mov_b64 exec, s[70:71]
    s_cbranch_execz K2_G56
    v_lshrrev_b32 v99, 16, v83
    ds_read_b32 v99, v99 offset:34816
K2_G56:
    s_mov_b64 exec, s[72:73]
    s_cbranch_execz K2_G57
    v_lshrrev_b32 v100, 16, v85
    ds_read_b32 v100, v100 offset:34816
K2_G57:
    s_mov_b64 exec, s[74:75]
    s_cbranch_execz K2_G58
    v_lshrrev_b32 v101, 16, v87
    ds_read_b32 v101, v101 offset:34816
K2_G58:
    s_mov_b64 exec, s[76:77]
    s_cbranch_execz K2_G59
    v_lshrrev_b32 v102, 16, v89
    ds_read_b32 v102, v102 offset:34816
K2_G59:
    s_mov_b64 exec, s[78:79]
    s_cbranch_execz K2_G60
    v_lshrrev_b32 v103, 16, v91
    ds_read_b32 v103, v103 offset:34816
K2_G60:
    s_mov_b64 exec, s[80:81]
    s_cbranch_execz K2_G61
    v_lshrrev_b32 v104, 16, v93
    ds_read_b32 v104, v104 offset:34816
K2_G61:
    s_mov_b64 exec, s[82:83]
    s_cbranch_execz K2_G62
    v_lshrrev_b32 v105, 16, v95
    ds_read_b32 v105, v105 offset:34816
K2_G62:
    s_mov_b64 exec, s[84:85]
    s_cbranch_execz K2_G63
    v_lshrrev_b32 v106, 16, v97
    ds_read_b32 v106, v106 offset:34816
K2_G63:
    s_waitcnt lgkmcnt(0)
    s_mov_b64 exec, s[68:69]
    s_cbranch_execz K2_G64
    v_lshl_add_u32 v98, v190, 3, v98
    ds_write_b64 v98, v[80:81]
K2_G64:
    s_mov_b64 exec, s[70:71]
    s_cbranch_execz K2_G65
    v_lshl_add_u32 v99, v191, 3, v99
    ds_write_b64 v99, v[82:83]
K2_G65:
    s_mov_b64 exec, s[72:73]
    s_cbranch_execz K2_G66
    v_lshl_add_u32 v100, v192, 3, v100
    ds_write_b64 v100, v[84:85]
K2_G66:
    s_mov_b64 exec, s[74:75]
    s_cbranch_execz K2_G67
    v_lshl_add_u32 v101, v193, 3, v101
    ds_write_b64 v101, v[86:87]
K2_G67:
    s_mov_b64 exec, s[76:77]
    s_cbranch_execz K2_G68
    v_lshl_add_u32 v102, v194, 3, v102
    ds_write_b64 v102, v[88:89]
K2_G68:
    s_mov_b64 exec, s[78:79]
    s_cbranch_execz K2_G69
    v_lshl_add_u32 v103, v195, 3, v103
    ds_write_b64 v103, v[90:91]
K2_G69:
    s_mov_b64 exec, s[80:81]
    s_cbranch_execz K2_G70
    v_lshl_add_u32 v104, v196, 3, v104
    ds_write_b64 v104, v[92:93]
K2_G70:
    s_mov_b64 exec, s[82:83]
    s_cbranch_execz K2_G71
    v_lshl_add_u32 v105, v197, 3, v105
    ds_write_b64 v105, v[94:95]
K2_G71:
    s_mov_b64 exec, s[84:85]
    s_cbranch_execz K2_G72
    v_lshl_add_u32 v106, v198, 3, v106
    ds_write_b64 v106, v[96:97]
K2_G72:
    s_branch K2_B3
K2_PLAN:
    s_mul_i32 s99, s98, 3
    s_lshr_b32 s99, s99, 9
    s_max_u32 s99, s99, 1
    v_cvt_f32_u32 v84, v76
    v_add_f32 v84, -0.5, v84
    v_max_f32 v104, v104, v84
    v_cvt_f32_u32 v85, v77
    v_add_f32 v85, -0.5, v85
    v_max_f32 v105, v105, v85
    v_cvt_f32_u32 v86, v78
    v_add_f32 v86, -0.5, v86
    v_max_f32 v106, v106, v86
    v_cvt_f32_u32 v87, v79
    v_add_f32 v87, -0.5, v87
    v_max_f32 v107, v107, v87
K2_DLOOP:
    v_cvt_f32_u32 v220, s99
    v_rcp_f32 v221, v220
    v_add_f32 v88, v104, v220
    v_add_f32 v89, v105, v220
    v_add_f32 v90, v106, v220
    v_add_f32 v91, v107, v220
    v_mul_f32 v88, v88, v221
    v_cvt_u32_f32 v88, v88
    v_mul_f32 v89, v89, v221
    v_cvt_u32_f32 v89, v89
    v_mul_f32 v90, v90, v221
    v_cvt_u32_f32 v90, v90
    v_mul_f32 v91, v91, v221
    v_cvt_u32_f32 v91, v91
    v_add_u32 v222, v88, v89
    v_add3_u32 v222, v222, v90, v91
    s_nop 1
    v_add_u32_dpp v222, v222, v222 row_shr:1 row_mask:0xf bank_mask:0xf
    s_nop 1
    v_add_u32_dpp v222, v222, v222 row_shr:2 row_mask:0xf bank_mask:0xf
    s_nop 1
    v_add_u32_dpp v222, v222, v222 row_shr:4 row_mask:0xf bank_mask:0xf
    s_nop 1
    v_add_u32_dpp v222, v222, v222 row_shr:8 row_mask:0xf bank_mask:0xf
    s_nop 1
    v_add_u32_dpp v222, v222, v222 row_bcast:15 row_mask:0xa bank_mask:0xf
    s_nop 1
    v_add_u32_dpp v222, v222, v222 row_bcast:31 row_mask:0xc bank_mask:0xf
    s_nop 0
    v_readlane_b32 s95, v222, 63
    s_add_u32 s99, s99, 1
    s_cmp_gt_u32 s95, 255
    s_cbranch_scc1 K2_DLOOP
    v_cvt_f32_u32 v92, v88
    v_rcp_f32 v96, v92
    v_add_f32 v92, v92, v84
    v_cmp_eq_u32_e64 s[48:49], 1, v88
    v_lshlrev_b32 v44, 16, v88
    v_cvt_f32_u32 v93, v89
    v_rcp_f32 v97, v93
    v_add_f32 v93, v93, v85
    v_cmp_eq_u32_e64 s[50:51], 1, v89
    v_lshlrev_b32 v45, 16, v89
    v_cvt_f32_u32 v94, v90
    v_rcp_f32 v98, v94
    v_add_f32 v94, v94, v86
    v_cmp_eq_u32_e64 s[52:53], 1, v90
    v_lshlrev_b32 v46, 16, v90
    v_cvt_f32_u32 v95, v91
    v_rcp_f32 v99, v95
    v_add_f32 v95, v95, v87
    v_cmp_eq_u32_e64 s[54:55], 1, v91
    v_lshlrev_b32 v47, 16, v91
    v_cndmask_b32_e64 v44, v44, 1, s[48:49]
    v_cndmask_b32_e64 v45, v45, 1, s[50:51]
    v_cndmask_b32_e64 v46, v46, 1, s[52:53]
    v_cndmask_b32_e64 v47, v47, 1, s[54:55]
    v_mul_f32 v92, v92, v96
    v_cvt_u32_f32 v92, v92
    v_sub_u32 v96, 63, v92
    v_lshlrev_b32 v96, 2, v96
    ds_add_rtn_u32 v100, v96, v44 offset:128
    v_mul_f32 v93, v93, v97
    v_cvt_u32_f32 v93, v93
    v_sub_u32 v97, 63, v93
    v_lshlrev_b32 v97, 2, v97
    ds_add_rtn_u32 v101, v97, v45 offset:128
    v_mul_f32 v94, v94, v98
    v_cvt_u32_f32 v94, v94
    v_sub_u32 v98, 63, v94
    v_lshlrev_b32 v98, 2, v98
    ds_add_rtn_u32 v102, v98, v46 offset:128
    v_mul_f32 v95, v95, v99
    v_cvt_u32_f32 v95, v95
    v_sub_u32 v99, 63, v95
    v_lshlrev_b32 v99, 2, v99
    ds_add_rtn_u32 v103, v99, v47 offset:128
    v_lshrrev_b32 v220, 2, v203
    ds_read_b32 v221, v220 offset:128
    v_add_u32 v222, 0, v250
    v_lshl_or_b32 v172, v222, 24, v60
    v_lshl_or_b32 v172, v92, 18, v172
    v_lshlrev_b32 v173, 3, v88
    v_sub_u32 v222, 1, v92
    v_mad_i32_i24 v76, v222, v88, v76
    v_add_u32 v222, 64, v250
    v_lshl_or_b32 v174, v222, 24, v64
    v_lshl_or_b32 v174, v93, 18, v174
    v_lshlrev_b32 v175, 3, v89
    v_sub_u32 v222, 1, v93
    v_mad_i32_i24 v77, v222, v89, v77
    v_add_u32 v222, 128, v250
    v_lshl_or_b32 v176, v222, 24, v68
    v_lshl_or_b32 v176, v94, 18, v176
    v_lshlrev_b32 v177, 3, v90
    v_sub_u32 v222, 1, v94
    v_mad_i32_i24 v78, v222, v90, v78
    v_add_u32 v222, 192, v250
    v_lshl_or_b32 v178, v222, 24, v72
    v_lshl_or_b32 v178, v95, 18, v178
    v_lshlrev_b32 v179, 3, v91
    v_sub_u32 v222, 1, v95
    v_mad_i32_i24 v79, v222, v91, v79
    v_max3_u32 v224, v88, v89, v90
    v_max_u32 v224, v224, v91
    v_mov_b32 v225, -262136
    s_mov_b32 s99, 0
    s_waitcnt lgkmcnt(0)
    v_mov_b32 v222, v221
    v_and_b32 v57, 0xffff, v221
    v_cmp_ne_u32 vcc, 0, v57
    v_and_b32 v52, 0xffff, v100
    v_lshrrev_b32 v100, 16, v100
    v_add_u32_dpp v222, v222, v222 row_shr:1 row_mask:0xf bank_mask:0xf
    v_min_u32 v48, 1, v52
    v_cndmask_b32_e64 v100, v100, v52, s[48:49]
    v_add_u32_dpp v222, v222, v222 row_shr:2 row_mask:0xf bank_mask:0xf
    v_mad_i32_i24 v48, v48, -10, 20
    v_cndmask_b32_e64 v48, 0, v48, s[48:49]
    v_add_u32_dpp v222, v222, v222 row_shr:4 row_mask:0xf bank_mask:0xf
    v_and_b32 v53, 0xffff, v101
    v_lshrrev_b32 v101, 16, v101
    v_add_u32_dpp v222, v222, v222 row_shr:8 row_mask:0xf bank_mask:0xf
    v_min_u32 v49, 1, v53
    v_cndmask_b32_e64 v101, v101, v53, s[50:51]
    v_add_u32_dpp v222, v222, v222 row_bcast:15 row_mask:0xa bank_mask:0xf
    v_mad_i32_i24 v49, v49, -10, 20
    v_cndmask_b32_e64 v49, 0, v49, s[50:51]
    v_add_u32_dpp v222, v222, v222 row_bcast:31 row_mask:0xc bank_mask:0xf
    v_lshrrev_b32 v58, 16, v222
    v_cndmask_b32 v56, 0, v58, vcc
    v_sub_u32 v222, v222, v221
    v_and_b32 v54, 0xffff, v102
    v_lshrrev_b32 v102, 16, v102
    v_max_u32_dpp v56, v56, v56 row_shr:1 row_mask:0xf bank_mask:0xf
    v_min_u32 v50, 1, v54
    v_cndmask_b32_e64 v102, v102, v54, s[52:53]
    v_max_u32_dpp v56, v56, v56 row_shr:2 row_mask:0xf bank_mask:0xf
    v_mad_i32_i24 v50, v50, -10, 20
    v_cndmask_b32_e64 v50, 0, v50, s[52:53]
    v_max_u32_dpp v56, v56, v56 row_shr:4 row_mask:0xf bank_mask:0xf
    v_and_b32 v55, 0xffff, v103
    v_lshrrev_b32 v103, 16, v103
    v_max_u32_dpp v56, v56, v56 row_shr:8 row_mask:0xf bank_mask:0xf
    v_min_u32 v51, 1, v55
    v_cndmask_b32_e64 v103, v103, v55, s[54:55]
    v_max_u32_dpp v56, v56, v56 row_bcast:15 row_mask:0xa bank_mask:0xf
    v_mad_i32_i24 v51, v51, -10, 20
    v_cndmask_b32_e64 v51, 0, v51, s[54:55]
    v_max_u32_dpp v56, v56, v56 row_bcast:31 row_mask:0xc bank_mask:0xf
    v_and_b32 v57, 0xffff, v222
    v_and_b32 v221, 1, v222
    v_mov_b32_dpp v56, v56 wave_shr:1 row_mask:0xf bank_mask:0xf
    v_cmp_eq_u32 vcc, 1, v221
    v_lshrrev_b32 v222, 16, v222
    v_add3_u32 v222, v222, v57, v221
    v_cndmask_b32 v56, v58, v56, vcc
    v_add_u32 v58, v58, v57
    v_add_u32 v56, v56, v57
    v_lshl_or_b32 v222, v58, 10, v222
    v_lshl_or_b32 v222, v56, 20, v222
    ds_bpermute_b32 v96, v96, v222
    ds_bpermute_b32 v97, v97, v222
    ds_bpermute_b32 v98, v98, v222
    ds_bpermute_b32 v99, v99, v222
    s_waitcnt lgkmcnt(3)
    v_bfe_u32 v96, v96, v48, 10
    v_add_lshl_u32 v96, v96, v100, 2
    v_lshl_or_b32 v222, v88, 16, v96
    v_lshlrev_b32 v96, 1, v96
    ds_write_b32 v220, v222 offset:32768
    s_waitcnt lgkmcnt(3)
    v_bfe_u32 v97, v97, v49, 10
    v_add_lshl_u32 v97, v97, v101, 2
    v_lshl_or_b32 v222, v89, 16, v97
    v_lshlrev_b32 v97, 1, v97
    ds_write_b32 v220, v222 offset:33024
    s_waitcnt lgkmcnt(3)
    v_bfe_u32 v98, v98, v50, 10
    v_add_lshl_u32 v98, v98, v102, 2
    v_lshl_or_b32 v222, v90, 16, v98
    v_lshlrev_b32 v98, 1, v98
    ds_write_b32 v220, v222 offset:33280
    s_waitcnt lgkmcnt(3)
    v_bfe_u32 v99, v99, v51, 10
    v_add_lshl_u32 v99, v99, v103, 2
    v_lshl_or_b32 v222, v91, 16, v99
    v_lshlrev_b32 v99, 1, v99
    ds_write_b32 v220, v222 offset:33536
K2_PLOOP:
    v_cmp_lt_u32_e64 s[32:33], s99, v88
    v_cmp_lt_u32_e64 s[34:35], s99, v89
    v_cmp_lt_u32_e64 s[36:37], s99, v90
    v_cmp_lt_u32_e64 s[38:39], s99, v91
    s_add_u32 s99, s99, 1
    v_cmp_eq_u32_e64 s[40:41], s99, v76
    v_cmp_eq_u32_e64 s[42:43], s99, v77
    v_cmp_eq_u32_e64 s[44:45], s99, v78
    v_cmp_eq_u32_e64 s[46:47], s99, v79
    s_mov_b64 exec, s[32:33]
    ds_write_b64 v96, v[172:173] offset:512
    s_mov_b64 exec, s[34:35]
    ds_write_b64 v97, v[174:175] offset:512
    s_mov_b64 exec, s[36:37]
    ds_write_b64 v98, v[176:177] offset:512
    s_mov_b64 exec, s[38:39]
    ds_write_b64 v99, v[178:179] offset:512
    s_mov_b64 exec, -1
    v_cmp_lt_u32 vcc, s99, v224
    v_cndmask_b32_e64 v222, 8, v225, s[40:41]
    v_add_u32 v172, v172, v222
    v_add_u32 v96, 8, v96
    v_cndmask_b32_e64 v222, 8, v225, s[42:43]
    v_add_u32 v174, v174, v222
    v_add_u32 v97, 8, v97
    v_cndmask_b32_e64 v222, 8, v225, s[44:45]
    v_add_u32 v176, v176, v222
    v_add_u32 v98, 8, v98
    v_cndmask_b32_e64 v222, 8, v225, s[46:47]
    v_add_u32 v178, v178, v222
    v_add_u32 v99, 8, v99
    s_cbranch_vccnz K2_PLOOP
    v_mov_b32 v222, s99
    ds_write_b32 v228, v222 offset:104
    s_waitcnt vmcnt(0)
K2_B3:
    s_mov_b64 exec, -1
    s_lshl_b32 s95, s100, 8
    v_and_b32 v220, 31, v250
    v_lshl_add_u32 v220, v220, 3, s95
    s_mov_b32 s6, 0
    s_waitcnt vmcnt(3) lgkmcnt(0)
    s_barrier
    ds_read_b64 v[220:221], v220 offset:512
    ds_read_b32 v222, v229 offset:104
    s_waitcnt lgkmcnt(0)
    v_bfe_u32 v235, v220, 18, 6
    v_and_b32 v207, 0x3ffff, v220
    v_lshrrev_b32 v249, 24, v220
    v_mov_b32 v206, v221
    v_readfirstlane_b32 s97, v222
    v_cmp_lt_u32_e64 s[28:29], s6, v235
    s_add_u32 s6, s6, 1
    v_add_u32 v221, s4, v249
    buffer_load_dwordx2 v[240:241], v221, s[16:19], 0 idxen
    v_cndmask_b32_e64 v203, 0, v207, s[28:29]
    v_add_u32 v207, v207, v206
    ds_read_b32 v218, v203
    ds_read_u16 v203, v203 offset:4
    v_bfe_u32 v220, v249, 1, 3
    v_lshlrev_b32 v220, 4, v220
    v_lshlrev_b32 v221, 2, v219
    v_xor_b32 v220, v220, v221
    v_lshl_add_u32 v220, v249, 7, v220
    v_add_u32 v220, 100352, v220
    v_xor_b32 v221, 16, v220
    v_xor_b32 v222, 32, v220
    v_xor_b32 v223, 48, v220
    s_waitcnt lgkmcnt(0)
    ds_bpermute_b32 v210, v239, v203 offset:0
    ds_bpermute_b32 v212, v239, v203 offset:32
    ds_bpermute_b32 v214, v239, v203 offset:64
    ds_bpermute_b32 v216, v239, v203 offset:96
    ds_read_b128 v[172:175], v220
    ds_read_b128 v[176:179], v221
    ds_read_b128 v[180:183], v222
    ds_read_b128 v[184:187], v223
    buffer_load_dwordx4 v[188:191], v[218:219], s[12:15], 0 idxen offen
    buffer_load_dwordx2 v[200:201], v203, s[16:19], 0 idxen
    v_cmp_lt_u32_e64 s[30:31], s6, v235
    s_add_u32 s6, s6, 1
    s_cmp_eq_u64 s[28:29], 0
    s_cbranch_scc1 K2_EMPTY
    s_waitcnt lgkmcnt(4)
    s_add_u32 m0, s94, 0
    s_nop 0
    buffer_load_dwordx4 v[210:211], s[8:11], 0 idxen offen lds
    s_add_u32 m0, s94, 1024
    s_nop 0
    buffer_load_dwordx4 v[212:213], s[8:11], 0 idxen offen lds
    s_add_u32 m0, s94, 2048
    s_nop 0
    buffer_load_dwordx4 v[214:215], s[8:11], 0 idxen offen lds
    s_add_u32 m0, s94, 3072
    s_nop 0
    buffer_load_dwordx4 v[216:217], s[8:11], 0 idxen offen lds
    v_cndmask_b32_e64 v203, 0, v207, s[30:31]
    v_add_u32 v207, v207, v206
    ds_read_b32 v218, v203
    ds_read_u16 v203, v203 offset:4
    s_waitcnt lgkmcnt(0)
    ds_bpermute_b32 v210, v239, v203 offset:0
    ds_bpermute_b32 v212, v239, v203 offset:32
    ds_bpermute_b32 v214, v239, v203 offset:64
    ds_bpermute_b32 v216, v239, v203 offset:96
    buffer_load_dwordx4 v[192:195], v[218:219], s[12:15], 0 idxen offen
    buffer_load_dwordx2 v[204:205], v203, s[16:19], 0 idxen
    v_cmp_lt_u32_e64 s[32:33], s6, v235
    s_add_u32 s6, s6, 1
    s_waitcnt lgkmcnt(0)
    s_add_u32 m0, s94, 32768
    s_nop 0
    buffer_load_dwordx4 v[210:211], s[8:11], 0 idxen offen lds
    s_add_u32 m0, s94, 33792
    s_nop 0
    buffer_load_dwordx4 v[212:213], s[8:11], 0 idxen offen lds
    s_add_u32 m0, s94, 34816
    s_nop 0
    buffer_load_dwordx4 v[214:215], s[8:11], 0 idxen offen lds
    s_add_u32 m0, s94, 35840
    s_nop 0
    buffer_load_dwordx4 v[216:217], s[8:11], 0 idxen offen lds
    v_cndmask_b32_e64 v203, 0, v207, s[32:33]
    v_add_u32 v207, v207, v206
    ds_read_b32 v218, v203
    ds_read_u16 v203, v203 offset:4
    s_waitcnt lgkmcnt(0)
    ds_bpermute_b32 v210, v239, v203 offset:0
    ds_bpermute_b32 v212, v239, v203 offset:32
    ds_bpermute_b32 v214, v239, v203 offset:64
    ds_bpermute_b32 v216, v239, v203 offset:96
    v_and_b32 v221, 63, v250
    v_lshlrev_b32 v220, 4, v221
    v_lshlrev_b32 v221, 2, v221
    v_add_u32 v220, 138240, v220
    v_lshlrev_b32 v222, 3, v219
    v_add_u32 v221, 156672, v221
    v_add_u32 v222, 157696, v222
    ds_read_b128 v[140:143], v220 offset:0
    ds_read_b128 v[144:147], v220 offset:1024
    ds_read_b128 v[148:151], v220 offset:2048
    ds_read_b128 v[152:155], v220 offset:3072
    ds_read_b128 v[156:159], v220 offset:4096
    ds_read_b128 v[160:163], v220 offset:5120
    ds_read_b128 v[164:167], v220 offset:6144
    ds_read_b128 v[168:171], v220 offset:7168
    ds_read_b128 v[0:3], v220 offset:8192
    ds_read_b128 v[4:7], v220 offset:9216
    ds_read_b128 v[8:11], v220 offset:10240
    ds_read_b128 v[12:15], v220 offset:11264
    ds_read_b128 v[16:19], v220 offset:12288
    ds_read_b128 v[20:23], v220 offset:13312
    ds_read_b128 v[24:27], v220 offset:14336
    ds_read_b128 v[28:31], v220 offset:15360
    ds_read_b128 v[32:35], v220 offset:16384
    ds_read_b128 v[36:39], v220 offset:17408
    ds_read_b32 v40, v221
    ds_read_b32 v42, v221 offset:256
    ds_read_b128 v[108:111], v222 offset:0
    ds_read_b128 v[112:115], v222 offset:16
    ds_read_b128 v[116:119], v222 offset:32
    ds_read_b128 v[120:123], v222 offset:48
    ds_read_b128 v[124:127], v222 offset:64
    ds_read_b128 v[128:131], v222 offset:80
    ds_read_b128 v[132:135], v222 offset:96
    ds_read_b128 v[136:139], v222 offset:112
    v_mov_b32 v76, 0
    v_mov_b32 v77, 0
    v_mov_b32 v78, 0
    v_mov_b32 v79, 0
    v_mov_b32 v80, 0
    v_mov_b32 v81, 0
    v_mov_b32 v82, 0
    v_mov_b32 v83, 0
    v_mov_b32 v84, 0
    v_mov_b32 v85, 0
    v_mov_b32 v86, 0
    v_mov_b32 v87, 0
    v_mov_b32 v88, 0
    v_mov_b32 v89, 0
    v_mov_b32 v90, 0
    v_mov_b32 v91, 0
    v_mov_b32 v92, 0
    v_mov_b32 v93, 0
    v_mov_b32 v94, 0
    v_mov_b32 v95, 0
    v_mov_b32 v96, 0
    v_mov_b32 v97, 0
    v_mov_b32 v98, 0
    v_mov_b32 v99, 0
    v_mov_b32 v100, 0
    v_mov_b32 v101, 0
    v_mov_b32 v102, 0
    v_mov_b32 v103, 0
    v_mov_b32 v104, 0
    v_mov_b32 v105, 0
    v_mov_b32 v106, 0
    v_mov_b32 v107, 0
    v_mov_b32 v244, 0
    v_mov_b32 v245, 0
    v_mov_b32 v246, 0
    v_mov_b32 v247, 0
    s_waitcnt lgkmcnt(0)
    v_mfma_f32_32x32x16_bf16 v[44:59], v[140:143], v[172:175], 0
    v_mfma_f32_32x32x16_bf16 v[60:75], v[156:159], v[172:175], 0
    v_mfma_f32_32x32x16_bf16 v[44:59], v[144:147], v[176:179], v[44:59]
    v_mfma_f32_32x32x16_bf16 v[60:75], v[160:163], v[176:179], v[60:75]
    v_mfma_f32_32x32x16_bf16 v[44:59], v[148:151], v[180:183], v[44:59]
    v_mfma_f32_32x32x16_bf16 v[60:75], v[164:167], v[180:183], v[60:75]
    v_mfma_f32_32x32x16_bf16 v[44:59], v[152:155], v[184:187], v[44:59]
    v_mfma_f32_32x32x16_bf16 v[60:75], v[168:171], v[184:187], v[60:75]
    s_waitcnt vmcnt(6)
    ds_read_b128 v[172:175], v251 offset:0
    ds_read_b128 v[176:179], v252 offset:0
    ds_read_b128 v[180:183], v253 offset:0
    ds_read_b128 v[184:187], v254 offset:0
    v_mov_b32 v242, v241
    v_and_b32 v241, 0xffff0000, v240
    v_lshlrev_b32 v240, 16, v240
    v_lshlrev_b32 v232, 16, v200
    v_and_b32 v233, 0xffff0000, v200
    v_sub_f32 v234, v242, v201
    v_pk_add_f32 v[232:233], v[240:241], v[232:233] neg_lo:[0,1] neg_hi:[0,1]
    v_mul_f32 v208, v232, v232
    v_fmac_f32 v208, v233, v233
    v_fmac_f32 v208, v234, v234
    v_cvt_pk_bf16_f32 v208, v208, v208
    buffer_load_dwordx4 v[196:199], v[218:219], s[12:15], 0 idxen offen
    buffer_load_dwordx2 v[200:201], v203, s[16:19], 0 idxen
    s_waitcnt lgkmcnt(0)
    s_add_u32 m0, s94, 0
    s_nop 0
    buffer_load_dwordx4 v[210:211], s[8:11], 0 idxen offen lds
    s_add_u32 m0, s94, 1024
    s_nop 0
    buffer_load_dwordx4 v[212:213], s[8:11], 0 idxen offen lds
    s_add_u32 m0, s94, 2048
    s_nop 0
    buffer_load_dwordx4 v[214:215], s[8:11], 0 idxen offen lds
    s_add_u32 m0, s94, 3072
    s_nop 0
    buffer_load_dwordx4 v[216:217], s[8:11], 0 idxen offen lds
    v_mfma_f32_32x32x8_bf16 v[140:155], v[40:41], v[208:209], v[44:59]
    v_mfma_f32_32x32x16_bf16 v[140:155], v[32:35], v[188:191], v[140:155]
    v_mfma_f32_32x32x16_bf16 v[140:155], v[0:3], v[172:175], v[140:155]
    v_mfma_f32_32x32x16_bf16 v[140:155], v[4:7], v[176:179], v[140:155]
    v_mfma_f32_32x32x16_bf16 v[140:155], v[8:11], v[180:183], v[140:155]
    v_mfma_f32_32x32x16_bf16 v[140:155], v[12:15], v[184:187], v[140:155]
    s_nop 7
K2_LOOP:
    v_cmp_lt_u32_e64 s[34:35], s6, v235
    s_add_u32 s6, s6, 1
    v_mfma_f32_32x32x8_bf16 v[156:171], v[42:43], v[208:209], v[60:75]
    v_cndmask_b32_e64 v203, 0, v207, s[34:35]
    v_add_u32 v207, v207, v206
    ds_read_b32 v218, v203
    ds_read_u16 v203, v203 offset:4
    s_mov_b64 exec, s[28:29]
    v_exp_f32 v220, v140
    v_exp_f32 v221, v141
    v_exp_f32 v222, v142
    v_exp_f32 v223, v143
    v_mfma_f32_32x32x16_bf16 v[156:171], v[36:39], v[188:191], v[156:171]
    v_exp_f32 v224, v144
    v_exp_f32 v225, v145
    v_exp_f32 v226, v146
    v_exp_f32 v227, v147
    v_pk_add_f32 v[220:221], v[220:221], 1.0 op_sel_hi:[1,0]
    v_pk_add_f32 v[222:223], v[222:223], 1.0 op_sel_hi:[1,0]
    v_mfma_f32_32x32x16_bf16 v[156:171], v[16:19], v[172:175], v[156:171]
    v_pk_add_f32 v[224:225], v[224:225], 1.0 op_sel_hi:[1,0]
    v_pk_add_f32 v[226:227], v[226:227], 1.0 op_sel_hi:[1,0]
    v_rcp_f32 v220, v220
    v_rcp_f32 v221, v221
    v_rcp_f32 v222, v222
    v_rcp_f32 v223, v223
    v_mfma_f32_32x32x16_bf16 v[156:171], v[20:23], v[176:179], v[156:171]
    v_rcp_f32 v224, v224
    v_rcp_f32 v225, v225
    v_rcp_f32 v226, v226
    v_rcp_f32 v227, v227
    s_waitcnt lgkmcnt(0)
    s_mov_b64 exec, -1
    ds_bpermute_b32 v210, v239, v203 offset:0
    ds_bpermute_b32 v212, v239, v203 offset:32
    ds_bpermute_b32 v214, v239, v203 offset:64
    ds_bpermute_b32 v216, v239, v203 offset:96
    s_mov_b64 exec, s[28:29]
    v_pk_fma_f32 v[76:77], v[140:141], v[220:221], v[76:77]
    v_pk_fma_f32 v[78:79], v[142:143], v[222:223], v[78:79]
    v_mfma_f32_32x32x16_bf16 v[156:171], v[24:27], v[180:183], v[156:171]
    v_pk_fma_f32 v[80:81], v[144:145], v[224:225], v[80:81]
    v_pk_fma_f32 v[82:83], v[146:147], v[226:227], v[82:83]
    v_pk_mul_f32 v[228:229], v[76:77], v[108:109]
    v_pk_mul_f32 v[230:231], v[78:79], v[110:111]
    v_pk_fma_f32 v[228:229], v[80:81], v[112:113], v[228:229]
    v_pk_fma_f32 v[230:231], v[82:83], v[114:115], v[230:231]
    v_exp_f32 v220, v148
    v_exp_f32 v221, v149
    v_mfma_f32_32x32x16_bf16 v[156:171], v[28:31], v[184:187], v[156:171]
    v_exp_f32 v222, v150
    v_exp_f32 v223, v151
    v_exp_f32 v224, v152
    v_exp_f32 v225, v153
    v_exp_f32 v226, v154
    v_exp_f32 v227, v155
    s_waitcnt vmcnt(6)
    ds_read_b128 v[172:175], v251 offset:32768
    ds_read_b128 v[176:179], v252 offset:32768
    ds_read_b128 v[180:183], v253 offset:32768
    ds_read_b128 v[184:187], v254 offset:32768
    v_lshlrev_b32 v236, 16, v204
    v_and_b32 v237, 0xffff0000, v204
    v_sub_f32 v238, v242, v205
    v_pk_add_f32 v[236:237], v[240:241], v[236:237] neg_lo:[0,1] neg_hi:[0,1]
    v_mul_f32 v208, v236, v236
    v_fmac_f32 v208, v237, v237
    v_fmac_f32 v208, v238, v238
    v_cvt_pk_bf16_f32 v208, v208, v208
    v_pk_add_f32 v[220:221], v[220:221], 1.0 op_sel_hi:[1,0]
    v_pk_add_f32 v[222:223], v[222:223], 1.0 op_sel_hi:[1,0]
    v_pk_add_f32 v[224:225], v[224:225], 1.0 op_sel_hi:[1,0]
    v_pk_add_f32 v[226:227], v[226:227], 1.0 op_sel_hi:[1,0]
    v_rcp_f32 v220, v220
    v_rcp_f32 v221, v221
    v_rcp_f32 v222, v222
    v_rcp_f32 v223, v223
    v_rcp_f32 v224, v224
    v_rcp_f32 v225, v225
    v_rcp_f32 v226, v226
    v_rcp_f32 v227, v227
    s_waitcnt lgkmcnt(0)
    v_pk_fma_f32 v[84:85], v[148:149], v[220:221], v[84:85]
    v_pk_fma_f32 v[86:87], v[150:151], v[222:223], v[86:87]
    v_pk_fma_f32 v[88:89], v[152:153], v[224:225], v[88:89]
    v_pk_fma_f32 v[90:91], v[154:155], v[226:227], v[90:91]
    v_pk_fma_f32 v[228:229], v[84:85], v[116:117], v[228:229]
    v_pk_fma_f32 v[230:231], v[86:87], v[118:119], v[230:231]
    v_pk_fma_f32 v[228:229], v[88:89], v[120:121], v[228:229]
    v_pk_fma_f32 v[230:231], v[90:91], v[122:123], v[230:231]
    v_mfma_f32_32x32x8_bf16 v[140:155], v[40:41], v[208:209], v[44:59]
    v_exp_f32 v220, v156
    v_exp_f32 v221, v157
    v_exp_f32 v222, v158
    v_exp_f32 v223, v159
    v_mfma_f32_32x32x16_bf16 v[140:155], v[32:35], v[192:195], v[140:155]
    v_exp_f32 v224, v160
    v_exp_f32 v225, v161
    v_exp_f32 v226, v162
    v_exp_f32 v227, v163
    v_pk_add_f32 v[220:221], v[220:221], 1.0 op_sel_hi:[1,0]
    v_pk_add_f32 v[222:223], v[222:223], 1.0 op_sel_hi:[1,0]
    v_mfma_f32_32x32x16_bf16 v[140:155], v[0:3], v[172:175], v[140:155]
    v_pk_add_f32 v[224:225], v[224:225], 1.0 op_sel_hi:[1,0]
    v_pk_add_f32 v[226:227], v[226:227], 1.0 op_sel_hi:[1,0]
    v_rcp_f32 v220, v220
    v_rcp_f32 v221, v221
    v_rcp_f32 v222, v222
    v_rcp_f32 v223, v223
    v_mfma_f32_32x32x16_bf16 v[140:155], v[4:7], v[176:179], v[140:155]
    v_rcp_f32 v224, v224
    v_rcp_f32 v225, v225
    v_rcp_f32 v226, v226
    v_rcp_f32 v227, v227
    v_pk_fma_f32 v[92:93], v[156:157], v[220:221], v[92:93]
    v_pk_fma_f32 v[94:95], v[158:159], v[222:223], v[94:95]
    v_mfma_f32_32x32x16_bf16 v[140:155], v[8:11], v[180:183], v[140:155]
    v_pk_fma_f32 v[96:97], v[160:161], v[224:225], v[96:97]
    v_pk_fma_f32 v[98:99], v[162:163], v[226:227], v[98:99]
    v_pk_fma_f32 v[228:229], v[92:93], v[124:125], v[228:229]
    v_pk_fma_f32 v[230:231], v[94:95], v[126:127], v[230:231]
    v_pk_fma_f32 v[228:229], v[96:97], v[128:129], v[228:229]
    v_pk_fma_f32 v[230:231], v[98:99], v[130:131], v[230:231]
    v_exp_f32 v220, v164
    v_exp_f32 v221, v165
    v_mfma_f32_32x32x16_bf16 v[140:155], v[12:15], v[184:187], v[140:155]
    v_exp_f32 v222, v166
    v_exp_f32 v223, v167
    v_exp_f32 v224, v168
    v_exp_f32 v225, v169
    v_exp_f32 v226, v170
    v_exp_f32 v227, v171
    s_mov_b64 exec, -1
    s_add_u32 m0, s94, 32768
    s_nop 0
    buffer_load_dwordx4 v[210:211], s[8:11], 0 idxen offen lds
    s_add_u32 m0, s94, 33792
    s_nop 0
    buffer_load_dwordx4 v[212:213], s[8:11], 0 idxen offen lds
    s_add_u32 m0, s94, 34816
    s_nop 0
    buffer_load_dwordx4 v[214:215], s[8:11], 0 idxen offen lds
    s_add_u32 m0, s94, 35840
    s_nop 0
    buffer_load_dwordx4 v[216:217], s[8:11], 0 idxen offen lds
    s_mov_b64 exec, s[28:29]
    v_pk_add_f32 v[220:221], v[220:221], 1.0 op_sel_hi:[1,0]
    v_pk_add_f32 v[222:223], v[222:223], 1.0 op_sel_hi:[1,0]
    v_pk_add_f32 v[224:225], v[224:225], 1.0 op_sel_hi:[1,0]
    v_pk_add_f32 v[226:227], v[226:227], 1.0 op_sel_hi:[1,0]
    v_rcp_f32 v220, v220
    v_rcp_f32 v221, v221
    v_rcp_f32 v222, v222
    v_rcp_f32 v223, v223
    v_rcp_f32 v224, v224
    v_rcp_f32 v225, v225
    v_rcp_f32 v226, v226
    v_rcp_f32 v227, v227
    v_pk_fma_f32 v[100:101], v[164:165], v[220:221], v[100:101]
    v_pk_fma_f32 v[102:103], v[166:167], v[222:223], v[102:103]
    v_pk_fma_f32 v[104:105], v[168:169], v[224:225], v[104:105]
    v_pk_fma_f32 v[106:107], v[170:171], v[226:227], v[106:107]
    v_pk_fma_f32 v[228:229], v[100:101], v[132:133], v[228:229]
    v_pk_fma_f32 v[230:231], v[102:103], v[134:135], v[230:231]
    v_pk_fma_f32 v[228:229], v[104:105], v[136:137], v[228:229]
    v_pk_fma_f32 v[230:231], v[106:107], v[138:139], v[230:231]
    s_mov_b64 exec, -1
    buffer_load_dwordx4 v[188:191], v[218:219], s[12:15], 0 idxen offen
    buffer_load_dwordx2 v[204:205], v203, s[16:19], 0 idxen
    s_mov_b64 exec, s[28:29]
    v_pk_add_f32 v[228:229], v[228:229], v[230:231]
    s_cmp_eq_u64 s[30:31], 0
    v_add_f32 v243, v228, v229
    v_sub_f32 v248, v243, v247
    v_pk_fma_f32 v[244:245], v[232:233], v[248:249], v[244:245] op_sel_hi:[1,0,1]
    v_fmac_f32 v246, v234, v248
    s_mov_b64 exec, -1
    s_cbranch_scc1 K2_DONE
    v_cmp_lt_u32_e64 s[36:37], s6, v235
    s_add_u32 s6, s6, 1
    v_mfma_f32_32x32x8_bf16 v[156:171], v[42:43], v[208:209], v[60:75]
    v_cndmask_b32_e64 v203, 0, v207, s[36:37]
    v_add_u32 v207, v207, v206
    ds_read_b32 v218, v203
    ds_read_u16 v203, v203 offset:4
    s_mov_b64 exec, s[30:31]
    v_exp_f32 v220, v140
    v_exp_f32 v221, v141
    v_exp_f32 v222, v142
    v_exp_f32 v223, v143
    v_mfma_f32_32x32x16_bf16 v[156:171], v[36:39], v[192:195], v[156:171]
    v_exp_f32 v224, v144
    v_exp_f32 v225, v145
    v_exp_f32 v226, v146
    v_exp_f32 v227, v147
    v_pk_add_f32 v[220:221], v[220:221], 1.0 op_sel_hi:[1,0]
    v_pk_add_f32 v[222:223], v[222:223], 1.0 op_sel_hi:[1,0]
    v_mfma_f32_32x32x16_bf16 v[156:171], v[16:19], v[172:175], v[156:171]
    v_pk_add_f32 v[224:225], v[224:225], 1.0 op_sel_hi:[1,0]
    v_pk_add_f32 v[226:227], v[226:227], 1.0 op_sel_hi:[1,0]
    v_rcp_f32 v220, v220
    v_rcp_f32 v221, v221
    v_rcp_f32 v222, v222
    v_rcp_f32 v223, v223
    v_mfma_f32_32x32x16_bf16 v[156:171], v[20:23], v[176:179], v[156:171]
    v_rcp_f32 v224, v224
    v_rcp_f32 v225, v225
    v_rcp_f32 v226, v226
    v_rcp_f32 v227, v227
    s_waitcnt lgkmcnt(0)
    s_mov_b64 exec, -1
    ds_bpermute_b32 v210, v239, v203 offset:0
    ds_bpermute_b32 v212, v239, v203 offset:32
    ds_bpermute_b32 v214, v239, v203 offset:64
    ds_bpermute_b32 v216, v239, v203 offset:96
    s_mov_b64 exec, s[30:31]
    v_pk_fma_f32 v[76:77], v[140:141], v[220:221], v[76:77]
    v_pk_fma_f32 v[78:79], v[142:143], v[222:223], v[78:79]
    v_mfma_f32_32x32x16_bf16 v[156:171], v[24:27], v[180:183], v[156:171]
    v_pk_fma_f32 v[80:81], v[144:145], v[224:225], v[80:81]
    v_pk_fma_f32 v[82:83], v[146:147], v[226:227], v[82:83]
    v_pk_mul_f32 v[228:229], v[76:77], v[108:109]
    v_pk_mul_f32 v[230:231], v[78:79], v[110:111]
    v_pk_fma_f32 v[228:229], v[80:81], v[112:113], v[228:229]
    v_pk_fma_f32 v[230:231], v[82:83], v[114:115], v[230:231]
    v_exp_f32 v220, v148
    v_exp_f32 v221, v149
    v_mfma_f32_32x32x16_bf16 v[156:171], v[28:31], v[184:187], v[156:171]
    v_exp_f32 v222, v150
    v_exp_f32 v223, v151
    v_exp_f32 v224, v152
    v_exp_f32 v225, v153
    v_exp_f32 v226, v154
    v_exp_f32 v227, v155
    s_waitcnt vmcnt(6)
    ds_read_b128 v[172:175], v251 offset:0
    ds_read_b128 v[176:179], v252 offset:0
    ds_read_b128 v[180:183], v253 offset:0
    ds_read_b128 v[184:187], v254 offset:0
    v_lshlrev_b32 v232, 16, v200
    v_and_b32 v233, 0xffff0000, v200
    v_sub_f32 v234, v242, v201
    v_pk_add_f32 v[232:233], v[240:241], v[232:233] neg_lo:[0,1] neg_hi:[0,1]
    v_mul_f32 v208, v232, v232
    v_fmac_f32 v208, v233, v233
    v_fmac_f32 v208, v234, v234
    v_cvt_pk_bf16_f32 v208, v208, v208
    v_pk_add_f32 v[220:221], v[220:221], 1.0 op_sel_hi:[1,0]
    v_pk_add_f32 v[222:223], v[222:223], 1.0 op_sel_hi:[1,0]
    v_pk_add_f32 v[224:225], v[224:225], 1.0 op_sel_hi:[1,0]
    v_pk_add_f32 v[226:227], v[226:227], 1.0 op_sel_hi:[1,0]
    v_rcp_f32 v220, v220
    v_rcp_f32 v221, v221
    v_rcp_f32 v222, v222
    v_rcp_f32 v223, v223
    v_rcp_f32 v224, v224
    v_rcp_f32 v225, v225
    v_rcp_f32 v226, v226
    v_rcp_f32 v227, v227
    s_waitcnt lgkmcnt(0)
    v_pk_fma_f32 v[84:85], v[148:149], v[220:221], v[84:85]
    v_pk_fma_f32 v[86:87], v[150:151], v[222:223], v[86:87]
    v_pk_fma_f32 v[88:89], v[152:153], v[224:225], v[88:89]
    v_pk_fma_f32 v[90:91], v[154:155], v[226:227], v[90:91]
    v_pk_fma_f32 v[228:229], v[84:85], v[116:117], v[228:229]
    v_pk_fma_f32 v[230:231], v[86:87], v[118:119], v[230:231]
    v_pk_fma_f32 v[228:229], v[88:89], v[120:121], v[228:229]
    v_pk_fma_f32 v[230:231], v[90:91], v[122:123], v[230:231]
    v_mfma_f32_32x32x8_bf16 v[140:155], v[40:41], v[208:209], v[44:59]
    v_exp_f32 v220, v156
    v_exp_f32 v221, v157
    v_exp_f32 v222, v158
    v_exp_f32 v223, v159
    v_mfma_f32_32x32x16_bf16 v[140:155], v[32:35], v[196:199], v[140:155]
    v_exp_f32 v224, v160
    v_exp_f32 v225, v161
    v_exp_f32 v226, v162
    v_exp_f32 v227, v163
    v_pk_add_f32 v[220:221], v[220:221], 1.0 op_sel_hi:[1,0]
    v_pk_add_f32 v[222:223], v[222:223], 1.0 op_sel_hi:[1,0]
    v_mfma_f32_32x32x16_bf16 v[140:155], v[0:3], v[172:175], v[140:155]
    v_pk_add_f32 v[224:225], v[224:225], 1.0 op_sel_hi:[1,0]
    v_pk_add_f32 v[226:227], v[226:227], 1.0 op_sel_hi:[1,0]
    v_rcp_f32 v220, v220
    v_rcp_f32 v221, v221
    v_rcp_f32 v222, v222
    v_rcp_f32 v223, v223
    v_mfma_f32_32x32x16_bf16 v[140:155], v[4:7], v[176:179], v[140:155]
    v_rcp_f32 v224, v224
    v_rcp_f32 v225, v225
    v_rcp_f32 v226, v226
    v_rcp_f32 v227, v227
    v_pk_fma_f32 v[92:93], v[156:157], v[220:221], v[92:93]
    v_pk_fma_f32 v[94:95], v[158:159], v[222:223], v[94:95]
    v_mfma_f32_32x32x16_bf16 v[140:155], v[8:11], v[180:183], v[140:155]
    v_pk_fma_f32 v[96:97], v[160:161], v[224:225], v[96:97]
    v_pk_fma_f32 v[98:99], v[162:163], v[226:227], v[98:99]
    v_pk_fma_f32 v[228:229], v[92:93], v[124:125], v[228:229]
    v_pk_fma_f32 v[230:231], v[94:95], v[126:127], v[230:231]
    v_pk_fma_f32 v[228:229], v[96:97], v[128:129], v[228:229]
    v_pk_fma_f32 v[230:231], v[98:99], v[130:131], v[230:231]
    v_exp_f32 v220, v164
    v_exp_f32 v221, v165
    v_mfma_f32_32x32x16_bf16 v[140:155], v[12:15], v[184:187], v[140:155]
    v_exp_f32 v222, v166
    v_exp_f32 v223, v167
    v_exp_f32 v224, v168
    v_exp_f32 v225, v169
    v_exp_f32 v226, v170
    v_exp_f32 v227, v171
    s_mov_b64 exec, -1
    s_add_u32 m0, s94, 0
    s_nop 0
    buffer_load_dwordx4 v[210:211], s[8:11], 0 idxen offen lds
    s_add_u32 m0, s94, 1024
    s_nop 0
    buffer_load_dwordx4 v[212:213], s[8:11], 0 idxen offen lds
    s_add_u32 m0, s94, 2048
    s_nop 0
    buffer_load_dwordx4 v[214:215], s[8:11], 0 idxen offen lds
    s_add_u32 m0, s94, 3072
    s_nop 0
    buffer_load_dwordx4 v[216:217], s[8:11], 0 idxen offen lds
    s_mov_b64 exec, s[30:31]
    v_pk_add_f32 v[220:221], v[220:221], 1.0 op_sel_hi:[1,0]
    v_pk_add_f32 v[222:223], v[222:223], 1.0 op_sel_hi:[1,0]
    v_pk_add_f32 v[224:225], v[224:225], 1.0 op_sel_hi:[1,0]
    v_pk_add_f32 v[226:227], v[226:227], 1.0 op_sel_hi:[1,0]
    v_rcp_f32 v220, v220
    v_rcp_f32 v221, v221
    v_rcp_f32 v222, v222
    v_rcp_f32 v223, v223
    v_rcp_f32 v224, v224
    v_rcp_f32 v225, v225
    v_rcp_f32 v226, v226
    v_rcp_f32 v227, v227
    v_pk_fma_f32 v[100:101], v[164:165], v[220:221], v[100:101]
    v_pk_fma_f32 v[102:103], v[166:167], v[222:223], v[102:103]
    v_pk_fma_f32 v[104:105], v[168:169], v[224:225], v[104:105]
    v_pk_fma_f32 v[106:107], v[170:171], v[226:227], v[106:107]
    v_pk_fma_f32 v[228:229], v[100:101], v[132:133], v[228:229]
    v_pk_fma_f32 v[230:231], v[102:103], v[134:135], v[230:231]
    v_pk_fma_f32 v[228:229], v[104:105], v[136:137], v[228:229]
    v_pk_fma_f32 v[230:231], v[106:107], v[138:139], v[230:231]
    s_mov_b64 exec, -1
    buffer_load_dwordx4 v[192:195], v[218:219], s[12:15], 0 idxen offen
    buffer_load_dwordx2 v[200:201], v203, s[16:19], 0 idxen
    s_mov_b64 exec, s[30:31]
    v_pk_add_f32 v[228:229], v[228:229], v[230:231]
    s_cmp_eq_u64 s[32:33], 0
    v_add_f32 v247, v228, v229
    v_sub_f32 v248, v247, v243
    v_pk_fma_f32 v[244:245], v[236:237], v[248:249], v[244:245] op_sel_hi:[1,0,1]
    v_fmac_f32 v246, v238, v248
    s_mov_b64 exec, -1
    s_cbranch_scc1 K2_DONE
    v_cmp_lt_u32_e64 s[38:39], s6, v235
    s_add_u32 s6, s6, 1
    v_mfma_f32_32x32x8_bf16 v[156:171], v[42:43], v[208:209], v[60:75]
    v_cndmask_b32_e64 v203, 0, v207, s[38:39]
    v_add_u32 v207, v207, v206
    ds_read_b32 v218, v203
    ds_read_u16 v203, v203 offset:4
    s_mov_b64 exec, s[32:33]
    v_exp_f32 v220, v140
    v_exp_f32 v221, v141
    v_exp_f32 v222, v142
    v_exp_f32 v223, v143
    v_mfma_f32_32x32x16_bf16 v[156:171], v[36:39], v[196:199], v[156:171]
    v_exp_f32 v224, v144
    v_exp_f32 v225, v145
    v_exp_f32 v226, v146
    v_exp_f32 v227, v147
    v_pk_add_f32 v[220:221], v[220:221], 1.0 op_sel_hi:[1,0]
    v_pk_add_f32 v[222:223], v[222:223], 1.0 op_sel_hi:[1,0]
    v_mfma_f32_32x32x16_bf16 v[156:171], v[16:19], v[172:175], v[156:171]
    v_pk_add_f32 v[224:225], v[224:225], 1.0 op_sel_hi:[1,0]
    v_pk_add_f32 v[226:227], v[226:227], 1.0 op_sel_hi:[1,0]
    v_rcp_f32 v220, v220
    v_rcp_f32 v221, v221
    v_rcp_f32 v222, v222
    v_rcp_f32 v223, v223
    v_mfma_f32_32x32x16_bf16 v[156:171], v[20:23], v[176:179], v[156:171]
    v_rcp_f32 v224, v224
    v_rcp_f32 v225, v225
    v_rcp_f32 v226, v226
    v_rcp_f32 v227, v227
    s_waitcnt lgkmcnt(0)
    s_mov_b64 exec, -1
    ds_bpermute_b32 v210, v239, v203 offset:0
    ds_bpermute_b32 v212, v239, v203 offset:32
    ds_bpermute_b32 v214, v239, v203 offset:64
    ds_bpermute_b32 v216, v239, v203 offset:96
    s_mov_b64 exec, s[32:33]
    v_pk_fma_f32 v[76:77], v[140:141], v[220:221], v[76:77]
    v_pk_fma_f32 v[78:79], v[142:143], v[222:223], v[78:79]
    v_mfma_f32_32x32x16_bf16 v[156:171], v[24:27], v[180:183], v[156:171]
    v_pk_fma_f32 v[80:81], v[144:145], v[224:225], v[80:81]
    v_pk_fma_f32 v[82:83], v[146:147], v[226:227], v[82:83]
    v_pk_mul_f32 v[228:229], v[76:77], v[108:109]
    v_pk_mul_f32 v[230:231], v[78:79], v[110:111]
    v_pk_fma_f32 v[228:229], v[80:81], v[112:113], v[228:229]
    v_pk_fma_f32 v[230:231], v[82:83], v[114:115], v[230:231]
    v_exp_f32 v220, v148
    v_exp_f32 v221, v149
    v_mfma_f32_32x32x16_bf16 v[156:171], v[28:31], v[184:187], v[156:171]
    v_exp_f32 v222, v150
    v_exp_f32 v223, v151
    v_exp_f32 v224, v152
    v_exp_f32 v225, v153
    v_exp_f32 v226, v154
    v_exp_f32 v227, v155
    s_waitcnt vmcnt(6)
    ds_read_b128 v[172:175], v251 offset:32768
    ds_read_b128 v[176:179], v252 offset:32768
    ds_read_b128 v[180:183], v253 offset:32768
    ds_read_b128 v[184:187], v254 offset:32768
    v_lshlrev_b32 v236, 16, v204
    v_and_b32 v237, 0xffff0000, v204
    v_sub_f32 v238, v242, v205
    v_pk_add_f32 v[236:237], v[240:241], v[236:237] neg_lo:[0,1] neg_hi:[0,1]
    v_mul_f32 v208, v236, v236
    v_fmac_f32 v208, v237, v237
    v_fmac_f32 v208, v238, v238
    v_cvt_pk_bf16_f32 v208, v208, v208
    v_pk_add_f32 v[220:221], v[220:221], 1.0 op_sel_hi:[1,0]
    v_pk_add_f32 v[222:223], v[222:223], 1.0 op_sel_hi:[1,0]
    v_pk_add_f32 v[224:225], v[224:225], 1.0 op_sel_hi:[1,0]
    v_pk_add_f32 v[226:227], v[226:227], 1.0 op_sel_hi:[1,0]
    v_rcp_f32 v220, v220
    v_rcp_f32 v221, v221
    v_rcp_f32 v222, v222
    v_rcp_f32 v223, v223
    v_rcp_f32 v224, v224
    v_rcp_f32 v225, v225
    v_rcp_f32 v226, v226
    v_rcp_f32 v227, v227
    s_waitcnt lgkmcnt(0)
    v_pk_fma_f32 v[84:85], v[148:149], v[220:221], v[84:85]
    v_pk_fma_f32 v[86:87], v[150:151], v[222:223], v[86:87]
    v_pk_fma_f32 v[88:89], v[152:153], v[224:225], v[88:89]
    v_pk_fma_f32 v[90:91], v[154:155], v[226:227], v[90:91]
    v_pk_fma_f32 v[228:229], v[84:85], v[116:117], v[228:229]
    v_pk_fma_f32 v[230:231], v[86:87], v[118:119], v[230:231]
    v_pk_fma_f32 v[228:229], v[88:89], v[120:121], v[228:229]
    v_pk_fma_f32 v[230:231], v[90:91], v[122:123], v[230:231]
    v_mfma_f32_32x32x8_bf16 v[140:155], v[40:41], v[208:209], v[44:59]
    v_exp_f32 v220, v156
    v_exp_f32 v221, v157
    v_exp_f32 v222, v158
    v_exp_f32 v223, v159
    v_mfma_f32_32x32x16_bf16 v[140:155], v[32:35], v[188:191], v[140:155]
    v_exp_f32 v224, v160
    v_exp_f32 v225, v161
    v_exp_f32 v226, v162
    v_exp_f32 v227, v163
    v_pk_add_f32 v[220:221], v[220:221], 1.0 op_sel_hi:[1,0]
    v_pk_add_f32 v[222:223], v[222:223], 1.0 op_sel_hi:[1,0]
    v_mfma_f32_32x32x16_bf16 v[140:155], v[0:3], v[172:175], v[140:155]
    v_pk_add_f32 v[224:225], v[224:225], 1.0 op_sel_hi:[1,0]
    v_pk_add_f32 v[226:227], v[226:227], 1.0 op_sel_hi:[1,0]
    v_rcp_f32 v220, v220
    v_rcp_f32 v221, v221
    v_rcp_f32 v222, v222
    v_rcp_f32 v223, v223
    v_mfma_f32_32x32x16_bf16 v[140:155], v[4:7], v[176:179], v[140:155]
    v_rcp_f32 v224, v224
    v_rcp_f32 v225, v225
    v_rcp_f32 v226, v226
    v_rcp_f32 v227, v227
    v_pk_fma_f32 v[92:93], v[156:157], v[220:221], v[92:93]
    v_pk_fma_f32 v[94:95], v[158:159], v[222:223], v[94:95]
    v_mfma_f32_32x32x16_bf16 v[140:155], v[8:11], v[180:183], v[140:155]
    v_pk_fma_f32 v[96:97], v[160:161], v[224:225], v[96:97]
    v_pk_fma_f32 v[98:99], v[162:163], v[226:227], v[98:99]
    v_pk_fma_f32 v[228:229], v[92:93], v[124:125], v[228:229]
    v_pk_fma_f32 v[230:231], v[94:95], v[126:127], v[230:231]
    v_pk_fma_f32 v[228:229], v[96:97], v[128:129], v[228:229]
    v_pk_fma_f32 v[230:231], v[98:99], v[130:131], v[230:231]
    v_exp_f32 v220, v164
    v_exp_f32 v221, v165
    v_mfma_f32_32x32x16_bf16 v[140:155], v[12:15], v[184:187], v[140:155]
    v_exp_f32 v222, v166
    v_exp_f32 v223, v167
    v_exp_f32 v224, v168
    v_exp_f32 v225, v169
    v_exp_f32 v226, v170
    v_exp_f32 v227, v171
    s_mov_b64 exec, -1
    s_add_u32 m0, s94, 32768
    s_nop 0
    buffer_load_dwordx4 v[210:211], s[8:11], 0 idxen offen lds
    s_add_u32 m0, s94, 33792
    s_nop 0
    buffer_load_dwordx4 v[212:213], s[8:11], 0 idxen offen lds
    s_add_u32 m0, s94, 34816
    s_nop 0
    buffer_load_dwordx4 v[214:215], s[8:11], 0 idxen offen lds
    s_add_u32 m0, s94, 35840
    s_nop 0
    buffer_load_dwordx4 v[216:217], s[8:11], 0 idxen offen lds
    s_mov_b64 exec, s[32:33]
    v_pk_add_f32 v[220:221], v[220:221], 1.0 op_sel_hi:[1,0]
    v_pk_add_f32 v[222:223], v[222:223], 1.0 op_sel_hi:[1,0]
    v_pk_add_f32 v[224:225], v[224:225], 1.0 op_sel_hi:[1,0]
    v_pk_add_f32 v[226:227], v[226:227], 1.0 op_sel_hi:[1,0]
    v_rcp_f32 v220, v220
    v_rcp_f32 v221, v221
    v_rcp_f32 v222, v222
    v_rcp_f32 v223, v223
    v_rcp_f32 v224, v224
    v_rcp_f32 v225, v225
    v_rcp_f32 v226, v226
    v_rcp_f32 v227, v227
    v_pk_fma_f32 v[100:101], v[164:165], v[220:221], v[100:101]
    v_pk_fma_f32 v[102:103], v[166:167], v[222:223], v[102:103]
    v_pk_fma_f32 v[104:105], v[168:169], v[224:225], v[104:105]
    v_pk_fma_f32 v[106:107], v[170:171], v[226:227], v[106:107]
    v_pk_fma_f32 v[228:229], v[100:101], v[132:133], v[228:229]
    v_pk_fma_f32 v[230:231], v[102:103], v[134:135], v[230:231]
    v_pk_fma_f32 v[228:229], v[104:105], v[136:137], v[228:229]
    v_pk_fma_f32 v[230:231], v[106:107], v[138:139], v[230:231]
    s_mov_b64 exec, -1
    buffer_load_dwordx4 v[196:199], v[218:219], s[12:15], 0 idxen offen
    buffer_load_dwordx2 v[204:205], v203, s[16:19], 0 idxen
    s_mov_b64 exec, s[32:33]
    v_pk_add_f32 v[228:229], v[228:229], v[230:231]
    s_cmp_eq_u64 s[34:35], 0
    v_add_f32 v243, v228, v229
    v_sub_f32 v248, v243, v247
    v_pk_fma_f32 v[244:245], v[232:233], v[248:249], v[244:245] op_sel_hi:[1,0,1]
    v_fmac_f32 v246, v234, v248
    s_mov_b64 exec, -1
    s_cbranch_scc1 K2_DONE
    v_cmp_lt_u32_e64 s[28:29], s6, v235
    s_add_u32 s6, s6, 1
    v_mfma_f32_32x32x8_bf16 v[156:171], v[42:43], v[208:209], v[60:75]
    v_cndmask_b32_e64 v203, 0, v207, s[28:29]
    v_add_u32 v207, v207, v206
    ds_read_b32 v218, v203
    ds_read_u16 v203, v203 offset:4
    s_mov_b64 exec, s[34:35]
    v_exp_f32 v220, v140
    v_exp_f32 v221, v141
    v_exp_f32 v222, v142
    v_exp_f32 v223, v143
    v_mfma_f32_32x32x16_bf16 v[156:171], v[36:39], v[188:191], v[156:171]
    v_exp_f32 v224, v144
    v_exp_f32 v225, v145
    v_exp_f32 v226, v146
    v_exp_f32 v227, v147
    v_pk_add_f32 v[220:221], v[220:221], 1.0 op_sel_hi:[1,0]
    v_pk_add_f32 v[222:223], v[222:223], 1.0 op_sel_hi:[1,0]
    v_mfma_f32_32x32x16_bf16 v[156:171], v[16:19], v[172:175], v[156:171]
    v_pk_add_f32 v[224:225], v[224:225], 1.0 op_sel_hi:[1,0]
    v_pk_add_f32 v[226:227], v[226:227], 1.0 op_sel_hi:[1,0]
    v_rcp_f32 v220, v220
    v_rcp_f32 v221, v221
    v_rcp_f32 v222, v222
    v_rcp_f32 v223, v223
    v_mfma_f32_32x32x16_bf16 v[156:171], v[20:23], v[176:179], v[156:171]
    v_rcp_f32 v224, v224
    v_rcp_f32 v225, v225
    v_rcp_f32 v226, v226
    v_rcp_f32 v227, v227
    s_waitcnt lgkmcnt(0)
    s_mov_b64 exec, -1
    ds_bpermute_b32 v210, v239, v203 offset:0
    ds_bpermute_b32 v212, v239, v203 offset:32
    ds_bpermute_b32 v214, v239, v203 offset:64
    ds_bpermute_b32 v216, v239, v203 offset:96
    s_mov_b64 exec, s[34:35]
    v_pk_fma_f32 v[76:77], v[140:141], v[220:221], v[76:77]
    v_pk_fma_f32 v[78:79], v[142:143], v[222:223], v[78:79]
    v_mfma_f32_32x32x16_bf16 v[156:171], v[24:27], v[180:183], v[156:171]
    v_pk_fma_f32 v[80:81], v[144:145], v[224:225], v[80:81]
    v_pk_fma_f32 v[82:83], v[146:147], v[226:227], v[82:83]
    v_pk_mul_f32 v[228:229], v[76:77], v[108:109]
    v_pk_mul_f32 v[230:231], v[78:79], v[110:111]
    v_pk_fma_f32 v[228:229], v[80:81], v[112:113], v[228:229]
    v_pk_fma_f32 v[230:231], v[82:83], v[114:115], v[230:231]
    v_exp_f32 v220, v148
    v_exp_f32 v221, v149
    v_mfma_f32_32x32x16_bf16 v[156:171], v[28:31], v[184:187], v[156:171]
    v_exp_f32 v222, v150
    v_exp_f32 v223, v151
    v_exp_f32 v224, v152
    v_exp_f32 v225, v153
    v_exp_f32 v226, v154
    v_exp_f32 v227, v155
    s_waitcnt vmcnt(6)
    ds_read_b128 v[172:175], v251 offset:0
    ds_read_b128 v[176:179], v252 offset:0
    ds_read_b128 v[180:183], v253 offset:0
    ds_read_b128 v[184:187], v254 offset:0
    v_lshlrev_b32 v232, 16, v200
    v_and_b32 v233, 0xffff0000, v200
    v_sub_f32 v234, v242, v201
    v_pk_add_f32 v[232:233], v[240:241], v[232:233] neg_lo:[0,1] neg_hi:[0,1]
    v_mul_f32 v208, v232, v232
    v_fmac_f32 v208, v233, v233
    v_fmac_f32 v208, v234, v234
    v_cvt_pk_bf16_f32 v208, v208, v208
    v_pk_add_f32 v[220:221], v[220:221], 1.0 op_sel_hi:[1,0]
    v_pk_add_f32 v[222:223], v[222:223], 1.0 op_sel_hi:[1,0]
    v_pk_add_f32 v[224:225], v[224:225], 1.0 op_sel_hi:[1,0]
    v_pk_add_f32 v[226:227], v[226:227], 1.0 op_sel_hi:[1,0]
    v_rcp_f32 v220, v220
    v_rcp_f32 v221, v221
    v_rcp_f32 v222, v222
    v_rcp_f32 v223, v223
    v_rcp_f32 v224, v224
    v_rcp_f32 v225, v225
    v_rcp_f32 v226, v226
    v_rcp_f32 v227, v227
    s_waitcnt lgkmcnt(0)
    v_pk_fma_f32 v[84:85], v[148:149], v[220:221], v[84:85]
    v_pk_fma_f32 v[86:87], v[150:151], v[222:223], v[86:87]
    v_pk_fma_f32 v[88:89], v[152:153], v[224:225], v[88:89]
    v_pk_fma_f32 v[90:91], v[154:155], v[226:227], v[90:91]
    v_pk_fma_f32 v[228:229], v[84:85], v[116:117], v[228:229]
    v_pk_fma_f32 v[230:231], v[86:87], v[118:119], v[230:231]
    v_pk_fma_f32 v[228:229], v[88:89], v[120:121], v[228:229]
    v_pk_fma_f32 v[230:231], v[90:91], v[122:123], v[230:231]
    v_mfma_f32_32x32x8_bf16 v[140:155], v[40:41], v[208:209], v[44:59]
    v_exp_f32 v220, v156
    v_exp_f32 v221, v157
    v_exp_f32 v222, v158
    v_exp_f32 v223, v159
    v_mfma_f32_32x32x16_bf16 v[140:155], v[32:35], v[192:195], v[140:155]
    v_exp_f32 v224, v160
    v_exp_f32 v225, v161
    v_exp_f32 v226, v162
    v_exp_f32 v227, v163
    v_pk_add_f32 v[220:221], v[220:221], 1.0 op_sel_hi:[1,0]
    v_pk_add_f32 v[222:223], v[222:223], 1.0 op_sel_hi:[1,0]
    v_mfma_f32_32x32x16_bf16 v[140:155], v[0:3], v[172:175], v[140:155]
    v_pk_add_f32 v[224:225], v[224:225], 1.0 op_sel_hi:[1,0]
    v_pk_add_f32 v[226:227], v[226:227], 1.0 op_sel_hi:[1,0]
    v_rcp_f32 v220, v220
    v_rcp_f32 v221, v221
    v_rcp_f32 v222, v222
    v_rcp_f32 v223, v223
    v_mfma_f32_32x32x16_bf16 v[140:155], v[4:7], v[176:179], v[140:155]
    v_rcp_f32 v224, v224
    v_rcp_f32 v225, v225
    v_rcp_f32 v226, v226
    v_rcp_f32 v227, v227
    v_pk_fma_f32 v[92:93], v[156:157], v[220:221], v[92:93]
    v_pk_fma_f32 v[94:95], v[158:159], v[222:223], v[94:95]
    v_mfma_f32_32x32x16_bf16 v[140:155], v[8:11], v[180:183], v[140:155]
    v_pk_fma_f32 v[96:97], v[160:161], v[224:225], v[96:97]
    v_pk_fma_f32 v[98:99], v[162:163], v[226:227], v[98:99]
    v_pk_fma_f32 v[228:229], v[92:93], v[124:125], v[228:229]
    v_pk_fma_f32 v[230:231], v[94:95], v[126:127], v[230:231]
    v_pk_fma_f32 v[228:229], v[96:97], v[128:129], v[228:229]
    v_pk_fma_f32 v[230:231], v[98:99], v[130:131], v[230:231]
    v_exp_f32 v220, v164
    v_exp_f32 v221, v165
    v_mfma_f32_32x32x16_bf16 v[140:155], v[12:15], v[184:187], v[140:155]
    v_exp_f32 v222, v166
    v_exp_f32 v223, v167
    v_exp_f32 v224, v168
    v_exp_f32 v225, v169
    v_exp_f32 v226, v170
    v_exp_f32 v227, v171
    s_mov_b64 exec, -1
    s_add_u32 m0, s94, 0
    s_nop 0
    buffer_load_dwordx4 v[210:211], s[8:11], 0 idxen offen lds
    s_add_u32 m0, s94, 1024
    s_nop 0
    buffer_load_dwordx4 v[212:213], s[8:11], 0 idxen offen lds
    s_add_u32 m0, s94, 2048
    s_nop 0
    buffer_load_dwordx4 v[214:215], s[8:11], 0 idxen offen lds
    s_add_u32 m0, s94, 3072
    s_nop 0
    buffer_load_dwordx4 v[216:217], s[8:11], 0 idxen offen lds
    s_mov_b64 exec, s[34:35]
    v_pk_add_f32 v[220:221], v[220:221], 1.0 op_sel_hi:[1,0]
    v_pk_add_f32 v[222:223], v[222:223], 1.0 op_sel_hi:[1,0]
    v_pk_add_f32 v[224:225], v[224:225], 1.0 op_sel_hi:[1,0]
    v_pk_add_f32 v[226:227], v[226:227], 1.0 op_sel_hi:[1,0]
    v_rcp_f32 v220, v220
    v_rcp_f32 v221, v221
    v_rcp_f32 v222, v222
    v_rcp_f32 v223, v223
    v_rcp_f32 v224, v224
    v_rcp_f32 v225, v225
    v_rcp_f32 v226, v226
    v_rcp_f32 v227, v227
    v_pk_fma_f32 v[100:101], v[164:165], v[220:221], v[100:101]
    v_pk_fma_f32 v[102:103], v[166:167], v[222:223], v[102:103]
    v_pk_fma_f32 v[104:105], v[168:169], v[224:225], v[104:105]
    v_pk_fma_f32 v[106:107], v[170:171], v[226:227], v[106:107]
    v_pk_fma_f32 v[228:229], v[100:101], v[132:133], v[228:229]
    v_pk_fma_f32 v[230:231], v[102:103], v[134:135], v[230:231]
    v_pk_fma_f32 v[228:229], v[104:105], v[136:137], v[228:229]
    v_pk_fma_f32 v[230:231], v[106:107], v[138:139], v[230:231]
    s_mov_b64 exec, -1
    buffer_load_dwordx4 v[188:191], v[218:219], s[12:15], 0 idxen offen
    buffer_load_dwordx2 v[200:201], v203, s[16:19], 0 idxen
    s_mov_b64 exec, s[34:35]
    v_pk_add_f32 v[228:229], v[228:229], v[230:231]
    s_cmp_eq_u64 s[36:37], 0
    v_add_f32 v247, v228, v229
    v_sub_f32 v248, v247, v243
    v_pk_fma_f32 v[244:245], v[236:237], v[248:249], v[244:245] op_sel_hi:[1,0,1]
    v_fmac_f32 v246, v238, v248
    s_mov_b64 exec, -1
    s_cbranch_scc1 K2_DONE
    v_cmp_lt_u32_e64 s[30:31], s6, v235
    s_add_u32 s6, s6, 1
    v_mfma_f32_32x32x8_bf16 v[156:171], v[42:43], v[208:209], v[60:75]
    v_cndmask_b32_e64 v203, 0, v207, s[30:31]
    v_add_u32 v207, v207, v206
    ds_read_b32 v218, v203
    ds_read_u16 v203, v203 offset:4
    s_mov_b64 exec, s[36:37]
    v_exp_f32 v220, v140
    v_exp_f32 v221, v141
    v_exp_f32 v222, v142
    v_exp_f32 v223, v143
    v_mfma_f32_32x32x16_bf16 v[156:171], v[36:39], v[192:195], v[156:171]
    v_exp_f32 v224, v144
    v_exp_f32 v225, v145
    v_exp_f32 v226, v146
    v_exp_f32 v227, v147
    v_pk_add_f32 v[220:221], v[220:221], 1.0 op_sel_hi:[1,0]
    v_pk_add_f32 v[222:223], v[222:223], 1.0 op_sel_hi:[1,0]
    v_mfma_f32_32x32x16_bf16 v[156:171], v[16:19], v[172:175], v[156:171]
    v_pk_add_f32 v[224:225], v[224:225], 1.0 op_sel_hi:[1,0]
    v_pk_add_f32 v[226:227], v[226:227], 1.0 op_sel_hi:[1,0]
    v_rcp_f32 v220, v220
    v_rcp_f32 v221, v221
    v_rcp_f32 v222, v222
    v_rcp_f32 v223, v223
    v_mfma_f32_32x32x16_bf16 v[156:171], v[20:23], v[176:179], v[156:171]
    v_rcp_f32 v224, v224
    v_rcp_f32 v225, v225
    v_rcp_f32 v226, v226
    v_rcp_f32 v227, v227
    s_waitcnt lgkmcnt(0)
    s_mov_b64 exec, -1
    ds_bpermute_b32 v210, v239, v203 offset:0
    ds_bpermute_b32 v212, v239, v203 offset:32
    ds_bpermute_b32 v214, v239, v203 offset:64
    ds_bpermute_b32 v216, v239, v203 offset:96
    s_mov_b64 exec, s[36:37]
    v_pk_fma_f32 v[76:77], v[140:141], v[220:221], v[76:77]
    v_pk_fma_f32 v[78:79], v[142:143], v[222:223], v[78:79]
    v_mfma_f32_32x32x16_bf16 v[156:171], v[24:27], v[180:183], v[156:171]
    v_pk_fma_f32 v[80:81], v[144:145], v[224:225], v[80:81]
    v_pk_fma_f32 v[82:83], v[146:147], v[226:227], v[82:83]
    v_pk_mul_f32 v[228:229], v[76:77], v[108:109]
    v_pk_mul_f32 v[230:231], v[78:79], v[110:111]
    v_pk_fma_f32 v[228:229], v[80:81], v[112:113], v[228:229]
    v_pk_fma_f32 v[230:231], v[82:83], v[114:115], v[230:231]
    v_exp_f32 v220, v148
    v_exp_f32 v221, v149
    v_mfma_f32_32x32x16_bf16 v[156:171], v[28:31], v[184:187], v[156:171]
    v_exp_f32 v222, v150
    v_exp_f32 v223, v151
    v_exp_f32 v224, v152
    v_exp_f32 v225, v153
    v_exp_f32 v226, v154
    v_exp_f32 v227, v155
    s_waitcnt vmcnt(6)
    ds_read_b128 v[172:175], v251 offset:32768
    ds_read_b128 v[176:179], v252 offset:32768
    ds_read_b128 v[180:183], v253 offset:32768
    ds_read_b128 v[184:187], v254 offset:32768
    v_lshlrev_b32 v236, 16, v204
    v_and_b32 v237, 0xffff0000, v204
    v_sub_f32 v238, v242, v205
    v_pk_add_f32 v[236:237], v[240:241], v[236:237] neg_lo:[0,1] neg_hi:[0,1]
    v_mul_f32 v208, v236, v236
    v_fmac_f32 v208, v237, v237
    v_fmac_f32 v208, v238, v238
    v_cvt_pk_bf16_f32 v208, v208, v208
    v_pk_add_f32 v[220:221], v[220:221], 1.0 op_sel_hi:[1,0]
    v_pk_add_f32 v[222:223], v[222:223], 1.0 op_sel_hi:[1,0]
    v_pk_add_f32 v[224:225], v[224:225], 1.0 op_sel_hi:[1,0]
    v_pk_add_f32 v[226:227], v[226:227], 1.0 op_sel_hi:[1,0]
    v_rcp_f32 v220, v220
    v_rcp_f32 v221, v221
    v_rcp_f32 v222, v222
    v_rcp_f32 v223, v223
    v_rcp_f32 v224, v224
    v_rcp_f32 v225, v225
    v_rcp_f32 v226, v226
    v_rcp_f32 v227, v227
    s_waitcnt lgkmcnt(0)
    v_pk_fma_f32 v[84:85], v[148:149], v[220:221], v[84:85]
    v_pk_fma_f32 v[86:87], v[150:151], v[222:223], v[86:87]
    v_pk_fma_f32 v[88:89], v[152:153], v[224:225], v[88:89]
    v_pk_fma_f32 v[90:91], v[154:155], v[226:227], v[90:91]
    v_pk_fma_f32 v[228:229], v[84:85], v[116:117], v[228:229]
    v_pk_fma_f32 v[230:231], v[86:87], v[118:119], v[230:231]
    v_pk_fma_f32 v[228:229], v[88:89], v[120:121], v[228:229]
    v_pk_fma_f32 v[230:231], v[90:91], v[122:123], v[230:231]
    v_mfma_f32_32x32x8_bf16 v[140:155], v[40:41], v[208:209], v[44:59]
    v_exp_f32 v220, v156
    v_exp_f32 v221, v157
    v_exp_f32 v222, v158
    v_exp_f32 v223, v159
    v_mfma_f32_32x32x16_bf16 v[140:155], v[32:35], v[196:199], v[140:155]
    v_exp_f32 v224, v160
    v_exp_f32 v225, v161
    v_exp_f32 v226, v162
    v_exp_f32 v227, v163
    v_pk_add_f32 v[220:221], v[220:221], 1.0 op_sel_hi:[1,0]
    v_pk_add_f32 v[222:223], v[222:223], 1.0 op_sel_hi:[1,0]
    v_mfma_f32_32x32x16_bf16 v[140:155], v[0:3], v[172:175], v[140:155]
    v_pk_add_f32 v[224:225], v[224:225], 1.0 op_sel_hi:[1,0]
    v_pk_add_f32 v[226:227], v[226:227], 1.0 op_sel_hi:[1,0]
    v_rcp_f32 v220, v220
    v_rcp_f32 v221, v221
    v_rcp_f32 v222, v222
    v_rcp_f32 v223, v223
    v_mfma_f32_32x32x16_bf16 v[140:155], v[4:7], v[176:179], v[140:155]
    v_rcp_f32 v224, v224
    v_rcp_f32 v225, v225
    v_rcp_f32 v226, v226
    v_rcp_f32 v227, v227
    v_pk_fma_f32 v[92:93], v[156:157], v[220:221], v[92:93]
    v_pk_fma_f32 v[94:95], v[158:159], v[222:223], v[94:95]
    v_mfma_f32_32x32x16_bf16 v[140:155], v[8:11], v[180:183], v[140:155]
    v_pk_fma_f32 v[96:97], v[160:161], v[224:225], v[96:97]
    v_pk_fma_f32 v[98:99], v[162:163], v[226:227], v[98:99]
    v_pk_fma_f32 v[228:229], v[92:93], v[124:125], v[228:229]
    v_pk_fma_f32 v[230:231], v[94:95], v[126:127], v[230:231]
    v_pk_fma_f32 v[228:229], v[96:97], v[128:129], v[228:229]
    v_pk_fma_f32 v[230:231], v[98:99], v[130:131], v[230:231]
    v_exp_f32 v220, v164
    v_exp_f32 v221, v165
    v_mfma_f32_32x32x16_bf16 v[140:155], v[12:15], v[184:187], v[140:155]
    v_exp_f32 v222, v166
    v_exp_f32 v223, v167
    v_exp_f32 v224, v168
    v_exp_f32 v225, v169
    v_exp_f32 v226, v170
    v_exp_f32 v227, v171
    s_mov_b64 exec, -1
    s_add_u32 m0, s94, 32768
    s_nop 0
    buffer_load_dwordx4 v[210:211], s[8:11], 0 idxen offen lds
    s_add_u32 m0, s94, 33792
    s_nop 0
    buffer_load_dwordx4 v[212:213], s[8:11], 0 idxen offen lds
    s_add_u32 m0, s94, 34816
    s_nop 0
    buffer_load_dwordx4 v[214:215], s[8:11], 0 idxen offen lds
    s_add_u32 m0, s94, 35840
    s_nop 0
    buffer_load_dwordx4 v[216:217], s[8:11], 0 idxen offen lds
    s_mov_b64 exec, s[36:37]
    v_pk_add_f32 v[220:221], v[220:221], 1.0 op_sel_hi:[1,0]
    v_pk_add_f32 v[222:223], v[222:223], 1.0 op_sel_hi:[1,0]
    v_pk_add_f32 v[224:225], v[224:225], 1.0 op_sel_hi:[1,0]
    v_pk_add_f32 v[226:227], v[226:227], 1.0 op_sel_hi:[1,0]
    v_rcp_f32 v220, v220
    v_rcp_f32 v221, v221
    v_rcp_f32 v222, v222
    v_rcp_f32 v223, v223
    v_rcp_f32 v224, v224
    v_rcp_f32 v225, v225
    v_rcp_f32 v226, v226
    v_rcp_f32 v227, v227
    v_pk_fma_f32 v[100:101], v[164:165], v[220:221], v[100:101]
    v_pk_fma_f32 v[102:103], v[166:167], v[222:223], v[102:103]
    v_pk_fma_f32 v[104:105], v[168:169], v[224:225], v[104:105]
    v_pk_fma_f32 v[106:107], v[170:171], v[226:227], v[106:107]
    v_pk_fma_f32 v[228:229], v[100:101], v[132:133], v[228:229]
    v_pk_fma_f32 v[230:231], v[102:103], v[134:135], v[230:231]
    v_pk_fma_f32 v[228:229], v[104:105], v[136:137], v[228:229]
    v_pk_fma_f32 v[230:231], v[106:107], v[138:139], v[230:231]
    s_mov_b64 exec, -1
    buffer_load_dwordx4 v[192:195], v[218:219], s[12:15], 0 idxen offen
    buffer_load_dwordx2 v[204:205], v203, s[16:19], 0 idxen
    s_mov_b64 exec, s[36:37]
    v_pk_add_f32 v[228:229], v[228:229], v[230:231]
    s_cmp_eq_u64 s[38:39], 0
    v_add_f32 v243, v228, v229
    v_sub_f32 v248, v243, v247
    v_pk_fma_f32 v[244:245], v[232:233], v[248:249], v[244:245] op_sel_hi:[1,0,1]
    v_fmac_f32 v246, v234, v248
    s_mov_b64 exec, -1
    s_cbranch_scc1 K2_DONE
    v_cmp_lt_u32_e64 s[32:33], s6, v235
    s_add_u32 s6, s6, 1
    v_mfma_f32_32x32x8_bf16 v[156:171], v[42:43], v[208:209], v[60:75]
    v_cndmask_b32_e64 v203, 0, v207, s[32:33]
    v_add_u32 v207, v207, v206
    ds_read_b32 v218, v203
    ds_read_u16 v203, v203 offset:4
    s_mov_b64 exec, s[38:39]
    v_exp_f32 v220, v140
    v_exp_f32 v221, v141
    v_exp_f32 v222, v142
    v_exp_f32 v223, v143
    v_mfma_f32_32x32x16_bf16 v[156:171], v[36:39], v[196:199], v[156:171]
    v_exp_f32 v224, v144
    v_exp_f32 v225, v145
    v_exp_f32 v226, v146
    v_exp_f32 v227, v147
    v_pk_add_f32 v[220:221], v[220:221], 1.0 op_sel_hi:[1,0]
    v_pk_add_f32 v[222:223], v[222:223], 1.0 op_sel_hi:[1,0]
    v_mfma_f32_32x32x16_bf16 v[156:171], v[16:19], v[172:175], v[156:171]
    v_pk_add_f32 v[224:225], v[224:225], 1.0 op_sel_hi:[1,0]
    v_pk_add_f32 v[226:227], v[226:227], 1.0 op_sel_hi:[1,0]
    v_rcp_f32 v220, v220
    v_rcp_f32 v221, v221
    v_rcp_f32 v222, v222
    v_rcp_f32 v223, v223
    v_mfma_f32_32x32x16_bf16 v[156:171], v[20:23], v[176:179], v[156:171]
    v_rcp_f32 v224, v224
    v_rcp_f32 v225, v225
    v_rcp_f32 v226, v226
    v_rcp_f32 v227, v227
    s_waitcnt lgkmcnt(0)
    s_mov_b64 exec, -1
    ds_bpermute_b32 v210, v239, v203 offset:0
    ds_bpermute_b32 v212, v239, v203 offset:32
    ds_bpermute_b32 v214, v239, v203 offset:64
    ds_bpermute_b32 v216, v239, v203 offset:96
    s_mov_b64 exec, s[38:39]
    v_pk_fma_f32 v[76:77], v[140:141], v[220:221], v[76:77]
    v_pk_fma_f32 v[78:79], v[142:143], v[222:223], v[78:79]
    v_mfma_f32_32x32x16_bf16 v[156:171], v[24:27], v[180:183], v[156:171]
    v_pk_fma_f32 v[80:81], v[144:145], v[224:225], v[80:81]
    v_pk_fma_f32 v[82:83], v[146:147], v[226:227], v[82:83]
    v_pk_mul_f32 v[228:229], v[76:77], v[108:109]
    v_pk_mul_f32 v[230:231], v[78:79], v[110:111]
    v_pk_fma_f32 v[228:229], v[80:81], v[112:113], v[228:229]
    v_pk_fma_f32 v[230:231], v[82:83], v[114:115], v[230:231]
    v_exp_f32 v220, v148
    v_exp_f32 v221, v149
    v_mfma_f32_32x32x16_bf16 v[156:171], v[28:31], v[184:187], v[156:171]
    v_exp_f32 v222, v150
    v_exp_f32 v223, v151
    v_exp_f32 v224, v152
    v_exp_f32 v225, v153
    v_exp_f32 v226, v154
    v_exp_f32 v227, v155
    s_waitcnt vmcnt(6)
    ds_read_b128 v[172:175], v251 offset:0
    ds_read_b128 v[176:179], v252 offset:0
    ds_read_b128 v[180:183], v253 offset:0
    ds_read_b128 v[184:187], v254 offset:0
    v_lshlrev_b32 v232, 16, v200
    v_and_b32 v233, 0xffff0000, v200
    v_sub_f32 v234, v242, v201
    v_pk_add_f32 v[232:233], v[240:241], v[232:233] neg_lo:[0,1] neg_hi:[0,1]
    v_mul_f32 v208, v232, v232
    v_fmac_f32 v208, v233, v233
    v_fmac_f32 v208, v234, v234
    v_cvt_pk_bf16_f32 v208, v208, v208
    v_pk_add_f32 v[220:221], v[220:221], 1.0 op_sel_hi:[1,0]
    v_pk_add_f32 v[222:223], v[222:223], 1.0 op_sel_hi:[1,0]
    v_pk_add_f32 v[224:225], v[224:225], 1.0 op_sel_hi:[1,0]
    v_pk_add_f32 v[226:227], v[226:227], 1.0 op_sel_hi:[1,0]
    v_rcp_f32 v220, v220
    v_rcp_f32 v221, v221
    v_rcp_f32 v222, v222
    v_rcp_f32 v223, v223
    v_rcp_f32 v224, v224
    v_rcp_f32 v225, v225
    v_rcp_f32 v226, v226
    v_rcp_f32 v227, v227
    s_waitcnt lgkmcnt(0)
    v_pk_fma_f32 v[84:85], v[148:149], v[220:221], v[84:85]
    v_pk_fma_f32 v[86:87], v[150:151], v[222:223], v[86:87]
    v_pk_fma_f32 v[88:89], v[152:153], v[224:225], v[88:89]
    v_pk_fma_f32 v[90:91], v[154:155], v[226:227], v[90:91]
    v_pk_fma_f32 v[228:229], v[84:85], v[116:117], v[228:229]
    v_pk_fma_f32 v[230:231], v[86:87], v[118:119], v[230:231]
    v_pk_fma_f32 v[228:229], v[88:89], v[120:121], v[228:229]
    v_pk_fma_f32 v[230:231], v[90:91], v[122:123], v[230:231]
    v_mfma_f32_32x32x8_bf16 v[140:155], v[40:41], v[208:209], v[44:59]
    v_exp_f32 v220, v156
    v_exp_f32 v221, v157
    v_exp_f32 v222, v158
    v_exp_f32 v223, v159
    v_mfma_f32_32x32x16_bf16 v[140:155], v[32:35], v[188:191], v[140:155]
    v_exp_f32 v224, v160
    v_exp_f32 v225, v161
    v_exp_f32 v226, v162
    v_exp_f32 v227, v163
    v_pk_add_f32 v[220:221], v[220:221], 1.0 op_sel_hi:[1,0]
    v_pk_add_f32 v[222:223], v[222:223], 1.0 op_sel_hi:[1,0]
    v_mfma_f32_32x32x16_bf16 v[140:155], v[0:3], v[172:175], v[140:155]
    v_pk_add_f32 v[224:225], v[224:225], 1.0 op_sel_hi:[1,0]
    v_pk_add_f32 v[226:227], v[226:227], 1.0 op_sel_hi:[1,0]
    v_rcp_f32 v220, v220
    v_rcp_f32 v221, v221
    v_rcp_f32 v222, v222
    v_rcp_f32 v223, v223
    v_mfma_f32_32x32x16_bf16 v[140:155], v[4:7], v[176:179], v[140:155]
    v_rcp_f32 v224, v224
    v_rcp_f32 v225, v225
    v_rcp_f32 v226, v226
    v_rcp_f32 v227, v227
    v_pk_fma_f32 v[92:93], v[156:157], v[220:221], v[92:93]
    v_pk_fma_f32 v[94:95], v[158:159], v[222:223], v[94:95]
    v_mfma_f32_32x32x16_bf16 v[140:155], v[8:11], v[180:183], v[140:155]
    v_pk_fma_f32 v[96:97], v[160:161], v[224:225], v[96:97]
    v_pk_fma_f32 v[98:99], v[162:163], v[226:227], v[98:99]
    v_pk_fma_f32 v[228:229], v[92:93], v[124:125], v[228:229]
    v_pk_fma_f32 v[230:231], v[94:95], v[126:127], v[230:231]
    v_pk_fma_f32 v[228:229], v[96:97], v[128:129], v[228:229]
    v_pk_fma_f32 v[230:231], v[98:99], v[130:131], v[230:231]
    v_exp_f32 v220, v164
    v_exp_f32 v221, v165
    v_mfma_f32_32x32x16_bf16 v[140:155], v[12:15], v[184:187], v[140:155]
    v_exp_f32 v222, v166
    v_exp_f32 v223, v167
    v_exp_f32 v224, v168
    v_exp_f32 v225, v169
    v_exp_f32 v226, v170
    v_exp_f32 v227, v171
    s_mov_b64 exec, -1
    s_add_u32 m0, s94, 0
    s_nop 0
    buffer_load_dwordx4 v[210:211], s[8:11], 0 idxen offen lds
    s_add_u32 m0, s94, 1024
    s_nop 0
    buffer_load_dwordx4 v[212:213], s[8:11], 0 idxen offen lds
    s_add_u32 m0, s94, 2048
    s_nop 0
    buffer_load_dwordx4 v[214:215], s[8:11], 0 idxen offen lds
    s_add_u32 m0, s94, 3072
    s_nop 0
    buffer_load_dwordx4 v[216:217], s[8:11], 0 idxen offen lds
    s_mov_b64 exec, s[38:39]
    v_pk_add_f32 v[220:221], v[220:221], 1.0 op_sel_hi:[1,0]
    v_pk_add_f32 v[222:223], v[222:223], 1.0 op_sel_hi:[1,0]
    v_pk_add_f32 v[224:225], v[224:225], 1.0 op_sel_hi:[1,0]
    v_pk_add_f32 v[226:227], v[226:227], 1.0 op_sel_hi:[1,0]
    v_rcp_f32 v220, v220
    v_rcp_f32 v221, v221
    v_rcp_f32 v222, v222
    v_rcp_f32 v223, v223
    v_rcp_f32 v224, v224
    v_rcp_f32 v225, v225
    v_rcp_f32 v226, v226
    v_rcp_f32 v227, v227
    v_pk_fma_f32 v[100:101], v[164:165], v[220:221], v[100:101]
    v_pk_fma_f32 v[102:103], v[166:167], v[222:223], v[102:103]
    v_pk_fma_f32 v[104:105], v[168:169], v[224:225], v[104:105]
    v_pk_fma_f32 v[106:107], v[170:171], v[226:227], v[106:107]
    v_pk_fma_f32 v[228:229], v[100:101], v[132:133], v[228:229]
    v_pk_fma_f32 v[230:231], v[102:103], v[134:135], v[230:231]
    v_pk_fma_f32 v[228:229], v[104:105], v[136:137], v[228:229]
    v_pk_fma_f32 v[230:231], v[106:107], v[138:139], v[230:231]
    s_mov_b64 exec, -1
    buffer_load_dwordx4 v[196:199], v[218:219], s[12:15], 0 idxen offen
    buffer_load_dwordx2 v[200:201], v203, s[16:19], 0 idxen
    s_mov_b64 exec, s[38:39]
    v_pk_add_f32 v[228:229], v[228:229], v[230:231]
    s_cmp_eq_u64 s[28:29], 0
    v_add_f32 v247, v228, v229
    v_sub_f32 v248, v247, v243
    v_pk_fma_f32 v[244:245], v[236:237], v[248:249], v[244:245] op_sel_hi:[1,0,1]
    v_fmac_f32 v246, v238, v248
    s_mov_b64 exec, -1
    s_cbranch_scc0 K2_LOOP
K2_DONE:
    v_and_b32 v203, 63, v250
    s_or_b32 s95, s7, s93
    s_cselect_b32 s97, 3, s97
    s_cmp_gt_u32 s97, 2
    v_lshlrev_b32 v203, 4, v203
    s_cbranch_scc1 K2_SLOW
    v_bfe_u32 v220, v249, 1, 3
    v_lshlrev_b32 v220, 4, v220
    v_lshlrev_b32 v221, 2, v219
    v_xor_b32 v220, v220, v221
    v_lshl_add_u32 v220, v249, 7, v220
    v_add_u32 v220, 100352, v220
    v_xor_b32 v221, 16, v220
    v_xor_b32 v222, 32, v220
    v_xor_b32 v223, 48, v220
    ds_read_b128 v[172:175], v220
    ds_read_b128 v[176:179], v221
    ds_read_b128 v[180:183], v222
    ds_read_b128 v[184:187], v223
    v_add_u32 v220, 125952, v203
    v_cmp_eq_u32_e64 s[46:47], 16, v206
    v_cmp_eq_u32_e64 s[44:45], 8, v206
    v_add_u32 v218, s4, v249
    ds_read_b128 v[0:3], v220 offset:32768
    ds_read_b128 v[4:7], v220 offset:33792
    ds_read_b128 v[8:11], v220 offset:34816
    ds_read_b128 v[12:15], v220 offset:35840
    ds_read_b128 v[16:19], v220 offset:0
    ds_read_b128 v[20:23], v220 offset:1024
    ds_read_b128 v[24:27], v220 offset:2048
    ds_read_b128 v[28:31], v220 offset:3072
    ds_read_b128 v[44:47], v220 offset:4096
    ds_read_b128 v[48:51], v220 offset:5120
    ds_read_b128 v[52:55], v220 offset:6144
    ds_read_b128 v[56:59], v220 offset:7168
    ds_read_b128 v[60:63], v220 offset:8192
    ds_read_b128 v[64:67], v220 offset:9216
    ds_read_b128 v[68:71], v220 offset:10240
    ds_read_b128 v[72:75], v220 offset:11264
    s_mov_b64 exec, s[46:47]
    s_and_b32 s46, s46, 0x55555555
    s_or_b32 s44, s44, s46
    s_mov_b32 s98, s94
    v_add_f32_dpp v244, v244, v244 quad_perm:[1,0,3,2] row_mask:0xf bank_mask:0xf
    v_add_f32_dpp v245, v245, v245 quad_perm:[1,0,3,2] row_mask:0xf bank_mask:0xf
    v_add_f32_dpp v246, v246, v246 quad_perm:[1,0,3,2] row_mask:0xf bank_mask:0xf
    v_add_f32_dpp v76, v76, v76 quad_perm:[1,0,3,2] row_mask:0xf bank_mask:0xf
    v_add_f32_dpp v77, v77, v77 quad_perm:[1,0,3,2] row_mask:0xf bank_mask:0xf
    v_add_f32_dpp v78, v78, v78 quad_perm:[1,0,3,2] row_mask:0xf bank_mask:0xf
    v_add_f32_dpp v79, v79, v79 quad_perm:[1,0,3,2] row_mask:0xf bank_mask:0xf
    v_add_f32_dpp v80, v80, v80 quad_perm:[1,0,3,2] row_mask:0xf bank_mask:0xf
    v_add_f32_dpp v81, v81, v81 quad_perm:[1,0,3,2] row_mask:0xf bank_mask:0xf
    v_add_f32_dpp v82, v82, v82 quad_perm:[1,0,3,2] row_mask:0xf bank_mask:0xf
    v_add_f32_dpp v83, v83, v83 quad_perm:[1,0,3,2] row_mask:0xf bank_mask:0xf
    v_add_f32_dpp v84, v84, v84 quad_perm:[1,0,3,2] row_mask:0xf bank_mask:0xf
    v_add_f32_dpp v85, v85, v85 quad_perm:[1,0,3,2] row_mask:0xf bank_mask:0xf
    v_add_f32_dpp v86, v86, v86 quad_perm:[1,0,3,2] row_mask:0xf bank_mask:0xf
    v_add_f32_dpp v87, v87, v87 quad_perm:[1,0,3,2] row_mask:0xf bank_mask:0xf
    v_add_f32_dpp v88, v88, v88 quad_perm:[1,0,3,2] row_mask:0xf bank_mask:0xf
    v_add_f32_dpp v89, v89, v89 quad_perm:[1,0,3,2] row_mask:0xf bank_mask:0xf
    v_add_f32_dpp v90, v90, v90 quad_perm:[1,0,3,2] row_mask:0xf bank_mask:0xf
    v_add_f32_dpp v91, v91, v91 quad_perm:[1,0,3,2] row_mask:0xf bank_mask:0xf
    v_add_f32_dpp v92, v92, v92 quad_perm:[1,0,3,2] row_mask:0xf bank_mask:0xf
    v_add_f32_dpp v93, v93, v93 quad_perm:[1,0,3,2] row_mask:0xf bank_mask:0xf
    v_add_f32_dpp v94, v94, v94 quad_perm:[1,0,3,2] row_mask:0xf bank_mask:0xf
    v_add_f32_dpp v95, v95, v95 quad_perm:[1,0,3,2] row_mask:0xf bank_mask:0xf
    v_add_f32_dpp v96, v96, v96 quad_perm:[1,0,3,2] row_mask:0xf bank_mask:0xf
    v_add_f32_dpp v97, v97, v97 quad_perm:[1,0,3,2] row_mask:0xf bank_mask:0xf
    v_add_f32_dpp v98, v98, v98 quad_perm:[1,0,3,2] row_mask:0xf bank_mask:0xf
    v_add_f32_dpp v99, v99, v99 quad_perm:[1,0,3,2] row_mask:0xf bank_mask:0xf
    v_add_f32_dpp v100, v100, v100 quad_perm:[1,0,3,2] row_mask:0xf bank_mask:0xf
    v_add_f32_dpp v101, v101, v101 quad_perm:[1,0,3,2] row_mask:0xf bank_mask:0xf
    v_add_f32_dpp v102, v102, v102 quad_perm:[1,0,3,2] row_mask:0xf bank_mask:0xf
    v_add_f32_dpp v103, v103, v103 quad_perm:[1,0,3,2] row_mask:0xf bank_mask:0xf
    v_add_f32_dpp v104, v104, v104 quad_perm:[1,0,3,2] row_mask:0xf bank_mask:0xf
    v_add_f32_dpp v105, v105, v105 quad_perm:[1,0,3,2] row_mask:0xf bank_mask:0xf
    v_add_f32_dpp v106, v106, v106 quad_perm:[1,0,3,2] row_mask:0xf bank_mask:0xf
    v_add_f32_dpp v107, v107, v107 quad_perm:[1,0,3,2] row_mask:0xf bank_mask:0xf
    s_mov_b64 exec, -1
    v_mov_b32 v224, v244
    v_mov_b32 v225, v245
    v_mov_b32 v226, v246
    s_nop 1
    v_permlane32_swap_b32 v224, v244
    v_permlane32_swap_b32 v225, v245
    v_permlane32_swap_b32 v226, v246
    s_nop 1
    v_add_f32 v244, v244, v224
    v_add_f32 v245, v245, v225
    v_add_f32 v246, v246, v226
    s_branch K2_TAIL
K2_EMPTY:
    s_waitcnt vmcnt(0) lgkmcnt(0)
    v_mov_b32 v244, 0
    v_mov_b32 v245, 0
    v_mov_b32 v246, 0
    v_mov_b32 v76, 0
    v_mov_b32 v77, 0
    v_mov_b32 v78, 0
    v_mov_b32 v79, 0
    v_mov_b32 v80, 0
    v_mov_b32 v81, 0
    v_mov_b32 v82, 0
    v_mov_b32 v83, 0
    v_mov_b32 v84, 0
    v_mov_b32 v85, 0
    v_mov_b32 v86, 0
    v_mov_b32 v87, 0
    v_mov_b32 v88, 0
    v_mov_b32 v89, 0
    v_mov_b32 v90, 0
    v_mov_b32 v91, 0
    v_mov_b32 v92, 0
    v_mov_b32 v93, 0
    v_mov_b32 v94, 0
    v_mov_b32 v95, 0
    v_mov_b32 v96, 0
    v_mov_b32 v97, 0
    v_mov_b32 v98, 0
    v_mov_b32 v99, 0
    v_mov_b32 v100, 0
    v_mov_b32 v101, 0
    v_mov_b32 v102, 0
    v_mov_b32 v103, 0
    v_mov_b32 v104, 0
    v_mov_b32 v105, 0
    v_mov_b32 v106, 0
    v_mov_b32 v107, 0
    v_mov_b32 v242, v241
    v_and_b32 v241, 0xffff0000, v240
    v_lshlrev_b32 v240, 16, v240
    s_branch K2_DONE
K2_SLOW:
    v_and_b32 v223, 31, v250
    v_lshlrev_b32 v220, 2, v219
    v_xor_b32 v220, v220, v251
    v_lshl_add_u32 v220, v219, 11, v220
    s_lshl_b32 s95, s100, 10
    s_add_u32 s95, s95, 129024
    v_lshl_add_u32 v221, v223, 5, v219
    v_add_u32 v221, s95, v221
    s_lshl_b32 s95, s5, 5
    v_add_u32 v223, s95, v223
    v_add_u32 v218, s4, v223
    v_min_u32 v222, 49999, v218
    s_waitcnt vmcnt(0)
    buffer_load_dwordx2 v[240:241], v222, s[16:19], 0 idxen
    v_xor_b32 v222, 0, v220
    ds_write_b128 v222, v[76:79]
    v_xor_b32 v222, 16, v220
    ds_write_b128 v222, v[80:83]
    v_xor_b32 v222, 32, v220
    ds_write_b128 v222, v[84:87]
    v_xor_b32 v222, 48, v220
    ds_write_b128 v222, v[88:91]
    v_xor_b32 v222, 64, v220
    ds_write_b128 v222, v[92:95]
    v_xor_b32 v222, 80, v220
    ds_write_b128 v222, v[96:99]
    v_xor_b32 v222, 96, v220
    ds_write_b128 v222, v[100:103]
    v_xor_b32 v222, 112, v220
    ds_write_b128 v222, v[104:107]
    ds_write_b128 v221, v[244:247]
    v_lshlrev_b32 v220, 2, v223
    ds_read_b32 v235, v220 offset:32768
    s_sub_u32 s99, s101, s94
    v_add_u32 v251, s99, v251
    v_add_u32 v252, s99, v252
    v_add_u32 v253, s99, v253
    v_add_u32 v254, s99, v254
    ds_read_b128 v[172:175], v251 offset:0
    ds_read_b128 v[176:179], v252 offset:0
    ds_read_b128 v[180:183], v253 offset:0
    ds_read_b128 v[184:187], v254 offset:0
    v_mov_b32 v76, 0
    v_mov_b32 v77, 0
    v_mov_b32 v78, 0
    v_mov_b32 v79, 0
    v_mov_b32 v80, 0
    v_mov_b32 v81, 0
    v_mov_b32 v82, 0
    v_mov_b32 v83, 0
    v_mov_b32 v84, 0
    v_mov_b32 v85, 0
    v_mov_b32 v86, 0
    v_mov_b32 v87, 0
    v_mov_b32 v88, 0
    v_mov_b32 v89, 0
    v_mov_b32 v90, 0
    v_mov_b32 v91, 0
    v_mov_b32 v92, 0
    v_mov_b32 v93, 0
    v_mov_b32 v94, 0
    v_mov_b32 v95, 0
    v_mov_b32 v96, 0
    v_mov_b32 v97, 0
    v_mov_b32 v98, 0
    v_mov_b32 v99, 0
    v_mov_b32 v100, 0
    v_mov_b32 v101, 0
    v_mov_b32 v102, 0
    v_mov_b32 v103, 0
    v_mov_b32 v104, 0
    v_mov_b32 v105, 0
    v_mov_b32 v106, 0
    v_mov_b32 v107, 0
    v_mov_b32 v244, 0
    v_mov_b32 v245, 0
    v_mov_b32 v246, 0
    s_lshl_b32 s99, s3, 8
    v_add_u32 v249, s99, v223
    v_mul_u32_u24 v249, 272, v249
    v_lshl_add_u32 v243, v219, 3, v249
    s_mov_b32 s99, 7602176
    s_cmp_eq_u32 s7, 0
    s_cbranch_scc1 K2_NOLD
    buffer_load_dwordx4 v[76:79], v243, s[20:23], s99 offen offset:0 sc0 sc1
    buffer_load_dwordx4 v[80:83], v243, s[20:23], s99 offen offset:16 sc0 sc1
    buffer_load_dwordx4 v[84:87], v243, s[20:23], s99 offen offset:32 sc0 sc1
    buffer_load_dwordx4 v[88:91], v243, s[20:23], s99 offen offset:48 sc0 sc1
    buffer_load_dwordx4 v[92:95], v243, s[20:23], s99 offen offset:64 sc0 sc1
    buffer_load_dwordx4 v[96:99], v243, s[20:23], s99 offen offset:80 sc0 sc1
    buffer_load_dwordx4 v[100:103], v243, s[20:23], s99 offen offset:96 sc0 sc1
    buffer_load_dwordx4 v[104:107], v243, s[20:23], s99 offen offset:112 sc0 sc1
    buffer_load_dwordx3 v[244:246], v249, s[20:23], s99 offen offset:256 sc0 sc1
    s_waitcnt vmcnt(0)
K2_NOLD:
    s_waitcnt lgkmcnt(0)
    v_and_b32 v207, 0xffff, v235
    v_lshrrev_b32 v235, 16, v235
    v_lshlrev_b32 v247, 11, v219
    v_add_u32 v247, 34816, v247
    v_add_u32 v220, 138240, v203
    v_cmp_lt_u32 vcc, 0, v235
    s_barrier
    s_cbranch_vccz K2_GDONE
K2_GLOOP:
    s_mov_b64 exec, vcc
    v_bfe_u32 v221, v207, 3, 3
    v_lshlrev_b32 v221, 4, v221
    v_lshl_add_u32 v221, v207, 5, v221
    v_add_u32 v221, v247, v221
    v_xor_b32 v222, 0, v221
    ds_read_b128 v[140:143], v222
    v_xor_b32 v222, 16, v221
    ds_read_b128 v[144:147], v222
    v_xor_b32 v222, 32, v221
    ds_read_b128 v[148:151], v222
    v_xor_b32 v222, 48, v221
    ds_read_b128 v[152:155], v222
    v_xor_b32 v222, 64, v221
    ds_read_b128 v[156:159], v222
    v_xor_b32 v222, 80, v221
    ds_read_b128 v[160:163], v222
    v_xor_b32 v222, 96, v221
    ds_read_b128 v[164:167], v222
    v_xor_b32 v222, 112, v221
    ds_read_b128 v[168:171], v222
    v_lshlrev_b32 v222, 3, v207
    v_add_u32 v222, 129024, v222
    ds_read_b128 v[188:191], v222
    ds_read_b128 v[192:195], v222 offset:16
    v_add_u32 v207, 4, v207
    v_subrev_u32 v235, 1, v235
    v_cmp_lt_u32 vcc, 0, v235
    s_waitcnt lgkmcnt(9)
    v_pk_add_f32 v[76:77], v[76:77], v[140:141]
    v_pk_add_f32 v[78:79], v[78:79], v[142:143]
    s_waitcnt lgkmcnt(8)
    v_pk_add_f32 v[80:81], v[80:81], v[144:145]
    v_pk_add_f32 v[82:83], v[82:83], v[146:147]
    s_waitcnt lgkmcnt(7)
    v_pk_add_f32 v[84:85], v[84:85], v[148:149]
    v_pk_add_f32 v[86:87], v[86:87], v[150:151]
    s_waitcnt lgkmcnt(6)
    v_pk_add_f32 v[88:89], v[88:89], v[152:153]
    v_pk_add_f32 v[90:91], v[90:91], v[154:155]
    s_waitcnt lgkmcnt(5)
    v_pk_add_f32 v[92:93], v[92:93], v[156:157]
    v_pk_add_f32 v[94:95], v[94:95], v[158:159]
    s_waitcnt lgkmcnt(4)
    v_pk_add_f32 v[96:97], v[96:97], v[160:161]
    v_pk_add_f32 v[98:99], v[98:99], v[162:163]
    s_waitcnt lgkmcnt(3)
    v_pk_add_f32 v[100:101], v[100:101], v[164:165]
    v_pk_add_f32 v[102:103], v[102:103], v[166:167]
    s_waitcnt lgkmcnt(2)
    v_pk_add_f32 v[104:105], v[104:105], v[168:169]
    v_pk_add_f32 v[106:107], v[106:107], v[170:171]
    s_waitcnt lgkmcnt(0)
    v_pk_add_f32 v[244:245], v[244:245], v[188:189]
    v_add_f32 v246, v246, v190
    v_pk_add_f32 v[244:245], v[244:245], v[192:193]
    v_add_f32 v246, v246, v194
    s_cbranch_vccnz K2_GLOOP
    s_mov_b64 exec, -1
K2_GDONE:
    s_cmp_eq_u32 s93, 0
    s_cbranch_scc1 K2_EPI
    buffer_store_dwordx4 v[76:79], v243, s[20:23], s99 offen offset:0
    buffer_store_dwordx4 v[80:83], v243, s[20:23], s99 offen offset:16
    buffer_store_dwordx4 v[84:87], v243, s[20:23], s99 offen offset:32
    buffer_store_dwordx4 v[88:91], v243, s[20:23], s99 offen offset:48
    buffer_store_dwordx4 v[92:95], v243, s[20:23], s99 offen offset:64
    buffer_store_dwordx4 v[96:99], v243, s[20:23], s99 offen offset:80
    buffer_store_dwordx4 v[100:103], v243, s[20:23], s99 offen offset:96
    buffer_store_dwordx4 v[104:107], v243, s[20:23], s99 offen offset:112
    buffer_store_dwordx3 v[244:246], v249, s[20:23], s99 offen offset:256
    s_add_u32 s7, s7, s92
    s_waitcnt vmcnt(0)
    s_barrier
    s_branch K2_TOP
K2_EPI:
    s_cmp_ge_u32 s5, 6
    s_cbranch_scc1 K2_NWH2
    s_mul_i32 s95, s5, 2048
    s_add_u32 m0, s95, 138240
    s_add_u32 s95, s95, 7561216
    buffer_load_dwordx4 v203, s[20:23], s95 offen offset:0 lds
    buffer_load_dwordx4 v203, s[20:23], s95 offen offset:1024 lds
K2_NWH2:
    s_lshl_b32 s95, s5, 5
    s_cmp_ge_u32 s95, s96
    s_waitcnt vmcnt(0)
    s_barrier
    s_cbranch_scc1 K2_END0
    ds_read_b128 v[0:3], v220 offset:20480
    ds_read_b128 v[4:7], v220 offset:21504
    ds_read_b128 v[8:11], v220 offset:22528
    ds_read_b128 v[12:15], v220 offset:23552
    ds_read_b128 v[16:19], v220 offset:0
    ds_read_b128 v[20:23], v220 offset:1024
    ds_read_b128 v[24:27], v220 offset:2048
    ds_read_b128 v[28:31], v220 offset:3072
    ds_read_b128 v[44:47], v220 offset:4096
    ds_read_b128 v[48:51], v220 offset:5120
    ds_read_b128 v[52:55], v220 offset:6144
    ds_read_b128 v[56:59], v220 offset:7168
    ds_read_b128 v[60:63], v220 offset:8192
    ds_read_b128 v[64:67], v220 offset:9216
    ds_read_b128 v[68:71], v220 offset:10240
    ds_read_b128 v[72:75], v220 offset:11264
    v_cmp_gt_u32_e64 s[44:45], s96, v223
    s_mov_b32 s98, s101
    s_waitcnt vmcnt(0)
    v_mov_b32 v242, v241
    v_and_b32 v241, 0xffff0000, v240
    v_lshlrev_b32 v240, 16, v240
K2_TAIL:
    v_add_u32 v235, s98, v203
    v_lshlrev_b32 v203, 7, v218
    v_cndmask_b32_e64 v203, 2.0, v203, s[44:45]
    s_waitcnt lgkmcnt(8)
    v_mfma_f32_32x32x16_bf16 v[140:155], v[0:3], v[172:175], 0
    v_cvt_pk_bf16_f32 v108, v76, v77
    v_cvt_pk_bf16_f32 v109, v78, v79
    v_mfma_f32_32x32x16_bf16 v[156:171], v[16:19], v[172:175], 0
    v_cvt_pk_bf16_f32 v110, v80, v81
    v_cvt_pk_bf16_f32 v111, v82, v83
    v_mfma_f32_32x32x16_bf16 v[140:155], v[4:7], v[176:179], v[140:155]
    v_cvt_pk_bf16_f32 v112, v84, v85
    v_cvt_pk_bf16_f32 v113, v86, v87
    v_mfma_f32_32x32x16_bf16 v[156:171], v[20:23], v[176:179], v[156:171]
    v_cvt_pk_bf16_f32 v114, v88, v89
    v_cvt_pk_bf16_f32 v115, v90, v91
    v_mfma_f32_32x32x16_bf16 v[140:155], v[8:11], v[180:183], v[140:155]
    v_cvt_pk_bf16_f32 v116, v92, v93
    v_cvt_pk_bf16_f32 v117, v94, v95
    v_mfma_f32_32x32x16_bf16 v[156:171], v[24:27], v[180:183], v[156:171]
    v_cvt_pk_bf16_f32 v118, v96, v97
    v_cvt_pk_bf16_f32 v119, v98, v99
    v_mfma_f32_32x32x16_bf16 v[140:155], v[12:15], v[184:187], v[140:155]
    v_cvt_pk_bf16_f32 v120, v100, v101
    v_cvt_pk_bf16_f32 v121, v102, v103
    v_mfma_f32_32x32x16_bf16 v[156:171], v[28:31], v[184:187], v[156:171]
    v_cvt_pk_bf16_f32 v122, v104, v105
    v_cvt_pk_bf16_f32 v123, v106, v107
    s_waitcnt lgkmcnt(0)
    ds_bpermute_b32 v210, v239, v203 offset:0
    ds_bpermute_b32 v212, v239, v203 offset:32
    ds_bpermute_b32 v214, v239, v203 offset:64
    ds_bpermute_b32 v216, v239, v203 offset:96
    v_mfma_f32_32x32x16_bf16 v[140:155], v[44:47], v[108:111], v[140:155]
    v_lshlrev_b32 v76, 16, v172
    v_and_b32 v77, 0xffff0000, v172
    v_lshlrev_b32 v78, 16, v173
    v_and_b32 v79, 0xffff0000, v173
    v_lshlrev_b32 v80, 16, v174
    v_and_b32 v81, 0xffff0000, v174
    v_lshlrev_b32 v82, 16, v175
    v_and_b32 v83, 0xffff0000, v175
    v_mfma_f32_32x32x16_bf16 v[140:155], v[48:51], v[112:115], v[140:155]
    v_lshlrev_b32 v84, 16, v176
    v_and_b32 v85, 0xffff0000, v176
    v_lshlrev_b32 v86, 16, v177
    v_and_b32 v87, 0xffff0000, v177
    v_lshlrev_b32 v88, 16, v178
    v_and_b32 v89, 0xffff0000, v178
    v_lshlrev_b32 v90, 16, v179
    v_and_b32 v91, 0xffff0000, v179
    v_mfma_f32_32x32x16_bf16 v[140:155], v[52:55], v[116:119], v[140:155]
    v_lshlrev_b32 v92, 16, v180
    v_and_b32 v93, 0xffff0000, v180
    v_lshlrev_b32 v94, 16, v181
    v_and_b32 v95, 0xffff0000, v181
    v_lshlrev_b32 v96, 16, v182
    v_and_b32 v97, 0xffff0000, v182
    v_lshlrev_b32 v98, 16, v183
    v_and_b32 v99, 0xffff0000, v183
    v_mfma_f32_32x32x16_bf16 v[140:155], v[56:59], v[120:123], v[140:155]
    v_lshlrev_b32 v100, 16, v184
    v_and_b32 v101, 0xffff0000, v184
    v_lshlrev_b32 v102, 16, v185
    v_and_b32 v103, 0xffff0000, v185
    v_lshlrev_b32 v104, 16, v186
    v_and_b32 v105, 0xffff0000, v186
    v_lshlrev_b32 v106, 16, v187
    v_and_b32 v107, 0xffff0000, v187
    v_mfma_f32_32x32x16_bf16 v[156:171], v[60:63], v[108:111], v[156:171]
    v_mov_b32 v243, 0
    v_pk_add_f32 v[244:245], v[244:245], v[240:241]
    v_add_f32 v246, v246, v242
    v_cvt_pk_bf16_f32 v244, v244, v245
    v_cvt_pk_bf16_f32 v246, v246, v246
    s_mov_b32 exec_lo, s44
    s_mov_b32 exec_hi, 0
    s_cmp_eq_u32 s98, s94
    s_cbranch_scc1 K2_PF
    v_mul_u32_u24 v220, 6, v218
    s_mov_b32 s99, 6400000
    buffer_store_short v244, v220, s[24:27], s99 offen
    buffer_store_short_d16_hi v244, v220, s[24:27], s99 offen offset:2
    buffer_store_short v246, v220, s[24:27], s99 offen offset:4
    s_branch K2_PD
K2_PF:
    s_mov_b32 s99, 32768
    v_mad_u32_u24 v220, v249, 6, s99
    ds_write_b16 v220, v244
    ds_write_b16_d16_hi v220, v244 offset:2
    ds_write_b16 v220, v246 offset:4
    s_mov_b64 exec, 1
    v_mov_b32 v220, 108
    v_mov_b32 v221, 1
    ds_add_rtn_u32 v243, v220, v221
K2_PD:
    s_mov_b64 exec, -1
    s_mov_b32 s40, 0xbf317218
    s_mov_b32 s41, 0xbf317218
    v_mfma_f32_32x32x16_bf16 v[156:171], v[64:67], v[112:115], v[156:171]
    v_exp_f32 v220, v140
    v_exp_f32 v221, v141
    v_exp_f32 v222, v142
    v_exp_f32 v223, v143
    v_mfma_f32_32x32x16_bf16 v[156:171], v[68:71], v[116:119], v[156:171]
    v_exp_f32 v224, v144
    v_exp_f32 v225, v145
    v_exp_f32 v226, v146
    v_exp_f32 v227, v147
    v_pk_add_f32 v[220:221], v[220:221], 1.0 op_sel_hi:[1,0]
    v_pk_add_f32 v[222:223], v[222:223], 1.0 op_sel_hi:[1,0]
    v_mfma_f32_32x32x16_bf16 v[156:171], v[72:75], v[120:123], v[156:171]
    v_pk_add_f32 v[224:225], v[224:225], 1.0 op_sel_hi:[1,0]
    v_pk_add_f32 v[226:227], v[226:227], 1.0 op_sel_hi:[1,0]
    v_rcp_f32 v220, v220
    v_rcp_f32 v221, v221
    v_rcp_f32 v222, v222
    v_rcp_f32 v223, v223
    v_rcp_f32 v224, v224
    v_rcp_f32 v225, v225
    v_rcp_f32 v226, v226
    v_rcp_f32 v227, v227
    s_waitcnt lgkmcnt(0)
    v_add_u32 v210, v210, v211
    v_add_u32 v212, v212, v213
    v_add_u32 v214, v214, v215
    v_add_u32 v216, v216, v217
    v_pk_mul_f32 v[220:221], v[220:221], v[140:141]
    v_pk_mul_f32 v[222:223], v[222:223], v[142:143]
    v_pk_mul_f32 v[224:225], v[224:225], v[144:145]
    v_pk_mul_f32 v[226:227], v[226:227], v[146:147]
    v_pk_fma_f32 v[220:221], v[220:221], s[40:41], v[76:77]
    v_pk_fma_f32 v[222:223], v[222:223], s[40:41], v[78:79]
    v_pk_fma_f32 v[224:225], v[224:225], s[40:41], v[80:81]
    v_pk_fma_f32 v[226:227], v[226:227], s[40:41], v[82:83]
    v_cvt_pk_bf16_f32 v172, v220, v221
    v_cvt_pk_bf16_f32 v173, v222, v223
    v_cvt_pk_bf16_f32 v174, v224, v225
    v_cvt_pk_bf16_f32 v175, v226, v227
    s_waitcnt vmcnt(0)
    ds_write_b128 v251, v[172:175]
    v_exp_f32 v220, v148
    v_exp_f32 v221, v149
    v_exp_f32 v222, v150
    v_exp_f32 v223, v151
    v_exp_f32 v224, v152
    v_exp_f32 v225, v153
    v_exp_f32 v226, v154
    v_exp_f32 v227, v155
    v_pk_add_f32 v[220:221], v[220:221], 1.0 op_sel_hi:[1,0]
    v_pk_add_f32 v[222:223], v[222:223], 1.0 op_sel_hi:[1,0]
    v_pk_add_f32 v[224:225], v[224:225], 1.0 op_sel_hi:[1,0]
    v_pk_add_f32 v[226:227], v[226:227], 1.0 op_sel_hi:[1,0]
    v_rcp_f32 v220, v220
    v_rcp_f32 v221, v221
    v_rcp_f32 v222, v222
    v_rcp_f32 v223, v223
    v_rcp_f32 v224, v224
    v_rcp_f32 v225, v225
    v_rcp_f32 v226, v226
    v_rcp_f32 v227, v227
    v_pk_mul_f32 v[220:221], v[220:221], v[148:149]
    v_pk_mul_f32 v[222:223], v[222:223], v[150:151]
    v_pk_mul_f32 v[224:225], v[224:225], v[152:153]
    v_pk_mul_f32 v[226:227], v[226:227], v[154:155]
    v_pk_fma_f32 v[220:221], v[220:221], s[40:41], v[84:85]
    v_pk_fma_f32 v[222:223], v[222:223], s[40:41], v[86:87]
    v_pk_fma_f32 v[224:225], v[224:225], s[40:41], v[88:89]
    v_pk_fma_f32 v[226:227], v[226:227], s[40:41], v[90:91]
    v_cvt_pk_bf16_f32 v176, v220, v221
    v_cvt_pk_bf16_f32 v177, v222, v223
    v_cvt_pk_bf16_f32 v178, v224, v225
    v_cvt_pk_bf16_f32 v179, v226, v227
    ds_write_b128 v252, v[176:179]
    v_exp_f32 v220, v156
    v_exp_f32 v221, v157
    v_exp_f32 v222, v158
    v_exp_f32 v223, v159
    v_exp_f32 v224, v160
    v_exp_f32 v225, v161
    v_exp_f32 v226, v162
    v_exp_f32 v227, v163
    v_pk_add_f32 v[220:221], v[220:221], 1.0 op_sel_hi:[1,0]
    v_pk_add_f32 v[222:223], v[222:223], 1.0 op_sel_hi:[1,0]
    v_pk_add_f32 v[224:225], v[224:225], 1.0 op_sel_hi:[1,0]
    v_pk_add_f32 v[226:227], v[226:227], 1.0 op_sel_hi:[1,0]
    v_rcp_f32 v220, v220
    v_rcp_f32 v221, v221
    v_rcp_f32 v222, v222
    v_rcp_f32 v223, v223
    v_rcp_f32 v224, v224
    v_rcp_f32 v225, v225
    v_rcp_f32 v226, v226
    v_rcp_f32 v227, v227
    v_pk_mul_f32 v[220:221], v[220:221], v[156:157]
    v_pk_mul_f32 v[222:223], v[222:223], v[158:159]
    v_pk_mul_f32 v[224:225], v[224:225], v[160:161]
    v_pk_mul_f32 v[226:227], v[226:227], v[162:163]
    v_pk_fma_f32 v[220:221], v[220:221], s[40:41], v[92:93]
    v_pk_fma_f32 v[222:223], v[222:223], s[40:41], v[94:95]
    v_pk_fma_f32 v[224:225], v[224:225], s[40:41], v[96:97]
    v_pk_fma_f32 v[226:227], v[226:227], s[40:41], v[98:99]
    v_cvt_pk_bf16_f32 v180, v220, v221
    v_cvt_pk_bf16_f32 v181, v222, v223
    v_cvt_pk_bf16_f32 v182, v224, v225
    v_cvt_pk_bf16_f32 v183, v226, v227
    ds_write_b128 v253, v[180:183]
    v_exp_f32 v220, v164
    v_exp_f32 v221, v165
    v_exp_f32 v222, v166
    v_exp_f32 v223, v167
    v_exp_f32 v224, v168
    v_exp_f32 v225, v169
    v_exp_f32 v226, v170
    v_exp_f32 v227, v171
    v_pk_add_f32 v[220:221], v[220:221], 1.0 op_sel_hi:[1,0]
    v_pk_add_f32 v[222:223], v[222:223], 1.0 op_sel_hi:[1,0]
    v_pk_add_f32 v[224:225], v[224:225], 1.0 op_sel_hi:[1,0]
    v_pk_add_f32 v[226:227], v[226:227], 1.0 op_sel_hi:[1,0]
    v_rcp_f32 v220, v220
    v_rcp_f32 v221, v221
    v_rcp_f32 v222, v222
    v_rcp_f32 v223, v223
    v_rcp_f32 v224, v224
    v_rcp_f32 v225, v225
    v_rcp_f32 v226, v226
    v_rcp_f32 v227, v227
    v_pk_mul_f32 v[220:221], v[220:221], v[164:165]
    v_pk_mul_f32 v[222:223], v[222:223], v[166:167]
    v_pk_mul_f32 v[224:225], v[224:225], v[168:169]
    v_pk_mul_f32 v[226:227], v[226:227], v[170:171]
    v_pk_fma_f32 v[220:221], v[220:221], s[40:41], v[100:101]
    v_pk_fma_f32 v[222:223], v[222:223], s[40:41], v[102:103]
    v_pk_fma_f32 v[224:225], v[224:225], s[40:41], v[104:105]
    v_pk_fma_f32 v[226:227], v[226:227], s[40:41], v[106:107]
    v_cvt_pk_bf16_f32 v184, v220, v221
    v_cvt_pk_bf16_f32 v185, v222, v223
    v_cvt_pk_bf16_f32 v186, v224, v225
    v_cvt_pk_bf16_f32 v187, v226, v227
    ds_write_b128 v254, v[184:187]
    ds_read_b128 v[140:143], v235 offset:0
    ds_read_b128 v[144:147], v235 offset:1024
    ds_read_b128 v[148:151], v235 offset:2048
    ds_read_b128 v[152:155], v235 offset:3072
    s_waitcnt lgkmcnt(3)
    buffer_store_dwordx4 v[140:143], v210, s[24:27], 0 offen sc1
    s_waitcnt lgkmcnt(2)
    buffer_store_dwordx4 v[144:147], v212, s[24:27], 0 offen sc1
    s_waitcnt lgkmcnt(1)
    buffer_store_dwordx4 v[148:151], v214, s[24:27], 0 offen sc1
    s_waitcnt lgkmcnt(0)
    buffer_store_dwordx4 v[152:155], v216, s[24:27], 0 offen sc1
    v_readfirstlane_b32 s95, v243
    v_and_b32 v220, 63, v250
    v_lshlrev_b32 v220, 3, v220
    s_cmp_lg_u32 s95, 7
    s_cbranch_scc1 K2_PE
    ds_read_b64 v[188:189], v220 offset:32768
    ds_read_b64 v[190:191], v220 offset:33280
    ds_read_b64 v[192:193], v220 offset:33792
    s_mul_i32 s99, s4, 6
    s_add_u32 s99, s99, 6400000
    s_mul_i32 s95, s96, 6
    v_cmp_gt_i32 vcc, s95, v220
    s_sub_i32 s95, s95, 512
    s_waitcnt lgkmcnt(2)
    s_mov_b64 exec, vcc
    buffer_store_dwordx2 v[188:189], v220, s[24:27], s99 offen offset:0 sc1
    v_cmp_gt_i32 vcc, s95, v220
    s_sub_i32 s95, s95, 512
    s_waitcnt lgkmcnt(1)
    s_mov_b64 exec, vcc
    buffer_store_dwordx2 v[190:191], v220, s[24:27], s99 offen offset:512 sc1
    v_cmp_gt_i32 vcc, s95, v220
    s_sub_i32 s95, s95, 512
    s_waitcnt lgkmcnt(0)
    s_mov_b64 exec, vcc
    buffer_store_dwordx2 v[192:193], v220, s[24:27], s99 offen offset:1024 sc1
    s_mov_b64 exec, -1
K2_PE:
    s_endpgm
K2_END0:
    s_waitcnt vmcnt(0)
K2_END:
    s_endpgm
.section .rodata,"a"
.p2align 6
.amdhsa_kernel egnn_sort_kernel
  .amdhsa_next_free_vgpr 56
  .amdhsa_next_free_sgpr 48
  .amdhsa_accum_offset 56
  .amdhsa_group_segment_fixed_size 0
  .amdhsa_kernarg_size 88
  .amdhsa_user_sgpr_count 2
  .amdhsa_user_sgpr_kernarg_segment_ptr 1
  .amdhsa_system_sgpr_workgroup_id_x 1
.end_amdhsa_kernel
.p2align 6
.amdhsa_kernel egnn_main_kernel
  .amdhsa_next_free_vgpr 256
  .amdhsa_next_free_sgpr 102
  .amdhsa_accum_offset 256
  .amdhsa_group_segment_fixed_size 0
  .amdhsa_kernarg_size 88
  .amdhsa_user_sgpr_count 2
  .amdhsa_user_sgpr_kernarg_segment_ptr 1
  .amdhsa_system_sgpr_workgroup_id_x 1
.end_amdhsa_kernel
```

```asm
; @launch kernel=egnn_sort_kernel grid=(250,1,1) block=(896,1,1) lds=27904
; @launch kernel=egnn_main_kernel grid=(256,1,1) block=(512,1,1) lds=162816
.amdgcn_target "amdgcn-amd-amdhsa--gfx950"
.text
.globl egnn_sort_kernel
.p2align 8
.type egnn_sort_kernel,@function
egnn_sort_kernel:
    s_cmp_ge_u32 s2, 250
    s_cbranch_scc1 K1_END
    s_load_dwordx2 s[38:39], s[0:1], 80
    v_lshrrev_b32 v1, 6, v0
    s_nop 0
    v_readfirstlane_b32 s3, v1
    s_cmp_ge_u32 s3, 13
    s_cbranch_scc1 K1_FRAG
    s_load_dwordx4 s[4:7], s[0:1], 24
    s_load_dwordx4 s[8:11], s[0:1], 8
    s_and_b32 s28, s2, 7
    s_min_u32 s29, s28, 2
    s_mul_i32 s28, s28, 31
    s_lshr_b32 s2, s2, 3
    s_add_u32 s2, s2, s28
    s_add_u32 s2, s2, s29
    v_lshlrev_b32 v1, 2, v0
    v_mov_b32 v2, 0
    v_mov_b32 v3, 1
    v_cmp_gt_u32 vcc, 288, v0
    s_mov_b64 exec, vcc
    ds_write_b32 v1, v2 offset:0
    s_mov_b64 exec, -1
    s_mul_i32 s28, s2, 12800
    s_mul_i32 s29, s2, 200
    s_mul_i32 s30, s2, 3200
    s_mov_b32 s31, 85599
    s_movk_i32 s32, -196
    v_add_u32 v12, s29, v0
    v_mul_u32_u24 v13, 6, v12
    v_lshlrev_b32 v14, 4, v0
    v_mov_b32 v15, 800
    v_cmp_gt_u32 s[34:35], v15, v0
    v_mov_b32 v15, 200
    v_cmp_gt_u32 s[36:37], v15, v0
    s_waitcnt lgkmcnt(0)
    s_mov_b32 s12, s4
    s_and_b32 s13, s5, 0xffff
    s_mov_b32 s14, 3200000
    s_mov_b32 s15, 0x20000
    s_mov_b32 s16, s6
    s_and_b32 s17, s7, 0xffff
    s_mov_b32 s18, 3200000
    s_mov_b32 s19, 0x20000
    s_mov_b32 s20, s8
    s_and_b32 s21, s9, 0xffff
    s_mov_b32 s22, 300000
    s_mov_b32 s23, 0x20000
    s_mov_b32 s24, s38
    s_and_b32 s25, s39, 0xffff
    s_mov_b32 s26, 25600000
    s_mov_b32 s27, 0x20000
    s_cmp_ge_u32 s3, 4
    s_cbranch_scc1 K1_NOPOS
    s_mov_b64 exec, s[36:37]
    buffer_load_ushort v16, v13, s[20:23], 0 offen
    buffer_load_ushort v17, v13, s[20:23], 0 offen offset:2
    buffer_load_ushort v18, v13, s[20:23], 0 offen offset:4
K1_NOPOS:
    s_mov_b64 exec, s[34:35]
    buffer_load_dwordx4 v[4:7], v14, s[16:19], s28 offen nt
    v_add_u32 v20, s30, v1
    v_add_u32 v22, 1, v20
    v_add_u32 v24, 2, v20
    v_add_u32 v26, 3, v20
    s_barrier
    s_waitcnt vmcnt(0)
    buffer_load_dwordx4 v[8:11], v14, s[12:15], s28 offen nt
    v_mul_u32_u24 v28, s31, v4
    v_lshrrev_b32 v28, 24, v28
    v_mad_i32_i24 v4, v28, s32, v4
    v_lshlrev_b32 v28, 2, v28
    ds_add_rtn_u32 v32, v28, v3 offset:0
    v_mul_u32_u24 v29, s31, v5
    v_lshrrev_b32 v29, 24, v29
    v_mad_i32_i24 v5, v29, s32, v5
    v_lshlrev_b32 v29, 2, v29
    ds_add_rtn_u32 v33, v29, v3 offset:0
    v_mul_u32_u24 v30, s31, v6
    v_lshrrev_b32 v30, 24, v30
    v_mad_i32_i24 v6, v30, s32, v6
    v_lshlrev_b32 v30, 2, v30
    ds_add_rtn_u32 v34, v30, v3 offset:0
    v_mul_u32_u24 v31, s31, v7
    v_lshrrev_b32 v31, 24, v31
    v_mad_i32_i24 v7, v31, s32, v7
    v_lshlrev_b32 v31, 2, v31
    ds_add_rtn_u32 v35, v31, v3 offset:0
    s_cmp_ge_u32 s3, 4
    s_cbranch_scc1 K1_P3
    s_mov_b64 exec, s[36:37]
    v_lshl_or_b32 v16, v17, 16, v16
    v_lshlrev_b32 v17, 16, v18
    v_lshlrev_b32 v12, 3, v12
    s_mov_b32 s33, 6684672
    buffer_store_dwordx2 v[16:17], v12, s[24:27], s33 offen
    s_mov_b64 exec, s[34:35]
K1_P3:
    s_mov_b64 exec, -1
    v_and_b32 v2, 63, v0
    v_lshlrev_b32 v2, 4, v2
    s_waitcnt lgkmcnt(0)
    s_barrier
    ds_read_b128 v[36:39], v2 offset:0
    s_waitcnt lgkmcnt(0)
    v_add_u32 v42, v36, v37
    v_add_u32 v43, v42, v38
    v_add_u32 v44, v43, v39
    v_mov_b32 v45, v44
    s_nop 1
    v_add_u32_dpp v45, v45, v45 row_shr:1 row_mask:0xf bank_mask:0xf
    s_nop 1
    v_add_u32_dpp v45, v45, v45 row_shr:2 row_mask:0xf bank_mask:0xf
    s_nop 1
    v_add_u32_dpp v45, v45, v45 row_shr:4 row_mask:0xf bank_mask:0xf
    s_nop 1
    v_add_u32_dpp v45, v45, v45 row_shr:8 row_mask:0xf bank_mask:0xf
    s_nop 1
    v_add_u32_dpp v45, v45, v45 row_bcast:15 row_mask:0xa bank_mask:0xf
    s_nop 1
    v_add_u32_dpp v45, v45, v45 row_bcast:31 row_mask:0xc bank_mask:0xf
    v_sub_u32 v40, v45, v44
    v_add_u32 v41, v40, v36
    v_add_u32 v42, v40, v42
    v_add_u32 v43, v40, v43
    v_lshlrev_b32 v48, 3, v40
    v_lshlrev_b32 v49, 3, v41
    v_lshlrev_b32 v50, 3, v42
    v_lshlrev_b32 v51, 3, v43
    ds_write_b128 v2, v[48:51] offset:1280
    s_mov_b64 exec, s[34:35]
    ds_read_b32 v28, v28 offset:1280
    ds_read_b32 v29, v29 offset:1280
    ds_read_b32 v30, v30 offset:1280
    ds_read_b32 v31, v31 offset:1280
    s_cmp_ge_u32 s3, 4
    s_cbranch_scc1 K1_SW0
    s_waitcnt vmcnt(1)
    s_branch K1_SW1
K1_SW0:
    s_waitcnt vmcnt(0)
K1_SW1:
    v_mul_u32_u24 v21, 1342, v8
    v_lshrrev_b32 v21, 24, v21
    v_lshl_or_b32 v4, v4, 2, v21
    v_lshl_or_b32 v21, v4, 18, v8
    v_mul_u32_u24 v23, 1342, v9
    v_lshrrev_b32 v23, 24, v23
    v_lshl_or_b32 v5, v5, 2, v23
    v_lshl_or_b32 v23, v5, 18, v9
    v_mul_u32_u24 v25, 1342, v10
    v_lshrrev_b32 v25, 24, v25
    v_lshl_or_b32 v6, v6, 2, v25
    v_lshl_or_b32 v25, v6, 18, v10
    v_mul_u32_u24 v27, 1342, v11
    v_lshrrev_b32 v27, 24, v27
    v_lshl_or_b32 v7, v7, 2, v27
    v_lshl_or_b32 v27, v7, 18, v11
    s_cmp_lg_u32 s3, 12
    s_cbranch_scc1 K1_NOOFF
    s_mov_b64 exec, -1
    v_lshl_or_b32 v40, v36, 16, v40
    v_lshl_or_b32 v41, v37, 16, v41
    v_lshl_or_b32 v42, v38, 16, v42
    v_lshl_or_b32 v43, v39, 16, v43
    v_lshlrev_b32 v2, 8, v2
    s_lshl_b32 s33, s2, 4
    s_add_u32 s33, s33, 6422528
    buffer_store_dwordx4 v[40:43], v2, s[24:27], s33 offen
    s_mov_b64 exec, s[34:35]
K1_NOOFF:
    s_waitcnt lgkmcnt(3)
    v_lshl_add_u32 v28, v32, 3, v28
    ds_write_b64 v28, v[20:21] offset:2304
    s_waitcnt lgkmcnt(3)
    v_lshl_add_u32 v29, v33, 3, v29
    ds_write_b64 v29, v[22:23] offset:2304
    s_waitcnt lgkmcnt(3)
    v_lshl_add_u32 v30, v34, 3, v30
    ds_write_b64 v30, v[24:25] offset:2304
    s_waitcnt lgkmcnt(3)
    v_lshl_add_u32 v31, v35, 3, v31
    ds_write_b64 v31, v[26:27] offset:2304
    s_mul_i32 s33, s2, 25600
    s_add_u32 s38, s33, 12800
    s_waitcnt lgkmcnt(0)
    s_barrier
    ds_read_b128 v[4:7], v14 offset:2304
    ds_read_b128 v[8:11], v14 offset:15104
    s_waitcnt lgkmcnt(1)
    buffer_store_dwordx4 v[4:7], v14, s[24:27], s33 offen sc1
    s_waitcnt lgkmcnt(0)
    buffer_store_dwordx4 v[8:11], v14, s[24:27], s38 offen sc1
    s_endpgm
K1_FRAG:
    s_cmp_ge_u32 s2, 144
    s_cbranch_scc1 K1_END
    s_load_dwordx4 s[4:7], s[0:1], 40
    s_load_dwordx2 s[8:9], s[0:1], 56
    s_lshr_b32 s28, s2, 2
    s_and_b32 s3, s2, 3
    s_lshl_b32 s3, s3, 6
    v_and_b32 v1, 63, v0
    v_add_u32 v1, s3, v1
    v_lshlrev_b32 v10, 2, v1
    s_lshl_b32 s33, s28, 10
    s_add_u32 s33, s33, 7536640
    s_mov_b32 s34, 0xbfb8aa3b
    s_waitcnt lgkmcnt(0)
    s_mov_b32 s12, s4
    s_and_b32 s13, s5, 0xffff
    s_mov_b32 s14, 18560
    s_mov_b32 s15, 0x20000
    s_mov_b32 s16, s6
    s_and_b32 s17, s7, 0xffff
    s_mov_b32 s18, 128
    s_mov_b32 s19, 0x20000
    s_mov_b32 s20, s8
    s_and_b32 s21, s9, 0xffff
    s_mov_b32 s22, 16384
    s_mov_b32 s23, 0x20000
    s_mov_b32 s24, s38
    s_and_b32 s25, s39, 0xffff
    s_mov_b32 s26, 25427968
    s_mov_b32 s27, 0x20000
    s_cmp_eq_u32 s28, 19
    s_cbranch_scc1 K1_WX
    s_cmp_eq_u32 s28, 18
    s_cbranch_scc1 K1_W3
    v_lshrrev_b32 v2, 2, v1
    v_and_b32 v3, 4, v2
    v_lshlrev_b32 v3, 3, v3
    v_bfe_u32 v4, v2, 3, 2
    v_lshl_add_u32 v3, v4, 2, v3
    v_and_b32 v4, 3, v2
    v_add_u32 v3, v3, v4
    v_lshrrev_b32 v5, 7, v1
    v_and_b32 v6, 3, v1
    s_mov_b32 s35, 32
    s_cmp_ge_u32 s28, 18
    s_cbranch_scc1 K1_FH
    s_cmp_ge_u32 s28, 16
    s_cbranch_scc1 K1_F4
    s_mov_b32 s36, s28
    s_branch K1_FC
K1_FH:
    s_sub_u32 s36, s28, 20
    s_mov_b32 s12, s20
    s_mov_b32 s13, s21
    s_mov_b32 s14, s22
    s_cmp_ge_u32 s36, 8
    s_cselect_b32 s34, 1.0, s34
K1_FC:
    s_lshr_b32 s37, s36, 3
    s_lshl_b32 s37, s37, 6
    s_and_b32 s38, s36, 3
    s_lshl_b32 s38, s38, 3
    s_add_u32 s37, s37, s38
    s_bfe_u32 s38, s36, 0x10002
    s_branch K1_FD
K1_F4:
    s_mov_b32 s35, 8
    s_movk_i32 s37, 129
    s_sub_u32 s38, s28, 16
K1_FD:
    s_lshl_b32 s38, s38, 4
    v_mul_u32_u24 v5, s35, v5
    v_lshl_add_u32 v5, v6, 1, v5
    v_add_u32 v5, s37, v5
    v_add_u32 v3, s38, v3
    v_lshlrev_b32 v3, 1, v3
    v_lshl_add_u32 v3, v5, 7, v3
    buffer_load_ushort v7, v3, s[12:15], 0 offen
    buffer_load_ushort v8, v3, s[12:15], 0 offen offset:128
    s_waitcnt vmcnt(0)
    v_lshlrev_b32 v7, 16, v7
    v_lshlrev_b32 v8, 16, v8
    v_mul_f32 v7, s34, v7
    v_mul_f32 v8, s34, v8
    v_cvt_pk_bf16_f32 v7, v7, v8
    buffer_store_dword v7, v10, s[24:27], s33 offen
    s_endpgm
K1_W3:
    v_and_b32 v2, 31, v1
    v_and_b32 v3, 4, v2
    v_lshlrev_b32 v3, 3, v3
    v_bfe_u32 v4, v2, 3, 2
    v_lshl_add_u32 v3, v4, 2, v3
    v_and_b32 v4, 3, v2
    v_add_u32 v3, v3, v4
    v_bfe_u32 v5, v1, 6, 1
    v_lshl_add_u32 v3, v5, 4, v3
    v_lshlrev_b32 v3, 1, v3
    s_movk_i32 s35, 16384
    buffer_load_ushort v7, v3, s[12:15], s35 offen
    v_and_b32 v6, 32, v1
    v_cmp_eq_u32 vcc, 0, v6
    s_waitcnt vmcnt(0)
    v_lshlrev_b32 v7, 16, v7
    v_mul_f32 v7, s34, v7
    v_cvt_pk_bf16_f32 v8, v7, v7
    v_lshlrev_b32 v8, 16, v8
    v_sub_f32 v9, v7, v8
    v_cvt_pk_bf16_f32 v7, v8, v9
    v_cndmask_b32 v7, 0, v7, vcc
    buffer_store_dword v7, v10, s[24:27], s33 offen
    s_endpgm
K1_WX:
    v_lshlrev_b32 v3, 1, v1
    buffer_load_ushort v7, v3, s[16:19], 0 offen
    s_waitcnt vmcnt(0)
    v_lshlrev_b32 v7, 16, v7
    v_mul_f32 v7, 0xbf317218, v7
    buffer_store_dword v7, v10, s[24:27], s33 offen
K1_END:
    s_endpgm
.globl egnn_main_kernel
.p2align 8
.type egnn_main_kernel,@function
egnn_main_kernel:
    s_cmp_ge_u32 s2, 256
    s_cbranch_scc1 K2_END
    s_load_dwordx2 s[28:29], s[0:1], 0
    s_load_dwordx2 s[30:31], s[0:1], 16
    s_load_dwordx2 s[32:33], s[0:1], 64
    s_load_dwordx2 s[34:35], s[0:1], 80
    v_mov_b32 v250, v0
    v_lshrrev_b32 v220, 6, v0
    s_and_b32 s3, s2, 7
    s_lshl_b32 s3, s3, 5
    v_readfirstlane_b32 s5, v220
    s_lshr_b32 s95, s2, 3
    s_add_u32 s3, s3, s95
    s_mul_i32 s4, s3, 196
    s_sub_u32 s96, 50000, s4
    s_min_u32 s96, s96, 196
    s_mov_b32 s7, 0
    s_mov_b32 s92, 48
    s_sub_u32 s100, 11, s5
    s_cmp_lt_u32 s5, 4
    s_cselect_b32 s100, s5, s100
    s_lshl_b32 s94, s100, 12
    s_add_u32 s94, s94, 34816
    s_waitcnt lgkmcnt(0)
    s_add_u32 s88, s34, 6422528
    s_addc_u32 s89, s35, 0
    s_and_b32 s89, s89, 0xffff
    s_mov_b32 s90, 262144
    s_mov_b32 s91, 0x20000
    s_mov_b32 s8, s28
    s_and_b32 s9, s29, 0xffff
    s_or_b32 s9, s9, 8388608
    s_mov_b32 s10, 50000
    s_mov_b32 s11, 0x20000
    s_mov_b32 s12, s30
    s_and_b32 s13, s31, 0xffff
    s_or_b32 s13, s13, 2097152
    s_mov_b32 s14, 800000
    s_mov_b32 s15, 0x20000
    s_add_u32 s16, s34, 6684672
    s_addc_u32 s17, s35, 0
    s_and_b32 s17, s17, 0xffff
    s_or_b32 s17, s17, 524288
    s_mov_b32 s18, 50000
    s_mov_b32 s19, 0x20000
    s_mov_b32 s20, s34
    s_and_b32 s21, s35, 0xffff
    s_mov_b32 s22, 25427968
    s_mov_b32 s23, 0x20000
    s_mov_b32 s24, s32
    s_and_b32 s25, s33, 0xffff
    s_mov_b32 s26, 6700000
    s_mov_b32 s27, 0x20000
K2_TOP:
    v_bfe_u32 v220, v250, 4, 2
    s_mul_i32 s95, s5, 36
    s_sub_u32 s95, s95, 36
    v_mad_u32_u24 v220, v220, 9, s95
    v_lshlrev_b32 v221, 4, v220
    s_and_b32 s95, s3, 3
    s_mul_i32 s95, s95, 1020
    s_lshl_b32 s99, s3, 10
    s_sub_u32 s95, s99, s95
    s_cmp_eq_u32 s5, 0
    s_cbranch_scc1 K2_NOOF
    buffer_load_dword v172, v221, s[88:91], s95 offen offset:0
    buffer_load_dword v173, v221, s[88:91], s95 offen offset:16
    buffer_load_dword v174, v221, s[88:91], s95 offen offset:32
    buffer_load_dword v175, v221, s[88:91], s95 offen offset:48
    buffer_load_dword v176, v221, s[88:91], s95 offen offset:64
    buffer_load_dword v177, v221, s[88:91], s95 offen offset:80
    buffer_load_dword v178, v221, s[88:91], s95 offen offset:96
    buffer_load_dword v179, v221, s[88:91], s95 offen offset:112
    buffer_load_dword v180, v221, s[88:91], s95 offen offset:128
K2_NOOF:
    v_and_b32 v222, 63, v250
    v_lshlrev_b32 v203, 4, v222
    v_lshrrev_b32 v239, 3, v222
    v_lshrrev_b32 v223, 4, v222
    v_xor_b32 v223, v223, v222
    v_and_b32 v223, 7, v223
    v_lshlrev_b32 v211, 4, v223
    v_xor_b32 v213, 64, v211
    v_mov_b32 v215, v211
    v_mov_b32 v217, v213
    s_lshl_b32 s95, s5, 5
    s_add_u32 s95, s95, s4
    v_add_u32 v210, s95, v239
    v_add_u32 v212, 8, v210
    v_add_u32 v214, 16, v210
    v_add_u32 v216, 24, v210
    s_add_u32 s99, s4, s96
    v_cmp_gt_u32 vcc, s99, v210
    s_nop 1
    v_cndmask_b32 v210, -1, v210, vcc
    v_cmp_gt_u32 vcc, s99, v212
    s_nop 1
    v_cndmask_b32 v212, -1, v212, vcc
    v_cmp_gt_u32 vcc, s99, v214
    s_nop 1
    v_cndmask_b32 v214, -1, v214, vcc
    v_cmp_gt_u32 vcc, s99, v216
    s_nop 1
    v_cndmask_b32 v216, -1, v216, vcc
    s_lshl_b32 s101, s5, 12
    s_add_u32 s101, s101, 100352
    s_barrier
    s_mul_i32 s95, s5, 3072
    s_add_u32 m0, s95, 138240
    s_add_u32 s95, s95, 7536640
    buffer_load_dwordx4 v203, s[20:23], s95 offen offset:0 lds
    buffer_load_dwordx4 v203, s[20:23], s95 offen offset:1024 lds
    buffer_load_dwordx4 v203, s[20:23], s95 offen offset:2048 lds
    v_mov_b32 v228, 0
    v_mov_b32 v229, 0
    v_mov_b32 v230, 0
    v_mov_b32 v231, 0
    s_lshl_b32 s95, s5, 10
    s_cmp_ge_u32 s5, 4
    s_cselect_b32 s99, 30720, 0
    s_add_u32 s95, s95, s99
    v_add_u32 v223, s95, v203
    ds_write_b128 v223, v[228:231]
    v_and_b32 v223, 2047, v223
    ds_write_b128 v223, v[228:231] offset:38912
    v_lshlrev_b32 v239, 2, v239
    v_mov_b32 v41, 0
    v_mov_b32 v43, 0
    v_mov_b32 v209, 0
    v_lshrrev_b32 v219, 5, v222
    v_lshlrev_b32 v219, 4, v219
    v_and_b32 v223, 31, v222
    v_bfe_u32 v251, v222, 1, 3
    v_lshlrev_b32 v251, 4, v251
    v_lshlrev_b32 v252, 2, v219
    v_xor_b32 v251, v251, v252
    v_lshl_add_u32 v251, v223, 7, v251
    v_add_u32 v251, s94, v251
    v_xor_b32 v252, 16, v251
    v_xor_b32 v253, 32, v251
    v_xor_b32 v254, 48, v251
    v_and_b32 v222, 15, v250
    v_cmp_gt_u32 vcc, 243, v220
    v_mul_u32_u24 v220, 3200, v220
    v_add3_u32 v220, v220, v222, s7
    v_add_u32 v221, 16, v222
    v_add_u32 v223, 32, v222
    v_cmp_gt_u32_e64 s[32:33], s92, v221
    v_cmp_gt_u32_e64 s[34:35], s92, v222
    s_nop 0
    v_cndmask_b32_e64 v221, 2.0, v221, s[32:33]
    v_cndmask_b32_e64 v223, 2.0, v223, s[32:33]
    v_cndmask_b32_e64 v222, 2.0, v222, s[34:35]
    s_cmp_eq_u32 s5, 0
    s_waitcnt vmcnt(3)
    s_cbranch_scc0 K2_MK
    s_branch K2_NOREC
K2_MK:
    v_cndmask_b32 v179, 0, v179, vcc
    v_cndmask_b32 v180, 0, v180, vcc
    v_and_b32 v98, 0xffff, v172
    v_lshrrev_b32 v172, 16, v172
    v_subrev_u32 v172, s7, v172
    v_cmp_gt_i32_e64 s[32:33], v172, v222
    v_add_lshl_u32 v98, v98, v220, 3
    s_mov_b32 s95, 0
    v_cndmask_b32_e64 v98, 2.0, v98, s[32:33]
    buffer_load_dwordx2 v[44:45], v98, s[20:23], s95 offen
    v_and_b32 v99, 0xffff, v173
    v_lshrrev_b32 v173, 16, v173
    v_subrev_u32 v173, s7, v173
    v_cmp_gt_i32_e64 s[34:35], v173, v222
    v_add_lshl_u32 v99, v99, v220, 3
    s_mov_b32 s95, 25600
    v_cndmask_b32_e64 v99, 2.0, v99, s[34:35]
    buffer_load_dwordx2 v[46:47], v99, s[20:23], s95 offen
    v_and_b32 v100, 0xffff, v174
    v_lshrrev_b32 v174, 16, v174
    v_subrev_u32 v174, s7, v174
    v_cmp_gt_i32_e64 s[36:37], v174, v222
    v_add_lshl_u32 v100, v100, v220, 3
    s_mov_b32 s95, 51200
    v_cndmask_b32_e64 v100, 2.0, v100, s[36:37]
    buffer_load_dwordx2 v[48:49], v100, s[20:23], s95 offen
    v_and_b32 v101, 0xffff, v175
    v_lshrrev_b32 v175, 16, v175
    v_subrev_u32 v175, s7, v175
    v_cmp_gt_i32_e64 s[38:39], v175, v222
    v_add_lshl_u32 v101, v101, v220, 3
    s_mov_b32 s95, 76800
    v_cndmask_b32_e64 v101, 2.0, v101, s[38:39]
    buffer_load_dwordx2 v[50:51], v101, s[20:23], s95 offen
    v_and_b32 v102, 0xffff, v176
    v_lshrrev_b32 v176, 16, v176
    v_subrev_u32 v176, s7, v176
    v_cmp_gt_i32_e64 s[40:41], v176, v222
    v_add_lshl_u32 v102, v102, v220, 3
    s_mov_b32 s95, 102400
    v_cndmask_b32_e64 v102, 2.0, v102, s[40:41]
    buffer_load_dwordx2 v[52:53], v102, s[20:23], s95 offen
    v_and_b32 v103, 0xffff, v177
    v_lshrrev_b32 v177, 16, v177
    v_subrev_u32 v177, s7, v177
    v_cmp_gt_i32_e64 s[42:43], v177, v222
    v_add_lshl_u32 v103, v103, v220, 3
    s_mov_b32 s95, 128000
    v_cndmask_b32_e64 v103, 2.0, v103, s[42:43]
    buffer_load_dwordx2 v[54:55], v103, s[20:23], s95 offen
    v_and_b32 v104, 0xffff, v178
    v_lshrrev_b32 v178, 16, v178
    v_subrev_u32 v178, s7, v178
    v_cmp_gt_i32_e64 s[44:45], v178, v222
    v_add_lshl_u32 v104, v104, v220, 3
    s_mov_b32 s95, 153600
    v_cndmask_b32_e64 v104, 2.0, v104, s[44:45]
    buffer_load_dwordx2 v[56:57], v104, s[20:23], s95 offen
    v_and_b32 v105, 0xffff, v179
    v_lshrrev_b32 v179, 16, v179
    v_subrev_u32 v179, s7, v179
    v_cmp_gt_i32_e64 s[46:47], v179, v222
    v_add_lshl_u32 v105, v105, v220, 3
    s_mov_b32 s95, 179200
    v_cndmask_b32_e64 v105, 2.0, v105, s[46:47]
    buffer_load_dwordx2 v[58:59], v105, s[20:23], s95 offen
    v_and_b32 v106, 0xffff, v180
    v_lshrrev_b32 v180, 16, v180
    v_subrev_u32 v180, s7, v180
    v_cmp_gt_i32_e64 s[48:49], v180, v222
    v_add_lshl_u32 v106, v106, v220, 3
    s_mov_b32 s95, 204800
    v_cndmask_b32_e64 v106, 2.0, v106, s[48:49]
    buffer_load_dwordx2 v[60:61], v106, s[20:23], s95 offen
    v_cmp_gt_i32_e64 s[50:51], v172, v221
    v_cmp_gt_i32_e64 s[68:69], v172, v223
    v_cmp_gt_i32_e64 s[52:53], v173, v221
    v_cmp_gt_i32_e64 s[70:71], v173, v223
    v_cmp_gt_i32_e64 s[54:55], v174, v221
    v_cmp_gt_i32_e64 s[72:73], v174, v223
    v_cmp_gt_i32_e64 s[56:57], v175, v221
    v_cmp_gt_i32_e64 s[74:75], v175, v223
    v_cmp_gt_i32_e64 s[58:59], v176, v221
    v_cmp_gt_i32_e64 s[76:77], v176, v223
    v_cmp_gt_i32_e64 s[60:61], v177, v221
    v_cmp_gt_i32_e64 s[78:79], v177, v223
    v_cmp_gt_i32_e64 s[62:63], v178, v221
    v_cmp_gt_i32_e64 s[80:81], v178, v223
    v_cmp_gt_i32_e64 s[64:65], v179, v221
    v_cmp_gt_i32_e64 s[82:83], v179, v223
    v_cmp_gt_i32_e64 s[66:67], v180, v221
    v_cmp_gt_i32_e64 s[84:85], v180, v223
    s_mov_b32 s95, 0
    s_mov_b64 exec, s[50:51]
    s_cbranch_execz K2_G1
    buffer_load_dwordx2 v[62:63], v98, s[20:23], s95 offen offset:128
K2_G1:
    s_mov_b32 s95, 25600
    s_mov_b64 exec, s[52:53]
    s_cbranch_execz K2_G2
    buffer_load_dwordx2 v[64:65], v99, s[20:23], s95 offen offset:128
K2_G2:
    s_mov_b32 s95, 51200
    s_mov_b64 exec, s[54:55]
    s_cbranch_execz K2_G3
    buffer_load_dwordx2 v[66:67], v100, s[20:23], s95 offen offset:128
K2_G3:
    s_mov_b32 s95, 76800
    s_mov_b64 exec, s[56:57]
    s_cbranch_execz K2_G4
    buffer_load_dwordx2 v[68:69], v101, s[20:23], s95 offen offset:128
K2_G4:
    s_mov_b32 s95, 102400
    s_mov_b64 exec, s[58:59]
    s_cbranch_execz K2_G5
    buffer_load_dwordx2 v[70:71], v102, s[20:23], s95 offen offset:128
K2_G5:
    s_mov_b32 s95, 128000
    s_mov_b64 exec, s[60:61]
    s_cbranch_execz K2_G6
    buffer_load_dwordx2 v[72:73], v103, s[20:23], s95 offen offset:128
K2_G6:
    s_mov_b32 s95, 153600
    s_mov_b64 exec, s[62:63]
    s_cbranch_execz K2_G7
    buffer_load_dwordx2 v[74:75], v104, s[20:23], s95 offen offset:128
K2_G7:
    s_mov_b32 s95, 179200
    s_mov_b64 exec, s[64:65]
    s_cbranch_execz K2_G8
    buffer_load_dwordx2 v[76:77], v105, s[20:23], s95 offen offset:128
K2_G8:
    s_mov_b32 s95, 204800
    s_mov_b64 exec, s[66:67]
    s_cbranch_execz K2_G9
    buffer_load_dwordx2 v[78:79], v106, s[20:23], s95 offen offset:128
K2_G9:
    s_or_b64 vcc, s[68:69], s[70:71]
    s_or_b64 vcc, vcc, s[72:73]
    s_or_b64 vcc, vcc, s[74:75]
    s_or_b64 vcc, vcc, s[76:77]
    s_or_b64 vcc, vcc, s[78:79]
    s_or_b64 vcc, vcc, s[80:81]
    s_or_b64 vcc, vcc, s[82:83]
    s_or_b64 vcc, vcc, s[84:85]
    s_cselect_b32 s97, 1, 0
    s_cbranch_scc0 K2_NP2A
    s_mov_b32 s95, 0
    s_mov_b64 exec, s[68:69]
    s_cbranch_execz K2_G10
    buffer_load_dwordx2 v[80:81], v98, s[20:23], s95 offen offset:256
K2_G10:
    s_mov_b32 s95, 25600
    s_mov_b64 exec, s[70:71]
    s_cbranch_execz K2_G11
    buffer_load_dwordx2 v[82:83], v99, s[20:23], s95 offen offset:256
K2_G11:
    s_mov_b32 s95, 51200
    s_mov_b64 exec, s[72:73]
    s_cbranch_execz K2_G12
    buffer_load_dwordx2 v[84:85], v100, s[20:23], s95 offen offset:256
K2_G12:
    s_mov_b32 s95, 76800
    s_mov_b64 exec, s[74:75]
    s_cbranch_execz K2_G13
    buffer_load_dwordx2 v[86:87], v101, s[20:23], s95 offen offset:256
K2_G13:
    s_mov_b32 s95, 102400
    s_mov_b64 exec, s[76:77]
    s_cbranch_execz K2_G14
    buffer_load_dwordx2 v[88:89], v102, s[20:23], s95 offen offset:256
K2_G14:
    s_mov_b32 s95, 128000
    s_mov_b64 exec, s[78:79]
    s_cbranch_execz K2_G15
    buffer_load_dwordx2 v[90:91], v103, s[20:23], s95 offen offset:256
K2_G15:
    s_mov_b32 s95, 153600
    s_mov_b64 exec, s[80:81]
    s_cbranch_execz K2_G16
    buffer_load_dwordx2 v[92:93], v104, s[20:23], s95 offen offset:256
K2_G16:
    s_mov_b32 s95, 179200
    s_mov_b64 exec, s[82:83]
    s_cbranch_execz K2_G17
    buffer_load_dwordx2 v[94:95], v105, s[20:23], s95 offen offset:256
K2_G17:
    s_mov_b32 s95, 204800
    s_mov_b64 exec, s[84:85]
    s_cbranch_execz K2_G18
    buffer_load_dwordx2 v[96:97], v106, s[20:23], s95 offen offset:256
K2_G18:
K2_NP2A:
    s_mov_b64 exec, -1
    v_max3_i32 v221, v172, v173, v174
    v_max3_i32 v221, v221, v175, v176
    v_max3_i32 v221, v221, v177, v178
    v_max3_i32 v221, v221, v179, v180
    v_mov_b32 v223, 1
    v_cmp_lt_i32_e64 s[86:87], s92, v221
K2_NOREC:
    s_waitcnt lgkmcnt(0)
    s_barrier
    s_add_u32 s95, s101, 0
    s_cmp_lt_u32 s95, 125952
    s_cselect_b32 m0, s95, 43008
    s_nop 0
    buffer_load_dwordx4 v[210:211], s[8:11], 0 idxen offen lds
    s_add_u32 s95, s101, 1024
    s_cmp_lt_u32 s95, 125952
    s_cselect_b32 m0, s95, 43008
    s_nop 0
    buffer_load_dwordx4 v[212:213], s[8:11], 0 idxen offen lds
    s_add_u32 s95, s101, 2048
    s_cmp_lt_u32 s95, 125952
    s_cselect_b32 m0, s95, 43008
    s_nop 0
    buffer_load_dwordx4 v[214:215], s[8:11], 0 idxen offen lds
    s_add_u32 s95, s101, 3072
    s_cmp_lt_u32 s95, 125952
    s_cselect_b32 m0, s95, 43008
    s_nop 0
    buffer_load_dwordx4 v[216:217], s[8:11], 0 idxen offen lds
    s_cmp_lg_u32 s5, 0
    s_cbranch_scc1 K2_NOPW
    s_lshr_b32 s95, s2, 3
    s_mul_i32 s99, s95, 0
    v_add_u32 v224, s99, v203
    s_mul_i32 s99, s95, 0
    v_add_u32 v225, s99, v250
    v_add_u32 v224, 0, v250
    v_cmp_gt_u32 vcc, s96, v224
    s_nop 1
    v_cndmask_b32_e64 v104, -0.5, 0.5, vcc
    v_add_u32 v224, 64, v250
    v_cmp_gt_u32 vcc, s96, v224
    s_nop 1
    v_cndmask_b32_e64 v105, -0.5, 0.5, vcc
    v_add_u32 v224, 128, v250
    v_cmp_gt_u32 vcc, s96, v224
    s_nop 1
    v_cndmask_b32_e64 v106, -0.5, 0.5, vcc
    v_add_u32 v224, 192, v250
    v_cmp_gt_u32 vcc, s96, v224
    s_nop 1
    v_cndmask_b32_e64 v107, -0.5, 0.5, vcc
    s_branch K2_B1
K2_NOPW:
    s_mov_b64 exec, s[86:87]
    ds_write_b32 v228, v223 offset:96
    s_mov_b64 exec, -1
    s_waitcnt vmcnt(4)
    s_mov_b64 exec, s[32:33]
    v_lshrrev_b32 v172, 16, v45
    ds_add_rtn_u32 v172, v172, v223 offset:34816
    s_mov_b64 exec, s[34:35]
    v_lshrrev_b32 v173, 16, v47
    ds_add_rtn_u32 v173, v173, v223 offset:34816
    s_mov_b64 exec, s[36:37]
    v_lshrrev_b32 v174, 16, v49
    ds_add_rtn_u32 v174, v174, v223 offset:34816
    s_mov_b64 exec, s[38:39]
    v_lshrrev_b32 v175, 16, v51
    ds_add_rtn_u32 v175, v175, v223 offset:34816
    s_mov_b64 exec, s[40:41]
    v_lshrrev_b32 v176, 16, v53
    ds_add_rtn_u32 v176, v176, v223 offset:34816
    s_mov_b64 exec, s[42:43]
    v_lshrrev_b32 v177, 16, v55
    ds_add_rtn_u32 v177, v177, v223 offset:34816
    s_mov_b64 exec, s[44:45]
    v_lshrrev_b32 v178, 16, v57
    ds_add_rtn_u32 v178, v178, v223 offset:34816
    s_mov_b64 exec, s[46:47]
    v_lshrrev_b32 v179, 16, v59
    ds_add_rtn_u32 v179, v179, v223 offset:34816
    s_mov_b64 exec, s[48:49]
    v_lshrrev_b32 v180, 16, v61
    ds_add_rtn_u32 v180, v180, v223 offset:34816
    s_mov_b64 exec, s[50:51]
    s_cbranch_execz K2_G19
    v_lshrrev_b32 v181, 16, v63
    ds_add_rtn_u32 v181, v181, v223 offset:34816
K2_G19:
    s_mov_b64 exec, s[52:53]
    s_cbranch_execz K2_G20
    v_lshrrev_b32 v182, 16, v65
    ds_add_rtn_u32 v182, v182, v223 offset:34816
K2_G20:
    s_mov_b64 exec, s[54:55]
    s_cbranch_execz K2_G21
    v_lshrrev_b32 v183, 16, v67
    ds_add_rtn_u32 v183, v183, v223 offset:34816
K2_G21:
    s_mov_b64 exec, s[56:57]
    s_cbranch_execz K2_G22
    v_lshrrev_b32 v184, 16, v69
    ds_add_rtn_u32 v184, v184, v223 offset:34816
K2_G22:
    s_mov_b64 exec, s[58:59]
    s_cbranch_execz K2_G23
    v_lshrrev_b32 v185, 16, v71
    ds_add_rtn_u32 v185, v185, v223 offset:34816
K2_G23:
    s_mov_b64 exec, s[60:61]
    s_cbranch_execz K2_G24
    v_lshrrev_b32 v186, 16, v73
    ds_add_rtn_u32 v186, v186, v223 offset:34816
K2_G24:
    s_mov_b64 exec, s[62:63]
    s_cbranch_execz K2_G25
    v_lshrrev_b32 v187, 16, v75
    ds_add_rtn_u32 v187, v187, v223 offset:34816
K2_G25:
    s_mov_b64 exec, s[64:65]
    s_cbranch_execz K2_G26
    v_lshrrev_b32 v188, 16, v77
    ds_add_rtn_u32 v188, v188, v223 offset:34816
K2_G26:
    s_mov_b64 exec, s[66:67]
    s_cbranch_execz K2_G27
    v_lshrrev_b32 v189, 16, v79
    ds_add_rtn_u32 v189, v189, v223 offset:34816
K2_G27:
    s_cmp_eq_u32 s97, 0
    s_cbranch_scc1 K2_NP2B
    s_mov_b64 exec, s[68:69]
    s_cbranch_execz K2_G28
    v_lshrrev_b32 v190, 16, v81
    ds_add_rtn_u32 v190, v190, v223 offset:34816
K2_G28:
    s_mov_b64 exec, s[70:71]
    s_cbranch_execz K2_G29
    v_lshrrev_b32 v191, 16, v83
    ds_add_rtn_u32 v191, v191, v223 offset:34816
K2_G29:
    s_mov_b64 exec, s[72:73]
    s_cbranch_execz K2_G30
    v_lshrrev_b32 v192, 16, v85
    ds_add_rtn_u32 v192, v192, v223 offset:34816
K2_G30:
    s_mov_b64 exec, s[74:75]
    s_cbranch_execz K2_G31
    v_lshrrev_b32 v193, 16, v87
    ds_add_rtn_u32 v193, v193, v223 offset:34816
K2_G31:
    s_mov_b64 exec, s[76:77]
    s_cbranch_execz K2_G32
    v_lshrrev_b32 v194, 16, v89
    ds_add_rtn_u32 v194, v194, v223 offset:34816
K2_G32:
    s_mov_b64 exec, s[78:79]
    s_cbranch_execz K2_G33
    v_lshrrev_b32 v195, 16, v91
    ds_add_rtn_u32 v195, v195, v223 offset:34816
K2_G33:
    s_mov_b64 exec, s[80:81]
    s_cbranch_execz K2_G34
    v_lshrrev_b32 v196, 16, v93
    ds_add_rtn_u32 v196, v196, v223 offset:34816
K2_G34:
    s_mov_b64 exec, s[82:83]
    s_cbranch_execz K2_G35
    v_lshrrev_b32 v197, 16, v95
    ds_add_rtn_u32 v197, v197, v223 offset:34816
K2_G35:
    s_mov_b64 exec, s[84:85]
    s_cbranch_execz K2_G36
    v_lshrrev_b32 v198, 16, v97
    ds_add_rtn_u32 v198, v198, v223 offset:34816
K2_G36:
K2_NP2B:
    s_mov_b64 exec, -1
K2_B1:
    s_cmp_lg_u32 s5, 0
    s_waitcnt lgkmcnt(0)
    s_barrier
    s_cbranch_scc1 K2_W2
    ds_read_b128 v[44:47], v203 offset:34816
    ds_read_b128 v[48:51], v203 offset:35840
    ds_read_b128 v[52:55], v203 offset:36864
    ds_read_b128 v[56:59], v203 offset:37888
    s_waitcnt lgkmcnt(3)
    v_add_u32 v76, v44, v45
    v_add3_u32 v76, v76, v46, v47
    s_waitcnt lgkmcnt(2)
    v_add_u32 v77, v48, v49
    v_add3_u32 v77, v77, v50, v51
    s_waitcnt lgkmcnt(1)
    v_add_u32 v78, v52, v53
    v_add3_u32 v78, v78, v54, v55
    s_waitcnt lgkmcnt(0)
    v_add_u32 v79, v56, v57
    v_add3_u32 v79, v79, v58, v59
    v_add_u32 v82, v76, v77
    v_add_u32 v83, v82, v78
    v_add_u32 v220, v83, v79
    v_mov_b32 v221, v220
    s_nop 1
    v_add_u32_dpp v221, v221, v221 row_shr:1 row_mask:0xf bank_mask:0xf
    s_nop 1
    v_add_u32_dpp v221, v221, v221 row_shr:2 row_mask:0xf bank_mask:0xf
    s_nop 1
    v_add_u32_dpp v221, v221, v221 row_shr:4 row_mask:0xf bank_mask:0xf
    s_nop 1
    v_add_u32_dpp v221, v221, v221 row_shr:8 row_mask:0xf bank_mask:0xf
    s_nop 1
    v_add_u32_dpp v221, v221, v221 row_bcast:15 row_mask:0xa bank_mask:0xf
    s_nop 1
    v_add_u32_dpp v221, v221, v221 row_bcast:31 row_mask:0xc bank_mask:0xf
    v_sub_u32 v80, v221, v220
    v_add_u32 v81, v80, v76
    v_add_u32 v82, v80, v82
    v_add_u32 v83, v80, v83
    s_movk_i32 s95, 2560
    v_lshl_add_u32 v60, v80, 3, s95
    v_lshl_add_u32 v61, v44, 3, v60
    v_lshl_add_u32 v62, v45, 3, v61
    v_lshl_add_u32 v63, v46, 3, v62
    ds_write_b128 v203, v[60:63] offset:34816
    v_lshl_add_u32 v64, v81, 3, s95
    v_lshl_add_u32 v65, v48, 3, v64
    v_lshl_add_u32 v66, v49, 3, v65
    v_lshl_add_u32 v67, v50, 3, v66
    ds_write_b128 v203, v[64:67] offset:35840
    v_lshl_add_u32 v68, v82, 3, s95
    v_lshl_add_u32 v69, v52, 3, v68
    v_lshl_add_u32 v70, v53, 3, v69
    v_lshl_add_u32 v71, v54, 3, v70
    ds_write_b128 v203, v[68:71] offset:36864
    v_lshl_add_u32 v72, v83, 3, s95
    v_lshl_add_u32 v73, v56, 3, v72
    v_lshl_add_u32 v74, v57, 3, v73
    v_lshl_add_u32 v75, v58, 3, v74
    ds_write_b128 v203, v[72:75] offset:37888
    s_mov_b32 exec_lo, 0
    s_brev_b32 exec_hi, 1
    ds_write_b32 v228, v221 offset:100
    s_mov_b64 exec, -1
K2_W2:
    s_cmp_ge_u32 s5, 6
    s_cbranch_scc1 K2_NWH
    s_mul_i32 s95, s5, 2048
    s_add_u32 m0, s95, 125952
    s_add_u32 s95, s95, 7561216
    buffer_load_dwordx4 v203, s[20:23], s95 offen offset:0 lds
    buffer_load_dwordx4 v203, s[20:23], s95 offen offset:1024 lds
K2_NWH:
    s_cmp_eq_u32 s5, 0
    s_cbranch_scc1 K2_NFT
    s_mov_b32 s95, 0xc0000
    s_mov_b64 exec, s[32:33]
    v_and_or_b32 v140, v45, s95, v172
    v_lshrrev_b32 v141, 17, v45
    v_cmpx_gt_u32 vcc, 1, v140
    ds_write_b64 v141, v[44:45] offset:38912
    s_mov_b64 exec, s[34:35]
    v_and_or_b32 v142, v47, s95, v173
    v_lshrrev_b32 v143, 17, v47
    v_cmpx_gt_u32 vcc, 1, v142
    ds_write_b64 v143, v[46:47] offset:38912
    s_mov_b64 exec, s[36:37]
    v_and_or_b32 v144, v49, s95, v174
    v_lshrrev_b32 v145, 17, v49
    v_cmpx_gt_u32 vcc, 1, v144
    ds_write_b64 v145, v[48:49] offset:38912
    s_mov_b64 exec, s[38:39]
    v_and_or_b32 v146, v51, s95, v175
    v_lshrrev_b32 v147, 17, v51
    v_cmpx_gt_u32 vcc, 1, v146
    ds_write_b64 v147, v[50:51] offset:38912
    s_mov_b64 exec, s[40:41]
    v_and_or_b32 v148, v53, s95, v176
    v_lshrrev_b32 v149, 17, v53
    v_cmpx_gt_u32 vcc, 1, v148
    ds_write_b64 v149, v[52:53] offset:38912
    s_mov_b64 exec, s[42:43]
    v_and_or_b32 v150, v55, s95, v177
    v_lshrrev_b32 v151, 17, v55
    v_cmpx_gt_u32 vcc, 1, v150
    ds_write_b64 v151, v[54:55] offset:38912
    s_mov_b64 exec, s[44:45]
    v_and_or_b32 v152, v57, s95, v178
    v_lshrrev_b32 v153, 17, v57
    v_cmpx_gt_u32 vcc, 1, v152
    ds_write_b64 v153, v[56:57] offset:38912
    s_mov_b64 exec, s[46:47]
    v_and_or_b32 v154, v59, s95, v179
    v_lshrrev_b32 v155, 17, v59
    v_cmpx_gt_u32 vcc, 1, v154
    ds_write_b64 v155, v[58:59] offset:38912
    s_mov_b64 exec, s[48:49]
    v_and_or_b32 v156, v61, s95, v180
    v_lshrrev_b32 v157, 17, v61
    v_cmpx_gt_u32 vcc, 1, v156
    ds_write_b64 v157, v[60:61] offset:38912
    s_mov_b64 exec, -1
    s_mul_i32 s95, s5, 224
    v_lshrrev_b32 v140, 1, v203
    v_add_u32 v140, s95, v140
K2_NFT:
    s_cmp_eq_u32 s5, 0
    s_waitcnt lgkmcnt(0)
    s_barrier
    ds_read_b64 v[232:233], v228 offset:96
    s_cbranch_scc1 K2_NOS1
    ds_read_b64 v[140:141], v140 offset:38688
    s_mov_b64 exec, s[32:33]
    v_lshrrev_b32 v98, 16, v45
    ds_read_b32 v98, v98 offset:34816
    s_mov_b64 exec, s[34:35]
    v_lshrrev_b32 v99, 16, v47
    ds_read_b32 v99, v99 offset:34816
    s_mov_b64 exec, s[36:37]
    v_lshrrev_b32 v100, 16, v49
    ds_read_b32 v100, v100 offset:34816
    s_mov_b64 exec, s[38:39]
    v_lshrrev_b32 v101, 16, v51
    ds_read_b32 v101, v101 offset:34816
    s_mov_b64 exec, s[40:41]
    v_lshrrev_b32 v102, 16, v53
    ds_read_b32 v102, v102 offset:34816
    s_mov_b64 exec, s[42:43]
    v_lshrrev_b32 v103, 16, v55
    ds_read_b32 v103, v103 offset:34816
    s_mov_b64 exec, s[44:45]
    v_lshrrev_b32 v104, 16, v57
    ds_read_b32 v104, v104 offset:34816
    s_mov_b64 exec, s[46:47]
    v_lshrrev_b32 v105, 16, v59
    ds_read_b32 v105, v105 offset:34816
    s_mov_b64 exec, s[48:49]
    v_lshrrev_b32 v106, 16, v61
    ds_read_b32 v106, v106 offset:34816
    s_mov_b64 exec, -1
    s_waitcnt lgkmcnt(9)
    v_and_b32 v141, 0xffff, v141
    s_mov_b64 exec, 0xfffffff
    buffer_load_dword v202, v140, s[12:15], 0 idxen
    buffer_load_dword v202, v141, s[8:11], 0 idxen
    buffer_load_dword v202, v141, s[16:19], 0 idxen
    s_mov_b64 exec, s[50:51]
    s_cbranch_execz K2_G37
    v_lshrrev_b32 v220, 16, v63
    ds_read_b32 v220, v220 offset:34816
K2_G37:
    s_mov_b64 exec, s[52:53]
    s_cbranch_execz K2_G38
    v_lshrrev_b32 v221, 16, v65
    ds_read_b32 v221, v221 offset:34816
K2_G38:
    s_mov_b64 exec, s[54:55]
    s_cbranch_execz K2_G39
    v_lshrrev_b32 v222, 16, v67
    ds_read_b32 v222, v222 offset:34816
K2_G39:
    s_mov_b64 exec, s[56:57]
    s_cbranch_execz K2_G40
    v_lshrrev_b32 v223, 16, v69
    ds_read_b32 v223, v223 offset:34816
K2_G40:
    s_mov_b64 exec, s[58:59]
    s_cbranch_execz K2_G41
    v_lshrrev_b32 v224, 16, v71
    ds_read_b32 v224, v224 offset:34816
K2_G41:
    s_mov_b64 exec, s[60:61]
    s_cbranch_execz K2_G42
    v_lshrrev_b32 v225, 16, v73
    ds_read_b32 v225, v225 offset:34816
K2_G42:
    s_mov_b64 exec, s[62:63]
    s_cbranch_execz K2_G43
    v_lshrrev_b32 v226, 16, v75
    ds_read_b32 v226, v226 offset:34816
K2_G43:
    s_mov_b64 exec, s[64:65]
    s_cbranch_execz K2_G44
    v_lshrrev_b32 v227, 16, v77
    ds_read_b32 v227, v227 offset:34816
K2_G44:
    s_mov_b64 exec, s[66:67]
    s_cbranch_execz K2_G45
    v_lshrrev_b32 v228, 16, v79
    ds_read_b32 v228, v228 offset:34816
K2_G45:
    s_mov_b64 exec, -1
K2_NOS1:
    s_waitcnt lgkmcnt(0)
    v_readfirstlane_b32 s98, v233
    v_readfirstlane_b32 s93, v232
    s_cmp_le_u32 s98, 3776
    s_cbranch_scc1 K2_FITS
    s_cmp_eq_u32 s92, 15
    s_cbranch_scc1 K2_END0
    s_mov_b32 s92, 15
    s_waitcnt vmcnt(0)
    s_barrier
    s_branch K2_TOP
K2_FITS:
    s_cmp_eq_u32 s5, 0
    s_cbranch_scc1 K2_PLAN
    s_mov_b64 exec, s[32:33]
    v_lshl_add_u32 v98, v172, 3, v98
    ds_write_b64 v98, v[44:45]
    s_mov_b64 exec, s[34:35]
    v_lshl_add_u32 v99, v173, 3, v99
    ds_write_b64 v99, v[46:47]
    s_mov_b64 exec, s[36:37]
    v_lshl_add_u32 v100, v174, 3, v100
    ds_write_b64 v100, v[48:49]
    s_mov_b64 exec, s[38:39]
    v_lshl_add_u32 v101, v175, 3, v101
    ds_write_b64 v101, v[50:51]
    s_mov_b64 exec, s[40:41]
    v_lshl_add_u32 v102, v176, 3, v102
    ds_write_b64 v102, v[52:53]
    s_mov_b64 exec, s[42:43]
    v_lshl_add_u32 v103, v177, 3, v103
    ds_write_b64 v103, v[54:55]
    s_mov_b64 exec, s[44:45]
    v_lshl_add_u32 v104, v178, 3, v104
    ds_write_b64 v104, v[56:57]
    s_mov_b64 exec, s[46:47]
    v_lshl_add_u32 v105, v179, 3, v105
    ds_write_b64 v105, v[58:59]
    s_mov_b64 exec, s[48:49]
    v_lshl_add_u32 v106, v180, 3, v106
    ds_write_b64 v106, v[60:61]
    s_mov_b64 exec, s[50:51]
    s_cbranch_execz K2_G46
    v_lshl_add_u32 v220, v181, 3, v220
    ds_write_b64 v220, v[62:63]
K2_G46:
    s_mov_b64 exec, s[52:53]
    s_cbranch_execz K2_G47
    v_lshl_add_u32 v221, v182, 3, v221
    ds_write_b64 v221, v[64:65]
K2_G47:
    s_mov_b64 exec, s[54:55]
    s_cbranch_execz K2_G48
    v_lshl_add_u32 v222, v183, 3, v222
    ds_write_b64 v222, v[66:67]
K2_G48:
    s_mov_b64 exec, s[56:57]
    s_cbranch_execz K2_G49
    v_lshl_add_u32 v223, v184, 3, v223
    ds_write_b64 v223, v[68:69]
K2_G49:
    s_mov_b64 exec, s[58:59]
    s_cbranch_execz K2_G50
    v_lshl_add_u32 v224, v185, 3, v224
    ds_write_b64 v224, v[70:71]
K2_G50:
    s_mov_b64 exec, s[60:61]
    s_cbranch_execz K2_G51
    v_lshl_add_u32 v225, v186, 3, v225
    ds_write_b64 v225, v[72:73]
K2_G51:
    s_mov_b64 exec, s[62:63]
    s_cbranch_execz K2_G52
    v_lshl_add_u32 v226, v187, 3, v226
    ds_write_b64 v226, v[74:75]
K2_G52:
    s_mov_b64 exec, s[64:65]
    s_cbranch_execz K2_G53
    v_lshl_add_u32 v227, v188, 3, v227
    ds_write_b64 v227, v[76:77]
K2_G53:
    s_mov_b64 exec, s[66:67]
    s_cbranch_execz K2_G54
    v_lshl_add_u32 v228, v189, 3, v228
    ds_write_b64 v228, v[78:79]
K2_G54:
    s_cmp_eq_u32 s97, 0
    s_cbranch_scc1 K2_B3
    s_mov_b64 exec, s[68:69]
    s_cbranch_execz K2_G55
    v_lshrrev_b32 v98, 16, v81
    ds_read_b32 v98, v98 offset:34816
K2_G55:
    s_mov_b64 exec, s[70:71]
    s_cbranch_execz K2_G56
    v_lshrrev_b32 v99, 16, v83
    ds_read_b32 v99, v99 offset:34816
K2_G56:
    s_mov_b64 exec, s[72:73]
    s_cbranch_execz K2_G57
    v_lshrrev_b32 v100, 16, v85
    ds_read_b32 v100, v100 offset:34816
K2_G57:
    s_mov_b64 exec, s[74:75]
    s_cbranch_execz K2_G58
    v_lshrrev_b32 v101, 16, v87
    ds_read_b32 v101, v101 offset:34816
K2_G58:
    s_mov_b64 exec, s[76:77]
    s_cbranch_execz K2_G59
    v_lshrrev_b32 v102, 16, v89
    ds_read_b32 v102, v102 offset:34816
K2_G59:
    s_mov_b64 exec, s[78:79]
    s_cbranch_execz K2_G60
    v_lshrrev_b32 v103, 16, v91
    ds_read_b32 v103, v103 offset:34816
K2_G60:
    s_mov_b64 exec, s[80:81]
    s_cbranch_execz K2_G61
    v_lshrrev_b32 v104, 16, v93
    ds_read_b32 v104, v104 offset:34816
K2_G61:
    s_mov_b64 exec, s[82:83]
    s_cbranch_execz K2_G62
    v_lshrrev_b32 v105, 16, v95
    ds_read_b32 v105, v105 offset:34816
K2_G62:
    s_mov_b64 exec, s[84:85]
    s_cbranch_execz K2_G63
    v_lshrrev_b32 v106, 16, v97
    ds_read_b32 v106, v106 offset:34816
K2_G63:
    s_waitcnt lgkmcnt(0)
    s_mov_b64 exec, s[68:69]
    s_cbranch_execz K2_G64
    v_lshl_add_u32 v98, v190, 3, v98
    ds_write_b64 v98, v[80:81]
K2_G64:
    s_mov_b64 exec, s[70:71]
    s_cbranch_execz K2_G65
    v_lshl_add_u32 v99, v191, 3, v99
    ds_write_b64 v99, v[82:83]
K2_G65:
    s_mov_b64 exec, s[72:73]
    s_cbranch_execz K2_G66
    v_lshl_add_u32 v100, v192, 3, v100
    ds_write_b64 v100, v[84:85]
K2_G66:
    s_mov_b64 exec, s[74:75]
    s_cbranch_execz K2_G67
    v_lshl_add_u32 v101, v193, 3, v101
    ds_write_b64 v101, v[86:87]
K2_G67:
    s_mov_b64 exec, s[76:77]
    s_cbranch_execz K2_G68
    v_lshl_add_u32 v102, v194, 3, v102
    ds_write_b64 v102, v[88:89]
K2_G68:
    s_mov_b64 exec, s[78:79]
    s_cbranch_execz K2_G69
    v_lshl_add_u32 v103, v195, 3, v103
    ds_write_b64 v103, v[90:91]
K2_G69:
    s_mov_b64 exec, s[80:81]
    s_cbranch_execz K2_G70
    v_lshl_add_u32 v104, v196, 3, v104
    ds_write_b64 v104, v[92:93]
K2_G70:
    s_mov_b64 exec, s[82:83]
    s_cbranch_execz K2_G71
    v_lshl_add_u32 v105, v197, 3, v105
    ds_write_b64 v105, v[94:95]
K2_G71:
    s_mov_b64 exec, s[84:85]
    s_cbranch_execz K2_G72
    v_lshl_add_u32 v106, v198, 3, v106
    ds_write_b64 v106, v[96:97]
K2_G72:
    s_branch K2_B3
K2_PLAN:
    s_mul_i32 s99, s98, 3
    s_lshr_b32 s99, s99, 9
    s_max_u32 s99, s99, 1
    v_cvt_f32_u32 v84, v76
    v_add_f32 v84, -0.5, v84
    v_max_f32 v104, v104, v84
    v_cvt_f32_u32 v85, v77
    v_add_f32 v85, -0.5, v85
    v_max_f32 v105, v105, v85
    v_cvt_f32_u32 v86, v78
    v_add_f32 v86, -0.5, v86
    v_max_f32 v106, v106, v86
    v_cvt_f32_u32 v87, v79
    v_add_f32 v87, -0.5, v87
    v_max_f32 v107, v107, v87
K2_DLOOP:
    v_cvt_f32_u32 v220, s99
    v_rcp_f32 v221, v220
    v_add_f32 v88, v104, v220
    v_add_f32 v89, v105, v220
    v_add_f32 v90, v106, v220
    v_add_f32 v91, v107, v220
    v_mul_f32 v88, v88, v221
    v_cvt_u32_f32 v88, v88
    v_mul_f32 v89, v89, v221
    v_cvt_u32_f32 v89, v89
    v_mul_f32 v90, v90, v221
    v_cvt_u32_f32 v90, v90
    v_mul_f32 v91, v91, v221
    v_cvt_u32_f32 v91, v91
    v_add_u32 v222, v88, v89
    v_add3_u32 v222, v222, v90, v91
    s_nop 1
    v_add_u32_dpp v222, v222, v222 row_shr:1 row_mask:0xf bank_mask:0xf
    s_nop 1
    v_add_u32_dpp v222, v222, v222 row_shr:2 row_mask:0xf bank_mask:0xf
    s_nop 1
    v_add_u32_dpp v222, v222, v222 row_shr:4 row_mask:0xf bank_mask:0xf
    s_nop 1
    v_add_u32_dpp v222, v222, v222 row_shr:8 row_mask:0xf bank_mask:0xf
    s_nop 1
    v_add_u32_dpp v222, v222, v222 row_bcast:15 row_mask:0xa bank_mask:0xf
    s_nop 1
    v_add_u32_dpp v222, v222, v222 row_bcast:31 row_mask:0xc bank_mask:0xf
    s_nop 0
    v_readlane_b32 s95, v222, 63
    s_add_u32 s99, s99, 1
    s_cmp_gt_u32 s95, 255
    s_cbranch_scc1 K2_DLOOP
    v_cvt_f32_u32 v92, v88
    v_rcp_f32 v96, v92
    v_add_f32 v92, v92, v84
    v_cmp_eq_u32_e64 s[48:49], 1, v88
    v_lshlrev_b32 v44, 16, v88
    v_cvt_f32_u32 v93, v89
    v_rcp_f32 v97, v93
    v_add_f32 v93, v93, v85
    v_cmp_eq_u32_e64 s[50:51], 1, v89
    v_lshlrev_b32 v45, 16, v89
    v_cvt_f32_u32 v94, v90
    v_rcp_f32 v98, v94
    v_add_f32 v94, v94, v86
    v_cmp_eq_u32_e64 s[52:53], 1, v90
    v_lshlrev_b32 v46, 16, v90
    v_cvt_f32_u32 v95, v91
    v_rcp_f32 v99, v95
    v_add_f32 v95, v95, v87
    v_cmp_eq_u32_e64 s[54:55], 1, v91
    v_lshlrev_b32 v47, 16, v91
    v_cndmask_b32_e64 v44, v44, 1, s[48:49]
    v_cndmask_b32_e64 v45, v45, 1, s[50:51]
    v_cndmask_b32_e64 v46, v46, 1, s[52:53]
    v_cndmask_b32_e64 v47, v47, 1, s[54:55]
    v_mul_f32 v92, v92, v96
    v_cvt_u32_f32 v92, v92
    v_sub_u32 v96, 63, v92
    v_lshlrev_b32 v96, 2, v96
    ds_add_rtn_u32 v100, v96, v44 offset:128
    v_mul_f32 v93, v93, v97
    v_cvt_u32_f32 v93, v93
    v_sub_u32 v97, 63, v93
    v_lshlrev_b32 v97, 2, v97
    ds_add_rtn_u32 v101, v97, v45 offset:128
    v_mul_f32 v94, v94, v98
    v_cvt_u32_f32 v94, v94
    v_sub_u32 v98, 63, v94
    v_lshlrev_b32 v98, 2, v98
    ds_add_rtn_u32 v102, v98, v46 offset:128
    v_mul_f32 v95, v95, v99
    v_cvt_u32_f32 v95, v95
    v_sub_u32 v99, 63, v95
    v_lshlrev_b32 v99, 2, v99
    ds_add_rtn_u32 v103, v99, v47 offset:128
    v_lshrrev_b32 v220, 2, v203
    ds_read_b32 v221, v220 offset:128
    v_add_u32 v222, 0, v250
    v_lshl_or_b32 v172, v222, 24, v60
    v_lshl_or_b32 v172, v92, 18, v172
    v_lshlrev_b32 v173, 3, v88
    v_sub_u32 v222, 1, v92
    v_mad_i32_i24 v76, v222, v88, v76
    v_add_u32 v222, 64, v250
    v_lshl_or_b32 v174, v222, 24, v64
    v_lshl_or_b32 v174, v93, 18, v174
    v_lshlrev_b32 v175, 3, v89
    v_sub_u32 v222, 1, v93
    v_mad_i32_i24 v77, v222, v89, v77
    v_add_u32 v222, 128, v250
    v_lshl_or_b32 v176, v222, 24, v68
    v_lshl_or_b32 v176, v94, 18, v176
    v_lshlrev_b32 v177, 3, v90
    v_sub_u32 v222, 1, v94
    v_mad_i32_i24 v78, v222, v90, v78
    v_add_u32 v222, 192, v250
    v_lshl_or_b32 v178, v222, 24, v72
    v_lshl_or_b32 v178, v95, 18, v178
    v_lshlrev_b32 v179, 3, v91
    v_sub_u32 v222, 1, v95
    v_mad_i32_i24 v79, v222, v91, v79
    v_max3_u32 v224, v88, v89, v90
    v_max_u32 v224, v224, v91
    v_mov_b32 v225, -262136
    s_mov_b32 s99, 0
    s_waitcnt lgkmcnt(0)
    v_mov_b32 v222, v221
    v_and_b32 v57, 0xffff, v221
    v_cmp_ne_u32 vcc, 0, v57
    v_and_b32 v52, 0xffff, v100
    v_lshrrev_b32 v100, 16, v100
    v_add_u32_dpp v222, v222, v222 row_shr:1 row_mask:0xf bank_mask:0xf
    v_min_u32 v48, 1, v52
    v_cndmask_b32_e64 v100, v100, v52, s[48:49]
    v_add_u32_dpp v222, v222, v222 row_shr:2 row_mask:0xf bank_mask:0xf
    v_mad_i32_i24 v48, v48, -10, 20
    v_cndmask_b32_e64 v48, 0, v48, s[48:49]
    v_add_u32_dpp v222, v222, v222 row_shr:4 row_mask:0xf bank_mask:0xf
    v_and_b32 v53, 0xffff, v101
    v_lshrrev_b32 v101, 16, v101
    v_add_u32_dpp v222, v222, v222 row_shr:8 row_mask:0xf bank_mask:0xf
    v_min_u32 v49, 1, v53
    v_cndmask_b32_e64 v101, v101, v53, s[50:51]
    v_add_u32_dpp v222, v222, v222 row_bcast:15 row_mask:0xa bank_mask:0xf
    v_mad_i32_i24 v49, v49, -10, 20
    v_cndmask_b32_e64 v49, 0, v49, s[50:51]
    v_add_u32_dpp v222, v222, v222 row_bcast:31 row_mask:0xc bank_mask:0xf
    v_lshrrev_b32 v58, 16, v222
    v_cndmask_b32 v56, 0, v58, vcc
    v_sub_u32 v222, v222, v221
    v_and_b32 v54, 0xffff, v102
    v_lshrrev_b32 v102, 16, v102
    v_max_u32_dpp v56, v56, v56 row_shr:1 row_mask:0xf bank_mask:0xf
    v_min_u32 v50, 1, v54
    v_cndmask_b32_e64 v102, v102, v54, s[52:53]
    v_max_u32_dpp v56, v56, v56 row_shr:2 row_mask:0xf bank_mask:0xf
    v_mad_i32_i24 v50, v50, -10, 20
    v_cndmask_b32_e64 v50, 0, v50, s[52:53]
    v_max_u32_dpp v56, v56, v56 row_shr:4 row_mask:0xf bank_mask:0xf
    v_and_b32 v55, 0xffff, v103
    v_lshrrev_b32 v103, 16, v103
    v_max_u32_dpp v56, v56, v56 row_shr:8 row_mask:0xf bank_mask:0xf
    v_min_u32 v51, 1, v55
    v_cndmask_b32_e64 v103, v103, v55, s[54:55]
    v_max_u32_dpp v56, v56, v56 row_bcast:15 row_mask:0xa bank_mask:0xf
    v_mad_i32_i24 v51, v51, -10, 20
    v_cndmask_b32_e64 v51, 0, v51, s[54:55]
    v_max_u32_dpp v56, v56, v56 row_bcast:31 row_mask:0xc bank_mask:0xf
    v_and_b32 v57, 0xffff, v222
    v_and_b32 v221, 1, v222
    v_mov_b32_dpp v56, v56 wave_shr:1 row_mask:0xf bank_mask:0xf
    v_cmp_eq_u32 vcc, 1, v221
    v_lshrrev_b32 v222, 16, v222
    v_add3_u32 v222, v222, v57, v221
    v_cndmask_b32 v56, v58, v56, vcc
    v_add_u32 v58, v58, v57
    v_add_u32 v56, v56, v57
    v_lshl_or_b32 v222, v58, 10, v222
    v_lshl_or_b32 v222, v56, 20, v222
    ds_bpermute_b32 v96, v96, v222
    ds_bpermute_b32 v97, v97, v222
    ds_bpermute_b32 v98, v98, v222
    ds_bpermute_b32 v99, v99, v222
    s_waitcnt lgkmcnt(3)
    v_bfe_u32 v96, v96, v48, 10
    v_add_lshl_u32 v96, v96, v100, 2
    v_lshl_or_b32 v222, v88, 16, v96
    v_lshlrev_b32 v96, 1, v96
    ds_write_b32 v220, v222 offset:32768
    s_waitcnt lgkmcnt(3)
    v_bfe_u32 v97, v97, v49, 10
    v_add_lshl_u32 v97, v97, v101, 2
    v_lshl_or_b32 v222, v89, 16, v97
    v_lshlrev_b32 v97, 1, v97
    ds_write_b32 v220, v222 offset:33024
    s_waitcnt lgkmcnt(3)
    v_bfe_u32 v98, v98, v50, 10
    v_add_lshl_u32 v98, v98, v102, 2
    v_lshl_or_b32 v222, v90, 16, v98
    v_lshlrev_b32 v98, 1, v98
    ds_write_b32 v220, v222 offset:33280
    s_waitcnt lgkmcnt(3)
    v_bfe_u32 v99, v99, v51, 10
    v_add_lshl_u32 v99, v99, v103, 2
    v_lshl_or_b32 v222, v91, 16, v99
    v_lshlrev_b32 v99, 1, v99
    ds_write_b32 v220, v222 offset:33536
K2_PLOOP:
    v_cmp_lt_u32_e64 s[32:33], s99, v88
    v_cmp_lt_u32_e64 s[34:35], s99, v89
    v_cmp_lt_u32_e64 s[36:37], s99, v90
    v_cmp_lt_u32_e64 s[38:39], s99, v91
    s_add_u32 s99, s99, 1
    v_cmp_eq_u32_e64 s[40:41], s99, v76
    v_cmp_eq_u32_e64 s[42:43], s99, v77
    v_cmp_eq_u32_e64 s[44:45], s99, v78
    v_cmp_eq_u32_e64 s[46:47], s99, v79
    s_mov_b64 exec, s[32:33]
    ds_write_b64 v96, v[172:173] offset:512
    s_mov_b64 exec, s[34:35]
    ds_write_b64 v97, v[174:175] offset:512
    s_mov_b64 exec, s[36:37]
    ds_write_b64 v98, v[176:177] offset:512
    s_mov_b64 exec, s[38:39]
    ds_write_b64 v99, v[178:179] offset:512
    s_mov_b64 exec, -1
    v_cmp_lt_u32 vcc, s99, v224
    v_cndmask_b32_e64 v222, 8, v225, s[40:41]
    v_add_u32 v172, v172, v222
    v_add_u32 v96, 8, v96
    v_cndmask_b32_e64 v222, 8, v225, s[42:43]
    v_add_u32 v174, v174, v222
    v_add_u32 v97, 8, v97
    v_cndmask_b32_e64 v222, 8, v225, s[44:45]
    v_add_u32 v176, v176, v222
    v_add_u32 v98, 8, v98
    v_cndmask_b32_e64 v222, 8, v225, s[46:47]
    v_add_u32 v178, v178, v222
    v_add_u32 v99, 8, v99
    s_cbranch_vccnz K2_PLOOP
    v_mov_b32 v222, s99
    ds_write_b32 v228, v222 offset:104
    s_waitcnt vmcnt(0)
K2_B3:
    s_mov_b64 exec, -1
    s_lshl_b32 s95, s100, 8
    v_and_b32 v220, 31, v250
    v_lshl_add_u32 v220, v220, 3, s95
    s_mov_b32 s6, 0
    s_waitcnt vmcnt(3) lgkmcnt(0)
    s_barrier
    ds_read_b64 v[220:221], v220 offset:512
    ds_read_b32 v222, v229 offset:104
    s_waitcnt lgkmcnt(0)
    v_bfe_u32 v235, v220, 18, 6
    v_and_b32 v207, 0x3ffff, v220
    v_lshrrev_b32 v249, 24, v220
    v_mov_b32 v206, v221
    v_readfirstlane_b32 s97, v222
    v_cmp_lt_u32_e64 s[28:29], s6, v235
    s_add_u32 s6, s6, 1
    v_add_u32 v221, s4, v249
    buffer_load_dwordx2 v[240:241], v221, s[16:19], 0 idxen
    v_cndmask_b32_e64 v203, 0, v207, s[28:29]
    v_add_u32 v207, v207, v206
    ds_read_b32 v218, v203
    ds_read_u16 v203, v203 offset:4
    v_bfe_u32 v220, v249, 1, 3
    v_lshlrev_b32 v220, 4, v220
    v_lshlrev_b32 v221, 2, v219
    v_xor_b32 v220, v220, v221
    v_lshl_add_u32 v220, v249, 7, v220
    v_add_u32 v220, 100352, v220
    v_xor_b32 v221, 16, v220
    v_xor_b32 v222, 32, v220
    v_xor_b32 v223, 48, v220
    s_waitcnt lgkmcnt(0)
    ds_bpermute_b32 v210, v239, v203 offset:0
    ds_bpermute_b32 v212, v239, v203 offset:32
    ds_bpermute_b32 v214, v239, v203 offset:64
    ds_bpermute_b32 v216, v239, v203 offset:96
    ds_read_b128 v[172:175], v220
    ds_read_b128 v[176:179], v221
    ds_read_b128 v[180:183], v222
    ds_read_b128 v[184:187], v223
    buffer_load_dwordx4 v[188:191], v[218:219], s[12:15], 0 idxen offen
    buffer_load_dwordx2 v[200:201], v203, s[16:19], 0 idxen
    v_cmp_lt_u32_e64 s[30:31], s6, v235
    s_add_u32 s6, s6, 1
    s_cmp_eq_u64 s[28:29], 0
    s_cbranch_scc1 K2_EMPTY
    s_waitcnt lgkmcnt(4)
    s_add_u32 m0, s94, 0
    s_nop 0
    buffer_load_dwordx4 v[210:211], s[8:11], 0 idxen offen lds
    s_add_u32 m0, s94, 1024
    s_nop 0
    buffer_load_dwordx4 v[212:213], s[8:11], 0 idxen offen lds
    s_add_u32 m0, s94, 2048
    s_nop 0
    buffer_load_dwordx4 v[214:215], s[8:11], 0 idxen offen lds
    s_add_u32 m0, s94, 3072
    s_nop 0
    buffer_load_dwordx4 v[216:217], s[8:11], 0 idxen offen lds
    v_cndmask_b32_e64 v203, 0, v207, s[30:31]
    v_add_u32 v207, v207, v206
    ds_read_b32 v218, v203
    ds_read_u16 v203, v203 offset:4
    s_waitcnt lgkmcnt(0)
    ds_bpermute_b32 v210, v239, v203 offset:0
    ds_bpermute_b32 v212, v239, v203 offset:32
    ds_bpermute_b32 v214, v239, v203 offset:64
    ds_bpermute_b32 v216, v239, v203 offset:96
    buffer_load_dwordx4 v[192:195], v[218:219], s[12:15], 0 idxen offen
    buffer_load_dwordx2 v[204:205], v203, s[16:19], 0 idxen
    v_cmp_lt_u32_e64 s[32:33], s6, v235
    s_add_u32 s6, s6, 1
    s_waitcnt lgkmcnt(0)
    s_add_u32 m0, s94, 32768
    s_nop 0
    buffer_load_dwordx4 v[210:211], s[8:11], 0 idxen offen lds
    s_add_u32 m0, s94, 33792
    s_nop 0
    buffer_load_dwordx4 v[212:213], s[8:11], 0 idxen offen lds
    s_add_u32 m0, s94, 34816
    s_nop 0
    buffer_load_dwordx4 v[214:215], s[8:11], 0 idxen offen lds
    s_add_u32 m0, s94, 35840
    s_nop 0
    buffer_load_dwordx4 v[216:217], s[8:11], 0 idxen offen lds
    v_cndmask_b32_e64 v203, 0, v207, s[32:33]
    v_add_u32 v207, v207, v206
    ds_read_b32 v218, v203
    ds_read_u16 v203, v203 offset:4
    s_waitcnt lgkmcnt(0)
    ds_bpermute_b32 v210, v239, v203 offset:0
    ds_bpermute_b32 v212, v239, v203 offset:32
    ds_bpermute_b32 v214, v239, v203 offset:64
    ds_bpermute_b32 v216, v239, v203 offset:96
    v_and_b32 v221, 63, v250
    v_lshlrev_b32 v220, 4, v221
    v_lshlrev_b32 v221, 2, v221
    v_add_u32 v220, 138240, v220
    v_lshlrev_b32 v222, 3, v219
    v_add_u32 v221, 156672, v221
    v_add_u32 v222, 157696, v222
    ds_read_b128 v[140:143], v220 offset:0
    ds_read_b128 v[144:147], v220 offset:1024
    ds_read_b128 v[148:151], v220 offset:2048
    ds_read_b128 v[152:155], v220 offset:3072
    ds_read_b128 v[156:159], v220 offset:4096
    ds_read_b128 v[160:163], v220 offset:5120
    ds_read_b128 v[164:167], v220 offset:6144
    ds_read_b128 v[168:171], v220 offset:7168
    ds_read_b128 v[0:3], v220 offset:8192
    ds_read_b128 v[4:7], v220 offset:9216
    ds_read_b128 v[8:11], v220 offset:10240
    ds_read_b128 v[12:15], v220 offset:11264
    ds_read_b128 v[16:19], v220 offset:12288
    ds_read_b128 v[20:23], v220 offset:13312
    ds_read_b128 v[24:27], v220 offset:14336
    ds_read_b128 v[28:31], v220 offset:15360
    ds_read_b128 v[32:35], v220 offset:16384
    ds_read_b128 v[36:39], v220 offset:17408
    ds_read_b32 v40, v221
    ds_read_b32 v42, v221 offset:256
    ds_read_b128 v[108:111], v222 offset:0
    ds_read_b128 v[112:115], v222 offset:16
    ds_read_b128 v[116:119], v222 offset:32
    ds_read_b128 v[120:123], v222 offset:48
    ds_read_b128 v[124:127], v222 offset:64
    ds_read_b128 v[128:131], v222 offset:80
    ds_read_b128 v[132:135], v222 offset:96
    ds_read_b128 v[136:139], v222 offset:112
    v_mov_b32 v76, 0
    v_mov_b32 v77, 0
    v_mov_b32 v78, 0
    v_mov_b32 v79, 0
    v_mov_b32 v80, 0
    v_mov_b32 v81, 0
    v_mov_b32 v82, 0
    v_mov_b32 v83, 0
    v_mov_b32 v84, 0
    v_mov_b32 v85, 0
    v_mov_b32 v86, 0
    v_mov_b32 v87, 0
    v_mov_b32 v88, 0
    v_mov_b32 v89, 0
    v_mov_b32 v90, 0
    v_mov_b32 v91, 0
    v_mov_b32 v92, 0
    v_mov_b32 v93, 0
    v_mov_b32 v94, 0
    v_mov_b32 v95, 0
    v_mov_b32 v96, 0
    v_mov_b32 v97, 0
    v_mov_b32 v98, 0
    v_mov_b32 v99, 0
    v_mov_b32 v100, 0
    v_mov_b32 v101, 0
    v_mov_b32 v102, 0
    v_mov_b32 v103, 0
    v_mov_b32 v104, 0
    v_mov_b32 v105, 0
    v_mov_b32 v106, 0
    v_mov_b32 v107, 0
    v_mov_b32 v244, 0
    v_mov_b32 v245, 0
    v_mov_b32 v246, 0
    v_mov_b32 v247, 0
    s_waitcnt lgkmcnt(0)
    v_mfma_f32_32x32x16_bf16 v[44:59], v[140:143], v[172:175], 0
    v_mfma_f32_32x32x16_bf16 v[60:75], v[156:159], v[172:175], 0
    v_mfma_f32_32x32x16_bf16 v[44:59], v[144:147], v[176:179], v[44:59]
    v_mfma_f32_32x32x16_bf16 v[60:75], v[160:163], v[176:179], v[60:75]
    v_mfma_f32_32x32x16_bf16 v[44:59], v[148:151], v[180:183], v[44:59]
    v_mfma_f32_32x32x16_bf16 v[60:75], v[164:167], v[180:183], v[60:75]
    v_mfma_f32_32x32x16_bf16 v[44:59], v[152:155], v[184:187], v[44:59]
    v_mfma_f32_32x32x16_bf16 v[60:75], v[168:171], v[184:187], v[60:75]
    s_waitcnt vmcnt(6)
    ds_read_b128 v[172:175], v251 offset:0
    ds_read_b128 v[176:179], v252 offset:0
    ds_read_b128 v[180:183], v253 offset:0
    ds_read_b128 v[184:187], v254 offset:0
    v_mov_b32 v242, v241
    v_and_b32 v241, 0xffff0000, v240
    v_lshlrev_b32 v240, 16, v240
    v_lshlrev_b32 v232, 16, v200
    v_and_b32 v233, 0xffff0000, v200
    v_sub_f32 v234, v242, v201
    v_pk_add_f32 v[232:233], v[240:241], v[232:233] neg_lo:[0,1] neg_hi:[0,1]
    v_mul_f32 v208, v232, v232
    v_fmac_f32 v208, v233, v233
    v_fmac_f32 v208, v234, v234
    v_cvt_pk_bf16_f32 v208, v208, v208
    s_waitcnt lgkmcnt(0)
    s_nop 0
    v_mfma_f32_32x32x8_bf16 v[140:155], v[40:41], v[208:209], v[44:59]
    v_mfma_f32_32x32x16_bf16 v[140:155], v[32:35], v[188:191], v[140:155]
    v_mfma_f32_32x32x16_bf16 v[140:155], v[0:3], v[172:175], v[140:155]
    v_mfma_f32_32x32x16_bf16 v[140:155], v[4:7], v[176:179], v[140:155]
    v_mfma_f32_32x32x16_bf16 v[140:155], v[8:11], v[180:183], v[140:155]
    v_mfma_f32_32x32x16_bf16 v[140:155], v[12:15], v[184:187], v[140:155]
    s_nop 7
K2_LOOP:
    v_mfma_f32_32x32x8_bf16 v[156:171], v[42:43], v[208:209], v[60:75]
    s_mov_b64 exec, s[28:29]
    s_nop 1
    v_exp_f32 v220, v140
    v_exp_f32 v221, v141
    v_exp_f32 v222, v142
    v_exp_f32 v223, v143
    v_mfma_f32_32x32x16_bf16 v[156:171], v[36:39], v[188:191], v[156:171]
    v_exp_f32 v224, v144
    v_exp_f32 v225, v145
    s_waitcnt lgkmcnt(0)
    s_mov_b64 exec, -1
    s_add_u32 m0, s94, 0
    s_nop 0
    buffer_load_dwordx4 v[210:211], s[8:11], 0 idxen offen lds
    s_add_u32 m0, s94, 1024
    s_nop 0
    buffer_load_dwordx4 v[212:213], s[8:11], 0 idxen offen lds
    s_add_u32 m0, s94, 2048
    s_nop 0
    buffer_load_dwordx4 v[214:215], s[8:11], 0 idxen offen lds
    s_add_u32 m0, s94, 3072
    s_nop 0
    buffer_load_dwordx4 v[216:217], s[8:11], 0 idxen offen lds
    s_mov_b64 exec, s[28:29]
    v_exp_f32 v226, v146
    v_exp_f32 v227, v147
    v_pk_add_f32 v[220:221], v[220:221], 1.0 op_sel_hi:[1,0]
    v_pk_add_f32 v[222:223], v[222:223], 1.0 op_sel_hi:[1,0]
    v_mfma_f32_32x32x16_bf16 v[156:171], v[16:19], v[172:175], v[156:171]
    v_pk_add_f32 v[224:225], v[224:225], 1.0 op_sel_hi:[1,0]
    v_pk_add_f32 v[226:227], v[226:227], 1.0 op_sel_hi:[1,0]
    v_rcp_f32 v220, v220
    v_rcp_f32 v221, v221
    v_rcp_f32 v222, v222
    v_rcp_f32 v223, v223
    v_mfma_f32_32x32x16_bf16 v[156:171], v[20:23], v[176:179], v[156:171]
    v_rcp_f32 v224, v224
    v_rcp_f32 v225, v225
    v_rcp_f32 v226, v226
    v_rcp_f32 v227, v227
    v_pk_fma_f32 v[76:77], v[140:141], v[220:221], v[76:77]
    v_pk_fma_f32 v[78:79], v[142:143], v[222:223], v[78:79]
    v_mfma_f32_32x32x16_bf16 v[156:171], v[24:27], v[180:183], v[156:171]
    v_pk_fma_f32 v[80:81], v[144:145], v[224:225], v[80:81]
    v_pk_fma_f32 v[82:83], v[146:147], v[226:227], v[82:83]
    v_pk_mul_f32 v[228:229], v[76:77], v[108:109]
    v_pk_mul_f32 v[230:231], v[78:79], v[110:111]
    v_pk_fma_f32 v[228:229], v[80:81], v[112:113], v[228:229]
    v_pk_fma_f32 v[230:231], v[82:83], v[114:115], v[230:231]
    v_exp_f32 v220, v148
    v_exp_f32 v221, v149
    v_mfma_f32_32x32x16_bf16 v[156:171], v[28:31], v[184:187], v[156:171]
    v_exp_f32 v222, v150
    v_exp_f32 v223, v151
    s_mov_b64 exec, -1
    buffer_load_dwordx4 v[196:199], v[218:219], s[12:15], 0 idxen offen
    buffer_load_dwordx2 v[200:201], v203, s[16:19], 0 idxen
    s_mov_b64 exec, s[28:29]
    v_exp_f32 v224, v152
    v_exp_f32 v225, v153
    v_exp_f32 v226, v154
    v_exp_f32 v227, v155
    s_waitcnt vmcnt(6)
    ds_read_b128 v[172:175], v251 offset:32768
    ds_read_b128 v[176:179], v252 offset:32768
    ds_read_b128 v[180:183], v253 offset:32768
    ds_read_b128 v[184:187], v254 offset:32768
    v_cmp_lt_u32_e64 s[34:35], s6, v235
    s_add_u32 s6, s6, 1
    v_lshlrev_b32 v236, 16, v204
    v_and_b32 v237, 0xffff0000, v204
    v_sub_f32 v238, v242, v205
    v_pk_add_f32 v[236:237], v[240:241], v[236:237] neg_lo:[0,1] neg_hi:[0,1]
    v_mul_f32 v208, v236, v236
    v_fmac_f32 v208, v237, v237
    v_fmac_f32 v208, v238, v238
    v_cvt_pk_bf16_f32 v208, v208, v208
    v_cndmask_b32_e64 v203, 0, v207, s[34:35]
    v_add_u32 v207, v207, v206
    ds_read_b32 v218, v203
    ds_read_u16 v203, v203 offset:4
    v_pk_add_f32 v[220:221], v[220:221], 1.0 op_sel_hi:[1,0]
    v_pk_add_f32 v[222:223], v[222:223], 1.0 op_sel_hi:[1,0]
    v_pk_add_f32 v[224:225], v[224:225], 1.0 op_sel_hi:[1,0]
    v_pk_add_f32 v[226:227], v[226:227], 1.0 op_sel_hi:[1,0]
    v_rcp_f32 v220, v220
    v_rcp_f32 v221, v221
    v_rcp_f32 v222, v222
    v_rcp_f32 v223, v223
    v_rcp_f32 v224, v224
    v_rcp_f32 v225, v225
    v_rcp_f32 v226, v226
    v_rcp_f32 v227, v227
    s_waitcnt lgkmcnt(0)
    s_mov_b64 exec, -1
    ds_bpermute_b32 v210, v239, v203 offset:0
    ds_bpermute_b32 v212, v239, v203 offset:32
    ds_bpermute_b32 v214, v239, v203 offset:64
    ds_bpermute_b32 v216, v239, v203 offset:96
    s_mov_b64 exec, s[28:29]
    v_pk_fma_f32 v[84:85], v[148:149], v[220:221], v[84:85]
    v_pk_fma_f32 v[86:87], v[150:151], v[222:223], v[86:87]
    v_pk_fma_f32 v[88:89], v[152:153], v[224:225], v[88:89]
    v_pk_fma_f32 v[90:91], v[154:155], v[226:227], v[90:91]
    v_pk_fma_f32 v[228:229], v[84:85], v[116:117], v[228:229]
    v_pk_fma_f32 v[230:231], v[86:87], v[118:119], v[230:231]
    v_pk_fma_f32 v[228:229], v[88:89], v[120:121], v[228:229]
    v_pk_fma_f32 v[230:231], v[90:91], v[122:123], v[230:231]
    v_mfma_f32_32x32x8_bf16 v[140:155], v[40:41], v[208:209], v[44:59]
    v_exp_f32 v220, v156
    v_exp_f32 v221, v157
    v_exp_f32 v222, v158
    v_exp_f32 v223, v159
    v_mfma_f32_32x32x16_bf16 v[140:155], v[32:35], v[192:195], v[140:155]
    v_exp_f32 v224, v160
    v_exp_f32 v225, v161
    v_exp_f32 v226, v162
    v_exp_f32 v227, v163
    v_pk_add_f32 v[220:221], v[220:221], 1.0 op_sel_hi:[1,0]
    v_pk_add_f32 v[222:223], v[222:223], 1.0 op_sel_hi:[1,0]
    v_mfma_f32_32x32x16_bf16 v[140:155], v[0:3], v[172:175], v[140:155]
    v_pk_add_f32 v[224:225], v[224:225], 1.0 op_sel_hi:[1,0]
    v_pk_add_f32 v[226:227], v[226:227], 1.0 op_sel_hi:[1,0]
    v_rcp_f32 v220, v220
    v_rcp_f32 v221, v221
    v_rcp_f32 v222, v222
    v_rcp_f32 v223, v223
    v_mfma_f32_32x32x16_bf16 v[140:155], v[4:7], v[176:179], v[140:155]
    v_rcp_f32 v224, v224
    v_rcp_f32 v225, v225
    v_rcp_f32 v226, v226
    v_rcp_f32 v227, v227
    v_pk_fma_f32 v[92:93], v[156:157], v[220:221], v[92:93]
    v_pk_fma_f32 v[94:95], v[158:159], v[222:223], v[94:95]
    v_mfma_f32_32x32x16_bf16 v[140:155], v[8:11], v[180:183], v[140:155]
    v_pk_fma_f32 v[96:97], v[160:161], v[224:225], v[96:97]
    v_pk_fma_f32 v[98:99], v[162:163], v[226:227], v[98:99]
    v_pk_fma_f32 v[228:229], v[92:93], v[124:125], v[228:229]
    v_pk_fma_f32 v[230:231], v[94:95], v[126:127], v[230:231]
    v_pk_fma_f32 v[228:229], v[96:97], v[128:129], v[228:229]
    v_pk_fma_f32 v[230:231], v[98:99], v[130:131], v[230:231]
    v_exp_f32 v220, v164
    v_exp_f32 v221, v165
    v_mfma_f32_32x32x16_bf16 v[140:155], v[12:15], v[184:187], v[140:155]
    v_exp_f32 v222, v166
    v_exp_f32 v223, v167
    v_exp_f32 v224, v168
    v_exp_f32 v225, v169
    v_exp_f32 v226, v170
    v_exp_f32 v227, v171
    v_pk_add_f32 v[220:221], v[220:221], 1.0 op_sel_hi:[1,0]
    v_pk_add_f32 v[222:223], v[222:223], 1.0 op_sel_hi:[1,0]
    v_pk_add_f32 v[224:225], v[224:225], 1.0 op_sel_hi:[1,0]
    v_pk_add_f32 v[226:227], v[226:227], 1.0 op_sel_hi:[1,0]
    v_rcp_f32 v220, v220
    v_rcp_f32 v221, v221
    v_rcp_f32 v222, v222
    v_rcp_f32 v223, v223
    v_rcp_f32 v224, v224
    v_rcp_f32 v225, v225
    v_rcp_f32 v226, v226
    v_rcp_f32 v227, v227
    v_pk_fma_f32 v[100:101], v[164:165], v[220:221], v[100:101]
    v_pk_fma_f32 v[102:103], v[166:167], v[222:223], v[102:103]
    v_pk_fma_f32 v[104:105], v[168:169], v[224:225], v[104:105]
    v_pk_fma_f32 v[106:107], v[170:171], v[226:227], v[106:107]
    v_pk_fma_f32 v[228:229], v[100:101], v[132:133], v[228:229]
    v_pk_fma_f32 v[230:231], v[102:103], v[134:135], v[230:231]
    v_pk_fma_f32 v[228:229], v[104:105], v[136:137], v[228:229]
    v_pk_fma_f32 v[230:231], v[106:107], v[138:139], v[230:231]
    v_pk_add_f32 v[228:229], v[228:229], v[230:231]
    s_cmp_eq_u64 s[30:31], 0
    v_add_f32 v243, v228, v229
    v_sub_f32 v248, v243, v247
    v_pk_fma_f32 v[244:245], v[232:233], v[248:249], v[244:245] op_sel_hi:[1,0,1]
    v_fmac_f32 v246, v234, v248
    s_mov_b64 exec, -1
    s_cbranch_scc1 K2_DONE
    v_mfma_f32_32x32x8_bf16 v[156:171], v[42:43], v[208:209], v[60:75]
    s_mov_b64 exec, s[30:31]
    v_exp_f32 v220, v140
    v_exp_f32 v221, v141
    v_exp_f32 v222, v142
    v_exp_f32 v223, v143
    v_mfma_f32_32x32x16_bf16 v[156:171], v[36:39], v[192:195], v[156:171]
    v_exp_f32 v224, v144
    v_exp_f32 v225, v145
    s_waitcnt lgkmcnt(0)
    s_mov_b64 exec, -1
    s_add_u32 m0, s94, 32768
    s_nop 0
    buffer_load_dwordx4 v[210:211], s[8:11], 0 idxen offen lds
    s_add_u32 m0, s94, 33792
    s_nop 0
    buffer_load_dwordx4 v[212:213], s[8:11], 0 idxen offen lds
    s_add_u32 m0, s94, 34816
    s_nop 0
    buffer_load_dwordx4 v[214:215], s[8:11], 0 idxen offen lds
    s_add_u32 m0, s94, 35840
    s_nop 0
    buffer_load_dwordx4 v[216:217], s[8:11], 0 idxen offen lds
    s_mov_b64 exec, s[30:31]
    v_exp_f32 v226, v146
    v_exp_f32 v227, v147
    v_pk_add_f32 v[220:221], v[220:221], 1.0 op_sel_hi:[1,0]
    v_pk_add_f32 v[222:223], v[222:223], 1.0 op_sel_hi:[1,0]
    v_mfma_f32_32x32x16_bf16 v[156:171], v[16:19], v[172:175], v[156:171]
    v_pk_add_f32 v[224:225], v[224:225], 1.0 op_sel_hi:[1,0]
    v_pk_add_f32 v[226:227], v[226:227], 1.0 op_sel_hi:[1,0]
    v_rcp_f32 v220, v220
    v_rcp_f32 v221, v221
    v_rcp_f32 v222, v222
    v_rcp_f32 v223, v223
    v_mfma_f32_32x32x16_bf16 v[156:171], v[20:23], v[176:179], v[156:171]
    v_rcp_f32 v224, v224
    v_rcp_f32 v225, v225
    v_rcp_f32 v226, v226
    v_rcp_f32 v227, v227
    v_pk_fma_f32 v[76:77], v[140:141], v[220:221], v[76:77]
    v_pk_fma_f32 v[78:79], v[142:143], v[222:223], v[78:79]
    v_mfma_f32_32x32x16_bf16 v[156:171], v[24:27], v[180:183], v[156:171]
    v_pk_fma_f32 v[80:81], v[144:145], v[224:225], v[80:81]
    v_pk_fma_f32 v[82:83], v[146:147], v[226:227], v[82:83]
    v_pk_mul_f32 v[228:229], v[76:77], v[108:109]
    v_pk_mul_f32 v[230:231], v[78:79], v[110:111]
    v_pk_fma_f32 v[228:229], v[80:81], v[112:113], v[228:229]
    v_pk_fma_f32 v[230:231], v[82:83], v[114:115], v[230:231]
    v_exp_f32 v220, v148
    v_exp_f32 v221, v149
    v_mfma_f32_32x32x16_bf16 v[156:171], v[28:31], v[184:187], v[156:171]
    v_exp_f32 v222, v150
    v_exp_f32 v223, v151
    s_mov_b64 exec, -1
    buffer_load_dwordx4 v[188:191], v[218:219], s[12:15], 0 idxen offen
    buffer_load_dwordx2 v[204:205], v203, s[16:19], 0 idxen
    s_mov_b64 exec, s[30:31]
    v_exp_f32 v224, v152
    v_exp_f32 v225, v153
    v_exp_f32 v226, v154
    v_exp_f32 v227, v155
    s_waitcnt vmcnt(6)
    ds_read_b128 v[172:175], v251 offset:0
    ds_read_b128 v[176:179], v252 offset:0
    ds_read_b128 v[180:183], v253 offset:0
    ds_read_b128 v[184:187], v254 offset:0
    v_cmp_lt_u32_e64 s[36:37], s6, v235
    s_add_u32 s6, s6, 1
    v_lshlrev_b32 v232, 16, v200
    v_and_b32 v233, 0xffff0000, v200
    v_sub_f32 v234, v242, v201
    v_pk_add_f32 v[232:233], v[240:241], v[232:233] neg_lo:[0,1] neg_hi:[0,1]
    v_mul_f32 v208, v232, v232
    v_fmac_f32 v208, v233, v233
    v_fmac_f32 v208, v234, v234
    v_cvt_pk_bf16_f32 v208, v208, v208
    v_cndmask_b32_e64 v203, 0, v207, s[36:37]
    v_add_u32 v207, v207, v206
    ds_read_b32 v218, v203
    ds_read_u16 v203, v203 offset:4
    v_pk_add_f32 v[220:221], v[220:221], 1.0 op_sel_hi:[1,0]
    v_pk_add_f32 v[222:223], v[222:223], 1.0 op_sel_hi:[1,0]
    v_pk_add_f32 v[224:225], v[224:225], 1.0 op_sel_hi:[1,0]
    v_pk_add_f32 v[226:227], v[226:227], 1.0 op_sel_hi:[1,0]
    v_rcp_f32 v220, v220
    v_rcp_f32 v221, v221
    v_rcp_f32 v222, v222
    v_rcp_f32 v223, v223
    v_rcp_f32 v224, v224
    v_rcp_f32 v225, v225
    v_rcp_f32 v226, v226
    v_rcp_f32 v227, v227
    s_waitcnt lgkmcnt(0)
    s_mov_b64 exec, -1
    ds_bpermute_b32 v210, v239, v203 offset:0
    ds_bpermute_b32 v212, v239, v203 offset:32
    ds_bpermute_b32 v214, v239, v203 offset:64
    ds_bpermute_b32 v216, v239, v203 offset:96
    s_mov_b64 exec, s[30:31]
    v_pk_fma_f32 v[84:85], v[148:149], v[220:221], v[84:85]
    v_pk_fma_f32 v[86:87], v[150:151], v[222:223], v[86:87]
    v_pk_fma_f32 v[88:89], v[152:153], v[224:225], v[88:89]
    v_pk_fma_f32 v[90:91], v[154:155], v[226:227], v[90:91]
    v_pk_fma_f32 v[228:229], v[84:85], v[116:117], v[228:229]
    v_pk_fma_f32 v[230:231], v[86:87], v[118:119], v[230:231]
    v_pk_fma_f32 v[228:229], v[88:89], v[120:121], v[228:229]
    v_pk_fma_f32 v[230:231], v[90:91], v[122:123], v[230:231]
    v_mfma_f32_32x32x8_bf16 v[140:155], v[40:41], v[208:209], v[44:59]
    v_exp_f32 v220, v156
    v_exp_f32 v221, v157
    v_exp_f32 v222, v158
    v_exp_f32 v223, v159
    v_mfma_f32_32x32x16_bf16 v[140:155], v[32:35], v[196:199], v[140:155]
    v_exp_f32 v224, v160
    v_exp_f32 v225, v161
    v_exp_f32 v226, v162
    v_exp_f32 v227, v163
    v_pk_add_f32 v[220:221], v[220:221], 1.0 op_sel_hi:[1,0]
    v_pk_add_f32 v[222:223], v[222:223], 1.0 op_sel_hi:[1,0]
    v_mfma_f32_32x32x16_bf16 v[140:155], v[0:3], v[172:175], v[140:155]
    v_pk_add_f32 v[224:225], v[224:225], 1.0 op_sel_hi:[1,0]
    v_pk_add_f32 v[226:227], v[226:227], 1.0 op_sel_hi:[1,0]
    v_rcp_f32 v220, v220
    v_rcp_f32 v221, v221
    v_rcp_f32 v222, v222
    v_rcp_f32 v223, v223
    v_mfma_f32_32x32x16_bf16 v[140:155], v[4:7], v[176:179], v[140:155]
    v_rcp_f32 v224, v224
    v_rcp_f32 v225, v225
    v_rcp_f32 v226, v226
    v_rcp_f32 v227, v227
    v_pk_fma_f32 v[92:93], v[156:157], v[220:221], v[92:93]
    v_pk_fma_f32 v[94:95], v[158:159], v[222:223], v[94:95]
    v_mfma_f32_32x32x16_bf16 v[140:155], v[8:11], v[180:183], v[140:155]
    v_pk_fma_f32 v[96:97], v[160:161], v[224:225], v[96:97]
    v_pk_fma_f32 v[98:99], v[162:163], v[226:227], v[98:99]
    v_pk_fma_f32 v[228:229], v[92:93], v[124:125], v[228:229]
    v_pk_fma_f32 v[230:231], v[94:95], v[126:127], v[230:231]
    v_pk_fma_f32 v[228:229], v[96:97], v[128:129], v[228:229]
    v_pk_fma_f32 v[230:231], v[98:99], v[130:131], v[230:231]
    v_exp_f32 v220, v164
    v_exp_f32 v221, v165
    v_mfma_f32_32x32x16_bf16 v[140:155], v[12:15], v[184:187], v[140:155]
    v_exp_f32 v222, v166
    v_exp_f32 v223, v167
    v_exp_f32 v224, v168
    v_exp_f32 v225, v169
    v_exp_f32 v226, v170
    v_exp_f32 v227, v171
    v_pk_add_f32 v[220:221], v[220:221], 1.0 op_sel_hi:[1,0]
    v_pk_add_f32 v[222:223], v[222:223], 1.0 op_sel_hi:[1,0]
    v_pk_add_f32 v[224:225], v[224:225], 1.0 op_sel_hi:[1,0]
    v_pk_add_f32 v[226:227], v[226:227], 1.0 op_sel_hi:[1,0]
    v_rcp_f32 v220, v220
    v_rcp_f32 v221, v221
    v_rcp_f32 v222, v222
    v_rcp_f32 v223, v223
    v_rcp_f32 v224, v224
    v_rcp_f32 v225, v225
    v_rcp_f32 v226, v226
    v_rcp_f32 v227, v227
    v_pk_fma_f32 v[100:101], v[164:165], v[220:221], v[100:101]
    v_pk_fma_f32 v[102:103], v[166:167], v[222:223], v[102:103]
    v_pk_fma_f32 v[104:105], v[168:169], v[224:225], v[104:105]
    v_pk_fma_f32 v[106:107], v[170:171], v[226:227], v[106:107]
    v_pk_fma_f32 v[228:229], v[100:101], v[132:133], v[228:229]
    v_pk_fma_f32 v[230:231], v[102:103], v[134:135], v[230:231]
    v_pk_fma_f32 v[228:229], v[104:105], v[136:137], v[228:229]
    v_pk_fma_f32 v[230:231], v[106:107], v[138:139], v[230:231]
    v_pk_add_f32 v[228:229], v[228:229], v[230:231]
    s_cmp_eq_u64 s[32:33], 0
    v_add_f32 v247, v228, v229
    v_sub_f32 v248, v247, v243
    v_pk_fma_f32 v[244:245], v[236:237], v[248:249], v[244:245] op_sel_hi:[1,0,1]
    v_fmac_f32 v246, v238, v248
    s_mov_b64 exec, -1
    s_cbranch_scc1 K2_DONE
    v_mfma_f32_32x32x8_bf16 v[156:171], v[42:43], v[208:209], v[60:75]
    s_mov_b64 exec, s[32:33]
    v_exp_f32 v220, v140
    v_exp_f32 v221, v141
    v_exp_f32 v222, v142
    v_exp_f32 v223, v143
    v_mfma_f32_32x32x16_bf16 v[156:171], v[36:39], v[196:199], v[156:171]
    v_exp_f32 v224, v144
    v_exp_f32 v225, v145
    s_waitcnt lgkmcnt(0)
    s_mov_b64 exec, -1
    s_add_u32 m0, s94, 0
    s_nop 0
    buffer_load_dwordx4 v[210:211], s[8:11], 0 idxen offen lds
    s_add_u32 m0, s94, 1024
    s_nop 0
    buffer_load_dwordx4 v[212:213], s[8:11], 0 idxen offen lds
    s_add_u32 m0, s94, 2048
    s_nop 0
    buffer_load_dwordx4 v[214:215], s[8:11], 0 idxen offen lds
    s_add_u32 m0, s94, 3072
    s_nop 0
    buffer_load_dwordx4 v[216:217], s[8:11], 0 idxen offen lds
    s_mov_b64 exec, s[32:33]
    v_exp_f32 v226, v146
    v_exp_f32 v227, v147
    v_pk_add_f32 v[220:221], v[220:221], 1.0 op_sel_hi:[1,0]
    v_pk_add_f32 v[222:223], v[222:223], 1.0 op_sel_hi:[1,0]
    v_mfma_f32_32x32x16_bf16 v[156:171], v[16:19], v[172:175], v[156:171]
    v_pk_add_f32 v[224:225], v[224:225], 1.0 op_sel_hi:[1,0]
    v_pk_add_f32 v[226:227], v[226:227], 1.0 op_sel_hi:[1,0]
    v_rcp_f32 v220, v220
    v_rcp_f32 v221, v221
    v_rcp_f32 v222, v222
    v_rcp_f32 v223, v223
    v_mfma_f32_32x32x16_bf16 v[156:171], v[20:23], v[176:179], v[156:171]
    v_rcp_f32 v224, v224
    v_rcp_f32 v225, v225
    v_rcp_f32 v226, v226
    v_rcp_f32 v227, v227
    v_pk_fma_f32 v[76:77], v[140:141], v[220:221], v[76:77]
    v_pk_fma_f32 v[78:79], v[142:143], v[222:223], v[78:79]
    v_mfma_f32_32x32x16_bf16 v[156:171], v[24:27], v[180:183], v[156:171]
    v_pk_fma_f32 v[80:81], v[144:145], v[224:225], v[80:81]
    v_pk_fma_f32 v[82:83], v[146:147], v[226:227], v[82:83]
    v_pk_mul_f32 v[228:229], v[76:77], v[108:109]
    v_pk_mul_f32 v[230:231], v[78:79], v[110:111]
    v_pk_fma_f32 v[228:229], v[80:81], v[112:113], v[228:229]
    v_pk_fma_f32 v[230:231], v[82:83], v[114:115], v[230:231]
    v_exp_f32 v220, v148
    v_exp_f32 v221, v149
    v_mfma_f32_32x32x16_bf16 v[156:171], v[28:31], v[184:187], v[156:171]
    v_exp_f32 v222, v150
    v_exp_f32 v223, v151
    s_mov_b64 exec, -1
    buffer_load_dwordx4 v[192:195], v[218:219], s[12:15], 0 idxen offen
    buffer_load_dwordx2 v[200:201], v203, s[16:19], 0 idxen
    s_mov_b64 exec, s[32:33]
    v_exp_f32 v224, v152
    v_exp_f32 v225, v153
    v_exp_f32 v226, v154
    v_exp_f32 v227, v155
    s_waitcnt vmcnt(6)
    ds_read_b128 v[172:175], v251 offset:32768
    ds_read_b128 v[176:179], v252 offset:32768
    ds_read_b128 v[180:183], v253 offset:32768
    ds_read_b128 v[184:187], v254 offset:32768
    v_cmp_lt_u32_e64 s[38:39], s6, v235
    s_add_u32 s6, s6, 1
    v_lshlrev_b32 v236, 16, v204
    v_and_b32 v237, 0xffff0000, v204
    v_sub_f32 v238, v242, v205
    v_pk_add_f32 v[236:237], v[240:241], v[236:237] neg_lo:[0,1] neg_hi:[0,1]
    v_mul_f32 v208, v236, v236
    v_fmac_f32 v208, v237, v237
    v_fmac_f32 v208, v238, v238
    v_cvt_pk_bf16_f32 v208, v208, v208
    v_cndmask_b32_e64 v203, 0, v207, s[38:39]
    v_add_u32 v207, v207, v206
    ds_read_b32 v218, v203
    ds_read_u16 v203, v203 offset:4
    v_pk_add_f32 v[220:221], v[220:221], 1.0 op_sel_hi:[1,0]
    v_pk_add_f32 v[222:223], v[222:223], 1.0 op_sel_hi:[1,0]
    v_pk_add_f32 v[224:225], v[224:225], 1.0 op_sel_hi:[1,0]
    v_pk_add_f32 v[226:227], v[226:227], 1.0 op_sel_hi:[1,0]
    v_rcp_f32 v220, v220
    v_rcp_f32 v221, v221
    v_rcp_f32 v222, v222
    v_rcp_f32 v223, v223
    v_rcp_f32 v224, v224
    v_rcp_f32 v225, v225
    v_rcp_f32 v226, v226
    v_rcp_f32 v227, v227
    s_waitcnt lgkmcnt(0)
    s_mov_b64 exec, -1
    ds_bpermute_b32 v210, v239, v203 offset:0
    ds_bpermute_b32 v212, v239, v203 offset:32
    ds_bpermute_b32 v214, v239, v203 offset:64
    ds_bpermute_b32 v216, v239, v203 offset:96
    s_mov_b64 exec, s[32:33]
    v_pk_fma_f32 v[84:85], v[148:149], v[220:221], v[84:85]
    v_pk_fma_f32 v[86:87], v[150:151], v[222:223], v[86:87]
    v_pk_fma_f32 v[88:89], v[152:153], v[224:225], v[88:89]
    v_pk_fma_f32 v[90:91], v[154:155], v[226:227], v[90:91]
    v_pk_fma_f32 v[228:229], v[84:85], v[116:117], v[228:229]
    v_pk_fma_f32 v[230:231], v[86:87], v[118:119], v[230:231]
    v_pk_fma_f32 v[228:229], v[88:89], v[120:121], v[228:229]
    v_pk_fma_f32 v[230:231], v[90:91], v[122:123], v[230:231]
    v_mfma_f32_32x32x8_bf16 v[140:155], v[40:41], v[208:209], v[44:59]
    v_exp_f32 v220, v156
    v_exp_f32 v221, v157
    v_exp_f32 v222, v158
    v_exp_f32 v223, v159
    v_mfma_f32_32x32x16_bf16 v[140:155], v[32:35], v[188:191], v[140:155]
    v_exp_f32 v224, v160
    v_exp_f32 v225, v161
    v_exp_f32 v226, v162
    v_exp_f32 v227, v163
    v_pk_add_f32 v[220:221], v[220:221], 1.0 op_sel_hi:[1,0]
    v_pk_add_f32 v[222:223], v[222:223], 1.0 op_sel_hi:[1,0]
    v_mfma_f32_32x32x16_bf16 v[140:155], v[0:3], v[172:175], v[140:155]
    v_pk_add_f32 v[224:225], v[224:225], 1.0 op_sel_hi:[1,0]
    v_pk_add_f32 v[226:227], v[226:227], 1.0 op_sel_hi:[1,0]
    v_rcp_f32 v220, v220
    v_rcp_f32 v221, v221
    v_rcp_f32 v222, v222
    v_rcp_f32 v223, v223
    v_mfma_f32_32x32x16_bf16 v[140:155], v[4:7], v[176:179], v[140:155]
    v_rcp_f32 v224, v224
    v_rcp_f32 v225, v225
    v_rcp_f32 v226, v226
    v_rcp_f32 v227, v227
    v_pk_fma_f32 v[92:93], v[156:157], v[220:221], v[92:93]
    v_pk_fma_f32 v[94:95], v[158:159], v[222:223], v[94:95]
    v_mfma_f32_32x32x16_bf16 v[140:155], v[8:11], v[180:183], v[140:155]
    v_pk_fma_f32 v[96:97], v[160:161], v[224:225], v[96:97]
    v_pk_fma_f32 v[98:99], v[162:163], v[226:227], v[98:99]
    v_pk_fma_f32 v[228:229], v[92:93], v[124:125], v[228:229]
    v_pk_fma_f32 v[230:231], v[94:95], v[126:127], v[230:231]
    v_pk_fma_f32 v[228:229], v[96:97], v[128:129], v[228:229]
    v_pk_fma_f32 v[230:231], v[98:99], v[130:131], v[230:231]
    v_exp_f32 v220, v164
    v_exp_f32 v221, v165
    v_mfma_f32_32x32x16_bf16 v[140:155], v[12:15], v[184:187], v[140:155]
    v_exp_f32 v222, v166
    v_exp_f32 v223, v167
    v_exp_f32 v224, v168
    v_exp_f32 v225, v169
    v_exp_f32 v226, v170
    v_exp_f32 v227, v171
    v_pk_add_f32 v[220:221], v[220:221], 1.0 op_sel_hi:[1,0]
    v_pk_add_f32 v[222:223], v[222:223], 1.0 op_sel_hi:[1,0]
    v_pk_add_f32 v[224:225], v[224:225], 1.0 op_sel_hi:[1,0]
    v_pk_add_f32 v[226:227], v[226:227], 1.0 op_sel_hi:[1,0]
    v_rcp_f32 v220, v220
    v_rcp_f32 v221, v221
    v_rcp_f32 v222, v222
    v_rcp_f32 v223, v223
    v_rcp_f32 v224, v224
    v_rcp_f32 v225, v225
    v_rcp_f32 v226, v226
    v_rcp_f32 v227, v227
    v_pk_fma_f32 v[100:101], v[164:165], v[220:221], v[100:101]
    v_pk_fma_f32 v[102:103], v[166:167], v[222:223], v[102:103]
    v_pk_fma_f32 v[104:105], v[168:169], v[224:225], v[104:105]
    v_pk_fma_f32 v[106:107], v[170:171], v[226:227], v[106:107]
    v_pk_fma_f32 v[228:229], v[100:101], v[132:133], v[228:229]
    v_pk_fma_f32 v[230:231], v[102:103], v[134:135], v[230:231]
    v_pk_fma_f32 v[228:229], v[104:105], v[136:137], v[228:229]
    v_pk_fma_f32 v[230:231], v[106:107], v[138:139], v[230:231]
    v_pk_add_f32 v[228:229], v[228:229], v[230:231]
    s_cmp_eq_u64 s[34:35], 0
    v_add_f32 v243, v228, v229
    v_sub_f32 v248, v243, v247
    v_pk_fma_f32 v[244:245], v[232:233], v[248:249], v[244:245] op_sel_hi:[1,0,1]
    v_fmac_f32 v246, v234, v248
    s_mov_b64 exec, -1
    s_cbranch_scc1 K2_DONE
    v_mfma_f32_32x32x8_bf16 v[156:171], v[42:43], v[208:209], v[60:75]
    s_mov_b64 exec, s[34:35]
    v_exp_f32 v220, v140
    v_exp_f32 v221, v141
    v_exp_f32 v222, v142
    v_exp_f32 v223, v143
    v_mfma_f32_32x32x16_bf16 v[156:171], v[36:39], v[188:191], v[156:171]
    v_exp_f32 v224, v144
    v_exp_f32 v225, v145
    s_waitcnt lgkmcnt(0)
    s_mov_b64 exec, -1
    s_add_u32 m0, s94, 32768
    s_nop 0
    buffer_load_dwordx4 v[210:211], s[8:11], 0 idxen offen lds
    s_add_u32 m0, s94, 33792
    s_nop 0
    buffer_load_dwordx4 v[212:213], s[8:11], 0 idxen offen lds
    s_add_u32 m0, s94, 34816
    s_nop 0
    buffer_load_dwordx4 v[214:215], s[8:11], 0 idxen offen lds
    s_add_u32 m0, s94, 35840
    s_nop 0
    buffer_load_dwordx4 v[216:217], s[8:11], 0 idxen offen lds
    s_mov_b64 exec, s[34:35]
    v_exp_f32 v226, v146
    v_exp_f32 v227, v147
    v_pk_add_f32 v[220:221], v[220:221], 1.0 op_sel_hi:[1,0]
    v_pk_add_f32 v[222:223], v[222:223], 1.0 op_sel_hi:[1,0]
    v_mfma_f32_32x32x16_bf16 v[156:171], v[16:19], v[172:175], v[156:171]
    v_pk_add_f32 v[224:225], v[224:225], 1.0 op_sel_hi:[1,0]
    v_pk_add_f32 v[226:227], v[226:227], 1.0 op_sel_hi:[1,0]
    v_rcp_f32 v220, v220
    v_rcp_f32 v221, v221
    v_rcp_f32 v222, v222
    v_rcp_f32 v223, v223
    v_mfma_f32_32x32x16_bf16 v[156:171], v[20:23], v[176:179], v[156:171]
    v_rcp_f32 v224, v224
    v_rcp_f32 v225, v225
    v_rcp_f32 v226, v226
    v_rcp_f32 v227, v227
    v_pk_fma_f32 v[76:77], v[140:141], v[220:221], v[76:77]
    v_pk_fma_f32 v[78:79], v[142:143], v[222:223], v[78:79]
    v_mfma_f32_32x32x16_bf16 v[156:171], v[24:27], v[180:183], v[156:171]
    v_pk_fma_f32 v[80:81], v[144:145], v[224:225], v[80:81]
    v_pk_fma_f32 v[82:83], v[146:147], v[226:227], v[82:83]
    v_pk_mul_f32 v[228:229], v[76:77], v[108:109]
    v_pk_mul_f32 v[230:231], v[78:79], v[110:111]
    v_pk_fma_f32 v[228:229], v[80:81], v[112:113], v[228:229]
    v_pk_fma_f32 v[230:231], v[82:83], v[114:115], v[230:231]
    v_exp_f32 v220, v148
    v_exp_f32 v221, v149
    v_mfma_f32_32x32x16_bf16 v[156:171], v[28:31], v[184:187], v[156:171]
    v_exp_f32 v222, v150
    v_exp_f32 v223, v151
    s_mov_b64 exec, -1
    buffer_load_dwordx4 v[196:199], v[218:219], s[12:15], 0 idxen offen
    buffer_load_dwordx2 v[204:205], v203, s[16:19], 0 idxen
    s_mov_b64 exec, s[34:35]
    v_exp_f32 v224, v152
    v_exp_f32 v225, v153
    v_exp_f32 v226, v154
    v_exp_f32 v227, v155
    s_waitcnt vmcnt(6)
    ds_read_b128 v[172:175], v251 offset:0
    ds_read_b128 v[176:179], v252 offset:0
    ds_read_b128 v[180:183], v253 offset:0
    ds_read_b128 v[184:187], v254 offset:0
    v_cmp_lt_u32_e64 s[28:29], s6, v235
    s_add_u32 s6, s6, 1
    v_lshlrev_b32 v232, 16, v200
    v_and_b32 v233, 0xffff0000, v200
    v_sub_f32 v234, v242, v201
    v_pk_add_f32 v[232:233], v[240:241], v[232:233] neg_lo:[0,1] neg_hi:[0,1]
    v_mul_f32 v208, v232, v232
    v_fmac_f32 v208, v233, v233
    v_fmac_f32 v208, v234, v234
    v_cvt_pk_bf16_f32 v208, v208, v208
    v_cndmask_b32_e64 v203, 0, v207, s[28:29]
    v_add_u32 v207, v207, v206
    ds_read_b32 v218, v203
    ds_read_u16 v203, v203 offset:4
    v_pk_add_f32 v[220:221], v[220:221], 1.0 op_sel_hi:[1,0]
    v_pk_add_f32 v[222:223], v[222:223], 1.0 op_sel_hi:[1,0]
    v_pk_add_f32 v[224:225], v[224:225], 1.0 op_sel_hi:[1,0]
    v_pk_add_f32 v[226:227], v[226:227], 1.0 op_sel_hi:[1,0]
    v_rcp_f32 v220, v220
    v_rcp_f32 v221, v221
    v_rcp_f32 v222, v222
    v_rcp_f32 v223, v223
    v_rcp_f32 v224, v224
    v_rcp_f32 v225, v225
    v_rcp_f32 v226, v226
    v_rcp_f32 v227, v227
    s_waitcnt lgkmcnt(0)
    s_mov_b64 exec, -1
    ds_bpermute_b32 v210, v239, v203 offset:0
    ds_bpermute_b32 v212, v239, v203 offset:32
    ds_bpermute_b32 v214, v239, v203 offset:64
    ds_bpermute_b32 v216, v239, v203 offset:96
    s_mov_b64 exec, s[34:35]
    v_pk_fma_f32 v[84:85], v[148:149], v[220:221], v[84:85]
    v_pk_fma_f32 v[86:87], v[150:151], v[222:223], v[86:87]
    v_pk_fma_f32 v[88:89], v[152:153], v[224:225], v[88:89]
    v_pk_fma_f32 v[90:91], v[154:155], v[226:227], v[90:91]
    v_pk_fma_f32 v[228:229], v[84:85], v[116:117], v[228:229]
    v_pk_fma_f32 v[230:231], v[86:87], v[118:119], v[230:231]
    v_pk_fma_f32 v[228:229], v[88:89], v[120:121], v[228:229]
    v_pk_fma_f32 v[230:231], v[90:91], v[122:123], v[230:231]
    v_mfma_f32_32x32x8_bf16 v[140:155], v[40:41], v[208:209], v[44:59]
    v_exp_f32 v220, v156
    v_exp_f32 v221, v157
    v_exp_f32 v222, v158
    v_exp_f32 v223, v159
    v_mfma_f32_32x32x16_bf16 v[140:155], v[32:35], v[192:195], v[140:155]
    v_exp_f32 v224, v160
    v_exp_f32 v225, v161
    v_exp_f32 v226, v162
    v_exp_f32 v227, v163
    v_pk_add_f32 v[220:221], v[220:221], 1.0 op_sel_hi:[1,0]
    v_pk_add_f32 v[222:223], v[222:223], 1.0 op_sel_hi:[1,0]
    v_mfma_f32_32x32x16_bf16 v[140:155], v[0:3], v[172:175], v[140:155]
    v_pk_add_f32 v[224:225], v[224:225], 1.0 op_sel_hi:[1,0]
    v_pk_add_f32 v[226:227], v[226:227], 1.0 op_sel_hi:[1,0]
    v_rcp_f32 v220, v220
    v_rcp_f32 v221, v221
    v_rcp_f32 v222, v222
    v_rcp_f32 v223, v223
    v_mfma_f32_32x32x16_bf16 v[140:155], v[4:7], v[176:179], v[140:155]
    v_rcp_f32 v224, v224
    v_rcp_f32 v225, v225
    v_rcp_f32 v226, v226
    v_rcp_f32 v227, v227
    v_pk_fma_f32 v[92:93], v[156:157], v[220:221], v[92:93]
    v_pk_fma_f32 v[94:95], v[158:159], v[222:223], v[94:95]
    v_mfma_f32_32x32x16_bf16 v[140:155], v[8:11], v[180:183], v[140:155]
    v_pk_fma_f32 v[96:97], v[160:161], v[224:225], v[96:97]
    v_pk_fma_f32 v[98:99], v[162:163], v[226:227], v[98:99]
    v_pk_fma_f32 v[228:229], v[92:93], v[124:125], v[228:229]
    v_pk_fma_f32 v[230:231], v[94:95], v[126:127], v[230:231]
    v_pk_fma_f32 v[228:229], v[96:97], v[128:129], v[228:229]
    v_pk_fma_f32 v[230:231], v[98:99], v[130:131], v[230:231]
    v_exp_f32 v220, v164
    v_exp_f32 v221, v165
    v_mfma_f32_32x32x16_bf16 v[140:155], v[12:15], v[184:187], v[140:155]
    v_exp_f32 v222, v166
    v_exp_f32 v223, v167
    v_exp_f32 v224, v168
    v_exp_f32 v225, v169
    v_exp_f32 v226, v170
    v_exp_f32 v227, v171
    v_pk_add_f32 v[220:221], v[220:221], 1.0 op_sel_hi:[1,0]
    v_pk_add_f32 v[222:223], v[222:223], 1.0 op_sel_hi:[1,0]
    v_pk_add_f32 v[224:225], v[224:225], 1.0 op_sel_hi:[1,0]
    v_pk_add_f32 v[226:227], v[226:227], 1.0 op_sel_hi:[1,0]
    v_rcp_f32 v220, v220
    v_rcp_f32 v221, v221
    v_rcp_f32 v222, v222
    v_rcp_f32 v223, v223
    v_rcp_f32 v224, v224
    v_rcp_f32 v225, v225
    v_rcp_f32 v226, v226
    v_rcp_f32 v227, v227
    v_pk_fma_f32 v[100:101], v[164:165], v[220:221], v[100:101]
    v_pk_fma_f32 v[102:103], v[166:167], v[222:223], v[102:103]
    v_pk_fma_f32 v[104:105], v[168:169], v[224:225], v[104:105]
    v_pk_fma_f32 v[106:107], v[170:171], v[226:227], v[106:107]
    v_pk_fma_f32 v[228:229], v[100:101], v[132:133], v[228:229]
    v_pk_fma_f32 v[230:231], v[102:103], v[134:135], v[230:231]
    v_pk_fma_f32 v[228:229], v[104:105], v[136:137], v[228:229]
    v_pk_fma_f32 v[230:231], v[106:107], v[138:139], v[230:231]
    v_pk_add_f32 v[228:229], v[228:229], v[230:231]
    s_cmp_eq_u64 s[36:37], 0
    v_add_f32 v247, v228, v229
    v_sub_f32 v248, v247, v243
    v_pk_fma_f32 v[244:245], v[236:237], v[248:249], v[244:245] op_sel_hi:[1,0,1]
    v_fmac_f32 v246, v238, v248
    s_mov_b64 exec, -1
    s_cbranch_scc1 K2_DONE
    v_mfma_f32_32x32x8_bf16 v[156:171], v[42:43], v[208:209], v[60:75]
    s_mov_b64 exec, s[36:37]
    v_exp_f32 v220, v140
    v_exp_f32 v221, v141
    v_exp_f32 v222, v142
    v_exp_f32 v223, v143
    v_mfma_f32_32x32x16_bf16 v[156:171], v[36:39], v[192:195], v[156:171]
    v_exp_f32 v224, v144
    v_exp_f32 v225, v145
    s_waitcnt lgkmcnt(0)
    s_mov_b64 exec, -1
    s_add_u32 m0, s94, 0
    s_nop 0
    buffer_load_dwordx4 v[210:211], s[8:11], 0 idxen offen lds
    s_add_u32 m0, s94, 1024
    s_nop 0
    buffer_load_dwordx4 v[212:213], s[8:11], 0 idxen offen lds
    s_add_u32 m0, s94, 2048
    s_nop 0
    buffer_load_dwordx4 v[214:215], s[8:11], 0 idxen offen lds
    s_add_u32 m0, s94, 3072
    s_nop 0
    buffer_load_dwordx4 v[216:217], s[8:11], 0 idxen offen lds
    s_mov_b64 exec, s[36:37]
    v_exp_f32 v226, v146
    v_exp_f32 v227, v147
    v_pk_add_f32 v[220:221], v[220:221], 1.0 op_sel_hi:[1,0]
    v_pk_add_f32 v[222:223], v[222:223], 1.0 op_sel_hi:[1,0]
    v_mfma_f32_32x32x16_bf16 v[156:171], v[16:19], v[172:175], v[156:171]
    v_pk_add_f32 v[224:225], v[224:225], 1.0 op_sel_hi:[1,0]
    v_pk_add_f32 v[226:227], v[226:227], 1.0 op_sel_hi:[1,0]
    v_rcp_f32 v220, v220
    v_rcp_f32 v221, v221
    v_rcp_f32 v222, v222
    v_rcp_f32 v223, v223
    v_mfma_f32_32x32x16_bf16 v[156:171], v[20:23], v[176:179], v[156:171]
    v_rcp_f32 v224, v224
    v_rcp_f32 v225, v225
    v_rcp_f32 v226, v226
    v_rcp_f32 v227, v227
    v_pk_fma_f32 v[76:77], v[140:141], v[220:221], v[76:77]
    v_pk_fma_f32 v[78:79], v[142:143], v[222:223], v[78:79]
    v_mfma_f32_32x32x16_bf16 v[156:171], v[24:27], v[180:183], v[156:171]
    v_pk_fma_f32 v[80:81], v[144:145], v[224:225], v[80:81]
    v_pk_fma_f32 v[82:83], v[146:147], v[226:227], v[82:83]
    v_pk_mul_f32 v[228:229], v[76:77], v[108:109]
    v_pk_mul_f32 v[230:231], v[78:79], v[110:111]
    v_pk_fma_f32 v[228:229], v[80:81], v[112:113], v[228:229]
    v_pk_fma_f32 v[230:231], v[82:83], v[114:115], v[230:231]
    v_exp_f32 v220, v148
    v_exp_f32 v221, v149
    v_mfma_f32_32x32x16_bf16 v[156:171], v[28:31], v[184:187], v[156:171]
    v_exp_f32 v222, v150
    v_exp_f32 v223, v151
    s_mov_b64 exec, -1
    buffer_load_dwordx4 v[188:191], v[218:219], s[12:15], 0 idxen offen
    buffer_load_dwordx2 v[200:201], v203, s[16:19], 0 idxen
    s_mov_b64 exec, s[36:37]
    v_exp_f32 v224, v152
    v_exp_f32 v225, v153
    v_exp_f32 v226, v154
    v_exp_f32 v227, v155
    s_waitcnt vmcnt(6)
    ds_read_b128 v[172:175], v251 offset:32768
    ds_read_b128 v[176:179], v252 offset:32768
    ds_read_b128 v[180:183], v253 offset:32768
    ds_read_b128 v[184:187], v254 offset:32768
    v_cmp_lt_u32_e64 s[30:31], s6, v235
    s_add_u32 s6, s6, 1
    v_lshlrev_b32 v236, 16, v204
    v_and_b32 v237, 0xffff0000, v204
    v_sub_f32 v238, v242, v205
    v_pk_add_f32 v[236:237], v[240:241], v[236:237] neg_lo:[0,1] neg_hi:[0,1]
    v_mul_f32 v208, v236, v236
    v_fmac_f32 v208, v237, v237
    v_fmac_f32 v208, v238, v238
    v_cvt_pk_bf16_f32 v208, v208, v208
    v_cndmask_b32_e64 v203, 0, v207, s[30:31]
    v_add_u32 v207, v207, v206
    ds_read_b32 v218, v203
    ds_read_u16 v203, v203 offset:4
    v_pk_add_f32 v[220:221], v[220:221], 1.0 op_sel_hi:[1,0]
    v_pk_add_f32 v[222:223], v[222:223], 1.0 op_sel_hi:[1,0]
    v_pk_add_f32 v[224:225], v[224:225], 1.0 op_sel_hi:[1,0]
    v_pk_add_f32 v[226:227], v[226:227], 1.0 op_sel_hi:[1,0]
    v_rcp_f32 v220, v220
    v_rcp_f32 v221, v221
    v_rcp_f32 v222, v222
    v_rcp_f32 v223, v223
    v_rcp_f32 v224, v224
    v_rcp_f32 v225, v225
    v_rcp_f32 v226, v226
    v_rcp_f32 v227, v227
    s_waitcnt lgkmcnt(0)
    s_mov_b64 exec, -1
    ds_bpermute_b32 v210, v239, v203 offset:0
    ds_bpermute_b32 v212, v239, v203 offset:32
    ds_bpermute_b32 v214, v239, v203 offset:64
    ds_bpermute_b32 v216, v239, v203 offset:96
    s_mov_b64 exec, s[36:37]
    v_pk_fma_f32 v[84:85], v[148:149], v[220:221], v[84:85]
    v_pk_fma_f32 v[86:87], v[150:151], v[222:223], v[86:87]
    v_pk_fma_f32 v[88:89], v[152:153], v[224:225], v[88:89]
    v_pk_fma_f32 v[90:91], v[154:155], v[226:227], v[90:91]
    v_pk_fma_f32 v[228:229], v[84:85], v[116:117], v[228:229]
    v_pk_fma_f32 v[230:231], v[86:87], v[118:119], v[230:231]
    v_pk_fma_f32 v[228:229], v[88:89], v[120:121], v[228:229]
    v_pk_fma_f32 v[230:231], v[90:91], v[122:123], v[230:231]
    v_mfma_f32_32x32x8_bf16 v[140:155], v[40:41], v[208:209], v[44:59]
    v_exp_f32 v220, v156
    v_exp_f32 v221, v157
    v_exp_f32 v222, v158
    v_exp_f32 v223, v159
    v_mfma_f32_32x32x16_bf16 v[140:155], v[32:35], v[196:199], v[140:155]
    v_exp_f32 v224, v160
    v_exp_f32 v225, v161
    v_exp_f32 v226, v162
    v_exp_f32 v227, v163
    v_pk_add_f32 v[220:221], v[220:221], 1.0 op_sel_hi:[1,0]
    v_pk_add_f32 v[222:223], v[222:223], 1.0 op_sel_hi:[1,0]
    v_mfma_f32_32x32x16_bf16 v[140:155], v[0:3], v[172:175], v[140:155]
    v_pk_add_f32 v[224:225], v[224:225], 1.0 op_sel_hi:[1,0]
    v_pk_add_f32 v[226:227], v[226:227], 1.0 op_sel_hi:[1,0]
    v_rcp_f32 v220, v220
    v_rcp_f32 v221, v221
    v_rcp_f32 v222, v222
    v_rcp_f32 v223, v223
    v_mfma_f32_32x32x16_bf16 v[140:155], v[4:7], v[176:179], v[140:155]
    v_rcp_f32 v224, v224
    v_rcp_f32 v225, v225
    v_rcp_f32 v226, v226
    v_rcp_f32 v227, v227
    v_pk_fma_f32 v[92:93], v[156:157], v[220:221], v[92:93]
    v_pk_fma_f32 v[94:95], v[158:159], v[222:223], v[94:95]
    v_mfma_f32_32x32x16_bf16 v[140:155], v[8:11], v[180:183], v[140:155]
    v_pk_fma_f32 v[96:97], v[160:161], v[224:225], v[96:97]
    v_pk_fma_f32 v[98:99], v[162:163], v[226:227], v[98:99]
    v_pk_fma_f32 v[228:229], v[92:93], v[124:125], v[228:229]
    v_pk_fma_f32 v[230:231], v[94:95], v[126:127], v[230:231]
    v_pk_fma_f32 v[228:229], v[96:97], v[128:129], v[228:229]
    v_pk_fma_f32 v[230:231], v[98:99], v[130:131], v[230:231]
    v_exp_f32 v220, v164
    v_exp_f32 v221, v165
    v_mfma_f32_32x32x16_bf16 v[140:155], v[12:15], v[184:187], v[140:155]
    v_exp_f32 v222, v166
    v_exp_f32 v223, v167
    v_exp_f32 v224, v168
    v_exp_f32 v225, v169
    v_exp_f32 v226, v170
    v_exp_f32 v227, v171
    v_pk_add_f32 v[220:221], v[220:221], 1.0 op_sel_hi:[1,0]
    v_pk_add_f32 v[222:223], v[222:223], 1.0 op_sel_hi:[1,0]
    v_pk_add_f32 v[224:225], v[224:225], 1.0 op_sel_hi:[1,0]
    v_pk_add_f32 v[226:227], v[226:227], 1.0 op_sel_hi:[1,0]
    v_rcp_f32 v220, v220
    v_rcp_f32 v221, v221
    v_rcp_f32 v222, v222
    v_rcp_f32 v223, v223
    v_rcp_f32 v224, v224
    v_rcp_f32 v225, v225
    v_rcp_f32 v226, v226
    v_rcp_f32 v227, v227
    v_pk_fma_f32 v[100:101], v[164:165], v[220:221], v[100:101]
    v_pk_fma_f32 v[102:103], v[166:167], v[222:223], v[102:103]
    v_pk_fma_f32 v[104:105], v[168:169], v[224:225], v[104:105]
    v_pk_fma_f32 v[106:107], v[170:171], v[226:227], v[106:107]
    v_pk_fma_f32 v[228:229], v[100:101], v[132:133], v[228:229]
    v_pk_fma_f32 v[230:231], v[102:103], v[134:135], v[230:231]
    v_pk_fma_f32 v[228:229], v[104:105], v[136:137], v[228:229]
    v_pk_fma_f32 v[230:231], v[106:107], v[138:139], v[230:231]
    v_pk_add_f32 v[228:229], v[228:229], v[230:231]
    s_cmp_eq_u64 s[38:39], 0
    v_add_f32 v243, v228, v229
    v_sub_f32 v248, v243, v247
    v_pk_fma_f32 v[244:245], v[232:233], v[248:249], v[244:245] op_sel_hi:[1,0,1]
    v_fmac_f32 v246, v234, v248
    s_mov_b64 exec, -1
    s_cbranch_scc1 K2_DONE
    v_mfma_f32_32x32x8_bf16 v[156:171], v[42:43], v[208:209], v[60:75]
    s_mov_b64 exec, s[38:39]
    v_exp_f32 v220, v140
    v_exp_f32 v221, v141
    v_exp_f32 v222, v142
    v_exp_f32 v223, v143
    v_mfma_f32_32x32x16_bf16 v[156:171], v[36:39], v[196:199], v[156:171]
    v_exp_f32 v224, v144
    v_exp_f32 v225, v145
    s_waitcnt lgkmcnt(0)
    s_mov_b64 exec, -1
    s_add_u32 m0, s94, 32768
    s_nop 0
    buffer_load_dwordx4 v[210:211], s[8:11], 0 idxen offen lds
    s_add_u32 m0, s94, 33792
    s_nop 0
    buffer_load_dwordx4 v[212:213], s[8:11], 0 idxen offen lds
    s_add_u32 m0, s94, 34816
    s_nop 0
    buffer_load_dwordx4 v[214:215], s[8:11], 0 idxen offen lds
    s_add_u32 m0, s94, 35840
    s_nop 0
    buffer_load_dwordx4 v[216:217], s[8:11], 0 idxen offen lds
    s_mov_b64 exec, s[38:39]
    v_exp_f32 v226, v146
    v_exp_f32 v227, v147
    v_pk_add_f32 v[220:221], v[220:221], 1.0 op_sel_hi:[1,0]
    v_pk_add_f32 v[222:223], v[222:223], 1.0 op_sel_hi:[1,0]
    v_mfma_f32_32x32x16_bf16 v[156:171], v[16:19], v[172:175], v[156:171]
    v_pk_add_f32 v[224:225], v[224:225], 1.0 op_sel_hi:[1,0]
    v_pk_add_f32 v[226:227], v[226:227], 1.0 op_sel_hi:[1,0]
    v_rcp_f32 v220, v220
    v_rcp_f32 v221, v221
    v_rcp_f32 v222, v222
    v_rcp_f32 v223, v223
    v_mfma_f32_32x32x16_bf16 v[156:171], v[20:23], v[176:179], v[156:171]
    v_rcp_f32 v224, v224
    v_rcp_f32 v225, v225
    v_rcp_f32 v226, v226
    v_rcp_f32 v227, v227
    v_pk_fma_f32 v[76:77], v[140:141], v[220:221], v[76:77]
    v_pk_fma_f32 v[78:79], v[142:143], v[222:223], v[78:79]
    v_mfma_f32_32x32x16_bf16 v[156:171], v[24:27], v[180:183], v[156:171]
    v_pk_fma_f32 v[80:81], v[144:145], v[224:225], v[80:81]
    v_pk_fma_f32 v[82:83], v[146:147], v[226:227], v[82:83]
    v_pk_mul_f32 v[228:229], v[76:77], v[108:109]
    v_pk_mul_f32 v[230:231], v[78:79], v[110:111]
    v_pk_fma_f32 v[228:229], v[80:81], v[112:113], v[228:229]
    v_pk_fma_f32 v[230:231], v[82:83], v[114:115], v[230:231]
    v_exp_f32 v220, v148
    v_exp_f32 v221, v149
    v_mfma_f32_32x32x16_bf16 v[156:171], v[28:31], v[184:187], v[156:171]
    v_exp_f32 v222, v150
    v_exp_f32 v223, v151
    s_mov_b64 exec, -1
    buffer_load_dwordx4 v[192:195], v[218:219], s[12:15], 0 idxen offen
    buffer_load_dwordx2 v[204:205], v203, s[16:19], 0 idxen
    s_mov_b64 exec, s[38:39]
    v_exp_f32 v224, v152
    v_exp_f32 v225, v153
    v_exp_f32 v226, v154
    v_exp_f32 v227, v155
    s_waitcnt vmcnt(6)
    ds_read_b128 v[172:175], v251 offset:0
    ds_read_b128 v[176:179], v252 offset:0
    ds_read_b128 v[180:183], v253 offset:0
    ds_read_b128 v[184:187], v254 offset:0
    v_cmp_lt_u32_e64 s[32:33], s6, v235
    s_add_u32 s6, s6, 1
    v_lshlrev_b32 v232, 16, v200
    v_and_b32 v233, 0xffff0000, v200
    v_sub_f32 v234, v242, v201
    v_pk_add_f32 v[232:233], v[240:241], v[232:233] neg_lo:[0,1] neg_hi:[0,1]
    v_mul_f32 v208, v232, v232
    v_fmac_f32 v208, v233, v233
    v_fmac_f32 v208, v234, v234
    v_cvt_pk_bf16_f32 v208, v208, v208
    v_cndmask_b32_e64 v203, 0, v207, s[32:33]
    v_add_u32 v207, v207, v206
    ds_read_b32 v218, v203
    ds_read_u16 v203, v203 offset:4
    v_pk_add_f32 v[220:221], v[220:221], 1.0 op_sel_hi:[1,0]
    v_pk_add_f32 v[222:223], v[222:223], 1.0 op_sel_hi:[1,0]
    v_pk_add_f32 v[224:225], v[224:225], 1.0 op_sel_hi:[1,0]
    v_pk_add_f32 v[226:227], v[226:227], 1.0 op_sel_hi:[1,0]
    v_rcp_f32 v220, v220
    v_rcp_f32 v221, v221
    v_rcp_f32 v222, v222
    v_rcp_f32 v223, v223
    v_rcp_f32 v224, v224
    v_rcp_f32 v225, v225
    v_rcp_f32 v226, v226
    v_rcp_f32 v227, v227
    s_waitcnt lgkmcnt(0)
    s_mov_b64 exec, -1
    ds_bpermute_b32 v210, v239, v203 offset:0
    ds_bpermute_b32 v212, v239, v203 offset:32
    ds_bpermute_b32 v214, v239, v203 offset:64
    ds_bpermute_b32 v216, v239, v203 offset:96
    s_mov_b64 exec, s[38:39]
    v_pk_fma_f32 v[84:85], v[148:149], v[220:221], v[84:85]
    v_pk_fma_f32 v[86:87], v[150:151], v[222:223], v[86:87]
    v_pk_fma_f32 v[88:89], v[152:153], v[224:225], v[88:89]
    v_pk_fma_f32 v[90:91], v[154:155], v[226:227], v[90:91]
    v_pk_fma_f32 v[228:229], v[84:85], v[116:117], v[228:229]
    v_pk_fma_f32 v[230:231], v[86:87], v[118:119], v[230:231]
    v_pk_fma_f32 v[228:229], v[88:89], v[120:121], v[228:229]
    v_pk_fma_f32 v[230:231], v[90:91], v[122:123], v[230:231]
    v_mfma_f32_32x32x8_bf16 v[140:155], v[40:41], v[208:209], v[44:59]
    v_exp_f32 v220, v156
    v_exp_f32 v221, v157
    v_exp_f32 v222, v158
    v_exp_f32 v223, v159
    v_mfma_f32_32x32x16_bf16 v[140:155], v[32:35], v[188:191], v[140:155]
    v_exp_f32 v224, v160
    v_exp_f32 v225, v161
    v_exp_f32 v226, v162
    v_exp_f32 v227, v163
    v_pk_add_f32 v[220:221], v[220:221], 1.0 op_sel_hi:[1,0]
    v_pk_add_f32 v[222:223], v[222:223], 1.0 op_sel_hi:[1,0]
    v_mfma_f32_32x32x16_bf16 v[140:155], v[0:3], v[172:175], v[140:155]
    v_pk_add_f32 v[224:225], v[224:225], 1.0 op_sel_hi:[1,0]
    v_pk_add_f32 v[226:227], v[226:227], 1.0 op_sel_hi:[1,0]
    v_rcp_f32 v220, v220
    v_rcp_f32 v221, v221
    v_rcp_f32 v222, v222
    v_rcp_f32 v223, v223
    v_mfma_f32_32x32x16_bf16 v[140:155], v[4:7], v[176:179], v[140:155]
    v_rcp_f32 v224, v224
    v_rcp_f32 v225, v225
    v_rcp_f32 v226, v226
    v_rcp_f32 v227, v227
    v_pk_fma_f32 v[92:93], v[156:157], v[220:221], v[92:93]
    v_pk_fma_f32 v[94:95], v[158:159], v[222:223], v[94:95]
    v_mfma_f32_32x32x16_bf16 v[140:155], v[8:11], v[180:183], v[140:155]
    v_pk_fma_f32 v[96:97], v[160:161], v[224:225], v[96:97]
    v_pk_fma_f32 v[98:99], v[162:163], v[226:227], v[98:99]
    v_pk_fma_f32 v[228:229], v[92:93], v[124:125], v[228:229]
    v_pk_fma_f32 v[230:231], v[94:95], v[126:127], v[230:231]
    v_pk_fma_f32 v[228:229], v[96:97], v[128:129], v[228:229]
    v_pk_fma_f32 v[230:231], v[98:99], v[130:131], v[230:231]
    v_exp_f32 v220, v164
    v_exp_f32 v221, v165
    v_mfma_f32_32x32x16_bf16 v[140:155], v[12:15], v[184:187], v[140:155]
    v_exp_f32 v222, v166
    v_exp_f32 v223, v167
    v_exp_f32 v224, v168
    v_exp_f32 v225, v169
    v_exp_f32 v226, v170
    v_exp_f32 v227, v171
    v_pk_add_f32 v[220:221], v[220:221], 1.0 op_sel_hi:[1,0]
    v_pk_add_f32 v[222:223], v[222:223], 1.0 op_sel_hi:[1,0]
    v_pk_add_f32 v[224:225], v[224:225], 1.0 op_sel_hi:[1,0]
    v_pk_add_f32 v[226:227], v[226:227], 1.0 op_sel_hi:[1,0]
    v_rcp_f32 v220, v220
    v_rcp_f32 v221, v221
    v_rcp_f32 v222, v222
    v_rcp_f32 v223, v223
    v_rcp_f32 v224, v224
    v_rcp_f32 v225, v225
    v_rcp_f32 v226, v226
    v_rcp_f32 v227, v227
    v_pk_fma_f32 v[100:101], v[164:165], v[220:221], v[100:101]
    v_pk_fma_f32 v[102:103], v[166:167], v[222:223], v[102:103]
    v_pk_fma_f32 v[104:105], v[168:169], v[224:225], v[104:105]
    v_pk_fma_f32 v[106:107], v[170:171], v[226:227], v[106:107]
    v_pk_fma_f32 v[228:229], v[100:101], v[132:133], v[228:229]
    v_pk_fma_f32 v[230:231], v[102:103], v[134:135], v[230:231]
    v_pk_fma_f32 v[228:229], v[104:105], v[136:137], v[228:229]
    v_pk_fma_f32 v[230:231], v[106:107], v[138:139], v[230:231]
    v_pk_add_f32 v[228:229], v[228:229], v[230:231]
    s_cmp_eq_u64 s[28:29], 0
    v_add_f32 v247, v228, v229
    v_sub_f32 v248, v247, v243
    v_pk_fma_f32 v[244:245], v[236:237], v[248:249], v[244:245] op_sel_hi:[1,0,1]
    v_fmac_f32 v246, v238, v248
    s_mov_b64 exec, -1
    s_cbranch_scc0 K2_LOOP
K2_DONE:
    v_and_b32 v203, 63, v250
    s_or_b32 s95, s7, s93
    s_cselect_b32 s97, 3, s97
    s_cmp_gt_u32 s97, 2
    v_lshlrev_b32 v203, 4, v203
    s_cbranch_scc1 K2_SLOW
    v_bfe_u32 v220, v249, 1, 3
    v_lshlrev_b32 v220, 4, v220
    v_lshlrev_b32 v221, 2, v219
    v_xor_b32 v220, v220, v221
    v_lshl_add_u32 v220, v249, 7, v220
    v_add_u32 v220, 100352, v220
    v_xor_b32 v221, 16, v220
    v_xor_b32 v222, 32, v220
    v_xor_b32 v223, 48, v220
    ds_read_b128 v[172:175], v220
    ds_read_b128 v[176:179], v221
    ds_read_b128 v[180:183], v222
    ds_read_b128 v[184:187], v223
    v_add_u32 v220, 125952, v203
    v_cmp_eq_u32_e64 s[46:47], 16, v206
    v_cmp_eq_u32_e64 s[44:45], 8, v206
    v_add_u32 v218, s4, v249
    ds_read_b128 v[0:3], v220 offset:32768
    ds_read_b128 v[4:7], v220 offset:33792
    ds_read_b128 v[8:11], v220 offset:34816
    ds_read_b128 v[12:15], v220 offset:35840
    ds_read_b128 v[16:19], v220 offset:0
    ds_read_b128 v[20:23], v220 offset:1024
    ds_read_b128 v[24:27], v220 offset:2048
    ds_read_b128 v[28:31], v220 offset:3072
    ds_read_b128 v[44:47], v220 offset:4096
    ds_read_b128 v[48:51], v220 offset:5120
    ds_read_b128 v[52:55], v220 offset:6144
    ds_read_b128 v[56:59], v220 offset:7168
    ds_read_b128 v[60:63], v220 offset:8192
    ds_read_b128 v[64:67], v220 offset:9216
    ds_read_b128 v[68:71], v220 offset:10240
    ds_read_b128 v[72:75], v220 offset:11264
    s_mov_b64 exec, s[46:47]
    s_and_b32 s46, s46, 0x55555555
    s_or_b32 s44, s44, s46
    s_mov_b32 s98, s94
    v_add_f32_dpp v244, v244, v244 quad_perm:[1,0,3,2] row_mask:0xf bank_mask:0xf
    v_add_f32_dpp v245, v245, v245 quad_perm:[1,0,3,2] row_mask:0xf bank_mask:0xf
    v_add_f32_dpp v246, v246, v246 quad_perm:[1,0,3,2] row_mask:0xf bank_mask:0xf
    v_add_f32_dpp v76, v76, v76 quad_perm:[1,0,3,2] row_mask:0xf bank_mask:0xf
    v_add_f32_dpp v77, v77, v77 quad_perm:[1,0,3,2] row_mask:0xf bank_mask:0xf
    v_add_f32_dpp v78, v78, v78 quad_perm:[1,0,3,2] row_mask:0xf bank_mask:0xf
    v_add_f32_dpp v79, v79, v79 quad_perm:[1,0,3,2] row_mask:0xf bank_mask:0xf
    v_add_f32_dpp v80, v80, v80 quad_perm:[1,0,3,2] row_mask:0xf bank_mask:0xf
    v_add_f32_dpp v81, v81, v81 quad_perm:[1,0,3,2] row_mask:0xf bank_mask:0xf
    v_add_f32_dpp v82, v82, v82 quad_perm:[1,0,3,2] row_mask:0xf bank_mask:0xf
    v_add_f32_dpp v83, v83, v83 quad_perm:[1,0,3,2] row_mask:0xf bank_mask:0xf
    v_add_f32_dpp v84, v84, v84 quad_perm:[1,0,3,2] row_mask:0xf bank_mask:0xf
    v_add_f32_dpp v85, v85, v85 quad_perm:[1,0,3,2] row_mask:0xf bank_mask:0xf
    v_add_f32_dpp v86, v86, v86 quad_perm:[1,0,3,2] row_mask:0xf bank_mask:0xf
    v_add_f32_dpp v87, v87, v87 quad_perm:[1,0,3,2] row_mask:0xf bank_mask:0xf
    v_add_f32_dpp v88, v88, v88 quad_perm:[1,0,3,2] row_mask:0xf bank_mask:0xf
    v_add_f32_dpp v89, v89, v89 quad_perm:[1,0,3,2] row_mask:0xf bank_mask:0xf
    v_add_f32_dpp v90, v90, v90 quad_perm:[1,0,3,2] row_mask:0xf bank_mask:0xf
    v_add_f32_dpp v91, v91, v91 quad_perm:[1,0,3,2] row_mask:0xf bank_mask:0xf
    v_add_f32_dpp v92, v92, v92 quad_perm:[1,0,3,2] row_mask:0xf bank_mask:0xf
    v_add_f32_dpp v93, v93, v93 quad_perm:[1,0,3,2] row_mask:0xf bank_mask:0xf
    v_add_f32_dpp v94, v94, v94 quad_perm:[1,0,3,2] row_mask:0xf bank_mask:0xf
    v_add_f32_dpp v95, v95, v95 quad_perm:[1,0,3,2] row_mask:0xf bank_mask:0xf
    v_add_f32_dpp v96, v96, v96 quad_perm:[1,0,3,2] row_mask:0xf bank_mask:0xf
    v_add_f32_dpp v97, v97, v97 quad_perm:[1,0,3,2] row_mask:0xf bank_mask:0xf
    v_add_f32_dpp v98, v98, v98 quad_perm:[1,0,3,2] row_mask:0xf bank_mask:0xf
    v_add_f32_dpp v99, v99, v99 quad_perm:[1,0,3,2] row_mask:0xf bank_mask:0xf
    v_add_f32_dpp v100, v100, v100 quad_perm:[1,0,3,2] row_mask:0xf bank_mask:0xf
    v_add_f32_dpp v101, v101, v101 quad_perm:[1,0,3,2] row_mask:0xf bank_mask:0xf
    v_add_f32_dpp v102, v102, v102 quad_perm:[1,0,3,2] row_mask:0xf bank_mask:0xf
    v_add_f32_dpp v103, v103, v103 quad_perm:[1,0,3,2] row_mask:0xf bank_mask:0xf
    v_add_f32_dpp v104, v104, v104 quad_perm:[1,0,3,2] row_mask:0xf bank_mask:0xf
    v_add_f32_dpp v105, v105, v105 quad_perm:[1,0,3,2] row_mask:0xf bank_mask:0xf
    v_add_f32_dpp v106, v106, v106 quad_perm:[1,0,3,2] row_mask:0xf bank_mask:0xf
    v_add_f32_dpp v107, v107, v107 quad_perm:[1,0,3,2] row_mask:0xf bank_mask:0xf
    s_mov_b64 exec, -1
    v_mov_b32 v224, v244
    v_mov_b32 v225, v245
    v_mov_b32 v226, v246
    s_nop 1
    v_permlane32_swap_b32 v224, v244
    v_permlane32_swap_b32 v225, v245
    v_permlane32_swap_b32 v226, v246
    s_nop 1
    v_add_f32 v244, v244, v224
    v_add_f32 v245, v245, v225
    v_add_f32 v246, v246, v226
    s_branch K2_TAIL
K2_EMPTY:
    s_waitcnt vmcnt(0) lgkmcnt(0)
    v_mov_b32 v244, 0
    v_mov_b32 v245, 0
    v_mov_b32 v246, 0
    v_mov_b32 v76, 0
    v_mov_b32 v77, 0
    v_mov_b32 v78, 0
    v_mov_b32 v79, 0
    v_mov_b32 v80, 0
    v_mov_b32 v81, 0
    v_mov_b32 v82, 0
    v_mov_b32 v83, 0
    v_mov_b32 v84, 0
    v_mov_b32 v85, 0
    v_mov_b32 v86, 0
    v_mov_b32 v87, 0
    v_mov_b32 v88, 0
    v_mov_b32 v89, 0
    v_mov_b32 v90, 0
    v_mov_b32 v91, 0
    v_mov_b32 v92, 0
    v_mov_b32 v93, 0
    v_mov_b32 v94, 0
    v_mov_b32 v95, 0
    v_mov_b32 v96, 0
    v_mov_b32 v97, 0
    v_mov_b32 v98, 0
    v_mov_b32 v99, 0
    v_mov_b32 v100, 0
    v_mov_b32 v101, 0
    v_mov_b32 v102, 0
    v_mov_b32 v103, 0
    v_mov_b32 v104, 0
    v_mov_b32 v105, 0
    v_mov_b32 v106, 0
    v_mov_b32 v107, 0
    v_mov_b32 v242, v241
    v_and_b32 v241, 0xffff0000, v240
    v_lshlrev_b32 v240, 16, v240
    s_branch K2_DONE
K2_SLOW:
    v_and_b32 v223, 31, v250
    v_lshlrev_b32 v220, 2, v219
    v_xor_b32 v220, v220, v251
    v_lshl_add_u32 v220, v219, 11, v220
    s_lshl_b32 s95, s100, 10
    s_add_u32 s95, s95, 129024
    v_lshl_add_u32 v221, v223, 5, v219
    v_add_u32 v221, s95, v221
    s_lshl_b32 s95, s5, 5
    v_add_u32 v223, s95, v223
    v_add_u32 v218, s4, v223
    v_min_u32 v222, 49999, v218
    s_waitcnt vmcnt(0)
    buffer_load_dwordx2 v[240:241], v222, s[16:19], 0 idxen
    v_xor_b32 v222, 0, v220
    ds_write_b128 v222, v[76:79]
    v_xor_b32 v222, 16, v220
    ds_write_b128 v222, v[80:83]
    v_xor_b32 v222, 32, v220
    ds_write_b128 v222, v[84:87]
    v_xor_b32 v222, 48, v220
    ds_write_b128 v222, v[88:91]
    v_xor_b32 v222, 64, v220
    ds_write_b128 v222, v[92:95]
    v_xor_b32 v222, 80, v220
    ds_write_b128 v222, v[96:99]
    v_xor_b32 v222, 96, v220
    ds_write_b128 v222, v[100:103]
    v_xor_b32 v222, 112, v220
    ds_write_b128 v222, v[104:107]
    ds_write_b128 v221, v[244:247]
    v_lshlrev_b32 v220, 2, v223
    ds_read_b32 v235, v220 offset:32768
    s_sub_u32 s99, s101, s94
    v_add_u32 v251, s99, v251
    v_add_u32 v252, s99, v252
    v_add_u32 v253, s99, v253
    v_add_u32 v254, s99, v254
    ds_read_b128 v[172:175], v251 offset:0
    ds_read_b128 v[176:179], v252 offset:0
    ds_read_b128 v[180:183], v253 offset:0
    ds_read_b128 v[184:187], v254 offset:0
    v_mov_b32 v76, 0
    v_mov_b32 v77, 0
    v_mov_b32 v78, 0
    v_mov_b32 v79, 0
    v_mov_b32 v80, 0
    v_mov_b32 v81, 0
    v_mov_b32 v82, 0
    v_mov_b32 v83, 0
    v_mov_b32 v84, 0
    v_mov_b32 v85, 0
    v_mov_b32 v86, 0
    v_mov_b32 v87, 0
    v_mov_b32 v88, 0
    v_mov_b32 v89, 0
    v_mov_b32 v90, 0
    v_mov_b32 v91, 0
    v_mov_b32 v92, 0
    v_mov_b32 v93, 0
    v_mov_b32 v94, 0
    v_mov_b32 v95, 0
    v_mov_b32 v96, 0
    v_mov_b32 v97, 0
    v_mov_b32 v98, 0
    v_mov_b32 v99, 0
    v_mov_b32 v100, 0
    v_mov_b32 v101, 0
    v_mov_b32 v102, 0
    v_mov_b32 v103, 0
    v_mov_b32 v104, 0
    v_mov_b32 v105, 0
    v_mov_b32 v106, 0
    v_mov_b32 v107, 0
    v_mov_b32 v244, 0
    v_mov_b32 v245, 0
    v_mov_b32 v246, 0
    s_lshl_b32 s99, s3, 8
    v_add_u32 v249, s99, v223
    v_mul_u32_u24 v249, 272, v249
    v_lshl_add_u32 v243, v219, 3, v249
    s_mov_b32 s99, 7602176
    s_cmp_eq_u32 s7, 0
    s_cbranch_scc1 K2_NOLD
    buffer_load_dwordx4 v[76:79], v243, s[20:23], s99 offen offset:0 sc0 sc1
    buffer_load_dwordx4 v[80:83], v243, s[20:23], s99 offen offset:16 sc0 sc1
    buffer_load_dwordx4 v[84:87], v243, s[20:23], s99 offen offset:32 sc0 sc1
    buffer_load_dwordx4 v[88:91], v243, s[20:23], s99 offen offset:48 sc0 sc1
    buffer_load_dwordx4 v[92:95], v243, s[20:23], s99 offen offset:64 sc0 sc1
    buffer_load_dwordx4 v[96:99], v243, s[20:23], s99 offen offset:80 sc0 sc1
    buffer_load_dwordx4 v[100:103], v243, s[20:23], s99 offen offset:96 sc0 sc1
    buffer_load_dwordx4 v[104:107], v243, s[20:23], s99 offen offset:112 sc0 sc1
    buffer_load_dwordx3 v[244:246], v249, s[20:23], s99 offen offset:256 sc0 sc1
    s_waitcnt vmcnt(0)
K2_NOLD:
    s_waitcnt lgkmcnt(0)
    v_and_b32 v207, 0xffff, v235
    v_lshrrev_b32 v235, 16, v235
    v_lshlrev_b32 v247, 11, v219
    v_add_u32 v247, 34816, v247
    v_add_u32 v220, 138240, v203
    v_cmp_lt_u32 vcc, 0, v235
    s_barrier
    s_cbranch_vccz K2_GDONE
K2_GLOOP:
    s_mov_b64 exec, vcc
    v_bfe_u32 v221, v207, 3, 3
    v_lshlrev_b32 v221, 4, v221
    v_lshl_add_u32 v221, v207, 5, v221
    v_add_u32 v221, v247, v221
    v_xor_b32 v222, 0, v221
    ds_read_b128 v[140:143], v222
    v_xor_b32 v222, 16, v221
    ds_read_b128 v[144:147], v222
    v_xor_b32 v222, 32, v221
    ds_read_b128 v[148:151], v222
    v_xor_b32 v222, 48, v221
    ds_read_b128 v[152:155], v222
    v_xor_b32 v222, 64, v221
    ds_read_b128 v[156:159], v222
    v_xor_b32 v222, 80, v221
    ds_read_b128 v[160:163], v222
    v_xor_b32 v222, 96, v221
    ds_read_b128 v[164:167], v222
    v_xor_b32 v222, 112, v221
    ds_read_b128 v[168:171], v222
    v_lshlrev_b32 v222, 3, v207
    v_add_u32 v222, 129024, v222
    ds_read_b128 v[188:191], v222
    ds_read_b128 v[192:195], v222 offset:16
    v_add_u32 v207, 4, v207
    v_subrev_u32 v235, 1, v235
    v_cmp_lt_u32 vcc, 0, v235
    s_waitcnt lgkmcnt(9)
    v_pk_add_f32 v[76:77], v[76:77], v[140:141]
    v_pk_add_f32 v[78:79], v[78:79], v[142:143]
    s_waitcnt lgkmcnt(8)
    v_pk_add_f32 v[80:81], v[80:81], v[144:145]
    v_pk_add_f32 v[82:83], v[82:83], v[146:147]
    s_waitcnt lgkmcnt(7)
    v_pk_add_f32 v[84:85], v[84:85], v[148:149]
    v_pk_add_f32 v[86:87], v[86:87], v[150:151]
    s_waitcnt lgkmcnt(6)
    v_pk_add_f32 v[88:89], v[88:89], v[152:153]
    v_pk_add_f32 v[90:91], v[90:91], v[154:155]
    s_waitcnt lgkmcnt(5)
    v_pk_add_f32 v[92:93], v[92:93], v[156:157]
    v_pk_add_f32 v[94:95], v[94:95], v[158:159]
    s_waitcnt lgkmcnt(4)
    v_pk_add_f32 v[96:97], v[96:97], v[160:161]
    v_pk_add_f32 v[98:99], v[98:99], v[162:163]
    s_waitcnt lgkmcnt(3)
    v_pk_add_f32 v[100:101], v[100:101], v[164:165]
    v_pk_add_f32 v[102:103], v[102:103], v[166:167]
    s_waitcnt lgkmcnt(2)
    v_pk_add_f32 v[104:105], v[104:105], v[168:169]
    v_pk_add_f32 v[106:107], v[106:107], v[170:171]
    s_waitcnt lgkmcnt(0)
    v_pk_add_f32 v[244:245], v[244:245], v[188:189]
    v_add_f32 v246, v246, v190
    v_pk_add_f32 v[244:245], v[244:245], v[192:193]
    v_add_f32 v246, v246, v194
    s_cbranch_vccnz K2_GLOOP
    s_mov_b64 exec, -1
K2_GDONE:
    s_cmp_eq_u32 s93, 0
    s_cbranch_scc1 K2_EPI
    buffer_store_dwordx4 v[76:79], v243, s[20:23], s99 offen offset:0
    buffer_store_dwordx4 v[80:83], v243, s[20:23], s99 offen offset:16
    buffer_store_dwordx4 v[84:87], v243, s[20:23], s99 offen offset:32
    buffer_store_dwordx4 v[88:91], v243, s[20:23], s99 offen offset:48
    buffer_store_dwordx4 v[92:95], v243, s[20:23], s99 offen offset:64
    buffer_store_dwordx4 v[96:99], v243, s[20:23], s99 offen offset:80
    buffer_store_dwordx4 v[100:103], v243, s[20:23], s99 offen offset:96
    buffer_store_dwordx4 v[104:107], v243, s[20:23], s99 offen offset:112
    buffer_store_dwordx3 v[244:246], v249, s[20:23], s99 offen offset:256
    s_add_u32 s7, s7, s92
    s_waitcnt vmcnt(0)
    s_barrier
    s_branch K2_TOP
K2_EPI:
    s_cmp_ge_u32 s5, 6
    s_cbranch_scc1 K2_NWH2
    s_mul_i32 s95, s5, 2048
    s_add_u32 m0, s95, 138240
    s_add_u32 s95, s95, 7561216
    buffer_load_dwordx4 v203, s[20:23], s95 offen offset:0 lds
    buffer_load_dwordx4 v203, s[20:23], s95 offen offset:1024 lds
K2_NWH2:
    s_lshl_b32 s95, s5, 5
    s_cmp_ge_u32 s95, s96
    s_waitcnt vmcnt(0)
    s_barrier
    s_cbranch_scc1 K2_END0
    ds_read_b128 v[0:3], v220 offset:20480
    ds_read_b128 v[4:7], v220 offset:21504
    ds_read_b128 v[8:11], v220 offset:22528
    ds_read_b128 v[12:15], v220 offset:23552
    ds_read_b128 v[16:19], v220 offset:0
    ds_read_b128 v[20:23], v220 offset:1024
    ds_read_b128 v[24:27], v220 offset:2048
    ds_read_b128 v[28:31], v220 offset:3072
    ds_read_b128 v[44:47], v220 offset:4096
    ds_read_b128 v[48:51], v220 offset:5120
    ds_read_b128 v[52:55], v220 offset:6144
    ds_read_b128 v[56:59], v220 offset:7168
    ds_read_b128 v[60:63], v220 offset:8192
    ds_read_b128 v[64:67], v220 offset:9216
    ds_read_b128 v[68:71], v220 offset:10240
    ds_read_b128 v[72:75], v220 offset:11264
    v_cmp_gt_u32_e64 s[44:45], s96, v223
    s_mov_b32 s98, s101
    s_waitcnt vmcnt(0)
    v_mov_b32 v242, v241
    v_and_b32 v241, 0xffff0000, v240
    v_lshlrev_b32 v240, 16, v240
K2_TAIL:
    v_add_u32 v235, s98, v203
    v_lshlrev_b32 v203, 7, v218
    v_cndmask_b32_e64 v203, 2.0, v203, s[44:45]
    s_waitcnt lgkmcnt(8)
    v_mfma_f32_32x32x16_bf16 v[140:155], v[0:3], v[172:175], 0
    v_cvt_pk_bf16_f32 v108, v76, v77
    v_cvt_pk_bf16_f32 v109, v78, v79
    v_mfma_f32_32x32x16_bf16 v[156:171], v[16:19], v[172:175], 0
    v_cvt_pk_bf16_f32 v110, v80, v81
    v_cvt_pk_bf16_f32 v111, v82, v83
    v_mfma_f32_32x32x16_bf16 v[140:155], v[4:7], v[176:179], v[140:155]
    v_cvt_pk_bf16_f32 v112, v84, v85
    v_cvt_pk_bf16_f32 v113, v86, v87
    v_mfma_f32_32x32x16_bf16 v[156:171], v[20:23], v[176:179], v[156:171]
    v_cvt_pk_bf16_f32 v114, v88, v89
    v_cvt_pk_bf16_f32 v115, v90, v91
    v_mfma_f32_32x32x16_bf16 v[140:155], v[8:11], v[180:183], v[140:155]
    v_cvt_pk_bf16_f32 v116, v92, v93
    v_cvt_pk_bf16_f32 v117, v94, v95
    v_mfma_f32_32x32x16_bf16 v[156:171], v[24:27], v[180:183], v[156:171]
    v_cvt_pk_bf16_f32 v118, v96, v97
    v_cvt_pk_bf16_f32 v119, v98, v99
    v_mfma_f32_32x32x16_bf16 v[140:155], v[12:15], v[184:187], v[140:155]
    v_cvt_pk_bf16_f32 v120, v100, v101
    v_cvt_pk_bf16_f32 v121, v102, v103
    v_mfma_f32_32x32x16_bf16 v[156:171], v[28:31], v[184:187], v[156:171]
    v_cvt_pk_bf16_f32 v122, v104, v105
    v_cvt_pk_bf16_f32 v123, v106, v107
    s_waitcnt lgkmcnt(0)
    ds_bpermute_b32 v210, v239, v203 offset:0
    ds_bpermute_b32 v212, v239, v203 offset:32
    ds_bpermute_b32 v214, v239, v203 offset:64
    ds_bpermute_b32 v216, v239, v203 offset:96
    v_mfma_f32_32x32x16_bf16 v[140:155], v[44:47], v[108:111], v[140:155]
    v_lshlrev_b32 v76, 16, v172
    v_and_b32 v77, 0xffff0000, v172
    v_lshlrev_b32 v78, 16, v173
    v_and_b32 v79, 0xffff0000, v173
    v_lshlrev_b32 v80, 16, v174
    v_and_b32 v81, 0xffff0000, v174
    v_lshlrev_b32 v82, 16, v175
    v_and_b32 v83, 0xffff0000, v175
    v_mfma_f32_32x32x16_bf16 v[140:155], v[48:51], v[112:115], v[140:155]
    v_lshlrev_b32 v84, 16, v176
    v_and_b32 v85, 0xffff0000, v176
    v_lshlrev_b32 v86, 16, v177
    v_and_b32 v87, 0xffff0000, v177
    v_lshlrev_b32 v88, 16, v178
    v_and_b32 v89, 0xffff0000, v178
    v_lshlrev_b32 v90, 16, v179
    v_and_b32 v91, 0xffff0000, v179
    v_mfma_f32_32x32x16_bf16 v[140:155], v[52:55], v[116:119], v[140:155]
    v_lshlrev_b32 v92, 16, v180
    v_and_b32 v93, 0xffff0000, v180
    v_lshlrev_b32 v94, 16, v181
    v_and_b32 v95, 0xffff0000, v181
    v_lshlrev_b32 v96, 16, v182
    v_and_b32 v97, 0xffff0000, v182
    v_lshlrev_b32 v98, 16, v183
    v_and_b32 v99, 0xffff0000, v183
    v_mfma_f32_32x32x16_bf16 v[140:155], v[56:59], v[120:123], v[140:155]
    v_lshlrev_b32 v100, 16, v184
    v_and_b32 v101, 0xffff0000, v184
    v_lshlrev_b32 v102, 16, v185
    v_and_b32 v103, 0xffff0000, v185
    v_lshlrev_b32 v104, 16, v186
    v_and_b32 v105, 0xffff0000, v186
    v_lshlrev_b32 v106, 16, v187
    v_and_b32 v107, 0xffff0000, v187
    v_mfma_f32_32x32x16_bf16 v[156:171], v[60:63], v[108:111], v[156:171]
    v_mov_b32 v243, 0
    v_pk_add_f32 v[244:245], v[244:245], v[240:241]
    v_add_f32 v246, v246, v242
    v_cvt_pk_bf16_f32 v244, v244, v245
    v_cvt_pk_bf16_f32 v246, v246, v246
    s_mov_b32 exec_lo, s44
    s_mov_b32 exec_hi, 0
    s_cmp_eq_u32 s98, s94
    s_cbranch_scc1 K2_PF
    v_mul_u32_u24 v220, 6, v218
    s_mov_b32 s99, 6400000
    buffer_store_short v244, v220, s[24:27], s99 offen
    buffer_store_short_d16_hi v244, v220, s[24:27], s99 offen offset:2
    buffer_store_short v246, v220, s[24:27], s99 offen offset:4
    s_branch K2_PD
K2_PF:
    s_mov_b32 s99, 32768
    v_mad_u32_u24 v220, v249, 6, s99
    ds_write_b16 v220, v244
    ds_write_b16_d16_hi v220, v244 offset:2
    ds_write_b16 v220, v246 offset:4
    s_mov_b64 exec, 1
    v_mov_b32 v220, 108
    v_mov_b32 v221, 1
    ds_add_rtn_u32 v243, v220, v221
K2_PD:
    s_mov_b64 exec, -1
    s_mov_b32 s40, 0xbf317218
    s_mov_b32 s41, 0xbf317218
    v_mfma_f32_32x32x16_bf16 v[156:171], v[64:67], v[112:115], v[156:171]
    v_exp_f32 v220, v140
    v_exp_f32 v221, v141
    v_exp_f32 v222, v142
    v_exp_f32 v223, v143
    v_mfma_f32_32x32x16_bf16 v[156:171], v[68:71], v[116:119], v[156:171]
    v_exp_f32 v224, v144
    v_exp_f32 v225, v145
    v_exp_f32 v226, v146
    v_exp_f32 v227, v147
    v_pk_add_f32 v[220:221], v[220:221], 1.0 op_sel_hi:[1,0]
    v_pk_add_f32 v[222:223], v[222:223], 1.0 op_sel_hi:[1,0]
    v_mfma_f32_32x32x16_bf16 v[156:171], v[72:75], v[120:123], v[156:171]
    v_pk_add_f32 v[224:225], v[224:225], 1.0 op_sel_hi:[1,0]
    v_pk_add_f32 v[226:227], v[226:227], 1.0 op_sel_hi:[1,0]
    v_rcp_f32 v220, v220
    v_rcp_f32 v221, v221
    v_rcp_f32 v222, v222
    v_rcp_f32 v223, v223
    v_rcp_f32 v224, v224
    v_rcp_f32 v225, v225
    v_rcp_f32 v226, v226
    v_rcp_f32 v227, v227
    s_waitcnt lgkmcnt(0)
    v_add_u32 v210, v210, v211
    v_add_u32 v212, v212, v213
    v_add_u32 v214, v214, v215
    v_add_u32 v216, v216, v217
    v_pk_mul_f32 v[220:221], v[220:221], v[140:141]
    v_pk_mul_f32 v[222:223], v[222:223], v[142:143]
    v_pk_mul_f32 v[224:225], v[224:225], v[144:145]
    v_pk_mul_f32 v[226:227], v[226:227], v[146:147]
    v_pk_fma_f32 v[220:221], v[220:221], s[40:41], v[76:77]
    v_pk_fma_f32 v[222:223], v[222:223], s[40:41], v[78:79]
    v_pk_fma_f32 v[224:225], v[224:225], s[40:41], v[80:81]
    v_pk_fma_f32 v[226:227], v[226:227], s[40:41], v[82:83]
    v_cvt_pk_bf16_f32 v172, v220, v221
    v_cvt_pk_bf16_f32 v173, v222, v223
    v_cvt_pk_bf16_f32 v174, v224, v225
    v_cvt_pk_bf16_f32 v175, v226, v227
    s_waitcnt vmcnt(0)
    ds_write_b128 v251, v[172:175]
    v_exp_f32 v220, v148
    v_exp_f32 v221, v149
    v_exp_f32 v222, v150
    v_exp_f32 v223, v151
    v_exp_f32 v224, v152
    v_exp_f32 v225, v153
    v_exp_f32 v226, v154
    v_exp_f32 v227, v155
    v_pk_add_f32 v[220:221], v[220:221], 1.0 op_sel_hi:[1,0]
    v_pk_add_f32 v[222:223], v[222:223], 1.0 op_sel_hi:[1,0]
    v_pk_add_f32 v[224:225], v[224:225], 1.0 op_sel_hi:[1,0]
    v_pk_add_f32 v[226:227], v[226:227], 1.0 op_sel_hi:[1,0]
    v_rcp_f32 v220, v220
    v_rcp_f32 v221, v221
    v_rcp_f32 v222, v222
    v_rcp_f32 v223, v223
    v_rcp_f32 v224, v224
    v_rcp_f32 v225, v225
    v_rcp_f32 v226, v226
    v_rcp_f32 v227, v227
    v_pk_mul_f32 v[220:221], v[220:221], v[148:149]
    v_pk_mul_f32 v[222:223], v[222:223], v[150:151]
    v_pk_mul_f32 v[224:225], v[224:225], v[152:153]
    v_pk_mul_f32 v[226:227], v[226:227], v[154:155]
    v_pk_fma_f32 v[220:221], v[220:221], s[40:41], v[84:85]
    v_pk_fma_f32 v[222:223], v[222:223], s[40:41], v[86:87]
    v_pk_fma_f32 v[224:225], v[224:225], s[40:41], v[88:89]
    v_pk_fma_f32 v[226:227], v[226:227], s[40:41], v[90:91]
    v_cvt_pk_bf16_f32 v176, v220, v221
    v_cvt_pk_bf16_f32 v177, v222, v223
    v_cvt_pk_bf16_f32 v178, v224, v225
    v_cvt_pk_bf16_f32 v179, v226, v227
    ds_write_b128 v252, v[176:179]
    v_exp_f32 v220, v156
    v_exp_f32 v221, v157
    v_exp_f32 v222, v158
    v_exp_f32 v223, v159
    v_exp_f32 v224, v160
    v_exp_f32 v225, v161
    v_exp_f32 v226, v162
    v_exp_f32 v227, v163
    v_pk_add_f32 v[220:221], v[220:221], 1.0 op_sel_hi:[1,0]
    v_pk_add_f32 v[222:223], v[222:223], 1.0 op_sel_hi:[1,0]
    v_pk_add_f32 v[224:225], v[224:225], 1.0 op_sel_hi:[1,0]
    v_pk_add_f32 v[226:227], v[226:227], 1.0 op_sel_hi:[1,0]
    v_rcp_f32 v220, v220
    v_rcp_f32 v221, v221
    v_rcp_f32 v222, v222
    v_rcp_f32 v223, v223
    v_rcp_f32 v224, v224
    v_rcp_f32 v225, v225
    v_rcp_f32 v226, v226
    v_rcp_f32 v227, v227
    v_pk_mul_f32 v[220:221], v[220:221], v[156:157]
    v_pk_mul_f32 v[222:223], v[222:223], v[158:159]
    v_pk_mul_f32 v[224:225], v[224:225], v[160:161]
    v_pk_mul_f32 v[226:227], v[226:227], v[162:163]
    v_pk_fma_f32 v[220:221], v[220:221], s[40:41], v[92:93]
    v_pk_fma_f32 v[222:223], v[222:223], s[40:41], v[94:95]
    v_pk_fma_f32 v[224:225], v[224:225], s[40:41], v[96:97]
    v_pk_fma_f32 v[226:227], v[226:227], s[40:41], v[98:99]
    v_cvt_pk_bf16_f32 v180, v220, v221
    v_cvt_pk_bf16_f32 v181, v222, v223
    v_cvt_pk_bf16_f32 v182, v224, v225
    v_cvt_pk_bf16_f32 v183, v226, v227
    ds_write_b128 v253, v[180:183]
    v_exp_f32 v220, v164
    v_exp_f32 v221, v165
    v_exp_f32 v222, v166
    v_exp_f32 v223, v167
    v_exp_f32 v224, v168
    v_exp_f32 v225, v169
    v_exp_f32 v226, v170
    v_exp_f32 v227, v171
    v_pk_add_f32 v[220:221], v[220:221], 1.0 op_sel_hi:[1,0]
    v_pk_add_f32 v[222:223], v[222:223], 1.0 op_sel_hi:[1,0]
    v_pk_add_f32 v[224:225], v[224:225], 1.0 op_sel_hi:[1,0]
    v_pk_add_f32 v[226:227], v[226:227], 1.0 op_sel_hi:[1,0]
    v_rcp_f32 v220, v220
    v_rcp_f32 v221, v221
    v_rcp_f32 v222, v222
    v_rcp_f32 v223, v223
    v_rcp_f32 v224, v224
    v_rcp_f32 v225, v225
    v_rcp_f32 v226, v226
    v_rcp_f32 v227, v227
    v_pk_mul_f32 v[220:221], v[220:221], v[164:165]
    v_pk_mul_f32 v[222:223], v[222:223], v[166:167]
    v_pk_mul_f32 v[224:225], v[224:225], v[168:169]
    v_pk_mul_f32 v[226:227], v[226:227], v[170:171]
    v_pk_fma_f32 v[220:221], v[220:221], s[40:41], v[100:101]
    v_pk_fma_f32 v[222:223], v[222:223], s[40:41], v[102:103]
    v_pk_fma_f32 v[224:225], v[224:225], s[40:41], v[104:105]
    v_pk_fma_f32 v[226:227], v[226:227], s[40:41], v[106:107]
    v_cvt_pk_bf16_f32 v184, v220, v221
    v_cvt_pk_bf16_f32 v185, v222, v223
    v_cvt_pk_bf16_f32 v186, v224, v225
    v_cvt_pk_bf16_f32 v187, v226, v227
    ds_write_b128 v254, v[184:187]
    ds_read_b128 v[140:143], v235 offset:0
    ds_read_b128 v[144:147], v235 offset:1024
    ds_read_b128 v[148:151], v235 offset:2048
    ds_read_b128 v[152:155], v235 offset:3072
    s_waitcnt lgkmcnt(3)
    buffer_store_dwordx4 v[140:143], v210, s[24:27], 0 offen sc1
    s_waitcnt lgkmcnt(2)
    buffer_store_dwordx4 v[144:147], v212, s[24:27], 0 offen sc1
    s_waitcnt lgkmcnt(1)
    buffer_store_dwordx4 v[148:151], v214, s[24:27], 0 offen sc1
    s_waitcnt lgkmcnt(0)
    buffer_store_dwordx4 v[152:155], v216, s[24:27], 0 offen sc1
    v_readfirstlane_b32 s95, v243
    v_and_b32 v220, 63, v250
    v_lshlrev_b32 v220, 3, v220
    s_cmp_lg_u32 s95, 7
    s_cbranch_scc1 K2_PE
    ds_read_b64 v[188:189], v220 offset:32768
    ds_read_b64 v[190:191], v220 offset:33280
    ds_read_b64 v[192:193], v220 offset:33792
    s_mul_i32 s99, s4, 6
    s_add_u32 s99, s99, 6400000
    s_mul_i32 s95, s96, 6
    v_cmp_gt_i32 vcc, s95, v220
    s_sub_i32 s95, s95, 512
    s_waitcnt lgkmcnt(2)
    s_mov_b64 exec, vcc
    buffer_store_dwordx2 v[188:189], v220, s[24:27], s99 offen offset:0 sc1
    v_cmp_gt_i32 vcc, s95, v220
    s_sub_i32 s95, s95, 512
    s_waitcnt lgkmcnt(1)
    s_mov_b64 exec, vcc
    buffer_store_dwordx2 v[190:191], v220, s[24:27], s99 offen offset:512 sc1
    v_cmp_gt_i32 vcc, s95, v220
    s_sub_i32 s95, s95, 512
    s_waitcnt lgkmcnt(0)
    s_mov_b64 exec, vcc
    buffer_store_dwordx2 v[192:193], v220, s[24:27], s99 offen offset:1024 sc1
    s_mov_b64 exec, -1
K2_PE:
    s_endpgm
K2_END0:
    s_waitcnt vmcnt(0)
K2_END:
    s_endpgm
.section .rodata,"a"
.p2align 6
.amdhsa_kernel egnn_sort_kernel
  .amdhsa_next_free_vgpr 56
  .amdhsa_next_free_sgpr 48
  .amdhsa_accum_offset 56
  .amdhsa_group_segment_fixed_size 0
  .amdhsa_kernarg_size 88
  .amdhsa_user_sgpr_count 2
  .amdhsa_user_sgpr_kernarg_segment_ptr 1
  .amdhsa_system_sgpr_workgroup_id_x 1
.end_amdhsa_kernel
.p2align 6
.amdhsa_kernel egnn_main_kernel
  .amdhsa_next_free_vgpr 256
  .amdhsa_next_free_sgpr 102
  .amdhsa_accum_offset 256
  .amdhsa_group_segment_fixed_size 0
  .amdhsa_kernarg_size 88
  .amdhsa_user_sgpr_count 2
  .amdhsa_user_sgpr_kernarg_segment_ptr 1
  .amdhsa_system_sgpr_workgroup_id_x 1
.end_amdhsa_kernel
```

```asm
; @launch kernel=egnn_sort_kernel grid=(250,1,1) block=(896,1,1) lds=27904
; @launch kernel=egnn_main_kernel grid=(256,1,1) block=(512,1,1) lds=162816
.amdgcn_target "amdgcn-amd-amdhsa--gfx950"
.text
.globl egnn_sort_kernel
.p2align 8
.type egnn_sort_kernel,@function
egnn_sort_kernel:
    s_cmp_ge_u32 s2, 250
    s_cbranch_scc1 K1_END
    s_load_dwordx2 s[38:39], s[0:1], 80
    v_lshrrev_b32 v1, 6, v0
    s_nop 0
    v_readfirstlane_b32 s3, v1
    s_cmp_ge_u32 s3, 13
    s_cbranch_scc1 K1_FRAG
    s_load_dwordx4 s[4:7], s[0:1], 24
    s_load_dwordx4 s[8:11], s[0:1], 8
    s_and_b32 s28, s2, 7
    s_min_u32 s29, s28, 2
    s_mul_i32 s28, s28, 31
    s_lshr_b32 s2, s2, 3
    s_add_u32 s2, s2, s28
    s_add_u32 s2, s2, s29
    v_lshlrev_b32 v1, 2, v0
    v_mov_b32 v2, 0
    v_mov_b32 v3, 1
    v_cmp_gt_u32 vcc, 288, v0
    s_mov_b64 exec, vcc
    ds_write_b32 v1, v2 offset:0
    s_mov_b64 exec, -1
    s_mul_i32 s28, s2, 12800
    s_mul_i32 s29, s2, 200
    s_mul_i32 s30, s2, 3200
    s_mov_b32 s31, 85599
    s_movk_i32 s32, -196
    v_add_u32 v12, s29, v0
    v_mul_u32_u24 v13, 6, v12
    v_lshlrev_b32 v14, 4, v0
    v_mov_b32 v15, 800
    v_cmp_gt_u32 s[34:35], v15, v0
    v_mov_b32 v15, 200
    v_cmp_gt_u32 s[36:37], v15, v0
    s_waitcnt lgkmcnt(0)
    s_mov_b32 s12, s4
    s_and_b32 s13, s5, 0xffff
    s_mov_b32 s14, 3200000
    s_mov_b32 s15, 0x20000
    s_mov_b32 s16, s6
    s_and_b32 s17, s7, 0xffff
    s_mov_b32 s18, 3200000
    s_mov_b32 s19, 0x20000
    s_mov_b32 s20, s8
    s_and_b32 s21, s9, 0xffff
    s_mov_b32 s22, 300000
    s_mov_b32 s23, 0x20000
    s_mov_b32 s24, s38
    s_and_b32 s25, s39, 0xffff
    s_mov_b32 s26, 25600000
    s_mov_b32 s27, 0x20000
    s_cmp_ge_u32 s3, 4
    s_cbranch_scc1 K1_NOPOS
    s_mov_b64 exec, s[36:37]
    buffer_load_ushort v16, v13, s[20:23], 0 offen
    buffer_load_ushort v17, v13, s[20:23], 0 offen offset:2
    buffer_load_ushort v18, v13, s[20:23], 0 offen offset:4
K1_NOPOS:
    s_mov_b64 exec, s[34:35]
    buffer_load_dwordx4 v[4:7], v14, s[16:19], s28 offen nt
    v_add_u32 v20, s30, v1
    v_add_u32 v22, 1, v20
    v_add_u32 v24, 2, v20
    v_add_u32 v26, 3, v20
    s_barrier
    s_waitcnt vmcnt(0)
    buffer_load_dwordx4 v[8:11], v14, s[12:15], s28 offen nt
    v_mul_u32_u24 v28, s31, v4
    v_lshrrev_b32 v28, 24, v28
    v_mad_i32_i24 v4, v28, s32, v4
    v_lshlrev_b32 v28, 2, v28
    ds_add_rtn_u32 v32, v28, v3 offset:0
    v_mul_u32_u24 v29, s31, v5
    v_lshrrev_b32 v29, 24, v29
    v_mad_i32_i24 v5, v29, s32, v5
    v_lshlrev_b32 v29, 2, v29
    ds_add_rtn_u32 v33, v29, v3 offset:0
    v_mul_u32_u24 v30, s31, v6
    v_lshrrev_b32 v30, 24, v30
    v_mad_i32_i24 v6, v30, s32, v6
    v_lshlrev_b32 v30, 2, v30
    ds_add_rtn_u32 v34, v30, v3 offset:0
    v_mul_u32_u24 v31, s31, v7
    v_lshrrev_b32 v31, 24, v31
    v_mad_i32_i24 v7, v31, s32, v7
    v_lshlrev_b32 v31, 2, v31
    ds_add_rtn_u32 v35, v31, v3 offset:0
    s_cmp_ge_u32 s3, 4
    s_cbranch_scc1 K1_P3
    s_mov_b64 exec, s[36:37]
    v_lshl_or_b32 v16, v17, 16, v16
    v_lshlrev_b32 v17, 16, v18
    v_lshlrev_b32 v12, 3, v12
    s_mov_b32 s33, 6684672
    buffer_store_dwordx2 v[16:17], v12, s[24:27], s33 offen
    s_mov_b64 exec, s[34:35]
K1_P3:
    s_mov_b64 exec, -1
    v_and_b32 v2, 63, v0
    v_lshlrev_b32 v2, 4, v2
    s_waitcnt lgkmcnt(0)
    s_barrier
    ds_read_b128 v[36:39], v2 offset:0
    s_waitcnt lgkmcnt(0)
    v_add_u32 v42, v36, v37
    v_add_u32 v43, v42, v38
    v_add_u32 v44, v43, v39
    v_mov_b32 v45, v44
    s_nop 1
    v_add_u32_dpp v45, v45, v45 row_shr:1 row_mask:0xf bank_mask:0xf
    s_nop 1
    v_add_u32_dpp v45, v45, v45 row_shr:2 row_mask:0xf bank_mask:0xf
    s_nop 1
    v_add_u32_dpp v45, v45, v45 row_shr:4 row_mask:0xf bank_mask:0xf
    s_nop 1
    v_add_u32_dpp v45, v45, v45 row_shr:8 row_mask:0xf bank_mask:0xf
    s_nop 1
    v_add_u32_dpp v45, v45, v45 row_bcast:15 row_mask:0xa bank_mask:0xf
    s_nop 1
    v_add_u32_dpp v45, v45, v45 row_bcast:31 row_mask:0xc bank_mask:0xf
    v_sub_u32 v40, v45, v44
    v_add_u32 v41, v40, v36
    v_add_u32 v42, v40, v42
    v_add_u32 v43, v40, v43
    v_lshlrev_b32 v48, 3, v40
    v_lshlrev_b32 v49, 3, v41
    v_lshlrev_b32 v50, 3, v42
    v_lshlrev_b32 v51, 3, v43
    ds_write_b128 v2, v[48:51] offset:1280
    s_mov_b64 exec, s[34:35]
    ds_read_b32 v28, v28 offset:1280
    ds_read_b32 v29, v29 offset:1280
    ds_read_b32 v30, v30 offset:1280
    ds_read_b32 v31, v31 offset:1280
    s_cmp_ge_u32 s3, 4
    s_cbranch_scc1 K1_SW0
    s_waitcnt vmcnt(1)
    s_branch K1_SW1
K1_SW0:
    s_waitcnt vmcnt(0)
K1_SW1:
    v_mul_u32_u24 v21, 1342, v8
    v_lshrrev_b32 v21, 24, v21
    v_lshl_or_b32 v4, v4, 2, v21
    v_lshl_or_b32 v21, v4, 18, v8
    v_mul_u32_u24 v23, 1342, v9
    v_lshrrev_b32 v23, 24, v23
    v_lshl_or_b32 v5, v5, 2, v23
    v_lshl_or_b32 v23, v5, 18, v9
    v_mul_u32_u24 v25, 1342, v10
    v_lshrrev_b32 v25, 24, v25
    v_lshl_or_b32 v6, v6, 2, v25
    v_lshl_or_b32 v25, v6, 18, v10
    v_mul_u32_u24 v27, 1342, v11
    v_lshrrev_b32 v27, 24, v27
    v_lshl_or_b32 v7, v7, 2, v27
    v_lshl_or_b32 v27, v7, 18, v11
    s_cmp_lg_u32 s3, 12
    s_cbranch_scc1 K1_NOOFF
    s_mov_b64 exec, -1
    v_lshl_or_b32 v40, v36, 16, v40
    v_lshl_or_b32 v41, v37, 16, v41
    v_lshl_or_b32 v42, v38, 16, v42
    v_lshl_or_b32 v43, v39, 16, v43
    v_lshlrev_b32 v2, 8, v2
    s_lshl_b32 s33, s2, 4
    s_add_u32 s33, s33, 6422528
    buffer_store_dwordx4 v[40:43], v2, s[24:27], s33 offen
    s_mov_b64 exec, s[34:35]
K1_NOOFF:
    s_waitcnt lgkmcnt(3)
    v_lshl_add_u32 v28, v32, 3, v28
    ds_write_b64 v28, v[20:21] offset:2304
    s_waitcnt lgkmcnt(3)
    v_lshl_add_u32 v29, v33, 3, v29
    ds_write_b64 v29, v[22:23] offset:2304
    s_waitcnt lgkmcnt(3)
    v_lshl_add_u32 v30, v34, 3, v30
    ds_write_b64 v30, v[24:25] offset:2304
    s_waitcnt lgkmcnt(3)
    v_lshl_add_u32 v31, v35, 3, v31
    ds_write_b64 v31, v[26:27] offset:2304
    s_mul_i32 s33, s2, 25600
    s_add_u32 s38, s33, 12800
    s_waitcnt lgkmcnt(0)
    s_barrier
    ds_read_b128 v[4:7], v14 offset:2304
    ds_read_b128 v[8:11], v14 offset:15104
    s_waitcnt lgkmcnt(1)
    buffer_store_dwordx4 v[4:7], v14, s[24:27], s33 offen sc1
    s_waitcnt lgkmcnt(0)
    buffer_store_dwordx4 v[8:11], v14, s[24:27], s38 offen sc1
    s_endpgm
K1_FRAG:
    s_cmp_ge_u32 s2, 144
    s_cbranch_scc1 K1_END
    s_load_dwordx4 s[4:7], s[0:1], 40
    s_load_dwordx2 s[8:9], s[0:1], 56
    s_lshr_b32 s28, s2, 2
    s_and_b32 s3, s2, 3
    s_lshl_b32 s3, s3, 6
    v_and_b32 v1, 63, v0
    v_add_u32 v1, s3, v1
    v_lshlrev_b32 v10, 2, v1
    s_lshl_b32 s33, s28, 10
    s_add_u32 s33, s33, 7536640
    s_mov_b32 s34, 0xbfb8aa3b
    s_waitcnt lgkmcnt(0)
    s_mov_b32 s12, s4
    s_and_b32 s13, s5, 0xffff
    s_mov_b32 s14, 18560
    s_mov_b32 s15, 0x20000
    s_mov_b32 s16, s6
    s_and_b32 s17, s7, 0xffff
    s_mov_b32 s18, 128
    s_mov_b32 s19, 0x20000
    s_mov_b32 s20, s8
    s_and_b32 s21, s9, 0xffff
    s_mov_b32 s22, 16384
    s_mov_b32 s23, 0x20000
    s_mov_b32 s24, s38
    s_and_b32 s25, s39, 0xffff
    s_mov_b32 s26, 25427968
    s_mov_b32 s27, 0x20000
    s_cmp_eq_u32 s28, 19
    s_cbranch_scc1 K1_WX
    s_cmp_eq_u32 s28, 18
    s_cbranch_scc1 K1_W3
    v_lshrrev_b32 v2, 2, v1
    v_and_b32 v3, 4, v2
    v_lshlrev_b32 v3, 3, v3
    v_bfe_u32 v4, v2, 3, 2
    v_lshl_add_u32 v3, v4, 2, v3
    v_and_b32 v4, 3, v2
    v_add_u32 v3, v3, v4
    v_lshrrev_b32 v5, 7, v1
    v_and_b32 v6, 3, v1
    s_mov_b32 s35, 32
    s_cmp_ge_u32 s28, 18
    s_cbranch_scc1 K1_FH
    s_cmp_ge_u32 s28, 16
    s_cbranch_scc1 K1_F4
    s_mov_b32 s36, s28
    s_branch K1_FC
K1_FH:
    s_sub_u32 s36, s28, 20
    s_mov_b32 s12, s20
    s_mov_b32 s13, s21
    s_mov_b32 s14, s22
    s_cmp_ge_u32 s36, 8
    s_cselect_b32 s34, 1.0, s34
K1_FC:
    s_lshr_b32 s37, s36, 3
    s_lshl_b32 s37, s37, 6
    s_and_b32 s38, s36, 3
    s_lshl_b32 s38, s38, 3
    s_add_u32 s37, s37, s38
    s_bfe_u32 s38, s36, 0x10002
    s_branch K1_FD
K1_F4:
    s_mov_b32 s35, 8
    s_movk_i32 s37, 129
    s_sub_u32 s38, s28, 16
K1_FD:
    s_lshl_b32 s38, s38, 4
    v_mul_u32_u24 v5, s35, v5
    v_lshl_add_u32 v5, v6, 1, v5
    v_add_u32 v5, s37, v5
    v_add_u32 v3, s38, v3
    v_lshlrev_b32 v3, 1, v3
    v_lshl_add_u32 v3, v5, 7, v3
    buffer_load_ushort v7, v3, s[12:15], 0 offen
    buffer_load_ushort v8, v3, s[12:15], 0 offen offset:128
    s_waitcnt vmcnt(0)
    v_lshlrev_b32 v7, 16, v7
    v_lshlrev_b32 v8, 16, v8
    v_mul_f32 v7, s34, v7
    v_mul_f32 v8, s34, v8
    v_cvt_pk_bf16_f32 v7, v7, v8
    buffer_store_dword v7, v10, s[24:27], s33 offen
    s_endpgm
K1_W3:
    v_and_b32 v2, 31, v1
    v_and_b32 v3, 4, v2
    v_lshlrev_b32 v3, 3, v3
    v_bfe_u32 v4, v2, 3, 2
    v_lshl_add_u32 v3, v4, 2, v3
    v_and_b32 v4, 3, v2
    v_add_u32 v3, v3, v4
    v_bfe_u32 v5, v1, 6, 1
    v_lshl_add_u32 v3, v5, 4, v3
    v_lshlrev_b32 v3, 1, v3
    s_movk_i32 s35, 16384
    buffer_load_ushort v7, v3, s[12:15], s35 offen
    v_and_b32 v6, 32, v1
    v_cmp_eq_u32 vcc, 0, v6
    s_waitcnt vmcnt(0)
    v_lshlrev_b32 v7, 16, v7
    v_mul_f32 v7, s34, v7
    v_cvt_pk_bf16_f32 v8, v7, v7
    v_lshlrev_b32 v8, 16, v8
    v_sub_f32 v9, v7, v8
    v_cvt_pk_bf16_f32 v7, v8, v9
    v_cndmask_b32 v7, 0, v7, vcc
    buffer_store_dword v7, v10, s[24:27], s33 offen
    s_endpgm
K1_WX:
    v_lshlrev_b32 v3, 1, v1
    buffer_load_ushort v7, v3, s[16:19], 0 offen
    s_waitcnt vmcnt(0)
    v_lshlrev_b32 v7, 16, v7
    v_mul_f32 v7, 0xbf317218, v7
    buffer_store_dword v7, v10, s[24:27], s33 offen
K1_END:
    s_endpgm
.globl egnn_main_kernel
.p2align 8
.type egnn_main_kernel,@function
egnn_main_kernel:
    s_cmp_ge_u32 s2, 256
    s_cbranch_scc1 K2_END
    s_load_dwordx2 s[28:29], s[0:1], 0
    s_load_dwordx2 s[30:31], s[0:1], 16
    s_load_dwordx2 s[32:33], s[0:1], 64
    s_load_dwordx2 s[34:35], s[0:1], 80
    v_mov_b32 v250, v0
    v_lshrrev_b32 v220, 6, v0
    s_and_b32 s3, s2, 7
    s_lshl_b32 s3, s3, 5
    v_readfirstlane_b32 s5, v220
    s_lshr_b32 s95, s2, 3
    s_add_u32 s3, s3, s95
    s_mul_i32 s4, s3, 196
    s_sub_u32 s96, 50000, s4
    s_min_u32 s96, s96, 196
    s_mov_b32 s7, 0
    s_mov_b32 s92, 48
    s_sub_u32 s100, 11, s5
    s_cmp_lt_u32 s5, 4
    s_cselect_b32 s100, s5, s100
    s_lshl_b32 s94, s100, 12
    s_add_u32 s94, s94, 34816
    s_waitcnt lgkmcnt(0)
    s_add_u32 s88, s34, 6422528
    s_addc_u32 s89, s35, 0
    s_and_b32 s89, s89, 0xffff
    s_mov_b32 s90, 262144
    s_mov_b32 s91, 0x20000
    s_mov_b32 s8, s28
    s_and_b32 s9, s29, 0xffff
    s_or_b32 s9, s9, 8388608
    s_mov_b32 s10, 50000
    s_mov_b32 s11, 0x20000
    s_mov_b32 s12, s30
    s_and_b32 s13, s31, 0xffff
    s_or_b32 s13, s13, 2097152
    s_mov_b32 s14, 800000
    s_mov_b32 s15, 0x20000
    s_add_u32 s16, s34, 6684672
    s_addc_u32 s17, s35, 0
    s_and_b32 s17, s17, 0xffff
    s_or_b32 s17, s17, 524288
    s_mov_b32 s18, 50000
    s_mov_b32 s19, 0x20000
    s_mov_b32 s20, s34
    s_and_b32 s21, s35, 0xffff
    s_mov_b32 s22, 25427968
    s_mov_b32 s23, 0x20000
    s_mov_b32 s24, s32
    s_and_b32 s25, s33, 0xffff
    s_mov_b32 s26, 6700000
    s_mov_b32 s27, 0x20000
K2_TOP:
    v_bfe_u32 v220, v250, 4, 2
    s_mul_i32 s95, s5, 36
    s_sub_u32 s95, s95, 36
    v_mad_u32_u24 v220, v220, 9, s95
    v_lshlrev_b32 v221, 4, v220
    s_and_b32 s95, s3, 3
    s_mul_i32 s95, s95, 1020
    s_lshl_b32 s99, s3, 10
    s_sub_u32 s95, s99, s95
    s_cmp_eq_u32 s5, 0
    s_cbranch_scc1 K2_NOOF
    buffer_load_dword v172, v221, s[88:91], s95 offen offset:0
    buffer_load_dword v173, v221, s[88:91], s95 offen offset:16
    buffer_load_dword v174, v221, s[88:91], s95 offen offset:32
    buffer_load_dword v175, v221, s[88:91], s95 offen offset:48
    buffer_load_dword v176, v221, s[88:91], s95 offen offset:64
    buffer_load_dword v177, v221, s[88:91], s95 offen offset:80
    buffer_load_dword v178, v221, s[88:91], s95 offen offset:96
    buffer_load_dword v179, v221, s[88:91], s95 offen offset:112
    buffer_load_dword v180, v221, s[88:91], s95 offen offset:128
K2_NOOF:
    v_and_b32 v222, 63, v250
    v_lshlrev_b32 v203, 4, v222
    v_lshrrev_b32 v239, 3, v222
    v_lshrrev_b32 v223, 4, v222
    v_xor_b32 v223, v223, v222
    v_and_b32 v223, 7, v223
    v_lshlrev_b32 v211, 4, v223
    v_xor_b32 v213, 64, v211
    v_mov_b32 v215, v211
    v_mov_b32 v217, v213
    s_lshl_b32 s95, s5, 5
    s_add_u32 s95, s95, s4
    v_add_u32 v210, s95, v239
    v_add_u32 v212, 8, v210
    v_add_u32 v214, 16, v210
    v_add_u32 v216, 24, v210
    s_add_u32 s99, s4, s96
    v_cmp_gt_u32 vcc, s99, v210
    s_nop 1
    v_cndmask_b32 v210, -1, v210, vcc
    v_cmp_gt_u32 vcc, s99, v212
    s_nop 1
    v_cndmask_b32 v212, -1, v212, vcc
    v_cmp_gt_u32 vcc, s99, v214
    s_nop 1
    v_cndmask_b32 v214, -1, v214, vcc
    v_cmp_gt_u32 vcc, s99, v216
    s_nop 1
    v_cndmask_b32 v216, -1, v216, vcc
    s_lshl_b32 s101, s5, 12
    s_add_u32 s101, s101, 100352
    s_barrier
    s_mul_i32 s95, s5, 3072
    s_add_u32 m0, s95, 138240
    s_add_u32 s95, s95, 7536640
    buffer_load_dwordx4 v203, s[20:23], s95 offen offset:0 lds
    buffer_load_dwordx4 v203, s[20:23], s95 offen offset:1024 lds
    buffer_load_dwordx4 v203, s[20:23], s95 offen offset:2048 lds
    v_mov_b32 v228, 0
    v_mov_b32 v229, 0
    v_mov_b32 v230, 0
    v_mov_b32 v231, 0
    s_lshl_b32 s95, s5, 10
    s_cmp_ge_u32 s5, 4
    s_cselect_b32 s99, 30720, 0
    s_add_u32 s95, s95, s99
    v_add_u32 v223, s95, v203
    ds_write_b128 v223, v[228:231]
    v_and_b32 v223, 2047, v223
    ds_write_b128 v223, v[228:231] offset:38912
    v_lshlrev_b32 v239, 2, v239
    v_mov_b32 v41, 0
    v_mov_b32 v43, 0
    v_mov_b32 v209, 0
    v_lshrrev_b32 v219, 5, v222
    v_lshlrev_b32 v219, 4, v219
    v_and_b32 v223, 31, v222
    v_bfe_u32 v251, v222, 1, 3
    v_lshlrev_b32 v251, 4, v251
    v_lshlrev_b32 v252, 2, v219
    v_xor_b32 v251, v251, v252
    v_lshl_add_u32 v251, v223, 7, v251
    v_add_u32 v251, s94, v251
    v_xor_b32 v252, 16, v251
    v_xor_b32 v253, 32, v251
    v_xor_b32 v254, 48, v251
    v_and_b32 v222, 15, v250
    v_cmp_gt_u32 vcc, 243, v220
    v_mul_u32_u24 v220, 3200, v220
    v_add3_u32 v220, v220, v222, s7
    v_add_u32 v221, 16, v222
    v_add_u32 v223, 32, v222
    v_cmp_gt_u32_e64 s[32:33], s92, v221
    v_cmp_gt_u32_e64 s[34:35], s92, v222
    s_nop 0
    v_cndmask_b32_e64 v221, 2.0, v221, s[32:33]
    v_cndmask_b32_e64 v223, 2.0, v223, s[32:33]
    v_cndmask_b32_e64 v222, 2.0, v222, s[34:35]
    s_cmp_eq_u32 s5, 0
    s_waitcnt vmcnt(3)
    s_cbranch_scc0 K2_MK
    s_branch K2_NOREC
K2_MK:
    v_cndmask_b32 v179, 0, v179, vcc
    v_cndmask_b32 v180, 0, v180, vcc
    v_and_b32 v98, 0xffff, v172
    v_lshrrev_b32 v172, 16, v172
    v_subrev_u32 v172, s7, v172
    v_cmp_gt_i32_e64 s[32:33], v172, v222
    v_add_lshl_u32 v98, v98, v220, 3
    s_mov_b32 s95, 0
    v_cndmask_b32_e64 v98, 2.0, v98, s[32:33]
    buffer_load_dwordx2 v[44:45], v98, s[20:23], s95 offen
    v_and_b32 v99, 0xffff, v173
    v_lshrrev_b32 v173, 16, v173
    v_subrev_u32 v173, s7, v173
    v_cmp_gt_i32_e64 s[34:35], v173, v222
    v_add_lshl_u32 v99, v99, v220, 3
    s_mov_b32 s95, 25600
    v_cndmask_b32_e64 v99, 2.0, v99, s[34:35]
    buffer_load_dwordx2 v[46:47], v99, s[20:23], s95 offen
    v_and_b32 v100, 0xffff, v174
    v_lshrrev_b32 v174, 16, v174
    v_subrev_u32 v174, s7, v174
    v_cmp_gt_i32_e64 s[36:37], v174, v222
    v_add_lshl_u32 v100, v100, v220, 3
    s_mov_b32 s95, 51200
    v_cndmask_b32_e64 v100, 2.0, v100, s[36:37]
    buffer_load_dwordx2 v[48:49], v100, s[20:23], s95 offen
    v_and_b32 v101, 0xffff, v175
    v_lshrrev_b32 v175, 16, v175
    v_subrev_u32 v175, s7, v175
    v_cmp_gt_i32_e64 s[38:39], v175, v222
    v_add_lshl_u32 v101, v101, v220, 3
    s_mov_b32 s95, 76800
    v_cndmask_b32_e64 v101, 2.0, v101, s[38:39]
    buffer_load_dwordx2 v[50:51], v101, s[20:23], s95 offen
    v_and_b32 v102, 0xffff, v176
    v_lshrrev_b32 v176, 16, v176
    v_subrev_u32 v176, s7, v176
    v_cmp_gt_i32_e64 s[40:41], v176, v222
    v_add_lshl_u32 v102, v102, v220, 3
    s_mov_b32 s95, 102400
    v_cndmask_b32_e64 v102, 2.0, v102, s[40:41]
    buffer_load_dwordx2 v[52:53], v102, s[20:23], s95 offen
    v_and_b32 v103, 0xffff, v177
    v_lshrrev_b32 v177, 16, v177
    v_subrev_u32 v177, s7, v177
    v_cmp_gt_i32_e64 s[42:43], v177, v222
    v_add_lshl_u32 v103, v103, v220, 3
    s_mov_b32 s95, 128000
    v_cndmask_b32_e64 v103, 2.0, v103, s[42:43]
    buffer_load_dwordx2 v[54:55], v103, s[20:23], s95 offen
    v_and_b32 v104, 0xffff, v178
    v_lshrrev_b32 v178, 16, v178
    v_subrev_u32 v178, s7, v178
    v_cmp_gt_i32_e64 s[44:45], v178, v222
    v_add_lshl_u32 v104, v104, v220, 3
    s_mov_b32 s95, 153600
    v_cndmask_b32_e64 v104, 2.0, v104, s[44:45]
    buffer_load_dwordx2 v[56:57], v104, s[20:23], s95 offen
    v_and_b32 v105, 0xffff, v179
    v_lshrrev_b32 v179, 16, v179
    v_subrev_u32 v179, s7, v179
    v_cmp_gt_i32_e64 s[46:47], v179, v222
    v_add_lshl_u32 v105, v105, v220, 3
    s_mov_b32 s95, 179200
    v_cndmask_b32_e64 v105, 2.0, v105, s[46:47]
    buffer_load_dwordx2 v[58:59], v105, s[20:23], s95 offen
    v_and_b32 v106, 0xffff, v180
    v_lshrrev_b32 v180, 16, v180
    v_subrev_u32 v180, s7, v180
    v_cmp_gt_i32_e64 s[48:49], v180, v222
    v_add_lshl_u32 v106, v106, v220, 3
    s_mov_b32 s95, 204800
    v_cndmask_b32_e64 v106, 2.0, v106, s[48:49]
    buffer_load_dwordx2 v[60:61], v106, s[20:23], s95 offen
    v_cmp_gt_i32_e64 s[50:51], v172, v221
    v_cmp_gt_i32_e64 s[68:69], v172, v223
    v_cmp_gt_i32_e64 s[52:53], v173, v221
    v_cmp_gt_i32_e64 s[70:71], v173, v223
    v_cmp_gt_i32_e64 s[54:55], v174, v221
    v_cmp_gt_i32_e64 s[72:73], v174, v223
    v_cmp_gt_i32_e64 s[56:57], v175, v221
    v_cmp_gt_i32_e64 s[74:75], v175, v223
    v_cmp_gt_i32_e64 s[58:59], v176, v221
    v_cmp_gt_i32_e64 s[76:77], v176, v223
    v_cmp_gt_i32_e64 s[60:61], v177, v221
    v_cmp_gt_i32_e64 s[78:79], v177, v223
    v_cmp_gt_i32_e64 s[62:63], v178, v221
    v_cmp_gt_i32_e64 s[80:81], v178, v223
    v_cmp_gt_i32_e64 s[64:65], v179, v221
    v_cmp_gt_i32_e64 s[82:83], v179, v223
    v_cmp_gt_i32_e64 s[66:67], v180, v221
    v_cmp_gt_i32_e64 s[84:85], v180, v223
    s_mov_b32 s95, 0
    s_mov_b64 exec, s[50:51]
    s_cbranch_execz K2_G1
    buffer_load_dwordx2 v[62:63], v98, s[20:23], s95 offen offset:128
K2_G1:
    s_mov_b32 s95, 25600
    s_mov_b64 exec, s[52:53]
    s_cbranch_execz K2_G2
    buffer_load_dwordx2 v[64:65], v99, s[20:23], s95 offen offset:128
K2_G2:
    s_mov_b32 s95, 51200
    s_mov_b64 exec, s[54:55]
    s_cbranch_execz K2_G3
    buffer_load_dwordx2 v[66:67], v100, s[20:23], s95 offen offset:128
K2_G3:
    s_mov_b32 s95, 76800
    s_mov_b64 exec, s[56:57]
    s_cbranch_execz K2_G4
    buffer_load_dwordx2 v[68:69], v101, s[20:23], s95 offen offset:128
K2_G4:
    s_mov_b32 s95, 102400
    s_mov_b64 exec, s[58:59]
    s_cbranch_execz K2_G5
    buffer_load_dwordx2 v[70:71], v102, s[20:23], s95 offen offset:128
K2_G5:
    s_mov_b32 s95, 128000
    s_mov_b64 exec, s[60:61]
    s_cbranch_execz K2_G6
    buffer_load_dwordx2 v[72:73], v103, s[20:23], s95 offen offset:128
K2_G6:
    s_mov_b32 s95, 153600
    s_mov_b64 exec, s[62:63]
    s_cbranch_execz K2_G7
    buffer_load_dwordx2 v[74:75], v104, s[20:23], s95 offen offset:128
K2_G7:
    s_mov_b32 s95, 179200
    s_mov_b64 exec, s[64:65]
    s_cbranch_execz K2_G8
    buffer_load_dwordx2 v[76:77], v105, s[20:23], s95 offen offset:128
K2_G8:
    s_mov_b32 s95, 204800
    s_mov_b64 exec, s[66:67]
    s_cbranch_execz K2_G9
    buffer_load_dwordx2 v[78:79], v106, s[20:23], s95 offen offset:128
K2_G9:
    s_or_b64 vcc, s[68:69], s[70:71]
    s_or_b64 vcc, vcc, s[72:73]
    s_or_b64 vcc, vcc, s[74:75]
    s_or_b64 vcc, vcc, s[76:77]
    s_or_b64 vcc, vcc, s[78:79]
    s_or_b64 vcc, vcc, s[80:81]
    s_or_b64 vcc, vcc, s[82:83]
    s_or_b64 vcc, vcc, s[84:85]
    s_cselect_b32 s97, 1, 0
    s_cbranch_scc0 K2_NP2A
    s_mov_b32 s95, 0
    s_mov_b64 exec, s[68:69]
    s_cbranch_execz K2_G10
    buffer_load_dwordx2 v[80:81], v98, s[20:23], s95 offen offset:256
K2_G10:
    s_mov_b32 s95, 25600
    s_mov_b64 exec, s[70:71]
    s_cbranch_execz K2_G11
    buffer_load_dwordx2 v[82:83], v99, s[20:23], s95 offen offset:256
K2_G11:
    s_mov_b32 s95, 51200
    s_mov_b64 exec, s[72:73]
    s_cbranch_execz K2_G12
    buffer_load_dwordx2 v[84:85], v100, s[20:23], s95 offen offset:256
K2_G12:
    s_mov_b32 s95, 76800
    s_mov_b64 exec, s[74:75]
    s_cbranch_execz K2_G13
    buffer_load_dwordx2 v[86:87], v101, s[20:23], s95 offen offset:256
K2_G13:
    s_mov_b32 s95, 102400
    s_mov_b64 exec, s[76:77]
    s_cbranch_execz K2_G14
    buffer_load_dwordx2 v[88:89], v102, s[20:23], s95 offen offset:256
K2_G14:
    s_mov_b32 s95, 128000
    s_mov_b64 exec, s[78:79]
    s_cbranch_execz K2_G15
    buffer_load_dwordx2 v[90:91], v103, s[20:23], s95 offen offset:256
K2_G15:
    s_mov_b32 s95, 153600
    s_mov_b64 exec, s[80:81]
    s_cbranch_execz K2_G16
    buffer_load_dwordx2 v[92:93], v104, s[20:23], s95 offen offset:256
K2_G16:
    s_mov_b32 s95, 179200
    s_mov_b64 exec, s[82:83]
    s_cbranch_execz K2_G17
    buffer_load_dwordx2 v[94:95], v105, s[20:23], s95 offen offset:256
K2_G17:
    s_mov_b32 s95, 204800
    s_mov_b64 exec, s[84:85]
    s_cbranch_execz K2_G18
    buffer_load_dwordx2 v[96:97], v106, s[20:23], s95 offen offset:256
K2_G18:
K2_NP2A:
    s_mov_b64 exec, -1
    v_max3_i32 v221, v172, v173, v174
    v_max3_i32 v221, v221, v175, v176
    v_max3_i32 v221, v221, v177, v178
    v_max3_i32 v221, v221, v179, v180
    v_mov_b32 v223, 1
    v_cmp_lt_i32_e64 s[86:87], s92, v221
K2_NOREC:
    s_waitcnt lgkmcnt(0)
    s_barrier
    s_add_u32 s95, s101, 0
    s_cmp_lt_u32 s95, 125952
    s_cselect_b32 m0, s95, 43008
    s_nop 0
    buffer_load_dwordx4 v[210:211], s[8:11], 0 idxen offen lds
    s_add_u32 s95, s101, 1024
    s_cmp_lt_u32 s95, 125952
    s_cselect_b32 m0, s95, 43008
    s_nop 0
    buffer_load_dwordx4 v[212:213], s[8:11], 0 idxen offen lds
    s_add_u32 s95, s101, 2048
    s_cmp_lt_u32 s95, 125952
    s_cselect_b32 m0, s95, 43008
    s_nop 0
    buffer_load_dwordx4 v[214:215], s[8:11], 0 idxen offen lds
    s_add_u32 s95, s101, 3072
    s_cmp_lt_u32 s95, 125952
    s_cselect_b32 m0, s95, 43008
    s_nop 0
    buffer_load_dwordx4 v[216:217], s[8:11], 0 idxen offen lds
    s_cmp_lg_u32 s5, 0
    s_cbranch_scc1 K2_NOPW
    s_lshr_b32 s95, s2, 3
    s_mul_i32 s99, s95, 0
    v_add_u32 v224, s99, v203
    s_mul_i32 s99, s95, 0
    v_add_u32 v225, s99, v250
    v_add_u32 v224, 0, v250
    v_cmp_gt_u32 vcc, s96, v224
    s_nop 1
    v_cndmask_b32_e64 v104, -0.5, 0.5, vcc
    v_add_u32 v224, 64, v250
    v_cmp_gt_u32 vcc, s96, v224
    s_nop 1
    v_cndmask_b32_e64 v105, -0.5, 0.5, vcc
    v_add_u32 v224, 128, v250
    v_cmp_gt_u32 vcc, s96, v224
    s_nop 1
    v_cndmask_b32_e64 v106, -0.5, 0.5, vcc
    v_add_u32 v224, 192, v250
    v_cmp_gt_u32 vcc, s96, v224
    s_nop 1
    v_cndmask_b32_e64 v107, -0.5, 0.5, vcc
    s_branch K2_B1
K2_NOPW:
    s_mov_b64 exec, s[86:87]
    ds_write_b32 v228, v223 offset:96
    s_mov_b64 exec, -1
    s_waitcnt vmcnt(4)
    s_mov_b64 exec, s[32:33]
    v_lshrrev_b32 v172, 16, v45
    ds_add_rtn_u32 v172, v172, v223 offset:34816
    s_mov_b64 exec, s[34:35]
    v_lshrrev_b32 v173, 16, v47
    ds_add_rtn_u32 v173, v173, v223 offset:34816
    s_mov_b64 exec, s[36:37]
    v_lshrrev_b32 v174, 16, v49
    ds_add_rtn_u32 v174, v174, v223 offset:34816
    s_mov_b64 exec, s[38:39]
    v_lshrrev_b32 v175, 16, v51
    ds_add_rtn_u32 v175, v175, v223 offset:34816
    s_mov_b64 exec, s[40:41]
    v_lshrrev_b32 v176, 16, v53
    ds_add_rtn_u32 v176, v176, v223 offset:34816
    s_mov_b64 exec, s[42:43]
    v_lshrrev_b32 v177, 16, v55
    ds_add_rtn_u32 v177, v177, v223 offset:34816
    s_mov_b64 exec, s[44:45]
    v_lshrrev_b32 v178, 16, v57
    ds_add_rtn_u32 v178, v178, v223 offset:34816
    s_mov_b64 exec, s[46:47]
    v_lshrrev_b32 v179, 16, v59
    ds_add_rtn_u32 v179, v179, v223 offset:34816
    s_mov_b64 exec, s[48:49]
    v_lshrrev_b32 v180, 16, v61
    ds_add_rtn_u32 v180, v180, v223 offset:34816
    s_mov_b64 exec, s[50:51]
    s_cbranch_execz K2_G19
    v_lshrrev_b32 v181, 16, v63
    ds_add_rtn_u32 v181, v181, v223 offset:34816
K2_G19:
    s_mov_b64 exec, s[52:53]
    s_cbranch_execz K2_G20
    v_lshrrev_b32 v182, 16, v65
    ds_add_rtn_u32 v182, v182, v223 offset:34816
K2_G20:
    s_mov_b64 exec, s[54:55]
    s_cbranch_execz K2_G21
    v_lshrrev_b32 v183, 16, v67
    ds_add_rtn_u32 v183, v183, v223 offset:34816
K2_G21:
    s_mov_b64 exec, s[56:57]
    s_cbranch_execz K2_G22
    v_lshrrev_b32 v184, 16, v69
    ds_add_rtn_u32 v184, v184, v223 offset:34816
K2_G22:
    s_mov_b64 exec, s[58:59]
    s_cbranch_execz K2_G23
    v_lshrrev_b32 v185, 16, v71
    ds_add_rtn_u32 v185, v185, v223 offset:34816
K2_G23:
    s_mov_b64 exec, s[60:61]
    s_cbranch_execz K2_G24
    v_lshrrev_b32 v186, 16, v73
    ds_add_rtn_u32 v186, v186, v223 offset:34816
K2_G24:
    s_mov_b64 exec, s[62:63]
    s_cbranch_execz K2_G25
    v_lshrrev_b32 v187, 16, v75
    ds_add_rtn_u32 v187, v187, v223 offset:34816
K2_G25:
    s_mov_b64 exec, s[64:65]
    s_cbranch_execz K2_G26
    v_lshrrev_b32 v188, 16, v77
    ds_add_rtn_u32 v188, v188, v223 offset:34816
K2_G26:
    s_mov_b64 exec, s[66:67]
    s_cbranch_execz K2_G27
    v_lshrrev_b32 v189, 16, v79
    ds_add_rtn_u32 v189, v189, v223 offset:34816
K2_G27:
    s_cmp_eq_u32 s97, 0
    s_cbranch_scc1 K2_NP2B
    s_mov_b64 exec, s[68:69]
    s_cbranch_execz K2_G28
    v_lshrrev_b32 v190, 16, v81
    ds_add_rtn_u32 v190, v190, v223 offset:34816
K2_G28:
    s_mov_b64 exec, s[70:71]
    s_cbranch_execz K2_G29
    v_lshrrev_b32 v191, 16, v83
    ds_add_rtn_u32 v191, v191, v223 offset:34816
K2_G29:
    s_mov_b64 exec, s[72:73]
    s_cbranch_execz K2_G30
    v_lshrrev_b32 v192, 16, v85
    ds_add_rtn_u32 v192, v192, v223 offset:34816
K2_G30:
    s_mov_b64 exec, s[74:75]
    s_cbranch_execz K2_G31
    v_lshrrev_b32 v193, 16, v87
    ds_add_rtn_u32 v193, v193, v223 offset:34816
K2_G31:
    s_mov_b64 exec, s[76:77]
    s_cbranch_execz K2_G32
    v_lshrrev_b32 v194, 16, v89
    ds_add_rtn_u32 v194, v194, v223 offset:34816
K2_G32:
    s_mov_b64 exec, s[78:79]
    s_cbranch_execz K2_G33
    v_lshrrev_b32 v195, 16, v91
    ds_add_rtn_u32 v195, v195, v223 offset:34816
K2_G33:
    s_mov_b64 exec, s[80:81]
    s_cbranch_execz K2_G34
    v_lshrrev_b32 v196, 16, v93
    ds_add_rtn_u32 v196, v196, v223 offset:34816
K2_G34:
    s_mov_b64 exec, s[82:83]
    s_cbranch_execz K2_G35
    v_lshrrev_b32 v197, 16, v95
    ds_add_rtn_u32 v197, v197, v223 offset:34816
K2_G35:
    s_mov_b64 exec, s[84:85]
    s_cbranch_execz K2_G36
    v_lshrrev_b32 v198, 16, v97
    ds_add_rtn_u32 v198, v198, v223 offset:34816
K2_G36:
K2_NP2B:
    s_mov_b64 exec, -1
K2_B1:
    s_cmp_lg_u32 s5, 0
    s_waitcnt lgkmcnt(0)
    s_barrier
    s_cbranch_scc1 K2_W2
    ds_read_b128 v[44:47], v203 offset:34816
    ds_read_b128 v[48:51], v203 offset:35840
    ds_read_b128 v[52:55], v203 offset:36864
    ds_read_b128 v[56:59], v203 offset:37888
    s_waitcnt lgkmcnt(3)
    v_add_u32 v76, v44, v45
    v_add3_u32 v76, v76, v46, v47
    s_waitcnt lgkmcnt(2)
    v_add_u32 v77, v48, v49
    v_add3_u32 v77, v77, v50, v51
    s_waitcnt lgkmcnt(1)
    v_add_u32 v78, v52, v53
    v_add3_u32 v78, v78, v54, v55
    s_waitcnt lgkmcnt(0)
    v_add_u32 v79, v56, v57
    v_add3_u32 v79, v79, v58, v59
    v_add_u32 v82, v76, v77
    v_add_u32 v83, v82, v78
    v_add_u32 v220, v83, v79
    v_mov_b32 v221, v220
    s_nop 1
    v_add_u32_dpp v221, v221, v221 row_shr:1 row_mask:0xf bank_mask:0xf
    s_nop 1
    v_add_u32_dpp v221, v221, v221 row_shr:2 row_mask:0xf bank_mask:0xf
    s_nop 1
    v_add_u32_dpp v221, v221, v221 row_shr:4 row_mask:0xf bank_mask:0xf
    s_nop 1
    v_add_u32_dpp v221, v221, v221 row_shr:8 row_mask:0xf bank_mask:0xf
    s_nop 1
    v_add_u32_dpp v221, v221, v221 row_bcast:15 row_mask:0xa bank_mask:0xf
    s_nop 1
    v_add_u32_dpp v221, v221, v221 row_bcast:31 row_mask:0xc bank_mask:0xf
    v_sub_u32 v80, v221, v220
    v_add_u32 v81, v80, v76
    v_add_u32 v82, v80, v82
    v_add_u32 v83, v80, v83
    s_movk_i32 s95, 2560
    v_lshl_add_u32 v60, v80, 3, s95
    v_lshl_add_u32 v61, v44, 3, v60
    v_lshl_add_u32 v62, v45, 3, v61
    v_lshl_add_u32 v63, v46, 3, v62
    ds_write_b128 v203, v[60:63] offset:34816
    v_lshl_add_u32 v64, v81, 3, s95
    v_lshl_add_u32 v65, v48, 3, v64
    v_lshl_add_u32 v66, v49, 3, v65
    v_lshl_add_u32 v67, v50, 3, v66
    ds_write_b128 v203, v[64:67] offset:35840
    v_lshl_add_u32 v68, v82, 3, s95
    v_lshl_add_u32 v69, v52, 3, v68
    v_lshl_add_u32 v70, v53, 3, v69
    v_lshl_add_u32 v71, v54, 3, v70
    ds_write_b128 v203, v[68:71] offset:36864
    v_lshl_add_u32 v72, v83, 3, s95
    v_lshl_add_u32 v73, v56, 3, v72
    v_lshl_add_u32 v74, v57, 3, v73
    v_lshl_add_u32 v75, v58, 3, v74
    ds_write_b128 v203, v[72:75] offset:37888
    s_mov_b32 exec_lo, 0
    s_brev_b32 exec_hi, 1
    ds_write_b32 v228, v221 offset:100
    s_mov_b64 exec, -1
K2_W2:
    s_cmp_ge_u32 s5, 6
    s_cbranch_scc1 K2_NWH
    s_mul_i32 s95, s5, 2048
    s_add_u32 m0, s95, 125952
    s_add_u32 s95, s95, 7561216
    buffer_load_dwordx4 v203, s[20:23], s95 offen offset:0 lds
    buffer_load_dwordx4 v203, s[20:23], s95 offen offset:1024 lds
K2_NWH:
    s_cmp_eq_u32 s5, 0
    s_cbranch_scc1 K2_NFT
    s_mov_b32 s95, 0xc0000
    s_mov_b64 exec, s[32:33]
    v_and_or_b32 v140, v45, s95, v172
    v_lshrrev_b32 v141, 17, v45
    v_cmpx_gt_u32 vcc, 1, v140
    ds_write_b64 v141, v[44:45] offset:38912
    s_mov_b64 exec, s[34:35]
    v_and_or_b32 v142, v47, s95, v173
    v_lshrrev_b32 v143, 17, v47
    v_cmpx_gt_u32 vcc, 1, v142
    ds_write_b64 v143, v[46:47] offset:38912
    s_mov_b64 exec, s[36:37]
    v_and_or_b32 v144, v49, s95, v174
    v_lshrrev_b32 v145, 17, v49
    v_cmpx_gt_u32 vcc, 1, v144
    ds_write_b64 v145, v[48:49] offset:38912
    s_mov_b64 exec, s[38:39]
    v_and_or_b32 v146, v51, s95, v175
    v_lshrrev_b32 v147, 17, v51
    v_cmpx_gt_u32 vcc, 1, v146
    ds_write_b64 v147, v[50:51] offset:38912
    s_mov_b64 exec, s[40:41]
    v_and_or_b32 v148, v53, s95, v176
    v_lshrrev_b32 v149, 17, v53
    v_cmpx_gt_u32 vcc, 1, v148
    ds_write_b64 v149, v[52:53] offset:38912
    s_mov_b64 exec, s[42:43]
    v_and_or_b32 v150, v55, s95, v177
    v_lshrrev_b32 v151, 17, v55
    v_cmpx_gt_u32 vcc, 1, v150
    ds_write_b64 v151, v[54:55] offset:38912
    s_mov_b64 exec, s[44:45]
    v_and_or_b32 v152, v57, s95, v178
    v_lshrrev_b32 v153, 17, v57
    v_cmpx_gt_u32 vcc, 1, v152
    ds_write_b64 v153, v[56:57] offset:38912
    s_mov_b64 exec, s[46:47]
    v_and_or_b32 v154, v59, s95, v179
    v_lshrrev_b32 v155, 17, v59
    v_cmpx_gt_u32 vcc, 1, v154
    ds_write_b64 v155, v[58:59] offset:38912
    s_mov_b64 exec, s[48:49]
    v_and_or_b32 v156, v61, s95, v180
    v_lshrrev_b32 v157, 17, v61
    v_cmpx_gt_u32 vcc, 1, v156
    ds_write_b64 v157, v[60:61] offset:38912
    s_mov_b64 exec, -1
    s_mul_i32 s95, s5, 224
    v_lshrrev_b32 v140, 1, v203
    v_add_u32 v140, s95, v140
K2_NFT:
    s_cmp_eq_u32 s5, 0
    s_waitcnt lgkmcnt(0)
    s_barrier
    ds_read_b64 v[232:233], v228 offset:96
    s_cbranch_scc1 K2_NOS1
    ds_read_b64 v[140:141], v140 offset:38688
    s_mov_b64 exec, s[32:33]
    v_lshrrev_b32 v98, 16, v45
    ds_read_b32 v98, v98 offset:34816
    s_mov_b64 exec, s[34:35]
    v_lshrrev_b32 v99, 16, v47
    ds_read_b32 v99, v99 offset:34816
    s_mov_b64 exec, s[36:37]
    v_lshrrev_b32 v100, 16, v49
    ds_read_b32 v100, v100 offset:34816
    s_mov_b64 exec, s[38:39]
    v_lshrrev_b32 v101, 16, v51
    ds_read_b32 v101, v101 offset:34816
    s_mov_b64 exec, s[40:41]
    v_lshrrev_b32 v102, 16, v53
    ds_read_b32 v102, v102 offset:34816
    s_mov_b64 exec, s[42:43]
    v_lshrrev_b32 v103, 16, v55
    ds_read_b32 v103, v103 offset:34816
    s_mov_b64 exec, s[44:45]
    v_lshrrev_b32 v104, 16, v57
    ds_read_b32 v104, v104 offset:34816
    s_mov_b64 exec, s[46:47]
    v_lshrrev_b32 v105, 16, v59
    ds_read_b32 v105, v105 offset:34816
    s_mov_b64 exec, s[48:49]
    v_lshrrev_b32 v106, 16, v61
    ds_read_b32 v106, v106 offset:34816
    s_mov_b64 exec, -1
    s_waitcnt lgkmcnt(9)
    v_and_b32 v141, 0xffff, v141
    s_mov_b64 exec, 0xfffffff
    buffer_load_dword v202, v140, s[12:15], 0 idxen
    buffer_load_dword v202, v141, s[8:11], 0 idxen
    buffer_load_dword v202, v141, s[16:19], 0 idxen
    s_mov_b64 exec, s[50:51]
    s_cbranch_execz K2_G37
    v_lshrrev_b32 v220, 16, v63
    ds_read_b32 v220, v220 offset:34816
K2_G37:
    s_mov_b64 exec, s[52:53]
    s_cbranch_execz K2_G38
    v_lshrrev_b32 v221, 16, v65
    ds_read_b32 v221, v221 offset:34816
K2_G38:
    s_mov_b64 exec, s[54:55]
    s_cbranch_execz K2_G39
    v_lshrrev_b32 v222, 16, v67
    ds_read_b32 v222, v222 offset:34816
K2_G39:
    s_mov_b64 exec, s[56:57]
    s_cbranch_execz K2_G40
    v_lshrrev_b32 v223, 16, v69
    ds_read_b32 v223, v223 offset:34816
K2_G40:
    s_mov_b64 exec, s[58:59]
    s_cbranch_execz K2_G41
    v_lshrrev_b32 v224, 16, v71
    ds_read_b32 v224, v224 offset:34816
K2_G41:
    s_mov_b64 exec, s[60:61]
    s_cbranch_execz K2_G42
    v_lshrrev_b32 v225, 16, v73
    ds_read_b32 v225, v225 offset:34816
K2_G42:
    s_mov_b64 exec, s[62:63]
    s_cbranch_execz K2_G43
    v_lshrrev_b32 v226, 16, v75
    ds_read_b32 v226, v226 offset:34816
K2_G43:
    s_mov_b64 exec, s[64:65]
    s_cbranch_execz K2_G44
    v_lshrrev_b32 v227, 16, v77
    ds_read_b32 v227, v227 offset:34816
K2_G44:
    s_mov_b64 exec, s[66:67]
    s_cbranch_execz K2_G45
    v_lshrrev_b32 v228, 16, v79
    ds_read_b32 v228, v228 offset:34816
K2_G45:
    s_mov_b64 exec, -1
K2_NOS1:
    s_waitcnt lgkmcnt(0)
    v_readfirstlane_b32 s98, v233
    v_readfirstlane_b32 s93, v232
    s_cmp_le_u32 s98, 3776
    s_cbranch_scc1 K2_FITS
    s_cmp_eq_u32 s92, 15
    s_cbranch_scc1 K2_END0
    s_mov_b32 s92, 15
    s_waitcnt vmcnt(0)
    s_barrier
    s_branch K2_TOP
K2_FITS:
    s_cmp_eq_u32 s5, 0
    s_cbranch_scc1 K2_PLAN
    s_mov_b64 exec, s[32:33]
    v_lshl_add_u32 v98, v172, 3, v98
    ds_write_b64 v98, v[44:45]
    s_mov_b64 exec, s[34:35]
    v_lshl_add_u32 v99, v173, 3, v99
    ds_write_b64 v99, v[46:47]
    s_mov_b64 exec, s[36:37]
    v_lshl_add_u32 v100, v174, 3, v100
    ds_write_b64 v100, v[48:49]
    s_mov_b64 exec, s[38:39]
    v_lshl_add_u32 v101, v175, 3, v101
    ds_write_b64 v101, v[50:51]
    s_mov_b64 exec, s[40:41]
    v_lshl_add_u32 v102, v176, 3, v102
    ds_write_b64 v102, v[52:53]
    s_mov_b64 exec, s[42:43]
    v_lshl_add_u32 v103, v177, 3, v103
    ds_write_b64 v103, v[54:55]
    s_mov_b64 exec, s[44:45]
    v_lshl_add_u32 v104, v178, 3, v104
    ds_write_b64 v104, v[56:57]
    s_mov_b64 exec, s[46:47]
    v_lshl_add_u32 v105, v179, 3, v105
    ds_write_b64 v105, v[58:59]
    s_mov_b64 exec, s[48:49]
    v_lshl_add_u32 v106, v180, 3, v106
    ds_write_b64 v106, v[60:61]
    s_mov_b64 exec, s[50:51]
    s_cbranch_execz K2_G46
    v_lshl_add_u32 v220, v181, 3, v220
    ds_write_b64 v220, v[62:63]
K2_G46:
    s_mov_b64 exec, s[52:53]
    s_cbranch_execz K2_G47
    v_lshl_add_u32 v221, v182, 3, v221
    ds_write_b64 v221, v[64:65]
K2_G47:
    s_mov_b64 exec, s[54:55]
    s_cbranch_execz K2_G48
    v_lshl_add_u32 v222, v183, 3, v222
    ds_write_b64 v222, v[66:67]
K2_G48:
    s_mov_b64 exec, s[56:57]
    s_cbranch_execz K2_G49
    v_lshl_add_u32 v223, v184, 3, v223
    ds_write_b64 v223, v[68:69]
K2_G49:
    s_mov_b64 exec, s[58:59]
    s_cbranch_execz K2_G50
    v_lshl_add_u32 v224, v185, 3, v224
    ds_write_b64 v224, v[70:71]
K2_G50:
    s_mov_b64 exec, s[60:61]
    s_cbranch_execz K2_G51
    v_lshl_add_u32 v225, v186, 3, v225
    ds_write_b64 v225, v[72:73]
K2_G51:
    s_mov_b64 exec, s[62:63]
    s_cbranch_execz K2_G52
    v_lshl_add_u32 v226, v187, 3, v226
    ds_write_b64 v226, v[74:75]
K2_G52:
    s_mov_b64 exec, s[64:65]
    s_cbranch_execz K2_G53
    v_lshl_add_u32 v227, v188, 3, v227
    ds_write_b64 v227, v[76:77]
K2_G53:
    s_mov_b64 exec, s[66:67]
    s_cbranch_execz K2_G54
    v_lshl_add_u32 v228, v189, 3, v228
    ds_write_b64 v228, v[78:79]
K2_G54:
    s_cmp_eq_u32 s97, 0
    s_cbranch_scc1 K2_B3
    s_mov_b64 exec, s[68:69]
    s_cbranch_execz K2_G55
    v_lshrrev_b32 v98, 16, v81
    ds_read_b32 v98, v98 offset:34816
K2_G55:
    s_mov_b64 exec, s[70:71]
    s_cbranch_execz K2_G56
    v_lshrrev_b32 v99, 16, v83
    ds_read_b32 v99, v99 offset:34816
K2_G56:
    s_mov_b64 exec, s[72:73]
    s_cbranch_execz K2_G57
    v_lshrrev_b32 v100, 16, v85
    ds_read_b32 v100, v100 offset:34816
K2_G57:
    s_mov_b64 exec, s[74:75]
    s_cbranch_execz K2_G58
    v_lshrrev_b32 v101, 16, v87
    ds_read_b32 v101, v101 offset:34816
K2_G58:
    s_mov_b64 exec, s[76:77]
    s_cbranch_execz K2_G59
    v_lshrrev_b32 v102, 16, v89
    ds_read_b32 v102, v102 offset:34816
K2_G59:
    s_mov_b64 exec, s[78:79]
    s_cbranch_execz K2_G60
    v_lshrrev_b32 v103, 16, v91
    ds_read_b32 v103, v103 offset:34816
K2_G60:
    s_mov_b64 exec, s[80:81]
    s_cbranch_execz K2_G61
    v_lshrrev_b32 v104, 16, v93
    ds_read_b32 v104, v104 offset:34816
K2_G61:
    s_mov_b64 exec, s[82:83]
    s_cbranch_execz K2_G62
    v_lshrrev_b32 v105, 16, v95
    ds_read_b32 v105, v105 offset:34816
K2_G62:
    s_mov_b64 exec, s[84:85]
    s_cbranch_execz K2_G63
    v_lshrrev_b32 v106, 16, v97
    ds_read_b32 v106, v106 offset:34816
K2_G63:
    s_waitcnt lgkmcnt(0)
    s_mov_b64 exec, s[68:69]
    s_cbranch_execz K2_G64
    v_lshl_add_u32 v98, v190, 3, v98
    ds_write_b64 v98, v[80:81]
K2_G64:
    s_mov_b64 exec, s[70:71]
    s_cbranch_execz K2_G65
    v_lshl_add_u32 v99, v191, 3, v99
    ds_write_b64 v99, v[82:83]
K2_G65:
    s_mov_b64 exec, s[72:73]
    s_cbranch_execz K2_G66
    v_lshl_add_u32 v100, v192, 3, v100
    ds_write_b64 v100, v[84:85]
K2_G66:
    s_mov_b64 exec, s[74:75]
    s_cbranch_execz K2_G67
    v_lshl_add_u32 v101, v193, 3, v101
    ds_write_b64 v101, v[86:87]
K2_G67:
    s_mov_b64 exec, s[76:77]
    s_cbranch_execz K2_G68
    v_lshl_add_u32 v102, v194, 3, v102
    ds_write_b64 v102, v[88:89]
K2_G68:
    s_mov_b64 exec, s[78:79]
    s_cbranch_execz K2_G69
    v_lshl_add_u32 v103, v195, 3, v103
    ds_write_b64 v103, v[90:91]
K2_G69:
    s_mov_b64 exec, s[80:81]
    s_cbranch_execz K2_G70
    v_lshl_add_u32 v104, v196, 3, v104
    ds_write_b64 v104, v[92:93]
K2_G70:
    s_mov_b64 exec, s[82:83]
    s_cbranch_execz K2_G71
    v_lshl_add_u32 v105, v197, 3, v105
    ds_write_b64 v105, v[94:95]
K2_G71:
    s_mov_b64 exec, s[84:85]
    s_cbranch_execz K2_G72
    v_lshl_add_u32 v106, v198, 3, v106
    ds_write_b64 v106, v[96:97]
K2_G72:
    s_branch K2_B3
K2_PLAN:
    s_mul_i32 s99, s98, 3
    s_lshr_b32 s99, s99, 9
    s_max_u32 s99, s99, 1
    v_cvt_f32_u32 v84, v76
    v_add_f32 v84, -0.5, v84
    v_max_f32 v104, v104, v84
    v_cvt_f32_u32 v85, v77
    v_add_f32 v85, -0.5, v85
    v_max_f32 v105, v105, v85
    v_cvt_f32_u32 v86, v78
    v_add_f32 v86, -0.5, v86
    v_max_f32 v106, v106, v86
    v_cvt_f32_u32 v87, v79
    v_add_f32 v87, -0.5, v87
    v_max_f32 v107, v107, v87
K2_DLOOP:
    v_cvt_f32_u32 v220, s99
    v_rcp_f32 v221, v220
    v_add_f32 v88, v104, v220
    v_add_f32 v89, v105, v220
    v_add_f32 v90, v106, v220
    v_add_f32 v91, v107, v220
    v_mul_f32 v88, v88, v221
    v_cvt_u32_f32 v88, v88
    v_mul_f32 v89, v89, v221
    v_cvt_u32_f32 v89, v89
    v_mul_f32 v90, v90, v221
    v_cvt_u32_f32 v90, v90
    v_mul_f32 v91, v91, v221
    v_cvt_u32_f32 v91, v91
    v_add_u32 v222, v88, v89
    v_add3_u32 v222, v222, v90, v91
    s_nop 1
    v_add_u32_dpp v222, v222, v222 row_shr:1 row_mask:0xf bank_mask:0xf
    s_nop 1
    v_add_u32_dpp v222, v222, v222 row_shr:2 row_mask:0xf bank_mask:0xf
    s_nop 1
    v_add_u32_dpp v222, v222, v222 row_shr:4 row_mask:0xf bank_mask:0xf
    s_nop 1
    v_add_u32_dpp v222, v222, v222 row_shr:8 row_mask:0xf bank_mask:0xf
    s_nop 1
    v_add_u32_dpp v222, v222, v222 row_bcast:15 row_mask:0xa bank_mask:0xf
    s_nop 1
    v_add_u32_dpp v222, v222, v222 row_bcast:31 row_mask:0xc bank_mask:0xf
    s_nop 0
    v_readlane_b32 s95, v222, 63
    s_add_u32 s99, s99, 1
    s_cmp_gt_u32 s95, 255
    s_cbranch_scc1 K2_DLOOP
    v_cvt_f32_u32 v92, v88
    v_rcp_f32 v96, v92
    v_add_f32 v92, v92, v84
    v_cmp_eq_u32_e64 s[48:49], 1, v88
    v_lshlrev_b32 v44, 16, v88
    v_cvt_f32_u32 v93, v89
    v_rcp_f32 v97, v93
    v_add_f32 v93, v93, v85
    v_cmp_eq_u32_e64 s[50:51], 1, v89
    v_lshlrev_b32 v45, 16, v89
    v_cvt_f32_u32 v94, v90
    v_rcp_f32 v98, v94
    v_add_f32 v94, v94, v86
    v_cmp_eq_u32_e64 s[52:53], 1, v90
    v_lshlrev_b32 v46, 16, v90
    v_cvt_f32_u32 v95, v91
    v_rcp_f32 v99, v95
    v_add_f32 v95, v95, v87
    v_cmp_eq_u32_e64 s[54:55], 1, v91
    v_lshlrev_b32 v47, 16, v91
    v_cndmask_b32_e64 v44, v44, 1, s[48:49]
    v_cndmask_b32_e64 v45, v45, 1, s[50:51]
    v_cndmask_b32_e64 v46, v46, 1, s[52:53]
    v_cndmask_b32_e64 v47, v47, 1, s[54:55]
    v_mul_f32 v92, v92, v96
    v_cvt_u32_f32 v92, v92
    v_sub_u32 v96, 63, v92
    v_lshlrev_b32 v96, 2, v96
    ds_add_rtn_u32 v100, v96, v44 offset:128
    v_mul_f32 v93, v93, v97
    v_cvt_u32_f32 v93, v93
    v_sub_u32 v97, 63, v93
    v_lshlrev_b32 v97, 2, v97
    ds_add_rtn_u32 v101, v97, v45 offset:128
    v_mul_f32 v94, v94, v98
    v_cvt_u32_f32 v94, v94
    v_sub_u32 v98, 63, v94
    v_lshlrev_b32 v98, 2, v98
    ds_add_rtn_u32 v102, v98, v46 offset:128
    v_mul_f32 v95, v95, v99
    v_cvt_u32_f32 v95, v95
    v_sub_u32 v99, 63, v95
    v_lshlrev_b32 v99, 2, v99
    ds_add_rtn_u32 v103, v99, v47 offset:128
    v_lshrrev_b32 v220, 2, v203
    ds_read_b32 v221, v220 offset:128
    v_add_u32 v222, 0, v250
    v_lshl_or_b32 v172, v222, 24, v60
    v_lshl_or_b32 v172, v92, 18, v172
    v_lshlrev_b32 v173, 3, v88
    v_sub_u32 v222, 1, v92
    v_mad_i32_i24 v76, v222, v88, v76
    v_add_u32 v222, 64, v250
    v_lshl_or_b32 v174, v222, 24, v64
    v_lshl_or_b32 v174, v93, 18, v174
    v_lshlrev_b32 v175, 3, v89
    v_sub_u32 v222, 1, v93
    v_mad_i32_i24 v77, v222, v89, v77
    v_add_u32 v222, 128, v250
    v_lshl_or_b32 v176, v222, 24, v68
    v_lshl_or_b32 v176, v94, 18, v176
    v_lshlrev_b32 v177, 3, v90
    v_sub_u32 v222, 1, v94
    v_mad_i32_i24 v78, v222, v90, v78
    v_add_u32 v222, 192, v250
    v_lshl_or_b32 v178, v222, 24, v72
    v_lshl_or_b32 v178, v95, 18, v178
    v_lshlrev_b32 v179, 3, v91
    v_sub_u32 v222, 1, v95
    v_mad_i32_i24 v79, v222, v91, v79
    v_max3_u32 v224, v88, v89, v90
    v_max_u32 v224, v224, v91
    v_mov_b32 v225, -262136
    s_mov_b32 s99, 0
    s_waitcnt lgkmcnt(0)
    v_mov_b32 v222, v221
    v_and_b32 v57, 0xffff, v221
    v_cmp_ne_u32 vcc, 0, v57
    v_and_b32 v52, 0xffff, v100
    v_lshrrev_b32 v100, 16, v100
    v_add_u32_dpp v222, v222, v222 row_shr:1 row_mask:0xf bank_mask:0xf
    v_min_u32 v48, 1, v52
    v_cndmask_b32_e64 v100, v100, v52, s[48:49]
    v_add_u32_dpp v222, v222, v222 row_shr:2 row_mask:0xf bank_mask:0xf
    v_mad_i32_i24 v48, v48, -10, 20
    v_cndmask_b32_e64 v48, 0, v48, s[48:49]
    v_add_u32_dpp v222, v222, v222 row_shr:4 row_mask:0xf bank_mask:0xf
    v_and_b32 v53, 0xffff, v101
    v_lshrrev_b32 v101, 16, v101
    v_add_u32_dpp v222, v222, v222 row_shr:8 row_mask:0xf bank_mask:0xf
    v_min_u32 v49, 1, v53
    v_cndmask_b32_e64 v101, v101, v53, s[50:51]
    v_add_u32_dpp v222, v222, v222 row_bcast:15 row_mask:0xa bank_mask:0xf
    v_mad_i32_i24 v49, v49, -10, 20
    v_cndmask_b32_e64 v49, 0, v49, s[50:51]
    v_add_u32_dpp v222, v222, v222 row_bcast:31 row_mask:0xc bank_mask:0xf
    v_lshrrev_b32 v58, 16, v222
    v_cndmask_b32 v56, 0, v58, vcc
    v_sub_u32 v222, v222, v221
    v_and_b32 v54, 0xffff, v102
    v_lshrrev_b32 v102, 16, v102
    v_max_u32_dpp v56, v56, v56 row_shr:1 row_mask:0xf bank_mask:0xf
    v_min_u32 v50, 1, v54
    v_cndmask_b32_e64 v102, v102, v54, s[52:53]
    v_max_u32_dpp v56, v56, v56 row_shr:2 row_mask:0xf bank_mask:0xf
    v_mad_i32_i24 v50, v50, -10, 20
    v_cndmask_b32_e64 v50, 0, v50, s[52:53]
    v_max_u32_dpp v56, v56, v56 row_shr:4 row_mask:0xf bank_mask:0xf
    v_and_b32 v55, 0xffff, v103
    v_lshrrev_b32 v103, 16, v103
    v_max_u32_dpp v56, v56, v56 row_shr:8 row_mask:0xf bank_mask:0xf
    v_min_u32 v51, 1, v55
    v_cndmask_b32_e64 v103, v103, v55, s[54:55]
    v_max_u32_dpp v56, v56, v56 row_bcast:15 row_mask:0xa bank_mask:0xf
    v_mad_i32_i24 v51, v51, -10, 20
    v_cndmask_b32_e64 v51, 0, v51, s[54:55]
    v_max_u32_dpp v56, v56, v56 row_bcast:31 row_mask:0xc bank_mask:0xf
    v_and_b32 v57, 0xffff, v222
    v_and_b32 v221, 1, v222
    v_mov_b32_dpp v56, v56 wave_shr:1 row_mask:0xf bank_mask:0xf
    v_cmp_eq_u32 vcc, 1, v221
    v_lshrrev_b32 v222, 16, v222
    v_add3_u32 v222, v222, v57, v221
    v_cndmask_b32 v56, v58, v56, vcc
    v_add_u32 v58, v58, v57
    v_add_u32 v56, v56, v57
    v_lshl_or_b32 v222, v58, 10, v222
    v_lshl_or_b32 v222, v56, 20, v222
    ds_bpermute_b32 v96, v96, v222
    ds_bpermute_b32 v97, v97, v222
    ds_bpermute_b32 v98, v98, v222
    ds_bpermute_b32 v99, v99, v222
    s_waitcnt lgkmcnt(3)
    v_bfe_u32 v96, v96, v48, 10
    v_add_lshl_u32 v96, v96, v100, 2
    v_lshl_or_b32 v222, v88, 16, v96
    v_lshlrev_b32 v96, 1, v96
    ds_write_b32 v220, v222 offset:32768
    s_waitcnt lgkmcnt(3)
    v_bfe_u32 v97, v97, v49, 10
    v_add_lshl_u32 v97, v97, v101, 2
    v_lshl_or_b32 v222, v89, 16, v97
    v_lshlrev_b32 v97, 1, v97
    ds_write_b32 v220, v222 offset:33024
    s_waitcnt lgkmcnt(3)
    v_bfe_u32 v98, v98, v50, 10
    v_add_lshl_u32 v98, v98, v102, 2
    v_lshl_or_b32 v222, v90, 16, v98
    v_lshlrev_b32 v98, 1, v98
    ds_write_b32 v220, v222 offset:33280
    s_waitcnt lgkmcnt(3)
    v_bfe_u32 v99, v99, v51, 10
    v_add_lshl_u32 v99, v99, v103, 2
    v_lshl_or_b32 v222, v91, 16, v99
    v_lshlrev_b32 v99, 1, v99
    ds_write_b32 v220, v222 offset:33536
K2_PLOOP:
    v_cmp_lt_u32_e64 s[32:33], s99, v88
    v_cmp_lt_u32_e64 s[34:35], s99, v89
    v_cmp_lt_u32_e64 s[36:37], s99, v90
    v_cmp_lt_u32_e64 s[38:39], s99, v91
    s_add_u32 s99, s99, 1
    v_cmp_eq_u32_e64 s[40:41], s99, v76
    v_cmp_eq_u32_e64 s[42:43], s99, v77
    v_cmp_eq_u32_e64 s[44:45], s99, v78
    v_cmp_eq_u32_e64 s[46:47], s99, v79
    s_mov_b64 exec, s[32:33]
    ds_write_b64 v96, v[172:173] offset:512
    s_mov_b64 exec, s[34:35]
    ds_write_b64 v97, v[174:175] offset:512
    s_mov_b64 exec, s[36:37]
    ds_write_b64 v98, v[176:177] offset:512
    s_mov_b64 exec, s[38:39]
    ds_write_b64 v99, v[178:179] offset:512
    s_mov_b64 exec, -1
    v_cmp_lt_u32 vcc, s99, v224
    v_cndmask_b32_e64 v222, 8, v225, s[40:41]
    v_add_u32 v172, v172, v222
    v_add_u32 v96, 8, v96
    v_cndmask_b32_e64 v222, 8, v225, s[42:43]
    v_add_u32 v174, v174, v222
    v_add_u32 v97, 8, v97
    v_cndmask_b32_e64 v222, 8, v225, s[44:45]
    v_add_u32 v176, v176, v222
    v_add_u32 v98, 8, v98
    v_cndmask_b32_e64 v222, 8, v225, s[46:47]
    v_add_u32 v178, v178, v222
    v_add_u32 v99, 8, v99
    s_cbranch_vccnz K2_PLOOP
    v_mov_b32 v222, s99
    ds_write_b32 v228, v222 offset:104
    s_waitcnt vmcnt(0)
K2_B3:
    s_mov_b64 exec, -1
    s_lshl_b32 s95, s100, 8
    v_and_b32 v220, 31, v250
    v_lshl_add_u32 v220, v220, 3, s95
    s_mov_b32 s6, 0
    s_waitcnt vmcnt(3) lgkmcnt(0)
    s_barrier
    ds_read_b64 v[220:221], v220 offset:512
    ds_read_b32 v222, v229 offset:104
    s_waitcnt lgkmcnt(0)
    v_bfe_u32 v235, v220, 18, 6
    v_and_b32 v207, 0x3ffff, v220
    v_lshrrev_b32 v249, 24, v220
    v_mov_b32 v206, v221
    v_readfirstlane_b32 s97, v222
    v_cmp_lt_u32_e64 s[28:29], s6, v235
    s_add_u32 s6, s6, 1
    v_add_u32 v221, s4, v249
    buffer_load_dwordx2 v[240:241], v221, s[16:19], 0 idxen
    v_cndmask_b32_e64 v203, 0, v207, s[28:29]
    v_add_u32 v207, v207, v206
    ds_read_b32 v218, v203
    ds_read_u16 v203, v203 offset:4
    v_bfe_u32 v220, v249, 1, 3
    v_lshlrev_b32 v220, 4, v220
    v_lshlrev_b32 v221, 2, v219
    v_xor_b32 v220, v220, v221
    v_lshl_add_u32 v220, v249, 7, v220
    v_add_u32 v220, 100352, v220
    v_xor_b32 v221, 16, v220
    v_xor_b32 v222, 32, v220
    v_xor_b32 v223, 48, v220
    s_waitcnt lgkmcnt(0)
    ds_bpermute_b32 v210, v239, v203 offset:0
    ds_bpermute_b32 v212, v239, v203 offset:32
    ds_bpermute_b32 v214, v239, v203 offset:64
    ds_bpermute_b32 v216, v239, v203 offset:96
    ds_read_b128 v[172:175], v220
    ds_read_b128 v[176:179], v221
    ds_read_b128 v[180:183], v222
    ds_read_b128 v[184:187], v223
    buffer_load_dwordx4 v[188:191], v[218:219], s[12:15], 0 idxen offen
    buffer_load_dwordx2 v[200:201], v203, s[16:19], 0 idxen
    v_cmp_lt_u32_e64 s[30:31], s6, v235
    s_add_u32 s6, s6, 1
    s_cmp_eq_u64 s[28:29], 0
    s_cbranch_scc1 K2_EMPTY
    s_waitcnt lgkmcnt(4)
    s_add_u32 m0, s94, 0
    s_nop 0
    buffer_load_dwordx4 v[210:211], s[8:11], 0 idxen offen lds
    s_add_u32 m0, s94, 1024
    s_nop 0
    buffer_load_dwordx4 v[212:213], s[8:11], 0 idxen offen lds
    s_add_u32 m0, s94, 2048
    s_nop 0
    buffer_load_dwordx4 v[214:215], s[8:11], 0 idxen offen lds
    s_add_u32 m0, s94, 3072
    s_nop 0
    buffer_load_dwordx4 v[216:217], s[8:11], 0 idxen offen lds
    v_cndmask_b32_e64 v203, 0, v207, s[30:31]
    v_add_u32 v207, v207, v206
    ds_read_b32 v218, v203
    ds_read_u16 v203, v203 offset:4
    s_waitcnt lgkmcnt(0)
    ds_bpermute_b32 v210, v239, v203 offset:0
    ds_bpermute_b32 v212, v239, v203 offset:32
    ds_bpermute_b32 v214, v239, v203 offset:64
    ds_bpermute_b32 v216, v239, v203 offset:96
    buffer_load_dwordx4 v[192:195], v[218:219], s[12:15], 0 idxen offen
    buffer_load_dwordx2 v[204:205], v203, s[16:19], 0 idxen
    v_cmp_lt_u32_e64 s[32:33], s6, v235
    s_add_u32 s6, s6, 1
    s_waitcnt lgkmcnt(0)
    s_add_u32 m0, s94, 32768
    s_nop 0
    buffer_load_dwordx4 v[210:211], s[8:11], 0 idxen offen lds
    s_add_u32 m0, s94, 33792
    s_nop 0
    buffer_load_dwordx4 v[212:213], s[8:11], 0 idxen offen lds
    s_add_u32 m0, s94, 34816
    s_nop 0
    buffer_load_dwordx4 v[214:215], s[8:11], 0 idxen offen lds
    s_add_u32 m0, s94, 35840
    s_nop 0
    buffer_load_dwordx4 v[216:217], s[8:11], 0 idxen offen lds
    v_cndmask_b32_e64 v203, 0, v207, s[32:33]
    v_add_u32 v207, v207, v206
    ds_read_b32 v218, v203
    ds_read_u16 v203, v203 offset:4
    s_waitcnt lgkmcnt(0)
    ds_bpermute_b32 v210, v239, v203 offset:0
    ds_bpermute_b32 v212, v239, v203 offset:32
    ds_bpermute_b32 v214, v239, v203 offset:64
    ds_bpermute_b32 v216, v239, v203 offset:96
    v_and_b32 v221, 63, v250
    v_lshlrev_b32 v220, 4, v221
    v_lshlrev_b32 v221, 2, v221
    v_add_u32 v220, 138240, v220
    v_lshlrev_b32 v222, 3, v219
    v_add_u32 v221, 156672, v221
    v_add_u32 v222, 157696, v222
    ds_read_b128 v[140:143], v220 offset:0
    ds_read_b128 v[144:147], v220 offset:1024
    ds_read_b128 v[148:151], v220 offset:2048
    ds_read_b128 v[152:155], v220 offset:3072
    ds_read_b128 v[156:159], v220 offset:4096
    ds_read_b128 v[160:163], v220 offset:5120
    ds_read_b128 v[164:167], v220 offset:6144
    ds_read_b128 v[168:171], v220 offset:7168
    ds_read_b128 v[0:3], v220 offset:8192
    ds_read_b128 v[4:7], v220 offset:9216
    ds_read_b128 v[8:11], v220 offset:10240
    ds_read_b128 v[12:15], v220 offset:11264
    ds_read_b128 v[16:19], v220 offset:12288
    ds_read_b128 v[20:23], v220 offset:13312
    ds_read_b128 v[24:27], v220 offset:14336
    ds_read_b128 v[28:31], v220 offset:15360
    ds_read_b128 v[32:35], v220 offset:16384
    ds_read_b128 v[36:39], v220 offset:17408
    ds_read_b32 v40, v221
    ds_read_b32 v42, v221 offset:256
    ds_read_b128 v[108:111], v222 offset:0
    ds_read_b128 v[112:115], v222 offset:16
    ds_read_b128 v[116:119], v222 offset:32
    ds_read_b128 v[120:123], v222 offset:48
    ds_read_b128 v[124:127], v222 offset:64
    ds_read_b128 v[128:131], v222 offset:80
    ds_read_b128 v[132:135], v222 offset:96
    ds_read_b128 v[136:139], v222 offset:112
    v_mov_b32 v76, 0
    v_mov_b32 v77, 0
    v_mov_b32 v78, 0
    v_mov_b32 v79, 0
    v_mov_b32 v80, 0
    v_mov_b32 v81, 0
    v_mov_b32 v82, 0
    v_mov_b32 v83, 0
    v_mov_b32 v84, 0
    v_mov_b32 v85, 0
    v_mov_b32 v86, 0
    v_mov_b32 v87, 0
    v_mov_b32 v88, 0
    v_mov_b32 v89, 0
    v_mov_b32 v90, 0
    v_mov_b32 v91, 0
    v_mov_b32 v92, 0
    v_mov_b32 v93, 0
    v_mov_b32 v94, 0
    v_mov_b32 v95, 0
    v_mov_b32 v96, 0
    v_mov_b32 v97, 0
    v_mov_b32 v98, 0
    v_mov_b32 v99, 0
    v_mov_b32 v100, 0
    v_mov_b32 v101, 0
    v_mov_b32 v102, 0
    v_mov_b32 v103, 0
    v_mov_b32 v104, 0
    v_mov_b32 v105, 0
    v_mov_b32 v106, 0
    v_mov_b32 v107, 0
    v_mov_b32 v244, 0
    v_mov_b32 v245, 0
    v_mov_b32 v246, 0
    v_mov_b32 v247, 0
    s_waitcnt lgkmcnt(0)
    v_mfma_f32_32x32x16_bf16 v[44:59], v[140:143], v[172:175], 0
    v_mfma_f32_32x32x16_bf16 v[60:75], v[156:159], v[172:175], 0
    v_mfma_f32_32x32x16_bf16 v[44:59], v[144:147], v[176:179], v[44:59]
    v_mfma_f32_32x32x16_bf16 v[60:75], v[160:163], v[176:179], v[60:75]
    v_mfma_f32_32x32x16_bf16 v[44:59], v[148:151], v[180:183], v[44:59]
    v_mfma_f32_32x32x16_bf16 v[60:75], v[164:167], v[180:183], v[60:75]
    v_mfma_f32_32x32x16_bf16 v[44:59], v[152:155], v[184:187], v[44:59]
    v_mfma_f32_32x32x16_bf16 v[60:75], v[168:171], v[184:187], v[60:75]
    s_waitcnt vmcnt(6)
    ds_read_b128 v[172:175], v251 offset:0
    ds_read_b128 v[176:179], v252 offset:0
    ds_read_b128 v[180:183], v253 offset:0
    ds_read_b128 v[184:187], v254 offset:0
    v_mov_b32 v242, v241
    v_and_b32 v241, 0xffff0000, v240
    v_lshlrev_b32 v240, 16, v240
    v_lshlrev_b32 v232, 16, v200
    v_and_b32 v233, 0xffff0000, v200
    v_sub_f32 v234, v242, v201
    v_pk_add_f32 v[232:233], v[240:241], v[232:233] neg_lo:[0,1] neg_hi:[0,1]
    v_mul_f32 v208, v232, v232
    v_fmac_f32 v208, v233, v233
    v_fmac_f32 v208, v234, v234
    v_cvt_pk_bf16_f32 v208, v208, v208
    s_waitcnt lgkmcnt(0)
    s_nop 0
    v_mfma_f32_32x32x8_bf16 v[140:155], v[40:41], v[208:209], v[44:59]
    v_mfma_f32_32x32x16_bf16 v[140:155], v[32:35], v[188:191], v[140:155]
    v_mfma_f32_32x32x16_bf16 v[140:155], v[0:3], v[172:175], v[140:155]
    v_mfma_f32_32x32x16_bf16 v[140:155], v[4:7], v[176:179], v[140:155]
    v_mfma_f32_32x32x16_bf16 v[140:155], v[8:11], v[180:183], v[140:155]
    v_mfma_f32_32x32x16_bf16 v[140:155], v[12:15], v[184:187], v[140:155]
    s_nop 7
K2_LOOP:
    v_mfma_f32_32x32x8_bf16 v[156:171], v[42:43], v[208:209], v[60:75]
    s_mov_b64 exec, s[28:29]
    s_nop 1
    v_exp_f32 v220, v140
    v_exp_f32 v221, v141
    v_exp_f32 v222, v142
    v_exp_f32 v223, v143
    v_mfma_f32_32x32x16_bf16 v[156:171], v[36:39], v[188:191], v[156:171]
    v_exp_f32 v224, v144
    v_exp_f32 v225, v145
    s_bitcmp1_b32 s5, 2
    s_cbranch_scc0 K2_VP1
    s_setprio 1
K2_VP1:
    s_waitcnt lgkmcnt(0)
    s_mov_b64 exec, -1
    s_add_u32 m0, s94, 0
    s_nop 0
    buffer_load_dwordx4 v[210:211], s[8:11], 0 idxen offen lds
    s_add_u32 m0, s94, 1024
    s_nop 0
    buffer_load_dwordx4 v[212:213], s[8:11], 0 idxen offen lds
    s_add_u32 m0, s94, 2048
    s_nop 0
    buffer_load_dwordx4 v[214:215], s[8:11], 0 idxen offen lds
    s_add_u32 m0, s94, 3072
    s_nop 0
    buffer_load_dwordx4 v[216:217], s[8:11], 0 idxen offen lds
    s_mov_b64 exec, s[28:29]
    s_setprio 0
    v_exp_f32 v226, v146
    v_exp_f32 v227, v147
    v_pk_add_f32 v[220:221], v[220:221], 1.0 op_sel_hi:[1,0]
    v_pk_add_f32 v[222:223], v[222:223], 1.0 op_sel_hi:[1,0]
    v_pk_add_f32 v[224:225], v[224:225], 1.0 op_sel_hi:[1,0]
    v_pk_add_f32 v[226:227], v[226:227], 1.0 op_sel_hi:[1,0]
    v_mfma_f32_32x32x16_bf16 v[156:171], v[16:19], v[172:175], v[156:171]
    v_rcp_f32 v220, v220
    v_rcp_f32 v221, v221
    v_rcp_f32 v222, v222
    v_rcp_f32 v223, v223
    v_mfma_f32_32x32x16_bf16 v[156:171], v[20:23], v[176:179], v[156:171]
    v_rcp_f32 v224, v224
    v_rcp_f32 v225, v225
    v_rcp_f32 v226, v226
    v_rcp_f32 v227, v227
    v_pk_fma_f32 v[76:77], v[140:141], v[220:221], v[76:77]
    v_pk_fma_f32 v[78:79], v[142:143], v[222:223], v[78:79]
    v_pk_fma_f32 v[80:81], v[144:145], v[224:225], v[80:81]
    v_pk_fma_f32 v[82:83], v[146:147], v[226:227], v[82:83]
    v_pk_mul_f32 v[228:229], v[76:77], v[108:109]
    v_pk_mul_f32 v[230:231], v[78:79], v[110:111]
    v_pk_fma_f32 v[228:229], v[80:81], v[112:113], v[228:229]
    v_pk_fma_f32 v[230:231], v[82:83], v[114:115], v[230:231]
    v_mfma_f32_32x32x16_bf16 v[156:171], v[24:27], v[180:183], v[156:171]
    v_exp_f32 v220, v148
    v_exp_f32 v221, v149
    v_exp_f32 v222, v150
    v_exp_f32 v223, v151
    v_mfma_f32_32x32x16_bf16 v[156:171], v[28:31], v[184:187], v[156:171]
    s_mov_b64 exec, -1
    buffer_load_dwordx4 v[196:199], v[218:219], s[12:15], 0 idxen offen
    buffer_load_dwordx2 v[200:201], v203, s[16:19], 0 idxen
    s_mov_b64 exec, s[28:29]
    v_exp_f32 v224, v152
    v_exp_f32 v225, v153
    v_exp_f32 v226, v154
    v_exp_f32 v227, v155
    s_waitcnt vmcnt(6)
    ds_read_b128 v[172:175], v251 offset:32768
    ds_read_b128 v[176:179], v252 offset:32768
    ds_read_b128 v[180:183], v253 offset:32768
    ds_read_b128 v[184:187], v254 offset:32768
    v_cmp_lt_u32_e64 s[34:35], s6, v235
    s_add_u32 s6, s6, 1
    v_lshlrev_b32 v236, 16, v204
    v_and_b32 v237, 0xffff0000, v204
    v_sub_f32 v238, v242, v205
    v_pk_add_f32 v[236:237], v[240:241], v[236:237] neg_lo:[0,1] neg_hi:[0,1]
    v_mul_f32 v208, v236, v236
    v_fmac_f32 v208, v237, v237
    v_fmac_f32 v208, v238, v238
    v_cvt_pk_bf16_f32 v208, v208, v208
    v_cndmask_b32_e64 v203, 0, v207, s[34:35]
    v_add_u32 v207, v207, v206
    ds_read_b32 v218, v203
    ds_read_u16 v203, v203 offset:4
    v_pk_add_f32 v[220:221], v[220:221], 1.0 op_sel_hi:[1,0]
    v_pk_add_f32 v[222:223], v[222:223], 1.0 op_sel_hi:[1,0]
    v_pk_add_f32 v[224:225], v[224:225], 1.0 op_sel_hi:[1,0]
    v_pk_add_f32 v[226:227], v[226:227], 1.0 op_sel_hi:[1,0]
    v_rcp_f32 v220, v220
    v_rcp_f32 v221, v221
    v_rcp_f32 v222, v222
    v_rcp_f32 v223, v223
    v_rcp_f32 v224, v224
    v_rcp_f32 v225, v225
    v_rcp_f32 v226, v226
    v_rcp_f32 v227, v227
    s_waitcnt lgkmcnt(0)
    s_mov_b64 exec, -1
    ds_bpermute_b32 v210, v239, v203 offset:0
    ds_bpermute_b32 v212, v239, v203 offset:32
    ds_bpermute_b32 v214, v239, v203 offset:64
    ds_bpermute_b32 v216, v239, v203 offset:96
    s_mov_b64 exec, s[28:29]
    v_pk_fma_f32 v[84:85], v[148:149], v[220:221], v[84:85]
    v_pk_fma_f32 v[86:87], v[150:151], v[222:223], v[86:87]
    v_pk_fma_f32 v[88:89], v[152:153], v[224:225], v[88:89]
    v_pk_fma_f32 v[90:91], v[154:155], v[226:227], v[90:91]
    v_pk_fma_f32 v[228:229], v[84:85], v[116:117], v[228:229]
    v_pk_fma_f32 v[230:231], v[86:87], v[118:119], v[230:231]
    v_pk_fma_f32 v[228:229], v[88:89], v[120:121], v[228:229]
    v_pk_fma_f32 v[230:231], v[90:91], v[122:123], v[230:231]
    v_mfma_f32_32x32x8_bf16 v[140:155], v[40:41], v[208:209], v[44:59]
    v_exp_f32 v220, v156
    v_exp_f32 v221, v157
    v_exp_f32 v222, v158
    v_exp_f32 v223, v159
    v_mfma_f32_32x32x16_bf16 v[140:155], v[32:35], v[192:195], v[140:155]
    v_exp_f32 v224, v160
    v_exp_f32 v225, v161
    v_exp_f32 v226, v162
    v_exp_f32 v227, v163
    v_pk_add_f32 v[220:221], v[220:221], 1.0 op_sel_hi:[1,0]
    v_pk_add_f32 v[222:223], v[222:223], 1.0 op_sel_hi:[1,0]
    v_pk_add_f32 v[224:225], v[224:225], 1.0 op_sel_hi:[1,0]
    v_pk_add_f32 v[226:227], v[226:227], 1.0 op_sel_hi:[1,0]
    v_mfma_f32_32x32x16_bf16 v[140:155], v[0:3], v[172:175], v[140:155]
    v_rcp_f32 v220, v220
    v_rcp_f32 v221, v221
    v_rcp_f32 v222, v222
    v_rcp_f32 v223, v223
    v_mfma_f32_32x32x16_bf16 v[140:155], v[4:7], v[176:179], v[140:155]
    v_rcp_f32 v224, v224
    v_rcp_f32 v225, v225
    v_rcp_f32 v226, v226
    v_rcp_f32 v227, v227
    v_pk_fma_f32 v[92:93], v[156:157], v[220:221], v[92:93]
    v_pk_fma_f32 v[94:95], v[158:159], v[222:223], v[94:95]
    v_pk_fma_f32 v[96:97], v[160:161], v[224:225], v[96:97]
    v_pk_fma_f32 v[98:99], v[162:163], v[226:227], v[98:99]
    v_pk_fma_f32 v[228:229], v[92:93], v[124:125], v[228:229]
    v_pk_fma_f32 v[230:231], v[94:95], v[126:127], v[230:231]
    v_pk_fma_f32 v[228:229], v[96:97], v[128:129], v[228:229]
    v_pk_fma_f32 v[230:231], v[98:99], v[130:131], v[230:231]
    v_mfma_f32_32x32x16_bf16 v[140:155], v[8:11], v[180:183], v[140:155]
    v_exp_f32 v220, v164
    v_exp_f32 v221, v165
    v_exp_f32 v222, v166
    v_exp_f32 v223, v167
    v_mfma_f32_32x32x16_bf16 v[140:155], v[12:15], v[184:187], v[140:155]
    v_exp_f32 v224, v168
    v_exp_f32 v225, v169
    v_exp_f32 v226, v170
    v_exp_f32 v227, v171
    v_pk_add_f32 v[220:221], v[220:221], 1.0 op_sel_hi:[1,0]
    v_pk_add_f32 v[222:223], v[222:223], 1.0 op_sel_hi:[1,0]
    v_pk_add_f32 v[224:225], v[224:225], 1.0 op_sel_hi:[1,0]
    v_pk_add_f32 v[226:227], v[226:227], 1.0 op_sel_hi:[1,0]
    v_rcp_f32 v220, v220
    v_rcp_f32 v221, v221
    v_rcp_f32 v222, v222
    v_rcp_f32 v223, v223
    v_rcp_f32 v224, v224
    v_rcp_f32 v225, v225
    v_rcp_f32 v226, v226
    v_rcp_f32 v227, v227
    v_pk_fma_f32 v[100:101], v[164:165], v[220:221], v[100:101]
    v_pk_fma_f32 v[102:103], v[166:167], v[222:223], v[102:103]
    v_pk_fma_f32 v[104:105], v[168:169], v[224:225], v[104:105]
    v_pk_fma_f32 v[106:107], v[170:171], v[226:227], v[106:107]
    v_pk_fma_f32 v[228:229], v[100:101], v[132:133], v[228:229]
    v_pk_fma_f32 v[230:231], v[102:103], v[134:135], v[230:231]
    v_pk_fma_f32 v[228:229], v[104:105], v[136:137], v[228:229]
    v_pk_fma_f32 v[230:231], v[106:107], v[138:139], v[230:231]
    v_pk_add_f32 v[228:229], v[228:229], v[230:231]
    s_cmp_eq_u64 s[30:31], 0
    v_add_f32 v243, v228, v229
    v_sub_f32 v248, v243, v247
    v_pk_fma_f32 v[244:245], v[232:233], v[248:249], v[244:245] op_sel_hi:[1,0,1]
    v_fmac_f32 v246, v234, v248
    s_mov_b64 exec, -1
    s_cbranch_scc1 K2_DONE
    v_mfma_f32_32x32x8_bf16 v[156:171], v[42:43], v[208:209], v[60:75]
    s_mov_b64 exec, s[30:31]
    v_exp_f32 v220, v140
    v_exp_f32 v221, v141
    v_exp_f32 v222, v142
    v_exp_f32 v223, v143
    v_mfma_f32_32x32x16_bf16 v[156:171], v[36:39], v[192:195], v[156:171]
    v_exp_f32 v224, v144
    v_exp_f32 v225, v145
    s_bitcmp1_b32 s5, 2
    s_cbranch_scc0 K2_VP3
    s_setprio 1
K2_VP3:
    s_waitcnt lgkmcnt(0)
    s_mov_b64 exec, -1
    s_add_u32 m0, s94, 32768
    s_nop 0
    buffer_load_dwordx4 v[210:211], s[8:11], 0 idxen offen lds
    s_add_u32 m0, s94, 33792
    s_nop 0
    buffer_load_dwordx4 v[212:213], s[8:11], 0 idxen offen lds
    s_add_u32 m0, s94, 34816
    s_nop 0
    buffer_load_dwordx4 v[214:215], s[8:11], 0 idxen offen lds
    s_add_u32 m0, s94, 35840
    s_nop 0
    buffer_load_dwordx4 v[216:217], s[8:11], 0 idxen offen lds
    s_mov_b64 exec, s[30:31]
    s_setprio 0
    v_exp_f32 v226, v146
    v_exp_f32 v227, v147
    v_pk_add_f32 v[220:221], v[220:221], 1.0 op_sel_hi:[1,0]
    v_pk_add_f32 v[222:223], v[222:223], 1.0 op_sel_hi:[1,0]
    v_pk_add_f32 v[224:225], v[224:225], 1.0 op_sel_hi:[1,0]
    v_pk_add_f32 v[226:227], v[226:227], 1.0 op_sel_hi:[1,0]
    v_mfma_f32_32x32x16_bf16 v[156:171], v[16:19], v[172:175], v[156:171]
    v_rcp_f32 v220, v220
    v_rcp_f32 v221, v221
    v_rcp_f32 v222, v222
    v_rcp_f32 v223, v223
    v_mfma_f32_32x32x16_bf16 v[156:171], v[20:23], v[176:179], v[156:171]
    v_rcp_f32 v224, v224
    v_rcp_f32 v225, v225
    v_rcp_f32 v226, v226
    v_rcp_f32 v227, v227
    v_pk_fma_f32 v[76:77], v[140:141], v[220:221], v[76:77]
    v_pk_fma_f32 v[78:79], v[142:143], v[222:223], v[78:79]
    v_pk_fma_f32 v[80:81], v[144:145], v[224:225], v[80:81]
    v_pk_fma_f32 v[82:83], v[146:147], v[226:227], v[82:83]
    v_pk_mul_f32 v[228:229], v[76:77], v[108:109]
    v_pk_mul_f32 v[230:231], v[78:79], v[110:111]
    v_pk_fma_f32 v[228:229], v[80:81], v[112:113], v[228:229]
    v_pk_fma_f32 v[230:231], v[82:83], v[114:115], v[230:231]
    v_mfma_f32_32x32x16_bf16 v[156:171], v[24:27], v[180:183], v[156:171]
    v_exp_f32 v220, v148
    v_exp_f32 v221, v149
    v_exp_f32 v222, v150
    v_exp_f32 v223, v151
    v_mfma_f32_32x32x16_bf16 v[156:171], v[28:31], v[184:187], v[156:171]
    s_mov_b64 exec, -1
    buffer_load_dwordx4 v[188:191], v[218:219], s[12:15], 0 idxen offen
    buffer_load_dwordx2 v[204:205], v203, s[16:19], 0 idxen
    s_mov_b64 exec, s[30:31]
    v_exp_f32 v224, v152
    v_exp_f32 v225, v153
    v_exp_f32 v226, v154
    v_exp_f32 v227, v155
    s_waitcnt vmcnt(6)
    ds_read_b128 v[172:175], v251 offset:0
    ds_read_b128 v[176:179], v252 offset:0
    ds_read_b128 v[180:183], v253 offset:0
    ds_read_b128 v[184:187], v254 offset:0
    v_cmp_lt_u32_e64 s[36:37], s6, v235
    s_add_u32 s6, s6, 1
    v_lshlrev_b32 v232, 16, v200
    v_and_b32 v233, 0xffff0000, v200
    v_sub_f32 v234, v242, v201
    v_pk_add_f32 v[232:233], v[240:241], v[232:233] neg_lo:[0,1] neg_hi:[0,1]
    v_mul_f32 v208, v232, v232
    v_fmac_f32 v208, v233, v233
    v_fmac_f32 v208, v234, v234
    v_cvt_pk_bf16_f32 v208, v208, v208
    v_cndmask_b32_e64 v203, 0, v207, s[36:37]
    v_add_u32 v207, v207, v206
    ds_read_b32 v218, v203
    ds_read_u16 v203, v203 offset:4
    v_pk_add_f32 v[220:221], v[220:221], 1.0 op_sel_hi:[1,0]
    v_pk_add_f32 v[222:223], v[222:223], 1.0 op_sel_hi:[1,0]
    v_pk_add_f32 v[224:225], v[224:225], 1.0 op_sel_hi:[1,0]
    v_pk_add_f32 v[226:227], v[226:227], 1.0 op_sel_hi:[1,0]
    v_rcp_f32 v220, v220
    v_rcp_f32 v221, v221
    v_rcp_f32 v222, v222
    v_rcp_f32 v223, v223
    v_rcp_f32 v224, v224
    v_rcp_f32 v225, v225
    v_rcp_f32 v226, v226
    v_rcp_f32 v227, v227
    s_waitcnt lgkmcnt(0)
    s_mov_b64 exec, -1
    ds_bpermute_b32 v210, v239, v203 offset:0
    ds_bpermute_b32 v212, v239, v203 offset:32
    ds_bpermute_b32 v214, v239, v203 offset:64
    ds_bpermute_b32 v216, v239, v203 offset:96
    s_mov_b64 exec, s[30:31]
    v_pk_fma_f32 v[84:85], v[148:149], v[220:221], v[84:85]
    v_pk_fma_f32 v[86:87], v[150:151], v[222:223], v[86:87]
    v_pk_fma_f32 v[88:89], v[152:153], v[224:225], v[88:89]
    v_pk_fma_f32 v[90:91], v[154:155], v[226:227], v[90:91]
    v_pk_fma_f32 v[228:229], v[84:85], v[116:117], v[228:229]
    v_pk_fma_f32 v[230:231], v[86:87], v[118:119], v[230:231]
    v_pk_fma_f32 v[228:229], v[88:89], v[120:121], v[228:229]
    v_pk_fma_f32 v[230:231], v[90:91], v[122:123], v[230:231]
    v_mfma_f32_32x32x8_bf16 v[140:155], v[40:41], v[208:209], v[44:59]
    v_exp_f32 v220, v156
    v_exp_f32 v221, v157
    v_exp_f32 v222, v158
    v_exp_f32 v223, v159
    v_mfma_f32_32x32x16_bf16 v[140:155], v[32:35], v[196:199], v[140:155]
    v_exp_f32 v224, v160
    v_exp_f32 v225, v161
    v_exp_f32 v226, v162
    v_exp_f32 v227, v163
    v_pk_add_f32 v[220:221], v[220:221], 1.0 op_sel_hi:[1,0]
    v_pk_add_f32 v[222:223], v[222:223], 1.0 op_sel_hi:[1,0]
    v_pk_add_f32 v[224:225], v[224:225], 1.0 op_sel_hi:[1,0]
    v_pk_add_f32 v[226:227], v[226:227], 1.0 op_sel_hi:[1,0]
    v_mfma_f32_32x32x16_bf16 v[140:155], v[0:3], v[172:175], v[140:155]
    v_rcp_f32 v220, v220
    v_rcp_f32 v221, v221
    v_rcp_f32 v222, v222
    v_rcp_f32 v223, v223
    v_mfma_f32_32x32x16_bf16 v[140:155], v[4:7], v[176:179], v[140:155]
    v_rcp_f32 v224, v224
    v_rcp_f32 v225, v225
    v_rcp_f32 v226, v226
    v_rcp_f32 v227, v227
    v_pk_fma_f32 v[92:93], v[156:157], v[220:221], v[92:93]
    v_pk_fma_f32 v[94:95], v[158:159], v[222:223], v[94:95]
    v_pk_fma_f32 v[96:97], v[160:161], v[224:225], v[96:97]
    v_pk_fma_f32 v[98:99], v[162:163], v[226:227], v[98:99]
    v_pk_fma_f32 v[228:229], v[92:93], v[124:125], v[228:229]
    v_pk_fma_f32 v[230:231], v[94:95], v[126:127], v[230:231]
    v_pk_fma_f32 v[228:229], v[96:97], v[128:129], v[228:229]
    v_pk_fma_f32 v[230:231], v[98:99], v[130:131], v[230:231]
    v_mfma_f32_32x32x16_bf16 v[140:155], v[8:11], v[180:183], v[140:155]
    v_exp_f32 v220, v164
    v_exp_f32 v221, v165
    v_exp_f32 v222, v166
    v_exp_f32 v223, v167
    v_mfma_f32_32x32x16_bf16 v[140:155], v[12:15], v[184:187], v[140:155]
    v_exp_f32 v224, v168
    v_exp_f32 v225, v169
    v_exp_f32 v226, v170
    v_exp_f32 v227, v171
    v_pk_add_f32 v[220:221], v[220:221], 1.0 op_sel_hi:[1,0]
    v_pk_add_f32 v[222:223], v[222:223], 1.0 op_sel_hi:[1,0]
    v_pk_add_f32 v[224:225], v[224:225], 1.0 op_sel_hi:[1,0]
    v_pk_add_f32 v[226:227], v[226:227], 1.0 op_sel_hi:[1,0]
    v_rcp_f32 v220, v220
    v_rcp_f32 v221, v221
    v_rcp_f32 v222, v222
    v_rcp_f32 v223, v223
    v_rcp_f32 v224, v224
    v_rcp_f32 v225, v225
    v_rcp_f32 v226, v226
    v_rcp_f32 v227, v227
    v_pk_fma_f32 v[100:101], v[164:165], v[220:221], v[100:101]
    v_pk_fma_f32 v[102:103], v[166:167], v[222:223], v[102:103]
    v_pk_fma_f32 v[104:105], v[168:169], v[224:225], v[104:105]
    v_pk_fma_f32 v[106:107], v[170:171], v[226:227], v[106:107]
    v_pk_fma_f32 v[228:229], v[100:101], v[132:133], v[228:229]
    v_pk_fma_f32 v[230:231], v[102:103], v[134:135], v[230:231]
    v_pk_fma_f32 v[228:229], v[104:105], v[136:137], v[228:229]
    v_pk_fma_f32 v[230:231], v[106:107], v[138:139], v[230:231]
    v_pk_add_f32 v[228:229], v[228:229], v[230:231]
    s_cmp_eq_u64 s[32:33], 0
    v_add_f32 v247, v228, v229
    v_sub_f32 v248, v247, v243
    v_pk_fma_f32 v[244:245], v[236:237], v[248:249], v[244:245] op_sel_hi:[1,0,1]
    v_fmac_f32 v246, v238, v248
    s_mov_b64 exec, -1
    s_cbranch_scc1 K2_DONE
    v_mfma_f32_32x32x8_bf16 v[156:171], v[42:43], v[208:209], v[60:75]
    s_mov_b64 exec, s[32:33]
    v_exp_f32 v220, v140
    v_exp_f32 v221, v141
    v_exp_f32 v222, v142
    v_exp_f32 v223, v143
    v_mfma_f32_32x32x16_bf16 v[156:171], v[36:39], v[196:199], v[156:171]
    v_exp_f32 v224, v144
    v_exp_f32 v225, v145
    s_bitcmp1_b32 s5, 2
    s_cbranch_scc0 K2_VP5
    s_setprio 1
K2_VP5:
    s_waitcnt lgkmcnt(0)
    s_mov_b64 exec, -1
    s_add_u32 m0, s94, 0
    s_nop 0
    buffer_load_dwordx4 v[210:211], s[8:11], 0 idxen offen lds
    s_add_u32 m0, s94, 1024
    s_nop 0
    buffer_load_dwordx4 v[212:213], s[8:11], 0 idxen offen lds
    s_add_u32 m0, s94, 2048
    s_nop 0
    buffer_load_dwordx4 v[214:215], s[8:11], 0 idxen offen lds
    s_add_u32 m0, s94, 3072
    s_nop 0
    buffer_load_dwordx4 v[216:217], s[8:11], 0 idxen offen lds
    s_mov_b64 exec, s[32:33]
    s_setprio 0
    v_exp_f32 v226, v146
    v_exp_f32 v227, v147
    v_pk_add_f32 v[220:221], v[220:221], 1.0 op_sel_hi:[1,0]
    v_pk_add_f32 v[222:223], v[222:223], 1.0 op_sel_hi:[1,0]
    v_pk_add_f32 v[224:225], v[224:225], 1.0 op_sel_hi:[1,0]
    v_pk_add_f32 v[226:227], v[226:227], 1.0 op_sel_hi:[1,0]
    v_mfma_f32_32x32x16_bf16 v[156:171], v[16:19], v[172:175], v[156:171]
    v_rcp_f32 v220, v220
    v_rcp_f32 v221, v221
    v_rcp_f32 v222, v222
    v_rcp_f32 v223, v223
    v_mfma_f32_32x32x16_bf16 v[156:171], v[20:23], v[176:179], v[156:171]
    v_rcp_f32 v224, v224
    v_rcp_f32 v225, v225
    v_rcp_f32 v226, v226
    v_rcp_f32 v227, v227
    v_pk_fma_f32 v[76:77], v[140:141], v[220:221], v[76:77]
    v_pk_fma_f32 v[78:79], v[142:143], v[222:223], v[78:79]
    v_pk_fma_f32 v[80:81], v[144:145], v[224:225], v[80:81]
    v_pk_fma_f32 v[82:83], v[146:147], v[226:227], v[82:83]
    v_pk_mul_f32 v[228:229], v[76:77], v[108:109]
    v_pk_mul_f32 v[230:231], v[78:79], v[110:111]
    v_pk_fma_f32 v[228:229], v[80:81], v[112:113], v[228:229]
    v_pk_fma_f32 v[230:231], v[82:83], v[114:115], v[230:231]
    v_mfma_f32_32x32x16_bf16 v[156:171], v[24:27], v[180:183], v[156:171]
    v_exp_f32 v220, v148
    v_exp_f32 v221, v149
    v_exp_f32 v222, v150
    v_exp_f32 v223, v151
    v_mfma_f32_32x32x16_bf16 v[156:171], v[28:31], v[184:187], v[156:171]
    s_mov_b64 exec, -1
    buffer_load_dwordx4 v[192:195], v[218:219], s[12:15], 0 idxen offen
    buffer_load_dwordx2 v[200:201], v203, s[16:19], 0 idxen
    s_mov_b64 exec, s[32:33]
    v_exp_f32 v224, v152
    v_exp_f32 v225, v153
    v_exp_f32 v226, v154
    v_exp_f32 v227, v155
    s_waitcnt vmcnt(6)
    ds_read_b128 v[172:175], v251 offset:32768
    ds_read_b128 v[176:179], v252 offset:32768
    ds_read_b128 v[180:183], v253 offset:32768
    ds_read_b128 v[184:187], v254 offset:32768
    v_cmp_lt_u32_e64 s[38:39], s6, v235
    s_add_u32 s6, s6, 1
    v_lshlrev_b32 v236, 16, v204
    v_and_b32 v237, 0xffff0000, v204
    v_sub_f32 v238, v242, v205
    v_pk_add_f32 v[236:237], v[240:241], v[236:237] neg_lo:[0,1] neg_hi:[0,1]
    v_mul_f32 v208, v236, v236
    v_fmac_f32 v208, v237, v237
    v_fmac_f32 v208, v238, v238
    v_cvt_pk_bf16_f32 v208, v208, v208
    v_cndmask_b32_e64 v203, 0, v207, s[38:39]
    v_add_u32 v207, v207, v206
    ds_read_b32 v218, v203
    ds_read_u16 v203, v203 offset:4
    v_pk_add_f32 v[220:221], v[220:221], 1.0 op_sel_hi:[1,0]
    v_pk_add_f32 v[222:223], v[222:223], 1.0 op_sel_hi:[1,0]
    v_pk_add_f32 v[224:225], v[224:225], 1.0 op_sel_hi:[1,0]
    v_pk_add_f32 v[226:227], v[226:227], 1.0 op_sel_hi:[1,0]
    v_rcp_f32 v220, v220
    v_rcp_f32 v221, v221
    v_rcp_f32 v222, v222
    v_rcp_f32 v223, v223
    v_rcp_f32 v224, v224
    v_rcp_f32 v225, v225
    v_rcp_f32 v226, v226
    v_rcp_f32 v227, v227
    s_waitcnt lgkmcnt(0)
    s_mov_b64 exec, -1
    ds_bpermute_b32 v210, v239, v203 offset:0
    ds_bpermute_b32 v212, v239, v203 offset:32
    ds_bpermute_b32 v214, v239, v203 offset:64
    ds_bpermute_b32 v216, v239, v203 offset:96
    s_mov_b64 exec, s[32:33]
    v_pk_fma_f32 v[84:85], v[148:149], v[220:221], v[84:85]
    v_pk_fma_f32 v[86:87], v[150:151], v[222:223], v[86:87]
    v_pk_fma_f32 v[88:89], v[152:153], v[224:225], v[88:89]
    v_pk_fma_f32 v[90:91], v[154:155], v[226:227], v[90:91]
    v_pk_fma_f32 v[228:229], v[84:85], v[116:117], v[228:229]
    v_pk_fma_f32 v[230:231], v[86:87], v[118:119], v[230:231]
    v_pk_fma_f32 v[228:229], v[88:89], v[120:121], v[228:229]
    v_pk_fma_f32 v[230:231], v[90:91], v[122:123], v[230:231]
    v_mfma_f32_32x32x8_bf16 v[140:155], v[40:41], v[208:209], v[44:59]
    v_exp_f32 v220, v156
    v_exp_f32 v221, v157
    v_exp_f32 v222, v158
    v_exp_f32 v223, v159
    v_mfma_f32_32x32x16_bf16 v[140:155], v[32:35], v[188:191], v[140:155]
    v_exp_f32 v224, v160
    v_exp_f32 v225, v161
    v_exp_f32 v226, v162
    v_exp_f32 v227, v163
    v_pk_add_f32 v[220:221], v[220:221], 1.0 op_sel_hi:[1,0]
    v_pk_add_f32 v[222:223], v[222:223], 1.0 op_sel_hi:[1,0]
    v_pk_add_f32 v[224:225], v[224:225], 1.0 op_sel_hi:[1,0]
    v_pk_add_f32 v[226:227], v[226:227], 1.0 op_sel_hi:[1,0]
    v_mfma_f32_32x32x16_bf16 v[140:155], v[0:3], v[172:175], v[140:155]
    v_rcp_f32 v220, v220
    v_rcp_f32 v221, v221
    v_rcp_f32 v222, v222
    v_rcp_f32 v223, v223
    v_mfma_f32_32x32x16_bf16 v[140:155], v[4:7], v[176:179], v[140:155]
    v_rcp_f32 v224, v224
    v_rcp_f32 v225, v225
    v_rcp_f32 v226, v226
    v_rcp_f32 v227, v227
    v_pk_fma_f32 v[92:93], v[156:157], v[220:221], v[92:93]
    v_pk_fma_f32 v[94:95], v[158:159], v[222:223], v[94:95]
    v_pk_fma_f32 v[96:97], v[160:161], v[224:225], v[96:97]
    v_pk_fma_f32 v[98:99], v[162:163], v[226:227], v[98:99]
    v_pk_fma_f32 v[228:229], v[92:93], v[124:125], v[228:229]
    v_pk_fma_f32 v[230:231], v[94:95], v[126:127], v[230:231]
    v_pk_fma_f32 v[228:229], v[96:97], v[128:129], v[228:229]
    v_pk_fma_f32 v[230:231], v[98:99], v[130:131], v[230:231]
    v_mfma_f32_32x32x16_bf16 v[140:155], v[8:11], v[180:183], v[140:155]
    v_exp_f32 v220, v164
    v_exp_f32 v221, v165
    v_exp_f32 v222, v166
    v_exp_f32 v223, v167
    v_mfma_f32_32x32x16_bf16 v[140:155], v[12:15], v[184:187], v[140:155]
    v_exp_f32 v224, v168
    v_exp_f32 v225, v169
    v_exp_f32 v226, v170
    v_exp_f32 v227, v171
    v_pk_add_f32 v[220:221], v[220:221], 1.0 op_sel_hi:[1,0]
    v_pk_add_f32 v[222:223], v[222:223], 1.0 op_sel_hi:[1,0]
    v_pk_add_f32 v[224:225], v[224:225], 1.0 op_sel_hi:[1,0]
    v_pk_add_f32 v[226:227], v[226:227], 1.0 op_sel_hi:[1,0]
    v_rcp_f32 v220, v220
    v_rcp_f32 v221, v221
    v_rcp_f32 v222, v222
    v_rcp_f32 v223, v223
    v_rcp_f32 v224, v224
    v_rcp_f32 v225, v225
    v_rcp_f32 v226, v226
    v_rcp_f32 v227, v227
    v_pk_fma_f32 v[100:101], v[164:165], v[220:221], v[100:101]
    v_pk_fma_f32 v[102:103], v[166:167], v[222:223], v[102:103]
    v_pk_fma_f32 v[104:105], v[168:169], v[224:225], v[104:105]
    v_pk_fma_f32 v[106:107], v[170:171], v[226:227], v[106:107]
    v_pk_fma_f32 v[228:229], v[100:101], v[132:133], v[228:229]
    v_pk_fma_f32 v[230:231], v[102:103], v[134:135], v[230:231]
    v_pk_fma_f32 v[228:229], v[104:105], v[136:137], v[228:229]
    v_pk_fma_f32 v[230:231], v[106:107], v[138:139], v[230:231]
    v_pk_add_f32 v[228:229], v[228:229], v[230:231]
    s_cmp_eq_u64 s[34:35], 0
    v_add_f32 v243, v228, v229
    v_sub_f32 v248, v243, v247
    v_pk_fma_f32 v[244:245], v[232:233], v[248:249], v[244:245] op_sel_hi:[1,0,1]
    v_fmac_f32 v246, v234, v248
    s_mov_b64 exec, -1
    s_cbranch_scc1 K2_DONE
    v_mfma_f32_32x32x8_bf16 v[156:171], v[42:43], v[208:209], v[60:75]
    s_mov_b64 exec, s[34:35]
    v_exp_f32 v220, v140
    v_exp_f32 v221, v141
    v_exp_f32 v222, v142
    v_exp_f32 v223, v143
    v_mfma_f32_32x32x16_bf16 v[156:171], v[36:39], v[188:191], v[156:171]
    v_exp_f32 v224, v144
    v_exp_f32 v225, v145
    s_bitcmp1_b32 s5, 2
    s_cbranch_scc0 K2_VP7
    s_setprio 1
K2_VP7:
    s_waitcnt lgkmcnt(0)
    s_mov_b64 exec, -1
    s_add_u32 m0, s94, 32768
    s_nop 0
    buffer_load_dwordx4 v[210:211], s[8:11], 0 idxen offen lds
    s_add_u32 m0, s94, 33792
    s_nop 0
    buffer_load_dwordx4 v[212:213], s[8:11], 0 idxen offen lds
    s_add_u32 m0, s94, 34816
    s_nop 0
    buffer_load_dwordx4 v[214:215], s[8:11], 0 idxen offen lds
    s_add_u32 m0, s94, 35840
    s_nop 0
    buffer_load_dwordx4 v[216:217], s[8:11], 0 idxen offen lds
    s_mov_b64 exec, s[34:35]
    s_setprio 0
    v_exp_f32 v226, v146
    v_exp_f32 v227, v147
    v_pk_add_f32 v[220:221], v[220:221], 1.0 op_sel_hi:[1,0]
    v_pk_add_f32 v[222:223], v[222:223], 1.0 op_sel_hi:[1,0]
    v_pk_add_f32 v[224:225], v[224:225], 1.0 op_sel_hi:[1,0]
    v_pk_add_f32 v[226:227], v[226:227], 1.0 op_sel_hi:[1,0]
    v_mfma_f32_32x32x16_bf16 v[156:171], v[16:19], v[172:175], v[156:171]
    v_rcp_f32 v220, v220
    v_rcp_f32 v221, v221
    v_rcp_f32 v222, v222
    v_rcp_f32 v223, v223
    v_mfma_f32_32x32x16_bf16 v[156:171], v[20:23], v[176:179], v[156:171]
    v_rcp_f32 v224, v224
    v_rcp_f32 v225, v225
    v_rcp_f32 v226, v226
    v_rcp_f32 v227, v227
    v_pk_fma_f32 v[76:77], v[140:141], v[220:221], v[76:77]
    v_pk_fma_f32 v[78:79], v[142:143], v[222:223], v[78:79]
    v_pk_fma_f32 v[80:81], v[144:145], v[224:225], v[80:81]
    v_pk_fma_f32 v[82:83], v[146:147], v[226:227], v[82:83]
    v_pk_mul_f32 v[228:229], v[76:77], v[108:109]
    v_pk_mul_f32 v[230:231], v[78:79], v[110:111]
    v_pk_fma_f32 v[228:229], v[80:81], v[112:113], v[228:229]
    v_pk_fma_f32 v[230:231], v[82:83], v[114:115], v[230:231]
    v_mfma_f32_32x32x16_bf16 v[156:171], v[24:27], v[180:183], v[156:171]
    v_exp_f32 v220, v148
    v_exp_f32 v221, v149
    v_exp_f32 v222, v150
    v_exp_f32 v223, v151
    v_mfma_f32_32x32x16_bf16 v[156:171], v[28:31], v[184:187], v[156:171]
    s_mov_b64 exec, -1
    buffer_load_dwordx4 v[196:199], v[218:219], s[12:15], 0 idxen offen
    buffer_load_dwordx2 v[204:205], v203, s[16:19], 0 idxen
    s_mov_b64 exec, s[34:35]
    v_exp_f32 v224, v152
    v_exp_f32 v225, v153
    v_exp_f32 v226, v154
    v_exp_f32 v227, v155
    s_waitcnt vmcnt(6)
    ds_read_b128 v[172:175], v251 offset:0
    ds_read_b128 v[176:179], v252 offset:0
    ds_read_b128 v[180:183], v253 offset:0
    ds_read_b128 v[184:187], v254 offset:0
    v_cmp_lt_u32_e64 s[28:29], s6, v235
    s_add_u32 s6, s6, 1
    v_lshlrev_b32 v232, 16, v200
    v_and_b32 v233, 0xffff0000, v200
    v_sub_f32 v234, v242, v201
    v_pk_add_f32 v[232:233], v[240:241], v[232:233] neg_lo:[0,1] neg_hi:[0,1]
    v_mul_f32 v208, v232, v232
    v_fmac_f32 v208, v233, v233
    v_fmac_f32 v208, v234, v234
    v_cvt_pk_bf16_f32 v208, v208, v208
    v_cndmask_b32_e64 v203, 0, v207, s[28:29]
    v_add_u32 v207, v207, v206
    ds_read_b32 v218, v203
    ds_read_u16 v203, v203 offset:4
    v_pk_add_f32 v[220:221], v[220:221], 1.0 op_sel_hi:[1,0]
    v_pk_add_f32 v[222:223], v[222:223], 1.0 op_sel_hi:[1,0]
    v_pk_add_f32 v[224:225], v[224:225], 1.0 op_sel_hi:[1,0]
    v_pk_add_f32 v[226:227], v[226:227], 1.0 op_sel_hi:[1,0]
    v_rcp_f32 v220, v220
    v_rcp_f32 v221, v221
    v_rcp_f32 v222, v222
    v_rcp_f32 v223, v223
    v_rcp_f32 v224, v224
    v_rcp_f32 v225, v225
    v_rcp_f32 v226, v226
    v_rcp_f32 v227, v227
    s_waitcnt lgkmcnt(0)
    s_mov_b64 exec, -1
    ds_bpermute_b32 v210, v239, v203 offset:0
    ds_bpermute_b32 v212, v239, v203 offset:32
    ds_bpermute_b32 v214, v239, v203 offset:64
    ds_bpermute_b32 v216, v239, v203 offset:96
    s_mov_b64 exec, s[34:35]
    v_pk_fma_f32 v[84:85], v[148:149], v[220:221], v[84:85]
    v_pk_fma_f32 v[86:87], v[150:151], v[222:223], v[86:87]
    v_pk_fma_f32 v[88:89], v[152:153], v[224:225], v[88:89]
    v_pk_fma_f32 v[90:91], v[154:155], v[226:227], v[90:91]
    v_pk_fma_f32 v[228:229], v[84:85], v[116:117], v[228:229]
    v_pk_fma_f32 v[230:231], v[86:87], v[118:119], v[230:231]
    v_pk_fma_f32 v[228:229], v[88:89], v[120:121], v[228:229]
    v_pk_fma_f32 v[230:231], v[90:91], v[122:123], v[230:231]
    v_mfma_f32_32x32x8_bf16 v[140:155], v[40:41], v[208:209], v[44:59]
    v_exp_f32 v220, v156
    v_exp_f32 v221, v157
    v_exp_f32 v222, v158
    v_exp_f32 v223, v159
    v_mfma_f32_32x32x16_bf16 v[140:155], v[32:35], v[192:195], v[140:155]
    v_exp_f32 v224, v160
    v_exp_f32 v225, v161
    v_exp_f32 v226, v162
    v_exp_f32 v227, v163
    v_pk_add_f32 v[220:221], v[220:221], 1.0 op_sel_hi:[1,0]
    v_pk_add_f32 v[222:223], v[222:223], 1.0 op_sel_hi:[1,0]
    v_pk_add_f32 v[224:225], v[224:225], 1.0 op_sel_hi:[1,0]
    v_pk_add_f32 v[226:227], v[226:227], 1.0 op_sel_hi:[1,0]
    v_mfma_f32_32x32x16_bf16 v[140:155], v[0:3], v[172:175], v[140:155]
    v_rcp_f32 v220, v220
    v_rcp_f32 v221, v221
    v_rcp_f32 v222, v222
    v_rcp_f32 v223, v223
    v_mfma_f32_32x32x16_bf16 v[140:155], v[4:7], v[176:179], v[140:155]
    v_rcp_f32 v224, v224
    v_rcp_f32 v225, v225
    v_rcp_f32 v226, v226
    v_rcp_f32 v227, v227
    v_pk_fma_f32 v[92:93], v[156:157], v[220:221], v[92:93]
    v_pk_fma_f32 v[94:95], v[158:159], v[222:223], v[94:95]
    v_pk_fma_f32 v[96:97], v[160:161], v[224:225], v[96:97]
    v_pk_fma_f32 v[98:99], v[162:163], v[226:227], v[98:99]
    v_pk_fma_f32 v[228:229], v[92:93], v[124:125], v[228:229]
    v_pk_fma_f32 v[230:231], v[94:95], v[126:127], v[230:231]
    v_pk_fma_f32 v[228:229], v[96:97], v[128:129], v[228:229]
    v_pk_fma_f32 v[230:231], v[98:99], v[130:131], v[230:231]
    v_mfma_f32_32x32x16_bf16 v[140:155], v[8:11], v[180:183], v[140:155]
    v_exp_f32 v220, v164
    v_exp_f32 v221, v165
    v_exp_f32 v222, v166
    v_exp_f32 v223, v167
    v_mfma_f32_32x32x16_bf16 v[140:155], v[12:15], v[184:187], v[140:155]
    v_exp_f32 v224, v168
    v_exp_f32 v225, v169
    v_exp_f32 v226, v170
    v_exp_f32 v227, v171
    v_pk_add_f32 v[220:221], v[220:221], 1.0 op_sel_hi:[1,0]
    v_pk_add_f32 v[222:223], v[222:223], 1.0 op_sel_hi:[1,0]
    v_pk_add_f32 v[224:225], v[224:225], 1.0 op_sel_hi:[1,0]
    v_pk_add_f32 v[226:227], v[226:227], 1.0 op_sel_hi:[1,0]
    v_rcp_f32 v220, v220
    v_rcp_f32 v221, v221
    v_rcp_f32 v222, v222
    v_rcp_f32 v223, v223
    v_rcp_f32 v224, v224
    v_rcp_f32 v225, v225
    v_rcp_f32 v226, v226
    v_rcp_f32 v227, v227
    v_pk_fma_f32 v[100:101], v[164:165], v[220:221], v[100:101]
    v_pk_fma_f32 v[102:103], v[166:167], v[222:223], v[102:103]
    v_pk_fma_f32 v[104:105], v[168:169], v[224:225], v[104:105]
    v_pk_fma_f32 v[106:107], v[170:171], v[226:227], v[106:107]
    v_pk_fma_f32 v[228:229], v[100:101], v[132:133], v[228:229]
    v_pk_fma_f32 v[230:231], v[102:103], v[134:135], v[230:231]
    v_pk_fma_f32 v[228:229], v[104:105], v[136:137], v[228:229]
    v_pk_fma_f32 v[230:231], v[106:107], v[138:139], v[230:231]
    v_pk_add_f32 v[228:229], v[228:229], v[230:231]
    s_cmp_eq_u64 s[36:37], 0
    v_add_f32 v247, v228, v229
    v_sub_f32 v248, v247, v243
    v_pk_fma_f32 v[244:245], v[236:237], v[248:249], v[244:245] op_sel_hi:[1,0,1]
    v_fmac_f32 v246, v238, v248
    s_mov_b64 exec, -1
    s_cbranch_scc1 K2_DONE
    v_mfma_f32_32x32x8_bf16 v[156:171], v[42:43], v[208:209], v[60:75]
    s_mov_b64 exec, s[36:37]
    v_exp_f32 v220, v140
    v_exp_f32 v221, v141
    v_exp_f32 v222, v142
    v_exp_f32 v223, v143
    v_mfma_f32_32x32x16_bf16 v[156:171], v[36:39], v[192:195], v[156:171]
    v_exp_f32 v224, v144
    v_exp_f32 v225, v145
    s_bitcmp1_b32 s5, 2
    s_cbranch_scc0 K2_VP9
    s_setprio 1
K2_VP9:
    s_waitcnt lgkmcnt(0)
    s_mov_b64 exec, -1
    s_add_u32 m0, s94, 0
    s_nop 0
    buffer_load_dwordx4 v[210:211], s[8:11], 0 idxen offen lds
    s_add_u32 m0, s94, 1024
    s_nop 0
    buffer_load_dwordx4 v[212:213], s[8:11], 0 idxen offen lds
    s_add_u32 m0, s94, 2048
    s_nop 0
    buffer_load_dwordx4 v[214:215], s[8:11], 0 idxen offen lds
    s_add_u32 m0, s94, 3072
    s_nop 0
    buffer_load_dwordx4 v[216:217], s[8:11], 0 idxen offen lds
    s_mov_b64 exec, s[36:37]
    s_setprio 0
    v_exp_f32 v226, v146
    v_exp_f32 v227, v147
    v_pk_add_f32 v[220:221], v[220:221], 1.0 op_sel_hi:[1,0]
    v_pk_add_f32 v[222:223], v[222:223], 1.0 op_sel_hi:[1,0]
    v_pk_add_f32 v[224:225], v[224:225], 1.0 op_sel_hi:[1,0]
    v_pk_add_f32 v[226:227], v[226:227], 1.0 op_sel_hi:[1,0]
    v_mfma_f32_32x32x16_bf16 v[156:171], v[16:19], v[172:175], v[156:171]
    v_rcp_f32 v220, v220
    v_rcp_f32 v221, v221
    v_rcp_f32 v222, v222
    v_rcp_f32 v223, v223
    v_mfma_f32_32x32x16_bf16 v[156:171], v[20:23], v[176:179], v[156:171]
    v_rcp_f32 v224, v224
    v_rcp_f32 v225, v225
    v_rcp_f32 v226, v226
    v_rcp_f32 v227, v227
    v_pk_fma_f32 v[76:77], v[140:141], v[220:221], v[76:77]
    v_pk_fma_f32 v[78:79], v[142:143], v[222:223], v[78:79]
    v_pk_fma_f32 v[80:81], v[144:145], v[224:225], v[80:81]
    v_pk_fma_f32 v[82:83], v[146:147], v[226:227], v[82:83]
    v_pk_mul_f32 v[228:229], v[76:77], v[108:109]
    v_pk_mul_f32 v[230:231], v[78:79], v[110:111]
    v_pk_fma_f32 v[228:229], v[80:81], v[112:113], v[228:229]
    v_pk_fma_f32 v[230:231], v[82:83], v[114:115], v[230:231]
    v_mfma_f32_32x32x16_bf16 v[156:171], v[24:27], v[180:183], v[156:171]
    v_exp_f32 v220, v148
    v_exp_f32 v221, v149
    v_exp_f32 v222, v150
    v_exp_f32 v223, v151
    v_mfma_f32_32x32x16_bf16 v[156:171], v[28:31], v[184:187], v[156:171]
    s_mov_b64 exec, -1
    buffer_load_dwordx4 v[188:191], v[218:219], s[12:15], 0 idxen offen
    buffer_load_dwordx2 v[200:201], v203, s[16:19], 0 idxen
    s_mov_b64 exec, s[36:37]
    v_exp_f32 v224, v152
    v_exp_f32 v225, v153
    v_exp_f32 v226, v154
    v_exp_f32 v227, v155
    s_waitcnt vmcnt(6)
    ds_read_b128 v[172:175], v251 offset:32768
    ds_read_b128 v[176:179], v252 offset:32768
    ds_read_b128 v[180:183], v253 offset:32768
    ds_read_b128 v[184:187], v254 offset:32768
    v_cmp_lt_u32_e64 s[30:31], s6, v235
    s_add_u32 s6, s6, 1
    v_lshlrev_b32 v236, 16, v204
    v_and_b32 v237, 0xffff0000, v204
    v_sub_f32 v238, v242, v205
    v_pk_add_f32 v[236:237], v[240:241], v[236:237] neg_lo:[0,1] neg_hi:[0,1]
    v_mul_f32 v208, v236, v236
    v_fmac_f32 v208, v237, v237
    v_fmac_f32 v208, v238, v238
    v_cvt_pk_bf16_f32 v208, v208, v208
    v_cndmask_b32_e64 v203, 0, v207, s[30:31]
    v_add_u32 v207, v207, v206
    ds_read_b32 v218, v203
    ds_read_u16 v203, v203 offset:4
    v_pk_add_f32 v[220:221], v[220:221], 1.0 op_sel_hi:[1,0]
    v_pk_add_f32 v[222:223], v[222:223], 1.0 op_sel_hi:[1,0]
    v_pk_add_f32 v[224:225], v[224:225], 1.0 op_sel_hi:[1,0]
    v_pk_add_f32 v[226:227], v[226:227], 1.0 op_sel_hi:[1,0]
    v_rcp_f32 v220, v220
    v_rcp_f32 v221, v221
    v_rcp_f32 v222, v222
    v_rcp_f32 v223, v223
    v_rcp_f32 v224, v224
    v_rcp_f32 v225, v225
    v_rcp_f32 v226, v226
    v_rcp_f32 v227, v227
    s_waitcnt lgkmcnt(0)
    s_mov_b64 exec, -1
    ds_bpermute_b32 v210, v239, v203 offset:0
    ds_bpermute_b32 v212, v239, v203 offset:32
    ds_bpermute_b32 v214, v239, v203 offset:64
    ds_bpermute_b32 v216, v239, v203 offset:96
    s_mov_b64 exec, s[36:37]
    v_pk_fma_f32 v[84:85], v[148:149], v[220:221], v[84:85]
    v_pk_fma_f32 v[86:87], v[150:151], v[222:223], v[86:87]
    v_pk_fma_f32 v[88:89], v[152:153], v[224:225], v[88:89]
    v_pk_fma_f32 v[90:91], v[154:155], v[226:227], v[90:91]
    v_pk_fma_f32 v[228:229], v[84:85], v[116:117], v[228:229]
    v_pk_fma_f32 v[230:231], v[86:87], v[118:119], v[230:231]
    v_pk_fma_f32 v[228:229], v[88:89], v[120:121], v[228:229]
    v_pk_fma_f32 v[230:231], v[90:91], v[122:123], v[230:231]
    v_mfma_f32_32x32x8_bf16 v[140:155], v[40:41], v[208:209], v[44:59]
    v_exp_f32 v220, v156
    v_exp_f32 v221, v157
    v_exp_f32 v222, v158
    v_exp_f32 v223, v159
    v_mfma_f32_32x32x16_bf16 v[140:155], v[32:35], v[196:199], v[140:155]
    v_exp_f32 v224, v160
    v_exp_f32 v225, v161
    v_exp_f32 v226, v162
    v_exp_f32 v227, v163
    v_pk_add_f32 v[220:221], v[220:221], 1.0 op_sel_hi:[1,0]
    v_pk_add_f32 v[222:223], v[222:223], 1.0 op_sel_hi:[1,0]
    v_pk_add_f32 v[224:225], v[224:225], 1.0 op_sel_hi:[1,0]
    v_pk_add_f32 v[226:227], v[226:227], 1.0 op_sel_hi:[1,0]
    v_mfma_f32_32x32x16_bf16 v[140:155], v[0:3], v[172:175], v[140:155]
    v_rcp_f32 v220, v220
    v_rcp_f32 v221, v221
    v_rcp_f32 v222, v222
    v_rcp_f32 v223, v223
    v_mfma_f32_32x32x16_bf16 v[140:155], v[4:7], v[176:179], v[140:155]
    v_rcp_f32 v224, v224
    v_rcp_f32 v225, v225
    v_rcp_f32 v226, v226
    v_rcp_f32 v227, v227
    v_pk_fma_f32 v[92:93], v[156:157], v[220:221], v[92:93]
    v_pk_fma_f32 v[94:95], v[158:159], v[222:223], v[94:95]
    v_pk_fma_f32 v[96:97], v[160:161], v[224:225], v[96:97]
    v_pk_fma_f32 v[98:99], v[162:163], v[226:227], v[98:99]
    v_pk_fma_f32 v[228:229], v[92:93], v[124:125], v[228:229]
    v_pk_fma_f32 v[230:231], v[94:95], v[126:127], v[230:231]
    v_pk_fma_f32 v[228:229], v[96:97], v[128:129], v[228:229]
    v_pk_fma_f32 v[230:231], v[98:99], v[130:131], v[230:231]
    v_mfma_f32_32x32x16_bf16 v[140:155], v[8:11], v[180:183], v[140:155]
    v_exp_f32 v220, v164
    v_exp_f32 v221, v165
    v_exp_f32 v222, v166
    v_exp_f32 v223, v167
    v_mfma_f32_32x32x16_bf16 v[140:155], v[12:15], v[184:187], v[140:155]
    v_exp_f32 v224, v168
    v_exp_f32 v225, v169
    v_exp_f32 v226, v170
    v_exp_f32 v227, v171
    v_pk_add_f32 v[220:221], v[220:221], 1.0 op_sel_hi:[1,0]
    v_pk_add_f32 v[222:223], v[222:223], 1.0 op_sel_hi:[1,0]
    v_pk_add_f32 v[224:225], v[224:225], 1.0 op_sel_hi:[1,0]
    v_pk_add_f32 v[226:227], v[226:227], 1.0 op_sel_hi:[1,0]
    v_rcp_f32 v220, v220
    v_rcp_f32 v221, v221
    v_rcp_f32 v222, v222
    v_rcp_f32 v223, v223
    v_rcp_f32 v224, v224
    v_rcp_f32 v225, v225
    v_rcp_f32 v226, v226
    v_rcp_f32 v227, v227
    v_pk_fma_f32 v[100:101], v[164:165], v[220:221], v[100:101]
    v_pk_fma_f32 v[102:103], v[166:167], v[222:223], v[102:103]
    v_pk_fma_f32 v[104:105], v[168:169], v[224:225], v[104:105]
    v_pk_fma_f32 v[106:107], v[170:171], v[226:227], v[106:107]
    v_pk_fma_f32 v[228:229], v[100:101], v[132:133], v[228:229]
    v_pk_fma_f32 v[230:231], v[102:103], v[134:135], v[230:231]
    v_pk_fma_f32 v[228:229], v[104:105], v[136:137], v[228:229]
    v_pk_fma_f32 v[230:231], v[106:107], v[138:139], v[230:231]
    v_pk_add_f32 v[228:229], v[228:229], v[230:231]
    s_cmp_eq_u64 s[38:39], 0
    v_add_f32 v243, v228, v229
    v_sub_f32 v248, v243, v247
    v_pk_fma_f32 v[244:245], v[232:233], v[248:249], v[244:245] op_sel_hi:[1,0,1]
    v_fmac_f32 v246, v234, v248
    s_mov_b64 exec, -1
    s_cbranch_scc1 K2_DONE
    v_mfma_f32_32x32x8_bf16 v[156:171], v[42:43], v[208:209], v[60:75]
    s_mov_b64 exec, s[38:39]
    v_exp_f32 v220, v140
    v_exp_f32 v221, v141
    v_exp_f32 v222, v142
    v_exp_f32 v223, v143
    v_mfma_f32_32x32x16_bf16 v[156:171], v[36:39], v[196:199], v[156:171]
    v_exp_f32 v224, v144
    v_exp_f32 v225, v145
    s_bitcmp1_b32 s5, 2
    s_cbranch_scc0 K2_VP11
    s_setprio 1
K2_VP11:
    s_waitcnt lgkmcnt(0)
    s_mov_b64 exec, -1
    s_add_u32 m0, s94, 32768
    s_nop 0
    buffer_load_dwordx4 v[210:211], s[8:11], 0 idxen offen lds
    s_add_u32 m0, s94, 33792
    s_nop 0
    buffer_load_dwordx4 v[212:213], s[8:11], 0 idxen offen lds
    s_add_u32 m0, s94, 34816
    s_nop 0
    buffer_load_dwordx4 v[214:215], s[8:11], 0 idxen offen lds
    s_add_u32 m0, s94, 35840
    s_nop 0
    buffer_load_dwordx4 v[216:217], s[8:11], 0 idxen offen lds
    s_mov_b64 exec, s[38:39]
    s_setprio 0
    v_exp_f32 v226, v146
    v_exp_f32 v227, v147
    v_pk_add_f32 v[220:221], v[220:221], 1.0 op_sel_hi:[1,0]
    v_pk_add_f32 v[222:223], v[222:223], 1.0 op_sel_hi:[1,0]
    v_pk_add_f32 v[224:225], v[224:225], 1.0 op_sel_hi:[1,0]
    v_pk_add_f32 v[226:227], v[226:227], 1.0 op_sel_hi:[1,0]
    v_mfma_f32_32x32x16_bf16 v[156:171], v[16:19], v[172:175], v[156:171]
    v_rcp_f32 v220, v220
    v_rcp_f32 v221, v221
    v_rcp_f32 v222, v222
    v_rcp_f32 v223, v223
    v_mfma_f32_32x32x16_bf16 v[156:171], v[20:23], v[176:179], v[156:171]
    v_rcp_f32 v224, v224
    v_rcp_f32 v225, v225
    v_rcp_f32 v226, v226
    v_rcp_f32 v227, v227
    v_pk_fma_f32 v[76:77], v[140:141], v[220:221], v[76:77]
    v_pk_fma_f32 v[78:79], v[142:143], v[222:223], v[78:79]
    v_pk_fma_f32 v[80:81], v[144:145], v[224:225], v[80:81]
    v_pk_fma_f32 v[82:83], v[146:147], v[226:227], v[82:83]
    v_pk_mul_f32 v[228:229], v[76:77], v[108:109]
    v_pk_mul_f32 v[230:231], v[78:79], v[110:111]
    v_pk_fma_f32 v[228:229], v[80:81], v[112:113], v[228:229]
    v_pk_fma_f32 v[230:231], v[82:83], v[114:115], v[230:231]
    v_mfma_f32_32x32x16_bf16 v[156:171], v[24:27], v[180:183], v[156:171]
    v_exp_f32 v220, v148
    v_exp_f32 v221, v149
    v_exp_f32 v222, v150
    v_exp_f32 v223, v151
    v_mfma_f32_32x32x16_bf16 v[156:171], v[28:31], v[184:187], v[156:171]
    s_mov_b64 exec, -1
    buffer_load_dwordx4 v[192:195], v[218:219], s[12:15], 0 idxen offen
    buffer_load_dwordx2 v[204:205], v203, s[16:19], 0 idxen
    s_mov_b64 exec, s[38:39]
    v_exp_f32 v224, v152
    v_exp_f32 v225, v153
    v_exp_f32 v226, v154
    v_exp_f32 v227, v155
    s_waitcnt vmcnt(6)
    ds_read_b128 v[172:175], v251 offset:0
    ds_read_b128 v[176:179], v252 offset:0
    ds_read_b128 v[180:183], v253 offset:0
    ds_read_b128 v[184:187], v254 offset:0
    v_cmp_lt_u32_e64 s[32:33], s6, v235
    s_add_u32 s6, s6, 1
    v_lshlrev_b32 v232, 16, v200
    v_and_b32 v233, 0xffff0000, v200
    v_sub_f32 v234, v242, v201
    v_pk_add_f32 v[232:233], v[240:241], v[232:233] neg_lo:[0,1] neg_hi:[0,1]
    v_mul_f32 v208, v232, v232
    v_fmac_f32 v208, v233, v233
    v_fmac_f32 v208, v234, v234
    v_cvt_pk_bf16_f32 v208, v208, v208
    v_cndmask_b32_e64 v203, 0, v207, s[32:33]
    v_add_u32 v207, v207, v206
    ds_read_b32 v218, v203
    ds_read_u16 v203, v203 offset:4
    v_pk_add_f32 v[220:221], v[220:221], 1.0 op_sel_hi:[1,0]
    v_pk_add_f32 v[222:223], v[222:223], 1.0 op_sel_hi:[1,0]
    v_pk_add_f32 v[224:225], v[224:225], 1.0 op_sel_hi:[1,0]
    v_pk_add_f32 v[226:227], v[226:227], 1.0 op_sel_hi:[1,0]
    v_rcp_f32 v220, v220
    v_rcp_f32 v221, v221
    v_rcp_f32 v222, v222
    v_rcp_f32 v223, v223
    v_rcp_f32 v224, v224
    v_rcp_f32 v225, v225
    v_rcp_f32 v226, v226
    v_rcp_f32 v227, v227
    s_waitcnt lgkmcnt(0)
    s_mov_b64 exec, -1
    ds_bpermute_b32 v210, v239, v203 offset:0
    ds_bpermute_b32 v212, v239, v203 offset:32
    ds_bpermute_b32 v214, v239, v203 offset:64
    ds_bpermute_b32 v216, v239, v203 offset:96
    s_mov_b64 exec, s[38:39]
    v_pk_fma_f32 v[84:85], v[148:149], v[220:221], v[84:85]
    v_pk_fma_f32 v[86:87], v[150:151], v[222:223], v[86:87]
    v_pk_fma_f32 v[88:89], v[152:153], v[224:225], v[88:89]
    v_pk_fma_f32 v[90:91], v[154:155], v[226:227], v[90:91]
    v_pk_fma_f32 v[228:229], v[84:85], v[116:117], v[228:229]
    v_pk_fma_f32 v[230:231], v[86:87], v[118:119], v[230:231]
    v_pk_fma_f32 v[228:229], v[88:89], v[120:121], v[228:229]
    v_pk_fma_f32 v[230:231], v[90:91], v[122:123], v[230:231]
    v_mfma_f32_32x32x8_bf16 v[140:155], v[40:41], v[208:209], v[44:59]
    v_exp_f32 v220, v156
    v_exp_f32 v221, v157
    v_exp_f32 v222, v158
    v_exp_f32 v223, v159
    v_mfma_f32_32x32x16_bf16 v[140:155], v[32:35], v[188:191], v[140:155]
    v_exp_f32 v224, v160
    v_exp_f32 v225, v161
    v_exp_f32 v226, v162
    v_exp_f32 v227, v163
    v_pk_add_f32 v[220:221], v[220:221], 1.0 op_sel_hi:[1,0]
    v_pk_add_f32 v[222:223], v[222:223], 1.0 op_sel_hi:[1,0]
    v_pk_add_f32 v[224:225], v[224:225], 1.0 op_sel_hi:[1,0]
    v_pk_add_f32 v[226:227], v[226:227], 1.0 op_sel_hi:[1,0]
    v_mfma_f32_32x32x16_bf16 v[140:155], v[0:3], v[172:175], v[140:155]
    v_rcp_f32 v220, v220
    v_rcp_f32 v221, v221
    v_rcp_f32 v222, v222
    v_rcp_f32 v223, v223
    v_mfma_f32_32x32x16_bf16 v[140:155], v[4:7], v[176:179], v[140:155]
    v_rcp_f32 v224, v224
    v_rcp_f32 v225, v225
    v_rcp_f32 v226, v226
    v_rcp_f32 v227, v227
    v_pk_fma_f32 v[92:93], v[156:157], v[220:221], v[92:93]
    v_pk_fma_f32 v[94:95], v[158:159], v[222:223], v[94:95]
    v_pk_fma_f32 v[96:97], v[160:161], v[224:225], v[96:97]
    v_pk_fma_f32 v[98:99], v[162:163], v[226:227], v[98:99]
    v_pk_fma_f32 v[228:229], v[92:93], v[124:125], v[228:229]
    v_pk_fma_f32 v[230:231], v[94:95], v[126:127], v[230:231]
    v_pk_fma_f32 v[228:229], v[96:97], v[128:129], v[228:229]
    v_pk_fma_f32 v[230:231], v[98:99], v[130:131], v[230:231]
    v_mfma_f32_32x32x16_bf16 v[140:155], v[8:11], v[180:183], v[140:155]
    v_exp_f32 v220, v164
    v_exp_f32 v221, v165
    v_exp_f32 v222, v166
    v_exp_f32 v223, v167
    v_mfma_f32_32x32x16_bf16 v[140:155], v[12:15], v[184:187], v[140:155]
    v_exp_f32 v224, v168
    v_exp_f32 v225, v169
    v_exp_f32 v226, v170
    v_exp_f32 v227, v171
    v_pk_add_f32 v[220:221], v[220:221], 1.0 op_sel_hi:[1,0]
    v_pk_add_f32 v[222:223], v[222:223], 1.0 op_sel_hi:[1,0]
    v_pk_add_f32 v[224:225], v[224:225], 1.0 op_sel_hi:[1,0]
    v_pk_add_f32 v[226:227], v[226:227], 1.0 op_sel_hi:[1,0]
    v_rcp_f32 v220, v220
    v_rcp_f32 v221, v221
    v_rcp_f32 v222, v222
    v_rcp_f32 v223, v223
    v_rcp_f32 v224, v224
    v_rcp_f32 v225, v225
    v_rcp_f32 v226, v226
    v_rcp_f32 v227, v227
    v_pk_fma_f32 v[100:101], v[164:165], v[220:221], v[100:101]
    v_pk_fma_f32 v[102:103], v[166:167], v[222:223], v[102:103]
    v_pk_fma_f32 v[104:105], v[168:169], v[224:225], v[104:105]
    v_pk_fma_f32 v[106:107], v[170:171], v[226:227], v[106:107]
    v_pk_fma_f32 v[228:229], v[100:101], v[132:133], v[228:229]
    v_pk_fma_f32 v[230:231], v[102:103], v[134:135], v[230:231]
    v_pk_fma_f32 v[228:229], v[104:105], v[136:137], v[228:229]
    v_pk_fma_f32 v[230:231], v[106:107], v[138:139], v[230:231]
    v_pk_add_f32 v[228:229], v[228:229], v[230:231]
    s_cmp_eq_u64 s[28:29], 0
    v_add_f32 v247, v228, v229
    v_sub_f32 v248, v247, v243
    v_pk_fma_f32 v[244:245], v[236:237], v[248:249], v[244:245] op_sel_hi:[1,0,1]
    v_fmac_f32 v246, v238, v248
    s_mov_b64 exec, -1
    s_cbranch_scc0 K2_LOOP
K2_DONE:
    v_and_b32 v203, 63, v250
    s_or_b32 s95, s7, s93
    s_cselect_b32 s97, 3, s97
    s_cmp_gt_u32 s97, 2
    v_lshlrev_b32 v203, 4, v203
    s_cbranch_scc1 K2_SLOW
    v_bfe_u32 v220, v249, 1, 3
    v_lshlrev_b32 v220, 4, v220
    v_lshlrev_b32 v221, 2, v219
    v_xor_b32 v220, v220, v221
    v_lshl_add_u32 v220, v249, 7, v220
    v_add_u32 v220, 100352, v220
    v_xor_b32 v221, 16, v220
    v_xor_b32 v222, 32, v220
    v_xor_b32 v223, 48, v220
    ds_read_b128 v[172:175], v220
    ds_read_b128 v[176:179], v221
    ds_read_b128 v[180:183], v222
    ds_read_b128 v[184:187], v223
    v_add_u32 v220, 125952, v203
    v_cmp_eq_u32_e64 s[46:47], 16, v206
    v_cmp_eq_u32_e64 s[44:45], 8, v206
    v_add_u32 v218, s4, v249
    ds_read_b128 v[0:3], v220 offset:32768
    ds_read_b128 v[4:7], v220 offset:33792
    ds_read_b128 v[8:11], v220 offset:34816
    ds_read_b128 v[12:15], v220 offset:35840
    ds_read_b128 v[16:19], v220 offset:0
    ds_read_b128 v[20:23], v220 offset:1024
    ds_read_b128 v[24:27], v220 offset:2048
    ds_read_b128 v[28:31], v220 offset:3072
    ds_read_b128 v[44:47], v220 offset:4096
    ds_read_b128 v[48:51], v220 offset:5120
    ds_read_b128 v[52:55], v220 offset:6144
    ds_read_b128 v[56:59], v220 offset:7168
    ds_read_b128 v[60:63], v220 offset:8192
    ds_read_b128 v[64:67], v220 offset:9216
    ds_read_b128 v[68:71], v220 offset:10240
    ds_read_b128 v[72:75], v220 offset:11264
    s_mov_b64 exec, s[46:47]
    s_and_b32 s46, s46, 0x55555555
    s_or_b32 s44, s44, s46
    s_mov_b32 s98, s94
    v_add_f32_dpp v244, v244, v244 quad_perm:[1,0,3,2] row_mask:0xf bank_mask:0xf
    v_add_f32_dpp v245, v245, v245 quad_perm:[1,0,3,2] row_mask:0xf bank_mask:0xf
    v_add_f32_dpp v246, v246, v246 quad_perm:[1,0,3,2] row_mask:0xf bank_mask:0xf
    v_add_f32_dpp v76, v76, v76 quad_perm:[1,0,3,2] row_mask:0xf bank_mask:0xf
    v_add_f32_dpp v77, v77, v77 quad_perm:[1,0,3,2] row_mask:0xf bank_mask:0xf
    v_add_f32_dpp v78, v78, v78 quad_perm:[1,0,3,2] row_mask:0xf bank_mask:0xf
    v_add_f32_dpp v79, v79, v79 quad_perm:[1,0,3,2] row_mask:0xf bank_mask:0xf
    v_add_f32_dpp v80, v80, v80 quad_perm:[1,0,3,2] row_mask:0xf bank_mask:0xf
    v_add_f32_dpp v81, v81, v81 quad_perm:[1,0,3,2] row_mask:0xf bank_mask:0xf
    v_add_f32_dpp v82, v82, v82 quad_perm:[1,0,3,2] row_mask:0xf bank_mask:0xf
    v_add_f32_dpp v83, v83, v83 quad_perm:[1,0,3,2] row_mask:0xf bank_mask:0xf
    v_add_f32_dpp v84, v84, v84 quad_perm:[1,0,3,2] row_mask:0xf bank_mask:0xf
    v_add_f32_dpp v85, v85, v85 quad_perm:[1,0,3,2] row_mask:0xf bank_mask:0xf
    v_add_f32_dpp v86, v86, v86 quad_perm:[1,0,3,2] row_mask:0xf bank_mask:0xf
    v_add_f32_dpp v87, v87, v87 quad_perm:[1,0,3,2] row_mask:0xf bank_mask:0xf
    v_add_f32_dpp v88, v88, v88 quad_perm:[1,0,3,2] row_mask:0xf bank_mask:0xf
    v_add_f32_dpp v89, v89, v89 quad_perm:[1,0,3,2] row_mask:0xf bank_mask:0xf
    v_add_f32_dpp v90, v90, v90 quad_perm:[1,0,3,2] row_mask:0xf bank_mask:0xf
    v_add_f32_dpp v91, v91, v91 quad_perm:[1,0,3,2] row_mask:0xf bank_mask:0xf
    v_add_f32_dpp v92, v92, v92 quad_perm:[1,0,3,2] row_mask:0xf bank_mask:0xf
    v_add_f32_dpp v93, v93, v93 quad_perm:[1,0,3,2] row_mask:0xf bank_mask:0xf
    v_add_f32_dpp v94, v94, v94 quad_perm:[1,0,3,2] row_mask:0xf bank_mask:0xf
    v_add_f32_dpp v95, v95, v95 quad_perm:[1,0,3,2] row_mask:0xf bank_mask:0xf
    v_add_f32_dpp v96, v96, v96 quad_perm:[1,0,3,2] row_mask:0xf bank_mask:0xf
    v_add_f32_dpp v97, v97, v97 quad_perm:[1,0,3,2] row_mask:0xf bank_mask:0xf
    v_add_f32_dpp v98, v98, v98 quad_perm:[1,0,3,2] row_mask:0xf bank_mask:0xf
    v_add_f32_dpp v99, v99, v99 quad_perm:[1,0,3,2] row_mask:0xf bank_mask:0xf
    v_add_f32_dpp v100, v100, v100 quad_perm:[1,0,3,2] row_mask:0xf bank_mask:0xf
    v_add_f32_dpp v101, v101, v101 quad_perm:[1,0,3,2] row_mask:0xf bank_mask:0xf
    v_add_f32_dpp v102, v102, v102 quad_perm:[1,0,3,2] row_mask:0xf bank_mask:0xf
    v_add_f32_dpp v103, v103, v103 quad_perm:[1,0,3,2] row_mask:0xf bank_mask:0xf
    v_add_f32_dpp v104, v104, v104 quad_perm:[1,0,3,2] row_mask:0xf bank_mask:0xf
    v_add_f32_dpp v105, v105, v105 quad_perm:[1,0,3,2] row_mask:0xf bank_mask:0xf
    v_add_f32_dpp v106, v106, v106 quad_perm:[1,0,3,2] row_mask:0xf bank_mask:0xf
    v_add_f32_dpp v107, v107, v107 quad_perm:[1,0,3,2] row_mask:0xf bank_mask:0xf
    s_mov_b64 exec, -1
    v_mov_b32 v224, v244
    v_mov_b32 v225, v245
    v_mov_b32 v226, v246
    s_nop 1
    v_permlane32_swap_b32 v224, v244
    v_permlane32_swap_b32 v225, v245
    v_permlane32_swap_b32 v226, v246
    s_nop 1
    v_add_f32 v244, v244, v224
    v_add_f32 v245, v245, v225
    v_add_f32 v246, v246, v226
    s_branch K2_TAIL
K2_EMPTY:
    s_waitcnt vmcnt(0) lgkmcnt(0)
    v_mov_b32 v244, 0
    v_mov_b32 v245, 0
    v_mov_b32 v246, 0
    v_mov_b32 v76, 0
    v_mov_b32 v77, 0
    v_mov_b32 v78, 0
    v_mov_b32 v79, 0
    v_mov_b32 v80, 0
    v_mov_b32 v81, 0
    v_mov_b32 v82, 0
    v_mov_b32 v83, 0
    v_mov_b32 v84, 0
    v_mov_b32 v85, 0
    v_mov_b32 v86, 0
    v_mov_b32 v87, 0
    v_mov_b32 v88, 0
    v_mov_b32 v89, 0
    v_mov_b32 v90, 0
    v_mov_b32 v91, 0
    v_mov_b32 v92, 0
    v_mov_b32 v93, 0
    v_mov_b32 v94, 0
    v_mov_b32 v95, 0
    v_mov_b32 v96, 0
    v_mov_b32 v97, 0
    v_mov_b32 v98, 0
    v_mov_b32 v99, 0
    v_mov_b32 v100, 0
    v_mov_b32 v101, 0
    v_mov_b32 v102, 0
    v_mov_b32 v103, 0
    v_mov_b32 v104, 0
    v_mov_b32 v105, 0
    v_mov_b32 v106, 0
    v_mov_b32 v107, 0
    v_mov_b32 v242, v241
    v_and_b32 v241, 0xffff0000, v240
    v_lshlrev_b32 v240, 16, v240
    s_branch K2_DONE
K2_SLOW:
    v_and_b32 v223, 31, v250
    v_lshlrev_b32 v220, 2, v219
    v_xor_b32 v220, v220, v251
    v_lshl_add_u32 v220, v219, 11, v220
    s_lshl_b32 s95, s100, 10
    s_add_u32 s95, s95, 129024
    v_lshl_add_u32 v221, v223, 5, v219
    v_add_u32 v221, s95, v221
    s_lshl_b32 s95, s5, 5
    v_add_u32 v223, s95, v223
    v_add_u32 v218, s4, v223
    v_min_u32 v222, 49999, v218
    s_waitcnt vmcnt(0)
    buffer_load_dwordx2 v[240:241], v222, s[16:19], 0 idxen
    v_xor_b32 v222, 0, v220
    ds_write_b128 v222, v[76:79]
    v_xor_b32 v222, 16, v220
    ds_write_b128 v222, v[80:83]
    v_xor_b32 v222, 32, v220
    ds_write_b128 v222, v[84:87]
    v_xor_b32 v222, 48, v220
    ds_write_b128 v222, v[88:91]
    v_xor_b32 v222, 64, v220
    ds_write_b128 v222, v[92:95]
    v_xor_b32 v222, 80, v220
    ds_write_b128 v222, v[96:99]
    v_xor_b32 v222, 96, v220
    ds_write_b128 v222, v[100:103]
    v_xor_b32 v222, 112, v220
    ds_write_b128 v222, v[104:107]
    ds_write_b128 v221, v[244:247]
    v_lshlrev_b32 v220, 2, v223
    ds_read_b32 v235, v220 offset:32768
    s_sub_u32 s99, s101, s94
    v_add_u32 v251, s99, v251
    v_add_u32 v252, s99, v252
    v_add_u32 v253, s99, v253
    v_add_u32 v254, s99, v254
    ds_read_b128 v[172:175], v251 offset:0
    ds_read_b128 v[176:179], v252 offset:0
    ds_read_b128 v[180:183], v253 offset:0
    ds_read_b128 v[184:187], v254 offset:0
    v_mov_b32 v76, 0
    v_mov_b32 v77, 0
    v_mov_b32 v78, 0
    v_mov_b32 v79, 0
    v_mov_b32 v80, 0
    v_mov_b32 v81, 0
    v_mov_b32 v82, 0
    v_mov_b32 v83, 0
    v_mov_b32 v84, 0
    v_mov_b32 v85, 0
    v_mov_b32 v86, 0
    v_mov_b32 v87, 0
    v_mov_b32 v88, 0
    v_mov_b32 v89, 0
    v_mov_b32 v90, 0
    v_mov_b32 v91, 0
    v_mov_b32 v92, 0
    v_mov_b32 v93, 0
    v_mov_b32 v94, 0
    v_mov_b32 v95, 0
    v_mov_b32 v96, 0
    v_mov_b32 v97, 0
    v_mov_b32 v98, 0
    v_mov_b32 v99, 0
    v_mov_b32 v100, 0
    v_mov_b32 v101, 0
    v_mov_b32 v102, 0
    v_mov_b32 v103, 0
    v_mov_b32 v104, 0
    v_mov_b32 v105, 0
    v_mov_b32 v106, 0
    v_mov_b32 v107, 0
    v_mov_b32 v244, 0
    v_mov_b32 v245, 0
    v_mov_b32 v246, 0
    s_lshl_b32 s99, s3, 8
    v_add_u32 v249, s99, v223
    v_mul_u32_u24 v249, 272, v249
    v_lshl_add_u32 v243, v219, 3, v249
    s_mov_b32 s99, 7602176
    s_cmp_eq_u32 s7, 0
    s_cbranch_scc1 K2_NOLD
    buffer_load_dwordx4 v[76:79], v243, s[20:23], s99 offen offset:0 sc0 sc1
    buffer_load_dwordx4 v[80:83], v243, s[20:23], s99 offen offset:16 sc0 sc1
    buffer_load_dwordx4 v[84:87], v243, s[20:23], s99 offen offset:32 sc0 sc1
    buffer_load_dwordx4 v[88:91], v243, s[20:23], s99 offen offset:48 sc0 sc1
    buffer_load_dwordx4 v[92:95], v243, s[20:23], s99 offen offset:64 sc0 sc1
    buffer_load_dwordx4 v[96:99], v243, s[20:23], s99 offen offset:80 sc0 sc1
    buffer_load_dwordx4 v[100:103], v243, s[20:23], s99 offen offset:96 sc0 sc1
    buffer_load_dwordx4 v[104:107], v243, s[20:23], s99 offen offset:112 sc0 sc1
    buffer_load_dwordx3 v[244:246], v249, s[20:23], s99 offen offset:256 sc0 sc1
    s_waitcnt vmcnt(0)
K2_NOLD:
    s_waitcnt lgkmcnt(0)
    v_and_b32 v207, 0xffff, v235
    v_lshrrev_b32 v235, 16, v235
    v_lshlrev_b32 v247, 11, v219
    v_add_u32 v247, 34816, v247
    v_add_u32 v220, 138240, v203
    v_cmp_lt_u32 vcc, 0, v235
    s_barrier
    s_cbranch_vccz K2_GDONE
K2_GLOOP:
    s_mov_b64 exec, vcc
    v_bfe_u32 v221, v207, 3, 3
    v_lshlrev_b32 v221, 4, v221
    v_lshl_add_u32 v221, v207, 5, v221
    v_add_u32 v221, v247, v221
    v_xor_b32 v222, 0, v221
    ds_read_b128 v[140:143], v222
    v_xor_b32 v222, 16, v221
    ds_read_b128 v[144:147], v222
    v_xor_b32 v222, 32, v221
    ds_read_b128 v[148:151], v222
    v_xor_b32 v222, 48, v221
    ds_read_b128 v[152:155], v222
    v_xor_b32 v222, 64, v221
    ds_read_b128 v[156:159], v222
    v_xor_b32 v222, 80, v221
    ds_read_b128 v[160:163], v222
    v_xor_b32 v222, 96, v221
    ds_read_b128 v[164:167], v222
    v_xor_b32 v222, 112, v221
    ds_read_b128 v[168:171], v222
    v_lshlrev_b32 v222, 3, v207
    v_add_u32 v222, 129024, v222
    ds_read_b128 v[188:191], v222
    ds_read_b128 v[192:195], v222 offset:16
    v_add_u32 v207, 4, v207
    v_subrev_u32 v235, 1, v235
    v_cmp_lt_u32 vcc, 0, v235
    s_waitcnt lgkmcnt(9)
    v_pk_add_f32 v[76:77], v[76:77], v[140:141]
    v_pk_add_f32 v[78:79], v[78:79], v[142:143]
    s_waitcnt lgkmcnt(8)
    v_pk_add_f32 v[80:81], v[80:81], v[144:145]
    v_pk_add_f32 v[82:83], v[82:83], v[146:147]
    s_waitcnt lgkmcnt(7)
    v_pk_add_f32 v[84:85], v[84:85], v[148:149]
    v_pk_add_f32 v[86:87], v[86:87], v[150:151]
    s_waitcnt lgkmcnt(6)
    v_pk_add_f32 v[88:89], v[88:89], v[152:153]
    v_pk_add_f32 v[90:91], v[90:91], v[154:155]
    s_waitcnt lgkmcnt(5)
    v_pk_add_f32 v[92:93], v[92:93], v[156:157]
    v_pk_add_f32 v[94:95], v[94:95], v[158:159]
    s_waitcnt lgkmcnt(4)
    v_pk_add_f32 v[96:97], v[96:97], v[160:161]
    v_pk_add_f32 v[98:99], v[98:99], v[162:163]
    s_waitcnt lgkmcnt(3)
    v_pk_add_f32 v[100:101], v[100:101], v[164:165]
    v_pk_add_f32 v[102:103], v[102:103], v[166:167]
    s_waitcnt lgkmcnt(2)
    v_pk_add_f32 v[104:105], v[104:105], v[168:169]
    v_pk_add_f32 v[106:107], v[106:107], v[170:171]
    s_waitcnt lgkmcnt(0)
    v_pk_add_f32 v[244:245], v[244:245], v[188:189]
    v_add_f32 v246, v246, v190
    v_pk_add_f32 v[244:245], v[244:245], v[192:193]
    v_add_f32 v246, v246, v194
    s_cbranch_vccnz K2_GLOOP
    s_mov_b64 exec, -1
K2_GDONE:
    s_cmp_eq_u32 s93, 0
    s_cbranch_scc1 K2_EPI
    buffer_store_dwordx4 v[76:79], v243, s[20:23], s99 offen offset:0
    buffer_store_dwordx4 v[80:83], v243, s[20:23], s99 offen offset:16
    buffer_store_dwordx4 v[84:87], v243, s[20:23], s99 offen offset:32
    buffer_store_dwordx4 v[88:91], v243, s[20:23], s99 offen offset:48
    buffer_store_dwordx4 v[92:95], v243, s[20:23], s99 offen offset:64
    buffer_store_dwordx4 v[96:99], v243, s[20:23], s99 offen offset:80
    buffer_store_dwordx4 v[100:103], v243, s[20:23], s99 offen offset:96
    buffer_store_dwordx4 v[104:107], v243, s[20:23], s99 offen offset:112
    buffer_store_dwordx3 v[244:246], v249, s[20:23], s99 offen offset:256
    s_add_u32 s7, s7, s92
    s_waitcnt vmcnt(0)
    s_barrier
    s_branch K2_TOP
K2_EPI:
    s_cmp_ge_u32 s5, 6
    s_cbranch_scc1 K2_NWH2
    s_mul_i32 s95, s5, 2048
    s_add_u32 m0, s95, 138240
    s_add_u32 s95, s95, 7561216
    buffer_load_dwordx4 v203, s[20:23], s95 offen offset:0 lds
    buffer_load_dwordx4 v203, s[20:23], s95 offen offset:1024 lds
K2_NWH2:
    s_lshl_b32 s95, s5, 5
    s_cmp_ge_u32 s95, s96
    s_waitcnt vmcnt(0)
    s_barrier
    s_cbranch_scc1 K2_END0
    ds_read_b128 v[0:3], v220 offset:20480
    ds_read_b128 v[4:7], v220 offset:21504
    ds_read_b128 v[8:11], v220 offset:22528
    ds_read_b128 v[12:15], v220 offset:23552
    ds_read_b128 v[16:19], v220 offset:0
    ds_read_b128 v[20:23], v220 offset:1024
    ds_read_b128 v[24:27], v220 offset:2048
    ds_read_b128 v[28:31], v220 offset:3072
    ds_read_b128 v[44:47], v220 offset:4096
    ds_read_b128 v[48:51], v220 offset:5120
    ds_read_b128 v[52:55], v220 offset:6144
    ds_read_b128 v[56:59], v220 offset:7168
    ds_read_b128 v[60:63], v220 offset:8192
    ds_read_b128 v[64:67], v220 offset:9216
    ds_read_b128 v[68:71], v220 offset:10240
    ds_read_b128 v[72:75], v220 offset:11264
    v_cmp_gt_u32_e64 s[44:45], s96, v223
    s_mov_b32 s98, s101
    s_waitcnt vmcnt(0)
    v_mov_b32 v242, v241
    v_and_b32 v241, 0xffff0000, v240
    v_lshlrev_b32 v240, 16, v240
K2_TAIL:
    v_add_u32 v235, s98, v203
    v_lshlrev_b32 v203, 7, v218
    v_cndmask_b32_e64 v203, 2.0, v203, s[44:45]
    s_waitcnt lgkmcnt(8)
    v_mfma_f32_32x32x16_bf16 v[140:155], v[0:3], v[172:175], 0
    v_cvt_pk_bf16_f32 v108, v76, v77
    v_cvt_pk_bf16_f32 v109, v78, v79
    v_mfma_f32_32x32x16_bf16 v[156:171], v[16:19], v[172:175], 0
    v_cvt_pk_bf16_f32 v110, v80, v81
    v_cvt_pk_bf16_f32 v111, v82, v83
    v_mfma_f32_32x32x16_bf16 v[140:155], v[4:7], v[176:179], v[140:155]
    v_cvt_pk_bf16_f32 v112, v84, v85
    v_cvt_pk_bf16_f32 v113, v86, v87
    v_mfma_f32_32x32x16_bf16 v[156:171], v[20:23], v[176:179], v[156:171]
    v_cvt_pk_bf16_f32 v114, v88, v89
    v_cvt_pk_bf16_f32 v115, v90, v91
    v_mfma_f32_32x32x16_bf16 v[140:155], v[8:11], v[180:183], v[140:155]
    v_cvt_pk_bf16_f32 v116, v92, v93
    v_cvt_pk_bf16_f32 v117, v94, v95
    v_mfma_f32_32x32x16_bf16 v[156:171], v[24:27], v[180:183], v[156:171]
    v_cvt_pk_bf16_f32 v118, v96, v97
    v_cvt_pk_bf16_f32 v119, v98, v99
    v_mfma_f32_32x32x16_bf16 v[140:155], v[12:15], v[184:187], v[140:155]
    v_cvt_pk_bf16_f32 v120, v100, v101
    v_cvt_pk_bf16_f32 v121, v102, v103
    v_mfma_f32_32x32x16_bf16 v[156:171], v[28:31], v[184:187], v[156:171]
    v_cvt_pk_bf16_f32 v122, v104, v105
    v_cvt_pk_bf16_f32 v123, v106, v107
    s_waitcnt lgkmcnt(0)
    ds_bpermute_b32 v210, v239, v203 offset:0
    ds_bpermute_b32 v212, v239, v203 offset:32
    ds_bpermute_b32 v214, v239, v203 offset:64
    ds_bpermute_b32 v216, v239, v203 offset:96
    v_mfma_f32_32x32x16_bf16 v[140:155], v[44:47], v[108:111], v[140:155]
    v_lshlrev_b32 v76, 16, v172
    v_and_b32 v77, 0xffff0000, v172
    v_lshlrev_b32 v78, 16, v173
    v_and_b32 v79, 0xffff0000, v173
    v_lshlrev_b32 v80, 16, v174
    v_and_b32 v81, 0xffff0000, v174
    v_lshlrev_b32 v82, 16, v175
    v_and_b32 v83, 0xffff0000, v175
    v_mfma_f32_32x32x16_bf16 v[140:155], v[48:51], v[112:115], v[140:155]
    v_lshlrev_b32 v84, 16, v176
    v_and_b32 v85, 0xffff0000, v176
    v_lshlrev_b32 v86, 16, v177
    v_and_b32 v87, 0xffff0000, v177
    v_lshlrev_b32 v88, 16, v178
    v_and_b32 v89, 0xffff0000, v178
    v_lshlrev_b32 v90, 16, v179
    v_and_b32 v91, 0xffff0000, v179
    v_mfma_f32_32x32x16_bf16 v[140:155], v[52:55], v[116:119], v[140:155]
    v_lshlrev_b32 v92, 16, v180
    v_and_b32 v93, 0xffff0000, v180
    v_lshlrev_b32 v94, 16, v181
    v_and_b32 v95, 0xffff0000, v181
    v_lshlrev_b32 v96, 16, v182
    v_and_b32 v97, 0xffff0000, v182
    v_lshlrev_b32 v98, 16, v183
    v_and_b32 v99, 0xffff0000, v183
    v_mfma_f32_32x32x16_bf16 v[140:155], v[56:59], v[120:123], v[140:155]
    v_lshlrev_b32 v100, 16, v184
    v_and_b32 v101, 0xffff0000, v184
    v_lshlrev_b32 v102, 16, v185
    v_and_b32 v103, 0xffff0000, v185
    v_lshlrev_b32 v104, 16, v186
    v_and_b32 v105, 0xffff0000, v186
    v_lshlrev_b32 v106, 16, v187
    v_and_b32 v107, 0xffff0000, v187
    v_mfma_f32_32x32x16_bf16 v[156:171], v[60:63], v[108:111], v[156:171]
    v_mov_b32 v243, 0
    v_pk_add_f32 v[244:245], v[244:245], v[240:241]
    v_add_f32 v246, v246, v242
    v_cvt_pk_bf16_f32 v244, v244, v245
    v_cvt_pk_bf16_f32 v246, v246, v246
    s_mov_b32 exec_lo, s44
    s_mov_b32 exec_hi, 0
    s_cmp_eq_u32 s98, s94
    s_cbranch_scc1 K2_PF
    v_mul_u32_u24 v220, 6, v218
    s_mov_b32 s99, 6400000
    buffer_store_short v244, v220, s[24:27], s99 offen
    buffer_store_short_d16_hi v244, v220, s[24:27], s99 offen offset:2
    buffer_store_short v246, v220, s[24:27], s99 offen offset:4
    s_branch K2_PD
K2_PF:
    s_mov_b32 s99, 32768
    v_mad_u32_u24 v220, v249, 6, s99
    ds_write_b16 v220, v244
    ds_write_b16_d16_hi v220, v244 offset:2
    ds_write_b16 v220, v246 offset:4
    s_mov_b64 exec, 1
    v_mov_b32 v220, 108
    v_mov_b32 v221, 1
    ds_add_rtn_u32 v243, v220, v221
K2_PD:
    s_mov_b64 exec, -1
    s_mov_b32 s40, 0xbf317218
    s_mov_b32 s41, 0xbf317218
    v_mfma_f32_32x32x16_bf16 v[156:171], v[64:67], v[112:115], v[156:171]
    v_exp_f32 v220, v140
    v_exp_f32 v221, v141
    v_exp_f32 v222, v142
    v_exp_f32 v223, v143
    v_mfma_f32_32x32x16_bf16 v[156:171], v[68:71], v[116:119], v[156:171]
    v_exp_f32 v224, v144
    v_exp_f32 v225, v145
    v_exp_f32 v226, v146
    v_exp_f32 v227, v147
    v_pk_add_f32 v[220:221], v[220:221], 1.0 op_sel_hi:[1,0]
    v_pk_add_f32 v[222:223], v[222:223], 1.0 op_sel_hi:[1,0]
    v_mfma_f32_32x32x16_bf16 v[156:171], v[72:75], v[120:123], v[156:171]
    v_pk_add_f32 v[224:225], v[224:225], 1.0 op_sel_hi:[1,0]
    v_pk_add_f32 v[226:227], v[226:227], 1.0 op_sel_hi:[1,0]
    v_rcp_f32 v220, v220
    v_rcp_f32 v221, v221
    v_rcp_f32 v222, v222
    v_rcp_f32 v223, v223
    v_rcp_f32 v224, v224
    v_rcp_f32 v225, v225
    v_rcp_f32 v226, v226
    v_rcp_f32 v227, v227
    s_waitcnt lgkmcnt(0)
    v_add_u32 v210, v210, v211
    v_add_u32 v212, v212, v213
    v_add_u32 v214, v214, v215
    v_add_u32 v216, v216, v217
    v_pk_mul_f32 v[220:221], v[220:221], v[140:141]
    v_pk_mul_f32 v[222:223], v[222:223], v[142:143]
    v_pk_mul_f32 v[224:225], v[224:225], v[144:145]
    v_pk_mul_f32 v[226:227], v[226:227], v[146:147]
    v_pk_fma_f32 v[220:221], v[220:221], s[40:41], v[76:77]
    v_pk_fma_f32 v[222:223], v[222:223], s[40:41], v[78:79]
    v_pk_fma_f32 v[224:225], v[224:225], s[40:41], v[80:81]
    v_pk_fma_f32 v[226:227], v[226:227], s[40:41], v[82:83]
    v_cvt_pk_bf16_f32 v172, v220, v221
    v_cvt_pk_bf16_f32 v173, v222, v223
    v_cvt_pk_bf16_f32 v174, v224, v225
    v_cvt_pk_bf16_f32 v175, v226, v227
    s_waitcnt vmcnt(0)
    ds_write_b128 v251, v[172:175]
    v_exp_f32 v220, v148
    v_exp_f32 v221, v149
    v_exp_f32 v222, v150
    v_exp_f32 v223, v151
    v_exp_f32 v224, v152
    v_exp_f32 v225, v153
    v_exp_f32 v226, v154
    v_exp_f32 v227, v155
    v_pk_add_f32 v[220:221], v[220:221], 1.0 op_sel_hi:[1,0]
    v_pk_add_f32 v[222:223], v[222:223], 1.0 op_sel_hi:[1,0]
    v_pk_add_f32 v[224:225], v[224:225], 1.0 op_sel_hi:[1,0]
    v_pk_add_f32 v[226:227], v[226:227], 1.0 op_sel_hi:[1,0]
    v_rcp_f32 v220, v220
    v_rcp_f32 v221, v221
    v_rcp_f32 v222, v222
    v_rcp_f32 v223, v223
    v_rcp_f32 v224, v224
    v_rcp_f32 v225, v225
    v_rcp_f32 v226, v226
    v_rcp_f32 v227, v227
    v_pk_mul_f32 v[220:221], v[220:221], v[148:149]
    v_pk_mul_f32 v[222:223], v[222:223], v[150:151]
    v_pk_mul_f32 v[224:225], v[224:225], v[152:153]
    v_pk_mul_f32 v[226:227], v[226:227], v[154:155]
    v_pk_fma_f32 v[220:221], v[220:221], s[40:41], v[84:85]
    v_pk_fma_f32 v[222:223], v[222:223], s[40:41], v[86:87]
    v_pk_fma_f32 v[224:225], v[224:225], s[40:41], v[88:89]
    v_pk_fma_f32 v[226:227], v[226:227], s[40:41], v[90:91]
    v_cvt_pk_bf16_f32 v176, v220, v221
    v_cvt_pk_bf16_f32 v177, v222, v223
    v_cvt_pk_bf16_f32 v178, v224, v225
    v_cvt_pk_bf16_f32 v179, v226, v227
    ds_write_b128 v252, v[176:179]
    v_exp_f32 v220, v156
    v_exp_f32 v221, v157
    v_exp_f32 v222, v158
    v_exp_f32 v223, v159
    v_exp_f32 v224, v160
    v_exp_f32 v225, v161
    v_exp_f32 v226, v162
    v_exp_f32 v227, v163
    v_pk_add_f32 v[220:221], v[220:221], 1.0 op_sel_hi:[1,0]
    v_pk_add_f32 v[222:223], v[222:223], 1.0 op_sel_hi:[1,0]
    v_pk_add_f32 v[224:225], v[224:225], 1.0 op_sel_hi:[1,0]
    v_pk_add_f32 v[226:227], v[226:227], 1.0 op_sel_hi:[1,0]
    v_rcp_f32 v220, v220
    v_rcp_f32 v221, v221
    v_rcp_f32 v222, v222
    v_rcp_f32 v223, v223
    v_rcp_f32 v224, v224
    v_rcp_f32 v225, v225
    v_rcp_f32 v226, v226
    v_rcp_f32 v227, v227
    v_pk_mul_f32 v[220:221], v[220:221], v[156:157]
    v_pk_mul_f32 v[222:223], v[222:223], v[158:159]
    v_pk_mul_f32 v[224:225], v[224:225], v[160:161]
    v_pk_mul_f32 v[226:227], v[226:227], v[162:163]
    v_pk_fma_f32 v[220:221], v[220:221], s[40:41], v[92:93]
    v_pk_fma_f32 v[222:223], v[222:223], s[40:41], v[94:95]
    v_pk_fma_f32 v[224:225], v[224:225], s[40:41], v[96:97]
    v_pk_fma_f32 v[226:227], v[226:227], s[40:41], v[98:99]
    v_cvt_pk_bf16_f32 v180, v220, v221
    v_cvt_pk_bf16_f32 v181, v222, v223
    v_cvt_pk_bf16_f32 v182, v224, v225
    v_cvt_pk_bf16_f32 v183, v226, v227
    ds_write_b128 v253, v[180:183]
    v_exp_f32 v220, v164
    v_exp_f32 v221, v165
    v_exp_f32 v222, v166
    v_exp_f32 v223, v167
    v_exp_f32 v224, v168
    v_exp_f32 v225, v169
    v_exp_f32 v226, v170
    v_exp_f32 v227, v171
    v_pk_add_f32 v[220:221], v[220:221], 1.0 op_sel_hi:[1,0]
    v_pk_add_f32 v[222:223], v[222:223], 1.0 op_sel_hi:[1,0]
    v_pk_add_f32 v[224:225], v[224:225], 1.0 op_sel_hi:[1,0]
    v_pk_add_f32 v[226:227], v[226:227], 1.0 op_sel_hi:[1,0]
    v_rcp_f32 v220, v220
    v_rcp_f32 v221, v221
    v_rcp_f32 v222, v222
    v_rcp_f32 v223, v223
    v_rcp_f32 v224, v224
    v_rcp_f32 v225, v225
    v_rcp_f32 v226, v226
    v_rcp_f32 v227, v227
    v_pk_mul_f32 v[220:221], v[220:221], v[164:165]
    v_pk_mul_f32 v[222:223], v[222:223], v[166:167]
    v_pk_mul_f32 v[224:225], v[224:225], v[168:169]
    v_pk_mul_f32 v[226:227], v[226:227], v[170:171]
    v_pk_fma_f32 v[220:221], v[220:221], s[40:41], v[100:101]
    v_pk_fma_f32 v[222:223], v[222:223], s[40:41], v[102:103]
    v_pk_fma_f32 v[224:225], v[224:225], s[40:41], v[104:105]
    v_pk_fma_f32 v[226:227], v[226:227], s[40:41], v[106:107]
    v_cvt_pk_bf16_f32 v184, v220, v221
    v_cvt_pk_bf16_f32 v185, v222, v223
    v_cvt_pk_bf16_f32 v186, v224, v225
    v_cvt_pk_bf16_f32 v187, v226, v227
    ds_write_b128 v254, v[184:187]
    ds_read_b128 v[140:143], v235 offset:0
    ds_read_b128 v[144:147], v235 offset:1024
    ds_read_b128 v[148:151], v235 offset:2048
    ds_read_b128 v[152:155], v235 offset:3072
    s_waitcnt lgkmcnt(3)
    buffer_store_dwordx4 v[140:143], v210, s[24:27], 0 offen sc1
    s_waitcnt lgkmcnt(2)
    buffer_store_dwordx4 v[144:147], v212, s[24:27], 0 offen sc1
    s_waitcnt lgkmcnt(1)
    buffer_store_dwordx4 v[148:151], v214, s[24:27], 0 offen sc1
    s_waitcnt lgkmcnt(0)
    buffer_store_dwordx4 v[152:155], v216, s[24:27], 0 offen sc1
    v_readfirstlane_b32 s95, v243
    v_and_b32 v220, 63, v250
    v_lshlrev_b32 v220, 3, v220
    s_cmp_lg_u32 s95, 7
    s_cbranch_scc1 K2_PE
    ds_read_b64 v[188:189], v220 offset:32768
    ds_read_b64 v[190:191], v220 offset:33280
    ds_read_b64 v[192:193], v220 offset:33792
    s_mul_i32 s99, s4, 6
    s_add_u32 s99, s99, 6400000
    s_mul_i32 s95, s96, 6
    v_cmp_gt_i32 vcc, s95, v220
    s_sub_i32 s95, s95, 512
    s_waitcnt lgkmcnt(2)
    s_mov_b64 exec, vcc
    buffer_store_dwordx2 v[188:189], v220, s[24:27], s99 offen offset:0 sc1
    v_cmp_gt_i32 vcc, s95, v220
    s_sub_i32 s95, s95, 512
    s_waitcnt lgkmcnt(1)
    s_mov_b64 exec, vcc
    buffer_store_dwordx2 v[190:191], v220, s[24:27], s99 offen offset:512 sc1
    v_cmp_gt_i32 vcc, s95, v220
    s_sub_i32 s95, s95, 512
    s_waitcnt lgkmcnt(0)
    s_mov_b64 exec, vcc
    buffer_store_dwordx2 v[192:193], v220, s[24:27], s99 offen offset:1024 sc1
    s_mov_b64 exec, -1
K2_PE:
    s_endpgm
K2_END0:
    s_waitcnt vmcnt(0)
K2_END:
    s_endpgm
.section .rodata,"a"
.p2align 6
.amdhsa_kernel egnn_sort_kernel
  .amdhsa_next_free_vgpr 56
  .amdhsa_next_free_sgpr 48
  .amdhsa_accum_offset 56
  .amdhsa_group_segment_fixed_size 0
  .amdhsa_kernarg_size 88
  .amdhsa_user_sgpr_count 2
  .amdhsa_user_sgpr_kernarg_segment_ptr 1
  .amdhsa_system_sgpr_workgroup_id_x 1
.end_amdhsa_kernel
.p2align 6
.amdhsa_kernel egnn_main_kernel
  .amdhsa_next_free_vgpr 256
  .amdhsa_next_free_sgpr 102
  .amdhsa_accum_offset 256
  .amdhsa_group_segment_fixed_size 0
  .amdhsa_kernarg_size 88
  .amdhsa_user_sgpr_count 2
  .amdhsa_user_sgpr_kernarg_segment_ptr 1
  .amdhsa_system_sgpr_workgroup_id_x 1
.end_amdhsa_kernel
```

```asm
; @launch kernel=egnn_sort_kernel grid=(250,1,1) block=(896,1,1) lds=27904
; @launch kernel=egnn_main_kernel grid=(256,1,1) block=(512,1,1) lds=162816
.amdgcn_target "amdgcn-amd-amdhsa--gfx950"
.text
.globl egnn_sort_kernel
.p2align 8
.type egnn_sort_kernel,@function
egnn_sort_kernel:
    s_cmp_ge_u32 s2, 250
    s_cbranch_scc1 K1_END
    s_load_dwordx2 s[38:39], s[0:1], 80
    v_lshrrev_b32 v1, 6, v0
    s_nop 0
    v_readfirstlane_b32 s3, v1
    s_cmp_ge_u32 s3, 13
    s_cbranch_scc1 K1_FRAG
    s_load_dwordx4 s[4:7], s[0:1], 24
    s_load_dwordx4 s[8:11], s[0:1], 8
    s_and_b32 s28, s2, 7
    s_min_u32 s29, s28, 2
    s_mul_i32 s28, s28, 31
    s_lshr_b32 s2, s2, 3
    s_add_u32 s2, s2, s28
    s_add_u32 s2, s2, s29
    v_lshlrev_b32 v1, 2, v0
    v_mov_b32 v2, 0
    v_mov_b32 v3, 1
    v_cmp_gt_u32 vcc, 288, v0
    s_mov_b64 exec, vcc
    ds_write_b32 v1, v2 offset:0
    s_mov_b64 exec, -1
    s_mul_i32 s28, s2, 12800
    s_mul_i32 s29, s2, 200
    s_mul_i32 s30, s2, 3200
    s_mov_b32 s31, 85599
    s_movk_i32 s32, -196
    v_add_u32 v12, s29, v0
    v_mul_u32_u24 v13, 6, v12
    v_lshlrev_b32 v14, 4, v0
    v_mov_b32 v15, 800
    v_cmp_gt_u32 s[34:35], v15, v0
    v_mov_b32 v15, 200
    v_cmp_gt_u32 s[36:37], v15, v0
    s_waitcnt lgkmcnt(0)
    s_mov_b32 s12, s4
    s_and_b32 s13, s5, 0xffff
    s_mov_b32 s14, 3200000
    s_mov_b32 s15, 0x20000
    s_mov_b32 s16, s6
    s_and_b32 s17, s7, 0xffff
    s_mov_b32 s18, 3200000
    s_mov_b32 s19, 0x20000
    s_mov_b32 s20, s8
    s_and_b32 s21, s9, 0xffff
    s_mov_b32 s22, 300000
    s_mov_b32 s23, 0x20000
    s_mov_b32 s24, s38
    s_and_b32 s25, s39, 0xffff
    s_mov_b32 s26, 25600000
    s_mov_b32 s27, 0x20000
    s_cmp_ge_u32 s3, 4
    s_cbranch_scc1 K1_NOPOS
    s_mov_b64 exec, s[36:37]
    buffer_load_ushort v16, v13, s[20:23], 0 offen
    buffer_load_ushort v17, v13, s[20:23], 0 offen offset:2
    buffer_load_ushort v18, v13, s[20:23], 0 offen offset:4
K1_NOPOS:
    s_mov_b64 exec, s[34:35]
    buffer_load_dwordx4 v[4:7], v14, s[16:19], s28 offen nt
    v_add_u32 v20, s30, v1
    v_add_u32 v22, 1, v20
    v_add_u32 v24, 2, v20
    v_add_u32 v26, 3, v20
    s_barrier
    s_waitcnt vmcnt(0)
    buffer_load_dwordx4 v[8:11], v14, s[12:15], s28 offen nt
    v_mul_u32_u24 v28, s31, v4
    v_lshrrev_b32 v28, 24, v28
    v_mad_i32_i24 v4, v28, s32, v4
    v_lshlrev_b32 v28, 2, v28
    ds_add_rtn_u32 v32, v28, v3 offset:0
    v_mul_u32_u24 v29, s31, v5
    v_lshrrev_b32 v29, 24, v29
    v_mad_i32_i24 v5, v29, s32, v5
    v_lshlrev_b32 v29, 2, v29
    ds_add_rtn_u32 v33, v29, v3 offset:0
    v_mul_u32_u24 v30, s31, v6
    v_lshrrev_b32 v30, 24, v30
    v_mad_i32_i24 v6, v30, s32, v6
    v_lshlrev_b32 v30, 2, v30
    ds_add_rtn_u32 v34, v30, v3 offset:0
    v_mul_u32_u24 v31, s31, v7
    v_lshrrev_b32 v31, 24, v31
    v_mad_i32_i24 v7, v31, s32, v7
    v_lshlrev_b32 v31, 2, v31
    ds_add_rtn_u32 v35, v31, v3 offset:0
    s_cmp_ge_u32 s3, 4
    s_cbranch_scc1 K1_P3
    s_mov_b64 exec, s[36:37]
    v_lshl_or_b32 v16, v17, 16, v16
    v_lshlrev_b32 v17, 16, v18
    v_lshlrev_b32 v12, 3, v12
    s_mov_b32 s33, 6684672
    buffer_store_dwordx2 v[16:17], v12, s[24:27], s33 offen
    s_mov_b64 exec, s[34:35]
K1_P3:
    s_mov_b64 exec, -1
    v_and_b32 v2, 63, v0
    v_lshlrev_b32 v2, 4, v2
    s_waitcnt lgkmcnt(0)
    s_barrier
    ds_read_b128 v[36:39], v2 offset:0
    s_waitcnt lgkmcnt(0)
    v_add_u32 v42, v36, v37
    v_add_u32 v43, v42, v38
    v_add_u32 v44, v43, v39
    v_mov_b32 v45, v44
    s_nop 1
    v_add_u32_dpp v45, v45, v45 row_shr:1 row_mask:0xf bank_mask:0xf
    s_nop 1
    v_add_u32_dpp v45, v45, v45 row_shr:2 row_mask:0xf bank_mask:0xf
    s_nop 1
    v_add_u32_dpp v45, v45, v45 row_shr:4 row_mask:0xf bank_mask:0xf
    s_nop 1
    v_add_u32_dpp v45, v45, v45 row_shr:8 row_mask:0xf bank_mask:0xf
    s_nop 1
    v_add_u32_dpp v45, v45, v45 row_bcast:15 row_mask:0xa bank_mask:0xf
    s_nop 1
    v_add_u32_dpp v45, v45, v45 row_bcast:31 row_mask:0xc bank_mask:0xf
    v_sub_u32 v40, v45, v44
    v_add_u32 v41, v40, v36
    v_add_u32 v42, v40, v42
    v_add_u32 v43, v40, v43
    v_lshlrev_b32 v48, 3, v40
    v_lshlrev_b32 v49, 3, v41
    v_lshlrev_b32 v50, 3, v42
    v_lshlrev_b32 v51, 3, v43
    ds_write_b128 v2, v[48:51] offset:1280
    s_mov_b64 exec, s[34:35]
    ds_read_b32 v28, v28 offset:1280
    ds_read_b32 v29, v29 offset:1280
    ds_read_b32 v30, v30 offset:1280
    ds_read_b32 v31, v31 offset:1280
    s_cmp_ge_u32 s3, 4
    s_cbranch_scc1 K1_SW0
    s_waitcnt vmcnt(1)
    s_branch K1_SW1
K1_SW0:
    s_waitcnt vmcnt(0)
K1_SW1:
    v_mul_u32_u24 v21, 1342, v8
    v_lshrrev_b32 v21, 24, v21
    v_lshl_or_b32 v4, v4, 2, v21
    v_lshl_or_b32 v21, v4, 18, v8
    v_mul_u32_u24 v23, 1342, v9
    v_lshrrev_b32 v23, 24, v23
    v_lshl_or_b32 v5, v5, 2, v23
    v_lshl_or_b32 v23, v5, 18, v9
    v_mul_u32_u24 v25, 1342, v10
    v_lshrrev_b32 v25, 24, v25
    v_lshl_or_b32 v6, v6, 2, v25
    v_lshl_or_b32 v25, v6, 18, v10
    v_mul_u32_u24 v27, 1342, v11
    v_lshrrev_b32 v27, 24, v27
    v_lshl_or_b32 v7, v7, 2, v27
    v_lshl_or_b32 v27, v7, 18, v11
    s_cmp_lg_u32 s3, 12
    s_cbranch_scc1 K1_NOOFF
    s_mov_b64 exec, -1
    v_lshl_or_b32 v40, v36, 16, v40
    v_lshl_or_b32 v41, v37, 16, v41
    v_lshl_or_b32 v42, v38, 16, v42
    v_lshl_or_b32 v43, v39, 16, v43
    v_lshlrev_b32 v2, 8, v2
    s_lshl_b32 s33, s2, 4
    s_add_u32 s33, s33, 6422528
    buffer_store_dwordx4 v[40:43], v2, s[24:27], s33 offen
    s_mov_b64 exec, s[34:35]
K1_NOOFF:
    s_waitcnt lgkmcnt(3)
    v_lshl_add_u32 v28, v32, 3, v28
    ds_write_b64 v28, v[20:21] offset:2304
    s_waitcnt lgkmcnt(3)
    v_lshl_add_u32 v29, v33, 3, v29
    ds_write_b64 v29, v[22:23] offset:2304
    s_waitcnt lgkmcnt(3)
    v_lshl_add_u32 v30, v34, 3, v30
    ds_write_b64 v30, v[24:25] offset:2304
    s_waitcnt lgkmcnt(3)
    v_lshl_add_u32 v31, v35, 3, v31
    ds_write_b64 v31, v[26:27] offset:2304
    s_mul_i32 s33, s2, 25600
    s_add_u32 s38, s33, 12800
    s_waitcnt lgkmcnt(0)
    s_barrier
    ds_read_b128 v[4:7], v14 offset:2304
    ds_read_b128 v[8:11], v14 offset:15104
    s_waitcnt lgkmcnt(1)
    buffer_store_dwordx4 v[4:7], v14, s[24:27], s33 offen sc1
    s_waitcnt lgkmcnt(0)
    buffer_store_dwordx4 v[8:11], v14, s[24:27], s38 offen sc1
    s_endpgm
K1_FRAG:
    s_cmp_ge_u32 s2, 144
    s_cbranch_scc1 K1_END
    s_load_dwordx4 s[4:7], s[0:1], 40
    s_load_dwordx2 s[8:9], s[0:1], 56
    s_lshr_b32 s28, s2, 2
    s_and_b32 s3, s2, 3
    s_lshl_b32 s3, s3, 6
    v_and_b32 v1, 63, v0
    v_add_u32 v1, s3, v1
    v_lshlrev_b32 v10, 2, v1
    s_lshl_b32 s33, s28, 10
    s_add_u32 s33, s33, 7536640
    s_mov_b32 s34, 0xbfb8aa3b
    s_waitcnt lgkmcnt(0)
    s_mov_b32 s12, s4
    s_and_b32 s13, s5, 0xffff
    s_mov_b32 s14, 18560
    s_mov_b32 s15, 0x20000
    s_mov_b32 s16, s6
    s_and_b32 s17, s7, 0xffff
    s_mov_b32 s18, 128
    s_mov_b32 s19, 0x20000
    s_mov_b32 s20, s8
    s_and_b32 s21, s9, 0xffff
    s_mov_b32 s22, 16384
    s_mov_b32 s23, 0x20000
    s_mov_b32 s24, s38
    s_and_b32 s25, s39, 0xffff
    s_mov_b32 s26, 25427968
    s_mov_b32 s27, 0x20000
    s_cmp_eq_u32 s28, 19
    s_cbranch_scc1 K1_WX
    s_cmp_eq_u32 s28, 18
    s_cbranch_scc1 K1_W3
    v_lshrrev_b32 v2, 2, v1
    v_and_b32 v3, 4, v2
    v_lshlrev_b32 v3, 3, v3
    v_bfe_u32 v4, v2, 3, 2
    v_lshl_add_u32 v3, v4, 2, v3
    v_and_b32 v4, 3, v2
    v_add_u32 v3, v3, v4
    v_lshrrev_b32 v5, 7, v1
    v_and_b32 v6, 3, v1
    s_mov_b32 s35, 32
    s_cmp_ge_u32 s28, 18
    s_cbranch_scc1 K1_FH
    s_cmp_ge_u32 s28, 16
    s_cbranch_scc1 K1_F4
    s_mov_b32 s36, s28
    s_branch K1_FC
K1_FH:
    s_sub_u32 s36, s28, 20
    s_mov_b32 s12, s20
    s_mov_b32 s13, s21
    s_mov_b32 s14, s22
    s_cmp_ge_u32 s36, 8
    s_cselect_b32 s34, 1.0, s34
K1_FC:
    s_lshr_b32 s37, s36, 3
    s_lshl_b32 s37, s37, 6
    s_and_b32 s38, s36, 3
    s_lshl_b32 s38, s38, 3
    s_add_u32 s37, s37, s38
    s_bfe_u32 s38, s36, 0x10002
    s_branch K1_FD
K1_F4:
    s_mov_b32 s35, 8
    s_movk_i32 s37, 129
    s_sub_u32 s38, s28, 16
K1_FD:
    s_lshl_b32 s38, s38, 4
    v_mul_u32_u24 v5, s35, v5
    v_lshl_add_u32 v5, v6, 1, v5
    v_add_u32 v5, s37, v5
    v_add_u32 v3, s38, v3
    v_lshlrev_b32 v3, 1, v3
    v_lshl_add_u32 v3, v5, 7, v3
    buffer_load_ushort v7, v3, s[12:15], 0 offen
    buffer_load_ushort v8, v3, s[12:15], 0 offen offset:128
    s_waitcnt vmcnt(0)
    v_lshlrev_b32 v7, 16, v7
    v_lshlrev_b32 v8, 16, v8
    v_mul_f32 v7, s34, v7
    v_mul_f32 v8, s34, v8
    v_cvt_pk_bf16_f32 v7, v7, v8
    buffer_store_dword v7, v10, s[24:27], s33 offen
    s_endpgm
K1_W3:
    v_and_b32 v2, 31, v1
    v_and_b32 v3, 4, v2
    v_lshlrev_b32 v3, 3, v3
    v_bfe_u32 v4, v2, 3, 2
    v_lshl_add_u32 v3, v4, 2, v3
    v_and_b32 v4, 3, v2
    v_add_u32 v3, v3, v4
    v_bfe_u32 v5, v1, 6, 1
    v_lshl_add_u32 v3, v5, 4, v3
    v_lshlrev_b32 v3, 1, v3
    s_movk_i32 s35, 16384
    buffer_load_ushort v7, v3, s[12:15], s35 offen
    v_and_b32 v6, 32, v1
    v_cmp_eq_u32 vcc, 0, v6
    s_waitcnt vmcnt(0)
    v_lshlrev_b32 v7, 16, v7
    v_mul_f32 v7, s34, v7
    v_cvt_pk_bf16_f32 v8, v7, v7
    v_lshlrev_b32 v8, 16, v8
    v_sub_f32 v9, v7, v8
    v_cvt_pk_bf16_f32 v7, v8, v9
    v_cndmask_b32 v7, 0, v7, vcc
    buffer_store_dword v7, v10, s[24:27], s33 offen
    s_endpgm
K1_WX:
    v_lshlrev_b32 v3, 1, v1
    buffer_load_ushort v7, v3, s[16:19], 0 offen
    s_waitcnt vmcnt(0)
    v_lshlrev_b32 v7, 16, v7
    v_mul_f32 v7, 0xbf317218, v7
    buffer_store_dword v7, v10, s[24:27], s33 offen
K1_END:
    s_endpgm
.globl egnn_main_kernel
.p2align 8
.type egnn_main_kernel,@function
egnn_main_kernel:
    s_cmp_ge_u32 s2, 256
    s_cbranch_scc1 K2_END
    s_load_dwordx2 s[28:29], s[0:1], 0
    s_load_dwordx2 s[30:31], s[0:1], 16
    s_load_dwordx2 s[32:33], s[0:1], 64
    s_load_dwordx2 s[34:35], s[0:1], 80
    v_mov_b32 v250, v0
    v_lshrrev_b32 v220, 6, v0
    s_and_b32 s3, s2, 7
    s_lshl_b32 s3, s3, 5
    v_readfirstlane_b32 s5, v220
    s_lshr_b32 s95, s2, 3
    s_add_u32 s3, s3, s95
    s_mul_i32 s4, s3, 196
    s_sub_u32 s96, 50000, s4
    s_min_u32 s96, s96, 196
    s_mov_b32 s7, 0
    s_mov_b32 s92, 48
    s_sub_u32 s100, 11, s5
    s_cmp_lt_u32 s5, 4
    s_cselect_b32 s100, s5, s100
    s_lshl_b32 s94, s100, 12
    s_add_u32 s94, s94, 34816
    s_waitcnt lgkmcnt(0)
    s_add_u32 s88, s34, 6422528
    s_addc_u32 s89, s35, 0
    s_and_b32 s89, s89, 0xffff
    s_mov_b32 s90, 262144
    s_mov_b32 s91, 0x20000
    s_mov_b32 s8, s28
    s_and_b32 s9, s29, 0xffff
    s_or_b32 s9, s9, 8388608
    s_mov_b32 s10, 50000
    s_mov_b32 s11, 0x20000
    s_mov_b32 s12, s30
    s_and_b32 s13, s31, 0xffff
    s_or_b32 s13, s13, 2097152
    s_mov_b32 s14, 800000
    s_mov_b32 s15, 0x20000
    s_add_u32 s16, s34, 6684672
    s_addc_u32 s17, s35, 0
    s_and_b32 s17, s17, 0xffff
    s_or_b32 s17, s17, 524288
    s_mov_b32 s18, 50000
    s_mov_b32 s19, 0x20000
    s_mov_b32 s20, s34
    s_and_b32 s21, s35, 0xffff
    s_mov_b32 s22, 25427968
    s_mov_b32 s23, 0x20000
    s_mov_b32 s24, s32
    s_and_b32 s25, s33, 0xffff
    s_mov_b32 s26, 6700000
    s_mov_b32 s27, 0x20000
K2_TOP:
    v_bfe_u32 v220, v250, 4, 2
    s_mul_i32 s95, s5, 36
    s_sub_u32 s95, s95, 36
    v_mad_u32_u24 v220, v220, 9, s95
    v_lshlrev_b32 v221, 4, v220
    s_and_b32 s95, s3, 3
    s_mul_i32 s95, s95, 1020
    s_lshl_b32 s99, s3, 10
    s_sub_u32 s95, s99, s95
    s_cmp_eq_u32 s5, 0
    s_cbranch_scc1 K2_NOOF
    buffer_load_dword v172, v221, s[88:91], s95 offen offset:0
    buffer_load_dword v173, v221, s[88:91], s95 offen offset:16
    buffer_load_dword v174, v221, s[88:91], s95 offen offset:32
    buffer_load_dword v175, v221, s[88:91], s95 offen offset:48
    buffer_load_dword v176, v221, s[88:91], s95 offen offset:64
    buffer_load_dword v177, v221, s[88:91], s95 offen offset:80
    buffer_load_dword v178, v221, s[88:91], s95 offen offset:96
    buffer_load_dword v179, v221, s[88:91], s95 offen offset:112
    buffer_load_dword v180, v221, s[88:91], s95 offen offset:128
K2_NOOF:
    v_and_b32 v222, 63, v250
    v_lshlrev_b32 v203, 4, v222
    v_lshrrev_b32 v239, 3, v222
    v_lshrrev_b32 v223, 4, v222
    v_xor_b32 v223, v223, v222
    v_and_b32 v223, 7, v223
    v_lshlrev_b32 v211, 4, v223
    v_xor_b32 v213, 64, v211
    v_mov_b32 v215, v211
    v_mov_b32 v217, v213
    s_lshl_b32 s95, s5, 5
    s_add_u32 s95, s95, s4
    v_add_u32 v210, s95, v239
    v_add_u32 v212, 8, v210
    v_add_u32 v214, 16, v210
    v_add_u32 v216, 24, v210
    s_add_u32 s99, s4, s96
    v_cmp_gt_u32 vcc, s99, v210
    s_nop 1
    v_cndmask_b32 v210, -1, v210, vcc
    v_cmp_gt_u32 vcc, s99, v212
    s_nop 1
    v_cndmask_b32 v212, -1, v212, vcc
    v_cmp_gt_u32 vcc, s99, v214
    s_nop 1
    v_cndmask_b32 v214, -1, v214, vcc
    v_cmp_gt_u32 vcc, s99, v216
    s_nop 1
    v_cndmask_b32 v216, -1, v216, vcc
    s_lshl_b32 s101, s5, 12
    s_add_u32 s101, s101, 100352
    s_barrier
    s_mul_i32 s95, s5, 3072
    s_add_u32 m0, s95, 138240
    s_add_u32 s95, s95, 7536640
    buffer_load_dwordx4 v203, s[20:23], s95 offen offset:0 lds
    buffer_load_dwordx4 v203, s[20:23], s95 offen offset:1024 lds
    buffer_load_dwordx4 v203, s[20:23], s95 offen offset:2048 lds
    v_mov_b32 v228, 0
    v_mov_b32 v229, 0
    v_mov_b32 v230, 0
    v_mov_b32 v231, 0
    s_lshl_b32 s95, s5, 10
    s_cmp_ge_u32 s5, 4
    s_cselect_b32 s99, 30720, 0
    s_add_u32 s95, s95, s99
    v_add_u32 v223, s95, v203
    ds_write_b128 v223, v[228:231]
    v_and_b32 v223, 2047, v223
    ds_write_b128 v223, v[228:231] offset:38912
    v_lshlrev_b32 v239, 2, v239
    v_mov_b32 v41, 0
    v_mov_b32 v43, 0
    v_mov_b32 v209, 0
    v_lshrrev_b32 v219, 5, v222
    v_lshlrev_b32 v219, 4, v219
    v_and_b32 v223, 31, v222
    v_bfe_u32 v251, v222, 1, 3
    v_lshlrev_b32 v251, 4, v251
    v_lshlrev_b32 v252, 2, v219
    v_xor_b32 v251, v251, v252
    v_lshl_add_u32 v251, v223, 7, v251
    v_add_u32 v251, s94, v251
    v_xor_b32 v252, 16, v251
    v_xor_b32 v253, 32, v251
    v_xor_b32 v254, 48, v251
    v_and_b32 v222, 15, v250
    v_cmp_gt_u32 vcc, 243, v220
    v_mul_u32_u24 v220, 3200, v220
    v_add3_u32 v220, v220, v222, s7
    v_add_u32 v221, 16, v222
    v_add_u32 v223, 32, v222
    v_cmp_gt_u32_e64 s[32:33], s92, v221
    v_cmp_gt_u32_e64 s[34:35], s92, v222
    s_nop 0
    v_cndmask_b32_e64 v221, 2.0, v221, s[32:33]
    v_cndmask_b32_e64 v223, 2.0, v223, s[32:33]
    v_cndmask_b32_e64 v222, 2.0, v222, s[34:35]
    s_cmp_eq_u32 s5, 0
    s_waitcnt vmcnt(3)
    s_cbranch_scc0 K2_MK
    s_branch K2_NOREC
K2_MK:
    v_cndmask_b32 v179, 0, v179, vcc
    v_cndmask_b32 v180, 0, v180, vcc
    v_and_b32 v98, 0xffff, v172
    v_lshrrev_b32 v172, 16, v172
    v_subrev_u32 v172, s7, v172
    v_cmp_gt_i32_e64 s[32:33], v172, v222
    v_add_lshl_u32 v98, v98, v220, 3
    s_mov_b32 s95, 0
    v_cndmask_b32_e64 v98, 2.0, v98, s[32:33]
    buffer_load_dwordx2 v[44:45], v98, s[20:23], s95 offen
    v_and_b32 v99, 0xffff, v173
    v_lshrrev_b32 v173, 16, v173
    v_subrev_u32 v173, s7, v173
    v_cmp_gt_i32_e64 s[34:35], v173, v222
    v_add_lshl_u32 v99, v99, v220, 3
    s_mov_b32 s95, 25600
    v_cndmask_b32_e64 v99, 2.0, v99, s[34:35]
    buffer_load_dwordx2 v[46:47], v99, s[20:23], s95 offen
    v_and_b32 v100, 0xffff, v174
    v_lshrrev_b32 v174, 16, v174
    v_subrev_u32 v174, s7, v174
    v_cmp_gt_i32_e64 s[36:37], v174, v222
    v_add_lshl_u32 v100, v100, v220, 3
    s_mov_b32 s95, 51200
    v_cndmask_b32_e64 v100, 2.0, v100, s[36:37]
    buffer_load_dwordx2 v[48:49], v100, s[20:23], s95 offen
    v_and_b32 v101, 0xffff, v175
    v_lshrrev_b32 v175, 16, v175
    v_subrev_u32 v175, s7, v175
    v_cmp_gt_i32_e64 s[38:39], v175, v222
    v_add_lshl_u32 v101, v101, v220, 3
    s_mov_b32 s95, 76800
    v_cndmask_b32_e64 v101, 2.0, v101, s[38:39]
    buffer_load_dwordx2 v[50:51], v101, s[20:23], s95 offen
    v_and_b32 v102, 0xffff, v176
    v_lshrrev_b32 v176, 16, v176
    v_subrev_u32 v176, s7, v176
    v_cmp_gt_i32_e64 s[40:41], v176, v222
    v_add_lshl_u32 v102, v102, v220, 3
    s_mov_b32 s95, 102400
    v_cndmask_b32_e64 v102, 2.0, v102, s[40:41]
    buffer_load_dwordx2 v[52:53], v102, s[20:23], s95 offen
    v_and_b32 v103, 0xffff, v177
    v_lshrrev_b32 v177, 16, v177
    v_subrev_u32 v177, s7, v177
    v_cmp_gt_i32_e64 s[42:43], v177, v222
    v_add_lshl_u32 v103, v103, v220, 3
    s_mov_b32 s95, 128000
    v_cndmask_b32_e64 v103, 2.0, v103, s[42:43]
    buffer_load_dwordx2 v[54:55], v103, s[20:23], s95 offen
    v_and_b32 v104, 0xffff, v178
    v_lshrrev_b32 v178, 16, v178
    v_subrev_u32 v178, s7, v178
    v_cmp_gt_i32_e64 s[44:45], v178, v222
    v_add_lshl_u32 v104, v104, v220, 3
    s_mov_b32 s95, 153600
    v_cndmask_b32_e64 v104, 2.0, v104, s[44:45]
    buffer_load_dwordx2 v[56:57], v104, s[20:23], s95 offen
    v_and_b32 v105, 0xffff, v179
    v_lshrrev_b32 v179, 16, v179
    v_subrev_u32 v179, s7, v179
    v_cmp_gt_i32_e64 s[46:47], v179, v222
    v_add_lshl_u32 v105, v105, v220, 3
    s_mov_b32 s95, 179200
    v_cndmask_b32_e64 v105, 2.0, v105, s[46:47]
    buffer_load_dwordx2 v[58:59], v105, s[20:23], s95 offen
    v_and_b32 v106, 0xffff, v180
    v_lshrrev_b32 v180, 16, v180
    v_subrev_u32 v180, s7, v180
    v_cmp_gt_i32_e64 s[48:49], v180, v222
    v_add_lshl_u32 v106, v106, v220, 3
    s_mov_b32 s95, 204800
    v_cndmask_b32_e64 v106, 2.0, v106, s[48:49]
    buffer_load_dwordx2 v[60:61], v106, s[20:23], s95 offen
    v_cmp_gt_i32_e64 s[50:51], v172, v221
    v_cmp_gt_i32_e64 s[68:69], v172, v223
    v_cmp_gt_i32_e64 s[52:53], v173, v221
    v_cmp_gt_i32_e64 s[70:71], v173, v223
    v_cmp_gt_i32_e64 s[54:55], v174, v221
    v_cmp_gt_i32_e64 s[72:73], v174, v223
    v_cmp_gt_i32_e64 s[56:57], v175, v221
    v_cmp_gt_i32_e64 s[74:75], v175, v223
    v_cmp_gt_i32_e64 s[58:59], v176, v221
    v_cmp_gt_i32_e64 s[76:77], v176, v223
    v_cmp_gt_i32_e64 s[60:61], v177, v221
    v_cmp_gt_i32_e64 s[78:79], v177, v223
    v_cmp_gt_i32_e64 s[62:63], v178, v221
    v_cmp_gt_i32_e64 s[80:81], v178, v223
    v_cmp_gt_i32_e64 s[64:65], v179, v221
    v_cmp_gt_i32_e64 s[82:83], v179, v223
    v_cmp_gt_i32_e64 s[66:67], v180, v221
    v_cmp_gt_i32_e64 s[84:85], v180, v223
    s_mov_b32 s95, 0
    s_mov_b64 exec, s[50:51]
    s_cbranch_execz K2_G1
    buffer_load_dwordx2 v[62:63], v98, s[20:23], s95 offen offset:128
K2_G1:
    s_mov_b32 s95, 25600
    s_mov_b64 exec, s[52:53]
    s_cbranch_execz K2_G2
    buffer_load_dwordx2 v[64:65], v99, s[20:23], s95 offen offset:128
K2_G2:
    s_mov_b32 s95, 51200
    s_mov_b64 exec, s[54:55]
    s_cbranch_execz K2_G3
    buffer_load_dwordx2 v[66:67], v100, s[20:23], s95 offen offset:128
K2_G3:
    s_mov_b32 s95, 76800
    s_mov_b64 exec, s[56:57]
    s_cbranch_execz K2_G4
    buffer_load_dwordx2 v[68:69], v101, s[20:23], s95 offen offset:128
K2_G4:
    s_mov_b32 s95, 102400
    s_mov_b64 exec, s[58:59]
    s_cbranch_execz K2_G5
    buffer_load_dwordx2 v[70:71], v102, s[20:23], s95 offen offset:128
K2_G5:
    s_mov_b32 s95, 128000
    s_mov_b64 exec, s[60:61]
    s_cbranch_execz K2_G6
    buffer_load_dwordx2 v[72:73], v103, s[20:23], s95 offen offset:128
K2_G6:
    s_mov_b32 s95, 153600
    s_mov_b64 exec, s[62:63]
    s_cbranch_execz K2_G7
    buffer_load_dwordx2 v[74:75], v104, s[20:23], s95 offen offset:128
K2_G7:
    s_mov_b32 s95, 179200
    s_mov_b64 exec, s[64:65]
    s_cbranch_execz K2_G8
    buffer_load_dwordx2 v[76:77], v105, s[20:23], s95 offen offset:128
K2_G8:
    s_mov_b32 s95, 204800
    s_mov_b64 exec, s[66:67]
    s_cbranch_execz K2_G9
    buffer_load_dwordx2 v[78:79], v106, s[20:23], s95 offen offset:128
K2_G9:
    s_or_b64 vcc, s[68:69], s[70:71]
    s_or_b64 vcc, vcc, s[72:73]
    s_or_b64 vcc, vcc, s[74:75]
    s_or_b64 vcc, vcc, s[76:77]
    s_or_b64 vcc, vcc, s[78:79]
    s_or_b64 vcc, vcc, s[80:81]
    s_or_b64 vcc, vcc, s[82:83]
    s_or_b64 vcc, vcc, s[84:85]
    s_cselect_b32 s97, 1, 0
    s_cbranch_scc0 K2_NP2A
    s_mov_b32 s95, 0
    s_mov_b64 exec, s[68:69]
    s_cbranch_execz K2_G10
    buffer_load_dwordx2 v[80:81], v98, s[20:23], s95 offen offset:256
K2_G10:
    s_mov_b32 s95, 25600
    s_mov_b64 exec, s[70:71]
    s_cbranch_execz K2_G11
    buffer_load_dwordx2 v[82:83], v99, s[20:23], s95 offen offset:256
K2_G11:
    s_mov_b32 s95, 51200
    s_mov_b64 exec, s[72:73]
    s_cbranch_execz K2_G12
    buffer_load_dwordx2 v[84:85], v100, s[20:23], s95 offen offset:256
K2_G12:
    s_mov_b32 s95, 76800
    s_mov_b64 exec, s[74:75]
    s_cbranch_execz K2_G13
    buffer_load_dwordx2 v[86:87], v101, s[20:23], s95 offen offset:256
K2_G13:
    s_mov_b32 s95, 102400
    s_mov_b64 exec, s[76:77]
    s_cbranch_execz K2_G14
    buffer_load_dwordx2 v[88:89], v102, s[20:23], s95 offen offset:256
K2_G14:
    s_mov_b32 s95, 128000
    s_mov_b64 exec, s[78:79]
    s_cbranch_execz K2_G15
    buffer_load_dwordx2 v[90:91], v103, s[20:23], s95 offen offset:256
K2_G15:
    s_mov_b32 s95, 153600
    s_mov_b64 exec, s[80:81]
    s_cbranch_execz K2_G16
    buffer_load_dwordx2 v[92:93], v104, s[20:23], s95 offen offset:256
K2_G16:
    s_mov_b32 s95, 179200
    s_mov_b64 exec, s[82:83]
    s_cbranch_execz K2_G17
    buffer_load_dwordx2 v[94:95], v105, s[20:23], s95 offen offset:256
K2_G17:
    s_mov_b32 s95, 204800
    s_mov_b64 exec, s[84:85]
    s_cbranch_execz K2_G18
    buffer_load_dwordx2 v[96:97], v106, s[20:23], s95 offen offset:256
K2_G18:
K2_NP2A:
    s_mov_b64 exec, -1
    v_max3_i32 v221, v172, v173, v174
    v_max3_i32 v221, v221, v175, v176
    v_max3_i32 v221, v221, v177, v178
    v_max3_i32 v221, v221, v179, v180
    v_mov_b32 v223, 1
    v_cmp_lt_i32_e64 s[86:87], s92, v221
K2_NOREC:
    s_waitcnt lgkmcnt(0)
    s_barrier
    s_add_u32 s95, s101, 0
    s_cmp_lt_u32 s95, 125952
    s_cselect_b32 m0, s95, 43008
    s_nop 0
    buffer_load_dwordx4 v[210:211], s[8:11], 0 idxen offen lds
    s_add_u32 s95, s101, 1024
    s_cmp_lt_u32 s95, 125952
    s_cselect_b32 m0, s95, 43008
    s_nop 0
    buffer_load_dwordx4 v[212:213], s[8:11], 0 idxen offen lds
    s_add_u32 s95, s101, 2048
    s_cmp_lt_u32 s95, 125952
    s_cselect_b32 m0, s95, 43008
    s_nop 0
    buffer_load_dwordx4 v[214:215], s[8:11], 0 idxen offen lds
    s_add_u32 s95, s101, 3072
    s_cmp_lt_u32 s95, 125952
    s_cselect_b32 m0, s95, 43008
    s_nop 0
    buffer_load_dwordx4 v[216:217], s[8:11], 0 idxen offen lds
    s_cmp_lg_u32 s5, 0
    s_cbranch_scc1 K2_NOPW
    s_lshr_b32 s95, s2, 3
    s_mul_i32 s99, s95, 0
    v_add_u32 v224, s99, v203
    s_mul_i32 s99, s95, 0
    v_add_u32 v225, s99, v250
    v_add_u32 v224, 0, v250
    v_cmp_gt_u32 vcc, s96, v224
    s_nop 1
    v_cndmask_b32_e64 v104, -0.5, 0.5, vcc
    v_add_u32 v224, 64, v250
    v_cmp_gt_u32 vcc, s96, v224
    s_nop 1
    v_cndmask_b32_e64 v105, -0.5, 0.5, vcc
    v_add_u32 v224, 128, v250
    v_cmp_gt_u32 vcc, s96, v224
    s_nop 1
    v_cndmask_b32_e64 v106, -0.5, 0.5, vcc
    v_add_u32 v224, 192, v250
    v_cmp_gt_u32 vcc, s96, v224
    s_nop 1
    v_cndmask_b32_e64 v107, -0.5, 0.5, vcc
    s_branch K2_B1
K2_NOPW:
    s_mov_b64 exec, s[86:87]
    ds_write_b32 v228, v223 offset:96
    s_mov_b64 exec, -1
    s_waitcnt vmcnt(4)
    s_mov_b64 exec, s[32:33]
    v_lshrrev_b32 v172, 16, v45
    ds_add_rtn_u32 v172, v172, v223 offset:34816
    s_mov_b64 exec, s[34:35]
    v_lshrrev_b32 v173, 16, v47
    ds_add_rtn_u32 v173, v173, v223 offset:34816
    s_mov_b64 exec, s[36:37]
    v_lshrrev_b32 v174, 16, v49
    ds_add_rtn_u32 v174, v174, v223 offset:34816
    s_mov_b64 exec, s[38:39]
    v_lshrrev_b32 v175, 16, v51
    ds_add_rtn_u32 v175, v175, v223 offset:34816
    s_mov_b64 exec, s[40:41]
    v_lshrrev_b32 v176, 16, v53
    ds_add_rtn_u32 v176, v176, v223 offset:34816
    s_mov_b64 exec, s[42:43]
    v_lshrrev_b32 v177, 16, v55
    ds_add_rtn_u32 v177, v177, v223 offset:34816
    s_mov_b64 exec, s[44:45]
    v_lshrrev_b32 v178, 16, v57
    ds_add_rtn_u32 v178, v178, v223 offset:34816
    s_mov_b64 exec, s[46:47]
    v_lshrrev_b32 v179, 16, v59
    ds_add_rtn_u32 v179, v179, v223 offset:34816
    s_mov_b64 exec, s[48:49]
    v_lshrrev_b32 v180, 16, v61
    ds_add_rtn_u32 v180, v180, v223 offset:34816
    s_mov_b64 exec, s[50:51]
    s_cbranch_execz K2_G19
    v_lshrrev_b32 v181, 16, v63
    ds_add_rtn_u32 v181, v181, v223 offset:34816
K2_G19:
    s_mov_b64 exec, s[52:53]
    s_cbranch_execz K2_G20
    v_lshrrev_b32 v182, 16, v65
    ds_add_rtn_u32 v182, v182, v223 offset:34816
K2_G20:
    s_mov_b64 exec, s[54:55]
    s_cbranch_execz K2_G21
    v_lshrrev_b32 v183, 16, v67
    ds_add_rtn_u32 v183, v183, v223 offset:34816
K2_G21:
    s_mov_b64 exec, s[56:57]
    s_cbranch_execz K2_G22
    v_lshrrev_b32 v184, 16, v69
    ds_add_rtn_u32 v184, v184, v223 offset:34816
K2_G22:
    s_mov_b64 exec, s[58:59]
    s_cbranch_execz K2_G23
    v_lshrrev_b32 v185, 16, v71
    ds_add_rtn_u32 v185, v185, v223 offset:34816
K2_G23:
    s_mov_b64 exec, s[60:61]
    s_cbranch_execz K2_G24
    v_lshrrev_b32 v186, 16, v73
    ds_add_rtn_u32 v186, v186, v223 offset:34816
K2_G24:
    s_mov_b64 exec, s[62:63]
    s_cbranch_execz K2_G25
    v_lshrrev_b32 v187, 16, v75
    ds_add_rtn_u32 v187, v187, v223 offset:34816
K2_G25:
    s_mov_b64 exec, s[64:65]
    s_cbranch_execz K2_G26
    v_lshrrev_b32 v188, 16, v77
    ds_add_rtn_u32 v188, v188, v223 offset:34816
K2_G26:
    s_mov_b64 exec, s[66:67]
    s_cbranch_execz K2_G27
    v_lshrrev_b32 v189, 16, v79
    ds_add_rtn_u32 v189, v189, v223 offset:34816
K2_G27:
    s_cmp_eq_u32 s97, 0
    s_cbranch_scc1 K2_NP2B
    s_mov_b64 exec, s[68:69]
    s_cbranch_execz K2_G28
    v_lshrrev_b32 v190, 16, v81
    ds_add_rtn_u32 v190, v190, v223 offset:34816
K2_G28:
    s_mov_b64 exec, s[70:71]
    s_cbranch_execz K2_G29
    v_lshrrev_b32 v191, 16, v83
    ds_add_rtn_u32 v191, v191, v223 offset:34816
K2_G29:
    s_mov_b64 exec, s[72:73]
    s_cbranch_execz K2_G30
    v_lshrrev_b32 v192, 16, v85
    ds_add_rtn_u32 v192, v192, v223 offset:34816
K2_G30:
    s_mov_b64 exec, s[74:75]
    s_cbranch_execz K2_G31
    v_lshrrev_b32 v193, 16, v87
    ds_add_rtn_u32 v193, v193, v223 offset:34816
K2_G31:
    s_mov_b64 exec, s[76:77]
    s_cbranch_execz K2_G32
    v_lshrrev_b32 v194, 16, v89
    ds_add_rtn_u32 v194, v194, v223 offset:34816
K2_G32:
    s_mov_b64 exec, s[78:79]
    s_cbranch_execz K2_G33
    v_lshrrev_b32 v195, 16, v91
    ds_add_rtn_u32 v195, v195, v223 offset:34816
K2_G33:
    s_mov_b64 exec, s[80:81]
    s_cbranch_execz K2_G34
    v_lshrrev_b32 v196, 16, v93
    ds_add_rtn_u32 v196, v196, v223 offset:34816
K2_G34:
    s_mov_b64 exec, s[82:83]
    s_cbranch_execz K2_G35
    v_lshrrev_b32 v197, 16, v95
    ds_add_rtn_u32 v197, v197, v223 offset:34816
K2_G35:
    s_mov_b64 exec, s[84:85]
    s_cbranch_execz K2_G36
    v_lshrrev_b32 v198, 16, v97
    ds_add_rtn_u32 v198, v198, v223 offset:34816
K2_G36:
K2_NP2B:
    s_mov_b64 exec, -1
K2_B1:
    s_cmp_lg_u32 s5, 0
    s_waitcnt lgkmcnt(0)
    s_barrier
    s_cbranch_scc1 K2_W2
    ds_read_b128 v[44:47], v203 offset:34816
    ds_read_b128 v[48:51], v203 offset:35840
    ds_read_b128 v[52:55], v203 offset:36864
    ds_read_b128 v[56:59], v203 offset:37888
    s_waitcnt lgkmcnt(3)
    v_add_u32 v76, v44, v45
    v_add3_u32 v76, v76, v46, v47
    s_waitcnt lgkmcnt(2)
    v_add_u32 v77, v48, v49
    v_add3_u32 v77, v77, v50, v51
    s_waitcnt lgkmcnt(1)
    v_add_u32 v78, v52, v53
    v_add3_u32 v78, v78, v54, v55
    s_waitcnt lgkmcnt(0)
    v_add_u32 v79, v56, v57
    v_add3_u32 v79, v79, v58, v59
    v_add_u32 v82, v76, v77
    v_add_u32 v83, v82, v78
    v_add_u32 v220, v83, v79
    v_mov_b32 v221, v220
    s_nop 1
    v_add_u32_dpp v221, v221, v221 row_shr:1 row_mask:0xf bank_mask:0xf
    s_nop 1
    v_add_u32_dpp v221, v221, v221 row_shr:2 row_mask:0xf bank_mask:0xf
    s_nop 1
    v_add_u32_dpp v221, v221, v221 row_shr:4 row_mask:0xf bank_mask:0xf
    s_nop 1
    v_add_u32_dpp v221, v221, v221 row_shr:8 row_mask:0xf bank_mask:0xf
    s_nop 1
    v_add_u32_dpp v221, v221, v221 row_bcast:15 row_mask:0xa bank_mask:0xf
    s_nop 1
    v_add_u32_dpp v221, v221, v221 row_bcast:31 row_mask:0xc bank_mask:0xf
    v_sub_u32 v80, v221, v220
    v_add_u32 v81, v80, v76
    v_add_u32 v82, v80, v82
    v_add_u32 v83, v80, v83
    s_movk_i32 s95, 2560
    v_lshl_add_u32 v60, v80, 3, s95
    v_lshl_add_u32 v61, v44, 3, v60
    v_lshl_add_u32 v62, v45, 3, v61
    v_lshl_add_u32 v63, v46, 3, v62
    ds_write_b128 v203, v[60:63] offset:34816
    v_lshl_add_u32 v64, v81, 3, s95
    v_lshl_add_u32 v65, v48, 3, v64
    v_lshl_add_u32 v66, v49, 3, v65
    v_lshl_add_u32 v67, v50, 3, v66
    ds_write_b128 v203, v[64:67] offset:35840
    v_lshl_add_u32 v68, v82, 3, s95
    v_lshl_add_u32 v69, v52, 3, v68
    v_lshl_add_u32 v70, v53, 3, v69
    v_lshl_add_u32 v71, v54, 3, v70
    ds_write_b128 v203, v[68:71] offset:36864
    v_lshl_add_u32 v72, v83, 3, s95
    v_lshl_add_u32 v73, v56, 3, v72
    v_lshl_add_u32 v74, v57, 3, v73
    v_lshl_add_u32 v75, v58, 3, v74
    ds_write_b128 v203, v[72:75] offset:37888
    s_mov_b32 exec_lo, 0
    s_brev_b32 exec_hi, 1
    ds_write_b32 v228, v221 offset:100
    s_mov_b64 exec, -1
K2_W2:
    s_cmp_ge_u32 s5, 6
    s_cbranch_scc1 K2_NWH
    s_mul_i32 s95, s5, 2048
    s_add_u32 m0, s95, 125952
    s_add_u32 s95, s95, 7561216
    buffer_load_dwordx4 v203, s[20:23], s95 offen offset:0 lds
    buffer_load_dwordx4 v203, s[20:23], s95 offen offset:1024 lds
K2_NWH:
    s_cmp_eq_u32 s5, 0
    s_cbranch_scc1 K2_NFT
    s_mov_b32 s95, 0xc0000
    s_mov_b64 exec, s[32:33]
    v_and_or_b32 v140, v45, s95, v172
    v_lshrrev_b32 v141, 17, v45
    v_cmpx_gt_u32 vcc, 1, v140
    ds_write_b64 v141, v[44:45] offset:38912
    s_mov_b64 exec, s[34:35]
    v_and_or_b32 v142, v47, s95, v173
    v_lshrrev_b32 v143, 17, v47
    v_cmpx_gt_u32 vcc, 1, v142
    ds_write_b64 v143, v[46:47] offset:38912
    s_mov_b64 exec, s[36:37]
    v_and_or_b32 v144, v49, s95, v174
    v_lshrrev_b32 v145, 17, v49
    v_cmpx_gt_u32 vcc, 1, v144
    ds_write_b64 v145, v[48:49] offset:38912
    s_mov_b64 exec, s[38:39]
    v_and_or_b32 v146, v51, s95, v175
    v_lshrrev_b32 v147, 17, v51
    v_cmpx_gt_u32 vcc, 1, v146
    ds_write_b64 v147, v[50:51] offset:38912
    s_mov_b64 exec, s[40:41]
    v_and_or_b32 v148, v53, s95, v176
    v_lshrrev_b32 v149, 17, v53
    v_cmpx_gt_u32 vcc, 1, v148
    ds_write_b64 v149, v[52:53] offset:38912
    s_mov_b64 exec, s[42:43]
    v_and_or_b32 v150, v55, s95, v177
    v_lshrrev_b32 v151, 17, v55
    v_cmpx_gt_u32 vcc, 1, v150
    ds_write_b64 v151, v[54:55] offset:38912
    s_mov_b64 exec, s[44:45]
    v_and_or_b32 v152, v57, s95, v178
    v_lshrrev_b32 v153, 17, v57
    v_cmpx_gt_u32 vcc, 1, v152
    ds_write_b64 v153, v[56:57] offset:38912
    s_mov_b64 exec, s[46:47]
    v_and_or_b32 v154, v59, s95, v179
    v_lshrrev_b32 v155, 17, v59
    v_cmpx_gt_u32 vcc, 1, v154
    ds_write_b64 v155, v[58:59] offset:38912
    s_mov_b64 exec, s[48:49]
    v_and_or_b32 v156, v61, s95, v180
    v_lshrrev_b32 v157, 17, v61
    v_cmpx_gt_u32 vcc, 1, v156
    ds_write_b64 v157, v[60:61] offset:38912
    s_mov_b64 exec, -1
    s_mul_i32 s95, s5, 224
    v_lshrrev_b32 v140, 1, v203
    v_add_u32 v140, s95, v140
K2_NFT:
    s_cmp_eq_u32 s5, 0
    s_waitcnt lgkmcnt(0)
    s_barrier
    ds_read_b64 v[232:233], v228 offset:96
    s_cbranch_scc1 K2_NOS1
    ds_read_b64 v[140:141], v140 offset:38688
    s_mov_b64 exec, s[32:33]
    v_lshrrev_b32 v98, 16, v45
    ds_read_b32 v98, v98 offset:34816
    s_mov_b64 exec, s[34:35]
    v_lshrrev_b32 v99, 16, v47
    ds_read_b32 v99, v99 offset:34816
    s_mov_b64 exec, s[36:37]
    v_lshrrev_b32 v100, 16, v49
    ds_read_b32 v100, v100 offset:34816
    s_mov_b64 exec, s[38:39]
    v_lshrrev_b32 v101, 16, v51
    ds_read_b32 v101, v101 offset:34816
    s_mov_b64 exec, s[40:41]
    v_lshrrev_b32 v102, 16, v53
    ds_read_b32 v102, v102 offset:34816
    s_mov_b64 exec, s[42:43]
    v_lshrrev_b32 v103, 16, v55
    ds_read_b32 v103, v103 offset:34816
    s_mov_b64 exec, s[44:45]
    v_lshrrev_b32 v104, 16, v57
    ds_read_b32 v104, v104 offset:34816
    s_mov_b64 exec, s[46:47]
    v_lshrrev_b32 v105, 16, v59
    ds_read_b32 v105, v105 offset:34816
    s_mov_b64 exec, s[48:49]
    v_lshrrev_b32 v106, 16, v61
    ds_read_b32 v106, v106 offset:34816
    s_mov_b64 exec, -1
    s_waitcnt lgkmcnt(9)
    v_and_b32 v141, 0xffff, v141
    s_mov_b64 exec, 0xfffffff
    buffer_load_dword v202, v140, s[12:15], 0 idxen
    buffer_load_dword v202, v141, s[8:11], 0 idxen
    buffer_load_dword v202, v141, s[16:19], 0 idxen
    s_mov_b64 exec, s[50:51]
    s_cbranch_execz K2_G37
    v_lshrrev_b32 v220, 16, v63
    ds_read_b32 v220, v220 offset:34816
K2_G37:
    s_mov_b64 exec, s[52:53]
    s_cbranch_execz K2_G38
    v_lshrrev_b32 v221, 16, v65
    ds_read_b32 v221, v221 offset:34816
K2_G38:
    s_mov_b64 exec, s[54:55]
    s_cbranch_execz K2_G39
    v_lshrrev_b32 v222, 16, v67
    ds_read_b32 v222, v222 offset:34816
K2_G39:
    s_mov_b64 exec, s[56:57]
    s_cbranch_execz K2_G40
    v_lshrrev_b32 v223, 16, v69
    ds_read_b32 v223, v223 offset:34816
K2_G40:
    s_mov_b64 exec, s[58:59]
    s_cbranch_execz K2_G41
    v_lshrrev_b32 v224, 16, v71
    ds_read_b32 v224, v224 offset:34816
K2_G41:
    s_mov_b64 exec, s[60:61]
    s_cbranch_execz K2_G42
    v_lshrrev_b32 v225, 16, v73
    ds_read_b32 v225, v225 offset:34816
K2_G42:
    s_mov_b64 exec, s[62:63]
    s_cbranch_execz K2_G43
    v_lshrrev_b32 v226, 16, v75
    ds_read_b32 v226, v226 offset:34816
K2_G43:
    s_mov_b64 exec, s[64:65]
    s_cbranch_execz K2_G44
    v_lshrrev_b32 v227, 16, v77
    ds_read_b32 v227, v227 offset:34816
K2_G44:
    s_mov_b64 exec, s[66:67]
    s_cbranch_execz K2_G45
    v_lshrrev_b32 v228, 16, v79
    ds_read_b32 v228, v228 offset:34816
K2_G45:
    s_mov_b64 exec, -1
K2_NOS1:
    s_waitcnt lgkmcnt(0)
    v_readfirstlane_b32 s98, v233
    v_readfirstlane_b32 s93, v232
    s_cmp_le_u32 s98, 3776
    s_cbranch_scc1 K2_FITS
    s_cmp_eq_u32 s92, 15
    s_cbranch_scc1 K2_END0
    s_mov_b32 s92, 15
    s_waitcnt vmcnt(0)
    s_barrier
    s_branch K2_TOP
K2_FITS:
    s_cmp_eq_u32 s5, 0
    s_cbranch_scc1 K2_PLAN
    s_mov_b64 exec, s[32:33]
    v_lshl_add_u32 v98, v172, 3, v98
    ds_write_b64 v98, v[44:45]
    s_mov_b64 exec, s[34:35]
    v_lshl_add_u32 v99, v173, 3, v99
    ds_write_b64 v99, v[46:47]
    s_mov_b64 exec, s[36:37]
    v_lshl_add_u32 v100, v174, 3, v100
    ds_write_b64 v100, v[48:49]
    s_mov_b64 exec, s[38:39]
    v_lshl_add_u32 v101, v175, 3, v101
    ds_write_b64 v101, v[50:51]
    s_mov_b64 exec, s[40:41]
    v_lshl_add_u32 v102, v176, 3, v102
    ds_write_b64 v102, v[52:53]
    s_mov_b64 exec, s[42:43]
    v_lshl_add_u32 v103, v177, 3, v103
    ds_write_b64 v103, v[54:55]
    s_mov_b64 exec, s[44:45]
    v_lshl_add_u32 v104, v178, 3, v104
    ds_write_b64 v104, v[56:57]
    s_mov_b64 exec, s[46:47]
    v_lshl_add_u32 v105, v179, 3, v105
    ds_write_b64 v105, v[58:59]
    s_mov_b64 exec, s[48:49]
    v_lshl_add_u32 v106, v180, 3, v106
    ds_write_b64 v106, v[60:61]
    s_mov_b64 exec, s[50:51]
    s_cbranch_execz K2_G46
    v_lshl_add_u32 v220, v181, 3, v220
    ds_write_b64 v220, v[62:63]
K2_G46:
    s_mov_b64 exec, s[52:53]
    s_cbranch_execz K2_G47
    v_lshl_add_u32 v221, v182, 3, v221
    ds_write_b64 v221, v[64:65]
K2_G47:
    s_mov_b64 exec, s[54:55]
    s_cbranch_execz K2_G48
    v_lshl_add_u32 v222, v183, 3, v222
    ds_write_b64 v222, v[66:67]
K2_G48:
    s_mov_b64 exec, s[56:57]
    s_cbranch_execz K2_G49
    v_lshl_add_u32 v223, v184, 3, v223
    ds_write_b64 v223, v[68:69]
K2_G49:
    s_mov_b64 exec, s[58:59]
    s_cbranch_execz K2_G50
    v_lshl_add_u32 v224, v185, 3, v224
    ds_write_b64 v224, v[70:71]
K2_G50:
    s_mov_b64 exec, s[60:61]
    s_cbranch_execz K2_G51
    v_lshl_add_u32 v225, v186, 3, v225
    ds_write_b64 v225, v[72:73]
K2_G51:
    s_mov_b64 exec, s[62:63]
    s_cbranch_execz K2_G52
    v_lshl_add_u32 v226, v187, 3, v226
    ds_write_b64 v226, v[74:75]
K2_G52:
    s_mov_b64 exec, s[64:65]
    s_cbranch_execz K2_G53
    v_lshl_add_u32 v227, v188, 3, v227
    ds_write_b64 v227, v[76:77]
K2_G53:
    s_mov_b64 exec, s[66:67]
    s_cbranch_execz K2_G54
    v_lshl_add_u32 v228, v189, 3, v228
    ds_write_b64 v228, v[78:79]
K2_G54:
    s_cmp_eq_u32 s97, 0
    s_cbranch_scc1 K2_B3
    s_mov_b64 exec, s[68:69]
    s_cbranch_execz K2_G55
    v_lshrrev_b32 v98, 16, v81
    ds_read_b32 v98, v98 offset:34816
K2_G55:
    s_mov_b64 exec, s[70:71]
    s_cbranch_execz K2_G56
    v_lshrrev_b32 v99, 16, v83
    ds_read_b32 v99, v99 offset:34816
K2_G56:
    s_mov_b64 exec, s[72:73]
    s_cbranch_execz K2_G57
    v_lshrrev_b32 v100, 16, v85
    ds_read_b32 v100, v100 offset:34816
K2_G57:
    s_mov_b64 exec, s[74:75]
    s_cbranch_execz K2_G58
    v_lshrrev_b32 v101, 16, v87
    ds_read_b32 v101, v101 offset:34816
K2_G58:
    s_mov_b64 exec, s[76:77]
    s_cbranch_execz K2_G59
    v_lshrrev_b32 v102, 16, v89
    ds_read_b32 v102, v102 offset:34816
K2_G59:
    s_mov_b64 exec, s[78:79]
    s_cbranch_execz K2_G60
    v_lshrrev_b32 v103, 16, v91
    ds_read_b32 v103, v103 offset:34816
K2_G60:
    s_mov_b64 exec, s[80:81]
    s_cbranch_execz K2_G61
    v_lshrrev_b32 v104, 16, v93
    ds_read_b32 v104, v104 offset:34816
K2_G61:
    s_mov_b64 exec, s[82:83]
    s_cbranch_execz K2_G62
    v_lshrrev_b32 v105, 16, v95
    ds_read_b32 v105, v105 offset:34816
K2_G62:
    s_mov_b64 exec, s[84:85]
    s_cbranch_execz K2_G63
    v_lshrrev_b32 v106, 16, v97
    ds_read_b32 v106, v106 offset:34816
K2_G63:
    s_waitcnt lgkmcnt(0)
    s_mov_b64 exec, s[68:69]
    s_cbranch_execz K2_G64
    v_lshl_add_u32 v98, v190, 3, v98
    ds_write_b64 v98, v[80:81]
K2_G64:
    s_mov_b64 exec, s[70:71]
    s_cbranch_execz K2_G65
    v_lshl_add_u32 v99, v191, 3, v99
    ds_write_b64 v99, v[82:83]
K2_G65:
    s_mov_b64 exec, s[72:73]
    s_cbranch_execz K2_G66
    v_lshl_add_u32 v100, v192, 3, v100
    ds_write_b64 v100, v[84:85]
K2_G66:
    s_mov_b64 exec, s[74:75]
    s_cbranch_execz K2_G67
    v_lshl_add_u32 v101, v193, 3, v101
    ds_write_b64 v101, v[86:87]
K2_G67:
    s_mov_b64 exec, s[76:77]
    s_cbranch_execz K2_G68
    v_lshl_add_u32 v102, v194, 3, v102
    ds_write_b64 v102, v[88:89]
K2_G68:
    s_mov_b64 exec, s[78:79]
    s_cbranch_execz K2_G69
    v_lshl_add_u32 v103, v195, 3, v103
    ds_write_b64 v103, v[90:91]
K2_G69:
    s_mov_b64 exec, s[80:81]
    s_cbranch_execz K2_G70
    v_lshl_add_u32 v104, v196, 3, v104
    ds_write_b64 v104, v[92:93]
K2_G70:
    s_mov_b64 exec, s[82:83]
    s_cbranch_execz K2_G71
    v_lshl_add_u32 v105, v197, 3, v105
    ds_write_b64 v105, v[94:95]
K2_G71:
    s_mov_b64 exec, s[84:85]
    s_cbranch_execz K2_G72
    v_lshl_add_u32 v106, v198, 3, v106
    ds_write_b64 v106, v[96:97]
K2_G72:
    s_branch K2_B3
K2_PLAN:
    s_mul_i32 s99, s98, 3
    s_lshr_b32 s99, s99, 9
    s_max_u32 s99, s99, 1
    v_cvt_f32_u32 v84, v76
    v_add_f32 v84, -0.5, v84
    v_max_f32 v104, v104, v84
    v_cvt_f32_u32 v85, v77
    v_add_f32 v85, -0.5, v85
    v_max_f32 v105, v105, v85
    v_cvt_f32_u32 v86, v78
    v_add_f32 v86, -0.5, v86
    v_max_f32 v106, v106, v86
    v_cvt_f32_u32 v87, v79
    v_add_f32 v87, -0.5, v87
    v_max_f32 v107, v107, v87
K2_DLOOP:
    v_cvt_f32_u32 v220, s99
    v_rcp_f32 v221, v220
    v_add_f32 v88, v104, v220
    v_add_f32 v89, v105, v220
    v_add_f32 v90, v106, v220
    v_add_f32 v91, v107, v220
    v_mul_f32 v88, v88, v221
    v_cvt_u32_f32 v88, v88
    v_mul_f32 v89, v89, v221
    v_cvt_u32_f32 v89, v89
    v_mul_f32 v90, v90, v221
    v_cvt_u32_f32 v90, v90
    v_mul_f32 v91, v91, v221
    v_cvt_u32_f32 v91, v91
    v_add_u32 v222, v88, v89
    v_add3_u32 v222, v222, v90, v91
    s_nop 1
    v_add_u32_dpp v222, v222, v222 row_shr:1 row_mask:0xf bank_mask:0xf
    s_nop 1
    v_add_u32_dpp v222, v222, v222 row_shr:2 row_mask:0xf bank_mask:0xf
    s_nop 1
    v_add_u32_dpp v222, v222, v222 row_shr:4 row_mask:0xf bank_mask:0xf
    s_nop 1
    v_add_u32_dpp v222, v222, v222 row_shr:8 row_mask:0xf bank_mask:0xf
    s_nop 1
    v_add_u32_dpp v222, v222, v222 row_bcast:15 row_mask:0xa bank_mask:0xf
    s_nop 1
    v_add_u32_dpp v222, v222, v222 row_bcast:31 row_mask:0xc bank_mask:0xf
    s_nop 0
    v_readlane_b32 s95, v222, 63
    s_add_u32 s99, s99, 1
    s_cmp_gt_u32 s95, 255
    s_cbranch_scc1 K2_DLOOP
    v_cvt_f32_u32 v92, v88
    v_rcp_f32 v96, v92
    v_add_f32 v92, v92, v84
    v_cmp_eq_u32_e64 s[48:49], 1, v88
    v_lshlrev_b32 v44, 16, v88
    v_cvt_f32_u32 v93, v89
    v_rcp_f32 v97, v93
    v_add_f32 v93, v93, v85
    v_cmp_eq_u32_e64 s[50:51], 1, v89
    v_lshlrev_b32 v45, 16, v89
    v_cvt_f32_u32 v94, v90
    v_rcp_f32 v98, v94
    v_add_f32 v94, v94, v86
    v_cmp_eq_u32_e64 s[52:53], 1, v90
    v_lshlrev_b32 v46, 16, v90
    v_cvt_f32_u32 v95, v91
    v_rcp_f32 v99, v95
    v_add_f32 v95, v95, v87
    v_cmp_eq_u32_e64 s[54:55], 1, v91
    v_lshlrev_b32 v47, 16, v91
    v_cndmask_b32_e64 v44, v44, 1, s[48:49]
    v_cndmask_b32_e64 v45, v45, 1, s[50:51]
    v_cndmask_b32_e64 v46, v46, 1, s[52:53]
    v_cndmask_b32_e64 v47, v47, 1, s[54:55]
    v_mul_f32 v92, v92, v96
    v_cvt_u32_f32 v92, v92
    v_sub_u32 v96, 63, v92
    v_lshlrev_b32 v96, 2, v96
    ds_add_rtn_u32 v100, v96, v44 offset:128
    v_mul_f32 v93, v93, v97
    v_cvt_u32_f32 v93, v93
    v_sub_u32 v97, 63, v93
    v_lshlrev_b32 v97, 2, v97
    ds_add_rtn_u32 v101, v97, v45 offset:128
    v_mul_f32 v94, v94, v98
    v_cvt_u32_f32 v94, v94
    v_sub_u32 v98, 63, v94
    v_lshlrev_b32 v98, 2, v98
    ds_add_rtn_u32 v102, v98, v46 offset:128
    v_mul_f32 v95, v95, v99
    v_cvt_u32_f32 v95, v95
    v_sub_u32 v99, 63, v95
    v_lshlrev_b32 v99, 2, v99
    ds_add_rtn_u32 v103, v99, v47 offset:128
    v_lshrrev_b32 v220, 2, v203
    ds_read_b32 v221, v220 offset:128
    v_add_u32 v222, 0, v250
    v_lshl_or_b32 v172, v222, 24, v60
    v_lshl_or_b32 v172, v92, 18, v172
    v_lshlrev_b32 v173, 3, v88
    v_sub_u32 v222, 1, v92
    v_mad_i32_i24 v76, v222, v88, v76
    v_add_u32 v222, 64, v250
    v_lshl_or_b32 v174, v222, 24, v64
    v_lshl_or_b32 v174, v93, 18, v174
    v_lshlrev_b32 v175, 3, v89
    v_sub_u32 v222, 1, v93
    v_mad_i32_i24 v77, v222, v89, v77
    v_add_u32 v222, 128, v250
    v_lshl_or_b32 v176, v222, 24, v68
    v_lshl_or_b32 v176, v94, 18, v176
    v_lshlrev_b32 v177, 3, v90
    v_sub_u32 v222, 1, v94
    v_mad_i32_i24 v78, v222, v90, v78
    v_add_u32 v222, 192, v250
    v_lshl_or_b32 v178, v222, 24, v72
    v_lshl_or_b32 v178, v95, 18, v178
    v_lshlrev_b32 v179, 3, v91
    v_sub_u32 v222, 1, v95
    v_mad_i32_i24 v79, v222, v91, v79
    v_max3_u32 v224, v88, v89, v90
    v_max_u32 v224, v224, v91
    v_mov_b32 v225, -262136
    s_mov_b32 s99, 0
    s_waitcnt lgkmcnt(0)
    v_mov_b32 v222, v221
    v_and_b32 v57, 0xffff, v221
    v_cmp_ne_u32 vcc, 0, v57
    v_and_b32 v52, 0xffff, v100
    v_lshrrev_b32 v100, 16, v100
    v_add_u32_dpp v222, v222, v222 row_shr:1 row_mask:0xf bank_mask:0xf
    v_min_u32 v48, 1, v52
    v_cndmask_b32_e64 v100, v100, v52, s[48:49]
    v_add_u32_dpp v222, v222, v222 row_shr:2 row_mask:0xf bank_mask:0xf
    v_mad_i32_i24 v48, v48, -10, 20
    v_cndmask_b32_e64 v48, 0, v48, s[48:49]
    v_add_u32_dpp v222, v222, v222 row_shr:4 row_mask:0xf bank_mask:0xf
    v_and_b32 v53, 0xffff, v101
    v_lshrrev_b32 v101, 16, v101
    v_add_u32_dpp v222, v222, v222 row_shr:8 row_mask:0xf bank_mask:0xf
    v_min_u32 v49, 1, v53
    v_cndmask_b32_e64 v101, v101, v53, s[50:51]
    v_add_u32_dpp v222, v222, v222 row_bcast:15 row_mask:0xa bank_mask:0xf
    v_mad_i32_i24 v49, v49, -10, 20
    v_cndmask_b32_e64 v49, 0, v49, s[50:51]
    v_add_u32_dpp v222, v222, v222 row_bcast:31 row_mask:0xc bank_mask:0xf
    v_lshrrev_b32 v58, 16, v222
    v_cndmask_b32 v56, 0, v58, vcc
    v_sub_u32 v222, v222, v221
    v_and_b32 v54, 0xffff, v102
    v_lshrrev_b32 v102, 16, v102
    v_max_u32_dpp v56, v56, v56 row_shr:1 row_mask:0xf bank_mask:0xf
    v_min_u32 v50, 1, v54
    v_cndmask_b32_e64 v102, v102, v54, s[52:53]
    v_max_u32_dpp v56, v56, v56 row_shr:2 row_mask:0xf bank_mask:0xf
    v_mad_i32_i24 v50, v50, -10, 20
    v_cndmask_b32_e64 v50, 0, v50, s[52:53]
    v_max_u32_dpp v56, v56, v56 row_shr:4 row_mask:0xf bank_mask:0xf
    v_and_b32 v55, 0xffff, v103
    v_lshrrev_b32 v103, 16, v103
    v_max_u32_dpp v56, v56, v56 row_shr:8 row_mask:0xf bank_mask:0xf
    v_min_u32 v51, 1, v55
    v_cndmask_b32_e64 v103, v103, v55, s[54:55]
    v_max_u32_dpp v56, v56, v56 row_bcast:15 row_mask:0xa bank_mask:0xf
    v_mad_i32_i24 v51, v51, -10, 20
    v_cndmask_b32_e64 v51, 0, v51, s[54:55]
    v_max_u32_dpp v56, v56, v56 row_bcast:31 row_mask:0xc bank_mask:0xf
    v_and_b32 v57, 0xffff, v222
    v_and_b32 v221, 1, v222
    v_mov_b32_dpp v56, v56 wave_shr:1 row_mask:0xf bank_mask:0xf
    v_cmp_eq_u32 vcc, 1, v221
    v_lshrrev_b32 v222, 16, v222
    v_add3_u32 v222, v222, v57, v221
    v_cndmask_b32 v56, v58, v56, vcc
    v_add_u32 v58, v58, v57
    v_add_u32 v56, v56, v57
    v_lshl_or_b32 v222, v58, 10, v222
    v_lshl_or_b32 v222, v56, 20, v222
    ds_bpermute_b32 v96, v96, v222
    ds_bpermute_b32 v97, v97, v222
    ds_bpermute_b32 v98, v98, v222
    ds_bpermute_b32 v99, v99, v222
    s_waitcnt lgkmcnt(3)
    v_bfe_u32 v96, v96, v48, 10
    v_add_lshl_u32 v96, v96, v100, 2
    v_lshl_or_b32 v222, v88, 16, v96
    v_lshlrev_b32 v96, 1, v96
    ds_write_b32 v220, v222 offset:32768
    s_waitcnt lgkmcnt(3)
    v_bfe_u32 v97, v97, v49, 10
    v_add_lshl_u32 v97, v97, v101, 2
    v_lshl_or_b32 v222, v89, 16, v97
    v_lshlrev_b32 v97, 1, v97
    ds_write_b32 v220, v222 offset:33024
    s_waitcnt lgkmcnt(3)
    v_bfe_u32 v98, v98, v50, 10
    v_add_lshl_u32 v98, v98, v102, 2
    v_lshl_or_b32 v222, v90, 16, v98
    v_lshlrev_b32 v98, 1, v98
    ds_write_b32 v220, v222 offset:33280
    s_waitcnt lgkmcnt(3)
    v_bfe_u32 v99, v99, v51, 10
    v_add_lshl_u32 v99, v99, v103, 2
    v_lshl_or_b32 v222, v91, 16, v99
    v_lshlrev_b32 v99, 1, v99
    ds_write_b32 v220, v222 offset:33536
K2_PLOOP:
    v_cmp_lt_u32_e64 s[32:33], s99, v88
    v_cmp_lt_u32_e64 s[34:35], s99, v89
    v_cmp_lt_u32_e64 s[36:37], s99, v90
    v_cmp_lt_u32_e64 s[38:39], s99, v91
    s_add_u32 s99, s99, 1
    v_cmp_eq_u32_e64 s[40:41], s99, v76
    v_cmp_eq_u32_e64 s[42:43], s99, v77
    v_cmp_eq_u32_e64 s[44:45], s99, v78
    v_cmp_eq_u32_e64 s[46:47], s99, v79
    s_mov_b64 exec, s[32:33]
    ds_write_b64 v96, v[172:173] offset:512
    s_mov_b64 exec, s[34:35]
    ds_write_b64 v97, v[174:175] offset:512
    s_mov_b64 exec, s[36:37]
    ds_write_b64 v98, v[176:177] offset:512
    s_mov_b64 exec, s[38:39]
    ds_write_b64 v99, v[178:179] offset:512
    s_mov_b64 exec, -1
    v_cmp_lt_u32 vcc, s99, v224
    v_cndmask_b32_e64 v222, 8, v225, s[40:41]
    v_add_u32 v172, v172, v222
    v_add_u32 v96, 8, v96
    v_cndmask_b32_e64 v222, 8, v225, s[42:43]
    v_add_u32 v174, v174, v222
    v_add_u32 v97, 8, v97
    v_cndmask_b32_e64 v222, 8, v225, s[44:45]
    v_add_u32 v176, v176, v222
    v_add_u32 v98, 8, v98
    v_cndmask_b32_e64 v222, 8, v225, s[46:47]
    v_add_u32 v178, v178, v222
    v_add_u32 v99, 8, v99
    s_cbranch_vccnz K2_PLOOP
    v_mov_b32 v222, s99
    ds_write_b32 v228, v222 offset:104
    s_waitcnt vmcnt(0)
K2_B3:
    s_mov_b64 exec, -1
    s_lshl_b32 s95, s100, 8
    v_and_b32 v220, 31, v250
    v_lshl_add_u32 v220, v220, 3, s95
    s_mov_b32 s6, 0
    s_waitcnt vmcnt(3) lgkmcnt(0)
    s_barrier
    ds_read_b64 v[220:221], v220 offset:512
    ds_read_b32 v222, v229 offset:104
    s_waitcnt lgkmcnt(0)
    v_bfe_u32 v235, v220, 18, 6
    v_and_b32 v207, 0x3ffff, v220
    v_lshrrev_b32 v249, 24, v220
    v_mov_b32 v206, v221
    v_readfirstlane_b32 s97, v222
    v_cmp_lt_u32_e64 s[28:29], s6, v235
    s_add_u32 s6, s6, 1
    v_add_u32 v221, s4, v249
    buffer_load_dwordx2 v[240:241], v221, s[16:19], 0 idxen
    v_cndmask_b32_e64 v203, 0, v207, s[28:29]
    v_add_u32 v207, v207, v206
    ds_read_b32 v218, v203
    ds_read_u16 v203, v203 offset:4
    v_bfe_u32 v220, v249, 1, 3
    v_lshlrev_b32 v220, 4, v220
    v_lshlrev_b32 v221, 2, v219
    v_xor_b32 v220, v220, v221
    v_lshl_add_u32 v220, v249, 7, v220
    v_add_u32 v220, 100352, v220
    v_xor_b32 v221, 16, v220
    v_xor_b32 v222, 32, v220
    v_xor_b32 v223, 48, v220
    s_waitcnt lgkmcnt(0)
    ds_bpermute_b32 v210, v239, v203 offset:0
    ds_bpermute_b32 v212, v239, v203 offset:32
    ds_bpermute_b32 v214, v239, v203 offset:64
    ds_bpermute_b32 v216, v239, v203 offset:96
    ds_read_b128 v[172:175], v220
    ds_read_b128 v[176:179], v221
    ds_read_b128 v[180:183], v222
    ds_read_b128 v[184:187], v223
    buffer_load_dwordx4 v[188:191], v[218:219], s[12:15], 0 idxen offen
    buffer_load_dwordx2 v[200:201], v203, s[16:19], 0 idxen
    v_cmp_lt_u32_e64 s[30:31], s6, v235
    s_add_u32 s6, s6, 1
    s_cmp_eq_u64 s[28:29], 0
    s_cbranch_scc1 K2_EMPTY
    s_waitcnt lgkmcnt(4)
    s_add_u32 m0, s94, 0
    s_nop 0
    buffer_load_dwordx4 v[210:211], s[8:11], 0 idxen offen lds
    s_add_u32 m0, s94, 1024
    s_nop 0
    buffer_load_dwordx4 v[212:213], s[8:11], 0 idxen offen lds
    s_add_u32 m0, s94, 2048
    s_nop 0
    buffer_load_dwordx4 v[214:215], s[8:11], 0 idxen offen lds
    s_add_u32 m0, s94, 3072
    s_nop 0
    buffer_load_dwordx4 v[216:217], s[8:11], 0 idxen offen lds
    v_cndmask_b32_e64 v203, 0, v207, s[30:31]
    v_add_u32 v207, v207, v206
    ds_read_b32 v218, v203
    ds_read_u16 v203, v203 offset:4
    s_waitcnt lgkmcnt(0)
    ds_bpermute_b32 v210, v239, v203 offset:0
    ds_bpermute_b32 v212, v239, v203 offset:32
    ds_bpermute_b32 v214, v239, v203 offset:64
    ds_bpermute_b32 v216, v239, v203 offset:96
    buffer_load_dwordx4 v[192:195], v[218:219], s[12:15], 0 idxen offen
    buffer_load_dwordx2 v[204:205], v203, s[16:19], 0 idxen
    v_cmp_lt_u32_e64 s[32:33], s6, v235
    s_add_u32 s6, s6, 1
    s_waitcnt lgkmcnt(0)
    s_add_u32 m0, s94, 32768
    s_nop 0
    buffer_load_dwordx4 v[210:211], s[8:11], 0 idxen offen lds
    s_add_u32 m0, s94, 33792
    s_nop 0
    buffer_load_dwordx4 v[212:213], s[8:11], 0 idxen offen lds
    s_add_u32 m0, s94, 34816
    s_nop 0
    buffer_load_dwordx4 v[214:215], s[8:11], 0 idxen offen lds
    s_add_u32 m0, s94, 35840
    s_nop 0
    buffer_load_dwordx4 v[216:217], s[8:11], 0 idxen offen lds
    v_cndmask_b32_e64 v203, 0, v207, s[32:33]
    v_add_u32 v207, v207, v206
    ds_read_b32 v218, v203
    ds_read_u16 v203, v203 offset:4
    s_waitcnt lgkmcnt(0)
    ds_bpermute_b32 v210, v239, v203 offset:0
    ds_bpermute_b32 v212, v239, v203 offset:32
    ds_bpermute_b32 v214, v239, v203 offset:64
    ds_bpermute_b32 v216, v239, v203 offset:96
    v_and_b32 v221, 63, v250
    v_lshlrev_b32 v220, 4, v221
    v_lshlrev_b32 v221, 2, v221
    v_add_u32 v220, 138240, v220
    v_lshlrev_b32 v222, 3, v219
    v_add_u32 v221, 156672, v221
    v_add_u32 v222, 157696, v222
    ds_read_b128 v[140:143], v220 offset:0
    ds_read_b128 v[144:147], v220 offset:1024
    ds_read_b128 v[148:151], v220 offset:2048
    ds_read_b128 v[152:155], v220 offset:3072
    ds_read_b128 v[156:159], v220 offset:4096
    ds_read_b128 v[160:163], v220 offset:5120
    ds_read_b128 v[164:167], v220 offset:6144
    ds_read_b128 v[168:171], v220 offset:7168
    ds_read_b128 v[0:3], v220 offset:8192
    ds_read_b128 v[4:7], v220 offset:9216
    ds_read_b128 v[8:11], v220 offset:10240
    ds_read_b128 v[12:15], v220 offset:11264
    ds_read_b128 v[16:19], v220 offset:12288
    ds_read_b128 v[20:23], v220 offset:13312
    ds_read_b128 v[24:27], v220 offset:14336
    ds_read_b128 v[28:31], v220 offset:15360
    ds_read_b128 v[32:35], v220 offset:16384
    ds_read_b128 v[36:39], v220 offset:17408
    ds_read_b32 v40, v221
    ds_read_b32 v42, v221 offset:256
    ds_read_b128 v[108:111], v222 offset:0
    ds_read_b128 v[112:115], v222 offset:16
    ds_read_b128 v[116:119], v222 offset:32
    ds_read_b128 v[120:123], v222 offset:48
    ds_read_b128 v[124:127], v222 offset:64
    ds_read_b128 v[128:131], v222 offset:80
    ds_read_b128 v[132:135], v222 offset:96
    ds_read_b128 v[136:139], v222 offset:112
    v_mov_b32 v76, 0
    v_mov_b32 v77, 0
    v_mov_b32 v78, 0
    v_mov_b32 v79, 0
    v_mov_b32 v80, 0
    v_mov_b32 v81, 0
    v_mov_b32 v82, 0
    v_mov_b32 v83, 0
    v_mov_b32 v84, 0
    v_mov_b32 v85, 0
    v_mov_b32 v86, 0
    v_mov_b32 v87, 0
    v_mov_b32 v88, 0
    v_mov_b32 v89, 0
    v_mov_b32 v90, 0
    v_mov_b32 v91, 0
    v_mov_b32 v92, 0
    v_mov_b32 v93, 0
    v_mov_b32 v94, 0
    v_mov_b32 v95, 0
    v_mov_b32 v96, 0
    v_mov_b32 v97, 0
    v_mov_b32 v98, 0
    v_mov_b32 v99, 0
    v_mov_b32 v100, 0
    v_mov_b32 v101, 0
    v_mov_b32 v102, 0
    v_mov_b32 v103, 0
    v_mov_b32 v104, 0
    v_mov_b32 v105, 0
    v_mov_b32 v106, 0
    v_mov_b32 v107, 0
    v_mov_b32 v244, 0
    v_mov_b32 v245, 0
    v_mov_b32 v246, 0
    v_mov_b32 v247, 0
    s_waitcnt lgkmcnt(0)
    v_mfma_f32_32x32x16_bf16 v[44:59], v[140:143], v[172:175], 0
    v_mfma_f32_32x32x16_bf16 v[60:75], v[156:159], v[172:175], 0
    v_mfma_f32_32x32x16_bf16 v[44:59], v[144:147], v[176:179], v[44:59]
    v_mfma_f32_32x32x16_bf16 v[60:75], v[160:163], v[176:179], v[60:75]
    v_mfma_f32_32x32x16_bf16 v[44:59], v[148:151], v[180:183], v[44:59]
    v_mfma_f32_32x32x16_bf16 v[60:75], v[164:167], v[180:183], v[60:75]
    v_mfma_f32_32x32x16_bf16 v[44:59], v[152:155], v[184:187], v[44:59]
    v_mfma_f32_32x32x16_bf16 v[60:75], v[168:171], v[184:187], v[60:75]
    s_waitcnt vmcnt(6)
    ds_read_b128 v[172:175], v251 offset:0
    ds_read_b128 v[176:179], v252 offset:0
    ds_read_b128 v[180:183], v253 offset:0
    ds_read_b128 v[184:187], v254 offset:0
    v_mov_b32 v242, v241
    v_and_b32 v241, 0xffff0000, v240
    v_lshlrev_b32 v240, 16, v240
    v_lshlrev_b32 v232, 16, v200
    v_and_b32 v233, 0xffff0000, v200
    v_sub_f32 v234, v242, v201
    v_pk_add_f32 v[232:233], v[240:241], v[232:233] neg_lo:[0,1] neg_hi:[0,1]
    v_mul_f32 v208, v232, v232
    v_fmac_f32 v208, v233, v233
    v_fmac_f32 v208, v234, v234
    v_cvt_pk_bf16_f32 v208, v208, v208
    s_waitcnt lgkmcnt(0)
    s_nop 0
    v_mfma_f32_32x32x8_bf16 v[140:155], v[40:41], v[208:209], v[44:59]
    v_mfma_f32_32x32x16_bf16 v[140:155], v[32:35], v[188:191], v[140:155]
    v_mfma_f32_32x32x16_bf16 v[140:155], v[0:3], v[172:175], v[140:155]
    v_mfma_f32_32x32x16_bf16 v[140:155], v[4:7], v[176:179], v[140:155]
    v_mfma_f32_32x32x16_bf16 v[140:155], v[8:11], v[180:183], v[140:155]
    v_mfma_f32_32x32x16_bf16 v[140:155], v[12:15], v[184:187], v[140:155]
    s_nop 7
K2_LOOP:
    v_mfma_f32_32x32x8_bf16 v[156:171], v[42:43], v[208:209], v[60:75]
    s_mov_b64 exec, s[28:29]
    s_nop 1
    v_exp_f32 v220, v140
    v_exp_f32 v221, v141
    v_exp_f32 v222, v142
    v_exp_f32 v223, v143
    v_mfma_f32_32x32x16_bf16 v[156:171], v[36:39], v[188:191], v[156:171]
    v_exp_f32 v224, v144
    v_exp_f32 v225, v145
    s_bitcmp1_b32 s5, 2
    s_cbranch_scc0 K2_VP1
    s_setprio 1
K2_VP1:
    s_waitcnt lgkmcnt(0)
    s_mov_b64 exec, -1
    s_add_u32 m0, s94, 0
    s_nop 0
    buffer_load_dwordx4 v[210:211], s[8:11], 0 idxen offen lds
    s_add_u32 m0, s94, 1024
    s_nop 0
    buffer_load_dwordx4 v[212:213], s[8:11], 0 idxen offen lds
    s_add_u32 m0, s94, 2048
    s_nop 0
    buffer_load_dwordx4 v[214:215], s[8:11], 0 idxen offen lds
    s_add_u32 m0, s94, 3072
    s_nop 0
    buffer_load_dwordx4 v[216:217], s[8:11], 0 idxen offen lds
    s_mov_b64 exec, s[28:29]
    s_setprio 0
    v_exp_f32 v226, v146
    v_exp_f32 v227, v147
    v_pk_add_f32 v[220:221], v[220:221], 1.0 op_sel_hi:[1,0]
    v_pk_add_f32 v[222:223], v[222:223], 1.0 op_sel_hi:[1,0]
    v_pk_add_f32 v[224:225], v[224:225], 1.0 op_sel_hi:[1,0]
    v_pk_add_f32 v[226:227], v[226:227], 1.0 op_sel_hi:[1,0]
    v_mfma_f32_32x32x16_bf16 v[156:171], v[16:19], v[172:175], v[156:171]
    v_rcp_f32 v220, v220
    v_rcp_f32 v221, v221
    v_rcp_f32 v222, v222
    v_rcp_f32 v223, v223
    v_mfma_f32_32x32x16_bf16 v[156:171], v[20:23], v[176:179], v[156:171]
    v_rcp_f32 v224, v224
    v_rcp_f32 v225, v225
    v_rcp_f32 v226, v226
    v_rcp_f32 v227, v227
    v_pk_fma_f32 v[76:77], v[140:141], v[220:221], v[76:77]
    v_pk_fma_f32 v[78:79], v[142:143], v[222:223], v[78:79]
    v_pk_fma_f32 v[80:81], v[144:145], v[224:225], v[80:81]
    v_pk_fma_f32 v[82:83], v[146:147], v[226:227], v[82:83]
    v_pk_mul_f32 v[228:229], v[76:77], v[108:109]
    v_pk_mul_f32 v[230:231], v[78:79], v[110:111]
    v_pk_fma_f32 v[228:229], v[80:81], v[112:113], v[228:229]
    v_pk_fma_f32 v[230:231], v[82:83], v[114:115], v[230:231]
    v_mfma_f32_32x32x16_bf16 v[156:171], v[24:27], v[180:183], v[156:171]
    v_exp_f32 v220, v148
    v_exp_f32 v221, v149
    v_exp_f32 v222, v150
    v_exp_f32 v223, v151
    v_mfma_f32_32x32x16_bf16 v[156:171], v[28:31], v[184:187], v[156:171]
    v_exp_f32 v224, v152
    v_exp_f32 v225, v153
    v_exp_f32 v226, v154
    s_mov_b64 exec, -1
    buffer_load_dwordx4 v[196:199], v[218:219], s[12:15], 0 idxen offen
    buffer_load_dwordx2 v[200:201], v203, s[16:19], 0 idxen
    s_mov_b64 exec, s[28:29]
    v_exp_f32 v227, v155
    s_waitcnt vmcnt(6)
    ds_read_b128 v[172:175], v251 offset:32768
    ds_read_b128 v[176:179], v252 offset:32768
    ds_read_b128 v[180:183], v253 offset:32768
    ds_read_b128 v[184:187], v254 offset:32768
    v_cmp_lt_u32_e64 s[34:35], s6, v235
    s_add_u32 s6, s6, 1
    v_lshlrev_b32 v236, 16, v204
    v_and_b32 v237, 0xffff0000, v204
    v_sub_f32 v238, v242, v205
    v_pk_add_f32 v[236:237], v[240:241], v[236:237] neg_lo:[0,1] neg_hi:[0,1]
    v_mul_f32 v208, v236, v236
    v_fmac_f32 v208, v237, v237
    v_fmac_f32 v208, v238, v238
    v_cvt_pk_bf16_f32 v208, v208, v208
    v_cndmask_b32_e64 v203, 0, v207, s[34:35]
    v_add_u32 v207, v207, v206
    ds_read_b32 v218, v203
    ds_read_u16 v203, v203 offset:4
    v_pk_add_f32 v[220:221], v[220:221], 1.0 op_sel_hi:[1,0]
    v_pk_add_f32 v[222:223], v[222:223], 1.0 op_sel_hi:[1,0]
    v_pk_add_f32 v[224:225], v[224:225], 1.0 op_sel_hi:[1,0]
    v_pk_add_f32 v[226:227], v[226:227], 1.0 op_sel_hi:[1,0]
    v_rcp_f32 v220, v220
    v_rcp_f32 v221, v221
    v_rcp_f32 v222, v222
    v_rcp_f32 v223, v223
    v_rcp_f32 v224, v224
    v_rcp_f32 v225, v225
    v_rcp_f32 v226, v226
    v_rcp_f32 v227, v227
    s_waitcnt lgkmcnt(0)
    s_mov_b64 exec, -1
    ds_bpermute_b32 v210, v239, v203 offset:0
    ds_bpermute_b32 v212, v239, v203 offset:32
    ds_bpermute_b32 v214, v239, v203 offset:64
    ds_bpermute_b32 v216, v239, v203 offset:96
    s_mov_b64 exec, s[28:29]
    v_pk_fma_f32 v[84:85], v[148:149], v[220:221], v[84:85]
    v_pk_fma_f32 v[86:87], v[150:151], v[222:223], v[86:87]
    v_pk_fma_f32 v[88:89], v[152:153], v[224:225], v[88:89]
    v_pk_fma_f32 v[90:91], v[154:155], v[226:227], v[90:91]
    v_pk_fma_f32 v[228:229], v[84:85], v[116:117], v[228:229]
    v_pk_fma_f32 v[230:231], v[86:87], v[118:119], v[230:231]
    v_pk_fma_f32 v[228:229], v[88:89], v[120:121], v[228:229]
    v_pk_fma_f32 v[230:231], v[90:91], v[122:123], v[230:231]
    v_mfma_f32_32x32x8_bf16 v[140:155], v[40:41], v[208:209], v[44:59]
    v_exp_f32 v220, v156
    v_exp_f32 v221, v157
    v_exp_f32 v222, v158
    v_exp_f32 v223, v159
    v_mfma_f32_32x32x16_bf16 v[140:155], v[32:35], v[192:195], v[140:155]
    v_exp_f32 v224, v160
    v_exp_f32 v225, v161
    v_exp_f32 v226, v162
    v_exp_f32 v227, v163
    v_pk_add_f32 v[220:221], v[220:221], 1.0 op_sel_hi:[1,0]
    v_pk_add_f32 v[222:223], v[222:223], 1.0 op_sel_hi:[1,0]
    v_pk_add_f32 v[224:225], v[224:225], 1.0 op_sel_hi:[1,0]
    v_pk_add_f32 v[226:227], v[226:227], 1.0 op_sel_hi:[1,0]
    v_mfma_f32_32x32x16_bf16 v[140:155], v[0:3], v[172:175], v[140:155]
    v_rcp_f32 v220, v220
    v_rcp_f32 v221, v221
    v_rcp_f32 v222, v222
    v_rcp_f32 v223, v223
    v_mfma_f32_32x32x16_bf16 v[140:155], v[4:7], v[176:179], v[140:155]
    v_rcp_f32 v224, v224
    v_rcp_f32 v225, v225
    v_rcp_f32 v226, v226
    v_rcp_f32 v227, v227
    v_pk_fma_f32 v[92:93], v[156:157], v[220:221], v[92:93]
    v_pk_fma_f32 v[94:95], v[158:159], v[222:223], v[94:95]
    v_pk_fma_f32 v[96:97], v[160:161], v[224:225], v[96:97]
    v_pk_fma_f32 v[98:99], v[162:163], v[226:227], v[98:99]
    v_pk_fma_f32 v[228:229], v[92:93], v[124:125], v[228:229]
    v_pk_fma_f32 v[230:231], v[94:95], v[126:127], v[230:231]
    v_pk_fma_f32 v[228:229], v[96:97], v[128:129], v[228:229]
    v_pk_fma_f32 v[230:231], v[98:99], v[130:131], v[230:231]
    v_mfma_f32_32x32x16_bf16 v[140:155], v[8:11], v[180:183], v[140:155]
    v_exp_f32 v220, v164
    v_exp_f32 v221, v165
    v_exp_f32 v222, v166
    v_exp_f32 v223, v167
    v_mfma_f32_32x32x16_bf16 v[140:155], v[12:15], v[184:187], v[140:155]
    v_exp_f32 v224, v168
    v_exp_f32 v225, v169
    v_exp_f32 v226, v170
    v_exp_f32 v227, v171
    v_pk_add_f32 v[220:221], v[220:221], 1.0 op_sel_hi:[1,0]
    v_pk_add_f32 v[222:223], v[222:223], 1.0 op_sel_hi:[1,0]
    v_pk_add_f32 v[224:225], v[224:225], 1.0 op_sel_hi:[1,0]
    v_pk_add_f32 v[226:227], v[226:227], 1.0 op_sel_hi:[1,0]
    v_rcp_f32 v220, v220
    v_rcp_f32 v221, v221
    v_rcp_f32 v222, v222
    v_rcp_f32 v223, v223
    v_rcp_f32 v224, v224
    v_rcp_f32 v225, v225
    v_rcp_f32 v226, v226
    v_rcp_f32 v227, v227
    v_pk_fma_f32 v[100:101], v[164:165], v[220:221], v[100:101]
    v_pk_fma_f32 v[102:103], v[166:167], v[222:223], v[102:103]
    v_pk_fma_f32 v[104:105], v[168:169], v[224:225], v[104:105]
    v_pk_fma_f32 v[106:107], v[170:171], v[226:227], v[106:107]
    v_pk_fma_f32 v[228:229], v[100:101], v[132:133], v[228:229]
    v_pk_fma_f32 v[230:231], v[102:103], v[134:135], v[230:231]
    v_pk_fma_f32 v[228:229], v[104:105], v[136:137], v[228:229]
    v_pk_fma_f32 v[230:231], v[106:107], v[138:139], v[230:231]
    v_pk_add_f32 v[228:229], v[228:229], v[230:231]
    s_cmp_eq_u64 s[30:31], 0
    v_add_f32 v243, v228, v229
    v_sub_f32 v248, v243, v247
    v_pk_fma_f32 v[244:245], v[232:233], v[248:249], v[244:245] op_sel_hi:[1,0,1]
    v_fmac_f32 v246, v234, v248
    s_mov_b64 exec, -1
    s_cbranch_scc1 K2_DONE
    v_mfma_f32_32x32x8_bf16 v[156:171], v[42:43], v[208:209], v[60:75]
    s_mov_b64 exec, s[30:31]
    v_exp_f32 v220, v140
    v_exp_f32 v221, v141
    v_exp_f32 v222, v142
    v_exp_f32 v223, v143
    v_mfma_f32_32x32x16_bf16 v[156:171], v[36:39], v[192:195], v[156:171]
    v_exp_f32 v224, v144
    v_exp_f32 v225, v145
    s_bitcmp1_b32 s5, 2
    s_cbranch_scc0 K2_VP3
    s_setprio 1
K2_VP3:
    s_waitcnt lgkmcnt(0)
    s_mov_b64 exec, -1
    s_add_u32 m0, s94, 32768
    s_nop 0
    buffer_load_dwordx4 v[210:211], s[8:11], 0 idxen offen lds
    s_add_u32 m0, s94, 33792
    s_nop 0
    buffer_load_dwordx4 v[212:213], s[8:11], 0 idxen offen lds
    s_add_u32 m0, s94, 34816
    s_nop 0
    buffer_load_dwordx4 v[214:215], s[8:11], 0 idxen offen lds
    s_add_u32 m0, s94, 35840
    s_nop 0
    buffer_load_dwordx4 v[216:217], s[8:11], 0 idxen offen lds
    s_mov_b64 exec, s[30:31]
    s_setprio 0
    v_exp_f32 v226, v146
    v_exp_f32 v227, v147
    v_pk_add_f32 v[220:221], v[220:221], 1.0 op_sel_hi:[1,0]
    v_pk_add_f32 v[222:223], v[222:223], 1.0 op_sel_hi:[1,0]
    v_pk_add_f32 v[224:225], v[224:225], 1.0 op_sel_hi:[1,0]
    v_pk_add_f32 v[226:227], v[226:227], 1.0 op_sel_hi:[1,0]
    v_mfma_f32_32x32x16_bf16 v[156:171], v[16:19], v[172:175], v[156:171]
    v_rcp_f32 v220, v220
    v_rcp_f32 v221, v221
    v_rcp_f32 v222, v222
    v_rcp_f32 v223, v223
    v_mfma_f32_32x32x16_bf16 v[156:171], v[20:23], v[176:179], v[156:171]
    v_rcp_f32 v224, v224
    v_rcp_f32 v225, v225
    v_rcp_f32 v226, v226
    v_rcp_f32 v227, v227
    v_pk_fma_f32 v[76:77], v[140:141], v[220:221], v[76:77]
    v_pk_fma_f32 v[78:79], v[142:143], v[222:223], v[78:79]
    v_pk_fma_f32 v[80:81], v[144:145], v[224:225], v[80:81]
    v_pk_fma_f32 v[82:83], v[146:147], v[226:227], v[82:83]
    v_pk_mul_f32 v[228:229], v[76:77], v[108:109]
    v_pk_mul_f32 v[230:231], v[78:79], v[110:111]
    v_pk_fma_f32 v[228:229], v[80:81], v[112:113], v[228:229]
    v_pk_fma_f32 v[230:231], v[82:83], v[114:115], v[230:231]
    v_mfma_f32_32x32x16_bf16 v[156:171], v[24:27], v[180:183], v[156:171]
    v_exp_f32 v220, v148
    v_exp_f32 v221, v149
    v_exp_f32 v222, v150
    v_exp_f32 v223, v151
    v_mfma_f32_32x32x16_bf16 v[156:171], v[28:31], v[184:187], v[156:171]
    v_exp_f32 v224, v152
    v_exp_f32 v225, v153
    v_exp_f32 v226, v154
    s_mov_b64 exec, -1
    buffer_load_dwordx4 v[188:191], v[218:219], s[12:15], 0 idxen offen
    buffer_load_dwordx2 v[204:205], v203, s[16:19], 0 idxen
    s_mov_b64 exec, s[30:31]
    v_exp_f32 v227, v155
    s_waitcnt vmcnt(6)
    ds_read_b128 v[172:175], v251 offset:0
    ds_read_b128 v[176:179], v252 offset:0
    ds_read_b128 v[180:183], v253 offset:0
    ds_read_b128 v[184:187], v254 offset:0
    v_cmp_lt_u32_e64 s[36:37], s6, v235
    s_add_u32 s6, s6, 1
    v_lshlrev_b32 v232, 16, v200
    v_and_b32 v233, 0xffff0000, v200
    v_sub_f32 v234, v242, v201
    v_pk_add_f32 v[232:233], v[240:241], v[232:233] neg_lo:[0,1] neg_hi:[0,1]
    v_mul_f32 v208, v232, v232
    v_fmac_f32 v208, v233, v233
    v_fmac_f32 v208, v234, v234
    v_cvt_pk_bf16_f32 v208, v208, v208
    v_cndmask_b32_e64 v203, 0, v207, s[36:37]
    v_add_u32 v207, v207, v206
    ds_read_b32 v218, v203
    ds_read_u16 v203, v203 offset:4
    v_pk_add_f32 v[220:221], v[220:221], 1.0 op_sel_hi:[1,0]
    v_pk_add_f32 v[222:223], v[222:223], 1.0 op_sel_hi:[1,0]
    v_pk_add_f32 v[224:225], v[224:225], 1.0 op_sel_hi:[1,0]
    v_pk_add_f32 v[226:227], v[226:227], 1.0 op_sel_hi:[1,0]
    v_rcp_f32 v220, v220
    v_rcp_f32 v221, v221
    v_rcp_f32 v222, v222
    v_rcp_f32 v223, v223
    v_rcp_f32 v224, v224
    v_rcp_f32 v225, v225
    v_rcp_f32 v226, v226
    v_rcp_f32 v227, v227
    s_waitcnt lgkmcnt(0)
    s_mov_b64 exec, -1
    ds_bpermute_b32 v210, v239, v203 offset:0
    ds_bpermute_b32 v212, v239, v203 offset:32
    ds_bpermute_b32 v214, v239, v203 offset:64
    ds_bpermute_b32 v216, v239, v203 offset:96
    s_mov_b64 exec, s[30:31]
    v_pk_fma_f32 v[84:85], v[148:149], v[220:221], v[84:85]
    v_pk_fma_f32 v[86:87], v[150:151], v[222:223], v[86:87]
    v_pk_fma_f32 v[88:89], v[152:153], v[224:225], v[88:89]
    v_pk_fma_f32 v[90:91], v[154:155], v[226:227], v[90:91]
    v_pk_fma_f32 v[228:229], v[84:85], v[116:117], v[228:229]
    v_pk_fma_f32 v[230:231], v[86:87], v[118:119], v[230:231]
    v_pk_fma_f32 v[228:229], v[88:89], v[120:121], v[228:229]
    v_pk_fma_f32 v[230:231], v[90:91], v[122:123], v[230:231]
    v_mfma_f32_32x32x8_bf16 v[140:155], v[40:41], v[208:209], v[44:59]
    v_exp_f32 v220, v156
    v_exp_f32 v221, v157
    v_exp_f32 v222, v158
    v_exp_f32 v223, v159
    v_mfma_f32_32x32x16_bf16 v[140:155], v[32:35], v[196:199], v[140:155]
    v_exp_f32 v224, v160
    v_exp_f32 v225, v161
    v_exp_f32 v226, v162
    v_exp_f32 v227, v163
    v_pk_add_f32 v[220:221], v[220:221], 1.0 op_sel_hi:[1,0]
    v_pk_add_f32 v[222:223], v[222:223], 1.0 op_sel_hi:[1,0]
    v_pk_add_f32 v[224:225], v[224:225], 1.0 op_sel_hi:[1,0]
    v_pk_add_f32 v[226:227], v[226:227], 1.0 op_sel_hi:[1,0]
    v_mfma_f32_32x32x16_bf16 v[140:155], v[0:3], v[172:175], v[140:155]
    v_rcp_f32 v220, v220
    v_rcp_f32 v221, v221
    v_rcp_f32 v222, v222
    v_rcp_f32 v223, v223
    v_mfma_f32_32x32x16_bf16 v[140:155], v[4:7], v[176:179], v[140:155]
    v_rcp_f32 v224, v224
    v_rcp_f32 v225, v225
    v_rcp_f32 v226, v226
    v_rcp_f32 v227, v227
    v_pk_fma_f32 v[92:93], v[156:157], v[220:221], v[92:93]
    v_pk_fma_f32 v[94:95], v[158:159], v[222:223], v[94:95]
    v_pk_fma_f32 v[96:97], v[160:161], v[224:225], v[96:97]
    v_pk_fma_f32 v[98:99], v[162:163], v[226:227], v[98:99]
    v_pk_fma_f32 v[228:229], v[92:93], v[124:125], v[228:229]
    v_pk_fma_f32 v[230:231], v[94:95], v[126:127], v[230:231]
    v_pk_fma_f32 v[228:229], v[96:97], v[128:129], v[228:229]
    v_pk_fma_f32 v[230:231], v[98:99], v[130:131], v[230:231]
    v_mfma_f32_32x32x16_bf16 v[140:155], v[8:11], v[180:183], v[140:155]
    v_exp_f32 v220, v164
    v_exp_f32 v221, v165
    v_exp_f32 v222, v166
    v_exp_f32 v223, v167
    v_mfma_f32_32x32x16_bf16 v[140:155], v[12:15], v[184:187], v[140:155]
    v_exp_f32 v224, v168
    v_exp_f32 v225, v169
    v_exp_f32 v226, v170
    v_exp_f32 v227, v171
    v_pk_add_f32 v[220:221], v[220:221], 1.0 op_sel_hi:[1,0]
    v_pk_add_f32 v[222:223], v[222:223], 1.0 op_sel_hi:[1,0]
    v_pk_add_f32 v[224:225], v[224:225], 1.0 op_sel_hi:[1,0]
    v_pk_add_f32 v[226:227], v[226:227], 1.0 op_sel_hi:[1,0]
    v_rcp_f32 v220, v220
    v_rcp_f32 v221, v221
    v_rcp_f32 v222, v222
    v_rcp_f32 v223, v223
    v_rcp_f32 v224, v224
    v_rcp_f32 v225, v225
    v_rcp_f32 v226, v226
    v_rcp_f32 v227, v227
    v_pk_fma_f32 v[100:101], v[164:165], v[220:221], v[100:101]
    v_pk_fma_f32 v[102:103], v[166:167], v[222:223], v[102:103]
    v_pk_fma_f32 v[104:105], v[168:169], v[224:225], v[104:105]
    v_pk_fma_f32 v[106:107], v[170:171], v[226:227], v[106:107]
    v_pk_fma_f32 v[228:229], v[100:101], v[132:133], v[228:229]
    v_pk_fma_f32 v[230:231], v[102:103], v[134:135], v[230:231]
    v_pk_fma_f32 v[228:229], v[104:105], v[136:137], v[228:229]
    v_pk_fma_f32 v[230:231], v[106:107], v[138:139], v[230:231]
    v_pk_add_f32 v[228:229], v[228:229], v[230:231]
    s_cmp_eq_u64 s[32:33], 0
    v_add_f32 v247, v228, v229
    v_sub_f32 v248, v247, v243
    v_pk_fma_f32 v[244:245], v[236:237], v[248:249], v[244:245] op_sel_hi:[1,0,1]
    v_fmac_f32 v246, v238, v248
    s_mov_b64 exec, -1
    s_cbranch_scc1 K2_DONE
    v_mfma_f32_32x32x8_bf16 v[156:171], v[42:43], v[208:209], v[60:75]
    s_mov_b64 exec, s[32:33]
    v_exp_f32 v220, v140
    v_exp_f32 v221, v141
    v_exp_f32 v222, v142
    v_exp_f32 v223, v143
    v_mfma_f32_32x32x16_bf16 v[156:171], v[36:39], v[196:199], v[156:171]
    v_exp_f32 v224, v144
    v_exp_f32 v225, v145
    s_bitcmp1_b32 s5, 2
    s_cbranch_scc0 K2_VP5
    s_setprio 1
K2_VP5:
    s_waitcnt lgkmcnt(0)
    s_mov_b64 exec, -1
    s_add_u32 m0, s94, 0
    s_nop 0
    buffer_load_dwordx4 v[210:211], s[8:11], 0 idxen offen lds
    s_add_u32 m0, s94, 1024
    s_nop 0
    buffer_load_dwordx4 v[212:213], s[8:11], 0 idxen offen lds
    s_add_u32 m0, s94, 2048
    s_nop 0
    buffer_load_dwordx4 v[214:215], s[8:11], 0 idxen offen lds
    s_add_u32 m0, s94, 3072
    s_nop 0
    buffer_load_dwordx4 v[216:217], s[8:11], 0 idxen offen lds
    s_mov_b64 exec, s[32:33]
    s_setprio 0
    v_exp_f32 v226, v146
    v_exp_f32 v227, v147
    v_pk_add_f32 v[220:221], v[220:221], 1.0 op_sel_hi:[1,0]
    v_pk_add_f32 v[222:223], v[222:223], 1.0 op_sel_hi:[1,0]
    v_pk_add_f32 v[224:225], v[224:225], 1.0 op_sel_hi:[1,0]
    v_pk_add_f32 v[226:227], v[226:227], 1.0 op_sel_hi:[1,0]
    v_mfma_f32_32x32x16_bf16 v[156:171], v[16:19], v[172:175], v[156:171]
    v_rcp_f32 v220, v220
    v_rcp_f32 v221, v221
    v_rcp_f32 v222, v222
    v_rcp_f32 v223, v223
    v_mfma_f32_32x32x16_bf16 v[156:171], v[20:23], v[176:179], v[156:171]
    v_rcp_f32 v224, v224
    v_rcp_f32 v225, v225
    v_rcp_f32 v226, v226
    v_rcp_f32 v227, v227
    v_pk_fma_f32 v[76:77], v[140:141], v[220:221], v[76:77]
    v_pk_fma_f32 v[78:79], v[142:143], v[222:223], v[78:79]
    v_pk_fma_f32 v[80:81], v[144:145], v[224:225], v[80:81]
    v_pk_fma_f32 v[82:83], v[146:147], v[226:227], v[82:83]
    v_pk_mul_f32 v[228:229], v[76:77], v[108:109]
    v_pk_mul_f32 v[230:231], v[78:79], v[110:111]
    v_pk_fma_f32 v[228:229], v[80:81], v[112:113], v[228:229]
    v_pk_fma_f32 v[230:231], v[82:83], v[114:115], v[230:231]
    v_mfma_f32_32x32x16_bf16 v[156:171], v[24:27], v[180:183], v[156:171]
    v_exp_f32 v220, v148
    v_exp_f32 v221, v149
    v_exp_f32 v222, v150
    v_exp_f32 v223, v151
    v_mfma_f32_32x32x16_bf16 v[156:171], v[28:31], v[184:187], v[156:171]
    v_exp_f32 v224, v152
    v_exp_f32 v225, v153
    v_exp_f32 v226, v154
    s_mov_b64 exec, -1
    buffer_load_dwordx4 v[192:195], v[218:219], s[12:15], 0 idxen offen
    buffer_load_dwordx2 v[200:201], v203, s[16:19], 0 idxen
    s_mov_b64 exec, s[32:33]
    v_exp_f32 v227, v155
    s_waitcnt vmcnt(6)
    ds_read_b128 v[172:175], v251 offset:32768
    ds_read_b128 v[176:179], v252 offset:32768
    ds_read_b128 v[180:183], v253 offset:32768
    ds_read_b128 v[184:187], v254 offset:32768
    v_cmp_lt_u32_e64 s[38:39], s6, v235
    s_add_u32 s6, s6, 1
    v_lshlrev_b32 v236, 16, v204
    v_and_b32 v237, 0xffff0000, v204
    v_sub_f32 v238, v242, v205
    v_pk_add_f32 v[236:237], v[240:241], v[236:237] neg_lo:[0,1] neg_hi:[0,1]
    v_mul_f32 v208, v236, v236
    v_fmac_f32 v208, v237, v237
    v_fmac_f32 v208, v238, v238
    v_cvt_pk_bf16_f32 v208, v208, v208
    v_cndmask_b32_e64 v203, 0, v207, s[38:39]
    v_add_u32 v207, v207, v206
    ds_read_b32 v218, v203
    ds_read_u16 v203, v203 offset:4
    v_pk_add_f32 v[220:221], v[220:221], 1.0 op_sel_hi:[1,0]
    v_pk_add_f32 v[222:223], v[222:223], 1.0 op_sel_hi:[1,0]
    v_pk_add_f32 v[224:225], v[224:225], 1.0 op_sel_hi:[1,0]
    v_pk_add_f32 v[226:227], v[226:227], 1.0 op_sel_hi:[1,0]
    v_rcp_f32 v220, v220
    v_rcp_f32 v221, v221
    v_rcp_f32 v222, v222
    v_rcp_f32 v223, v223
    v_rcp_f32 v224, v224
    v_rcp_f32 v225, v225
    v_rcp_f32 v226, v226
    v_rcp_f32 v227, v227
    s_waitcnt lgkmcnt(0)
    s_mov_b64 exec, -1
    ds_bpermute_b32 v210, v239, v203 offset:0
    ds_bpermute_b32 v212, v239, v203 offset:32
    ds_bpermute_b32 v214, v239, v203 offset:64
    ds_bpermute_b32 v216, v239, v203 offset:96
    s_mov_b64 exec, s[32:33]
    v_pk_fma_f32 v[84:85], v[148:149], v[220:221], v[84:85]
    v_pk_fma_f32 v[86:87], v[150:151], v[222:223], v[86:87]
    v_pk_fma_f32 v[88:89], v[152:153], v[224:225], v[88:89]
    v_pk_fma_f32 v[90:91], v[154:155], v[226:227], v[90:91]
    v_pk_fma_f32 v[228:229], v[84:85], v[116:117], v[228:229]
    v_pk_fma_f32 v[230:231], v[86:87], v[118:119], v[230:231]
    v_pk_fma_f32 v[228:229], v[88:89], v[120:121], v[228:229]
    v_pk_fma_f32 v[230:231], v[90:91], v[122:123], v[230:231]
    v_mfma_f32_32x32x8_bf16 v[140:155], v[40:41], v[208:209], v[44:59]
    v_exp_f32 v220, v156
    v_exp_f32 v221, v157
    v_exp_f32 v222, v158
    v_exp_f32 v223, v159
    v_mfma_f32_32x32x16_bf16 v[140:155], v[32:35], v[188:191], v[140:155]
    v_exp_f32 v224, v160
    v_exp_f32 v225, v161
    v_exp_f32 v226, v162
    v_exp_f32 v227, v163
    v_pk_add_f32 v[220:221], v[220:221], 1.0 op_sel_hi:[1,0]
    v_pk_add_f32 v[222:223], v[222:223], 1.0 op_sel_hi:[1,0]
    v_pk_add_f32 v[224:225], v[224:225], 1.0 op_sel_hi:[1,0]
    v_pk_add_f32 v[226:227], v[226:227], 1.0 op_sel_hi:[1,0]
    v_mfma_f32_32x32x16_bf16 v[140:155], v[0:3], v[172:175], v[140:155]
    v_rcp_f32 v220, v220
    v_rcp_f32 v221, v221
    v_rcp_f32 v222, v222
    v_rcp_f32 v223, v223
    v_mfma_f32_32x32x16_bf16 v[140:155], v[4:7], v[176:179], v[140:155]
    v_rcp_f32 v224, v224
    v_rcp_f32 v225, v225
    v_rcp_f32 v226, v226
    v_rcp_f32 v227, v227
    v_pk_fma_f32 v[92:93], v[156:157], v[220:221], v[92:93]
    v_pk_fma_f32 v[94:95], v[158:159], v[222:223], v[94:95]
    v_pk_fma_f32 v[96:97], v[160:161], v[224:225], v[96:97]
    v_pk_fma_f32 v[98:99], v[162:163], v[226:227], v[98:99]
    v_pk_fma_f32 v[228:229], v[92:93], v[124:125], v[228:229]
    v_pk_fma_f32 v[230:231], v[94:95], v[126:127], v[230:231]
    v_pk_fma_f32 v[228:229], v[96:97], v[128:129], v[228:229]
    v_pk_fma_f32 v[230:231], v[98:99], v[130:131], v[230:231]
    v_mfma_f32_32x32x16_bf16 v[140:155], v[8:11], v[180:183], v[140:155]
    v_exp_f32 v220, v164
    v_exp_f32 v221, v165
    v_exp_f32 v222, v166
    v_exp_f32 v223, v167
    v_mfma_f32_32x32x16_bf16 v[140:155], v[12:15], v[184:187], v[140:155]
    v_exp_f32 v224, v168
    v_exp_f32 v225, v169
    v_exp_f32 v226, v170
    v_exp_f32 v227, v171
    v_pk_add_f32 v[220:221], v[220:221], 1.0 op_sel_hi:[1,0]
    v_pk_add_f32 v[222:223], v[222:223], 1.0 op_sel_hi:[1,0]
    v_pk_add_f32 v[224:225], v[224:225], 1.0 op_sel_hi:[1,0]
    v_pk_add_f32 v[226:227], v[226:227], 1.0 op_sel_hi:[1,0]
    v_rcp_f32 v220, v220
    v_rcp_f32 v221, v221
    v_rcp_f32 v222, v222
    v_rcp_f32 v223, v223
    v_rcp_f32 v224, v224
    v_rcp_f32 v225, v225
    v_rcp_f32 v226, v226
    v_rcp_f32 v227, v227
    v_pk_fma_f32 v[100:101], v[164:165], v[220:221], v[100:101]
    v_pk_fma_f32 v[102:103], v[166:167], v[222:223], v[102:103]
    v_pk_fma_f32 v[104:105], v[168:169], v[224:225], v[104:105]
    v_pk_fma_f32 v[106:107], v[170:171], v[226:227], v[106:107]
    v_pk_fma_f32 v[228:229], v[100:101], v[132:133], v[228:229]
    v_pk_fma_f32 v[230:231], v[102:103], v[134:135], v[230:231]
    v_pk_fma_f32 v[228:229], v[104:105], v[136:137], v[228:229]
    v_pk_fma_f32 v[230:231], v[106:107], v[138:139], v[230:231]
    v_pk_add_f32 v[228:229], v[228:229], v[230:231]
    s_cmp_eq_u64 s[34:35], 0
    v_add_f32 v243, v228, v229
    v_sub_f32 v248, v243, v247
    v_pk_fma_f32 v[244:245], v[232:233], v[248:249], v[244:245] op_sel_hi:[1,0,1]
    v_fmac_f32 v246, v234, v248
    s_mov_b64 exec, -1
    s_cbranch_scc1 K2_DONE
    v_mfma_f32_32x32x8_bf16 v[156:171], v[42:43], v[208:209], v[60:75]
    s_mov_b64 exec, s[34:35]
    v_exp_f32 v220, v140
    v_exp_f32 v221, v141
    v_exp_f32 v222, v142
    v_exp_f32 v223, v143
    v_mfma_f32_32x32x16_bf16 v[156:171], v[36:39], v[188:191], v[156:171]
    v_exp_f32 v224, v144
    v_exp_f32 v225, v145
    s_bitcmp1_b32 s5, 2
    s_cbranch_scc0 K2_VP7
    s_setprio 1
K2_VP7:
    s_waitcnt lgkmcnt(0)
    s_mov_b64 exec, -1
    s_add_u32 m0, s94, 32768
    s_nop 0
    buffer_load_dwordx4 v[210:211], s[8:11], 0 idxen offen lds
    s_add_u32 m0, s94, 33792
    s_nop 0
    buffer_load_dwordx4 v[212:213], s[8:11], 0 idxen offen lds
    s_add_u32 m0, s94, 34816
    s_nop 0
    buffer_load_dwordx4 v[214:215], s[8:11], 0 idxen offen lds
    s_add_u32 m0, s94, 35840
    s_nop 0
    buffer_load_dwordx4 v[216:217], s[8:11], 0 idxen offen lds
    s_mov_b64 exec, s[34:35]
    s_setprio 0
    v_exp_f32 v226, v146
    v_exp_f32 v227, v147
    v_pk_add_f32 v[220:221], v[220:221], 1.0 op_sel_hi:[1,0]
    v_pk_add_f32 v[222:223], v[222:223], 1.0 op_sel_hi:[1,0]
    v_pk_add_f32 v[224:225], v[224:225], 1.0 op_sel_hi:[1,0]
    v_pk_add_f32 v[226:227], v[226:227], 1.0 op_sel_hi:[1,0]
    v_mfma_f32_32x32x16_bf16 v[156:171], v[16:19], v[172:175], v[156:171]
    v_rcp_f32 v220, v220
    v_rcp_f32 v221, v221
    v_rcp_f32 v222, v222
    v_rcp_f32 v223, v223
    v_mfma_f32_32x32x16_bf16 v[156:171], v[20:23], v[176:179], v[156:171]
    v_rcp_f32 v224, v224
    v_rcp_f32 v225, v225
    v_rcp_f32 v226, v226
    v_rcp_f32 v227, v227
    v_pk_fma_f32 v[76:77], v[140:141], v[220:221], v[76:77]
    v_pk_fma_f32 v[78:79], v[142:143], v[222:223], v[78:79]
    v_pk_fma_f32 v[80:81], v[144:145], v[224:225], v[80:81]
    v_pk_fma_f32 v[82:83], v[146:147], v[226:227], v[82:83]
    v_pk_mul_f32 v[228:229], v[76:77], v[108:109]
    v_pk_mul_f32 v[230:231], v[78:79], v[110:111]
    v_pk_fma_f32 v[228:229], v[80:81], v[112:113], v[228:229]
    v_pk_fma_f32 v[230:231], v[82:83], v[114:115], v[230:231]
    v_mfma_f32_32x32x16_bf16 v[156:171], v[24:27], v[180:183], v[156:171]
    v_exp_f32 v220, v148
    v_exp_f32 v221, v149
    v_exp_f32 v222, v150
    v_exp_f32 v223, v151
    v_mfma_f32_32x32x16_bf16 v[156:171], v[28:31], v[184:187], v[156:171]
    v_exp_f32 v224, v152
    v_exp_f32 v225, v153
    v_exp_f32 v226, v154
    s_mov_b64 exec, -1
    buffer_load_dwordx4 v[196:199], v[218:219], s[12:15], 0 idxen offen
    buffer_load_dwordx2 v[204:205], v203, s[16:19], 0 idxen
    s_mov_b64 exec, s[34:35]
    v_exp_f32 v227, v155
    s_waitcnt vmcnt(6)
    ds_read_b128 v[172:175], v251 offset:0
    ds_read_b128 v[176:179], v252 offset:0
    ds_read_b128 v[180:183], v253 offset:0
    ds_read_b128 v[184:187], v254 offset:0
    v_cmp_lt_u32_e64 s[28:29], s6, v235
    s_add_u32 s6, s6, 1
    v_lshlrev_b32 v232, 16, v200
    v_and_b32 v233, 0xffff0000, v200
    v_sub_f32 v234, v242, v201
    v_pk_add_f32 v[232:233], v[240:241], v[232:233] neg_lo:[0,1] neg_hi:[0,1]
    v_mul_f32 v208, v232, v232
    v_fmac_f32 v208, v233, v233
    v_fmac_f32 v208, v234, v234
    v_cvt_pk_bf16_f32 v208, v208, v208
    v_cndmask_b32_e64 v203, 0, v207, s[28:29]
    v_add_u32 v207, v207, v206
    ds_read_b32 v218, v203
    ds_read_u16 v203, v203 offset:4
    v_pk_add_f32 v[220:221], v[220:221], 1.0 op_sel_hi:[1,0]
    v_pk_add_f32 v[222:223], v[222:223], 1.0 op_sel_hi:[1,0]
    v_pk_add_f32 v[224:225], v[224:225], 1.0 op_sel_hi:[1,0]
    v_pk_add_f32 v[226:227], v[226:227], 1.0 op_sel_hi:[1,0]
    v_rcp_f32 v220, v220
    v_rcp_f32 v221, v221
    v_rcp_f32 v222, v222
    v_rcp_f32 v223, v223
    v_rcp_f32 v224, v224
    v_rcp_f32 v225, v225
    v_rcp_f32 v226, v226
    v_rcp_f32 v227, v227
    s_waitcnt lgkmcnt(0)
    s_mov_b64 exec, -1
    ds_bpermute_b32 v210, v239, v203 offset:0
    ds_bpermute_b32 v212, v239, v203 offset:32
    ds_bpermute_b32 v214, v239, v203 offset:64
    ds_bpermute_b32 v216, v239, v203 offset:96
    s_mov_b64 exec, s[34:35]
    v_pk_fma_f32 v[84:85], v[148:149], v[220:221], v[84:85]
    v_pk_fma_f32 v[86:87], v[150:151], v[222:223], v[86:87]
    v_pk_fma_f32 v[88:89], v[152:153], v[224:225], v[88:89]
    v_pk_fma_f32 v[90:91], v[154:155], v[226:227], v[90:91]
    v_pk_fma_f32 v[228:229], v[84:85], v[116:117], v[228:229]
    v_pk_fma_f32 v[230:231], v[86:87], v[118:119], v[230:231]
    v_pk_fma_f32 v[228:229], v[88:89], v[120:121], v[228:229]
    v_pk_fma_f32 v[230:231], v[90:91], v[122:123], v[230:231]
    v_mfma_f32_32x32x8_bf16 v[140:155], v[40:41], v[208:209], v[44:59]
    v_exp_f32 v220, v156
    v_exp_f32 v221, v157
    v_exp_f32 v222, v158
    v_exp_f32 v223, v159
    v_mfma_f32_32x32x16_bf16 v[140:155], v[32:35], v[192:195], v[140:155]
    v_exp_f32 v224, v160
    v_exp_f32 v225, v161
    v_exp_f32 v226, v162
    v_exp_f32 v227, v163
    v_pk_add_f32 v[220:221], v[220:221], 1.0 op_sel_hi:[1,0]
    v_pk_add_f32 v[222:223], v[222:223], 1.0 op_sel_hi:[1,0]
    v_pk_add_f32 v[224:225], v[224:225], 1.0 op_sel_hi:[1,0]
    v_pk_add_f32 v[226:227], v[226:227], 1.0 op_sel_hi:[1,0]
    v_mfma_f32_32x32x16_bf16 v[140:155], v[0:3], v[172:175], v[140:155]
    v_rcp_f32 v220, v220
    v_rcp_f32 v221, v221
    v_rcp_f32 v222, v222
    v_rcp_f32 v223, v223
    v_mfma_f32_32x32x16_bf16 v[140:155], v[4:7], v[176:179], v[140:155]
    v_rcp_f32 v224, v224
    v_rcp_f32 v225, v225
    v_rcp_f32 v226, v226
    v_rcp_f32 v227, v227
    v_pk_fma_f32 v[92:93], v[156:157], v[220:221], v[92:93]
    v_pk_fma_f32 v[94:95], v[158:159], v[222:223], v[94:95]
    v_pk_fma_f32 v[96:97], v[160:161], v[224:225], v[96:97]
    v_pk_fma_f32 v[98:99], v[162:163], v[226:227], v[98:99]
    v_pk_fma_f32 v[228:229], v[92:93], v[124:125], v[228:229]
    v_pk_fma_f32 v[230:231], v[94:95], v[126:127], v[230:231]
    v_pk_fma_f32 v[228:229], v[96:97], v[128:129], v[228:229]
    v_pk_fma_f32 v[230:231], v[98:99], v[130:131], v[230:231]
    v_mfma_f32_32x32x16_bf16 v[140:155], v[8:11], v[180:183], v[140:155]
    v_exp_f32 v220, v164
    v_exp_f32 v221, v165
    v_exp_f32 v222, v166
    v_exp_f32 v223, v167
    v_mfma_f32_32x32x16_bf16 v[140:155], v[12:15], v[184:187], v[140:155]
    v_exp_f32 v224, v168
    v_exp_f32 v225, v169
    v_exp_f32 v226, v170
    v_exp_f32 v227, v171
    v_pk_add_f32 v[220:221], v[220:221], 1.0 op_sel_hi:[1,0]
    v_pk_add_f32 v[222:223], v[222:223], 1.0 op_sel_hi:[1,0]
    v_pk_add_f32 v[224:225], v[224:225], 1.0 op_sel_hi:[1,0]
    v_pk_add_f32 v[226:227], v[226:227], 1.0 op_sel_hi:[1,0]
    v_rcp_f32 v220, v220
    v_rcp_f32 v221, v221
    v_rcp_f32 v222, v222
    v_rcp_f32 v223, v223
    v_rcp_f32 v224, v224
    v_rcp_f32 v225, v225
    v_rcp_f32 v226, v226
    v_rcp_f32 v227, v227
    v_pk_fma_f32 v[100:101], v[164:165], v[220:221], v[100:101]
    v_pk_fma_f32 v[102:103], v[166:167], v[222:223], v[102:103]
    v_pk_fma_f32 v[104:105], v[168:169], v[224:225], v[104:105]
    v_pk_fma_f32 v[106:107], v[170:171], v[226:227], v[106:107]
    v_pk_fma_f32 v[228:229], v[100:101], v[132:133], v[228:229]
    v_pk_fma_f32 v[230:231], v[102:103], v[134:135], v[230:231]
    v_pk_fma_f32 v[228:229], v[104:105], v[136:137], v[228:229]
    v_pk_fma_f32 v[230:231], v[106:107], v[138:139], v[230:231]
    v_pk_add_f32 v[228:229], v[228:229], v[230:231]
    s_cmp_eq_u64 s[36:37], 0
    v_add_f32 v247, v228, v229
    v_sub_f32 v248, v247, v243
    v_pk_fma_f32 v[244:245], v[236:237], v[248:249], v[244:245] op_sel_hi:[1,0,1]
    v_fmac_f32 v246, v238, v248
    s_mov_b64 exec, -1
    s_cbranch_scc1 K2_DONE
    v_mfma_f32_32x32x8_bf16 v[156:171], v[42:43], v[208:209], v[60:75]
    s_mov_b64 exec, s[36:37]
    v_exp_f32 v220, v140
    v_exp_f32 v221, v141
    v_exp_f32 v222, v142
    v_exp_f32 v223, v143
    v_mfma_f32_32x32x16_bf16 v[156:171], v[36:39], v[192:195], v[156:171]
    v_exp_f32 v224, v144
    v_exp_f32 v225, v145
    s_bitcmp1_b32 s5, 2
    s_cbranch_scc0 K2_VP9
    s_setprio 1
K2_VP9:
    s_waitcnt lgkmcnt(0)
    s_mov_b64 exec, -1
    s_add_u32 m0, s94, 0
    s_nop 0
    buffer_load_dwordx4 v[210:211], s[8:11], 0 idxen offen lds
    s_add_u32 m0, s94, 1024
    s_nop 0
    buffer_load_dwordx4 v[212:213], s[8:11], 0 idxen offen lds
    s_add_u32 m0, s94, 2048
    s_nop 0
    buffer_load_dwordx4 v[214:215], s[8:11], 0 idxen offen lds
    s_add_u32 m0, s94, 3072
    s_nop 0
    buffer_load_dwordx4 v[216:217], s[8:11], 0 idxen offen lds
    s_mov_b64 exec, s[36:37]
    s_setprio 0
    v_exp_f32 v226, v146
    v_exp_f32 v227, v147
    v_pk_add_f32 v[220:221], v[220:221], 1.0 op_sel_hi:[1,0]
    v_pk_add_f32 v[222:223], v[222:223], 1.0 op_sel_hi:[1,0]
    v_pk_add_f32 v[224:225], v[224:225], 1.0 op_sel_hi:[1,0]
    v_pk_add_f32 v[226:227], v[226:227], 1.0 op_sel_hi:[1,0]
    v_mfma_f32_32x32x16_bf16 v[156:171], v[16:19], v[172:175], v[156:171]
    v_rcp_f32 v220, v220
    v_rcp_f32 v221, v221
    v_rcp_f32 v222, v222
    v_rcp_f32 v223, v223
    v_mfma_f32_32x32x16_bf16 v[156:171], v[20:23], v[176:179], v[156:171]
    v_rcp_f32 v224, v224
    v_rcp_f32 v225, v225
    v_rcp_f32 v226, v226
    v_rcp_f32 v227, v227
    v_pk_fma_f32 v[76:77], v[140:141], v[220:221], v[76:77]
    v_pk_fma_f32 v[78:79], v[142:143], v[222:223], v[78:79]
    v_pk_fma_f32 v[80:81], v[144:145], v[224:225], v[80:81]
    v_pk_fma_f32 v[82:83], v[146:147], v[226:227], v[82:83]
    v_pk_mul_f32 v[228:229], v[76:77], v[108:109]
    v_pk_mul_f32 v[230:231], v[78:79], v[110:111]
    v_pk_fma_f32 v[228:229], v[80:81], v[112:113], v[228:229]
    v_pk_fma_f32 v[230:231], v[82:83], v[114:115], v[230:231]
    v_mfma_f32_32x32x16_bf16 v[156:171], v[24:27], v[180:183], v[156:171]
    v_exp_f32 v220, v148
    v_exp_f32 v221, v149
    v_exp_f32 v222, v150
    v_exp_f32 v223, v151
    v_mfma_f32_32x32x16_bf16 v[156:171], v[28:31], v[184:187], v[156:171]
    v_exp_f32 v224, v152
    v_exp_f32 v225, v153
    v_exp_f32 v226, v154
    s_mov_b64 exec, -1
    buffer_load_dwordx4 v[188:191], v[218:219], s[12:15], 0 idxen offen
    buffer_load_dwordx2 v[200:201], v203, s[16:19], 0 idxen
    s_mov_b64 exec, s[36:37]
    v_exp_f32 v227, v155
    s_waitcnt vmcnt(6)
    ds_read_b128 v[172:175], v251 offset:32768
    ds_read_b128 v[176:179], v252 offset:32768
    ds_read_b128 v[180:183], v253 offset:32768
    ds_read_b128 v[184:187], v254 offset:32768
    v_cmp_lt_u32_e64 s[30:31], s6, v235
    s_add_u32 s6, s6, 1
    v_lshlrev_b32 v236, 16, v204
    v_and_b32 v237, 0xffff0000, v204
    v_sub_f32 v238, v242, v205
    v_pk_add_f32 v[236:237], v[240:241], v[236:237] neg_lo:[0,1] neg_hi:[0,1]
    v_mul_f32 v208, v236, v236
    v_fmac_f32 v208, v237, v237
    v_fmac_f32 v208, v238, v238
    v_cvt_pk_bf16_f32 v208, v208, v208
    v_cndmask_b32_e64 v203, 0, v207, s[30:31]
    v_add_u32 v207, v207, v206
    ds_read_b32 v218, v203
    ds_read_u16 v203, v203 offset:4
    v_pk_add_f32 v[220:221], v[220:221], 1.0 op_sel_hi:[1,0]
    v_pk_add_f32 v[222:223], v[222:223], 1.0 op_sel_hi:[1,0]
    v_pk_add_f32 v[224:225], v[224:225], 1.0 op_sel_hi:[1,0]
    v_pk_add_f32 v[226:227], v[226:227], 1.0 op_sel_hi:[1,0]
    v_rcp_f32 v220, v220
    v_rcp_f32 v221, v221
    v_rcp_f32 v222, v222
    v_rcp_f32 v223, v223
    v_rcp_f32 v224, v224
    v_rcp_f32 v225, v225
    v_rcp_f32 v226, v226
    v_rcp_f32 v227, v227
    s_waitcnt lgkmcnt(0)
    s_mov_b64 exec, -1
    ds_bpermute_b32 v210, v239, v203 offset:0
    ds_bpermute_b32 v212, v239, v203 offset:32
    ds_bpermute_b32 v214, v239, v203 offset:64
    ds_bpermute_b32 v216, v239, v203 offset:96
    s_mov_b64 exec, s[36:37]
    v_pk_fma_f32 v[84:85], v[148:149], v[220:221], v[84:85]
    v_pk_fma_f32 v[86:87], v[150:151], v[222:223], v[86:87]
    v_pk_fma_f32 v[88:89], v[152:153], v[224:225], v[88:89]
    v_pk_fma_f32 v[90:91], v[154:155], v[226:227], v[90:91]
    v_pk_fma_f32 v[228:229], v[84:85], v[116:117], v[228:229]
    v_pk_fma_f32 v[230:231], v[86:87], v[118:119], v[230:231]
    v_pk_fma_f32 v[228:229], v[88:89], v[120:121], v[228:229]
    v_pk_fma_f32 v[230:231], v[90:91], v[122:123], v[230:231]
    v_mfma_f32_32x32x8_bf16 v[140:155], v[40:41], v[208:209], v[44:59]
    v_exp_f32 v220, v156
    v_exp_f32 v221, v157
    v_exp_f32 v222, v158
    v_exp_f32 v223, v159
    v_mfma_f32_32x32x16_bf16 v[140:155], v[32:35], v[196:199], v[140:155]
    v_exp_f32 v224, v160
    v_exp_f32 v225, v161
    v_exp_f32 v226, v162
    v_exp_f32 v227, v163
    v_pk_add_f32 v[220:221], v[220:221], 1.0 op_sel_hi:[1,0]
    v_pk_add_f32 v[222:223], v[222:223], 1.0 op_sel_hi:[1,0]
    v_pk_add_f32 v[224:225], v[224:225], 1.0 op_sel_hi:[1,0]
    v_pk_add_f32 v[226:227], v[226:227], 1.0 op_sel_hi:[1,0]
    v_mfma_f32_32x32x16_bf16 v[140:155], v[0:3], v[172:175], v[140:155]
    v_rcp_f32 v220, v220
    v_rcp_f32 v221, v221
    v_rcp_f32 v222, v222
    v_rcp_f32 v223, v223
    v_mfma_f32_32x32x16_bf16 v[140:155], v[4:7], v[176:179], v[140:155]
    v_rcp_f32 v224, v224
    v_rcp_f32 v225, v225
    v_rcp_f32 v226, v226
    v_rcp_f32 v227, v227
    v_pk_fma_f32 v[92:93], v[156:157], v[220:221], v[92:93]
    v_pk_fma_f32 v[94:95], v[158:159], v[222:223], v[94:95]
    v_pk_fma_f32 v[96:97], v[160:161], v[224:225], v[96:97]
    v_pk_fma_f32 v[98:99], v[162:163], v[226:227], v[98:99]
    v_pk_fma_f32 v[228:229], v[92:93], v[124:125], v[228:229]
    v_pk_fma_f32 v[230:231], v[94:95], v[126:127], v[230:231]
    v_pk_fma_f32 v[228:229], v[96:97], v[128:129], v[228:229]
    v_pk_fma_f32 v[230:231], v[98:99], v[130:131], v[230:231]
    v_mfma_f32_32x32x16_bf16 v[140:155], v[8:11], v[180:183], v[140:155]
    v_exp_f32 v220, v164
    v_exp_f32 v221, v165
    v_exp_f32 v222, v166
    v_exp_f32 v223, v167
    v_mfma_f32_32x32x16_bf16 v[140:155], v[12:15], v[184:187], v[140:155]
    v_exp_f32 v224, v168
    v_exp_f32 v225, v169
    v_exp_f32 v226, v170
    v_exp_f32 v227, v171
    v_pk_add_f32 v[220:221], v[220:221], 1.0 op_sel_hi:[1,0]
    v_pk_add_f32 v[222:223], v[222:223], 1.0 op_sel_hi:[1,0]
    v_pk_add_f32 v[224:225], v[224:225], 1.0 op_sel_hi:[1,0]
    v_pk_add_f32 v[226:227], v[226:227], 1.0 op_sel_hi:[1,0]
    v_rcp_f32 v220, v220
    v_rcp_f32 v221, v221
    v_rcp_f32 v222, v222
    v_rcp_f32 v223, v223
    v_rcp_f32 v224, v224
    v_rcp_f32 v225, v225
    v_rcp_f32 v226, v226
    v_rcp_f32 v227, v227
    v_pk_fma_f32 v[100:101], v[164:165], v[220:221], v[100:101]
    v_pk_fma_f32 v[102:103], v[166:167], v[222:223], v[102:103]
    v_pk_fma_f32 v[104:105], v[168:169], v[224:225], v[104:105]
    v_pk_fma_f32 v[106:107], v[170:171], v[226:227], v[106:107]
    v_pk_fma_f32 v[228:229], v[100:101], v[132:133], v[228:229]
    v_pk_fma_f32 v[230:231], v[102:103], v[134:135], v[230:231]
    v_pk_fma_f32 v[228:229], v[104:105], v[136:137], v[228:229]
    v_pk_fma_f32 v[230:231], v[106:107], v[138:139], v[230:231]
    v_pk_add_f32 v[228:229], v[228:229], v[230:231]
    s_cmp_eq_u64 s[38:39], 0
    v_add_f32 v243, v228, v229
    v_sub_f32 v248, v243, v247
    v_pk_fma_f32 v[244:245], v[232:233], v[248:249], v[244:245] op_sel_hi:[1,0,1]
    v_fmac_f32 v246, v234, v248
    s_mov_b64 exec, -1
    s_cbranch_scc1 K2_DONE
    v_mfma_f32_32x32x8_bf16 v[156:171], v[42:43], v[208:209], v[60:75]
    s_mov_b64 exec, s[38:39]
    v_exp_f32 v220, v140
    v_exp_f32 v221, v141
    v_exp_f32 v222, v142
    v_exp_f32 v223, v143
    v_mfma_f32_32x32x16_bf16 v[156:171], v[36:39], v[196:199], v[156:171]
    v_exp_f32 v224, v144
    v_exp_f32 v225, v145
    s_bitcmp1_b32 s5, 2
    s_cbranch_scc0 K2_VP11
    s_setprio 1
K2_VP11:
    s_waitcnt lgkmcnt(0)
    s_mov_b64 exec, -1
    s_add_u32 m0, s94, 32768
    s_nop 0
    buffer_load_dwordx4 v[210:211], s[8:11], 0 idxen offen lds
    s_add_u32 m0, s94, 33792
    s_nop 0
    buffer_load_dwordx4 v[212:213], s[8:11], 0 idxen offen lds
    s_add_u32 m0, s94, 34816
    s_nop 0
    buffer_load_dwordx4 v[214:215], s[8:11], 0 idxen offen lds
    s_add_u32 m0, s94, 35840
    s_nop 0
    buffer_load_dwordx4 v[216:217], s[8:11], 0 idxen offen lds
    s_mov_b64 exec, s[38:39]
    s_setprio 0
    v_exp_f32 v226, v146
    v_exp_f32 v227, v147
    v_pk_add_f32 v[220:221], v[220:221], 1.0 op_sel_hi:[1,0]
    v_pk_add_f32 v[222:223], v[222:223], 1.0 op_sel_hi:[1,0]
    v_pk_add_f32 v[224:225], v[224:225], 1.0 op_sel_hi:[1,0]
    v_pk_add_f32 v[226:227], v[226:227], 1.0 op_sel_hi:[1,0]
    v_mfma_f32_32x32x16_bf16 v[156:171], v[16:19], v[172:175], v[156:171]
    v_rcp_f32 v220, v220
    v_rcp_f32 v221, v221
    v_rcp_f32 v222, v222
    v_rcp_f32 v223, v223
    v_mfma_f32_32x32x16_bf16 v[156:171], v[20:23], v[176:179], v[156:171]
    v_rcp_f32 v224, v224
    v_rcp_f32 v225, v225
    v_rcp_f32 v226, v226
    v_rcp_f32 v227, v227
    v_pk_fma_f32 v[76:77], v[140:141], v[220:221], v[76:77]
    v_pk_fma_f32 v[78:79], v[142:143], v[222:223], v[78:79]
    v_pk_fma_f32 v[80:81], v[144:145], v[224:225], v[80:81]
    v_pk_fma_f32 v[82:83], v[146:147], v[226:227], v[82:83]
    v_pk_mul_f32 v[228:229], v[76:77], v[108:109]
    v_pk_mul_f32 v[230:231], v[78:79], v[110:111]
    v_pk_fma_f32 v[228:229], v[80:81], v[112:113], v[228:229]
    v_pk_fma_f32 v[230:231], v[82:83], v[114:115], v[230:231]
    v_mfma_f32_32x32x16_bf16 v[156:171], v[24:27], v[180:183], v[156:171]
    v_exp_f32 v220, v148
    v_exp_f32 v221, v149
    v_exp_f32 v222, v150
    v_exp_f32 v223, v151
    v_mfma_f32_32x32x16_bf16 v[156:171], v[28:31], v[184:187], v[156:171]
    v_exp_f32 v224, v152
    v_exp_f32 v225, v153
    v_exp_f32 v226, v154
    s_mov_b64 exec, -1
    buffer_load_dwordx4 v[192:195], v[218:219], s[12:15], 0 idxen offen
    buffer_load_dwordx2 v[204:205], v203, s[16:19], 0 idxen
    s_mov_b64 exec, s[38:39]
    v_exp_f32 v227, v155
    s_waitcnt vmcnt(6)
    ds_read_b128 v[172:175], v251 offset:0
    ds_read_b128 v[176:179], v252 offset:0
    ds_read_b128 v[180:183], v253 offset:0
    ds_read_b128 v[184:187], v254 offset:0
    v_cmp_lt_u32_e64 s[32:33], s6, v235
    s_add_u32 s6, s6, 1
    v_lshlrev_b32 v232, 16, v200
    v_and_b32 v233, 0xffff0000, v200
    v_sub_f32 v234, v242, v201
    v_pk_add_f32 v[232:233], v[240:241], v[232:233] neg_lo:[0,1] neg_hi:[0,1]
    v_mul_f32 v208, v232, v232
    v_fmac_f32 v208, v233, v233
    v_fmac_f32 v208, v234, v234
    v_cvt_pk_bf16_f32 v208, v208, v208
    v_cndmask_b32_e64 v203, 0, v207, s[32:33]
    v_add_u32 v207, v207, v206
    ds_read_b32 v218, v203
    ds_read_u16 v203, v203 offset:4
    v_pk_add_f32 v[220:221], v[220:221], 1.0 op_sel_hi:[1,0]
    v_pk_add_f32 v[222:223], v[222:223], 1.0 op_sel_hi:[1,0]
    v_pk_add_f32 v[224:225], v[224:225], 1.0 op_sel_hi:[1,0]
    v_pk_add_f32 v[226:227], v[226:227], 1.0 op_sel_hi:[1,0]
    v_rcp_f32 v220, v220
    v_rcp_f32 v221, v221
    v_rcp_f32 v222, v222
    v_rcp_f32 v223, v223
    v_rcp_f32 v224, v224
    v_rcp_f32 v225, v225
    v_rcp_f32 v226, v226
    v_rcp_f32 v227, v227
    s_waitcnt lgkmcnt(0)
    s_mov_b64 exec, -1
    ds_bpermute_b32 v210, v239, v203 offset:0
    ds_bpermute_b32 v212, v239, v203 offset:32
    ds_bpermute_b32 v214, v239, v203 offset:64
    ds_bpermute_b32 v216, v239, v203 offset:96
    s_mov_b64 exec, s[38:39]
    v_pk_fma_f32 v[84:85], v[148:149], v[220:221], v[84:85]
    v_pk_fma_f32 v[86:87], v[150:151], v[222:223], v[86:87]
    v_pk_fma_f32 v[88:89], v[152:153], v[224:225], v[88:89]
    v_pk_fma_f32 v[90:91], v[154:155], v[226:227], v[90:91]
    v_pk_fma_f32 v[228:229], v[84:85], v[116:117], v[228:229]
    v_pk_fma_f32 v[230:231], v[86:87], v[118:119], v[230:231]
    v_pk_fma_f32 v[228:229], v[88:89], v[120:121], v[228:229]
    v_pk_fma_f32 v[230:231], v[90:91], v[122:123], v[230:231]
    v_mfma_f32_32x32x8_bf16 v[140:155], v[40:41], v[208:209], v[44:59]
    v_exp_f32 v220, v156
    v_exp_f32 v221, v157
    v_exp_f32 v222, v158
    v_exp_f32 v223, v159
    v_mfma_f32_32x32x16_bf16 v[140:155], v[32:35], v[188:191], v[140:155]
    v_exp_f32 v224, v160
    v_exp_f32 v225, v161
    v_exp_f32 v226, v162
    v_exp_f32 v227, v163
    v_pk_add_f32 v[220:221], v[220:221], 1.0 op_sel_hi:[1,0]
    v_pk_add_f32 v[222:223], v[222:223], 1.0 op_sel_hi:[1,0]
    v_pk_add_f32 v[224:225], v[224:225], 1.0 op_sel_hi:[1,0]
    v_pk_add_f32 v[226:227], v[226:227], 1.0 op_sel_hi:[1,0]
    v_mfma_f32_32x32x16_bf16 v[140:155], v[0:3], v[172:175], v[140:155]
    v_rcp_f32 v220, v220
    v_rcp_f32 v221, v221
    v_rcp_f32 v222, v222
    v_rcp_f32 v223, v223
    v_mfma_f32_32x32x16_bf16 v[140:155], v[4:7], v[176:179], v[140:155]
    v_rcp_f32 v224, v224
    v_rcp_f32 v225, v225
    v_rcp_f32 v226, v226
    v_rcp_f32 v227, v227
    v_pk_fma_f32 v[92:93], v[156:157], v[220:221], v[92:93]
    v_pk_fma_f32 v[94:95], v[158:159], v[222:223], v[94:95]
    v_pk_fma_f32 v[96:97], v[160:161], v[224:225], v[96:97]
    v_pk_fma_f32 v[98:99], v[162:163], v[226:227], v[98:99]
    v_pk_fma_f32 v[228:229], v[92:93], v[124:125], v[228:229]
    v_pk_fma_f32 v[230:231], v[94:95], v[126:127], v[230:231]
    v_pk_fma_f32 v[228:229], v[96:97], v[128:129], v[228:229]
    v_pk_fma_f32 v[230:231], v[98:99], v[130:131], v[230:231]
    v_mfma_f32_32x32x16_bf16 v[140:155], v[8:11], v[180:183], v[140:155]
    v_exp_f32 v220, v164
    v_exp_f32 v221, v165
    v_exp_f32 v222, v166
    v_exp_f32 v223, v167
    v_mfma_f32_32x32x16_bf16 v[140:155], v[12:15], v[184:187], v[140:155]
    v_exp_f32 v224, v168
    v_exp_f32 v225, v169
    v_exp_f32 v226, v170
    v_exp_f32 v227, v171
    v_pk_add_f32 v[220:221], v[220:221], 1.0 op_sel_hi:[1,0]
    v_pk_add_f32 v[222:223], v[222:223], 1.0 op_sel_hi:[1,0]
    v_pk_add_f32 v[224:225], v[224:225], 1.0 op_sel_hi:[1,0]
    v_pk_add_f32 v[226:227], v[226:227], 1.0 op_sel_hi:[1,0]
    v_rcp_f32 v220, v220
    v_rcp_f32 v221, v221
    v_rcp_f32 v222, v222
    v_rcp_f32 v223, v223
    v_rcp_f32 v224, v224
    v_rcp_f32 v225, v225
    v_rcp_f32 v226, v226
    v_rcp_f32 v227, v227
    v_pk_fma_f32 v[100:101], v[164:165], v[220:221], v[100:101]
    v_pk_fma_f32 v[102:103], v[166:167], v[222:223], v[102:103]
    v_pk_fma_f32 v[104:105], v[168:169], v[224:225], v[104:105]
    v_pk_fma_f32 v[106:107], v[170:171], v[226:227], v[106:107]
    v_pk_fma_f32 v[228:229], v[100:101], v[132:133], v[228:229]
    v_pk_fma_f32 v[230:231], v[102:103], v[134:135], v[230:231]
    v_pk_fma_f32 v[228:229], v[104:105], v[136:137], v[228:229]
    v_pk_fma_f32 v[230:231], v[106:107], v[138:139], v[230:231]
    v_pk_add_f32 v[228:229], v[228:229], v[230:231]
    s_cmp_eq_u64 s[28:29], 0
    v_add_f32 v247, v228, v229
    v_sub_f32 v248, v247, v243
    v_pk_fma_f32 v[244:245], v[236:237], v[248:249], v[244:245] op_sel_hi:[1,0,1]
    v_fmac_f32 v246, v238, v248
    s_mov_b64 exec, -1
    s_cbranch_scc0 K2_LOOP
K2_DONE:
    v_and_b32 v203, 63, v250
    s_or_b32 s95, s7, s93
    s_cselect_b32 s97, 3, s97
    s_cmp_gt_u32 s97, 2
    v_lshlrev_b32 v203, 4, v203
    s_cbranch_scc1 K2_SLOW
    v_bfe_u32 v220, v249, 1, 3
    v_lshlrev_b32 v220, 4, v220
    v_lshlrev_b32 v221, 2, v219
    v_xor_b32 v220, v220, v221
    v_lshl_add_u32 v220, v249, 7, v220
    v_add_u32 v220, 100352, v220
    v_xor_b32 v221, 16, v220
    v_xor_b32 v222, 32, v220
    v_xor_b32 v223, 48, v220
    ds_read_b128 v[172:175], v220
    ds_read_b128 v[176:179], v221
    ds_read_b128 v[180:183], v222
    ds_read_b128 v[184:187], v223
    v_add_u32 v220, 125952, v203
    v_cmp_eq_u32_e64 s[46:47], 16, v206
    v_cmp_eq_u32_e64 s[44:45], 8, v206
    v_add_u32 v218, s4, v249
    ds_read_b128 v[0:3], v220 offset:32768
    ds_read_b128 v[4:7], v220 offset:33792
    ds_read_b128 v[8:11], v220 offset:34816
    ds_read_b128 v[12:15], v220 offset:35840
    ds_read_b128 v[16:19], v220 offset:0
    ds_read_b128 v[20:23], v220 offset:1024
    ds_read_b128 v[24:27], v220 offset:2048
    ds_read_b128 v[28:31], v220 offset:3072
    ds_read_b128 v[44:47], v220 offset:4096
    ds_read_b128 v[48:51], v220 offset:5120
    ds_read_b128 v[52:55], v220 offset:6144
    ds_read_b128 v[56:59], v220 offset:7168
    ds_read_b128 v[60:63], v220 offset:8192
    ds_read_b128 v[64:67], v220 offset:9216
    ds_read_b128 v[68:71], v220 offset:10240
    ds_read_b128 v[72:75], v220 offset:11264
    s_mov_b64 exec, s[46:47]
    s_and_b32 s46, s46, 0x55555555
    s_or_b32 s44, s44, s46
    s_mov_b32 s98, s94
    v_add_f32_dpp v244, v244, v244 quad_perm:[1,0,3,2] row_mask:0xf bank_mask:0xf
    v_add_f32_dpp v245, v245, v245 quad_perm:[1,0,3,2] row_mask:0xf bank_mask:0xf
    v_add_f32_dpp v246, v246, v246 quad_perm:[1,0,3,2] row_mask:0xf bank_mask:0xf
    v_add_f32_dpp v76, v76, v76 quad_perm:[1,0,3,2] row_mask:0xf bank_mask:0xf
    v_add_f32_dpp v77, v77, v77 quad_perm:[1,0,3,2] row_mask:0xf bank_mask:0xf
    v_add_f32_dpp v78, v78, v78 quad_perm:[1,0,3,2] row_mask:0xf bank_mask:0xf
    v_add_f32_dpp v79, v79, v79 quad_perm:[1,0,3,2] row_mask:0xf bank_mask:0xf
    v_add_f32_dpp v80, v80, v80 quad_perm:[1,0,3,2] row_mask:0xf bank_mask:0xf
    v_add_f32_dpp v81, v81, v81 quad_perm:[1,0,3,2] row_mask:0xf bank_mask:0xf
    v_add_f32_dpp v82, v82, v82 quad_perm:[1,0,3,2] row_mask:0xf bank_mask:0xf
    v_add_f32_dpp v83, v83, v83 quad_perm:[1,0,3,2] row_mask:0xf bank_mask:0xf
    v_add_f32_dpp v84, v84, v84 quad_perm:[1,0,3,2] row_mask:0xf bank_mask:0xf
    v_add_f32_dpp v85, v85, v85 quad_perm:[1,0,3,2] row_mask:0xf bank_mask:0xf
    v_add_f32_dpp v86, v86, v86 quad_perm:[1,0,3,2] row_mask:0xf bank_mask:0xf
    v_add_f32_dpp v87, v87, v87 quad_perm:[1,0,3,2] row_mask:0xf bank_mask:0xf
    v_add_f32_dpp v88, v88, v88 quad_perm:[1,0,3,2] row_mask:0xf bank_mask:0xf
    v_add_f32_dpp v89, v89, v89 quad_perm:[1,0,3,2] row_mask:0xf bank_mask:0xf
    v_add_f32_dpp v90, v90, v90 quad_perm:[1,0,3,2] row_mask:0xf bank_mask:0xf
    v_add_f32_dpp v91, v91, v91 quad_perm:[1,0,3,2] row_mask:0xf bank_mask:0xf
    v_add_f32_dpp v92, v92, v92 quad_perm:[1,0,3,2] row_mask:0xf bank_mask:0xf
    v_add_f32_dpp v93, v93, v93 quad_perm:[1,0,3,2] row_mask:0xf bank_mask:0xf
    v_add_f32_dpp v94, v94, v94 quad_perm:[1,0,3,2] row_mask:0xf bank_mask:0xf
    v_add_f32_dpp v95, v95, v95 quad_perm:[1,0,3,2] row_mask:0xf bank_mask:0xf
    v_add_f32_dpp v96, v96, v96 quad_perm:[1,0,3,2] row_mask:0xf bank_mask:0xf
    v_add_f32_dpp v97, v97, v97 quad_perm:[1,0,3,2] row_mask:0xf bank_mask:0xf
    v_add_f32_dpp v98, v98, v98 quad_perm:[1,0,3,2] row_mask:0xf bank_mask:0xf
    v_add_f32_dpp v99, v99, v99 quad_perm:[1,0,3,2] row_mask:0xf bank_mask:0xf
    v_add_f32_dpp v100, v100, v100 quad_perm:[1,0,3,2] row_mask:0xf bank_mask:0xf
    v_add_f32_dpp v101, v101, v101 quad_perm:[1,0,3,2] row_mask:0xf bank_mask:0xf
    v_add_f32_dpp v102, v102, v102 quad_perm:[1,0,3,2] row_mask:0xf bank_mask:0xf
    v_add_f32_dpp v103, v103, v103 quad_perm:[1,0,3,2] row_mask:0xf bank_mask:0xf
    v_add_f32_dpp v104, v104, v104 quad_perm:[1,0,3,2] row_mask:0xf bank_mask:0xf
    v_add_f32_dpp v105, v105, v105 quad_perm:[1,0,3,2] row_mask:0xf bank_mask:0xf
    v_add_f32_dpp v106, v106, v106 quad_perm:[1,0,3,2] row_mask:0xf bank_mask:0xf
    v_add_f32_dpp v107, v107, v107 quad_perm:[1,0,3,2] row_mask:0xf bank_mask:0xf
    s_mov_b64 exec, -1
    v_mov_b32 v224, v244
    v_mov_b32 v225, v245
    v_mov_b32 v226, v246
    s_nop 1
    v_permlane32_swap_b32 v224, v244
    v_permlane32_swap_b32 v225, v245
    v_permlane32_swap_b32 v226, v246
    s_nop 1
    v_add_f32 v244, v244, v224
    v_add_f32 v245, v245, v225
    v_add_f32 v246, v246, v226
    s_branch K2_TAIL
K2_EMPTY:
    s_waitcnt vmcnt(0) lgkmcnt(0)
    v_mov_b32 v244, 0
    v_mov_b32 v245, 0
    v_mov_b32 v246, 0
    v_mov_b32 v76, 0
    v_mov_b32 v77, 0
    v_mov_b32 v78, 0
    v_mov_b32 v79, 0
    v_mov_b32 v80, 0
    v_mov_b32 v81, 0
    v_mov_b32 v82, 0
    v_mov_b32 v83, 0
    v_mov_b32 v84, 0
    v_mov_b32 v85, 0
    v_mov_b32 v86, 0
    v_mov_b32 v87, 0
    v_mov_b32 v88, 0
    v_mov_b32 v89, 0
    v_mov_b32 v90, 0
    v_mov_b32 v91, 0
    v_mov_b32 v92, 0
    v_mov_b32 v93, 0
    v_mov_b32 v94, 0
    v_mov_b32 v95, 0
    v_mov_b32 v96, 0
    v_mov_b32 v97, 0
    v_mov_b32 v98, 0
    v_mov_b32 v99, 0
    v_mov_b32 v100, 0
    v_mov_b32 v101, 0
    v_mov_b32 v102, 0
    v_mov_b32 v103, 0
    v_mov_b32 v104, 0
    v_mov_b32 v105, 0
    v_mov_b32 v106, 0
    v_mov_b32 v107, 0
    v_mov_b32 v242, v241
    v_and_b32 v241, 0xffff0000, v240
    v_lshlrev_b32 v240, 16, v240
    s_branch K2_DONE
K2_SLOW:
    v_and_b32 v223, 31, v250
    v_lshlrev_b32 v220, 2, v219
    v_xor_b32 v220, v220, v251
    v_lshl_add_u32 v220, v219, 11, v220
    s_lshl_b32 s95, s100, 10
    s_add_u32 s95, s95, 129024
    v_lshl_add_u32 v221, v223, 5, v219
    v_add_u32 v221, s95, v221
    s_lshl_b32 s95, s5, 5
    v_add_u32 v223, s95, v223
    v_add_u32 v218, s4, v223
    v_min_u32 v222, 49999, v218
    s_waitcnt vmcnt(0)
    buffer_load_dwordx2 v[240:241], v222, s[16:19], 0 idxen
    v_xor_b32 v222, 0, v220
    ds_write_b128 v222, v[76:79]
    v_xor_b32 v222, 16, v220
    ds_write_b128 v222, v[80:83]
    v_xor_b32 v222, 32, v220
    ds_write_b128 v222, v[84:87]
    v_xor_b32 v222, 48, v220
    ds_write_b128 v222, v[88:91]
    v_xor_b32 v222, 64, v220
    ds_write_b128 v222, v[92:95]
    v_xor_b32 v222, 80, v220
    ds_write_b128 v222, v[96:99]
    v_xor_b32 v222, 96, v220
    ds_write_b128 v222, v[100:103]
    v_xor_b32 v222, 112, v220
    ds_write_b128 v222, v[104:107]
    ds_write_b128 v221, v[244:247]
    v_lshlrev_b32 v220, 2, v223
    ds_read_b32 v235, v220 offset:32768
    s_sub_u32 s99, s101, s94
    v_add_u32 v251, s99, v251
    v_add_u32 v252, s99, v252
    v_add_u32 v253, s99, v253
    v_add_u32 v254, s99, v254
    ds_read_b128 v[172:175], v251 offset:0
    ds_read_b128 v[176:179], v252 offset:0
    ds_read_b128 v[180:183], v253 offset:0
    ds_read_b128 v[184:187], v254 offset:0
    v_mov_b32 v76, 0
    v_mov_b32 v77, 0
    v_mov_b32 v78, 0
    v_mov_b32 v79, 0
    v_mov_b32 v80, 0
    v_mov_b32 v81, 0
    v_mov_b32 v82, 0
    v_mov_b32 v83, 0
    v_mov_b32 v84, 0
    v_mov_b32 v85, 0
    v_mov_b32 v86, 0
    v_mov_b32 v87, 0
    v_mov_b32 v88, 0
    v_mov_b32 v89, 0
    v_mov_b32 v90, 0
    v_mov_b32 v91, 0
    v_mov_b32 v92, 0
    v_mov_b32 v93, 0
    v_mov_b32 v94, 0
    v_mov_b32 v95, 0
    v_mov_b32 v96, 0
    v_mov_b32 v97, 0
    v_mov_b32 v98, 0
    v_mov_b32 v99, 0
    v_mov_b32 v100, 0
    v_mov_b32 v101, 0
    v_mov_b32 v102, 0
    v_mov_b32 v103, 0
    v_mov_b32 v104, 0
    v_mov_b32 v105, 0
    v_mov_b32 v106, 0
    v_mov_b32 v107, 0
    v_mov_b32 v244, 0
    v_mov_b32 v245, 0
    v_mov_b32 v246, 0
    s_lshl_b32 s99, s3, 8
    v_add_u32 v249, s99, v223
    v_mul_u32_u24 v249, 272, v249
    v_lshl_add_u32 v243, v219, 3, v249
    s_mov_b32 s99, 7602176
    s_cmp_eq_u32 s7, 0
    s_cbranch_scc1 K2_NOLD
    buffer_load_dwordx4 v[76:79], v243, s[20:23], s99 offen offset:0 sc0 sc1
    buffer_load_dwordx4 v[80:83], v243, s[20:23], s99 offen offset:16 sc0 sc1
    buffer_load_dwordx4 v[84:87], v243, s[20:23], s99 offen offset:32 sc0 sc1
    buffer_load_dwordx4 v[88:91], v243, s[20:23], s99 offen offset:48 sc0 sc1
    buffer_load_dwordx4 v[92:95], v243, s[20:23], s99 offen offset:64 sc0 sc1
    buffer_load_dwordx4 v[96:99], v243, s[20:23], s99 offen offset:80 sc0 sc1
    buffer_load_dwordx4 v[100:103], v243, s[20:23], s99 offen offset:96 sc0 sc1
    buffer_load_dwordx4 v[104:107], v243, s[20:23], s99 offen offset:112 sc0 sc1
    buffer_load_dwordx3 v[244:246], v249, s[20:23], s99 offen offset:256 sc0 sc1
    s_waitcnt vmcnt(0)
K2_NOLD:
    s_waitcnt lgkmcnt(0)
    v_and_b32 v207, 0xffff, v235
    v_lshrrev_b32 v235, 16, v235
    v_lshlrev_b32 v247, 11, v219
    v_add_u32 v247, 34816, v247
    v_add_u32 v220, 138240, v203
    v_cmp_lt_u32 vcc, 0, v235
    s_barrier
    s_cbranch_vccz K2_GDONE
K2_GLOOP:
    s_mov_b64 exec, vcc
    v_bfe_u32 v221, v207, 3, 3
    v_lshlrev_b32 v221, 4, v221
    v_lshl_add_u32 v221, v207, 5, v221
    v_add_u32 v221, v247, v221
    v_xor_b32 v222, 0, v221
    ds_read_b128 v[140:143], v222
    v_xor_b32 v222, 16, v221
    ds_read_b128 v[144:147], v222
    v_xor_b32 v222, 32, v221
    ds_read_b128 v[148:151], v222
    v_xor_b32 v222, 48, v221
    ds_read_b128 v[152:155], v222
    v_xor_b32 v222, 64, v221
    ds_read_b128 v[156:159], v222
    v_xor_b32 v222, 80, v221
    ds_read_b128 v[160:163], v222
    v_xor_b32 v222, 96, v221
    ds_read_b128 v[164:167], v222
    v_xor_b32 v222, 112, v221
    ds_read_b128 v[168:171], v222
    v_lshlrev_b32 v222, 3, v207
    v_add_u32 v222, 129024, v222
    ds_read_b128 v[188:191], v222
    ds_read_b128 v[192:195], v222 offset:16
    v_add_u32 v207, 4, v207
    v_subrev_u32 v235, 1, v235
    v_cmp_lt_u32 vcc, 0, v235
    s_waitcnt lgkmcnt(9)
    v_pk_add_f32 v[76:77], v[76:77], v[140:141]
    v_pk_add_f32 v[78:79], v[78:79], v[142:143]
    s_waitcnt lgkmcnt(8)
    v_pk_add_f32 v[80:81], v[80:81], v[144:145]
    v_pk_add_f32 v[82:83], v[82:83], v[146:147]
    s_waitcnt lgkmcnt(7)
    v_pk_add_f32 v[84:85], v[84:85], v[148:149]
    v_pk_add_f32 v[86:87], v[86:87], v[150:151]
    s_waitcnt lgkmcnt(6)
    v_pk_add_f32 v[88:89], v[88:89], v[152:153]
    v_pk_add_f32 v[90:91], v[90:91], v[154:155]
    s_waitcnt lgkmcnt(5)
    v_pk_add_f32 v[92:93], v[92:93], v[156:157]
    v_pk_add_f32 v[94:95], v[94:95], v[158:159]
    s_waitcnt lgkmcnt(4)
    v_pk_add_f32 v[96:97], v[96:97], v[160:161]
    v_pk_add_f32 v[98:99], v[98:99], v[162:163]
    s_waitcnt lgkmcnt(3)
    v_pk_add_f32 v[100:101], v[100:101], v[164:165]
    v_pk_add_f32 v[102:103], v[102:103], v[166:167]
    s_waitcnt lgkmcnt(2)
    v_pk_add_f32 v[104:105], v[104:105], v[168:169]
    v_pk_add_f32 v[106:107], v[106:107], v[170:171]
    s_waitcnt lgkmcnt(0)
    v_pk_add_f32 v[244:245], v[244:245], v[188:189]
    v_add_f32 v246, v246, v190
    v_pk_add_f32 v[244:245], v[244:245], v[192:193]
    v_add_f32 v246, v246, v194
    s_cbranch_vccnz K2_GLOOP
    s_mov_b64 exec, -1
K2_GDONE:
    s_cmp_eq_u32 s93, 0
    s_cbranch_scc1 K2_EPI
    buffer_store_dwordx4 v[76:79], v243, s[20:23], s99 offen offset:0
    buffer_store_dwordx4 v[80:83], v243, s[20:23], s99 offen offset:16
    buffer_store_dwordx4 v[84:87], v243, s[20:23], s99 offen offset:32
    buffer_store_dwordx4 v[88:91], v243, s[20:23], s99 offen offset:48
    buffer_store_dwordx4 v[92:95], v243, s[20:23], s99 offen offset:64
    buffer_store_dwordx4 v[96:99], v243, s[20:23], s99 offen offset:80
    buffer_store_dwordx4 v[100:103], v243, s[20:23], s99 offen offset:96
    buffer_store_dwordx4 v[104:107], v243, s[20:23], s99 offen offset:112
    buffer_store_dwordx3 v[244:246], v249, s[20:23], s99 offen offset:256
    s_add_u32 s7, s7, s92
    s_waitcnt vmcnt(0)
    s_barrier
    s_branch K2_TOP
K2_EPI:
    s_cmp_ge_u32 s5, 6
    s_cbranch_scc1 K2_NWH2
    s_mul_i32 s95, s5, 2048
    s_add_u32 m0, s95, 138240
    s_add_u32 s95, s95, 7561216
    buffer_load_dwordx4 v203, s[20:23], s95 offen offset:0 lds
    buffer_load_dwordx4 v203, s[20:23], s95 offen offset:1024 lds
K2_NWH2:
    s_lshl_b32 s95, s5, 5
    s_cmp_ge_u32 s95, s96
    s_waitcnt vmcnt(0)
    s_barrier
    s_cbranch_scc1 K2_END0
    ds_read_b128 v[0:3], v220 offset:20480
    ds_read_b128 v[4:7], v220 offset:21504
    ds_read_b128 v[8:11], v220 offset:22528
    ds_read_b128 v[12:15], v220 offset:23552
    ds_read_b128 v[16:19], v220 offset:0
    ds_read_b128 v[20:23], v220 offset:1024
    ds_read_b128 v[24:27], v220 offset:2048
    ds_read_b128 v[28:31], v220 offset:3072
    ds_read_b128 v[44:47], v220 offset:4096
    ds_read_b128 v[48:51], v220 offset:5120
    ds_read_b128 v[52:55], v220 offset:6144
    ds_read_b128 v[56:59], v220 offset:7168
    ds_read_b128 v[60:63], v220 offset:8192
    ds_read_b128 v[64:67], v220 offset:9216
    ds_read_b128 v[68:71], v220 offset:10240
    ds_read_b128 v[72:75], v220 offset:11264
    v_cmp_gt_u32_e64 s[44:45], s96, v223
    s_mov_b32 s98, s101
    s_waitcnt vmcnt(0)
    v_mov_b32 v242, v241
    v_and_b32 v241, 0xffff0000, v240
    v_lshlrev_b32 v240, 16, v240
K2_TAIL:
    v_add_u32 v235, s98, v203
    v_lshlrev_b32 v203, 7, v218
    v_cndmask_b32_e64 v203, 2.0, v203, s[44:45]
    s_waitcnt lgkmcnt(8)
    v_mfma_f32_32x32x16_bf16 v[140:155], v[0:3], v[172:175], 0
    v_cvt_pk_bf16_f32 v108, v76, v77
    v_cvt_pk_bf16_f32 v109, v78, v79
    v_mfma_f32_32x32x16_bf16 v[156:171], v[16:19], v[172:175], 0
    v_cvt_pk_bf16_f32 v110, v80, v81
    v_cvt_pk_bf16_f32 v111, v82, v83
    v_mfma_f32_32x32x16_bf16 v[140:155], v[4:7], v[176:179], v[140:155]
    v_cvt_pk_bf16_f32 v112, v84, v85
    v_cvt_pk_bf16_f32 v113, v86, v87
    v_mfma_f32_32x32x16_bf16 v[156:171], v[20:23], v[176:179], v[156:171]
    v_cvt_pk_bf16_f32 v114, v88, v89
    v_cvt_pk_bf16_f32 v115, v90, v91
    v_mfma_f32_32x32x16_bf16 v[140:155], v[8:11], v[180:183], v[140:155]
    v_cvt_pk_bf16_f32 v116, v92, v93
    v_cvt_pk_bf16_f32 v117, v94, v95
    v_mfma_f32_32x32x16_bf16 v[156:171], v[24:27], v[180:183], v[156:171]
    v_cvt_pk_bf16_f32 v118, v96, v97
    v_cvt_pk_bf16_f32 v119, v98, v99
    v_mfma_f32_32x32x16_bf16 v[140:155], v[12:15], v[184:187], v[140:155]
    v_cvt_pk_bf16_f32 v120, v100, v101
    v_cvt_pk_bf16_f32 v121, v102, v103
    v_mfma_f32_32x32x16_bf16 v[156:171], v[28:31], v[184:187], v[156:171]
    v_cvt_pk_bf16_f32 v122, v104, v105
    v_cvt_pk_bf16_f32 v123, v106, v107
    s_waitcnt lgkmcnt(0)
    ds_bpermute_b32 v210, v239, v203 offset:0
    ds_bpermute_b32 v212, v239, v203 offset:32
    ds_bpermute_b32 v214, v239, v203 offset:64
    ds_bpermute_b32 v216, v239, v203 offset:96
    v_mfma_f32_32x32x16_bf16 v[140:155], v[44:47], v[108:111], v[140:155]
    v_lshlrev_b32 v76, 16, v172
    v_and_b32 v77, 0xffff0000, v172
    v_lshlrev_b32 v78, 16, v173
    v_and_b32 v79, 0xffff0000, v173
    v_lshlrev_b32 v80, 16, v174
    v_and_b32 v81, 0xffff0000, v174
    v_lshlrev_b32 v82, 16, v175
    v_and_b32 v83, 0xffff0000, v175
    v_mfma_f32_32x32x16_bf16 v[140:155], v[48:51], v[112:115], v[140:155]
    v_lshlrev_b32 v84, 16, v176
    v_and_b32 v85, 0xffff0000, v176
    v_lshlrev_b32 v86, 16, v177
    v_and_b32 v87, 0xffff0000, v177
    v_lshlrev_b32 v88, 16, v178
    v_and_b32 v89, 0xffff0000, v178
    v_lshlrev_b32 v90, 16, v179
    v_and_b32 v91, 0xffff0000, v179
    v_mfma_f32_32x32x16_bf16 v[140:155], v[52:55], v[116:119], v[140:155]
    v_lshlrev_b32 v92, 16, v180
    v_and_b32 v93, 0xffff0000, v180
    v_lshlrev_b32 v94, 16, v181
    v_and_b32 v95, 0xffff0000, v181
    v_lshlrev_b32 v96, 16, v182
    v_and_b32 v97, 0xffff0000, v182
    v_lshlrev_b32 v98, 16, v183
    v_and_b32 v99, 0xffff0000, v183
    v_mfma_f32_32x32x16_bf16 v[140:155], v[56:59], v[120:123], v[140:155]
    v_lshlrev_b32 v100, 16, v184
    v_and_b32 v101, 0xffff0000, v184
    v_lshlrev_b32 v102, 16, v185
    v_and_b32 v103, 0xffff0000, v185
    v_lshlrev_b32 v104, 16, v186
    v_and_b32 v105, 0xffff0000, v186
    v_lshlrev_b32 v106, 16, v187
    v_and_b32 v107, 0xffff0000, v187
    v_mfma_f32_32x32x16_bf16 v[156:171], v[60:63], v[108:111], v[156:171]
    v_mov_b32 v243, 0
    v_pk_add_f32 v[244:245], v[244:245], v[240:241]
    v_add_f32 v246, v246, v242
    v_cvt_pk_bf16_f32 v244, v244, v245
    v_cvt_pk_bf16_f32 v246, v246, v246
    s_mov_b32 exec_lo, s44
    s_mov_b32 exec_hi, 0
    s_cmp_eq_u32 s98, s94
    s_cbranch_scc1 K2_PF
    v_mul_u32_u24 v220, 6, v218
    s_mov_b32 s99, 6400000
    buffer_store_short v244, v220, s[24:27], s99 offen
    buffer_store_short_d16_hi v244, v220, s[24:27], s99 offen offset:2
    buffer_store_short v246, v220, s[24:27], s99 offen offset:4
    s_branch K2_PD
K2_PF:
    s_mov_b32 s99, 32768
    v_mad_u32_u24 v220, v249, 6, s99
    ds_write_b16 v220, v244
    ds_write_b16_d16_hi v220, v244 offset:2
    ds_write_b16 v220, v246 offset:4
    s_mov_b64 exec, 1
    v_mov_b32 v220, 108
    v_mov_b32 v221, 1
    ds_add_rtn_u32 v243, v220, v221
K2_PD:
    s_mov_b64 exec, -1
    s_mov_b32 s40, 0xbf317218
    s_mov_b32 s41, 0xbf317218
    v_mfma_f32_32x32x16_bf16 v[156:171], v[64:67], v[112:115], v[156:171]
    v_exp_f32 v220, v140
    v_exp_f32 v221, v141
    v_exp_f32 v222, v142
    v_exp_f32 v223, v143
    v_mfma_f32_32x32x16_bf16 v[156:171], v[68:71], v[116:119], v[156:171]
    v_exp_f32 v224, v144
    v_exp_f32 v225, v145
    v_exp_f32 v226, v146
    v_exp_f32 v227, v147
    v_pk_add_f32 v[220:221], v[220:221], 1.0 op_sel_hi:[1,0]
    v_pk_add_f32 v[222:223], v[222:223], 1.0 op_sel_hi:[1,0]
    v_mfma_f32_32x32x16_bf16 v[156:171], v[72:75], v[120:123], v[156:171]
    v_pk_add_f32 v[224:225], v[224:225], 1.0 op_sel_hi:[1,0]
    v_pk_add_f32 v[226:227], v[226:227], 1.0 op_sel_hi:[1,0]
    v_rcp_f32 v220, v220
    v_rcp_f32 v221, v221
    v_rcp_f32 v222, v222
    v_rcp_f32 v223, v223
    v_rcp_f32 v224, v224
    v_rcp_f32 v225, v225
    v_rcp_f32 v226, v226
    v_rcp_f32 v227, v227
    s_waitcnt lgkmcnt(0)
    v_add_u32 v210, v210, v211
    v_add_u32 v212, v212, v213
    v_add_u32 v214, v214, v215
    v_add_u32 v216, v216, v217
    v_pk_mul_f32 v[220:221], v[220:221], v[140:141]
    v_pk_mul_f32 v[222:223], v[222:223], v[142:143]
    v_pk_mul_f32 v[224:225], v[224:225], v[144:145]
    v_pk_mul_f32 v[226:227], v[226:227], v[146:147]
    v_pk_fma_f32 v[220:221], v[220:221], s[40:41], v[76:77]
    v_pk_fma_f32 v[222:223], v[222:223], s[40:41], v[78:79]
    v_pk_fma_f32 v[224:225], v[224:225], s[40:41], v[80:81]
    v_pk_fma_f32 v[226:227], v[226:227], s[40:41], v[82:83]
    v_cvt_pk_bf16_f32 v172, v220, v221
    v_cvt_pk_bf16_f32 v173, v222, v223
    v_cvt_pk_bf16_f32 v174, v224, v225
    v_cvt_pk_bf16_f32 v175, v226, v227
    s_waitcnt vmcnt(0)
    ds_write_b128 v251, v[172:175]
    v_exp_f32 v220, v148
    v_exp_f32 v221, v149
    v_exp_f32 v222, v150
    v_exp_f32 v223, v151
    v_exp_f32 v224, v152
    v_exp_f32 v225, v153
    v_exp_f32 v226, v154
    v_exp_f32 v227, v155
    v_pk_add_f32 v[220:221], v[220:221], 1.0 op_sel_hi:[1,0]
    v_pk_add_f32 v[222:223], v[222:223], 1.0 op_sel_hi:[1,0]
    v_pk_add_f32 v[224:225], v[224:225], 1.0 op_sel_hi:[1,0]
    v_pk_add_f32 v[226:227], v[226:227], 1.0 op_sel_hi:[1,0]
    v_rcp_f32 v220, v220
    v_rcp_f32 v221, v221
    v_rcp_f32 v222, v222
    v_rcp_f32 v223, v223
    v_rcp_f32 v224, v224
    v_rcp_f32 v225, v225
    v_rcp_f32 v226, v226
    v_rcp_f32 v227, v227
    v_pk_mul_f32 v[220:221], v[220:221], v[148:149]
    v_pk_mul_f32 v[222:223], v[222:223], v[150:151]
    v_pk_mul_f32 v[224:225], v[224:225], v[152:153]
    v_pk_mul_f32 v[226:227], v[226:227], v[154:155]
    v_pk_fma_f32 v[220:221], v[220:221], s[40:41], v[84:85]
    v_pk_fma_f32 v[222:223], v[222:223], s[40:41], v[86:87]
    v_pk_fma_f32 v[224:225], v[224:225], s[40:41], v[88:89]
    v_pk_fma_f32 v[226:227], v[226:227], s[40:41], v[90:91]
    v_cvt_pk_bf16_f32 v176, v220, v221
    v_cvt_pk_bf16_f32 v177, v222, v223
    v_cvt_pk_bf16_f32 v178, v224, v225
    v_cvt_pk_bf16_f32 v179, v226, v227
    ds_write_b128 v252, v[176:179]
    v_exp_f32 v220, v156
    v_exp_f32 v221, v157
    v_exp_f32 v222, v158
    v_exp_f32 v223, v159
    v_exp_f32 v224, v160
    v_exp_f32 v225, v161
    v_exp_f32 v226, v162
    v_exp_f32 v227, v163
    v_pk_add_f32 v[220:221], v[220:221], 1.0 op_sel_hi:[1,0]
    v_pk_add_f32 v[222:223], v[222:223], 1.0 op_sel_hi:[1,0]
    v_pk_add_f32 v[224:225], v[224:225], 1.0 op_sel_hi:[1,0]
    v_pk_add_f32 v[226:227], v[226:227], 1.0 op_sel_hi:[1,0]
    v_rcp_f32 v220, v220
    v_rcp_f32 v221, v221
    v_rcp_f32 v222, v222
    v_rcp_f32 v223, v223
    v_rcp_f32 v224, v224
    v_rcp_f32 v225, v225
    v_rcp_f32 v226, v226
    v_rcp_f32 v227, v227
    v_pk_mul_f32 v[220:221], v[220:221], v[156:157]
    v_pk_mul_f32 v[222:223], v[222:223], v[158:159]
    v_pk_mul_f32 v[224:225], v[224:225], v[160:161]
    v_pk_mul_f32 v[226:227], v[226:227], v[162:163]
    v_pk_fma_f32 v[220:221], v[220:221], s[40:41], v[92:93]
    v_pk_fma_f32 v[222:223], v[222:223], s[40:41], v[94:95]
    v_pk_fma_f32 v[224:225], v[224:225], s[40:41], v[96:97]
    v_pk_fma_f32 v[226:227], v[226:227], s[40:41], v[98:99]
    v_cvt_pk_bf16_f32 v180, v220, v221
    v_cvt_pk_bf16_f32 v181, v222, v223
    v_cvt_pk_bf16_f32 v182, v224, v225
    v_cvt_pk_bf16_f32 v183, v226, v227
    ds_write_b128 v253, v[180:183]
    v_exp_f32 v220, v164
    v_exp_f32 v221, v165
    v_exp_f32 v222, v166
    v_exp_f32 v223, v167
    v_exp_f32 v224, v168
    v_exp_f32 v225, v169
    v_exp_f32 v226, v170
    v_exp_f32 v227, v171
    v_pk_add_f32 v[220:221], v[220:221], 1.0 op_sel_hi:[1,0]
    v_pk_add_f32 v[222:223], v[222:223], 1.0 op_sel_hi:[1,0]
    v_pk_add_f32 v[224:225], v[224:225], 1.0 op_sel_hi:[1,0]
    v_pk_add_f32 v[226:227], v[226:227], 1.0 op_sel_hi:[1,0]
    v_rcp_f32 v220, v220
    v_rcp_f32 v221, v221
    v_rcp_f32 v222, v222
    v_rcp_f32 v223, v223
    v_rcp_f32 v224, v224
    v_rcp_f32 v225, v225
    v_rcp_f32 v226, v226
    v_rcp_f32 v227, v227
    v_pk_mul_f32 v[220:221], v[220:221], v[164:165]
    v_pk_mul_f32 v[222:223], v[222:223], v[166:167]
    v_pk_mul_f32 v[224:225], v[224:225], v[168:169]
    v_pk_mul_f32 v[226:227], v[226:227], v[170:171]
    v_pk_fma_f32 v[220:221], v[220:221], s[40:41], v[100:101]
    v_pk_fma_f32 v[222:223], v[222:223], s[40:41], v[102:103]
    v_pk_fma_f32 v[224:225], v[224:225], s[40:41], v[104:105]
    v_pk_fma_f32 v[226:227], v[226:227], s[40:41], v[106:107]
    v_cvt_pk_bf16_f32 v184, v220, v221
    v_cvt_pk_bf16_f32 v185, v222, v223
    v_cvt_pk_bf16_f32 v186, v224, v225
    v_cvt_pk_bf16_f32 v187, v226, v227
    ds_write_b128 v254, v[184:187]
    ds_read_b128 v[140:143], v235 offset:0
    ds_read_b128 v[144:147], v235 offset:1024
    ds_read_b128 v[148:151], v235 offset:2048
    ds_read_b128 v[152:155], v235 offset:3072
    s_waitcnt lgkmcnt(3)
    buffer_store_dwordx4 v[140:143], v210, s[24:27], 0 offen sc1
    s_waitcnt lgkmcnt(2)
    buffer_store_dwordx4 v[144:147], v212, s[24:27], 0 offen sc1
    s_waitcnt lgkmcnt(1)
    buffer_store_dwordx4 v[148:151], v214, s[24:27], 0 offen sc1
    s_waitcnt lgkmcnt(0)
    buffer_store_dwordx4 v[152:155], v216, s[24:27], 0 offen sc1
    v_readfirstlane_b32 s95, v243
    v_and_b32 v220, 63, v250
    v_lshlrev_b32 v220, 3, v220
    s_cmp_lg_u32 s95, 7
    s_cbranch_scc1 K2_PE
    ds_read_b64 v[188:189], v220 offset:32768
    ds_read_b64 v[190:191], v220 offset:33280
    ds_read_b64 v[192:193], v220 offset:33792
    s_mul_i32 s99, s4, 6
    s_add_u32 s99, s99, 6400000
    s_mul_i32 s95, s96, 6
    v_cmp_gt_i32 vcc, s95, v220
    s_sub_i32 s95, s95, 512
    s_waitcnt lgkmcnt(2)
    s_mov_b64 exec, vcc
    buffer_store_dwordx2 v[188:189], v220, s[24:27], s99 offen offset:0 sc1
    v_cmp_gt_i32 vcc, s95, v220
    s_sub_i32 s95, s95, 512
    s_waitcnt lgkmcnt(1)
    s_mov_b64 exec, vcc
    buffer_store_dwordx2 v[190:191], v220, s[24:27], s99 offen offset:512 sc1
    v_cmp_gt_i32 vcc, s95, v220
    s_sub_i32 s95, s95, 512
    s_waitcnt lgkmcnt(0)
    s_mov_b64 exec, vcc
    buffer_store_dwordx2 v[192:193], v220, s[24:27], s99 offen offset:1024 sc1
    s_mov_b64 exec, -1
K2_PE:
    s_endpgm
K2_END0:
    s_waitcnt vmcnt(0)
K2_END:
    s_endpgm
.section .rodata,"a"
.p2align 6
.amdhsa_kernel egnn_sort_kernel
  .amdhsa_next_free_vgpr 56
  .amdhsa_next_free_sgpr 48
  .amdhsa_accum_offset 56
  .amdhsa_group_segment_fixed_size 0
  .amdhsa_kernarg_size 88
  .amdhsa_user_sgpr_count 2
  .amdhsa_user_sgpr_kernarg_segment_ptr 1
  .amdhsa_system_sgpr_workgroup_id_x 1
.end_amdhsa_kernel
.p2align 6
.amdhsa_kernel egnn_main_kernel
  .amdhsa_next_free_vgpr 256
  .amdhsa_next_free_sgpr 102
  .amdhsa_accum_offset 256
  .amdhsa_group_segment_fixed_size 0
  .amdhsa_kernarg_size 88
  .amdhsa_user_sgpr_count 2
  .amdhsa_user_sgpr_kernarg_segment_ptr 1
  .amdhsa_system_sgpr_workgroup_id_x 1
.end_amdhsa_kernel
```

```asm
; @launch kernel=egnn_sort_kernel grid=(250,1,1) block=(896,1,1) lds=27904
; @launch kernel=egnn_main_kernel grid=(256,1,1) block=(512,1,1) lds=162816
.amdgcn_target "amdgcn-amd-amdhsa--gfx950"
.text
.globl egnn_sort_kernel
.p2align 8
.type egnn_sort_kernel,@function
egnn_sort_kernel:
    s_cmp_ge_u32 s2, 250
    s_cbranch_scc1 K1_END
    s_load_dwordx2 s[38:39], s[0:1], 80
    v_lshrrev_b32 v1, 6, v0
    s_nop 0
    v_readfirstlane_b32 s3, v1
    s_cmp_ge_u32 s3, 13
    s_cbranch_scc1 K1_FRAG
    s_load_dwordx4 s[4:7], s[0:1], 24
    s_load_dwordx4 s[8:11], s[0:1], 8
    s_and_b32 s28, s2, 7
    s_min_u32 s29, s28, 2
    s_mul_i32 s28, s28, 31
    s_lshr_b32 s2, s2, 3
    s_add_u32 s2, s2, s28
    s_add_u32 s2, s2, s29
    v_lshlrev_b32 v1, 2, v0
    v_mov_b32 v2, 0
    v_mov_b32 v3, 1
    v_cmp_gt_u32 vcc, 288, v0
    s_mov_b64 exec, vcc
    ds_write_b32 v1, v2 offset:0
    s_mov_b64 exec, -1
    s_mul_i32 s28, s2, 12800
    s_mul_i32 s29, s2, 200
    s_mul_i32 s30, s2, 3200
    s_mov_b32 s31, 85599
    s_movk_i32 s32, -196
    v_add_u32 v12, s29, v0
    v_mul_u32_u24 v13, 6, v12
    v_lshlrev_b32 v14, 4, v0
    v_mov_b32 v15, 800
    v_cmp_gt_u32 s[34:35], v15, v0
    v_mov_b32 v15, 200
    v_cmp_gt_u32 s[36:37], v15, v0
    s_waitcnt lgkmcnt(0)
    s_mov_b32 s12, s4
    s_and_b32 s13, s5, 0xffff
    s_mov_b32 s14, 3200000
    s_mov_b32 s15, 0x20000
    s_mov_b32 s16, s6
    s_and_b32 s17, s7, 0xffff
    s_mov_b32 s18, 3200000
    s_mov_b32 s19, 0x20000
    s_mov_b32 s20, s8
    s_and_b32 s21, s9, 0xffff
    s_mov_b32 s22, 300000
    s_mov_b32 s23, 0x20000
    s_mov_b32 s24, s38
    s_and_b32 s25, s39, 0xffff
    s_mov_b32 s26, 25600000
    s_mov_b32 s27, 0x20000
    s_cmp_ge_u32 s3, 4
    s_cbranch_scc1 K1_NOPOS
    s_mov_b64 exec, s[36:37]
    buffer_load_ushort v16, v13, s[20:23], 0 offen
    buffer_load_ushort v17, v13, s[20:23], 0 offen offset:2
    buffer_load_ushort v18, v13, s[20:23], 0 offen offset:4
K1_NOPOS:
    s_mov_b64 exec, s[34:35]
    buffer_load_dwordx4 v[4:7], v14, s[16:19], s28 offen nt
    v_add_u32 v20, s30, v1
    v_add_u32 v22, 1, v20
    v_add_u32 v24, 2, v20
    v_add_u32 v26, 3, v20
    s_barrier
    s_waitcnt vmcnt(0)
    buffer_load_dwordx4 v[8:11], v14, s[12:15], s28 offen nt
    v_mul_u32_u24 v28, s31, v4
    v_lshrrev_b32 v28, 24, v28
    v_mad_i32_i24 v4, v28, s32, v4
    v_lshlrev_b32 v28, 2, v28
    ds_add_rtn_u32 v32, v28, v3 offset:0
    v_mul_u32_u24 v29, s31, v5
    v_lshrrev_b32 v29, 24, v29
    v_mad_i32_i24 v5, v29, s32, v5
    v_lshlrev_b32 v29, 2, v29
    ds_add_rtn_u32 v33, v29, v3 offset:0
    v_mul_u32_u24 v30, s31, v6
    v_lshrrev_b32 v30, 24, v30
    v_mad_i32_i24 v6, v30, s32, v6
    v_lshlrev_b32 v30, 2, v30
    ds_add_rtn_u32 v34, v30, v3 offset:0
    v_mul_u32_u24 v31, s31, v7
    v_lshrrev_b32 v31, 24, v31
    v_mad_i32_i24 v7, v31, s32, v7
    v_lshlrev_b32 v31, 2, v31
    ds_add_rtn_u32 v35, v31, v3 offset:0
    s_cmp_ge_u32 s3, 4
    s_cbranch_scc1 K1_P3
    s_mov_b64 exec, s[36:37]
    v_lshl_or_b32 v16, v17, 16, v16
    v_lshlrev_b32 v17, 16, v18
    v_lshlrev_b32 v12, 3, v12
    s_mov_b32 s33, 6684672
    buffer_store_dwordx2 v[16:17], v12, s[24:27], s33 offen
    s_mov_b64 exec, s[34:35]
K1_P3:
    s_mov_b64 exec, -1
    v_and_b32 v2, 63, v0
    v_lshlrev_b32 v2, 4, v2
    s_waitcnt lgkmcnt(0)
    s_barrier
    ds_read_b128 v[36:39], v2 offset:0
    s_waitcnt lgkmcnt(0)
    v_add_u32 v42, v36, v37
    v_add_u32 v43, v42, v38
    v_add_u32 v44, v43, v39
    v_mov_b32 v45, v44
    s_nop 1
    v_add_u32_dpp v45, v45, v45 row_shr:1 row_mask:0xf bank_mask:0xf
    s_nop 1
    v_add_u32_dpp v45, v45, v45 row_shr:2 row_mask:0xf bank_mask:0xf
    s_nop 1
    v_add_u32_dpp v45, v45, v45 row_shr:4 row_mask:0xf bank_mask:0xf
    s_nop 1
    v_add_u32_dpp v45, v45, v45 row_shr:8 row_mask:0xf bank_mask:0xf
    s_nop 1
    v_add_u32_dpp v45, v45, v45 row_bcast:15 row_mask:0xa bank_mask:0xf
    s_nop 1
    v_add_u32_dpp v45, v45, v45 row_bcast:31 row_mask:0xc bank_mask:0xf
    v_sub_u32 v40, v45, v44
    v_add_u32 v41, v40, v36
    v_add_u32 v42, v40, v42
    v_add_u32 v43, v40, v43
    v_lshlrev_b32 v48, 3, v40
    v_lshlrev_b32 v49, 3, v41
    v_lshlrev_b32 v50, 3, v42
    v_lshlrev_b32 v51, 3, v43
    ds_write_b128 v2, v[48:51] offset:1280
    s_mov_b64 exec, s[34:35]
    ds_read_b32 v28, v28 offset:1280
    ds_read_b32 v29, v29 offset:1280
    ds_read_b32 v30, v30 offset:1280
    ds_read_b32 v31, v31 offset:1280
    s_cmp_ge_u32 s3, 4
    s_cbranch_scc1 K1_SW0
    s_waitcnt vmcnt(1)
    s_branch K1_SW1
K1_SW0:
    s_waitcnt vmcnt(0)
K1_SW1:
    v_mul_u32_u24 v21, 1342, v8
    v_lshrrev_b32 v21, 24, v21
    v_lshl_or_b32 v4, v4, 2, v21
    v_lshl_or_b32 v21, v4, 18, v8
    v_mul_u32_u24 v23, 1342, v9
    v_lshrrev_b32 v23, 24, v23
    v_lshl_or_b32 v5, v5, 2, v23
    v_lshl_or_b32 v23, v5, 18, v9
    v_mul_u32_u24 v25, 1342, v10
    v_lshrrev_b32 v25, 24, v25
    v_lshl_or_b32 v6, v6, 2, v25
    v_lshl_or_b32 v25, v6, 18, v10
    v_mul_u32_u24 v27, 1342, v11
    v_lshrrev_b32 v27, 24, v27
    v_lshl_or_b32 v7, v7, 2, v27
    v_lshl_or_b32 v27, v7, 18, v11
    s_cmp_lg_u32 s3, 12
    s_cbranch_scc1 K1_NOOFF
    s_mov_b64 exec, -1
    v_lshl_or_b32 v40, v36, 16, v40
    v_lshl_or_b32 v41, v37, 16, v41
    v_lshl_or_b32 v42, v38, 16, v42
    v_lshl_or_b32 v43, v39, 16, v43
    v_lshlrev_b32 v2, 8, v2
    s_lshl_b32 s33, s2, 4
    s_add_u32 s33, s33, 6422528
    buffer_store_dwordx4 v[40:43], v2, s[24:27], s33 offen
    s_mov_b64 exec, s[34:35]
K1_NOOFF:
    s_waitcnt lgkmcnt(3)
    v_lshl_add_u32 v28, v32, 3, v28
    ds_write_b64 v28, v[20:21] offset:2304
    s_waitcnt lgkmcnt(3)
    v_lshl_add_u32 v29, v33, 3, v29
    ds_write_b64 v29, v[22:23] offset:2304
    s_waitcnt lgkmcnt(3)
    v_lshl_add_u32 v30, v34, 3, v30
    ds_write_b64 v30, v[24:25] offset:2304
    s_waitcnt lgkmcnt(3)
    v_lshl_add_u32 v31, v35, 3, v31
    ds_write_b64 v31, v[26:27] offset:2304
    s_mul_i32 s33, s2, 25600
    s_add_u32 s38, s33, 12800
    s_waitcnt lgkmcnt(0)
    s_barrier
    ds_read_b128 v[4:7], v14 offset:2304
    ds_read_b128 v[8:11], v14 offset:15104
    s_waitcnt lgkmcnt(1)
    buffer_store_dwordx4 v[4:7], v14, s[24:27], s33 offen sc1
    s_waitcnt lgkmcnt(0)
    buffer_store_dwordx4 v[8:11], v14, s[24:27], s38 offen sc1
    s_endpgm
K1_FRAG:
    s_cmp_ge_u32 s2, 144
    s_cbranch_scc1 K1_END
    s_load_dwordx4 s[4:7], s[0:1], 40
    s_load_dwordx2 s[8:9], s[0:1], 56
    s_lshr_b32 s28, s2, 2
    s_and_b32 s3, s2, 3
    s_lshl_b32 s3, s3, 6
    v_and_b32 v1, 63, v0
    v_add_u32 v1, s3, v1
    v_lshlrev_b32 v10, 2, v1
    s_lshl_b32 s33, s28, 10
    s_add_u32 s33, s33, 7536640
    s_mov_b32 s34, 0xbfb8aa3b
    s_waitcnt lgkmcnt(0)
    s_mov_b32 s12, s4
    s_and_b32 s13, s5, 0xffff
    s_mov_b32 s14, 18560
    s_mov_b32 s15, 0x20000
    s_mov_b32 s16, s6
    s_and_b32 s17, s7, 0xffff
    s_mov_b32 s18, 128
    s_mov_b32 s19, 0x20000
    s_mov_b32 s20, s8
    s_and_b32 s21, s9, 0xffff
    s_mov_b32 s22, 16384
    s_mov_b32 s23, 0x20000
    s_mov_b32 s24, s38
    s_and_b32 s25, s39, 0xffff
    s_mov_b32 s26, 25427968
    s_mov_b32 s27, 0x20000
    s_cmp_eq_u32 s28, 19
    s_cbranch_scc1 K1_WX
    s_cmp_eq_u32 s28, 18
    s_cbranch_scc1 K1_W3
    v_lshrrev_b32 v2, 2, v1
    v_and_b32 v3, 4, v2
    v_lshlrev_b32 v3, 3, v3
    v_bfe_u32 v4, v2, 3, 2
    v_lshl_add_u32 v3, v4, 2, v3
    v_and_b32 v4, 3, v2
    v_add_u32 v3, v3, v4
    v_lshrrev_b32 v5, 7, v1
    v_and_b32 v6, 3, v1
    s_mov_b32 s35, 32
    s_cmp_ge_u32 s28, 18
    s_cbranch_scc1 K1_FH
    s_cmp_ge_u32 s28, 16
    s_cbranch_scc1 K1_F4
    s_mov_b32 s36, s28
    s_branch K1_FC
K1_FH:
    s_sub_u32 s36, s28, 20
    s_mov_b32 s12, s20
    s_mov_b32 s13, s21
    s_mov_b32 s14, s22
    s_cmp_ge_u32 s36, 8
    s_cselect_b32 s34, 1.0, s34
K1_FC:
    s_lshr_b32 s37, s36, 3
    s_lshl_b32 s37, s37, 6
    s_and_b32 s38, s36, 3
    s_lshl_b32 s38, s38, 3
    s_add_u32 s37, s37, s38
    s_bfe_u32 s38, s36, 0x10002
    s_branch K1_FD
K1_F4:
    s_mov_b32 s35, 8
    s_movk_i32 s37, 129
    s_sub_u32 s38, s28, 16
K1_FD:
    s_lshl_b32 s38, s38, 4
    v_mul_u32_u24 v5, s35, v5
    v_lshl_add_u32 v5, v6, 1, v5
    v_add_u32 v5, s37, v5
    v_add_u32 v3, s38, v3
    v_lshlrev_b32 v3, 1, v3
    v_lshl_add_u32 v3, v5, 7, v3
    buffer_load_ushort v7, v3, s[12:15], 0 offen
    buffer_load_ushort v8, v3, s[12:15], 0 offen offset:128
    s_waitcnt vmcnt(0)
    v_lshlrev_b32 v7, 16, v7
    v_lshlrev_b32 v8, 16, v8
    v_mul_f32 v7, s34, v7
    v_mul_f32 v8, s34, v8
    v_cvt_pk_bf16_f32 v7, v7, v8
    buffer_store_dword v7, v10, s[24:27], s33 offen
    s_endpgm
K1_W3:
    v_and_b32 v2, 31, v1
    v_and_b32 v3, 4, v2
    v_lshlrev_b32 v3, 3, v3
    v_bfe_u32 v4, v2, 3, 2
    v_lshl_add_u32 v3, v4, 2, v3
    v_and_b32 v4, 3, v2
    v_add_u32 v3, v3, v4
    v_bfe_u32 v5, v1, 6, 1
    v_lshl_add_u32 v3, v5, 4, v3
    v_lshlrev_b32 v3, 1, v3
    s_movk_i32 s35, 16384
    buffer_load_ushort v7, v3, s[12:15], s35 offen
    v_and_b32 v6, 32, v1
    v_cmp_eq_u32 vcc, 0, v6
    s_waitcnt vmcnt(0)
    v_lshlrev_b32 v7, 16, v7
    v_mul_f32 v7, s34, v7
    v_cvt_pk_bf16_f32 v8, v7, v7
    v_lshlrev_b32 v8, 16, v8
    v_sub_f32 v9, v7, v8
    v_cvt_pk_bf16_f32 v7, v8, v9
    v_cndmask_b32 v7, 0, v7, vcc
    buffer_store_dword v7, v10, s[24:27], s33 offen
    s_endpgm
K1_WX:
    v_lshlrev_b32 v3, 1, v1
    buffer_load_ushort v7, v3, s[16:19], 0 offen
    s_waitcnt vmcnt(0)
    v_lshlrev_b32 v7, 16, v7
    v_mul_f32 v7, 0xbf317218, v7
    buffer_store_dword v7, v10, s[24:27], s33 offen
K1_END:
    s_endpgm
.globl egnn_main_kernel
.p2align 8
.type egnn_main_kernel,@function
egnn_main_kernel:
    s_cmp_ge_u32 s2, 256
    s_cbranch_scc1 K2_END
    s_load_dwordx2 s[28:29], s[0:1], 0
    s_load_dwordx2 s[30:31], s[0:1], 16
    s_load_dwordx2 s[32:33], s[0:1], 64
    s_load_dwordx2 s[34:35], s[0:1], 80
    v_mov_b32 v250, v0
    v_lshrrev_b32 v220, 6, v0
    s_and_b32 s3, s2, 7
    s_lshl_b32 s3, s3, 5
    v_readfirstlane_b32 s5, v220
    s_lshr_b32 s95, s2, 3
    s_add_u32 s3, s3, s95
    s_mul_i32 s4, s3, 196
    s_sub_u32 s96, 50000, s4
    s_min_u32 s96, s96, 196
    s_mov_b32 s7, 0
    s_mov_b32 s92, 48
    s_sub_u32 s100, 11, s5
    s_cmp_lt_u32 s5, 4
    s_cselect_b32 s100, s5, s100
    s_lshl_b32 s94, s100, 12
    s_add_u32 s94, s94, 34816
    s_waitcnt lgkmcnt(0)
    s_add_u32 s88, s34, 6422528
    s_addc_u32 s89, s35, 0
    s_and_b32 s89, s89, 0xffff
    s_mov_b32 s90, 262144
    s_mov_b32 s91, 0x20000
    s_mov_b32 s8, s28
    s_and_b32 s9, s29, 0xffff
    s_or_b32 s9, s9, 8388608
    s_mov_b32 s10, 50000
    s_mov_b32 s11, 0x20000
    s_mov_b32 s12, s30
    s_and_b32 s13, s31, 0xffff
    s_or_b32 s13, s13, 2097152
    s_mov_b32 s14, 800000
    s_mov_b32 s15, 0x20000
    s_add_u32 s16, s34, 6684672
    s_addc_u32 s17, s35, 0
    s_and_b32 s17, s17, 0xffff
    s_or_b32 s17, s17, 524288
    s_mov_b32 s18, 50000
    s_mov_b32 s19, 0x20000
    s_mov_b32 s20, s34
    s_and_b32 s21, s35, 0xffff
    s_mov_b32 s22, 25427968
    s_mov_b32 s23, 0x20000
    s_mov_b32 s24, s32
    s_and_b32 s25, s33, 0xffff
    s_mov_b32 s26, 6700000
    s_mov_b32 s27, 0x20000
K2_TOP:
    v_bfe_u32 v220, v250, 4, 2
    s_mul_i32 s95, s5, 36
    s_sub_u32 s95, s95, 36
    v_mad_u32_u24 v220, v220, 9, s95
    v_lshlrev_b32 v221, 4, v220
    s_and_b32 s95, s3, 3
    s_mul_i32 s95, s95, 1020
    s_lshl_b32 s99, s3, 10
    s_sub_u32 s95, s99, s95
    s_cmp_eq_u32 s5, 0
    s_cbranch_scc1 K2_NOOF
    buffer_load_dword v172, v221, s[88:91], s95 offen offset:0
    buffer_load_dword v173, v221, s[88:91], s95 offen offset:16
    buffer_load_dword v174, v221, s[88:91], s95 offen offset:32
    buffer_load_dword v175, v221, s[88:91], s95 offen offset:48
    buffer_load_dword v176, v221, s[88:91], s95 offen offset:64
    buffer_load_dword v177, v221, s[88:91], s95 offen offset:80
    buffer_load_dword v178, v221, s[88:91], s95 offen offset:96
    buffer_load_dword v179, v221, s[88:91], s95 offen offset:112
    buffer_load_dword v180, v221, s[88:91], s95 offen offset:128
K2_NOOF:
    v_and_b32 v222, 63, v250
    v_lshlrev_b32 v203, 4, v222
    v_lshrrev_b32 v239, 3, v222
    v_lshrrev_b32 v223, 4, v222
    v_xor_b32 v223, v223, v222
    v_and_b32 v223, 7, v223
    v_lshlrev_b32 v211, 4, v223
    v_xor_b32 v213, 64, v211
    v_mov_b32 v215, v211
    v_mov_b32 v217, v213
    s_lshl_b32 s95, s5, 5
    s_add_u32 s95, s95, s4
    v_add_u32 v210, s95, v239
    v_add_u32 v212, 8, v210
    v_add_u32 v214, 16, v210
    v_add_u32 v216, 24, v210
    s_add_u32 s99, s4, s96
    v_cmp_gt_u32 vcc, s99, v210
    s_nop 1
    v_cndmask_b32 v210, -1, v210, vcc
    v_cmp_gt_u32 vcc, s99, v212
    s_nop 1
    v_cndmask_b32 v212, -1, v212, vcc
    v_cmp_gt_u32 vcc, s99, v214
    s_nop 1
    v_cndmask_b32 v214, -1, v214, vcc
    v_cmp_gt_u32 vcc, s99, v216
    s_nop 1
    v_cndmask_b32 v216, -1, v216, vcc
    s_lshl_b32 s101, s5, 12
    s_add_u32 s101, s101, 100352
    s_barrier
    s_mul_i32 s95, s5, 3072
    s_add_u32 m0, s95, 138240
    s_add_u32 s95, s95, 7536640
    buffer_load_dwordx4 v203, s[20:23], s95 offen offset:0 lds
    buffer_load_dwordx4 v203, s[20:23], s95 offen offset:1024 lds
    buffer_load_dwordx4 v203, s[20:23], s95 offen offset:2048 lds
    v_mov_b32 v228, 0
    v_mov_b32 v229, 0
    v_mov_b32 v230, 0
    v_mov_b32 v231, 0
    s_lshl_b32 s95, s5, 10
    s_cmp_ge_u32 s5, 4
    s_cselect_b32 s99, 30720, 0
    s_add_u32 s95, s95, s99
    v_add_u32 v223, s95, v203
    ds_write_b128 v223, v[228:231]
    v_and_b32 v223, 2047, v223
    ds_write_b128 v223, v[228:231] offset:38912
    v_lshlrev_b32 v239, 2, v239
    v_mov_b32 v41, 0
    v_mov_b32 v43, 0
    v_mov_b32 v209, 0
    v_lshrrev_b32 v219, 5, v222
    v_lshlrev_b32 v219, 4, v219
    v_and_b32 v223, 31, v222
    v_bfe_u32 v251, v222, 1, 3
    v_lshlrev_b32 v251, 4, v251
    v_lshlrev_b32 v252, 2, v219
    v_xor_b32 v251, v251, v252
    v_lshl_add_u32 v251, v223, 7, v251
    v_add_u32 v251, s94, v251
    v_xor_b32 v252, 16, v251
    v_xor_b32 v253, 32, v251
    v_xor_b32 v254, 48, v251
    v_and_b32 v222, 15, v250
    v_cmp_gt_u32 vcc, 243, v220
    v_mul_u32_u24 v220, 3200, v220
    v_add3_u32 v220, v220, v222, s7
    v_add_u32 v221, 16, v222
    v_add_u32 v223, 32, v222
    v_cmp_gt_u32_e64 s[32:33], s92, v221
    v_cmp_gt_u32_e64 s[34:35], s92, v222
    s_nop 0
    v_cndmask_b32_e64 v221, 2.0, v221, s[32:33]
    v_cndmask_b32_e64 v223, 2.0, v223, s[32:33]
    v_cndmask_b32_e64 v222, 2.0, v222, s[34:35]
    s_cmp_eq_u32 s5, 0
    s_waitcnt vmcnt(3)
    s_cbranch_scc0 K2_MK
    s_branch K2_NOREC
K2_MK:
    v_cndmask_b32 v179, 0, v179, vcc
    v_cndmask_b32 v180, 0, v180, vcc
    v_and_b32 v98, 0xffff, v172
    v_lshrrev_b32 v172, 16, v172
    v_subrev_u32 v172, s7, v172
    v_cmp_gt_i32_e64 s[32:33], v172, v222
    v_add_lshl_u32 v98, v98, v220, 3
    s_mov_b32 s95, 0
    v_cndmask_b32_e64 v98, 2.0, v98, s[32:33]
    buffer_load_dwordx2 v[44:45], v98, s[20:23], s95 offen
    v_and_b32 v99, 0xffff, v173
    v_lshrrev_b32 v173, 16, v173
    v_subrev_u32 v173, s7, v173
    v_cmp_gt_i32_e64 s[34:35], v173, v222
    v_add_lshl_u32 v99, v99, v220, 3
    s_mov_b32 s95, 25600
    v_cndmask_b32_e64 v99, 2.0, v99, s[34:35]
    buffer_load_dwordx2 v[46:47], v99, s[20:23], s95 offen
    v_and_b32 v100, 0xffff, v174
    v_lshrrev_b32 v174, 16, v174
    v_subrev_u32 v174, s7, v174
    v_cmp_gt_i32_e64 s[36:37], v174, v222
    v_add_lshl_u32 v100, v100, v220, 3
    s_mov_b32 s95, 51200
    v_cndmask_b32_e64 v100, 2.0, v100, s[36:37]
    buffer_load_dwordx2 v[48:49], v100, s[20:23], s95 offen
    v_and_b32 v101, 0xffff, v175
    v_lshrrev_b32 v175, 16, v175
    v_subrev_u32 v175, s7, v175
    v_cmp_gt_i32_e64 s[38:39], v175, v222
    v_add_lshl_u32 v101, v101, v220, 3
    s_mov_b32 s95, 76800
    v_cndmask_b32_e64 v101, 2.0, v101, s[38:39]
    buffer_load_dwordx2 v[50:51], v101, s[20:23], s95 offen
    v_and_b32 v102, 0xffff, v176
    v_lshrrev_b32 v176, 16, v176
    v_subrev_u32 v176, s7, v176
    v_cmp_gt_i32_e64 s[40:41], v176, v222
    v_add_lshl_u32 v102, v102, v220, 3
    s_mov_b32 s95, 102400
    v_cndmask_b32_e64 v102, 2.0, v102, s[40:41]
    buffer_load_dwordx2 v[52:53], v102, s[20:23], s95 offen
    v_and_b32 v103, 0xffff, v177
    v_lshrrev_b32 v177, 16, v177
    v_subrev_u32 v177, s7, v177
    v_cmp_gt_i32_e64 s[42:43], v177, v222
    v_add_lshl_u32 v103, v103, v220, 3
    s_mov_b32 s95, 128000
    v_cndmask_b32_e64 v103, 2.0, v103, s[42:43]
    buffer_load_dwordx2 v[54:55], v103, s[20:23], s95 offen
    v_and_b32 v104, 0xffff, v178
    v_lshrrev_b32 v178, 16, v178
    v_subrev_u32 v178, s7, v178
    v_cmp_gt_i32_e64 s[44:45], v178, v222
    v_add_lshl_u32 v104, v104, v220, 3
    s_mov_b32 s95, 153600
    v_cndmask_b32_e64 v104, 2.0, v104, s[44:45]
    buffer_load_dwordx2 v[56:57], v104, s[20:23], s95 offen
    v_and_b32 v105, 0xffff, v179
    v_lshrrev_b32 v179, 16, v179
    v_subrev_u32 v179, s7, v179
    v_cmp_gt_i32_e64 s[46:47], v179, v222
    v_add_lshl_u32 v105, v105, v220, 3
    s_mov_b32 s95, 179200
    v_cndmask_b32_e64 v105, 2.0, v105, s[46:47]
    buffer_load_dwordx2 v[58:59], v105, s[20:23], s95 offen
    v_and_b32 v106, 0xffff, v180
    v_lshrrev_b32 v180, 16, v180
    v_subrev_u32 v180, s7, v180
    v_cmp_gt_i32_e64 s[48:49], v180, v222
    v_add_lshl_u32 v106, v106, v220, 3
    s_mov_b32 s95, 204800
    v_cndmask_b32_e64 v106, 2.0, v106, s[48:49]
    buffer_load_dwordx2 v[60:61], v106, s[20:23], s95 offen
    v_cmp_gt_i32_e64 s[50:51], v172, v221
    v_cmp_gt_i32_e64 s[68:69], v172, v223
    v_cmp_gt_i32_e64 s[52:53], v173, v221
    v_cmp_gt_i32_e64 s[70:71], v173, v223
    v_cmp_gt_i32_e64 s[54:55], v174, v221
    v_cmp_gt_i32_e64 s[72:73], v174, v223
    v_cmp_gt_i32_e64 s[56:57], v175, v221
    v_cmp_gt_i32_e64 s[74:75], v175, v223
    v_cmp_gt_i32_e64 s[58:59], v176, v221
    v_cmp_gt_i32_e64 s[76:77], v176, v223
    v_cmp_gt_i32_e64 s[60:61], v177, v221
    v_cmp_gt_i32_e64 s[78:79], v177, v223
    v_cmp_gt_i32_e64 s[62:63], v178, v221
    v_cmp_gt_i32_e64 s[80:81], v178, v223
    v_cmp_gt_i32_e64 s[64:65], v179, v221
    v_cmp_gt_i32_e64 s[82:83], v179, v223
    v_cmp_gt_i32_e64 s[66:67], v180, v221
    v_cmp_gt_i32_e64 s[84:85], v180, v223
    s_mov_b32 s95, 0
    s_mov_b64 exec, s[50:51]
    s_cbranch_execz K2_G1
    buffer_load_dwordx2 v[62:63], v98, s[20:23], s95 offen offset:128
K2_G1:
    s_mov_b32 s95, 25600
    s_mov_b64 exec, s[52:53]
    s_cbranch_execz K2_G2
    buffer_load_dwordx2 v[64:65], v99, s[20:23], s95 offen offset:128
K2_G2:
    s_mov_b32 s95, 51200
    s_mov_b64 exec, s[54:55]
    s_cbranch_execz K2_G3
    buffer_load_dwordx2 v[66:67], v100, s[20:23], s95 offen offset:128
K2_G3:
    s_mov_b32 s95, 76800
    s_mov_b64 exec, s[56:57]
    s_cbranch_execz K2_G4
    buffer_load_dwordx2 v[68:69], v101, s[20:23], s95 offen offset:128
K2_G4:
    s_mov_b32 s95, 102400
    s_mov_b64 exec, s[58:59]
    s_cbranch_execz K2_G5
    buffer_load_dwordx2 v[70:71], v102, s[20:23], s95 offen offset:128
K2_G5:
    s_mov_b32 s95, 128000
    s_mov_b64 exec, s[60:61]
    s_cbranch_execz K2_G6
    buffer_load_dwordx2 v[72:73], v103, s[20:23], s95 offen offset:128
K2_G6:
    s_mov_b32 s95, 153600
    s_mov_b64 exec, s[62:63]
    s_cbranch_execz K2_G7
    buffer_load_dwordx2 v[74:75], v104, s[20:23], s95 offen offset:128
K2_G7:
    s_mov_b32 s95, 179200
    s_mov_b64 exec, s[64:65]
    s_cbranch_execz K2_G8
    buffer_load_dwordx2 v[76:77], v105, s[20:23], s95 offen offset:128
K2_G8:
    s_mov_b32 s95, 204800
    s_mov_b64 exec, s[66:67]
    s_cbranch_execz K2_G9
    buffer_load_dwordx2 v[78:79], v106, s[20:23], s95 offen offset:128
K2_G9:
    s_or_b64 vcc, s[68:69], s[70:71]
    s_or_b64 vcc, vcc, s[72:73]
    s_or_b64 vcc, vcc, s[74:75]
    s_or_b64 vcc, vcc, s[76:77]
    s_or_b64 vcc, vcc, s[78:79]
    s_or_b64 vcc, vcc, s[80:81]
    s_or_b64 vcc, vcc, s[82:83]
    s_or_b64 vcc, vcc, s[84:85]
    s_cselect_b32 s97, 1, 0
    s_cbranch_scc0 K2_NP2A
    s_mov_b32 s95, 0
    s_mov_b64 exec, s[68:69]
    s_cbranch_execz K2_G10
    buffer_load_dwordx2 v[80:81], v98, s[20:23], s95 offen offset:256
K2_G10:
    s_mov_b32 s95, 25600
    s_mov_b64 exec, s[70:71]
    s_cbranch_execz K2_G11
    buffer_load_dwordx2 v[82:83], v99, s[20:23], s95 offen offset:256
K2_G11:
    s_mov_b32 s95, 51200
    s_mov_b64 exec, s[72:73]
    s_cbranch_execz K2_G12
    buffer_load_dwordx2 v[84:85], v100, s[20:23], s95 offen offset:256
K2_G12:
    s_mov_b32 s95, 76800
    s_mov_b64 exec, s[74:75]
    s_cbranch_execz K2_G13
    buffer_load_dwordx2 v[86:87], v101, s[20:23], s95 offen offset:256
K2_G13:
    s_mov_b32 s95, 102400
    s_mov_b64 exec, s[76:77]
    s_cbranch_execz K2_G14
    buffer_load_dwordx2 v[88:89], v102, s[20:23], s95 offen offset:256
K2_G14:
    s_mov_b32 s95, 128000
    s_mov_b64 exec, s[78:79]
    s_cbranch_execz K2_G15
    buffer_load_dwordx2 v[90:91], v103, s[20:23], s95 offen offset:256
K2_G15:
    s_mov_b32 s95, 153600
    s_mov_b64 exec, s[80:81]
    s_cbranch_execz K2_G16
    buffer_load_dwordx2 v[92:93], v104, s[20:23], s95 offen offset:256
K2_G16:
    s_mov_b32 s95, 179200
    s_mov_b64 exec, s[82:83]
    s_cbranch_execz K2_G17
    buffer_load_dwordx2 v[94:95], v105, s[20:23], s95 offen offset:256
K2_G17:
    s_mov_b32 s95, 204800
    s_mov_b64 exec, s[84:85]
    s_cbranch_execz K2_G18
    buffer_load_dwordx2 v[96:97], v106, s[20:23], s95 offen offset:256
K2_G18:
K2_NP2A:
    s_mov_b64 exec, -1
    v_max3_i32 v221, v172, v173, v174
    v_max3_i32 v221, v221, v175, v176
    v_max3_i32 v221, v221, v177, v178
    v_max3_i32 v221, v221, v179, v180
    v_mov_b32 v223, 1
    v_cmp_lt_i32_e64 s[86:87], s92, v221
K2_NOREC:
    s_waitcnt lgkmcnt(0)
    s_barrier
    s_add_u32 s95, s101, 0
    s_cmp_lt_u32 s95, 125952
    s_cselect_b32 m0, s95, 43008
    s_nop 0
    buffer_load_dwordx4 v[210:211], s[8:11], 0 idxen offen lds
    s_add_u32 s95, s101, 1024
    s_cmp_lt_u32 s95, 125952
    s_cselect_b32 m0, s95, 43008
    s_nop 0
    buffer_load_dwordx4 v[212:213], s[8:11], 0 idxen offen lds
    s_add_u32 s95, s101, 2048
    s_cmp_lt_u32 s95, 125952
    s_cselect_b32 m0, s95, 43008
    s_nop 0
    buffer_load_dwordx4 v[214:215], s[8:11], 0 idxen offen lds
    s_add_u32 s95, s101, 3072
    s_cmp_lt_u32 s95, 125952
    s_cselect_b32 m0, s95, 43008
    s_nop 0
    buffer_load_dwordx4 v[216:217], s[8:11], 0 idxen offen lds
    s_cmp_lg_u32 s5, 0
    s_cbranch_scc1 K2_NOPW
    s_lshr_b32 s95, s2, 3
    s_mul_i32 s99, s95, 0
    v_add_u32 v224, s99, v203
    s_mul_i32 s99, s95, 0
    v_add_u32 v225, s99, v250
    v_add_u32 v224, 0, v250
    v_cmp_gt_u32 vcc, s96, v224
    s_nop 1
    v_cndmask_b32_e64 v104, -0.5, 0.5, vcc
    v_add_u32 v224, 64, v250
    v_cmp_gt_u32 vcc, s96, v224
    s_nop 1
    v_cndmask_b32_e64 v105, -0.5, 0.5, vcc
    v_add_u32 v224, 128, v250
    v_cmp_gt_u32 vcc, s96, v224
    s_nop 1
    v_cndmask_b32_e64 v106, -0.5, 0.5, vcc
    v_add_u32 v224, 192, v250
    v_cmp_gt_u32 vcc, s96, v224
    s_nop 1
    v_cndmask_b32_e64 v107, -0.5, 0.5, vcc
    s_branch K2_B1
K2_NOPW:
    s_mov_b64 exec, s[86:87]
    ds_write_b32 v228, v223 offset:96
    s_mov_b64 exec, -1
    s_waitcnt vmcnt(4)
    s_mov_b64 exec, s[32:33]
    v_lshrrev_b32 v172, 16, v45
    ds_add_rtn_u32 v172, v172, v223 offset:34816
    s_mov_b64 exec, s[34:35]
    v_lshrrev_b32 v173, 16, v47
    ds_add_rtn_u32 v173, v173, v223 offset:34816
    s_mov_b64 exec, s[36:37]
    v_lshrrev_b32 v174, 16, v49
    ds_add_rtn_u32 v174, v174, v223 offset:34816
    s_mov_b64 exec, s[38:39]
    v_lshrrev_b32 v175, 16, v51
    ds_add_rtn_u32 v175, v175, v223 offset:34816
    s_mov_b64 exec, s[40:41]
    v_lshrrev_b32 v176, 16, v53
    ds_add_rtn_u32 v176, v176, v223 offset:34816
    s_mov_b64 exec, s[42:43]
    v_lshrrev_b32 v177, 16, v55
    ds_add_rtn_u32 v177, v177, v223 offset:34816
    s_mov_b64 exec, s[44:45]
    v_lshrrev_b32 v178, 16, v57
    ds_add_rtn_u32 v178, v178, v223 offset:34816
    s_mov_b64 exec, s[46:47]
    v_lshrrev_b32 v179, 16, v59
    ds_add_rtn_u32 v179, v179, v223 offset:34816
    s_mov_b64 exec, s[48:49]
    v_lshrrev_b32 v180, 16, v61
    ds_add_rtn_u32 v180, v180, v223 offset:34816
    s_mov_b64 exec, s[50:51]
    s_cbranch_execz K2_G19
    v_lshrrev_b32 v181, 16, v63
    ds_add_rtn_u32 v181, v181, v223 offset:34816
K2_G19:
    s_mov_b64 exec, s[52:53]
    s_cbranch_execz K2_G20
    v_lshrrev_b32 v182, 16, v65
    ds_add_rtn_u32 v182, v182, v223 offset:34816
K2_G20:
    s_mov_b64 exec, s[54:55]
    s_cbranch_execz K2_G21
    v_lshrrev_b32 v183, 16, v67
    ds_add_rtn_u32 v183, v183, v223 offset:34816
K2_G21:
    s_mov_b64 exec, s[56:57]
    s_cbranch_execz K2_G22
    v_lshrrev_b32 v184, 16, v69
    ds_add_rtn_u32 v184, v184, v223 offset:34816
K2_G22:
    s_mov_b64 exec, s[58:59]
    s_cbranch_execz K2_G23
    v_lshrrev_b32 v185, 16, v71
    ds_add_rtn_u32 v185, v185, v223 offset:34816
K2_G23:
    s_mov_b64 exec, s[60:61]
    s_cbranch_execz K2_G24
    v_lshrrev_b32 v186, 16, v73
    ds_add_rtn_u32 v186, v186, v223 offset:34816
K2_G24:
    s_mov_b64 exec, s[62:63]
    s_cbranch_execz K2_G25
    v_lshrrev_b32 v187, 16, v75
    ds_add_rtn_u32 v187, v187, v223 offset:34816
K2_G25:
    s_mov_b64 exec, s[64:65]
    s_cbranch_execz K2_G26
    v_lshrrev_b32 v188, 16, v77
    ds_add_rtn_u32 v188, v188, v223 offset:34816
K2_G26:
    s_mov_b64 exec, s[66:67]
    s_cbranch_execz K2_G27
    v_lshrrev_b32 v189, 16, v79
    ds_add_rtn_u32 v189, v189, v223 offset:34816
K2_G27:
    s_cmp_eq_u32 s97, 0
    s_cbranch_scc1 K2_NP2B
    s_mov_b64 exec, s[68:69]
    s_cbranch_execz K2_G28
    v_lshrrev_b32 v190, 16, v81
    ds_add_rtn_u32 v190, v190, v223 offset:34816
K2_G28:
    s_mov_b64 exec, s[70:71]
    s_cbranch_execz K2_G29
    v_lshrrev_b32 v191, 16, v83
    ds_add_rtn_u32 v191, v191, v223 offset:34816
K2_G29:
    s_mov_b64 exec, s[72:73]
    s_cbranch_execz K2_G30
    v_lshrrev_b32 v192, 16, v85
    ds_add_rtn_u32 v192, v192, v223 offset:34816
K2_G30:
    s_mov_b64 exec, s[74:75]
    s_cbranch_execz K2_G31
    v_lshrrev_b32 v193, 16, v87
    ds_add_rtn_u32 v193, v193, v223 offset:34816
K2_G31:
    s_mov_b64 exec, s[76:77]
    s_cbranch_execz K2_G32
    v_lshrrev_b32 v194, 16, v89
    ds_add_rtn_u32 v194, v194, v223 offset:34816
K2_G32:
    s_mov_b64 exec, s[78:79]
    s_cbranch_execz K2_G33
    v_lshrrev_b32 v195, 16, v91
    ds_add_rtn_u32 v195, v195, v223 offset:34816
K2_G33:
    s_mov_b64 exec, s[80:81]
    s_cbranch_execz K2_G34
    v_lshrrev_b32 v196, 16, v93
    ds_add_rtn_u32 v196, v196, v223 offset:34816
K2_G34:
    s_mov_b64 exec, s[82:83]
    s_cbranch_execz K2_G35
    v_lshrrev_b32 v197, 16, v95
    ds_add_rtn_u32 v197, v197, v223 offset:34816
K2_G35:
    s_mov_b64 exec, s[84:85]
    s_cbranch_execz K2_G36
    v_lshrrev_b32 v198, 16, v97
    ds_add_rtn_u32 v198, v198, v223 offset:34816
K2_G36:
K2_NP2B:
    s_mov_b64 exec, -1
K2_B1:
    s_cmp_lg_u32 s5, 0
    s_waitcnt lgkmcnt(0)
    s_barrier
    s_cbranch_scc1 K2_W2
    ds_read_b128 v[44:47], v203 offset:34816
    ds_read_b128 v[48:51], v203 offset:35840
    ds_read_b128 v[52:55], v203 offset:36864
    ds_read_b128 v[56:59], v203 offset:37888
    s_waitcnt lgkmcnt(3)
    v_add_u32 v76, v44, v45
    v_add3_u32 v76, v76, v46, v47
    s_waitcnt lgkmcnt(2)
    v_add_u32 v77, v48, v49
    v_add3_u32 v77, v77, v50, v51
    s_waitcnt lgkmcnt(1)
    v_add_u32 v78, v52, v53
    v_add3_u32 v78, v78, v54, v55
    s_waitcnt lgkmcnt(0)
    v_add_u32 v79, v56, v57
    v_add3_u32 v79, v79, v58, v59
    v_add_u32 v82, v76, v77
    v_add_u32 v83, v82, v78
    v_add_u32 v220, v83, v79
    v_mov_b32 v221, v220
    s_nop 1
    v_add_u32_dpp v221, v221, v221 row_shr:1 row_mask:0xf bank_mask:0xf
    s_nop 1
    v_add_u32_dpp v221, v221, v221 row_shr:2 row_mask:0xf bank_mask:0xf
    s_nop 1
    v_add_u32_dpp v221, v221, v221 row_shr:4 row_mask:0xf bank_mask:0xf
    s_nop 1
    v_add_u32_dpp v221, v221, v221 row_shr:8 row_mask:0xf bank_mask:0xf
    s_nop 1
    v_add_u32_dpp v221, v221, v221 row_bcast:15 row_mask:0xa bank_mask:0xf
    s_nop 1
    v_add_u32_dpp v221, v221, v221 row_bcast:31 row_mask:0xc bank_mask:0xf
    v_sub_u32 v80, v221, v220
    v_add_u32 v81, v80, v76
    v_add_u32 v82, v80, v82
    v_add_u32 v83, v80, v83
    s_movk_i32 s95, 2560
    v_lshl_add_u32 v60, v80, 3, s95
    v_lshl_add_u32 v61, v44, 3, v60
    v_lshl_add_u32 v62, v45, 3, v61
    v_lshl_add_u32 v63, v46, 3, v62
    ds_write_b128 v203, v[60:63] offset:34816
    v_lshl_add_u32 v64, v81, 3, s95
    v_lshl_add_u32 v65, v48, 3, v64
    v_lshl_add_u32 v66, v49, 3, v65
    v_lshl_add_u32 v67, v50, 3, v66
    ds_write_b128 v203, v[64:67] offset:35840
    v_lshl_add_u32 v68, v82, 3, s95
    v_lshl_add_u32 v69, v52, 3, v68
    v_lshl_add_u32 v70, v53, 3, v69
    v_lshl_add_u32 v71, v54, 3, v70
    ds_write_b128 v203, v[68:71] offset:36864
    v_lshl_add_u32 v72, v83, 3, s95
    v_lshl_add_u32 v73, v56, 3, v72
    v_lshl_add_u32 v74, v57, 3, v73
    v_lshl_add_u32 v75, v58, 3, v74
    ds_write_b128 v203, v[72:75] offset:37888
    s_mov_b32 exec_lo, 0
    s_brev_b32 exec_hi, 1
    ds_write_b32 v228, v221 offset:100
    s_mov_b64 exec, -1
K2_W2:
    s_cmp_ge_u32 s5, 6
    s_cbranch_scc1 K2_NWH
    s_mul_i32 s95, s5, 2048
    s_add_u32 m0, s95, 125952
    s_add_u32 s95, s95, 7561216
    buffer_load_dwordx4 v203, s[20:23], s95 offen offset:0 lds
    buffer_load_dwordx4 v203, s[20:23], s95 offen offset:1024 lds
K2_NWH:
    s_cmp_eq_u32 s5, 0
    s_cbranch_scc1 K2_NFT
    s_mov_b32 s95, 0xc0000
    s_mov_b64 exec, s[32:33]
    v_and_or_b32 v140, v45, s95, v172
    v_lshrrev_b32 v141, 17, v45
    v_cmpx_gt_u32 vcc, 1, v140
    ds_write_b64 v141, v[44:45] offset:38912
    s_mov_b64 exec, s[34:35]
    v_and_or_b32 v142, v47, s95, v173
    v_lshrrev_b32 v143, 17, v47
    v_cmpx_gt_u32 vcc, 1, v142
    ds_write_b64 v143, v[46:47] offset:38912
    s_mov_b64 exec, s[36:37]
    v_and_or_b32 v144, v49, s95, v174
    v_lshrrev_b32 v145, 17, v49
    v_cmpx_gt_u32 vcc, 1, v144
    ds_write_b64 v145, v[48:49] offset:38912
    s_mov_b64 exec, s[38:39]
    v_and_or_b32 v146, v51, s95, v175
    v_lshrrev_b32 v147, 17, v51
    v_cmpx_gt_u32 vcc, 1, v146
    ds_write_b64 v147, v[50:51] offset:38912
    s_mov_b64 exec, s[40:41]
    v_and_or_b32 v148, v53, s95, v176
    v_lshrrev_b32 v149, 17, v53
    v_cmpx_gt_u32 vcc, 1, v148
    ds_write_b64 v149, v[52:53] offset:38912
    s_mov_b64 exec, s[42:43]
    v_and_or_b32 v150, v55, s95, v177
    v_lshrrev_b32 v151, 17, v55
    v_cmpx_gt_u32 vcc, 1, v150
    ds_write_b64 v151, v[54:55] offset:38912
    s_mov_b64 exec, s[44:45]
    v_and_or_b32 v152, v57, s95, v178
    v_lshrrev_b32 v153, 17, v57
    v_cmpx_gt_u32 vcc, 1, v152
    ds_write_b64 v153, v[56:57] offset:38912
    s_mov_b64 exec, s[46:47]
    v_and_or_b32 v154, v59, s95, v179
    v_lshrrev_b32 v155, 17, v59
    v_cmpx_gt_u32 vcc, 1, v154
    ds_write_b64 v155, v[58:59] offset:38912
    s_mov_b64 exec, s[48:49]
    v_and_or_b32 v156, v61, s95, v180
    v_lshrrev_b32 v157, 17, v61
    v_cmpx_gt_u32 vcc, 1, v156
    ds_write_b64 v157, v[60:61] offset:38912
    s_mov_b64 exec, -1
    s_mul_i32 s95, s5, 224
    v_lshrrev_b32 v140, 1, v203
    v_add_u32 v140, s95, v140
K2_NFT:
    s_cmp_eq_u32 s5, 0
    s_waitcnt lgkmcnt(0)
    s_barrier
    ds_read_b64 v[232:233], v228 offset:96
    s_cbranch_scc1 K2_NOS1
    ds_read_b64 v[140:141], v140 offset:38688
    s_mov_b64 exec, s[32:33]
    v_lshrrev_b32 v98, 16, v45
    ds_read_b32 v98, v98 offset:34816
    s_mov_b64 exec, s[34:35]
    v_lshrrev_b32 v99, 16, v47
    ds_read_b32 v99, v99 offset:34816
    s_mov_b64 exec, s[36:37]
    v_lshrrev_b32 v100, 16, v49
    ds_read_b32 v100, v100 offset:34816
    s_mov_b64 exec, s[38:39]
    v_lshrrev_b32 v101, 16, v51
    ds_read_b32 v101, v101 offset:34816
    s_mov_b64 exec, s[40:41]
    v_lshrrev_b32 v102, 16, v53
    ds_read_b32 v102, v102 offset:34816
    s_mov_b64 exec, s[42:43]
    v_lshrrev_b32 v103, 16, v55
    ds_read_b32 v103, v103 offset:34816
    s_mov_b64 exec, s[44:45]
    v_lshrrev_b32 v104, 16, v57
    ds_read_b32 v104, v104 offset:34816
    s_mov_b64 exec, s[46:47]
    v_lshrrev_b32 v105, 16, v59
    ds_read_b32 v105, v105 offset:34816
    s_mov_b64 exec, s[48:49]
    v_lshrrev_b32 v106, 16, v61
    ds_read_b32 v106, v106 offset:34816
    s_mov_b64 exec, -1
    s_waitcnt lgkmcnt(9)
    v_and_b32 v141, 0xffff, v141
    s_mov_b64 exec, 0xfffffff
    buffer_load_dword v202, v140, s[12:15], 0 idxen
    buffer_load_dword v202, v141, s[8:11], 0 idxen
    buffer_load_dword v202, v141, s[16:19], 0 idxen
    s_mov_b64 exec, s[50:51]
    s_cbranch_execz K2_G37
    v_lshrrev_b32 v220, 16, v63
    ds_read_b32 v220, v220 offset:34816
K2_G37:
    s_mov_b64 exec, s[52:53]
    s_cbranch_execz K2_G38
    v_lshrrev_b32 v221, 16, v65
    ds_read_b32 v221, v221 offset:34816
K2_G38:
    s_mov_b64 exec, s[54:55]
    s_cbranch_execz K2_G39
    v_lshrrev_b32 v222, 16, v67
    ds_read_b32 v222, v222 offset:34816
K2_G39:
    s_mov_b64 exec, s[56:57]
    s_cbranch_execz K2_G40
    v_lshrrev_b32 v223, 16, v69
    ds_read_b32 v223, v223 offset:34816
K2_G40:
    s_mov_b64 exec, s[58:59]
    s_cbranch_execz K2_G41
    v_lshrrev_b32 v224, 16, v71
    ds_read_b32 v224, v224 offset:34816
K2_G41:
    s_mov_b64 exec, s[60:61]
    s_cbranch_execz K2_G42
    v_lshrrev_b32 v225, 16, v73
    ds_read_b32 v225, v225 offset:34816
K2_G42:
    s_mov_b64 exec, s[62:63]
    s_cbranch_execz K2_G43
    v_lshrrev_b32 v226, 16, v75
    ds_read_b32 v226, v226 offset:34816
K2_G43:
    s_mov_b64 exec, s[64:65]
    s_cbranch_execz K2_G44
    v_lshrrev_b32 v227, 16, v77
    ds_read_b32 v227, v227 offset:34816
K2_G44:
    s_mov_b64 exec, s[66:67]
    s_cbranch_execz K2_G45
    v_lshrrev_b32 v228, 16, v79
    ds_read_b32 v228, v228 offset:34816
K2_G45:
    s_mov_b64 exec, -1
K2_NOS1:
    s_waitcnt lgkmcnt(0)
    v_readfirstlane_b32 s98, v233
    v_readfirstlane_b32 s93, v232
    s_cmp_le_u32 s98, 3776
    s_cbranch_scc1 K2_FITS
    s_cmp_eq_u32 s92, 15
    s_cbranch_scc1 K2_END0
    s_mov_b32 s92, 15
    s_waitcnt vmcnt(0)
    s_barrier
    s_branch K2_TOP
K2_FITS:
    s_cmp_eq_u32 s5, 0
    s_cbranch_scc1 K2_PLAN
    s_mov_b64 exec, s[32:33]
    v_lshl_add_u32 v98, v172, 3, v98
    ds_write_b64 v98, v[44:45]
    s_mov_b64 exec, s[34:35]
    v_lshl_add_u32 v99, v173, 3, v99
    ds_write_b64 v99, v[46:47]
    s_mov_b64 exec, s[36:37]
    v_lshl_add_u32 v100, v174, 3, v100
    ds_write_b64 v100, v[48:49]
    s_mov_b64 exec, s[38:39]
    v_lshl_add_u32 v101, v175, 3, v101
    ds_write_b64 v101, v[50:51]
    s_mov_b64 exec, s[40:41]
    v_lshl_add_u32 v102, v176, 3, v102
    ds_write_b64 v102, v[52:53]
    s_mov_b64 exec, s[42:43]
    v_lshl_add_u32 v103, v177, 3, v103
    ds_write_b64 v103, v[54:55]
    s_mov_b64 exec, s[44:45]
    v_lshl_add_u32 v104, v178, 3, v104
    ds_write_b64 v104, v[56:57]
    s_mov_b64 exec, s[46:47]
    v_lshl_add_u32 v105, v179, 3, v105
    ds_write_b64 v105, v[58:59]
    s_mov_b64 exec, s[48:49]
    v_lshl_add_u32 v106, v180, 3, v106
    ds_write_b64 v106, v[60:61]
    s_mov_b64 exec, s[50:51]
    s_cbranch_execz K2_G46
    v_lshl_add_u32 v220, v181, 3, v220
    ds_write_b64 v220, v[62:63]
K2_G46:
    s_mov_b64 exec, s[52:53]
    s_cbranch_execz K2_G47
    v_lshl_add_u32 v221, v182, 3, v221
    ds_write_b64 v221, v[64:65]
K2_G47:
    s_mov_b64 exec, s[54:55]
    s_cbranch_execz K2_G48
    v_lshl_add_u32 v222, v183, 3, v222
    ds_write_b64 v222, v[66:67]
K2_G48:
    s_mov_b64 exec, s[56:57]
    s_cbranch_execz K2_G49
    v_lshl_add_u32 v223, v184, 3, v223
    ds_write_b64 v223, v[68:69]
K2_G49:
    s_mov_b64 exec, s[58:59]
    s_cbranch_execz K2_G50
    v_lshl_add_u32 v224, v185, 3, v224
    ds_write_b64 v224, v[70:71]
K2_G50:
    s_mov_b64 exec, s[60:61]
    s_cbranch_execz K2_G51
    v_lshl_add_u32 v225, v186, 3, v225
    ds_write_b64 v225, v[72:73]
K2_G51:
    s_mov_b64 exec, s[62:63]
    s_cbranch_execz K2_G52
    v_lshl_add_u32 v226, v187, 3, v226
    ds_write_b64 v226, v[74:75]
K2_G52:
    s_mov_b64 exec, s[64:65]
    s_cbranch_execz K2_G53
    v_lshl_add_u32 v227, v188, 3, v227
    ds_write_b64 v227, v[76:77]
K2_G53:
    s_mov_b64 exec, s[66:67]
    s_cbranch_execz K2_G54
    v_lshl_add_u32 v228, v189, 3, v228
    ds_write_b64 v228, v[78:79]
K2_G54:
    s_cmp_eq_u32 s97, 0
    s_cbranch_scc1 K2_B3
    s_mov_b64 exec, s[68:69]
    s_cbranch_execz K2_G55
    v_lshrrev_b32 v98, 16, v81
    ds_read_b32 v98, v98 offset:34816
K2_G55:
    s_mov_b64 exec, s[70:71]
    s_cbranch_execz K2_G56
    v_lshrrev_b32 v99, 16, v83
    ds_read_b32 v99, v99 offset:34816
K2_G56:
    s_mov_b64 exec, s[72:73]
    s_cbranch_execz K2_G57
    v_lshrrev_b32 v100, 16, v85
    ds_read_b32 v100, v100 offset:34816
K2_G57:
    s_mov_b64 exec, s[74:75]
    s_cbranch_execz K2_G58
    v_lshrrev_b32 v101, 16, v87
    ds_read_b32 v101, v101 offset:34816
K2_G58:
    s_mov_b64 exec, s[76:77]
    s_cbranch_execz K2_G59
    v_lshrrev_b32 v102, 16, v89
    ds_read_b32 v102, v102 offset:34816
K2_G59:
    s_mov_b64 exec, s[78:79]
    s_cbranch_execz K2_G60
    v_lshrrev_b32 v103, 16, v91
    ds_read_b32 v103, v103 offset:34816
K2_G60:
    s_mov_b64 exec, s[80:81]
    s_cbranch_execz K2_G61
    v_lshrrev_b32 v104, 16, v93
    ds_read_b32 v104, v104 offset:34816
K2_G61:
    s_mov_b64 exec, s[82:83]
    s_cbranch_execz K2_G62
    v_lshrrev_b32 v105, 16, v95
    ds_read_b32 v105, v105 offset:34816
K2_G62:
    s_mov_b64 exec, s[84:85]
    s_cbranch_execz K2_G63
    v_lshrrev_b32 v106, 16, v97
    ds_read_b32 v106, v106 offset:34816
K2_G63:
    s_waitcnt lgkmcnt(0)
    s_mov_b64 exec, s[68:69]
    s_cbranch_execz K2_G64
    v_lshl_add_u32 v98, v190, 3, v98
    ds_write_b64 v98, v[80:81]
K2_G64:
    s_mov_b64 exec, s[70:71]
    s_cbranch_execz K2_G65
    v_lshl_add_u32 v99, v191, 3, v99
    ds_write_b64 v99, v[82:83]
K2_G65:
    s_mov_b64 exec, s[72:73]
    s_cbranch_execz K2_G66
    v_lshl_add_u32 v100, v192, 3, v100
    ds_write_b64 v100, v[84:85]
K2_G66:
    s_mov_b64 exec, s[74:75]
    s_cbranch_execz K2_G67
    v_lshl_add_u32 v101, v193, 3, v101
    ds_write_b64 v101, v[86:87]
K2_G67:
    s_mov_b64 exec, s[76:77]
    s_cbranch_execz K2_G68
    v_lshl_add_u32 v102, v194, 3, v102
    ds_write_b64 v102, v[88:89]
K2_G68:
    s_mov_b64 exec, s[78:79]
    s_cbranch_execz K2_G69
    v_lshl_add_u32 v103, v195, 3, v103
    ds_write_b64 v103, v[90:91]
K2_G69:
    s_mov_b64 exec, s[80:81]
    s_cbranch_execz K2_G70
    v_lshl_add_u32 v104, v196, 3, v104
    ds_write_b64 v104, v[92:93]
K2_G70:
    s_mov_b64 exec, s[82:83]
    s_cbranch_execz K2_G71
    v_lshl_add_u32 v105, v197, 3, v105
    ds_write_b64 v105, v[94:95]
K2_G71:
    s_mov_b64 exec, s[84:85]
    s_cbranch_execz K2_G72
    v_lshl_add_u32 v106, v198, 3, v106
    ds_write_b64 v106, v[96:97]
K2_G72:
    s_branch K2_B3
K2_PLAN:
    s_mul_i32 s99, s98, 3
    s_lshr_b32 s99, s99, 9
    s_max_u32 s99, s99, 1
    v_cvt_f32_u32 v84, v76
    v_add_f32 v84, -0.5, v84
    v_max_f32 v104, v104, v84
    v_cvt_f32_u32 v85, v77
    v_add_f32 v85, -0.5, v85
    v_max_f32 v105, v105, v85
    v_cvt_f32_u32 v86, v78
    v_add_f32 v86, -0.5, v86
    v_max_f32 v106, v106, v86
    v_cvt_f32_u32 v87, v79
    v_add_f32 v87, -0.5, v87
    v_max_f32 v107, v107, v87
K2_DLOOP:
    v_cvt_f32_u32 v220, s99
    v_rcp_f32 v221, v220
    v_add_f32 v88, v104, v220
    v_add_f32 v89, v105, v220
    v_add_f32 v90, v106, v220
    v_add_f32 v91, v107, v220
    v_mul_f32 v88, v88, v221
    v_cvt_u32_f32 v88, v88
    v_mul_f32 v89, v89, v221
    v_cvt_u32_f32 v89, v89
    v_mul_f32 v90, v90, v221
    v_cvt_u32_f32 v90, v90
    v_mul_f32 v91, v91, v221
    v_cvt_u32_f32 v91, v91
    v_add_u32 v222, v88, v89
    v_add3_u32 v222, v222, v90, v91
    s_nop 1
    v_add_u32_dpp v222, v222, v222 row_shr:1 row_mask:0xf bank_mask:0xf
    s_nop 1
    v_add_u32_dpp v222, v222, v222 row_shr:2 row_mask:0xf bank_mask:0xf
    s_nop 1
    v_add_u32_dpp v222, v222, v222 row_shr:4 row_mask:0xf bank_mask:0xf
    s_nop 1
    v_add_u32_dpp v222, v222, v222 row_shr:8 row_mask:0xf bank_mask:0xf
    s_nop 1
    v_add_u32_dpp v222, v222, v222 row_bcast:15 row_mask:0xa bank_mask:0xf
    s_nop 1
    v_add_u32_dpp v222, v222, v222 row_bcast:31 row_mask:0xc bank_mask:0xf
    s_nop 0
    v_readlane_b32 s95, v222, 63
    s_add_u32 s99, s99, 1
    s_cmp_gt_u32 s95, 255
    s_cbranch_scc1 K2_DLOOP
    v_cvt_f32_u32 v92, v88
    v_rcp_f32 v96, v92
    v_add_f32 v92, v92, v84
    v_cmp_eq_u32_e64 s[48:49], 1, v88
    v_lshlrev_b32 v44, 16, v88
    v_cvt_f32_u32 v93, v89
    v_rcp_f32 v97, v93
    v_add_f32 v93, v93, v85
    v_cmp_eq_u32_e64 s[50:51], 1, v89
    v_lshlrev_b32 v45, 16, v89
    v_cvt_f32_u32 v94, v90
    v_rcp_f32 v98, v94
    v_add_f32 v94, v94, v86
    v_cmp_eq_u32_e64 s[52:53], 1, v90
    v_lshlrev_b32 v46, 16, v90
    v_cvt_f32_u32 v95, v91
    v_rcp_f32 v99, v95
    v_add_f32 v95, v95, v87
    v_cmp_eq_u32_e64 s[54:55], 1, v91
    v_lshlrev_b32 v47, 16, v91
    v_cndmask_b32_e64 v44, v44, 1, s[48:49]
    v_cndmask_b32_e64 v45, v45, 1, s[50:51]
    v_cndmask_b32_e64 v46, v46, 1, s[52:53]
    v_cndmask_b32_e64 v47, v47, 1, s[54:55]
    v_mul_f32 v92, v92, v96
    v_cvt_u32_f32 v92, v92
    v_sub_u32 v96, 63, v92
    v_lshlrev_b32 v96, 2, v96
    ds_add_rtn_u32 v100, v96, v44 offset:128
    v_mul_f32 v93, v93, v97
    v_cvt_u32_f32 v93, v93
    v_sub_u32 v97, 63, v93
    v_lshlrev_b32 v97, 2, v97
    ds_add_rtn_u32 v101, v97, v45 offset:128
    v_mul_f32 v94, v94, v98
    v_cvt_u32_f32 v94, v94
    v_sub_u32 v98, 63, v94
    v_lshlrev_b32 v98, 2, v98
    ds_add_rtn_u32 v102, v98, v46 offset:128
    v_mul_f32 v95, v95, v99
    v_cvt_u32_f32 v95, v95
    v_sub_u32 v99, 63, v95
    v_lshlrev_b32 v99, 2, v99
    ds_add_rtn_u32 v103, v99, v47 offset:128
    v_lshrrev_b32 v220, 2, v203
    ds_read_b32 v221, v220 offset:128
    v_add_u32 v222, 0, v250
    v_lshl_or_b32 v172, v222, 24, v60
    v_lshl_or_b32 v172, v92, 18, v172
    v_lshlrev_b32 v173, 3, v88
    v_sub_u32 v222, 1, v92
    v_mad_i32_i24 v76, v222, v88, v76
    v_add_u32 v222, 64, v250
    v_lshl_or_b32 v174, v222, 24, v64
    v_lshl_or_b32 v174, v93, 18, v174
    v_lshlrev_b32 v175, 3, v89
    v_sub_u32 v222, 1, v93
    v_mad_i32_i24 v77, v222, v89, v77
    v_add_u32 v222, 128, v250
    v_lshl_or_b32 v176, v222, 24, v68
    v_lshl_or_b32 v176, v94, 18, v176
    v_lshlrev_b32 v177, 3, v90
    v_sub_u32 v222, 1, v94
    v_mad_i32_i24 v78, v222, v90, v78
    v_add_u32 v222, 192, v250
    v_lshl_or_b32 v178, v222, 24, v72
    v_lshl_or_b32 v178, v95, 18, v178
    v_lshlrev_b32 v179, 3, v91
    v_sub_u32 v222, 1, v95
    v_mad_i32_i24 v79, v222, v91, v79
    v_max3_u32 v224, v88, v89, v90
    v_max_u32 v224, v224, v91
    v_mov_b32 v225, -262136
    s_mov_b32 s99, 0
    s_waitcnt lgkmcnt(0)
    v_mov_b32 v222, v221
    v_and_b32 v57, 0xffff, v221
    v_cmp_ne_u32 vcc, 0, v57
    v_and_b32 v52, 0xffff, v100
    v_lshrrev_b32 v100, 16, v100
    v_add_u32_dpp v222, v222, v222 row_shr:1 row_mask:0xf bank_mask:0xf
    v_min_u32 v48, 1, v52
    v_cndmask_b32_e64 v100, v100, v52, s[48:49]
    v_add_u32_dpp v222, v222, v222 row_shr:2 row_mask:0xf bank_mask:0xf
    v_mad_i32_i24 v48, v48, -10, 20
    v_cndmask_b32_e64 v48, 0, v48, s[48:49]
    v_add_u32_dpp v222, v222, v222 row_shr:4 row_mask:0xf bank_mask:0xf
    v_and_b32 v53, 0xffff, v101
    v_lshrrev_b32 v101, 16, v101
    v_add_u32_dpp v222, v222, v222 row_shr:8 row_mask:0xf bank_mask:0xf
    v_min_u32 v49, 1, v53
    v_cndmask_b32_e64 v101, v101, v53, s[50:51]
    v_add_u32_dpp v222, v222, v222 row_bcast:15 row_mask:0xa bank_mask:0xf
    v_mad_i32_i24 v49, v49, -10, 20
    v_cndmask_b32_e64 v49, 0, v49, s[50:51]
    v_add_u32_dpp v222, v222, v222 row_bcast:31 row_mask:0xc bank_mask:0xf
    v_lshrrev_b32 v58, 16, v222
    v_cndmask_b32 v56, 0, v58, vcc
    v_sub_u32 v222, v222, v221
    v_and_b32 v54, 0xffff, v102
    v_lshrrev_b32 v102, 16, v102
    v_max_u32_dpp v56, v56, v56 row_shr:1 row_mask:0xf bank_mask:0xf
    v_min_u32 v50, 1, v54
    v_cndmask_b32_e64 v102, v102, v54, s[52:53]
    v_max_u32_dpp v56, v56, v56 row_shr:2 row_mask:0xf bank_mask:0xf
    v_mad_i32_i24 v50, v50, -10, 20
    v_cndmask_b32_e64 v50, 0, v50, s[52:53]
    v_max_u32_dpp v56, v56, v56 row_shr:4 row_mask:0xf bank_mask:0xf
    v_and_b32 v55, 0xffff, v103
    v_lshrrev_b32 v103, 16, v103
    v_max_u32_dpp v56, v56, v56 row_shr:8 row_mask:0xf bank_mask:0xf
    v_min_u32 v51, 1, v55
    v_cndmask_b32_e64 v103, v103, v55, s[54:55]
    v_max_u32_dpp v56, v56, v56 row_bcast:15 row_mask:0xa bank_mask:0xf
    v_mad_i32_i24 v51, v51, -10, 20
    v_cndmask_b32_e64 v51, 0, v51, s[54:55]
    v_max_u32_dpp v56, v56, v56 row_bcast:31 row_mask:0xc bank_mask:0xf
    v_and_b32 v57, 0xffff, v222
    v_and_b32 v221, 1, v222
    v_mov_b32_dpp v56, v56 wave_shr:1 row_mask:0xf bank_mask:0xf
    v_cmp_eq_u32 vcc, 1, v221
    v_lshrrev_b32 v222, 16, v222
    v_add3_u32 v222, v222, v57, v221
    v_cndmask_b32 v56, v58, v56, vcc
    v_add_u32 v58, v58, v57
    v_add_u32 v56, v56, v57
    v_lshl_or_b32 v222, v58, 10, v222
    v_lshl_or_b32 v222, v56, 20, v222
    ds_bpermute_b32 v96, v96, v222
    ds_bpermute_b32 v97, v97, v222
    ds_bpermute_b32 v98, v98, v222
    ds_bpermute_b32 v99, v99, v222
    s_waitcnt lgkmcnt(3)
    v_bfe_u32 v96, v96, v48, 10
    v_add_lshl_u32 v96, v96, v100, 2
    v_lshl_or_b32 v222, v88, 16, v96
    v_lshlrev_b32 v96, 1, v96
    ds_write_b32 v220, v222 offset:32768
    s_waitcnt lgkmcnt(3)
    v_bfe_u32 v97, v97, v49, 10
    v_add_lshl_u32 v97, v97, v101, 2
    v_lshl_or_b32 v222, v89, 16, v97
    v_lshlrev_b32 v97, 1, v97
    ds_write_b32 v220, v222 offset:33024
    s_waitcnt lgkmcnt(3)
    v_bfe_u32 v98, v98, v50, 10
    v_add_lshl_u32 v98, v98, v102, 2
    v_lshl_or_b32 v222, v90, 16, v98
    v_lshlrev_b32 v98, 1, v98
    ds_write_b32 v220, v222 offset:33280
    s_waitcnt lgkmcnt(3)
    v_bfe_u32 v99, v99, v51, 10
    v_add_lshl_u32 v99, v99, v103, 2
    v_lshl_or_b32 v222, v91, 16, v99
    v_lshlrev_b32 v99, 1, v99
    ds_write_b32 v220, v222 offset:33536
K2_PLOOP:
    v_cmp_lt_u32_e64 s[32:33], s99, v88
    v_cmp_lt_u32_e64 s[34:35], s99, v89
    v_cmp_lt_u32_e64 s[36:37], s99, v90
    v_cmp_lt_u32_e64 s[38:39], s99, v91
    s_add_u32 s99, s99, 1
    v_cmp_eq_u32_e64 s[40:41], s99, v76
    v_cmp_eq_u32_e64 s[42:43], s99, v77
    v_cmp_eq_u32_e64 s[44:45], s99, v78
    v_cmp_eq_u32_e64 s[46:47], s99, v79
    s_mov_b64 exec, s[32:33]
    ds_write_b64 v96, v[172:173] offset:512
    s_mov_b64 exec, s[34:35]
    ds_write_b64 v97, v[174:175] offset:512
    s_mov_b64 exec, s[36:37]
    ds_write_b64 v98, v[176:177] offset:512
    s_mov_b64 exec, s[38:39]
    ds_write_b64 v99, v[178:179] offset:512
    s_mov_b64 exec, -1
    v_cmp_lt_u32 vcc, s99, v224
    v_cndmask_b32_e64 v222, 8, v225, s[40:41]
    v_add_u32 v172, v172, v222
    v_add_u32 v96, 8, v96
    v_cndmask_b32_e64 v222, 8, v225, s[42:43]
    v_add_u32 v174, v174, v222
    v_add_u32 v97, 8, v97
    v_cndmask_b32_e64 v222, 8, v225, s[44:45]
    v_add_u32 v176, v176, v222
    v_add_u32 v98, 8, v98
    v_cndmask_b32_e64 v222, 8, v225, s[46:47]
    v_add_u32 v178, v178, v222
    v_add_u32 v99, 8, v99
    s_cbranch_vccnz K2_PLOOP
    v_mov_b32 v222, s99
    ds_write_b32 v228, v222 offset:104
    s_waitcnt vmcnt(0)
K2_B3:
    s_mov_b64 exec, -1
    s_lshl_b32 s95, s100, 8
    v_and_b32 v220, 31, v250
    v_lshl_add_u32 v220, v220, 3, s95
    s_mov_b32 s6, 0
    s_waitcnt vmcnt(3) lgkmcnt(0)
    s_barrier
    ds_read_b64 v[220:221], v220 offset:512
    ds_read_b32 v222, v229 offset:104
    s_waitcnt lgkmcnt(0)
    v_bfe_u32 v235, v220, 18, 6
    v_and_b32 v207, 0x3ffff, v220
    v_lshrrev_b32 v249, 24, v220
    v_mov_b32 v206, v221
    v_readfirstlane_b32 s97, v222
    v_cmp_lt_u32_e64 s[28:29], s6, v235
    s_add_u32 s6, s6, 1
    v_add_u32 v221, s4, v249
    buffer_load_dwordx2 v[240:241], v221, s[16:19], 0 idxen
    v_cndmask_b32_e64 v203, 0, v207, s[28:29]
    v_add_u32 v207, v207, v206
    ds_read_b32 v218, v203
    ds_read_u16 v203, v203 offset:4
    v_bfe_u32 v220, v249, 1, 3
    v_lshlrev_b32 v220, 4, v220
    v_lshlrev_b32 v221, 2, v219
    v_xor_b32 v220, v220, v221
    v_lshl_add_u32 v220, v249, 7, v220
    v_add_u32 v220, 100352, v220
    v_xor_b32 v221, 16, v220
    v_xor_b32 v222, 32, v220
    v_xor_b32 v223, 48, v220
    s_waitcnt lgkmcnt(0)
    ds_bpermute_b32 v210, v239, v203 offset:0
    ds_bpermute_b32 v212, v239, v203 offset:32
    ds_bpermute_b32 v214, v239, v203 offset:64
    ds_bpermute_b32 v216, v239, v203 offset:96
    ds_read_b128 v[172:175], v220
    ds_read_b128 v[176:179], v221
    ds_read_b128 v[180:183], v222
    ds_read_b128 v[184:187], v223
    buffer_load_dwordx4 v[188:191], v[218:219], s[12:15], 0 idxen offen
    buffer_load_dwordx2 v[200:201], v203, s[16:19], 0 idxen
    v_cmp_lt_u32_e64 s[30:31], s6, v235
    s_add_u32 s6, s6, 1
    s_cmp_eq_u64 s[28:29], 0
    s_cbranch_scc1 K2_EMPTY
    s_waitcnt lgkmcnt(4)
    s_add_u32 m0, s94, 0
    s_nop 0
    buffer_load_dwordx4 v[210:211], s[8:11], 0 idxen offen lds
    s_add_u32 m0, s94, 1024
    s_nop 0
    buffer_load_dwordx4 v[212:213], s[8:11], 0 idxen offen lds
    s_add_u32 m0, s94, 2048
    s_nop 0
    buffer_load_dwordx4 v[214:215], s[8:11], 0 idxen offen lds
    s_add_u32 m0, s94, 3072
    s_nop 0
    buffer_load_dwordx4 v[216:217], s[8:11], 0 idxen offen lds
    v_cndmask_b32_e64 v203, 0, v207, s[30:31]
    v_add_u32 v207, v207, v206
    ds_read_b32 v218, v203
    ds_read_u16 v203, v203 offset:4
    s_waitcnt lgkmcnt(0)
    ds_bpermute_b32 v210, v239, v203 offset:0
    ds_bpermute_b32 v212, v239, v203 offset:32
    ds_bpermute_b32 v214, v239, v203 offset:64
    ds_bpermute_b32 v216, v239, v203 offset:96
    buffer_load_dwordx4 v[192:195], v[218:219], s[12:15], 0 idxen offen
    buffer_load_dwordx2 v[204:205], v203, s[16:19], 0 idxen
    v_cmp_lt_u32_e64 s[32:33], s6, v235
    s_add_u32 s6, s6, 1
    s_waitcnt lgkmcnt(0)
    s_add_u32 m0, s94, 32768
    s_nop 0
    buffer_load_dwordx4 v[210:211], s[8:11], 0 idxen offen lds
    s_add_u32 m0, s94, 33792
    s_nop 0
    buffer_load_dwordx4 v[212:213], s[8:11], 0 idxen offen lds
    s_add_u32 m0, s94, 34816
    s_nop 0
    buffer_load_dwordx4 v[214:215], s[8:11], 0 idxen offen lds
    s_add_u32 m0, s94, 35840
    s_nop 0
    buffer_load_dwordx4 v[216:217], s[8:11], 0 idxen offen lds
    v_cndmask_b32_e64 v203, 0, v207, s[32:33]
    v_add_u32 v207, v207, v206
    ds_read_b32 v218, v203
    ds_read_u16 v203, v203 offset:4
    s_waitcnt lgkmcnt(0)
    ds_bpermute_b32 v210, v239, v203 offset:0
    ds_bpermute_b32 v212, v239, v203 offset:32
    ds_bpermute_b32 v214, v239, v203 offset:64
    ds_bpermute_b32 v216, v239, v203 offset:96
    v_and_b32 v221, 63, v250
    v_lshlrev_b32 v220, 4, v221
    v_lshlrev_b32 v221, 2, v221
    v_add_u32 v220, 138240, v220
    v_lshlrev_b32 v222, 3, v219
    v_add_u32 v221, 156672, v221
    v_add_u32 v222, 157696, v222
    ds_read_b128 v[140:143], v220 offset:0
    ds_read_b128 v[144:147], v220 offset:1024
    ds_read_b128 v[148:151], v220 offset:2048
    ds_read_b128 v[152:155], v220 offset:3072
    ds_read_b128 v[156:159], v220 offset:4096
    ds_read_b128 v[160:163], v220 offset:5120
    ds_read_b128 v[164:167], v220 offset:6144
    ds_read_b128 v[168:171], v220 offset:7168
    ds_read_b128 v[0:3], v220 offset:8192
    ds_read_b128 v[4:7], v220 offset:9216
    ds_read_b128 v[8:11], v220 offset:10240
    ds_read_b128 v[12:15], v220 offset:11264
    ds_read_b128 v[16:19], v220 offset:12288
    ds_read_b128 v[20:23], v220 offset:13312
    ds_read_b128 v[24:27], v220 offset:14336
    ds_read_b128 v[28:31], v220 offset:15360
    ds_read_b128 v[32:35], v220 offset:16384
    ds_read_b128 v[36:39], v220 offset:17408
    ds_read_b32 v40, v221
    ds_read_b32 v42, v221 offset:256
    ds_read_b128 v[108:111], v222 offset:0
    ds_read_b128 v[112:115], v222 offset:16
    ds_read_b128 v[116:119], v222 offset:32
    ds_read_b128 v[120:123], v222 offset:48
    ds_read_b128 v[124:127], v222 offset:64
    ds_read_b128 v[128:131], v222 offset:80
    ds_read_b128 v[132:135], v222 offset:96
    ds_read_b128 v[136:139], v222 offset:112
    v_mov_b32 v76, 0
    v_mov_b32 v77, 0
    v_mov_b32 v78, 0
    v_mov_b32 v79, 0
    v_mov_b32 v80, 0
    v_mov_b32 v81, 0
    v_mov_b32 v82, 0
    v_mov_b32 v83, 0
    v_mov_b32 v84, 0
    v_mov_b32 v85, 0
    v_mov_b32 v86, 0
    v_mov_b32 v87, 0
    v_mov_b32 v88, 0
    v_mov_b32 v89, 0
    v_mov_b32 v90, 0
    v_mov_b32 v91, 0
    v_mov_b32 v92, 0
    v_mov_b32 v93, 0
    v_mov_b32 v94, 0
    v_mov_b32 v95, 0
    v_mov_b32 v96, 0
    v_mov_b32 v97, 0
    v_mov_b32 v98, 0
    v_mov_b32 v99, 0
    v_mov_b32 v100, 0
    v_mov_b32 v101, 0
    v_mov_b32 v102, 0
    v_mov_b32 v103, 0
    v_mov_b32 v104, 0
    v_mov_b32 v105, 0
    v_mov_b32 v106, 0
    v_mov_b32 v107, 0
    v_mov_b32 v244, 0
    v_mov_b32 v245, 0
    v_mov_b32 v246, 0
    v_mov_b32 v247, 0
    s_waitcnt lgkmcnt(0)
    v_mfma_f32_32x32x16_bf16 v[44:59], v[140:143], v[172:175], 0
    v_mfma_f32_32x32x16_bf16 v[60:75], v[156:159], v[172:175], 0
    v_mfma_f32_32x32x16_bf16 v[44:59], v[144:147], v[176:179], v[44:59]
    v_mfma_f32_32x32x16_bf16 v[60:75], v[160:163], v[176:179], v[60:75]
    v_mfma_f32_32x32x16_bf16 v[44:59], v[148:151], v[180:183], v[44:59]
    v_mfma_f32_32x32x16_bf16 v[60:75], v[164:167], v[180:183], v[60:75]
    v_mfma_f32_32x32x16_bf16 v[44:59], v[152:155], v[184:187], v[44:59]
    v_mfma_f32_32x32x16_bf16 v[60:75], v[168:171], v[184:187], v[60:75]
    s_waitcnt vmcnt(6)
    ds_read_b128 v[172:175], v251 offset:0
    ds_read_b128 v[176:179], v252 offset:0
    ds_read_b128 v[180:183], v253 offset:0
    ds_read_b128 v[184:187], v254 offset:0
    v_mov_b32 v242, v241
    v_and_b32 v241, 0xffff0000, v240
    v_lshlrev_b32 v240, 16, v240
    v_lshlrev_b32 v232, 16, v200
    v_and_b32 v233, 0xffff0000, v200
    v_sub_f32 v234, v242, v201
    v_pk_add_f32 v[232:233], v[240:241], v[232:233] neg_lo:[0,1] neg_hi:[0,1]
    v_mul_f32 v208, v232, v232
    v_fmac_f32 v208, v233, v233
    v_fmac_f32 v208, v234, v234
    v_cvt_pk_bf16_f32 v208, v208, v208
    s_waitcnt lgkmcnt(0)
    s_nop 0
    v_mfma_f32_32x32x8_bf16 v[140:155], v[40:41], v[208:209], v[44:59]
    v_mfma_f32_32x32x16_bf16 v[140:155], v[32:35], v[188:191], v[140:155]
    v_mfma_f32_32x32x16_bf16 v[140:155], v[0:3], v[172:175], v[140:155]
    v_mfma_f32_32x32x16_bf16 v[140:155], v[4:7], v[176:179], v[140:155]
    v_mfma_f32_32x32x16_bf16 v[140:155], v[8:11], v[180:183], v[140:155]
    v_mfma_f32_32x32x16_bf16 v[140:155], v[12:15], v[184:187], v[140:155]
    s_nop 7
K2_LOOP:
    v_mfma_f32_32x32x8_bf16 v[156:171], v[42:43], v[208:209], v[60:75]
    s_mov_b64 exec, s[28:29]
    s_nop 1
    v_exp_f32 v220, v140
    v_exp_f32 v221, v141
    v_exp_f32 v222, v142
    v_exp_f32 v223, v143
    v_mfma_f32_32x32x16_bf16 v[156:171], v[36:39], v[188:191], v[156:171]
    v_exp_f32 v224, v144
    v_exp_f32 v225, v145
    s_bitcmp1_b32 s5, 2
    s_cbranch_scc0 K2_VP1
    s_setprio 1
K2_VP1:
    s_waitcnt lgkmcnt(0)
    s_mov_b64 exec, -1
    s_add_u32 m0, s94, 0
    s_nop 0
    buffer_load_dwordx4 v[210:211], s[8:11], 0 idxen offen lds
    s_add_u32 m0, s94, 1024
    s_nop 0
    buffer_load_dwordx4 v[212:213], s[8:11], 0 idxen offen lds
    s_add_u32 m0, s94, 2048
    s_nop 0
    buffer_load_dwordx4 v[214:215], s[8:11], 0 idxen offen lds
    s_add_u32 m0, s94, 3072
    s_nop 0
    buffer_load_dwordx4 v[216:217], s[8:11], 0 idxen offen lds
    s_mov_b64 exec, s[28:29]
    s_setprio 0
    v_exp_f32 v226, v146
    v_exp_f32 v227, v147
    v_pk_add_f32 v[220:221], v[220:221], 1.0 op_sel_hi:[1,0]
    v_pk_add_f32 v[222:223], v[222:223], 1.0 op_sel_hi:[1,0]
    v_pk_add_f32 v[224:225], v[224:225], 1.0 op_sel_hi:[1,0]
    v_pk_add_f32 v[226:227], v[226:227], 1.0 op_sel_hi:[1,0]
    v_mfma_f32_32x32x16_bf16 v[156:171], v[16:19], v[172:175], v[156:171]
    v_rcp_f32 v220, v220
    v_rcp_f32 v221, v221
    v_rcp_f32 v222, v222
    v_rcp_f32 v223, v223
    v_mfma_f32_32x32x16_bf16 v[156:171], v[20:23], v[176:179], v[156:171]
    v_rcp_f32 v224, v224
    v_rcp_f32 v225, v225
    v_rcp_f32 v226, v226
    v_rcp_f32 v227, v227
    v_pk_fma_f32 v[76:77], v[140:141], v[220:221], v[76:77]
    v_pk_fma_f32 v[78:79], v[142:143], v[222:223], v[78:79]
    v_pk_fma_f32 v[80:81], v[144:145], v[224:225], v[80:81]
    v_pk_fma_f32 v[82:83], v[146:147], v[226:227], v[82:83]
    v_pk_mul_f32 v[228:229], v[76:77], v[108:109]
    v_pk_mul_f32 v[230:231], v[78:79], v[110:111]
    v_pk_fma_f32 v[228:229], v[80:81], v[112:113], v[228:229]
    v_pk_fma_f32 v[230:231], v[82:83], v[114:115], v[230:231]
    v_mfma_f32_32x32x16_bf16 v[156:171], v[24:27], v[180:183], v[156:171]
    v_exp_f32 v220, v148
    v_exp_f32 v221, v149
    v_exp_f32 v222, v150
    v_exp_f32 v223, v151
    v_mfma_f32_32x32x16_bf16 v[156:171], v[28:31], v[184:187], v[156:171]
    v_exp_f32 v224, v152
    v_exp_f32 v225, v153
    v_exp_f32 v226, v154
    buffer_load_dwordx4 v[196:199], v[218:219], s[12:15], 0 idxen offen
    buffer_load_dwordx2 v[200:201], v203, s[16:19], 0 idxen
    v_exp_f32 v227, v155
    s_waitcnt vmcnt(6)
    ds_read_b128 v[172:175], v251 offset:32768
    ds_read_b128 v[176:179], v252 offset:32768
    ds_read_b128 v[180:183], v253 offset:32768
    ds_read_b128 v[184:187], v254 offset:32768
    v_cmp_lt_u32_e64 s[34:35], s6, v235
    s_add_u32 s6, s6, 1
    v_lshlrev_b32 v236, 16, v204
    v_and_b32 v237, 0xffff0000, v204
    v_sub_f32 v238, v242, v205
    v_pk_add_f32 v[236:237], v[240:241], v[236:237] neg_lo:[0,1] neg_hi:[0,1]
    v_mul_f32 v208, v236, v236
    v_fmac_f32 v208, v237, v237
    v_fmac_f32 v208, v238, v238
    v_cvt_pk_bf16_f32 v208, v208, v208
    v_cndmask_b32_e64 v203, 0, v207, s[34:35]
    v_add_u32 v207, v207, v206
    ds_read_b32 v218, v203
    ds_read_u16 v203, v203 offset:4
    v_pk_add_f32 v[220:221], v[220:221], 1.0 op_sel_hi:[1,0]
    v_pk_add_f32 v[222:223], v[222:223], 1.0 op_sel_hi:[1,0]
    v_pk_add_f32 v[224:225], v[224:225], 1.0 op_sel_hi:[1,0]
    v_pk_add_f32 v[226:227], v[226:227], 1.0 op_sel_hi:[1,0]
    v_rcp_f32 v220, v220
    v_rcp_f32 v221, v221
    v_rcp_f32 v222, v222
    v_rcp_f32 v223, v223
    v_rcp_f32 v224, v224
    v_rcp_f32 v225, v225
    v_rcp_f32 v226, v226
    v_rcp_f32 v227, v227
    s_waitcnt lgkmcnt(0)
    s_mov_b64 exec, -1
    ds_bpermute_b32 v210, v239, v203 offset:0
    ds_bpermute_b32 v212, v239, v203 offset:32
    ds_bpermute_b32 v214, v239, v203 offset:64
    ds_bpermute_b32 v216, v239, v203 offset:96
    s_mov_b64 exec, s[28:29]
    v_pk_fma_f32 v[84:85], v[148:149], v[220:221], v[84:85]
    v_pk_fma_f32 v[86:87], v[150:151], v[222:223], v[86:87]
    v_pk_fma_f32 v[88:89], v[152:153], v[224:225], v[88:89]
    v_pk_fma_f32 v[90:91], v[154:155], v[226:227], v[90:91]
    v_pk_fma_f32 v[228:229], v[84:85], v[116:117], v[228:229]
    v_pk_fma_f32 v[230:231], v[86:87], v[118:119], v[230:231]
    v_pk_fma_f32 v[228:229], v[88:89], v[120:121], v[228:229]
    v_pk_fma_f32 v[230:231], v[90:91], v[122:123], v[230:231]
    v_mfma_f32_32x32x8_bf16 v[140:155], v[40:41], v[208:209], v[44:59]
    v_exp_f32 v220, v156
    v_exp_f32 v221, v157
    v_exp_f32 v222, v158
    v_exp_f32 v223, v159
    v_mfma_f32_32x32x16_bf16 v[140:155], v[32:35], v[192:195], v[140:155]
    v_exp_f32 v224, v160
    v_exp_f32 v225, v161
    v_exp_f32 v226, v162
    v_exp_f32 v227, v163
    v_pk_add_f32 v[220:221], v[220:221], 1.0 op_sel_hi:[1,0]
    v_pk_add_f32 v[222:223], v[222:223], 1.0 op_sel_hi:[1,0]
    v_pk_add_f32 v[224:225], v[224:225], 1.0 op_sel_hi:[1,0]
    v_pk_add_f32 v[226:227], v[226:227], 1.0 op_sel_hi:[1,0]
    v_mfma_f32_32x32x16_bf16 v[140:155], v[0:3], v[172:175], v[140:155]
    v_rcp_f32 v220, v220
    v_rcp_f32 v221, v221
    v_rcp_f32 v222, v222
    v_rcp_f32 v223, v223
    v_mfma_f32_32x32x16_bf16 v[140:155], v[4:7], v[176:179], v[140:155]
    v_rcp_f32 v224, v224
    v_rcp_f32 v225, v225
    v_rcp_f32 v226, v226
    v_rcp_f32 v227, v227
    v_pk_fma_f32 v[92:93], v[156:157], v[220:221], v[92:93]
    v_pk_fma_f32 v[94:95], v[158:159], v[222:223], v[94:95]
    v_pk_fma_f32 v[96:97], v[160:161], v[224:225], v[96:97]
    v_pk_fma_f32 v[98:99], v[162:163], v[226:227], v[98:99]
    v_pk_fma_f32 v[228:229], v[92:93], v[124:125], v[228:229]
    v_pk_fma_f32 v[230:231], v[94:95], v[126:127], v[230:231]
    v_pk_fma_f32 v[228:229], v[96:97], v[128:129], v[228:229]
    v_pk_fma_f32 v[230:231], v[98:99], v[130:131], v[230:231]
    v_mfma_f32_32x32x16_bf16 v[140:155], v[8:11], v[180:183], v[140:155]
    v_exp_f32 v220, v164
    v_exp_f32 v221, v165
    v_exp_f32 v222, v166
    v_exp_f32 v223, v167
    v_mfma_f32_32x32x16_bf16 v[140:155], v[12:15], v[184:187], v[140:155]
    v_exp_f32 v224, v168
    v_exp_f32 v225, v169
    v_exp_f32 v226, v170
    v_exp_f32 v227, v171
    v_pk_add_f32 v[220:221], v[220:221], 1.0 op_sel_hi:[1,0]
    v_pk_add_f32 v[222:223], v[222:223], 1.0 op_sel_hi:[1,0]
    v_pk_add_f32 v[224:225], v[224:225], 1.0 op_sel_hi:[1,0]
    v_pk_add_f32 v[226:227], v[226:227], 1.0 op_sel_hi:[1,0]
    v_rcp_f32 v220, v220
    v_rcp_f32 v221, v221
    v_rcp_f32 v222, v222
    v_rcp_f32 v223, v223
    v_rcp_f32 v224, v224
    v_rcp_f32 v225, v225
    v_rcp_f32 v226, v226
    v_rcp_f32 v227, v227
    v_pk_fma_f32 v[100:101], v[164:165], v[220:221], v[100:101]
    v_pk_fma_f32 v[102:103], v[166:167], v[222:223], v[102:103]
    v_pk_fma_f32 v[104:105], v[168:169], v[224:225], v[104:105]
    v_pk_fma_f32 v[106:107], v[170:171], v[226:227], v[106:107]
    v_pk_fma_f32 v[228:229], v[100:101], v[132:133], v[228:229]
    v_pk_fma_f32 v[230:231], v[102:103], v[134:135], v[230:231]
    v_pk_fma_f32 v[228:229], v[104:105], v[136:137], v[228:229]
    v_pk_fma_f32 v[230:231], v[106:107], v[138:139], v[230:231]
    v_pk_add_f32 v[228:229], v[228:229], v[230:231]
    s_cmp_eq_u64 s[30:31], 0
    v_add_f32 v243, v228, v229
    v_sub_f32 v248, v243, v247
    v_pk_fma_f32 v[244:245], v[232:233], v[248:249], v[244:245] op_sel_hi:[1,0,1]
    v_fmac_f32 v246, v234, v248
    s_mov_b64 exec, -1
    s_cbranch_scc1 K2_DONE
    v_mfma_f32_32x32x8_bf16 v[156:171], v[42:43], v[208:209], v[60:75]
    s_mov_b64 exec, s[30:31]
    v_exp_f32 v220, v140
    v_exp_f32 v221, v141
    v_exp_f32 v222, v142
    v_exp_f32 v223, v143
    v_mfma_f32_32x32x16_bf16 v[156:171], v[36:39], v[192:195], v[156:171]
    v_exp_f32 v224, v144
    v_exp_f32 v225, v145
    s_bitcmp1_b32 s5, 2
    s_cbranch_scc0 K2_VP3
    s_setprio 1
K2_VP3:
    s_waitcnt lgkmcnt(0)
    s_mov_b64 exec, -1
    s_add_u32 m0, s94, 32768
    s_nop 0
    buffer_load_dwordx4 v[210:211], s[8:11], 0 idxen offen lds
    s_add_u32 m0, s94, 33792
    s_nop 0
    buffer_load_dwordx4 v[212:213], s[8:11], 0 idxen offen lds
    s_add_u32 m0, s94, 34816
    s_nop 0
    buffer_load_dwordx4 v[214:215], s[8:11], 0 idxen offen lds
    s_add_u32 m0, s94, 35840
    s_nop 0
    buffer_load_dwordx4 v[216:217], s[8:11], 0 idxen offen lds
    s_mov_b64 exec, s[30:31]
    s_setprio 0
    v_exp_f32 v226, v146
    v_exp_f32 v227, v147
    v_pk_add_f32 v[220:221], v[220:221], 1.0 op_sel_hi:[1,0]
    v_pk_add_f32 v[222:223], v[222:223], 1.0 op_sel_hi:[1,0]
    v_pk_add_f32 v[224:225], v[224:225], 1.0 op_sel_hi:[1,0]
    v_pk_add_f32 v[226:227], v[226:227], 1.0 op_sel_hi:[1,0]
    v_mfma_f32_32x32x16_bf16 v[156:171], v[16:19], v[172:175], v[156:171]
    v_rcp_f32 v220, v220
    v_rcp_f32 v221, v221
    v_rcp_f32 v222, v222
    v_rcp_f32 v223, v223
    v_mfma_f32_32x32x16_bf16 v[156:171], v[20:23], v[176:179], v[156:171]
    v_rcp_f32 v224, v224
    v_rcp_f32 v225, v225
    v_rcp_f32 v226, v226
    v_rcp_f32 v227, v227
    v_pk_fma_f32 v[76:77], v[140:141], v[220:221], v[76:77]
    v_pk_fma_f32 v[78:79], v[142:143], v[222:223], v[78:79]
    v_pk_fma_f32 v[80:81], v[144:145], v[224:225], v[80:81]
    v_pk_fma_f32 v[82:83], v[146:147], v[226:227], v[82:83]
    v_pk_mul_f32 v[228:229], v[76:77], v[108:109]
    v_pk_mul_f32 v[230:231], v[78:79], v[110:111]
    v_pk_fma_f32 v[228:229], v[80:81], v[112:113], v[228:229]
    v_pk_fma_f32 v[230:231], v[82:83], v[114:115], v[230:231]
    v_mfma_f32_32x32x16_bf16 v[156:171], v[24:27], v[180:183], v[156:171]
    v_exp_f32 v220, v148
    v_exp_f32 v221, v149
    v_exp_f32 v222, v150
    v_exp_f32 v223, v151
    v_mfma_f32_32x32x16_bf16 v[156:171], v[28:31], v[184:187], v[156:171]
    v_exp_f32 v224, v152
    v_exp_f32 v225, v153
    v_exp_f32 v226, v154
    buffer_load_dwordx4 v[188:191], v[218:219], s[12:15], 0 idxen offen
    buffer_load_dwordx2 v[204:205], v203, s[16:19], 0 idxen
    v_exp_f32 v227, v155
    s_waitcnt vmcnt(6)
    ds_read_b128 v[172:175], v251 offset:0
    ds_read_b128 v[176:179], v252 offset:0
    ds_read_b128 v[180:183], v253 offset:0
    ds_read_b128 v[184:187], v254 offset:0
    v_cmp_lt_u32_e64 s[36:37], s6, v235
    s_add_u32 s6, s6, 1
    v_lshlrev_b32 v232, 16, v200
    v_and_b32 v233, 0xffff0000, v200
    v_sub_f32 v234, v242, v201
    v_pk_add_f32 v[232:233], v[240:241], v[232:233] neg_lo:[0,1] neg_hi:[0,1]
    v_mul_f32 v208, v232, v232
    v_fmac_f32 v208, v233, v233
    v_fmac_f32 v208, v234, v234
    v_cvt_pk_bf16_f32 v208, v208, v208
    v_cndmask_b32_e64 v203, 0, v207, s[36:37]
    v_add_u32 v207, v207, v206
    ds_read_b32 v218, v203
    ds_read_u16 v203, v203 offset:4
    v_pk_add_f32 v[220:221], v[220:221], 1.0 op_sel_hi:[1,0]
    v_pk_add_f32 v[222:223], v[222:223], 1.0 op_sel_hi:[1,0]
    v_pk_add_f32 v[224:225], v[224:225], 1.0 op_sel_hi:[1,0]
    v_pk_add_f32 v[226:227], v[226:227], 1.0 op_sel_hi:[1,0]
    v_rcp_f32 v220, v220
    v_rcp_f32 v221, v221
    v_rcp_f32 v222, v222
    v_rcp_f32 v223, v223
    v_rcp_f32 v224, v224
    v_rcp_f32 v225, v225
    v_rcp_f32 v226, v226
    v_rcp_f32 v227, v227
    s_waitcnt lgkmcnt(0)
    s_mov_b64 exec, -1
    ds_bpermute_b32 v210, v239, v203 offset:0
    ds_bpermute_b32 v212, v239, v203 offset:32
    ds_bpermute_b32 v214, v239, v203 offset:64
    ds_bpermute_b32 v216, v239, v203 offset:96
    s_mov_b64 exec, s[30:31]
    v_pk_fma_f32 v[84:85], v[148:149], v[220:221], v[84:85]
    v_pk_fma_f32 v[86:87], v[150:151], v[222:223], v[86:87]
    v_pk_fma_f32 v[88:89], v[152:153], v[224:225], v[88:89]
    v_pk_fma_f32 v[90:91], v[154:155], v[226:227], v[90:91]
    v_pk_fma_f32 v[228:229], v[84:85], v[116:117], v[228:229]
    v_pk_fma_f32 v[230:231], v[86:87], v[118:119], v[230:231]
    v_pk_fma_f32 v[228:229], v[88:89], v[120:121], v[228:229]
    v_pk_fma_f32 v[230:231], v[90:91], v[122:123], v[230:231]
    v_mfma_f32_32x32x8_bf16 v[140:155], v[40:41], v[208:209], v[44:59]
    v_exp_f32 v220, v156
    v_exp_f32 v221, v157
    v_exp_f32 v222, v158
    v_exp_f32 v223, v159
    v_mfma_f32_32x32x16_bf16 v[140:155], v[32:35], v[196:199], v[140:155]
    v_exp_f32 v224, v160
    v_exp_f32 v225, v161
    v_exp_f32 v226, v162
    v_exp_f32 v227, v163
    v_pk_add_f32 v[220:221], v[220:221], 1.0 op_sel_hi:[1,0]
    v_pk_add_f32 v[222:223], v[222:223], 1.0 op_sel_hi:[1,0]
    v_pk_add_f32 v[224:225], v[224:225], 1.0 op_sel_hi:[1,0]
    v_pk_add_f32 v[226:227], v[226:227], 1.0 op_sel_hi:[1,0]
    v_mfma_f32_32x32x16_bf16 v[140:155], v[0:3], v[172:175], v[140:155]
    v_rcp_f32 v220, v220
    v_rcp_f32 v221, v221
    v_rcp_f32 v222, v222
    v_rcp_f32 v223, v223
    v_mfma_f32_32x32x16_bf16 v[140:155], v[4:7], v[176:179], v[140:155]
    v_rcp_f32 v224, v224
    v_rcp_f32 v225, v225
    v_rcp_f32 v226, v226
    v_rcp_f32 v227, v227
    v_pk_fma_f32 v[92:93], v[156:157], v[220:221], v[92:93]
    v_pk_fma_f32 v[94:95], v[158:159], v[222:223], v[94:95]
    v_pk_fma_f32 v[96:97], v[160:161], v[224:225], v[96:97]
    v_pk_fma_f32 v[98:99], v[162:163], v[226:227], v[98:99]
    v_pk_fma_f32 v[228:229], v[92:93], v[124:125], v[228:229]
    v_pk_fma_f32 v[230:231], v[94:95], v[126:127], v[230:231]
    v_pk_fma_f32 v[228:229], v[96:97], v[128:129], v[228:229]
    v_pk_fma_f32 v[230:231], v[98:99], v[130:131], v[230:231]
    v_mfma_f32_32x32x16_bf16 v[140:155], v[8:11], v[180:183], v[140:155]
    v_exp_f32 v220, v164
    v_exp_f32 v221, v165
    v_exp_f32 v222, v166
    v_exp_f32 v223, v167
    v_mfma_f32_32x32x16_bf16 v[140:155], v[12:15], v[184:187], v[140:155]
    v_exp_f32 v224, v168
    v_exp_f32 v225, v169
    v_exp_f32 v226, v170
    v_exp_f32 v227, v171
    v_pk_add_f32 v[220:221], v[220:221], 1.0 op_sel_hi:[1,0]
    v_pk_add_f32 v[222:223], v[222:223], 1.0 op_sel_hi:[1,0]
    v_pk_add_f32 v[224:225], v[224:225], 1.0 op_sel_hi:[1,0]
    v_pk_add_f32 v[226:227], v[226:227], 1.0 op_sel_hi:[1,0]
    v_rcp_f32 v220, v220
    v_rcp_f32 v221, v221
    v_rcp_f32 v222, v222
    v_rcp_f32 v223, v223
    v_rcp_f32 v224, v224
    v_rcp_f32 v225, v225
    v_rcp_f32 v226, v226
    v_rcp_f32 v227, v227
    v_pk_fma_f32 v[100:101], v[164:165], v[220:221], v[100:101]
    v_pk_fma_f32 v[102:103], v[166:167], v[222:223], v[102:103]
    v_pk_fma_f32 v[104:105], v[168:169], v[224:225], v[104:105]
    v_pk_fma_f32 v[106:107], v[170:171], v[226:227], v[106:107]
    v_pk_fma_f32 v[228:229], v[100:101], v[132:133], v[228:229]
    v_pk_fma_f32 v[230:231], v[102:103], v[134:135], v[230:231]
    v_pk_fma_f32 v[228:229], v[104:105], v[136:137], v[228:229]
    v_pk_fma_f32 v[230:231], v[106:107], v[138:139], v[230:231]
    v_pk_add_f32 v[228:229], v[228:229], v[230:231]
    s_cmp_eq_u64 s[32:33], 0
    v_add_f32 v247, v228, v229
    v_sub_f32 v248, v247, v243
    v_pk_fma_f32 v[244:245], v[236:237], v[248:249], v[244:245] op_sel_hi:[1,0,1]
    v_fmac_f32 v246, v238, v248
    s_mov_b64 exec, -1
    s_cbranch_scc1 K2_DONE
    v_mfma_f32_32x32x8_bf16 v[156:171], v[42:43], v[208:209], v[60:75]
    s_mov_b64 exec, s[32:33]
    v_exp_f32 v220, v140
    v_exp_f32 v221, v141
    v_exp_f32 v222, v142
    v_exp_f32 v223, v143
    v_mfma_f32_32x32x16_bf16 v[156:171], v[36:39], v[196:199], v[156:171]
    v_exp_f32 v224, v144
    v_exp_f32 v225, v145
    s_bitcmp1_b32 s5, 2
    s_cbranch_scc0 K2_VP5
    s_setprio 1
K2_VP5:
    s_waitcnt lgkmcnt(0)
    s_mov_b64 exec, -1
    s_add_u32 m0, s94, 0
    s_nop 0
    buffer_load_dwordx4 v[210:211], s[8:11], 0 idxen offen lds
    s_add_u32 m0, s94, 1024
    s_nop 0
    buffer_load_dwordx4 v[212:213], s[8:11], 0 idxen offen lds
    s_add_u32 m0, s94, 2048
    s_nop 0
    buffer_load_dwordx4 v[214:215], s[8:11], 0 idxen offen lds
    s_add_u32 m0, s94, 3072
    s_nop 0
    buffer_load_dwordx4 v[216:217], s[8:11], 0 idxen offen lds
    s_mov_b64 exec, s[32:33]
    s_setprio 0
    v_exp_f32 v226, v146
    v_exp_f32 v227, v147
    v_pk_add_f32 v[220:221], v[220:221], 1.0 op_sel_hi:[1,0]
    v_pk_add_f32 v[222:223], v[222:223], 1.0 op_sel_hi:[1,0]
    v_pk_add_f32 v[224:225], v[224:225], 1.0 op_sel_hi:[1,0]
    v_pk_add_f32 v[226:227], v[226:227], 1.0 op_sel_hi:[1,0]
    v_mfma_f32_32x32x16_bf16 v[156:171], v[16:19], v[172:175], v[156:171]
    v_rcp_f32 v220, v220
    v_rcp_f32 v221, v221
    v_rcp_f32 v222, v222
    v_rcp_f32 v223, v223
    v_mfma_f32_32x32x16_bf16 v[156:171], v[20:23], v[176:179], v[156:171]
    v_rcp_f32 v224, v224
    v_rcp_f32 v225, v225
    v_rcp_f32 v226, v226
    v_rcp_f32 v227, v227
    v_pk_fma_f32 v[76:77], v[140:141], v[220:221], v[76:77]
    v_pk_fma_f32 v[78:79], v[142:143], v[222:223], v[78:79]
    v_pk_fma_f32 v[80:81], v[144:145], v[224:225], v[80:81]
    v_pk_fma_f32 v[82:83], v[146:147], v[226:227], v[82:83]
    v_pk_mul_f32 v[228:229], v[76:77], v[108:109]
    v_pk_mul_f32 v[230:231], v[78:79], v[110:111]
    v_pk_fma_f32 v[228:229], v[80:81], v[112:113], v[228:229]
    v_pk_fma_f32 v[230:231], v[82:83], v[114:115], v[230:231]
    v_mfma_f32_32x32x16_bf16 v[156:171], v[24:27], v[180:183], v[156:171]
    v_exp_f32 v220, v148
    v_exp_f32 v221, v149
    v_exp_f32 v222, v150
    v_exp_f32 v223, v151
    v_mfma_f32_32x32x16_bf16 v[156:171], v[28:31], v[184:187], v[156:171]
    v_exp_f32 v224, v152
    v_exp_f32 v225, v153
    v_exp_f32 v226, v154
    buffer_load_dwordx4 v[192:195], v[218:219], s[12:15], 0 idxen offen
    buffer_load_dwordx2 v[200:201], v203, s[16:19], 0 idxen
    v_exp_f32 v227, v155
    s_waitcnt vmcnt(6)
    ds_read_b128 v[172:175], v251 offset:32768
    ds_read_b128 v[176:179], v252 offset:32768
    ds_read_b128 v[180:183], v253 offset:32768
    ds_read_b128 v[184:187], v254 offset:32768
    v_cmp_lt_u32_e64 s[38:39], s6, v235
    s_add_u32 s6, s6, 1
    v_lshlrev_b32 v236, 16, v204
    v_and_b32 v237, 0xffff0000, v204
    v_sub_f32 v238, v242, v205
    v_pk_add_f32 v[236:237], v[240:241], v[236:237] neg_lo:[0,1] neg_hi:[0,1]
    v_mul_f32 v208, v236, v236
    v_fmac_f32 v208, v237, v237
    v_fmac_f32 v208, v238, v238
    v_cvt_pk_bf16_f32 v208, v208, v208
    v_cndmask_b32_e64 v203, 0, v207, s[38:39]
    v_add_u32 v207, v207, v206
    ds_read_b32 v218, v203
    ds_read_u16 v203, v203 offset:4
    v_pk_add_f32 v[220:221], v[220:221], 1.0 op_sel_hi:[1,0]
    v_pk_add_f32 v[222:223], v[222:223], 1.0 op_sel_hi:[1,0]
    v_pk_add_f32 v[224:225], v[224:225], 1.0 op_sel_hi:[1,0]
    v_pk_add_f32 v[226:227], v[226:227], 1.0 op_sel_hi:[1,0]
    v_rcp_f32 v220, v220
    v_rcp_f32 v221, v221
    v_rcp_f32 v222, v222
    v_rcp_f32 v223, v223
    v_rcp_f32 v224, v224
    v_rcp_f32 v225, v225
    v_rcp_f32 v226, v226
    v_rcp_f32 v227, v227
    s_waitcnt lgkmcnt(0)
    s_mov_b64 exec, -1
    ds_bpermute_b32 v210, v239, v203 offset:0
    ds_bpermute_b32 v212, v239, v203 offset:32
    ds_bpermute_b32 v214, v239, v203 offset:64
    ds_bpermute_b32 v216, v239, v203 offset:96
    s_mov_b64 exec, s[32:33]
    v_pk_fma_f32 v[84:85], v[148:149], v[220:221], v[84:85]
    v_pk_fma_f32 v[86:87], v[150:151], v[222:223], v[86:87]
    v_pk_fma_f32 v[88:89], v[152:153], v[224:225], v[88:89]
    v_pk_fma_f32 v[90:91], v[154:155], v[226:227], v[90:91]
    v_pk_fma_f32 v[228:229], v[84:85], v[116:117], v[228:229]
    v_pk_fma_f32 v[230:231], v[86:87], v[118:119], v[230:231]
    v_pk_fma_f32 v[228:229], v[88:89], v[120:121], v[228:229]
    v_pk_fma_f32 v[230:231], v[90:91], v[122:123], v[230:231]
    v_mfma_f32_32x32x8_bf16 v[140:155], v[40:41], v[208:209], v[44:59]
    v_exp_f32 v220, v156
    v_exp_f32 v221, v157
    v_exp_f32 v222, v158
    v_exp_f32 v223, v159
    v_mfma_f32_32x32x16_bf16 v[140:155], v[32:35], v[188:191], v[140:155]
    v_exp_f32 v224, v160
    v_exp_f32 v225, v161
    v_exp_f32 v226, v162
    v_exp_f32 v227, v163
    v_pk_add_f32 v[220:221], v[220:221], 1.0 op_sel_hi:[1,0]
    v_pk_add_f32 v[222:223], v[222:223], 1.0 op_sel_hi:[1,0]
    v_pk_add_f32 v[224:225], v[224:225], 1.0 op_sel_hi:[1,0]
    v_pk_add_f32 v[226:227], v[226:227], 1.0 op_sel_hi:[1,0]
    v_mfma_f32_32x32x16_bf16 v[140:155], v[0:3], v[172:175], v[140:155]
    v_rcp_f32 v220, v220
    v_rcp_f32 v221, v221
    v_rcp_f32 v222, v222
    v_rcp_f32 v223, v223
    v_mfma_f32_32x32x16_bf16 v[140:155], v[4:7], v[176:179], v[140:155]
    v_rcp_f32 v224, v224
    v_rcp_f32 v225, v225
    v_rcp_f32 v226, v226
    v_rcp_f32 v227, v227
    v_pk_fma_f32 v[92:93], v[156:157], v[220:221], v[92:93]
    v_pk_fma_f32 v[94:95], v[158:159], v[222:223], v[94:95]
    v_pk_fma_f32 v[96:97], v[160:161], v[224:225], v[96:97]
    v_pk_fma_f32 v[98:99], v[162:163], v[226:227], v[98:99]
    v_pk_fma_f32 v[228:229], v[92:93], v[124:125], v[228:229]
    v_pk_fma_f32 v[230:231], v[94:95], v[126:127], v[230:231]
    v_pk_fma_f32 v[228:229], v[96:97], v[128:129], v[228:229]
    v_pk_fma_f32 v[230:231], v[98:99], v[130:131], v[230:231]
    v_mfma_f32_32x32x16_bf16 v[140:155], v[8:11], v[180:183], v[140:155]
    v_exp_f32 v220, v164
    v_exp_f32 v221, v165
    v_exp_f32 v222, v166
    v_exp_f32 v223, v167
    v_mfma_f32_32x32x16_bf16 v[140:155], v[12:15], v[184:187], v[140:155]
    v_exp_f32 v224, v168
    v_exp_f32 v225, v169
    v_exp_f32 v226, v170
    v_exp_f32 v227, v171
    v_pk_add_f32 v[220:221], v[220:221], 1.0 op_sel_hi:[1,0]
    v_pk_add_f32 v[222:223], v[222:223], 1.0 op_sel_hi:[1,0]
    v_pk_add_f32 v[224:225], v[224:225], 1.0 op_sel_hi:[1,0]
    v_pk_add_f32 v[226:227], v[226:227], 1.0 op_sel_hi:[1,0]
    v_rcp_f32 v220, v220
    v_rcp_f32 v221, v221
    v_rcp_f32 v222, v222
    v_rcp_f32 v223, v223
    v_rcp_f32 v224, v224
    v_rcp_f32 v225, v225
    v_rcp_f32 v226, v226
    v_rcp_f32 v227, v227
    v_pk_fma_f32 v[100:101], v[164:165], v[220:221], v[100:101]
    v_pk_fma_f32 v[102:103], v[166:167], v[222:223], v[102:103]
    v_pk_fma_f32 v[104:105], v[168:169], v[224:225], v[104:105]
    v_pk_fma_f32 v[106:107], v[170:171], v[226:227], v[106:107]
    v_pk_fma_f32 v[228:229], v[100:101], v[132:133], v[228:229]
    v_pk_fma_f32 v[230:231], v[102:103], v[134:135], v[230:231]
    v_pk_fma_f32 v[228:229], v[104:105], v[136:137], v[228:229]
    v_pk_fma_f32 v[230:231], v[106:107], v[138:139], v[230:231]
    v_pk_add_f32 v[228:229], v[228:229], v[230:231]
    s_cmp_eq_u64 s[34:35], 0
    v_add_f32 v243, v228, v229
    v_sub_f32 v248, v243, v247
    v_pk_fma_f32 v[244:245], v[232:233], v[248:249], v[244:245] op_sel_hi:[1,0,1]
    v_fmac_f32 v246, v234, v248
    s_mov_b64 exec, -1
    s_cbranch_scc1 K2_DONE
    v_mfma_f32_32x32x8_bf16 v[156:171], v[42:43], v[208:209], v[60:75]
    s_mov_b64 exec, s[34:35]
    v_exp_f32 v220, v140
    v_exp_f32 v221, v141
    v_exp_f32 v222, v142
    v_exp_f32 v223, v143
    v_mfma_f32_32x32x16_bf16 v[156:171], v[36:39], v[188:191], v[156:171]
    v_exp_f32 v224, v144
    v_exp_f32 v225, v145
    s_bitcmp1_b32 s5, 2
    s_cbranch_scc0 K2_VP7
    s_setprio 1
K2_VP7:
    s_waitcnt lgkmcnt(0)
    s_mov_b64 exec, -1
    s_add_u32 m0, s94, 32768
    s_nop 0
    buffer_load_dwordx4 v[210:211], s[8:11], 0 idxen offen lds
    s_add_u32 m0, s94, 33792
    s_nop 0
    buffer_load_dwordx4 v[212:213], s[8:11], 0 idxen offen lds
    s_add_u32 m0, s94, 34816
    s_nop 0
    buffer_load_dwordx4 v[214:215], s[8:11], 0 idxen offen lds
    s_add_u32 m0, s94, 35840
    s_nop 0
    buffer_load_dwordx4 v[216:217], s[8:11], 0 idxen offen lds
    s_mov_b64 exec, s[34:35]
    s_setprio 0
    v_exp_f32 v226, v146
    v_exp_f32 v227, v147
    v_pk_add_f32 v[220:221], v[220:221], 1.0 op_sel_hi:[1,0]
    v_pk_add_f32 v[222:223], v[222:223], 1.0 op_sel_hi:[1,0]
    v_pk_add_f32 v[224:225], v[224:225], 1.0 op_sel_hi:[1,0]
    v_pk_add_f32 v[226:227], v[226:227], 1.0 op_sel_hi:[1,0]
    v_mfma_f32_32x32x16_bf16 v[156:171], v[16:19], v[172:175], v[156:171]
    v_rcp_f32 v220, v220
    v_rcp_f32 v221, v221
    v_rcp_f32 v222, v222
    v_rcp_f32 v223, v223
    v_mfma_f32_32x32x16_bf16 v[156:171], v[20:23], v[176:179], v[156:171]
    v_rcp_f32 v224, v224
    v_rcp_f32 v225, v225
    v_rcp_f32 v226, v226
    v_rcp_f32 v227, v227
    v_pk_fma_f32 v[76:77], v[140:141], v[220:221], v[76:77]
    v_pk_fma_f32 v[78:79], v[142:143], v[222:223], v[78:79]
    v_pk_fma_f32 v[80:81], v[144:145], v[224:225], v[80:81]
    v_pk_fma_f32 v[82:83], v[146:147], v[226:227], v[82:83]
    v_pk_mul_f32 v[228:229], v[76:77], v[108:109]
    v_pk_mul_f32 v[230:231], v[78:79], v[110:111]
    v_pk_fma_f32 v[228:229], v[80:81], v[112:113], v[228:229]
    v_pk_fma_f32 v[230:231], v[82:83], v[114:115], v[230:231]
    v_mfma_f32_32x32x16_bf16 v[156:171], v[24:27], v[180:183], v[156:171]
    v_exp_f32 v220, v148
    v_exp_f32 v221, v149
    v_exp_f32 v222, v150
    v_exp_f32 v223, v151
    v_mfma_f32_32x32x16_bf16 v[156:171], v[28:31], v[184:187], v[156:171]
    v_exp_f32 v224, v152
    v_exp_f32 v225, v153
    v_exp_f32 v226, v154
    buffer_load_dwordx4 v[196:199], v[218:219], s[12:15], 0 idxen offen
    buffer_load_dwordx2 v[204:205], v203, s[16:19], 0 idxen
    v_exp_f32 v227, v155
    s_waitcnt vmcnt(6)
    ds_read_b128 v[172:175], v251 offset:0
    ds_read_b128 v[176:179], v252 offset:0
    ds_read_b128 v[180:183], v253 offset:0
    ds_read_b128 v[184:187], v254 offset:0
    v_cmp_lt_u32_e64 s[28:29], s6, v235
    s_add_u32 s6, s6, 1
    v_lshlrev_b32 v232, 16, v200
    v_and_b32 v233, 0xffff0000, v200
    v_sub_f32 v234, v242, v201
    v_pk_add_f32 v[232:233], v[240:241], v[232:233] neg_lo:[0,1] neg_hi:[0,1]
    v_mul_f32 v208, v232, v232
    v_fmac_f32 v208, v233, v233
    v_fmac_f32 v208, v234, v234
    v_cvt_pk_bf16_f32 v208, v208, v208
    v_cndmask_b32_e64 v203, 0, v207, s[28:29]
    v_add_u32 v207, v207, v206
    ds_read_b32 v218, v203
    ds_read_u16 v203, v203 offset:4
    v_pk_add_f32 v[220:221], v[220:221], 1.0 op_sel_hi:[1,0]
    v_pk_add_f32 v[222:223], v[222:223], 1.0 op_sel_hi:[1,0]
    v_pk_add_f32 v[224:225], v[224:225], 1.0 op_sel_hi:[1,0]
    v_pk_add_f32 v[226:227], v[226:227], 1.0 op_sel_hi:[1,0]
    v_rcp_f32 v220, v220
    v_rcp_f32 v221, v221
    v_rcp_f32 v222, v222
    v_rcp_f32 v223, v223
    v_rcp_f32 v224, v224
    v_rcp_f32 v225, v225
    v_rcp_f32 v226, v226
    v_rcp_f32 v227, v227
    s_waitcnt lgkmcnt(0)
    s_mov_b64 exec, -1
    ds_bpermute_b32 v210, v239, v203 offset:0
    ds_bpermute_b32 v212, v239, v203 offset:32
    ds_bpermute_b32 v214, v239, v203 offset:64
    ds_bpermute_b32 v216, v239, v203 offset:96
    s_mov_b64 exec, s[34:35]
    v_pk_fma_f32 v[84:85], v[148:149], v[220:221], v[84:85]
    v_pk_fma_f32 v[86:87], v[150:151], v[222:223], v[86:87]
    v_pk_fma_f32 v[88:89], v[152:153], v[224:225], v[88:89]
    v_pk_fma_f32 v[90:91], v[154:155], v[226:227], v[90:91]
    v_pk_fma_f32 v[228:229], v[84:85], v[116:117], v[228:229]
    v_pk_fma_f32 v[230:231], v[86:87], v[118:119], v[230:231]
    v_pk_fma_f32 v[228:229], v[88:89], v[120:121], v[228:229]
    v_pk_fma_f32 v[230:231], v[90:91], v[122:123], v[230:231]
    v_mfma_f32_32x32x8_bf16 v[140:155], v[40:41], v[208:209], v[44:59]
    v_exp_f32 v220, v156
    v_exp_f32 v221, v157
    v_exp_f32 v222, v158
    v_exp_f32 v223, v159
    v_mfma_f32_32x32x16_bf16 v[140:155], v[32:35], v[192:195], v[140:155]
    v_exp_f32 v224, v160
    v_exp_f32 v225, v161
    v_exp_f32 v226, v162
    v_exp_f32 v227, v163
    v_pk_add_f32 v[220:221], v[220:221], 1.0 op_sel_hi:[1,0]
    v_pk_add_f32 v[222:223], v[222:223], 1.0 op_sel_hi:[1,0]
    v_pk_add_f32 v[224:225], v[224:225], 1.0 op_sel_hi:[1,0]
    v_pk_add_f32 v[226:227], v[226:227], 1.0 op_sel_hi:[1,0]
    v_mfma_f32_32x32x16_bf16 v[140:155], v[0:3], v[172:175], v[140:155]
    v_rcp_f32 v220, v220
    v_rcp_f32 v221, v221
    v_rcp_f32 v222, v222
    v_rcp_f32 v223, v223
    v_mfma_f32_32x32x16_bf16 v[140:155], v[4:7], v[176:179], v[140:155]
    v_rcp_f32 v224, v224
    v_rcp_f32 v225, v225
    v_rcp_f32 v226, v226
    v_rcp_f32 v227, v227
    v_pk_fma_f32 v[92:93], v[156:157], v[220:221], v[92:93]
    v_pk_fma_f32 v[94:95], v[158:159], v[222:223], v[94:95]
    v_pk_fma_f32 v[96:97], v[160:161], v[224:225], v[96:97]
    v_pk_fma_f32 v[98:99], v[162:163], v[226:227], v[98:99]
    v_pk_fma_f32 v[228:229], v[92:93], v[124:125], v[228:229]
    v_pk_fma_f32 v[230:231], v[94:95], v[126:127], v[230:231]
    v_pk_fma_f32 v[228:229], v[96:97], v[128:129], v[228:229]
    v_pk_fma_f32 v[230:231], v[98:99], v[130:131], v[230:231]
    v_mfma_f32_32x32x16_bf16 v[140:155], v[8:11], v[180:183], v[140:155]
    v_exp_f32 v220, v164
    v_exp_f32 v221, v165
    v_exp_f32 v222, v166
    v_exp_f32 v223, v167
    v_mfma_f32_32x32x16_bf16 v[140:155], v[12:15], v[184:187], v[140:155]
    v_exp_f32 v224, v168
    v_exp_f32 v225, v169
    v_exp_f32 v226, v170
    v_exp_f32 v227, v171
    v_pk_add_f32 v[220:221], v[220:221], 1.0 op_sel_hi:[1,0]
    v_pk_add_f32 v[222:223], v[222:223], 1.0 op_sel_hi:[1,0]
    v_pk_add_f32 v[224:225], v[224:225], 1.0 op_sel_hi:[1,0]
    v_pk_add_f32 v[226:227], v[226:227], 1.0 op_sel_hi:[1,0]
    v_rcp_f32 v220, v220
    v_rcp_f32 v221, v221
    v_rcp_f32 v222, v222
    v_rcp_f32 v223, v223
    v_rcp_f32 v224, v224
    v_rcp_f32 v225, v225
    v_rcp_f32 v226, v226
    v_rcp_f32 v227, v227
    v_pk_fma_f32 v[100:101], v[164:165], v[220:221], v[100:101]
    v_pk_fma_f32 v[102:103], v[166:167], v[222:223], v[102:103]
    v_pk_fma_f32 v[104:105], v[168:169], v[224:225], v[104:105]
    v_pk_fma_f32 v[106:107], v[170:171], v[226:227], v[106:107]
    v_pk_fma_f32 v[228:229], v[100:101], v[132:133], v[228:229]
    v_pk_fma_f32 v[230:231], v[102:103], v[134:135], v[230:231]
    v_pk_fma_f32 v[228:229], v[104:105], v[136:137], v[228:229]
    v_pk_fma_f32 v[230:231], v[106:107], v[138:139], v[230:231]
    v_pk_add_f32 v[228:229], v[228:229], v[230:231]
    s_cmp_eq_u64 s[36:37], 0
    v_add_f32 v247, v228, v229
    v_sub_f32 v248, v247, v243
    v_pk_fma_f32 v[244:245], v[236:237], v[248:249], v[244:245] op_sel_hi:[1,0,1]
    v_fmac_f32 v246, v238, v248
    s_mov_b64 exec, -1
    s_cbranch_scc1 K2_DONE
    v_mfma_f32_32x32x8_bf16 v[156:171], v[42:43], v[208:209], v[60:75]
    s_mov_b64 exec, s[36:37]
    v_exp_f32 v220, v140
    v_exp_f32 v221, v141
    v_exp_f32 v222, v142
    v_exp_f32 v223, v143
    v_mfma_f32_32x32x16_bf16 v[156:171], v[36:39], v[192:195], v[156:171]
    v_exp_f32 v224, v144
    v_exp_f32 v225, v145
    s_bitcmp1_b32 s5, 2
    s_cbranch_scc0 K2_VP9
    s_setprio 1
K2_VP9:
    s_waitcnt lgkmcnt(0)
    s_mov_b64 exec, -1
    s_add_u32 m0, s94, 0
    s_nop 0
    buffer_load_dwordx4 v[210:211], s[8:11], 0 idxen offen lds
    s_add_u32 m0, s94, 1024
    s_nop 0
    buffer_load_dwordx4 v[212:213], s[8:11], 0 idxen offen lds
    s_add_u32 m0, s94, 2048
    s_nop 0
    buffer_load_dwordx4 v[214:215], s[8:11], 0 idxen offen lds
    s_add_u32 m0, s94, 3072
    s_nop 0
    buffer_load_dwordx4 v[216:217], s[8:11], 0 idxen offen lds
    s_mov_b64 exec, s[36:37]
    s_setprio 0
    v_exp_f32 v226, v146
    v_exp_f32 v227, v147
    v_pk_add_f32 v[220:221], v[220:221], 1.0 op_sel_hi:[1,0]
    v_pk_add_f32 v[222:223], v[222:223], 1.0 op_sel_hi:[1,0]
    v_pk_add_f32 v[224:225], v[224:225], 1.0 op_sel_hi:[1,0]
    v_pk_add_f32 v[226:227], v[226:227], 1.0 op_sel_hi:[1,0]
    v_mfma_f32_32x32x16_bf16 v[156:171], v[16:19], v[172:175], v[156:171]
    v_rcp_f32 v220, v220
    v_rcp_f32 v221, v221
    v_rcp_f32 v222, v222
    v_rcp_f32 v223, v223
    v_mfma_f32_32x32x16_bf16 v[156:171], v[20:23], v[176:179], v[156:171]
    v_rcp_f32 v224, v224
    v_rcp_f32 v225, v225
    v_rcp_f32 v226, v226
    v_rcp_f32 v227, v227
    v_pk_fma_f32 v[76:77], v[140:141], v[220:221], v[76:77]
    v_pk_fma_f32 v[78:79], v[142:143], v[222:223], v[78:79]
    v_pk_fma_f32 v[80:81], v[144:145], v[224:225], v[80:81]
    v_pk_fma_f32 v[82:83], v[146:147], v[226:227], v[82:83]
    v_pk_mul_f32 v[228:229], v[76:77], v[108:109]
    v_pk_mul_f32 v[230:231], v[78:79], v[110:111]
    v_pk_fma_f32 v[228:229], v[80:81], v[112:113], v[228:229]
    v_pk_fma_f32 v[230:231], v[82:83], v[114:115], v[230:231]
    v_mfma_f32_32x32x16_bf16 v[156:171], v[24:27], v[180:183], v[156:171]
    v_exp_f32 v220, v148
    v_exp_f32 v221, v149
    v_exp_f32 v222, v150
    v_exp_f32 v223, v151
    v_mfma_f32_32x32x16_bf16 v[156:171], v[28:31], v[184:187], v[156:171]
    v_exp_f32 v224, v152
    v_exp_f32 v225, v153
    v_exp_f32 v226, v154
    buffer_load_dwordx4 v[188:191], v[218:219], s[12:15], 0 idxen offen
    buffer_load_dwordx2 v[200:201], v203, s[16:19], 0 idxen
    v_exp_f32 v227, v155
    s_waitcnt vmcnt(6)
    ds_read_b128 v[172:175], v251 offset:32768
    ds_read_b128 v[176:179], v252 offset:32768
    ds_read_b128 v[180:183], v253 offset:32768
    ds_read_b128 v[184:187], v254 offset:32768
    v_cmp_lt_u32_e64 s[30:31], s6, v235
    s_add_u32 s6, s6, 1
    v_lshlrev_b32 v236, 16, v204
    v_and_b32 v237, 0xffff0000, v204
    v_sub_f32 v238, v242, v205
    v_pk_add_f32 v[236:237], v[240:241], v[236:237] neg_lo:[0,1] neg_hi:[0,1]
    v_mul_f32 v208, v236, v236
    v_fmac_f32 v208, v237, v237
    v_fmac_f32 v208, v238, v238
    v_cvt_pk_bf16_f32 v208, v208, v208
    v_cndmask_b32_e64 v203, 0, v207, s[30:31]
    v_add_u32 v207, v207, v206
    ds_read_b32 v218, v203
    ds_read_u16 v203, v203 offset:4
    v_pk_add_f32 v[220:221], v[220:221], 1.0 op_sel_hi:[1,0]
    v_pk_add_f32 v[222:223], v[222:223], 1.0 op_sel_hi:[1,0]
    v_pk_add_f32 v[224:225], v[224:225], 1.0 op_sel_hi:[1,0]
    v_pk_add_f32 v[226:227], v[226:227], 1.0 op_sel_hi:[1,0]
    v_rcp_f32 v220, v220
    v_rcp_f32 v221, v221
    v_rcp_f32 v222, v222
    v_rcp_f32 v223, v223
    v_rcp_f32 v224, v224
    v_rcp_f32 v225, v225
    v_rcp_f32 v226, v226
    v_rcp_f32 v227, v227
    s_waitcnt lgkmcnt(0)
    s_mov_b64 exec, -1
    ds_bpermute_b32 v210, v239, v203 offset:0
    ds_bpermute_b32 v212, v239, v203 offset:32
    ds_bpermute_b32 v214, v239, v203 offset:64
    ds_bpermute_b32 v216, v239, v203 offset:96
    s_mov_b64 exec, s[36:37]
    v_pk_fma_f32 v[84:85], v[148:149], v[220:221], v[84:85]
    v_pk_fma_f32 v[86:87], v[150:151], v[222:223], v[86:87]
    v_pk_fma_f32 v[88:89], v[152:153], v[224:225], v[88:89]
    v_pk_fma_f32 v[90:91], v[154:155], v[226:227], v[90:91]
    v_pk_fma_f32 v[228:229], v[84:85], v[116:117], v[228:229]
    v_pk_fma_f32 v[230:231], v[86:87], v[118:119], v[230:231]
    v_pk_fma_f32 v[228:229], v[88:89], v[120:121], v[228:229]
    v_pk_fma_f32 v[230:231], v[90:91], v[122:123], v[230:231]
    v_mfma_f32_32x32x8_bf16 v[140:155], v[40:41], v[208:209], v[44:59]
    v_exp_f32 v220, v156
    v_exp_f32 v221, v157
    v_exp_f32 v222, v158
    v_exp_f32 v223, v159
    v_mfma_f32_32x32x16_bf16 v[140:155], v[32:35], v[196:199], v[140:155]
    v_exp_f32 v224, v160
    v_exp_f32 v225, v161
    v_exp_f32 v226, v162
    v_exp_f32 v227, v163
    v_pk_add_f32 v[220:221], v[220:221], 1.0 op_sel_hi:[1,0]
    v_pk_add_f32 v[222:223], v[222:223], 1.0 op_sel_hi:[1,0]
    v_pk_add_f32 v[224:225], v[224:225], 1.0 op_sel_hi:[1,0]
    v_pk_add_f32 v[226:227], v[226:227], 1.0 op_sel_hi:[1,0]
    v_mfma_f32_32x32x16_bf16 v[140:155], v[0:3], v[172:175], v[140:155]
    v_rcp_f32 v220, v220
    v_rcp_f32 v221, v221
    v_rcp_f32 v222, v222
    v_rcp_f32 v223, v223
    v_mfma_f32_32x32x16_bf16 v[140:155], v[4:7], v[176:179], v[140:155]
    v_rcp_f32 v224, v224
    v_rcp_f32 v225, v225
    v_rcp_f32 v226, v226
    v_rcp_f32 v227, v227
    v_pk_fma_f32 v[92:93], v[156:157], v[220:221], v[92:93]
    v_pk_fma_f32 v[94:95], v[158:159], v[222:223], v[94:95]
    v_pk_fma_f32 v[96:97], v[160:161], v[224:225], v[96:97]
    v_pk_fma_f32 v[98:99], v[162:163], v[226:227], v[98:99]
    v_pk_fma_f32 v[228:229], v[92:93], v[124:125], v[228:229]
    v_pk_fma_f32 v[230:231], v[94:95], v[126:127], v[230:231]
    v_pk_fma_f32 v[228:229], v[96:97], v[128:129], v[228:229]
    v_pk_fma_f32 v[230:231], v[98:99], v[130:131], v[230:231]
    v_mfma_f32_32x32x16_bf16 v[140:155], v[8:11], v[180:183], v[140:155]
    v_exp_f32 v220, v164
    v_exp_f32 v221, v165
    v_exp_f32 v222, v166
    v_exp_f32 v223, v167
    v_mfma_f32_32x32x16_bf16 v[140:155], v[12:15], v[184:187], v[140:155]
    v_exp_f32 v224, v168
    v_exp_f32 v225, v169
    v_exp_f32 v226, v170
    v_exp_f32 v227, v171
    v_pk_add_f32 v[220:221], v[220:221], 1.0 op_sel_hi:[1,0]
    v_pk_add_f32 v[222:223], v[222:223], 1.0 op_sel_hi:[1,0]
    v_pk_add_f32 v[224:225], v[224:225], 1.0 op_sel_hi:[1,0]
    v_pk_add_f32 v[226:227], v[226:227], 1.0 op_sel_hi:[1,0]
    v_rcp_f32 v220, v220
    v_rcp_f32 v221, v221
    v_rcp_f32 v222, v222
    v_rcp_f32 v223, v223
    v_rcp_f32 v224, v224
    v_rcp_f32 v225, v225
    v_rcp_f32 v226, v226
    v_rcp_f32 v227, v227
    v_pk_fma_f32 v[100:101], v[164:165], v[220:221], v[100:101]
    v_pk_fma_f32 v[102:103], v[166:167], v[222:223], v[102:103]
    v_pk_fma_f32 v[104:105], v[168:169], v[224:225], v[104:105]
    v_pk_fma_f32 v[106:107], v[170:171], v[226:227], v[106:107]
    v_pk_fma_f32 v[228:229], v[100:101], v[132:133], v[228:229]
    v_pk_fma_f32 v[230:231], v[102:103], v[134:135], v[230:231]
    v_pk_fma_f32 v[228:229], v[104:105], v[136:137], v[228:229]
    v_pk_fma_f32 v[230:231], v[106:107], v[138:139], v[230:231]
    v_pk_add_f32 v[228:229], v[228:229], v[230:231]
    s_cmp_eq_u64 s[38:39], 0
    v_add_f32 v243, v228, v229
    v_sub_f32 v248, v243, v247
    v_pk_fma_f32 v[244:245], v[232:233], v[248:249], v[244:245] op_sel_hi:[1,0,1]
    v_fmac_f32 v246, v234, v248
    s_mov_b64 exec, -1
    s_cbranch_scc1 K2_DONE
    v_mfma_f32_32x32x8_bf16 v[156:171], v[42:43], v[208:209], v[60:75]
    s_mov_b64 exec, s[38:39]
    v_exp_f32 v220, v140
    v_exp_f32 v221, v141
    v_exp_f32 v222, v142
    v_exp_f32 v223, v143
    v_mfma_f32_32x32x16_bf16 v[156:171], v[36:39], v[196:199], v[156:171]
    v_exp_f32 v224, v144
    v_exp_f32 v225, v145
    s_bitcmp1_b32 s5, 2
    s_cbranch_scc0 K2_VP11
    s_setprio 1
K2_VP11:
    s_waitcnt lgkmcnt(0)
    s_mov_b64 exec, -1
    s_add_u32 m0, s94, 32768
    s_nop 0
    buffer_load_dwordx4 v[210:211], s[8:11], 0 idxen offen lds
    s_add_u32 m0, s94, 33792
    s_nop 0
    buffer_load_dwordx4 v[212:213], s[8:11], 0 idxen offen lds
    s_add_u32 m0, s94, 34816
    s_nop 0
    buffer_load_dwordx4 v[214:215], s[8:11], 0 idxen offen lds
    s_add_u32 m0, s94, 35840
    s_nop 0
    buffer_load_dwordx4 v[216:217], s[8:11], 0 idxen offen lds
    s_mov_b64 exec, s[38:39]
    s_setprio 0
    v_exp_f32 v226, v146
    v_exp_f32 v227, v147
    v_pk_add_f32 v[220:221], v[220:221], 1.0 op_sel_hi:[1,0]
    v_pk_add_f32 v[222:223], v[222:223], 1.0 op_sel_hi:[1,0]
    v_pk_add_f32 v[224:225], v[224:225], 1.0 op_sel_hi:[1,0]
    v_pk_add_f32 v[226:227], v[226:227], 1.0 op_sel_hi:[1,0]
    v_mfma_f32_32x32x16_bf16 v[156:171], v[16:19], v[172:175], v[156:171]
    v_rcp_f32 v220, v220
    v_rcp_f32 v221, v221
    v_rcp_f32 v222, v222
    v_rcp_f32 v223, v223
    v_mfma_f32_32x32x16_bf16 v[156:171], v[20:23], v[176:179], v[156:171]
    v_rcp_f32 v224, v224
    v_rcp_f32 v225, v225
    v_rcp_f32 v226, v226
    v_rcp_f32 v227, v227
    v_pk_fma_f32 v[76:77], v[140:141], v[220:221], v[76:77]
    v_pk_fma_f32 v[78:79], v[142:143], v[222:223], v[78:79]
    v_pk_fma_f32 v[80:81], v[144:145], v[224:225], v[80:81]
    v_pk_fma_f32 v[82:83], v[146:147], v[226:227], v[82:83]
    v_pk_mul_f32 v[228:229], v[76:77], v[108:109]
    v_pk_mul_f32 v[230:231], v[78:79], v[110:111]
    v_pk_fma_f32 v[228:229], v[80:81], v[112:113], v[228:229]
    v_pk_fma_f32 v[230:231], v[82:83], v[114:115], v[230:231]
    v_mfma_f32_32x32x16_bf16 v[156:171], v[24:27], v[180:183], v[156:171]
    v_exp_f32 v220, v148
    v_exp_f32 v221, v149
    v_exp_f32 v222, v150
    v_exp_f32 v223, v151
    v_mfma_f32_32x32x16_bf16 v[156:171], v[28:31], v[184:187], v[156:171]
    v_exp_f32 v224, v152
    v_exp_f32 v225, v153
    v_exp_f32 v226, v154
    buffer_load_dwordx4 v[192:195], v[218:219], s[12:15], 0 idxen offen
    buffer_load_dwordx2 v[204:205], v203, s[16:19], 0 idxen
    v_exp_f32 v227, v155
    s_waitcnt vmcnt(6)
    ds_read_b128 v[172:175], v251 offset:0
    ds_read_b128 v[176:179], v252 offset:0
    ds_read_b128 v[180:183], v253 offset:0
    ds_read_b128 v[184:187], v254 offset:0
    v_cmp_lt_u32_e64 s[32:33], s6, v235
    s_add_u32 s6, s6, 1
    v_lshlrev_b32 v232, 16, v200
    v_and_b32 v233, 0xffff0000, v200
    v_sub_f32 v234, v242, v201
    v_pk_add_f32 v[232:233], v[240:241], v[232:233] neg_lo:[0,1] neg_hi:[0,1]
    v_mul_f32 v208, v232, v232
    v_fmac_f32 v208, v233, v233
    v_fmac_f32 v208, v234, v234
    v_cvt_pk_bf16_f32 v208, v208, v208
    v_cndmask_b32_e64 v203, 0, v207, s[32:33]
    v_add_u32 v207, v207, v206
    ds_read_b32 v218, v203
    ds_read_u16 v203, v203 offset:4
    v_pk_add_f32 v[220:221], v[220:221], 1.0 op_sel_hi:[1,0]
    v_pk_add_f32 v[222:223], v[222:223], 1.0 op_sel_hi:[1,0]
    v_pk_add_f32 v[224:225], v[224:225], 1.0 op_sel_hi:[1,0]
    v_pk_add_f32 v[226:227], v[226:227], 1.0 op_sel_hi:[1,0]
    v_rcp_f32 v220, v220
    v_rcp_f32 v221, v221
    v_rcp_f32 v222, v222
    v_rcp_f32 v223, v223
    v_rcp_f32 v224, v224
    v_rcp_f32 v225, v225
    v_rcp_f32 v226, v226
    v_rcp_f32 v227, v227
    s_waitcnt lgkmcnt(0)
    s_mov_b64 exec, -1
    ds_bpermute_b32 v210, v239, v203 offset:0
    ds_bpermute_b32 v212, v239, v203 offset:32
    ds_bpermute_b32 v214, v239, v203 offset:64
    ds_bpermute_b32 v216, v239, v203 offset:96
    s_mov_b64 exec, s[38:39]
    v_pk_fma_f32 v[84:85], v[148:149], v[220:221], v[84:85]
    v_pk_fma_f32 v[86:87], v[150:151], v[222:223], v[86:87]
    v_pk_fma_f32 v[88:89], v[152:153], v[224:225], v[88:89]
    v_pk_fma_f32 v[90:91], v[154:155], v[226:227], v[90:91]
    v_pk_fma_f32 v[228:229], v[84:85], v[116:117], v[228:229]
    v_pk_fma_f32 v[230:231], v[86:87], v[118:119], v[230:231]
    v_pk_fma_f32 v[228:229], v[88:89], v[120:121], v[228:229]
    v_pk_fma_f32 v[230:231], v[90:91], v[122:123], v[230:231]
    v_mfma_f32_32x32x8_bf16 v[140:155], v[40:41], v[208:209], v[44:59]
    v_exp_f32 v220, v156
    v_exp_f32 v221, v157
    v_exp_f32 v222, v158
    v_exp_f32 v223, v159
    v_mfma_f32_32x32x16_bf16 v[140:155], v[32:35], v[188:191], v[140:155]
    v_exp_f32 v224, v160
    v_exp_f32 v225, v161
    v_exp_f32 v226, v162
    v_exp_f32 v227, v163
    v_pk_add_f32 v[220:221], v[220:221], 1.0 op_sel_hi:[1,0]
    v_pk_add_f32 v[222:223], v[222:223], 1.0 op_sel_hi:[1,0]
    v_pk_add_f32 v[224:225], v[224:225], 1.0 op_sel_hi:[1,0]
    v_pk_add_f32 v[226:227], v[226:227], 1.0 op_sel_hi:[1,0]
    v_mfma_f32_32x32x16_bf16 v[140:155], v[0:3], v[172:175], v[140:155]
    v_rcp_f32 v220, v220
    v_rcp_f32 v221, v221
    v_rcp_f32 v222, v222
    v_rcp_f32 v223, v223
    v_mfma_f32_32x32x16_bf16 v[140:155], v[4:7], v[176:179], v[140:155]
    v_rcp_f32 v224, v224
    v_rcp_f32 v225, v225
    v_rcp_f32 v226, v226
    v_rcp_f32 v227, v227
    v_pk_fma_f32 v[92:93], v[156:157], v[220:221], v[92:93]
    v_pk_fma_f32 v[94:95], v[158:159], v[222:223], v[94:95]
    v_pk_fma_f32 v[96:97], v[160:161], v[224:225], v[96:97]
    v_pk_fma_f32 v[98:99], v[162:163], v[226:227], v[98:99]
    v_pk_fma_f32 v[228:229], v[92:93], v[124:125], v[228:229]
    v_pk_fma_f32 v[230:231], v[94:95], v[126:127], v[230:231]
    v_pk_fma_f32 v[228:229], v[96:97], v[128:129], v[228:229]
    v_pk_fma_f32 v[230:231], v[98:99], v[130:131], v[230:231]
    v_mfma_f32_32x32x16_bf16 v[140:155], v[8:11], v[180:183], v[140:155]
    v_exp_f32 v220, v164
    v_exp_f32 v221, v165
    v_exp_f32 v222, v166
    v_exp_f32 v223, v167
    v_mfma_f32_32x32x16_bf16 v[140:155], v[12:15], v[184:187], v[140:155]
    v_exp_f32 v224, v168
    v_exp_f32 v225, v169
    v_exp_f32 v226, v170
    v_exp_f32 v227, v171
    v_pk_add_f32 v[220:221], v[220:221], 1.0 op_sel_hi:[1,0]
    v_pk_add_f32 v[222:223], v[222:223], 1.0 op_sel_hi:[1,0]
    v_pk_add_f32 v[224:225], v[224:225], 1.0 op_sel_hi:[1,0]
    v_pk_add_f32 v[226:227], v[226:227], 1.0 op_sel_hi:[1,0]
    v_rcp_f32 v220, v220
    v_rcp_f32 v221, v221
    v_rcp_f32 v222, v222
    v_rcp_f32 v223, v223
    v_rcp_f32 v224, v224
    v_rcp_f32 v225, v225
    v_rcp_f32 v226, v226
    v_rcp_f32 v227, v227
    v_pk_fma_f32 v[100:101], v[164:165], v[220:221], v[100:101]
    v_pk_fma_f32 v[102:103], v[166:167], v[222:223], v[102:103]
    v_pk_fma_f32 v[104:105], v[168:169], v[224:225], v[104:105]
    v_pk_fma_f32 v[106:107], v[170:171], v[226:227], v[106:107]
    v_pk_fma_f32 v[228:229], v[100:101], v[132:133], v[228:229]
    v_pk_fma_f32 v[230:231], v[102:103], v[134:135], v[230:231]
    v_pk_fma_f32 v[228:229], v[104:105], v[136:137], v[228:229]
    v_pk_fma_f32 v[230:231], v[106:107], v[138:139], v[230:231]
    v_pk_add_f32 v[228:229], v[228:229], v[230:231]
    s_cmp_eq_u64 s[28:29], 0
    v_add_f32 v247, v228, v229
    v_sub_f32 v248, v247, v243
    v_pk_fma_f32 v[244:245], v[236:237], v[248:249], v[244:245] op_sel_hi:[1,0,1]
    v_fmac_f32 v246, v238, v248
    s_mov_b64 exec, -1
    s_cbranch_scc0 K2_LOOP
K2_DONE:
    v_and_b32 v203, 63, v250
    s_or_b32 s95, s7, s93
    s_cselect_b32 s97, 3, s97
    s_cmp_gt_u32 s97, 2
    v_lshlrev_b32 v203, 4, v203
    s_cbranch_scc1 K2_SLOW
    v_bfe_u32 v220, v249, 1, 3
    v_lshlrev_b32 v220, 4, v220
    v_lshlrev_b32 v221, 2, v219
    v_xor_b32 v220, v220, v221
    v_lshl_add_u32 v220, v249, 7, v220
    v_add_u32 v220, 100352, v220
    v_xor_b32 v221, 16, v220
    v_xor_b32 v222, 32, v220
    v_xor_b32 v223, 48, v220
    ds_read_b128 v[172:175], v220
    ds_read_b128 v[176:179], v221
    ds_read_b128 v[180:183], v222
    ds_read_b128 v[184:187], v223
    v_add_u32 v220, 125952, v203
    v_cmp_eq_u32_e64 s[46:47], 16, v206
    v_cmp_eq_u32_e64 s[44:45], 8, v206
    v_add_u32 v218, s4, v249
    ds_read_b128 v[0:3], v220 offset:32768
    ds_read_b128 v[4:7], v220 offset:33792
    ds_read_b128 v[8:11], v220 offset:34816
    ds_read_b128 v[12:15], v220 offset:35840
    ds_read_b128 v[16:19], v220 offset:0
    ds_read_b128 v[20:23], v220 offset:1024
    ds_read_b128 v[24:27], v220 offset:2048
    ds_read_b128 v[28:31], v220 offset:3072
    ds_read_b128 v[44:47], v220 offset:4096
    ds_read_b128 v[48:51], v220 offset:5120
    ds_read_b128 v[52:55], v220 offset:6144
    ds_read_b128 v[56:59], v220 offset:7168
    ds_read_b128 v[60:63], v220 offset:8192
    ds_read_b128 v[64:67], v220 offset:9216
    ds_read_b128 v[68:71], v220 offset:10240
    ds_read_b128 v[72:75], v220 offset:11264
    s_mov_b64 exec, s[46:47]
    s_and_b32 s46, s46, 0x55555555
    s_or_b32 s44, s44, s46
    s_mov_b32 s98, s94
    v_add_f32_dpp v244, v244, v244 quad_perm:[1,0,3,2] row_mask:0xf bank_mask:0xf
    v_add_f32_dpp v245, v245, v245 quad_perm:[1,0,3,2] row_mask:0xf bank_mask:0xf
    v_add_f32_dpp v246, v246, v246 quad_perm:[1,0,3,2] row_mask:0xf bank_mask:0xf
    v_add_f32_dpp v76, v76, v76 quad_perm:[1,0,3,2] row_mask:0xf bank_mask:0xf
    v_add_f32_dpp v77, v77, v77 quad_perm:[1,0,3,2] row_mask:0xf bank_mask:0xf
    v_add_f32_dpp v78, v78, v78 quad_perm:[1,0,3,2] row_mask:0xf bank_mask:0xf
    v_add_f32_dpp v79, v79, v79 quad_perm:[1,0,3,2] row_mask:0xf bank_mask:0xf
    v_add_f32_dpp v80, v80, v80 quad_perm:[1,0,3,2] row_mask:0xf bank_mask:0xf
    v_add_f32_dpp v81, v81, v81 quad_perm:[1,0,3,2] row_mask:0xf bank_mask:0xf
    v_add_f32_dpp v82, v82, v82 quad_perm:[1,0,3,2] row_mask:0xf bank_mask:0xf
    v_add_f32_dpp v83, v83, v83 quad_perm:[1,0,3,2] row_mask:0xf bank_mask:0xf
    v_add_f32_dpp v84, v84, v84 quad_perm:[1,0,3,2] row_mask:0xf bank_mask:0xf
    v_add_f32_dpp v85, v85, v85 quad_perm:[1,0,3,2] row_mask:0xf bank_mask:0xf
    v_add_f32_dpp v86, v86, v86 quad_perm:[1,0,3,2] row_mask:0xf bank_mask:0xf
    v_add_f32_dpp v87, v87, v87 quad_perm:[1,0,3,2] row_mask:0xf bank_mask:0xf
    v_add_f32_dpp v88, v88, v88 quad_perm:[1,0,3,2] row_mask:0xf bank_mask:0xf
    v_add_f32_dpp v89, v89, v89 quad_perm:[1,0,3,2] row_mask:0xf bank_mask:0xf
    v_add_f32_dpp v90, v90, v90 quad_perm:[1,0,3,2] row_mask:0xf bank_mask:0xf
    v_add_f32_dpp v91, v91, v91 quad_perm:[1,0,3,2] row_mask:0xf bank_mask:0xf
    v_add_f32_dpp v92, v92, v92 quad_perm:[1,0,3,2] row_mask:0xf bank_mask:0xf
    v_add_f32_dpp v93, v93, v93 quad_perm:[1,0,3,2] row_mask:0xf bank_mask:0xf
    v_add_f32_dpp v94, v94, v94 quad_perm:[1,0,3,2] row_mask:0xf bank_mask:0xf
    v_add_f32_dpp v95, v95, v95 quad_perm:[1,0,3,2] row_mask:0xf bank_mask:0xf
    v_add_f32_dpp v96, v96, v96 quad_perm:[1,0,3,2] row_mask:0xf bank_mask:0xf
    v_add_f32_dpp v97, v97, v97 quad_perm:[1,0,3,2] row_mask:0xf bank_mask:0xf
    v_add_f32_dpp v98, v98, v98 quad_perm:[1,0,3,2] row_mask:0xf bank_mask:0xf
    v_add_f32_dpp v99, v99, v99 quad_perm:[1,0,3,2] row_mask:0xf bank_mask:0xf
    v_add_f32_dpp v100, v100, v100 quad_perm:[1,0,3,2] row_mask:0xf bank_mask:0xf
    v_add_f32_dpp v101, v101, v101 quad_perm:[1,0,3,2] row_mask:0xf bank_mask:0xf
    v_add_f32_dpp v102, v102, v102 quad_perm:[1,0,3,2] row_mask:0xf bank_mask:0xf
    v_add_f32_dpp v103, v103, v103 quad_perm:[1,0,3,2] row_mask:0xf bank_mask:0xf
    v_add_f32_dpp v104, v104, v104 quad_perm:[1,0,3,2] row_mask:0xf bank_mask:0xf
    v_add_f32_dpp v105, v105, v105 quad_perm:[1,0,3,2] row_mask:0xf bank_mask:0xf
    v_add_f32_dpp v106, v106, v106 quad_perm:[1,0,3,2] row_mask:0xf bank_mask:0xf
    v_add_f32_dpp v107, v107, v107 quad_perm:[1,0,3,2] row_mask:0xf bank_mask:0xf
    s_mov_b64 exec, -1
    v_mov_b32 v224, v244
    v_mov_b32 v225, v245
    v_mov_b32 v226, v246
    s_nop 1
    v_permlane32_swap_b32 v224, v244
    v_permlane32_swap_b32 v225, v245
    v_permlane32_swap_b32 v226, v246
    s_nop 1
    v_add_f32 v244, v244, v224
    v_add_f32 v245, v245, v225
    v_add_f32 v246, v246, v226
    s_branch K2_TAIL
K2_EMPTY:
    s_waitcnt vmcnt(0) lgkmcnt(0)
    v_mov_b32 v244, 0
    v_mov_b32 v245, 0
    v_mov_b32 v246, 0
    v_mov_b32 v76, 0
    v_mov_b32 v77, 0
    v_mov_b32 v78, 0
    v_mov_b32 v79, 0
    v_mov_b32 v80, 0
    v_mov_b32 v81, 0
    v_mov_b32 v82, 0
    v_mov_b32 v83, 0
    v_mov_b32 v84, 0
    v_mov_b32 v85, 0
    v_mov_b32 v86, 0
    v_mov_b32 v87, 0
    v_mov_b32 v88, 0
    v_mov_b32 v89, 0
    v_mov_b32 v90, 0
    v_mov_b32 v91, 0
    v_mov_b32 v92, 0
    v_mov_b32 v93, 0
    v_mov_b32 v94, 0
    v_mov_b32 v95, 0
    v_mov_b32 v96, 0
    v_mov_b32 v97, 0
    v_mov_b32 v98, 0
    v_mov_b32 v99, 0
    v_mov_b32 v100, 0
    v_mov_b32 v101, 0
    v_mov_b32 v102, 0
    v_mov_b32 v103, 0
    v_mov_b32 v104, 0
    v_mov_b32 v105, 0
    v_mov_b32 v106, 0
    v_mov_b32 v107, 0
    v_mov_b32 v242, v241
    v_and_b32 v241, 0xffff0000, v240
    v_lshlrev_b32 v240, 16, v240
    s_branch K2_DONE
K2_SLOW:
    v_and_b32 v223, 31, v250
    v_lshlrev_b32 v220, 2, v219
    v_xor_b32 v220, v220, v251
    v_lshl_add_u32 v220, v219, 11, v220
    s_lshl_b32 s95, s100, 10
    s_add_u32 s95, s95, 129024
    v_lshl_add_u32 v221, v223, 5, v219
    v_add_u32 v221, s95, v221
    s_lshl_b32 s95, s5, 5
    v_add_u32 v223, s95, v223
    v_add_u32 v218, s4, v223
    v_min_u32 v222, 49999, v218
    s_waitcnt vmcnt(0)
    buffer_load_dwordx2 v[240:241], v222, s[16:19], 0 idxen
    v_xor_b32 v222, 0, v220
    ds_write_b128 v222, v[76:79]
    v_xor_b32 v222, 16, v220
    ds_write_b128 v222, v[80:83]
    v_xor_b32 v222, 32, v220
    ds_write_b128 v222, v[84:87]
    v_xor_b32 v222, 48, v220
    ds_write_b128 v222, v[88:91]
    v_xor_b32 v222, 64, v220
    ds_write_b128 v222, v[92:95]
    v_xor_b32 v222, 80, v220
    ds_write_b128 v222, v[96:99]
    v_xor_b32 v222, 96, v220
    ds_write_b128 v222, v[100:103]
    v_xor_b32 v222, 112, v220
    ds_write_b128 v222, v[104:107]
    ds_write_b128 v221, v[244:247]
    v_lshlrev_b32 v220, 2, v223
    ds_read_b32 v235, v220 offset:32768
    s_sub_u32 s99, s101, s94
    v_add_u32 v251, s99, v251
    v_add_u32 v252, s99, v252
    v_add_u32 v253, s99, v253
    v_add_u32 v254, s99, v254
    ds_read_b128 v[172:175], v251 offset:0
    ds_read_b128 v[176:179], v252 offset:0
    ds_read_b128 v[180:183], v253 offset:0
    ds_read_b128 v[184:187], v254 offset:0
    v_mov_b32 v76, 0
    v_mov_b32 v77, 0
    v_mov_b32 v78, 0
    v_mov_b32 v79, 0
    v_mov_b32 v80, 0
    v_mov_b32 v81, 0
    v_mov_b32 v82, 0
    v_mov_b32 v83, 0
    v_mov_b32 v84, 0
    v_mov_b32 v85, 0
    v_mov_b32 v86, 0
    v_mov_b32 v87, 0
    v_mov_b32 v88, 0
    v_mov_b32 v89, 0
    v_mov_b32 v90, 0
    v_mov_b32 v91, 0
    v_mov_b32 v92, 0
    v_mov_b32 v93, 0
    v_mov_b32 v94, 0
    v_mov_b32 v95, 0
    v_mov_b32 v96, 0
    v_mov_b32 v97, 0
    v_mov_b32 v98, 0
    v_mov_b32 v99, 0
    v_mov_b32 v100, 0
    v_mov_b32 v101, 0
    v_mov_b32 v102, 0
    v_mov_b32 v103, 0
    v_mov_b32 v104, 0
    v_mov_b32 v105, 0
    v_mov_b32 v106, 0
    v_mov_b32 v107, 0
    v_mov_b32 v244, 0
    v_mov_b32 v245, 0
    v_mov_b32 v246, 0
    s_lshl_b32 s99, s3, 8
    v_add_u32 v249, s99, v223
    v_mul_u32_u24 v249, 272, v249
    v_lshl_add_u32 v243, v219, 3, v249
    s_mov_b32 s99, 7602176
    s_cmp_eq_u32 s7, 0
    s_cbranch_scc1 K2_NOLD
    buffer_load_dwordx4 v[76:79], v243, s[20:23], s99 offen offset:0 sc0 sc1
    buffer_load_dwordx4 v[80:83], v243, s[20:23], s99 offen offset:16 sc0 sc1
    buffer_load_dwordx4 v[84:87], v243, s[20:23], s99 offen offset:32 sc0 sc1
    buffer_load_dwordx4 v[88:91], v243, s[20:23], s99 offen offset:48 sc0 sc1
    buffer_load_dwordx4 v[92:95], v243, s[20:23], s99 offen offset:64 sc0 sc1
    buffer_load_dwordx4 v[96:99], v243, s[20:23], s99 offen offset:80 sc0 sc1
    buffer_load_dwordx4 v[100:103], v243, s[20:23], s99 offen offset:96 sc0 sc1
    buffer_load_dwordx4 v[104:107], v243, s[20:23], s99 offen offset:112 sc0 sc1
    buffer_load_dwordx3 v[244:246], v249, s[20:23], s99 offen offset:256 sc0 sc1
    s_waitcnt vmcnt(0)
K2_NOLD:
    s_waitcnt lgkmcnt(0)
    v_and_b32 v207, 0xffff, v235
    v_lshrrev_b32 v235, 16, v235
    v_lshlrev_b32 v247, 11, v219
    v_add_u32 v247, 34816, v247
    v_add_u32 v220, 138240, v203
    v_cmp_lt_u32 vcc, 0, v235
    s_barrier
    s_cbranch_vccz K2_GDONE
K2_GLOOP:
    s_mov_b64 exec, vcc
    v_bfe_u32 v221, v207, 3, 3
    v_lshlrev_b32 v221, 4, v221
    v_lshl_add_u32 v221, v207, 5, v221
    v_add_u32 v221, v247, v221
    v_xor_b32 v222, 0, v221
    ds_read_b128 v[140:143], v222
    v_xor_b32 v222, 16, v221
    ds_read_b128 v[144:147], v222
    v_xor_b32 v222, 32, v221
    ds_read_b128 v[148:151], v222
    v_xor_b32 v222, 48, v221
    ds_read_b128 v[152:155], v222
    v_xor_b32 v222, 64, v221
    ds_read_b128 v[156:159], v222
    v_xor_b32 v222, 80, v221
    ds_read_b128 v[160:163], v222
    v_xor_b32 v222, 96, v221
    ds_read_b128 v[164:167], v222
    v_xor_b32 v222, 112, v221
    ds_read_b128 v[168:171], v222
    v_lshlrev_b32 v222, 3, v207
    v_add_u32 v222, 129024, v222
    ds_read_b128 v[188:191], v222
    ds_read_b128 v[192:195], v222 offset:16
    v_add_u32 v207, 4, v207
    v_subrev_u32 v235, 1, v235
    v_cmp_lt_u32 vcc, 0, v235
    s_waitcnt lgkmcnt(9)
    v_pk_add_f32 v[76:77], v[76:77], v[140:141]
    v_pk_add_f32 v[78:79], v[78:79], v[142:143]
    s_waitcnt lgkmcnt(8)
    v_pk_add_f32 v[80:81], v[80:81], v[144:145]
    v_pk_add_f32 v[82:83], v[82:83], v[146:147]
    s_waitcnt lgkmcnt(7)
    v_pk_add_f32 v[84:85], v[84:85], v[148:149]
    v_pk_add_f32 v[86:87], v[86:87], v[150:151]
    s_waitcnt lgkmcnt(6)
    v_pk_add_f32 v[88:89], v[88:89], v[152:153]
    v_pk_add_f32 v[90:91], v[90:91], v[154:155]
    s_waitcnt lgkmcnt(5)
    v_pk_add_f32 v[92:93], v[92:93], v[156:157]
    v_pk_add_f32 v[94:95], v[94:95], v[158:159]
    s_waitcnt lgkmcnt(4)
    v_pk_add_f32 v[96:97], v[96:97], v[160:161]
    v_pk_add_f32 v[98:99], v[98:99], v[162:163]
    s_waitcnt lgkmcnt(3)
    v_pk_add_f32 v[100:101], v[100:101], v[164:165]
    v_pk_add_f32 v[102:103], v[102:103], v[166:167]
    s_waitcnt lgkmcnt(2)
    v_pk_add_f32 v[104:105], v[104:105], v[168:169]
    v_pk_add_f32 v[106:107], v[106:107], v[170:171]
    s_waitcnt lgkmcnt(0)
    v_pk_add_f32 v[244:245], v[244:245], v[188:189]
    v_add_f32 v246, v246, v190
    v_pk_add_f32 v[244:245], v[244:245], v[192:193]
    v_add_f32 v246, v246, v194
    s_cbranch_vccnz K2_GLOOP
    s_mov_b64 exec, -1
K2_GDONE:
    s_cmp_eq_u32 s93, 0
    s_cbranch_scc1 K2_EPI
    buffer_store_dwordx4 v[76:79], v243, s[20:23], s99 offen offset:0
    buffer_store_dwordx4 v[80:83], v243, s[20:23], s99 offen offset:16
    buffer_store_dwordx4 v[84:87], v243, s[20:23], s99 offen offset:32
    buffer_store_dwordx4 v[88:91], v243, s[20:23], s99 offen offset:48
    buffer_store_dwordx4 v[92:95], v243, s[20:23], s99 offen offset:64
    buffer_store_dwordx4 v[96:99], v243, s[20:23], s99 offen offset:80
    buffer_store_dwordx4 v[100:103], v243, s[20:23], s99 offen offset:96
    buffer_store_dwordx4 v[104:107], v243, s[20:23], s99 offen offset:112
    buffer_store_dwordx3 v[244:246], v249, s[20:23], s99 offen offset:256
    s_add_u32 s7, s7, s92
    s_waitcnt vmcnt(0)
    s_barrier
    s_branch K2_TOP
K2_EPI:
    s_cmp_ge_u32 s5, 6
    s_cbranch_scc1 K2_NWH2
    s_mul_i32 s95, s5, 2048
    s_add_u32 m0, s95, 138240
    s_add_u32 s95, s95, 7561216
    buffer_load_dwordx4 v203, s[20:23], s95 offen offset:0 lds
    buffer_load_dwordx4 v203, s[20:23], s95 offen offset:1024 lds
K2_NWH2:
    s_lshl_b32 s95, s5, 5
    s_cmp_ge_u32 s95, s96
    s_waitcnt vmcnt(0)
    s_barrier
    s_cbranch_scc1 K2_END0
    ds_read_b128 v[0:3], v220 offset:20480
    ds_read_b128 v[4:7], v220 offset:21504
    ds_read_b128 v[8:11], v220 offset:22528
    ds_read_b128 v[12:15], v220 offset:23552
    ds_read_b128 v[16:19], v220 offset:0
    ds_read_b128 v[20:23], v220 offset:1024
    ds_read_b128 v[24:27], v220 offset:2048
    ds_read_b128 v[28:31], v220 offset:3072
    ds_read_b128 v[44:47], v220 offset:4096
    ds_read_b128 v[48:51], v220 offset:5120
    ds_read_b128 v[52:55], v220 offset:6144
    ds_read_b128 v[56:59], v220 offset:7168
    ds_read_b128 v[60:63], v220 offset:8192
    ds_read_b128 v[64:67], v220 offset:9216
    ds_read_b128 v[68:71], v220 offset:10240
    ds_read_b128 v[72:75], v220 offset:11264
    v_cmp_gt_u32_e64 s[44:45], s96, v223
    s_mov_b32 s98, s101
    s_waitcnt vmcnt(0)
    v_mov_b32 v242, v241
    v_and_b32 v241, 0xffff0000, v240
    v_lshlrev_b32 v240, 16, v240
K2_TAIL:
    v_add_u32 v235, s98, v203
    v_lshlrev_b32 v203, 7, v218
    v_cndmask_b32_e64 v203, 2.0, v203, s[44:45]
    s_waitcnt lgkmcnt(8)
    v_mfma_f32_32x32x16_bf16 v[140:155], v[0:3], v[172:175], 0
    v_cvt_pk_bf16_f32 v108, v76, v77
    v_cvt_pk_bf16_f32 v109, v78, v79
    v_mfma_f32_32x32x16_bf16 v[156:171], v[16:19], v[172:175], 0
    v_cvt_pk_bf16_f32 v110, v80, v81
    v_cvt_pk_bf16_f32 v111, v82, v83
    v_mfma_f32_32x32x16_bf16 v[140:155], v[4:7], v[176:179], v[140:155]
    v_cvt_pk_bf16_f32 v112, v84, v85
    v_cvt_pk_bf16_f32 v113, v86, v87
    v_mfma_f32_32x32x16_bf16 v[156:171], v[20:23], v[176:179], v[156:171]
    v_cvt_pk_bf16_f32 v114, v88, v89
    v_cvt_pk_bf16_f32 v115, v90, v91
    v_mfma_f32_32x32x16_bf16 v[140:155], v[8:11], v[180:183], v[140:155]
    v_cvt_pk_bf16_f32 v116, v92, v93
    v_cvt_pk_bf16_f32 v117, v94, v95
    v_mfma_f32_32x32x16_bf16 v[156:171], v[24:27], v[180:183], v[156:171]
    v_cvt_pk_bf16_f32 v118, v96, v97
    v_cvt_pk_bf16_f32 v119, v98, v99
    v_mfma_f32_32x32x16_bf16 v[140:155], v[12:15], v[184:187], v[140:155]
    v_cvt_pk_bf16_f32 v120, v100, v101
    v_cvt_pk_bf16_f32 v121, v102, v103
    v_mfma_f32_32x32x16_bf16 v[156:171], v[28:31], v[184:187], v[156:171]
    v_cvt_pk_bf16_f32 v122, v104, v105
    v_cvt_pk_bf16_f32 v123, v106, v107
    s_waitcnt lgkmcnt(0)
    ds_bpermute_b32 v210, v239, v203 offset:0
    ds_bpermute_b32 v212, v239, v203 offset:32
    ds_bpermute_b32 v214, v239, v203 offset:64
    ds_bpermute_b32 v216, v239, v203 offset:96
    v_mfma_f32_32x32x16_bf16 v[140:155], v[44:47], v[108:111], v[140:155]
    v_lshlrev_b32 v76, 16, v172
    v_and_b32 v77, 0xffff0000, v172
    v_lshlrev_b32 v78, 16, v173
    v_and_b32 v79, 0xffff0000, v173
    v_lshlrev_b32 v80, 16, v174
    v_and_b32 v81, 0xffff0000, v174
    v_lshlrev_b32 v82, 16, v175
    v_and_b32 v83, 0xffff0000, v175
    v_mfma_f32_32x32x16_bf16 v[140:155], v[48:51], v[112:115], v[140:155]
    v_lshlrev_b32 v84, 16, v176
    v_and_b32 v85, 0xffff0000, v176
    v_lshlrev_b32 v86, 16, v177
    v_and_b32 v87, 0xffff0000, v177
    v_lshlrev_b32 v88, 16, v178
    v_and_b32 v89, 0xffff0000, v178
    v_lshlrev_b32 v90, 16, v179
    v_and_b32 v91, 0xffff0000, v179
    v_mfma_f32_32x32x16_bf16 v[140:155], v[52:55], v[116:119], v[140:155]
    v_lshlrev_b32 v92, 16, v180
    v_and_b32 v93, 0xffff0000, v180
    v_lshlrev_b32 v94, 16, v181
    v_and_b32 v95, 0xffff0000, v181
    v_lshlrev_b32 v96, 16, v182
    v_and_b32 v97, 0xffff0000, v182
    v_lshlrev_b32 v98, 16, v183
    v_and_b32 v99, 0xffff0000, v183
    v_mfma_f32_32x32x16_bf16 v[140:155], v[56:59], v[120:123], v[140:155]
    v_lshlrev_b32 v100, 16, v184
    v_and_b32 v101, 0xffff0000, v184
    v_lshlrev_b32 v102, 16, v185
    v_and_b32 v103, 0xffff0000, v185
    v_lshlrev_b32 v104, 16, v186
    v_and_b32 v105, 0xffff0000, v186
    v_lshlrev_b32 v106, 16, v187
    v_and_b32 v107, 0xffff0000, v187
    v_mfma_f32_32x32x16_bf16 v[156:171], v[60:63], v[108:111], v[156:171]
    v_mov_b32 v243, 0
    v_pk_add_f32 v[244:245], v[244:245], v[240:241]
    v_add_f32 v246, v246, v242
    v_cvt_pk_bf16_f32 v244, v244, v245
    v_cvt_pk_bf16_f32 v246, v246, v246
    s_mov_b32 exec_lo, s44
    s_mov_b32 exec_hi, 0
    s_cmp_eq_u32 s98, s94
    s_cbranch_scc1 K2_PF
    v_mul_u32_u24 v220, 6, v218
    s_mov_b32 s99, 6400000
    buffer_store_short v244, v220, s[24:27], s99 offen
    buffer_store_short_d16_hi v244, v220, s[24:27], s99 offen offset:2
    buffer_store_short v246, v220, s[24:27], s99 offen offset:4
    s_branch K2_PD
K2_PF:
    s_mov_b32 s99, 32768
    v_mad_u32_u24 v220, v249, 6, s99
    ds_write_b16 v220, v244
    ds_write_b16_d16_hi v220, v244 offset:2
    ds_write_b16 v220, v246 offset:4
    s_mov_b64 exec, 1
    v_mov_b32 v220, 108
    v_mov_b32 v221, 1
    ds_add_rtn_u32 v243, v220, v221
K2_PD:
    s_mov_b64 exec, -1
    s_mov_b32 s40, 0xbf317218
    s_mov_b32 s41, 0xbf317218
    v_mfma_f32_32x32x16_bf16 v[156:171], v[64:67], v[112:115], v[156:171]
    v_exp_f32 v220, v140
    v_exp_f32 v221, v141
    v_exp_f32 v222, v142
    v_exp_f32 v223, v143
    v_mfma_f32_32x32x16_bf16 v[156:171], v[68:71], v[116:119], v[156:171]
    v_exp_f32 v224, v144
    v_exp_f32 v225, v145
    v_exp_f32 v226, v146
    v_exp_f32 v227, v147
    v_pk_add_f32 v[220:221], v[220:221], 1.0 op_sel_hi:[1,0]
    v_pk_add_f32 v[222:223], v[222:223], 1.0 op_sel_hi:[1,0]
    v_mfma_f32_32x32x16_bf16 v[156:171], v[72:75], v[120:123], v[156:171]
    v_pk_add_f32 v[224:225], v[224:225], 1.0 op_sel_hi:[1,0]
    v_pk_add_f32 v[226:227], v[226:227], 1.0 op_sel_hi:[1,0]
    v_rcp_f32 v220, v220
    v_rcp_f32 v221, v221
    v_rcp_f32 v222, v222
    v_rcp_f32 v223, v223
    v_rcp_f32 v224, v224
    v_rcp_f32 v225, v225
    v_rcp_f32 v226, v226
    v_rcp_f32 v227, v227
    s_waitcnt lgkmcnt(0)
    v_add_u32 v210, v210, v211
    v_add_u32 v212, v212, v213
    v_add_u32 v214, v214, v215
    v_add_u32 v216, v216, v217
    v_pk_mul_f32 v[220:221], v[220:221], v[140:141]
    v_pk_mul_f32 v[222:223], v[222:223], v[142:143]
    v_pk_mul_f32 v[224:225], v[224:225], v[144:145]
    v_pk_mul_f32 v[226:227], v[226:227], v[146:147]
    v_pk_fma_f32 v[220:221], v[220:221], s[40:41], v[76:77]
    v_pk_fma_f32 v[222:223], v[222:223], s[40:41], v[78:79]
    v_pk_fma_f32 v[224:225], v[224:225], s[40:41], v[80:81]
    v_pk_fma_f32 v[226:227], v[226:227], s[40:41], v[82:83]
    v_cvt_pk_bf16_f32 v172, v220, v221
    v_cvt_pk_bf16_f32 v173, v222, v223
    v_cvt_pk_bf16_f32 v174, v224, v225
    v_cvt_pk_bf16_f32 v175, v226, v227
    s_waitcnt vmcnt(0)
    ds_write_b128 v251, v[172:175]
    v_exp_f32 v220, v148
    v_exp_f32 v221, v149
    v_exp_f32 v222, v150
    v_exp_f32 v223, v151
    v_exp_f32 v224, v152
    v_exp_f32 v225, v153
    v_exp_f32 v226, v154
    v_exp_f32 v227, v155
    v_pk_add_f32 v[220:221], v[220:221], 1.0 op_sel_hi:[1,0]
    v_pk_add_f32 v[222:223], v[222:223], 1.0 op_sel_hi:[1,0]
    v_pk_add_f32 v[224:225], v[224:225], 1.0 op_sel_hi:[1,0]
    v_pk_add_f32 v[226:227], v[226:227], 1.0 op_sel_hi:[1,0]
    v_rcp_f32 v220, v220
    v_rcp_f32 v221, v221
    v_rcp_f32 v222, v222
    v_rcp_f32 v223, v223
    v_rcp_f32 v224, v224
    v_rcp_f32 v225, v225
    v_rcp_f32 v226, v226
    v_rcp_f32 v227, v227
    v_pk_mul_f32 v[220:221], v[220:221], v[148:149]
    v_pk_mul_f32 v[222:223], v[222:223], v[150:151]
    v_pk_mul_f32 v[224:225], v[224:225], v[152:153]
    v_pk_mul_f32 v[226:227], v[226:227], v[154:155]
    v_pk_fma_f32 v[220:221], v[220:221], s[40:41], v[84:85]
    v_pk_fma_f32 v[222:223], v[222:223], s[40:41], v[86:87]
    v_pk_fma_f32 v[224:225], v[224:225], s[40:41], v[88:89]
    v_pk_fma_f32 v[226:227], v[226:227], s[40:41], v[90:91]
    v_cvt_pk_bf16_f32 v176, v220, v221
    v_cvt_pk_bf16_f32 v177, v222, v223
    v_cvt_pk_bf16_f32 v178, v224, v225
    v_cvt_pk_bf16_f32 v179, v226, v227
    ds_write_b128 v252, v[176:179]
    v_exp_f32 v220, v156
    v_exp_f32 v221, v157
    v_exp_f32 v222, v158
    v_exp_f32 v223, v159
    v_exp_f32 v224, v160
    v_exp_f32 v225, v161
    v_exp_f32 v226, v162
    v_exp_f32 v227, v163
    v_pk_add_f32 v[220:221], v[220:221], 1.0 op_sel_hi:[1,0]
    v_pk_add_f32 v[222:223], v[222:223], 1.0 op_sel_hi:[1,0]
    v_pk_add_f32 v[224:225], v[224:225], 1.0 op_sel_hi:[1,0]
    v_pk_add_f32 v[226:227], v[226:227], 1.0 op_sel_hi:[1,0]
    v_rcp_f32 v220, v220
    v_rcp_f32 v221, v221
    v_rcp_f32 v222, v222
    v_rcp_f32 v223, v223
    v_rcp_f32 v224, v224
    v_rcp_f32 v225, v225
    v_rcp_f32 v226, v226
    v_rcp_f32 v227, v227
    v_pk_mul_f32 v[220:221], v[220:221], v[156:157]
    v_pk_mul_f32 v[222:223], v[222:223], v[158:159]
    v_pk_mul_f32 v[224:225], v[224:225], v[160:161]
    v_pk_mul_f32 v[226:227], v[226:227], v[162:163]
    v_pk_fma_f32 v[220:221], v[220:221], s[40:41], v[92:93]
    v_pk_fma_f32 v[222:223], v[222:223], s[40:41], v[94:95]
    v_pk_fma_f32 v[224:225], v[224:225], s[40:41], v[96:97]
    v_pk_fma_f32 v[226:227], v[226:227], s[40:41], v[98:99]
    v_cvt_pk_bf16_f32 v180, v220, v221
    v_cvt_pk_bf16_f32 v181, v222, v223
    v_cvt_pk_bf16_f32 v182, v224, v225
    v_cvt_pk_bf16_f32 v183, v226, v227
    ds_write_b128 v253, v[180:183]
    v_exp_f32 v220, v164
    v_exp_f32 v221, v165
    v_exp_f32 v222, v166
    v_exp_f32 v223, v167
    v_exp_f32 v224, v168
    v_exp_f32 v225, v169
    v_exp_f32 v226, v170
    v_exp_f32 v227, v171
    v_pk_add_f32 v[220:221], v[220:221], 1.0 op_sel_hi:[1,0]
    v_pk_add_f32 v[222:223], v[222:223], 1.0 op_sel_hi:[1,0]
    v_pk_add_f32 v[224:225], v[224:225], 1.0 op_sel_hi:[1,0]
    v_pk_add_f32 v[226:227], v[226:227], 1.0 op_sel_hi:[1,0]
    v_rcp_f32 v220, v220
    v_rcp_f32 v221, v221
    v_rcp_f32 v222, v222
    v_rcp_f32 v223, v223
    v_rcp_f32 v224, v224
    v_rcp_f32 v225, v225
    v_rcp_f32 v226, v226
    v_rcp_f32 v227, v227
    v_pk_mul_f32 v[220:221], v[220:221], v[164:165]
    v_pk_mul_f32 v[222:223], v[222:223], v[166:167]
    v_pk_mul_f32 v[224:225], v[224:225], v[168:169]
    v_pk_mul_f32 v[226:227], v[226:227], v[170:171]
    v_pk_fma_f32 v[220:221], v[220:221], s[40:41], v[100:101]
    v_pk_fma_f32 v[222:223], v[222:223], s[40:41], v[102:103]
    v_pk_fma_f32 v[224:225], v[224:225], s[40:41], v[104:105]
    v_pk_fma_f32 v[226:227], v[226:227], s[40:41], v[106:107]
    v_cvt_pk_bf16_f32 v184, v220, v221
    v_cvt_pk_bf16_f32 v185, v222, v223
    v_cvt_pk_bf16_f32 v186, v224, v225
    v_cvt_pk_bf16_f32 v187, v226, v227
    ds_write_b128 v254, v[184:187]
    ds_read_b128 v[140:143], v235 offset:0
    ds_read_b128 v[144:147], v235 offset:1024
    ds_read_b128 v[148:151], v235 offset:2048
    ds_read_b128 v[152:155], v235 offset:3072
    s_waitcnt lgkmcnt(3)
    buffer_store_dwordx4 v[140:143], v210, s[24:27], 0 offen sc1
    s_waitcnt lgkmcnt(2)
    buffer_store_dwordx4 v[144:147], v212, s[24:27], 0 offen sc1
    s_waitcnt lgkmcnt(1)
    buffer_store_dwordx4 v[148:151], v214, s[24:27], 0 offen sc1
    s_waitcnt lgkmcnt(0)
    buffer_store_dwordx4 v[152:155], v216, s[24:27], 0 offen sc1
    v_readfirstlane_b32 s95, v243
    v_and_b32 v220, 63, v250
    v_lshlrev_b32 v220, 3, v220
    s_cmp_lg_u32 s95, 7
    s_cbranch_scc1 K2_PE
    ds_read_b64 v[188:189], v220 offset:32768
    ds_read_b64 v[190:191], v220 offset:33280
    ds_read_b64 v[192:193], v220 offset:33792
    s_mul_i32 s99, s4, 6
    s_add_u32 s99, s99, 6400000
    s_mul_i32 s95, s96, 6
    v_cmp_gt_i32 vcc, s95, v220
    s_sub_i32 s95, s95, 512
    s_waitcnt lgkmcnt(2)
    s_mov_b64 exec, vcc
    buffer_store_dwordx2 v[188:189], v220, s[24:27], s99 offen offset:0 sc1
    v_cmp_gt_i32 vcc, s95, v220
    s_sub_i32 s95, s95, 512
    s_waitcnt lgkmcnt(1)
    s_mov_b64 exec, vcc
    buffer_store_dwordx2 v[190:191], v220, s[24:27], s99 offen offset:512 sc1
    v_cmp_gt_i32 vcc, s95, v220
    s_sub_i32 s95, s95, 512
    s_waitcnt lgkmcnt(0)
    s_mov_b64 exec, vcc
    buffer_store_dwordx2 v[192:193], v220, s[24:27], s99 offen offset:1024 sc1
    s_mov_b64 exec, -1
K2_PE:
    s_endpgm
K2_END0:
    s_waitcnt vmcnt(0)
K2_END:
    s_endpgm
.section .rodata,"a"
.p2align 6
.amdhsa_kernel egnn_sort_kernel
  .amdhsa_next_free_vgpr 56
  .amdhsa_next_free_sgpr 48
  .amdhsa_accum_offset 56
  .amdhsa_group_segment_fixed_size 0
  .amdhsa_kernarg_size 88
  .amdhsa_user_sgpr_count 2
  .amdhsa_user_sgpr_kernarg_segment_ptr 1
  .amdhsa_system_sgpr_workgroup_id_x 1
.end_amdhsa_kernel
.p2align 6
.amdhsa_kernel egnn_main_kernel
  .amdhsa_next_free_vgpr 256
  .amdhsa_next_free_sgpr 102
  .amdhsa_accum_offset 256
  .amdhsa_group_segment_fixed_size 0
  .amdhsa_kernarg_size 88
  .amdhsa_user_sgpr_count 2
  .amdhsa_user_sgpr_kernarg_segment_ptr 1
  .amdhsa_system_sgpr_workgroup_id_x 1
.end_amdhsa_kernel
```

```asm
; @launch kernel=egnn_sort_kernel grid=(250,1,1) block=(896,1,1) lds=27904
; @launch kernel=egnn_main_kernel grid=(256,1,1) block=(512,1,1) lds=162816
.amdgcn_target "amdgcn-amd-amdhsa--gfx950"
.text
.globl egnn_sort_kernel
.p2align 8
.type egnn_sort_kernel,@function
egnn_sort_kernel:
    s_cmp_ge_u32 s2, 250
    s_cbranch_scc1 K1_END
    s_load_dwordx2 s[38:39], s[0:1], 80
    v_lshrrev_b32 v1, 6, v0
    s_nop 0
    v_readfirstlane_b32 s3, v1
    s_cmp_ge_u32 s3, 13
    s_cbranch_scc1 K1_FRAG
    s_load_dwordx4 s[4:7], s[0:1], 24
    s_load_dwordx4 s[8:11], s[0:1], 8
    s_and_b32 s28, s2, 7
    s_min_u32 s29, s28, 2
    s_mul_i32 s28, s28, 31
    s_lshr_b32 s2, s2, 3
    s_add_u32 s2, s2, s28
    s_add_u32 s2, s2, s29
    v_lshlrev_b32 v1, 2, v0
    v_mov_b32 v2, 0
    v_mov_b32 v3, 1
    v_cmp_gt_u32 vcc, 288, v0
    s_mov_b64 exec, vcc
    ds_write_b32 v1, v2 offset:0
    s_mov_b64 exec, -1
    s_mul_i32 s28, s2, 12800
    s_mul_i32 s29, s2, 200
    s_mul_i32 s30, s2, 3200
    s_mov_b32 s31, 85599
    s_movk_i32 s32, -196
    v_add_u32 v12, s29, v0
    v_mul_u32_u24 v13, 6, v12
    v_lshlrev_b32 v14, 4, v0
    v_mov_b32 v15, 800
    v_cmp_gt_u32 s[34:35], v15, v0
    v_mov_b32 v15, 200
    v_cmp_gt_u32 s[36:37], v15, v0
    s_waitcnt lgkmcnt(0)
    s_mov_b32 s12, s4
    s_and_b32 s13, s5, 0xffff
    s_mov_b32 s14, 3200000
    s_mov_b32 s15, 0x20000
    s_mov_b32 s16, s6
    s_and_b32 s17, s7, 0xffff
    s_mov_b32 s18, 3200000
    s_mov_b32 s19, 0x20000
    s_mov_b32 s20, s8
    s_and_b32 s21, s9, 0xffff
    s_mov_b32 s22, 300000
    s_mov_b32 s23, 0x20000
    s_mov_b32 s24, s38
    s_and_b32 s25, s39, 0xffff
    s_mov_b32 s26, 25600000
    s_mov_b32 s27, 0x20000
    s_cmp_ge_u32 s3, 4
    s_cbranch_scc1 K1_NOPOS
    s_mov_b64 exec, s[36:37]
    buffer_load_ushort v16, v13, s[20:23], 0 offen
    buffer_load_ushort v17, v13, s[20:23], 0 offen offset:2
    buffer_load_ushort v18, v13, s[20:23], 0 offen offset:4
K1_NOPOS:
    s_mov_b64 exec, s[34:35]
    buffer_load_dwordx4 v[4:7], v14, s[16:19], s28 offen nt
    v_add_u32 v20, s30, v1
    v_add_u32 v22, 1, v20
    v_add_u32 v24, 2, v20
    v_add_u32 v26, 3, v20
    s_barrier
    s_waitcnt vmcnt(0)
    buffer_load_dwordx4 v[8:11], v14, s[12:15], s28 offen nt
    v_mul_u32_u24 v28, s31, v4
    v_lshrrev_b32 v28, 24, v28
    v_mad_i32_i24 v4, v28, s32, v4
    v_lshlrev_b32 v28, 2, v28
    ds_add_rtn_u32 v32, v28, v3 offset:0
    v_lshrrev_b32 v52, 8, v28
    v_mul_u32_u24 v29, s31, v5
    v_lshrrev_b32 v29, 24, v29
    v_mad_i32_i24 v5, v29, s32, v5
    v_lshlrev_b32 v29, 2, v29
    ds_add_rtn_u32 v33, v29, v3 offset:0
    v_lshrrev_b32 v53, 8, v29
    v_mul_u32_u24 v30, s31, v6
    v_lshrrev_b32 v30, 24, v30
    v_mad_i32_i24 v6, v30, s32, v6
    v_lshlrev_b32 v30, 2, v30
    ds_add_rtn_u32 v34, v30, v3 offset:0
    v_lshrrev_b32 v54, 8, v30
    v_mul_u32_u24 v31, s31, v7
    v_lshrrev_b32 v31, 24, v31
    v_mad_i32_i24 v7, v31, s32, v7
    v_lshlrev_b32 v31, 2, v31
    ds_add_rtn_u32 v35, v31, v3 offset:0
    v_lshrrev_b32 v55, 8, v31
    s_cmp_ge_u32 s3, 4
    s_cbranch_scc1 K1_P3
    s_mov_b64 exec, s[36:37]
    v_lshl_or_b32 v16, v17, 16, v16
    v_lshlrev_b32 v17, 16, v18
    v_lshlrev_b32 v12, 3, v12
    s_mov_b32 s33, 6684672
    buffer_store_dwordx2 v[16:17], v12, s[24:27], s33 offen
    s_mov_b64 exec, s[34:35]
K1_P3:
    s_mov_b64 exec, -1
    v_and_b32 v2, 63, v0
    v_lshlrev_b32 v2, 4, v2
    s_waitcnt lgkmcnt(0)
    s_barrier
    ds_read_b128 v[36:39], v2 offset:0
    s_waitcnt lgkmcnt(0)
    v_add_u32 v42, v36, v37
    v_add_u32 v43, v42, v38
    v_add_u32 v44, v43, v39
    v_mov_b32 v45, v44
    s_nop 1
    v_add_u32_dpp v45, v45, v45 row_shr:1 row_mask:0xf bank_mask:0xf
    s_nop 1
    v_add_u32_dpp v45, v45, v45 row_shr:2 row_mask:0xf bank_mask:0xf
    s_nop 1
    v_add_u32_dpp v45, v45, v45 row_shr:4 row_mask:0xf bank_mask:0xf
    s_nop 1
    v_add_u32_dpp v45, v45, v45 row_shr:8 row_mask:0xf bank_mask:0xf
    s_nop 1
    v_add_u32_dpp v45, v45, v45 row_bcast:15 row_mask:0xa bank_mask:0xf
    s_nop 1
    v_add_u32_dpp v45, v45, v45 row_bcast:31 row_mask:0xc bank_mask:0xf
    v_sub_u32 v40, v45, v44
    v_add_u32 v41, v40, v36
    v_add_u32 v42, v40, v42
    v_add_u32 v43, v40, v43
    v_lshlrev_b32 v48, 3, v40
    v_lshlrev_b32 v49, 3, v41
    v_lshlrev_b32 v50, 3, v42
    v_lshlrev_b32 v51, 3, v43
    ds_write_b128 v2, v[48:51] offset:1280
    s_mov_b64 exec, s[34:35]
    ds_read_b32 v28, v28 offset:1280
    ds_read_b32 v29, v29 offset:1280
    ds_read_b32 v30, v30 offset:1280
    ds_read_b32 v31, v31 offset:1280
    s_cmp_ge_u32 s3, 4
    s_cbranch_scc1 K1_SW0
    s_waitcnt vmcnt(1)
    s_branch K1_SW1
K1_SW0:
    s_waitcnt vmcnt(0)
K1_SW1:
    v_mul_u32_u24 v21, 1342, v8
    v_lshrrev_b32 v21, 24, v21
    v_sub_u32 v21, v21, v52
    v_and_b32 v21, 3, v21
    v_lshl_or_b32 v4, v4, 2, v21
    v_lshl_or_b32 v21, v4, 18, v8
    v_mul_u32_u24 v23, 1342, v9
    v_lshrrev_b32 v23, 24, v23
    v_sub_u32 v23, v23, v53
    v_and_b32 v23, 3, v23
    v_lshl_or_b32 v5, v5, 2, v23
    v_lshl_or_b32 v23, v5, 18, v9
    v_mul_u32_u24 v25, 1342, v10
    v_lshrrev_b32 v25, 24, v25
    v_sub_u32 v25, v25, v54
    v_and_b32 v25, 3, v25
    v_lshl_or_b32 v6, v6, 2, v25
    v_lshl_or_b32 v25, v6, 18, v10
    v_mul_u32_u24 v27, 1342, v11
    v_lshrrev_b32 v27, 24, v27
    v_sub_u32 v27, v27, v55
    v_and_b32 v27, 3, v27
    v_lshl_or_b32 v7, v7, 2, v27
    v_lshl_or_b32 v27, v7, 18, v11
    s_cmp_lg_u32 s3, 12
    s_cbranch_scc1 K1_NOOFF
    s_mov_b64 exec, -1
    v_lshl_or_b32 v40, v36, 16, v40
    v_lshl_or_b32 v41, v37, 16, v41
    v_lshl_or_b32 v42, v38, 16, v42
    v_lshl_or_b32 v43, v39, 16, v43
    v_lshlrev_b32 v2, 8, v2
    s_lshl_b32 s33, s2, 4
    s_add_u32 s33, s33, 6422528
    buffer_store_dwordx4 v[40:43], v2, s[24:27], s33 offen
    s_mov_b64 exec, s[34:35]
K1_NOOFF:
    s_waitcnt lgkmcnt(3)
    v_lshl_add_u32 v28, v32, 3, v28
    ds_write_b64 v28, v[20:21] offset:2304
    s_waitcnt lgkmcnt(3)
    v_lshl_add_u32 v29, v33, 3, v29
    ds_write_b64 v29, v[22:23] offset:2304
    s_waitcnt lgkmcnt(3)
    v_lshl_add_u32 v30, v34, 3, v30
    ds_write_b64 v30, v[24:25] offset:2304
    s_waitcnt lgkmcnt(3)
    v_lshl_add_u32 v31, v35, 3, v31
    ds_write_b64 v31, v[26:27] offset:2304
    s_mul_i32 s33, s2, 25600
    s_add_u32 s38, s33, 12800
    s_waitcnt lgkmcnt(0)
    s_barrier
    ds_read_b128 v[4:7], v14 offset:2304
    ds_read_b128 v[8:11], v14 offset:15104
    s_waitcnt lgkmcnt(1)
    buffer_store_dwordx4 v[4:7], v14, s[24:27], s33 offen sc1
    s_waitcnt lgkmcnt(0)
    buffer_store_dwordx4 v[8:11], v14, s[24:27], s38 offen sc1
    s_endpgm
K1_FRAG:
    s_cmp_ge_u32 s2, 144
    s_cbranch_scc1 K1_END
    s_load_dwordx4 s[4:7], s[0:1], 40
    s_load_dwordx2 s[8:9], s[0:1], 56
    s_lshr_b32 s28, s2, 2
    s_and_b32 s3, s2, 3
    s_lshl_b32 s3, s3, 6
    v_and_b32 v1, 63, v0
    v_add_u32 v1, s3, v1
    v_lshlrev_b32 v10, 2, v1
    s_lshl_b32 s33, s28, 10
    s_add_u32 s33, s33, 7536640
    s_mov_b32 s34, 0xbfb8aa3b
    s_waitcnt lgkmcnt(0)
    s_mov_b32 s12, s4
    s_and_b32 s13, s5, 0xffff
    s_mov_b32 s14, 18560
    s_mov_b32 s15, 0x20000
    s_mov_b32 s16, s6
    s_and_b32 s17, s7, 0xffff
    s_mov_b32 s18, 128
    s_mov_b32 s19, 0x20000
    s_mov_b32 s20, s8
    s_and_b32 s21, s9, 0xffff
    s_mov_b32 s22, 16384
    s_mov_b32 s23, 0x20000
    s_mov_b32 s24, s38
    s_and_b32 s25, s39, 0xffff
    s_mov_b32 s26, 25427968
    s_mov_b32 s27, 0x20000
    s_cmp_eq_u32 s28, 19
    s_cbranch_scc1 K1_WX
    s_cmp_eq_u32 s28, 18
    s_cbranch_scc1 K1_W3
    v_lshrrev_b32 v2, 2, v1
    v_and_b32 v3, 4, v2
    v_lshlrev_b32 v3, 3, v3
    v_bfe_u32 v4, v2, 3, 2
    v_lshl_add_u32 v3, v4, 2, v3
    v_and_b32 v4, 3, v2
    v_add_u32 v3, v3, v4
    v_lshrrev_b32 v5, 7, v1
    v_and_b32 v6, 3, v1
    s_mov_b32 s35, 32
    s_cmp_ge_u32 s28, 18
    s_cbranch_scc1 K1_FH
    s_cmp_ge_u32 s28, 16
    s_cbranch_scc1 K1_F4
    s_mov_b32 s36, s28
    s_branch K1_FC
K1_FH:
    s_sub_u32 s36, s28, 20
    s_mov_b32 s12, s20
    s_mov_b32 s13, s21
    s_mov_b32 s14, s22
    s_cmp_ge_u32 s36, 8
    s_cselect_b32 s34, 1.0, s34
K1_FC:
    s_lshr_b32 s37, s36, 3
    s_lshl_b32 s37, s37, 6
    s_and_b32 s38, s36, 3
    s_lshl_b32 s38, s38, 3
    s_add_u32 s37, s37, s38
    s_bfe_u32 s38, s36, 0x10002
    s_branch K1_FD
K1_F4:
    s_mov_b32 s35, 8
    s_movk_i32 s37, 129
    s_sub_u32 s38, s28, 16
K1_FD:
    s_lshl_b32 s38, s38, 4
    v_mul_u32_u24 v5, s35, v5
    v_lshl_add_u32 v5, v6, 1, v5
    v_add_u32 v5, s37, v5
    v_add_u32 v3, s38, v3
    v_lshlrev_b32 v3, 1, v3
    v_lshl_add_u32 v3, v5, 7, v3
    buffer_load_ushort v7, v3, s[12:15], 0 offen
    buffer_load_ushort v8, v3, s[12:15], 0 offen offset:128
    s_waitcnt vmcnt(0)
    v_lshlrev_b32 v7, 16, v7
    v_lshlrev_b32 v8, 16, v8
    v_mul_f32 v7, s34, v7
    v_mul_f32 v8, s34, v8
    v_cvt_pk_bf16_f32 v7, v7, v8
    buffer_store_dword v7, v10, s[24:27], s33 offen
    s_endpgm
K1_W3:
    v_and_b32 v2, 31, v1
    v_and_b32 v3, 4, v2
    v_lshlrev_b32 v3, 3, v3
    v_bfe_u32 v4, v2, 3, 2
    v_lshl_add_u32 v3, v4, 2, v3
    v_and_b32 v4, 3, v2
    v_add_u32 v3, v3, v4
    v_bfe_u32 v5, v1, 6, 1
    v_lshl_add_u32 v3, v5, 4, v3
    v_lshlrev_b32 v3, 1, v3
    s_movk_i32 s35, 16384
    buffer_load_ushort v7, v3, s[12:15], s35 offen
    v_and_b32 v6, 32, v1
    v_cmp_eq_u32 vcc, 0, v6
    s_waitcnt vmcnt(0)
    v_lshlrev_b32 v7, 16, v7
    v_mul_f32 v7, s34, v7
    v_cvt_pk_bf16_f32 v8, v7, v7
    v_lshlrev_b32 v8, 16, v8
    v_sub_f32 v9, v7, v8
    v_cvt_pk_bf16_f32 v7, v8, v9
    v_cndmask_b32 v7, 0, v7, vcc
    buffer_store_dword v7, v10, s[24:27], s33 offen
    s_endpgm
K1_WX:
    v_lshlrev_b32 v3, 1, v1
    buffer_load_ushort v7, v3, s[16:19], 0 offen
    s_waitcnt vmcnt(0)
    v_lshlrev_b32 v7, 16, v7
    v_mul_f32 v7, 0xbf317218, v7
    buffer_store_dword v7, v10, s[24:27], s33 offen
K1_END:
    s_endpgm
.globl egnn_main_kernel
.p2align 8
.type egnn_main_kernel,@function
egnn_main_kernel:
    s_cmp_ge_u32 s2, 256
    s_cbranch_scc1 K2_END
    s_load_dwordx2 s[28:29], s[0:1], 0
    s_load_dwordx2 s[30:31], s[0:1], 16
    s_load_dwordx2 s[32:33], s[0:1], 64
    s_load_dwordx2 s[34:35], s[0:1], 80
    v_mov_b32 v250, v0
    v_lshrrev_b32 v220, 6, v0
    s_and_b32 s3, s2, 7
    s_lshl_b32 s3, s3, 5
    v_readfirstlane_b32 s5, v220
    s_lshr_b32 s95, s2, 3
    s_add_u32 s3, s3, s95
    s_mul_i32 s4, s3, 196
    s_sub_u32 s96, 50000, s4
    s_min_u32 s96, s96, 196
    s_mov_b32 s7, 0
    s_mov_b32 s92, 48
    s_sub_u32 s100, 11, s5
    s_cmp_lt_u32 s5, 4
    s_cselect_b32 s100, s5, s100
    s_lshl_b32 s94, s100, 12
    s_add_u32 s94, s94, 34816
    s_waitcnt lgkmcnt(0)
    s_add_u32 s88, s34, 6422528
    s_addc_u32 s89, s35, 0
    s_and_b32 s89, s89, 0xffff
    s_mov_b32 s90, 262144
    s_mov_b32 s91, 0x20000
    s_mov_b32 s8, s28
    s_and_b32 s9, s29, 0xffff
    s_or_b32 s9, s9, 8388608
    s_mov_b32 s10, 50000
    s_mov_b32 s11, 0x20000
    s_mov_b32 s12, s30
    s_and_b32 s13, s31, 0xffff
    s_or_b32 s13, s13, 2097152
    s_mov_b32 s14, 800000
    s_mov_b32 s15, 0x20000
    s_add_u32 s16, s34, 6684672
    s_addc_u32 s17, s35, 0
    s_and_b32 s17, s17, 0xffff
    s_or_b32 s17, s17, 524288
    s_mov_b32 s18, 50000
    s_mov_b32 s19, 0x20000
    s_mov_b32 s20, s34
    s_and_b32 s21, s35, 0xffff
    s_mov_b32 s22, 25427968
    s_mov_b32 s23, 0x20000
    s_mov_b32 s24, s32
    s_and_b32 s25, s33, 0xffff
    s_mov_b32 s26, 6700000
    s_mov_b32 s27, 0x20000
K2_TOP:
    v_bfe_u32 v220, v250, 4, 2
    s_mul_i32 s95, s5, 36
    s_sub_u32 s95, s95, 36
    v_mad_u32_u24 v220, v220, 9, s95
    v_lshlrev_b32 v221, 4, v220
    s_and_b32 s95, s3, 3
    s_mul_i32 s95, s95, 1020
    s_lshl_b32 s99, s3, 10
    s_sub_u32 s95, s99, s95
    s_cmp_eq_u32 s5, 0
    s_cbranch_scc1 K2_NOOF
    buffer_load_dword v172, v221, s[88:91], s95 offen offset:0
    buffer_load_dword v173, v221, s[88:91], s95 offen offset:16
    buffer_load_dword v174, v221, s[88:91], s95 offen offset:32
    buffer_load_dword v175, v221, s[88:91], s95 offen offset:48
    buffer_load_dword v176, v221, s[88:91], s95 offen offset:64
    buffer_load_dword v177, v221, s[88:91], s95 offen offset:80
    buffer_load_dword v178, v221, s[88:91], s95 offen offset:96
    buffer_load_dword v179, v221, s[88:91], s95 offen offset:112
    buffer_load_dword v180, v221, s[88:91], s95 offen offset:128
K2_NOOF:
    v_and_b32 v222, 63, v250
    v_lshlrev_b32 v203, 4, v222
    v_lshrrev_b32 v239, 3, v222
    v_lshrrev_b32 v223, 4, v222
    v_xor_b32 v223, v223, v222
    v_and_b32 v223, 7, v223
    v_lshlrev_b32 v211, 4, v223
    v_xor_b32 v213, 64, v211
    v_mov_b32 v215, v211
    v_mov_b32 v217, v213
    s_lshl_b32 s95, s5, 5
    s_add_u32 s95, s95, s4
    v_add_u32 v210, s95, v239
    v_add_u32 v212, 8, v210
    v_add_u32 v214, 16, v210
    v_add_u32 v216, 24, v210
    s_add_u32 s99, s4, s96
    v_cmp_gt_u32 vcc, s99, v210
    s_nop 1
    v_cndmask_b32 v210, -1, v210, vcc
    v_cmp_gt_u32 vcc, s99, v212
    s_nop 1
    v_cndmask_b32 v212, -1, v212, vcc
    v_cmp_gt_u32 vcc, s99, v214
    s_nop 1
    v_cndmask_b32 v214, -1, v214, vcc
    v_cmp_gt_u32 vcc, s99, v216
    s_nop 1
    v_cndmask_b32 v216, -1, v216, vcc
    s_lshl_b32 s101, s5, 12
    s_add_u32 s101, s101, 100352
    s_barrier
    s_mul_i32 s95, s5, 3072
    s_add_u32 m0, s95, 138240
    s_add_u32 s95, s95, 7536640
    buffer_load_dwordx4 v203, s[20:23], s95 offen offset:0 lds
    buffer_load_dwordx4 v203, s[20:23], s95 offen offset:1024 lds
    buffer_load_dwordx4 v203, s[20:23], s95 offen offset:2048 lds
    v_mov_b32 v228, 0
    v_mov_b32 v229, 0
    v_mov_b32 v230, 0
    v_mov_b32 v231, 0
    s_lshl_b32 s95, s5, 10
    s_cmp_ge_u32 s5, 4
    s_cselect_b32 s99, 30720, 0
    s_add_u32 s95, s95, s99
    v_add_u32 v223, s95, v203
    ds_write_b128 v223, v[228:231]
    v_and_b32 v223, 2047, v223
    ds_write_b128 v223, v[228:231] offset:38912
    v_lshlrev_b32 v239, 2, v239
    v_mov_b32 v41, 0
    v_mov_b32 v43, 0
    v_mov_b32 v209, 0
    v_lshrrev_b32 v219, 5, v222
    v_lshlrev_b32 v219, 4, v219
    v_and_b32 v223, 31, v222
    v_bfe_u32 v251, v222, 1, 3
    v_lshlrev_b32 v251, 4, v251
    v_lshlrev_b32 v252, 2, v219
    v_xor_b32 v251, v251, v252
    v_lshl_add_u32 v251, v223, 7, v251
    v_add_u32 v251, s94, v251
    v_xor_b32 v252, 16, v251
    v_xor_b32 v253, 32, v251
    v_xor_b32 v254, 48, v251
    v_and_b32 v222, 15, v250
    v_cmp_gt_u32 vcc, 243, v220
    v_mul_u32_u24 v220, 3200, v220
    v_add3_u32 v220, v220, v222, s7
    v_add_u32 v221, 16, v222
    v_add_u32 v223, 32, v222
    v_cmp_gt_u32_e64 s[32:33], s92, v221
    v_cmp_gt_u32_e64 s[34:35], s92, v222
    s_nop 0
    v_cndmask_b32_e64 v221, 2.0, v221, s[32:33]
    v_cndmask_b32_e64 v223, 2.0, v223, s[32:33]
    v_cndmask_b32_e64 v222, 2.0, v222, s[34:35]
    s_cmp_eq_u32 s5, 0
    s_waitcnt vmcnt(3)
    s_cbranch_scc0 K2_MK
    s_branch K2_NOREC
K2_MK:
    v_cndmask_b32 v179, 0, v179, vcc
    v_cndmask_b32 v180, 0, v180, vcc
    v_and_b32 v98, 0xffff, v172
    v_lshrrev_b32 v172, 16, v172
    v_subrev_u32 v172, s7, v172
    v_cmp_gt_i32_e64 s[32:33], v172, v222
    v_add_lshl_u32 v98, v98, v220, 3
    s_mov_b32 s95, 0
    v_cndmask_b32_e64 v98, 2.0, v98, s[32:33]
    buffer_load_dwordx2 v[44:45], v98, s[20:23], s95 offen
    v_and_b32 v99, 0xffff, v173
    v_lshrrev_b32 v173, 16, v173
    v_subrev_u32 v173, s7, v173
    v_cmp_gt_i32_e64 s[34:35], v173, v222
    v_add_lshl_u32 v99, v99, v220, 3
    s_mov_b32 s95, 25600
    v_cndmask_b32_e64 v99, 2.0, v99, s[34:35]
    buffer_load_dwordx2 v[46:47], v99, s[20:23], s95 offen
    v_and_b32 v100, 0xffff, v174
    v_lshrrev_b32 v174, 16, v174
    v_subrev_u32 v174, s7, v174
    v_cmp_gt_i32_e64 s[36:37], v174, v222
    v_add_lshl_u32 v100, v100, v220, 3
    s_mov_b32 s95, 51200
    v_cndmask_b32_e64 v100, 2.0, v100, s[36:37]
    buffer_load_dwordx2 v[48:49], v100, s[20:23], s95 offen
    v_and_b32 v101, 0xffff, v175
    v_lshrrev_b32 v175, 16, v175
    v_subrev_u32 v175, s7, v175
    v_cmp_gt_i32_e64 s[38:39], v175, v222
    v_add_lshl_u32 v101, v101, v220, 3
    s_mov_b32 s95, 76800
    v_cndmask_b32_e64 v101, 2.0, v101, s[38:39]
    buffer_load_dwordx2 v[50:51], v101, s[20:23], s95 offen
    v_and_b32 v102, 0xffff, v176
    v_lshrrev_b32 v176, 16, v176
    v_subrev_u32 v176, s7, v176
    v_cmp_gt_i32_e64 s[40:41], v176, v222
    v_add_lshl_u32 v102, v102, v220, 3
    s_mov_b32 s95, 102400
    v_cndmask_b32_e64 v102, 2.0, v102, s[40:41]
    buffer_load_dwordx2 v[52:53], v102, s[20:23], s95 offen
    v_and_b32 v103, 0xffff, v177
    v_lshrrev_b32 v177, 16, v177
    v_subrev_u32 v177, s7, v177
    v_cmp_gt_i32_e64 s[42:43], v177, v222
    v_add_lshl_u32 v103, v103, v220, 3
    s_mov_b32 s95, 128000
    v_cndmask_b32_e64 v103, 2.0, v103, s[42:43]
    buffer_load_dwordx2 v[54:55], v103, s[20:23], s95 offen
    v_and_b32 v104, 0xffff, v178
    v_lshrrev_b32 v178, 16, v178
    v_subrev_u32 v178, s7, v178
    v_cmp_gt_i32_e64 s[44:45], v178, v222
    v_add_lshl_u32 v104, v104, v220, 3
    s_mov_b32 s95, 153600
    v_cndmask_b32_e64 v104, 2.0, v104, s[44:45]
    buffer_load_dwordx2 v[56:57], v104, s[20:23], s95 offen
    v_and_b32 v105, 0xffff, v179
    v_lshrrev_b32 v179, 16, v179
    v_subrev_u32 v179, s7, v179
    v_cmp_gt_i32_e64 s[46:47], v179, v222
    v_add_lshl_u32 v105, v105, v220, 3
    s_mov_b32 s95, 179200
    v_cndmask_b32_e64 v105, 2.0, v105, s[46:47]
    buffer_load_dwordx2 v[58:59], v105, s[20:23], s95 offen
    v_and_b32 v106, 0xffff, v180
    v_lshrrev_b32 v180, 16, v180
    v_subrev_u32 v180, s7, v180
    v_cmp_gt_i32_e64 s[48:49], v180, v222
    v_add_lshl_u32 v106, v106, v220, 3
    s_mov_b32 s95, 204800
    v_cndmask_b32_e64 v106, 2.0, v106, s[48:49]
    buffer_load_dwordx2 v[60:61], v106, s[20:23], s95 offen
    v_cmp_gt_i32_e64 s[50:51], v172, v221
    v_cmp_gt_i32_e64 s[68:69], v172, v223
    v_cmp_gt_i32_e64 s[52:53], v173, v221
    v_cmp_gt_i32_e64 s[70:71], v173, v223
    v_cmp_gt_i32_e64 s[54:55], v174, v221
    v_cmp_gt_i32_e64 s[72:73], v174, v223
    v_cmp_gt_i32_e64 s[56:57], v175, v221
    v_cmp_gt_i32_e64 s[74:75], v175, v223
    v_cmp_gt_i32_e64 s[58:59], v176, v221
    v_cmp_gt_i32_e64 s[76:77], v176, v223
    v_cmp_gt_i32_e64 s[60:61], v177, v221
    v_cmp_gt_i32_e64 s[78:79], v177, v223
    v_cmp_gt_i32_e64 s[62:63], v178, v221
    v_cmp_gt_i32_e64 s[80:81], v178, v223
    v_cmp_gt_i32_e64 s[64:65], v179, v221
    v_cmp_gt_i32_e64 s[82:83], v179, v223
    v_cmp_gt_i32_e64 s[66:67], v180, v221
    v_cmp_gt_i32_e64 s[84:85], v180, v223
    s_mov_b32 s95, 0
    s_mov_b64 exec, s[50:51]
    s_cbranch_execz K2_G1
    buffer_load_dwordx2 v[62:63], v98, s[20:23], s95 offen offset:128
K2_G1:
    s_mov_b32 s95, 25600
    s_mov_b64 exec, s[52:53]
    s_cbranch_execz K2_G2
    buffer_load_dwordx2 v[64:65], v99, s[20:23], s95 offen offset:128
K2_G2:
    s_mov_b32 s95, 51200
    s_mov_b64 exec, s[54:55]
    s_cbranch_execz K2_G3
    buffer_load_dwordx2 v[66:67], v100, s[20:23], s95 offen offset:128
K2_G3:
    s_mov_b32 s95, 76800
    s_mov_b64 exec, s[56:57]
    s_cbranch_execz K2_G4
    buffer_load_dwordx2 v[68:69], v101, s[20:23], s95 offen offset:128
K2_G4:
    s_mov_b32 s95, 102400
    s_mov_b64 exec, s[58:59]
    s_cbranch_execz K2_G5
    buffer_load_dwordx2 v[70:71], v102, s[20:23], s95 offen offset:128
K2_G5:
    s_mov_b32 s95, 128000
    s_mov_b64 exec, s[60:61]
    s_cbranch_execz K2_G6
    buffer_load_dwordx2 v[72:73], v103, s[20:23], s95 offen offset:128
K2_G6:
    s_mov_b32 s95, 153600
    s_mov_b64 exec, s[62:63]
    s_cbranch_execz K2_G7
    buffer_load_dwordx2 v[74:75], v104, s[20:23], s95 offen offset:128
K2_G7:
    s_mov_b32 s95, 179200
    s_mov_b64 exec, s[64:65]
    s_cbranch_execz K2_G8
    buffer_load_dwordx2 v[76:77], v105, s[20:23], s95 offen offset:128
K2_G8:
    s_mov_b32 s95, 204800
    s_mov_b64 exec, s[66:67]
    s_cbranch_execz K2_G9
    buffer_load_dwordx2 v[78:79], v106, s[20:23], s95 offen offset:128
K2_G9:
    s_or_b64 vcc, s[68:69], s[70:71]
    s_or_b64 vcc, vcc, s[72:73]
    s_or_b64 vcc, vcc, s[74:75]
    s_or_b64 vcc, vcc, s[76:77]
    s_or_b64 vcc, vcc, s[78:79]
    s_or_b64 vcc, vcc, s[80:81]
    s_or_b64 vcc, vcc, s[82:83]
    s_or_b64 vcc, vcc, s[84:85]
    s_cselect_b32 s97, 1, 0
    s_cbranch_scc0 K2_NP2A
    s_mov_b32 s95, 0
    s_mov_b64 exec, s[68:69]
    s_cbranch_execz K2_G10
    buffer_load_dwordx2 v[80:81], v98, s[20:23], s95 offen offset:256
K2_G10:
    s_mov_b32 s95, 25600
    s_mov_b64 exec, s[70:71]
    s_cbranch_execz K2_G11
    buffer_load_dwordx2 v[82:83], v99, s[20:23], s95 offen offset:256
K2_G11:
    s_mov_b32 s95, 51200
    s_mov_b64 exec, s[72:73]
    s_cbranch_execz K2_G12
    buffer_load_dwordx2 v[84:85], v100, s[20:23], s95 offen offset:256
K2_G12:
    s_mov_b32 s95, 76800
    s_mov_b64 exec, s[74:75]
    s_cbranch_execz K2_G13
    buffer_load_dwordx2 v[86:87], v101, s[20:23], s95 offen offset:256
K2_G13:
    s_mov_b32 s95, 102400
    s_mov_b64 exec, s[76:77]
    s_cbranch_execz K2_G14
    buffer_load_dwordx2 v[88:89], v102, s[20:23], s95 offen offset:256
K2_G14:
    s_mov_b32 s95, 128000
    s_mov_b64 exec, s[78:79]
    s_cbranch_execz K2_G15
    buffer_load_dwordx2 v[90:91], v103, s[20:23], s95 offen offset:256
K2_G15:
    s_mov_b32 s95, 153600
    s_mov_b64 exec, s[80:81]
    s_cbranch_execz K2_G16
    buffer_load_dwordx2 v[92:93], v104, s[20:23], s95 offen offset:256
K2_G16:
    s_mov_b32 s95, 179200
    s_mov_b64 exec, s[82:83]
    s_cbranch_execz K2_G17
    buffer_load_dwordx2 v[94:95], v105, s[20:23], s95 offen offset:256
K2_G17:
    s_mov_b32 s95, 204800
    s_mov_b64 exec, s[84:85]
    s_cbranch_execz K2_G18
    buffer_load_dwordx2 v[96:97], v106, s[20:23], s95 offen offset:256
K2_G18:
K2_NP2A:
    s_mov_b64 exec, -1
    v_max3_i32 v221, v172, v173, v174
    v_max3_i32 v221, v221, v175, v176
    v_max3_i32 v221, v221, v177, v178
    v_max3_i32 v221, v221, v179, v180
    v_mov_b32 v223, 1
    v_cmp_lt_i32_e64 s[86:87], s92, v221
K2_NOREC:
    s_waitcnt lgkmcnt(0)
    s_barrier
    s_add_u32 s95, s101, 0
    s_cmp_lt_u32 s95, 125952
    s_cselect_b32 m0, s95, 43008
    s_nop 0
    buffer_load_dwordx4 v[210:211], s[8:11], 0 idxen offen lds
    s_add_u32 s95, s101, 1024
    s_cmp_lt_u32 s95, 125952
    s_cselect_b32 m0, s95, 43008
    s_nop 0
    buffer_load_dwordx4 v[212:213], s[8:11], 0 idxen offen lds
    s_add_u32 s95, s101, 2048
    s_cmp_lt_u32 s95, 125952
    s_cselect_b32 m0, s95, 43008
    s_nop 0
    buffer_load_dwordx4 v[214:215], s[8:11], 0 idxen offen lds
    s_add_u32 s95, s101, 3072
    s_cmp_lt_u32 s95, 125952
    s_cselect_b32 m0, s95, 43008
    s_nop 0
    buffer_load_dwordx4 v[216:217], s[8:11], 0 idxen offen lds
    s_cmp_lg_u32 s5, 0
    s_cbranch_scc1 K2_NOPW
    s_lshr_b32 s95, s2, 3
    s_mul_i32 s99, s95, 0
    v_add_u32 v224, s99, v203
    s_mul_i32 s99, s95, 0
    v_add_u32 v225, s99, v250
    v_add_u32 v224, 0, v250
    v_cmp_gt_u32 vcc, s96, v224
    s_nop 1
    v_cndmask_b32_e64 v104, -0.5, 0.5, vcc
    v_add_u32 v224, 64, v250
    v_cmp_gt_u32 vcc, s96, v224
    s_nop 1
    v_cndmask_b32_e64 v105, -0.5, 0.5, vcc
    v_add_u32 v224, 128, v250
    v_cmp_gt_u32 vcc, s96, v224
    s_nop 1
    v_cndmask_b32_e64 v106, -0.5, 0.5, vcc
    v_add_u32 v224, 192, v250
    v_cmp_gt_u32 vcc, s96, v224
    s_nop 1
    v_cndmask_b32_e64 v107, -0.5, 0.5, vcc
    s_branch K2_B1
K2_NOPW:
    s_mov_b64 exec, s[86:87]
    ds_write_b32 v228, v223 offset:96
    s_mov_b64 exec, -1
    s_waitcnt vmcnt(4)
    s_mov_b64 exec, s[32:33]
    v_lshrrev_b32 v172, 16, v45
    ds_add_rtn_u32 v172, v172, v223 offset:34816
    s_mov_b64 exec, s[34:35]
    v_lshrrev_b32 v173, 16, v47
    ds_add_rtn_u32 v173, v173, v223 offset:34816
    s_mov_b64 exec, s[36:37]
    v_lshrrev_b32 v174, 16, v49
    ds_add_rtn_u32 v174, v174, v223 offset:34816
    s_mov_b64 exec, s[38:39]
    v_lshrrev_b32 v175, 16, v51
    ds_add_rtn_u32 v175, v175, v223 offset:34816
    s_mov_b64 exec, s[40:41]
    v_lshrrev_b32 v176, 16, v53
    ds_add_rtn_u32 v176, v176, v223 offset:34816
    s_mov_b64 exec, s[42:43]
    v_lshrrev_b32 v177, 16, v55
    ds_add_rtn_u32 v177, v177, v223 offset:34816
    s_mov_b64 exec, s[44:45]
    v_lshrrev_b32 v178, 16, v57
    ds_add_rtn_u32 v178, v178, v223 offset:34816
    s_mov_b64 exec, s[46:47]
    v_lshrrev_b32 v179, 16, v59
    ds_add_rtn_u32 v179, v179, v223 offset:34816
    s_mov_b64 exec, s[48:49]
    v_lshrrev_b32 v180, 16, v61
    ds_add_rtn_u32 v180, v180, v223 offset:34816
    s_mov_b64 exec, s[50:51]
    s_cbranch_execz K2_G19
    v_lshrrev_b32 v181, 16, v63
    ds_add_rtn_u32 v181, v181, v223 offset:34816
K2_G19:
    s_mov_b64 exec, s[52:53]
    s_cbranch_execz K2_G20
    v_lshrrev_b32 v182, 16, v65
    ds_add_rtn_u32 v182, v182, v223 offset:34816
K2_G20:
    s_mov_b64 exec, s[54:55]
    s_cbranch_execz K2_G21
    v_lshrrev_b32 v183, 16, v67
    ds_add_rtn_u32 v183, v183, v223 offset:34816
K2_G21:
    s_mov_b64 exec, s[56:57]
    s_cbranch_execz K2_G22
    v_lshrrev_b32 v184, 16, v69
    ds_add_rtn_u32 v184, v184, v223 offset:34816
K2_G22:
    s_mov_b64 exec, s[58:59]
    s_cbranch_execz K2_G23
    v_lshrrev_b32 v185, 16, v71
    ds_add_rtn_u32 v185, v185, v223 offset:34816
K2_G23:
    s_mov_b64 exec, s[60:61]
    s_cbranch_execz K2_G24
    v_lshrrev_b32 v186, 16, v73
    ds_add_rtn_u32 v186, v186, v223 offset:34816
K2_G24:
    s_mov_b64 exec, s[62:63]
    s_cbranch_execz K2_G25
    v_lshrrev_b32 v187, 16, v75
    ds_add_rtn_u32 v187, v187, v223 offset:34816
K2_G25:
    s_mov_b64 exec, s[64:65]
    s_cbranch_execz K2_G26
    v_lshrrev_b32 v188, 16, v77
    ds_add_rtn_u32 v188, v188, v223 offset:34816
K2_G26:
    s_mov_b64 exec, s[66:67]
    s_cbranch_execz K2_G27
    v_lshrrev_b32 v189, 16, v79
    ds_add_rtn_u32 v189, v189, v223 offset:34816
K2_G27:
    s_cmp_eq_u32 s97, 0
    s_cbranch_scc1 K2_NP2B
    s_mov_b64 exec, s[68:69]
    s_cbranch_execz K2_G28
    v_lshrrev_b32 v190, 16, v81
    ds_add_rtn_u32 v190, v190, v223 offset:34816
K2_G28:
    s_mov_b64 exec, s[70:71]
    s_cbranch_execz K2_G29
    v_lshrrev_b32 v191, 16, v83
    ds_add_rtn_u32 v191, v191, v223 offset:34816
K2_G29:
    s_mov_b64 exec, s[72:73]
    s_cbranch_execz K2_G30
    v_lshrrev_b32 v192, 16, v85
    ds_add_rtn_u32 v192, v192, v223 offset:34816
K2_G30:
    s_mov_b64 exec, s[74:75]
    s_cbranch_execz K2_G31
    v_lshrrev_b32 v193, 16, v87
    ds_add_rtn_u32 v193, v193, v223 offset:34816
K2_G31:
    s_mov_b64 exec, s[76:77]
    s_cbranch_execz K2_G32
    v_lshrrev_b32 v194, 16, v89
    ds_add_rtn_u32 v194, v194, v223 offset:34816
K2_G32:
    s_mov_b64 exec, s[78:79]
    s_cbranch_execz K2_G33
    v_lshrrev_b32 v195, 16, v91
    ds_add_rtn_u32 v195, v195, v223 offset:34816
K2_G33:
    s_mov_b64 exec, s[80:81]
    s_cbranch_execz K2_G34
    v_lshrrev_b32 v196, 16, v93
    ds_add_rtn_u32 v196, v196, v223 offset:34816
K2_G34:
    s_mov_b64 exec, s[82:83]
    s_cbranch_execz K2_G35
    v_lshrrev_b32 v197, 16, v95
    ds_add_rtn_u32 v197, v197, v223 offset:34816
K2_G35:
    s_mov_b64 exec, s[84:85]
    s_cbranch_execz K2_G36
    v_lshrrev_b32 v198, 16, v97
    ds_add_rtn_u32 v198, v198, v223 offset:34816
K2_G36:
K2_NP2B:
    s_mov_b64 exec, -1
K2_B1:
    s_cmp_lg_u32 s5, 0
    s_waitcnt lgkmcnt(0)
    s_barrier
    s_cbranch_scc1 K2_W2
    ds_read_b128 v[44:47], v203 offset:34816
    ds_read_b128 v[48:51], v203 offset:35840
    ds_read_b128 v[52:55], v203 offset:36864
    ds_read_b128 v[56:59], v203 offset:37888
    s_waitcnt lgkmcnt(3)
    v_add_u32 v76, v44, v45
    v_add3_u32 v76, v76, v46, v47
    s_waitcnt lgkmcnt(2)
    v_add_u32 v77, v48, v49
    v_add3_u32 v77, v77, v50, v51
    s_waitcnt lgkmcnt(1)
    v_add_u32 v78, v52, v53
    v_add3_u32 v78, v78, v54, v55
    s_waitcnt lgkmcnt(0)
    v_add_u32 v79, v56, v57
    v_add3_u32 v79, v79, v58, v59
    v_add_u32 v82, v76, v77
    v_add_u32 v83, v82, v78
    v_add_u32 v220, v83, v79
    v_mov_b32 v221, v220
    s_nop 1
    v_add_u32_dpp v221, v221, v221 row_shr:1 row_mask:0xf bank_mask:0xf
    s_nop 1
    v_add_u32_dpp v221, v221, v221 row_shr:2 row_mask:0xf bank_mask:0xf
    s_nop 1
    v_add_u32_dpp v221, v221, v221 row_shr:4 row_mask:0xf bank_mask:0xf
    s_nop 1
    v_add_u32_dpp v221, v221, v221 row_shr:8 row_mask:0xf bank_mask:0xf
    s_nop 1
    v_add_u32_dpp v221, v221, v221 row_bcast:15 row_mask:0xa bank_mask:0xf
    s_nop 1
    v_add_u32_dpp v221, v221, v221 row_bcast:31 row_mask:0xc bank_mask:0xf
    v_sub_u32 v80, v221, v220
    v_add_u32 v81, v80, v76
    v_add_u32 v82, v80, v82
    v_add_u32 v83, v80, v83
    s_movk_i32 s95, 2560
    v_lshl_add_u32 v60, v80, 3, s95
    v_lshl_add_u32 v61, v44, 3, v60
    v_lshl_add_u32 v62, v45, 3, v61
    v_lshl_add_u32 v63, v46, 3, v62
    ds_write_b128 v203, v[60:63] offset:34816
    v_lshl_add_u32 v64, v81, 3, s95
    v_lshl_add_u32 v65, v48, 3, v64
    v_lshl_add_u32 v66, v49, 3, v65
    v_lshl_add_u32 v67, v50, 3, v66
    ds_write_b128 v203, v[64:67] offset:35840
    v_lshl_add_u32 v68, v82, 3, s95
    v_lshl_add_u32 v69, v52, 3, v68
    v_lshl_add_u32 v70, v53, 3, v69
    v_lshl_add_u32 v71, v54, 3, v70
    ds_write_b128 v203, v[68:71] offset:36864
    v_lshl_add_u32 v72, v83, 3, s95
    v_lshl_add_u32 v73, v56, 3, v72
    v_lshl_add_u32 v74, v57, 3, v73
    v_lshl_add_u32 v75, v58, 3, v74
    ds_write_b128 v203, v[72:75] offset:37888
    s_mov_b32 exec_lo, 0
    s_brev_b32 exec_hi, 1
    ds_write_b32 v228, v221 offset:100
    s_mov_b64 exec, -1
K2_W2:
    s_cmp_ge_u32 s5, 6
    s_cbranch_scc1 K2_NWH
    s_mul_i32 s95, s5, 2048
    s_add_u32 m0, s95, 125952
    s_add_u32 s95, s95, 7561216
    buffer_load_dwordx4 v203, s[20:23], s95 offen offset:0 lds
    buffer_load_dwordx4 v203, s[20:23], s95 offen offset:1024 lds
K2_NWH:
    s_cmp_eq_u32 s5, 0
    s_cbranch_scc1 K2_NFT
    s_mov_b32 s95, 0xc0000
    s_mov_b64 exec, s[32:33]
    v_and_or_b32 v140, v45, s95, v172
    v_lshrrev_b32 v141, 17, v45
    v_cmpx_gt_u32 vcc, 1, v140
    ds_write_b64 v141, v[44:45] offset:38912
    s_mov_b64 exec, s[34:35]
    v_and_or_b32 v142, v47, s95, v173
    v_lshrrev_b32 v143, 17, v47
    v_cmpx_gt_u32 vcc, 1, v142
    ds_write_b64 v143, v[46:47] offset:38912
    s_mov_b64 exec, s[36:37]
    v_and_or_b32 v144, v49, s95, v174
    v_lshrrev_b32 v145, 17, v49
    v_cmpx_gt_u32 vcc, 1, v144
    ds_write_b64 v145, v[48:49] offset:38912
    s_mov_b64 exec, s[38:39]
    v_and_or_b32 v146, v51, s95, v175
    v_lshrrev_b32 v147, 17, v51
    v_cmpx_gt_u32 vcc, 1, v146
    ds_write_b64 v147, v[50:51] offset:38912
    s_mov_b64 exec, s[40:41]
    v_and_or_b32 v148, v53, s95, v176
    v_lshrrev_b32 v149, 17, v53
    v_cmpx_gt_u32 vcc, 1, v148
    ds_write_b64 v149, v[52:53] offset:38912
    s_mov_b64 exec, s[42:43]
    v_and_or_b32 v150, v55, s95, v177
    v_lshrrev_b32 v151, 17, v55
    v_cmpx_gt_u32 vcc, 1, v150
    ds_write_b64 v151, v[54:55] offset:38912
    s_mov_b64 exec, s[44:45]
    v_and_or_b32 v152, v57, s95, v178
    v_lshrrev_b32 v153, 17, v57
    v_cmpx_gt_u32 vcc, 1, v152
    ds_write_b64 v153, v[56:57] offset:38912
    s_mov_b64 exec, s[46:47]
    v_and_or_b32 v154, v59, s95, v179
    v_lshrrev_b32 v155, 17, v59
    v_cmpx_gt_u32 vcc, 1, v154
    ds_write_b64 v155, v[58:59] offset:38912
    s_mov_b64 exec, s[48:49]
    v_and_or_b32 v156, v61, s95, v180
    v_lshrrev_b32 v157, 17, v61
    v_cmpx_gt_u32 vcc, 1, v156
    ds_write_b64 v157, v[60:61] offset:38912
    s_mov_b64 exec, -1
    s_mul_i32 s95, s5, 224
    v_lshrrev_b32 v140, 1, v203
    v_add_u32 v140, s95, v140
K2_NFT:
    s_cmp_eq_u32 s5, 0
    s_waitcnt lgkmcnt(0)
    s_barrier
    ds_read_b64 v[232:233], v228 offset:96
    s_cbranch_scc1 K2_NOS1
    ds_read_b64 v[140:141], v140 offset:38688
    s_mov_b64 exec, s[32:33]
    v_lshrrev_b32 v98, 16, v45
    ds_read_b32 v98, v98 offset:34816
    s_mov_b64 exec, s[34:35]
    v_lshrrev_b32 v99, 16, v47
    ds_read_b32 v99, v99 offset:34816
    s_mov_b64 exec, s[36:37]
    v_lshrrev_b32 v100, 16, v49
    ds_read_b32 v100, v100 offset:34816
    s_mov_b64 exec, s[38:39]
    v_lshrrev_b32 v101, 16, v51
    ds_read_b32 v101, v101 offset:34816
    s_mov_b64 exec, s[40:41]
    v_lshrrev_b32 v102, 16, v53
    ds_read_b32 v102, v102 offset:34816
    s_mov_b64 exec, s[42:43]
    v_lshrrev_b32 v103, 16, v55
    ds_read_b32 v103, v103 offset:34816
    s_mov_b64 exec, s[44:45]
    v_lshrrev_b32 v104, 16, v57
    ds_read_b32 v104, v104 offset:34816
    s_mov_b64 exec, s[46:47]
    v_lshrrev_b32 v105, 16, v59
    ds_read_b32 v105, v105 offset:34816
    s_mov_b64 exec, s[48:49]
    v_lshrrev_b32 v106, 16, v61
    ds_read_b32 v106, v106 offset:34816
    s_mov_b64 exec, -1
    s_waitcnt lgkmcnt(9)
    v_and_b32 v141, 0xffff, v141
    s_mov_b64 exec, 0xfffffff
    buffer_load_dword v202, v140, s[12:15], 0 idxen
    buffer_load_dword v202, v141, s[8:11], 0 idxen
    buffer_load_dword v202, v141, s[16:19], 0 idxen
    s_mov_b64 exec, s[50:51]
    s_cbranch_execz K2_G37
    v_lshrrev_b32 v220, 16, v63
    ds_read_b32 v220, v220 offset:34816
K2_G37:
    s_mov_b64 exec, s[52:53]
    s_cbranch_execz K2_G38
    v_lshrrev_b32 v221, 16, v65
    ds_read_b32 v221, v221 offset:34816
K2_G38:
    s_mov_b64 exec, s[54:55]
    s_cbranch_execz K2_G39
    v_lshrrev_b32 v222, 16, v67
    ds_read_b32 v222, v222 offset:34816
K2_G39:
    s_mov_b64 exec, s[56:57]
    s_cbranch_execz K2_G40
    v_lshrrev_b32 v223, 16, v69
    ds_read_b32 v223, v223 offset:34816
K2_G40:
    s_mov_b64 exec, s[58:59]
    s_cbranch_execz K2_G41
    v_lshrrev_b32 v224, 16, v71
    ds_read_b32 v224, v224 offset:34816
K2_G41:
    s_mov_b64 exec, s[60:61]
    s_cbranch_execz K2_G42
    v_lshrrev_b32 v225, 16, v73
    ds_read_b32 v225, v225 offset:34816
K2_G42:
    s_mov_b64 exec, s[62:63]
    s_cbranch_execz K2_G43
    v_lshrrev_b32 v226, 16, v75
    ds_read_b32 v226, v226 offset:34816
K2_G43:
    s_mov_b64 exec, s[64:65]
    s_cbranch_execz K2_G44
    v_lshrrev_b32 v227, 16, v77
    ds_read_b32 v227, v227 offset:34816
K2_G44:
    s_mov_b64 exec, s[66:67]
    s_cbranch_execz K2_G45
    v_lshrrev_b32 v228, 16, v79
    ds_read_b32 v228, v228 offset:34816
K2_G45:
    s_mov_b64 exec, -1
K2_NOS1:
    s_waitcnt lgkmcnt(0)
    v_readfirstlane_b32 s98, v233
    v_readfirstlane_b32 s93, v232
    s_cmp_le_u32 s98, 3776
    s_cbranch_scc1 K2_FITS
    s_cmp_eq_u32 s92, 15
    s_cbranch_scc1 K2_END0
    s_mov_b32 s92, 15
    s_waitcnt vmcnt(0)
    s_barrier
    s_branch K2_TOP
K2_FITS:
    s_cmp_eq_u32 s5, 0
    s_cbranch_scc1 K2_PLAN
    s_mov_b64 exec, s[32:33]
    v_lshl_add_u32 v98, v172, 3, v98
    ds_write_b64 v98, v[44:45]
    s_mov_b64 exec, s[34:35]
    v_lshl_add_u32 v99, v173, 3, v99
    ds_write_b64 v99, v[46:47]
    s_mov_b64 exec, s[36:37]
    v_lshl_add_u32 v100, v174, 3, v100
    ds_write_b64 v100, v[48:49]
    s_mov_b64 exec, s[38:39]
    v_lshl_add_u32 v101, v175, 3, v101
    ds_write_b64 v101, v[50:51]
    s_mov_b64 exec, s[40:41]
    v_lshl_add_u32 v102, v176, 3, v102
    ds_write_b64 v102, v[52:53]
    s_mov_b64 exec, s[42:43]
    v_lshl_add_u32 v103, v177, 3, v103
    ds_write_b64 v103, v[54:55]
    s_mov_b64 exec, s[44:45]
    v_lshl_add_u32 v104, v178, 3, v104
    ds_write_b64 v104, v[56:57]
    s_mov_b64 exec, s[46:47]
    v_lshl_add_u32 v105, v179, 3, v105
    ds_write_b64 v105, v[58:59]
    s_mov_b64 exec, s[48:49]
    v_lshl_add_u32 v106, v180, 3, v106
    ds_write_b64 v106, v[60:61]
    s_mov_b64 exec, s[50:51]
    s_cbranch_execz K2_G46
    v_lshl_add_u32 v220, v181, 3, v220
    ds_write_b64 v220, v[62:63]
K2_G46:
    s_mov_b64 exec, s[52:53]
    s_cbranch_execz K2_G47
    v_lshl_add_u32 v221, v182, 3, v221
    ds_write_b64 v221, v[64:65]
K2_G47:
    s_mov_b64 exec, s[54:55]
    s_cbranch_execz K2_G48
    v_lshl_add_u32 v222, v183, 3, v222
    ds_write_b64 v222, v[66:67]
K2_G48:
    s_mov_b64 exec, s[56:57]
    s_cbranch_execz K2_G49
    v_lshl_add_u32 v223, v184, 3, v223
    ds_write_b64 v223, v[68:69]
K2_G49:
    s_mov_b64 exec, s[58:59]
    s_cbranch_execz K2_G50
    v_lshl_add_u32 v224, v185, 3, v224
    ds_write_b64 v224, v[70:71]
K2_G50:
    s_mov_b64 exec, s[60:61]
    s_cbranch_execz K2_G51
    v_lshl_add_u32 v225, v186, 3, v225
    ds_write_b64 v225, v[72:73]
K2_G51:
    s_mov_b64 exec, s[62:63]
    s_cbranch_execz K2_G52
    v_lshl_add_u32 v226, v187, 3, v226
    ds_write_b64 v226, v[74:75]
K2_G52:
    s_mov_b64 exec, s[64:65]
    s_cbranch_execz K2_G53
    v_lshl_add_u32 v227, v188, 3, v227
    ds_write_b64 v227, v[76:77]
K2_G53:
    s_mov_b64 exec, s[66:67]
    s_cbranch_execz K2_G54
    v_lshl_add_u32 v228, v189, 3, v228
    ds_write_b64 v228, v[78:79]
K2_G54:
    s_cmp_eq_u32 s97, 0
    s_cbranch_scc1 K2_B3
    s_mov_b64 exec, s[68:69]
    s_cbranch_execz K2_G55
    v_lshrrev_b32 v98, 16, v81
    ds_read_b32 v98, v98 offset:34816
K2_G55:
    s_mov_b64 exec, s[70:71]
    s_cbranch_execz K2_G56
    v_lshrrev_b32 v99, 16, v83
    ds_read_b32 v99, v99 offset:34816
K2_G56:
    s_mov_b64 exec, s[72:73]
    s_cbranch_execz K2_G57
    v_lshrrev_b32 v100, 16, v85
    ds_read_b32 v100, v100 offset:34816
K2_G57:
    s_mov_b64 exec, s[74:75]
    s_cbranch_execz K2_G58
    v_lshrrev_b32 v101, 16, v87
    ds_read_b32 v101, v101 offset:34816
K2_G58:
    s_mov_b64 exec, s[76:77]
    s_cbranch_execz K2_G59
    v_lshrrev_b32 v102, 16, v89
    ds_read_b32 v102, v102 offset:34816
K2_G59:
    s_mov_b64 exec, s[78:79]
    s_cbranch_execz K2_G60
    v_lshrrev_b32 v103, 16, v91
    ds_read_b32 v103, v103 offset:34816
K2_G60:
    s_mov_b64 exec, s[80:81]
    s_cbranch_execz K2_G61
    v_lshrrev_b32 v104, 16, v93
    ds_read_b32 v104, v104 offset:34816
K2_G61:
    s_mov_b64 exec, s[82:83]
    s_cbranch_execz K2_G62
    v_lshrrev_b32 v105, 16, v95
    ds_read_b32 v105, v105 offset:34816
K2_G62:
    s_mov_b64 exec, s[84:85]
    s_cbranch_execz K2_G63
    v_lshrrev_b32 v106, 16, v97
    ds_read_b32 v106, v106 offset:34816
K2_G63:
    s_waitcnt lgkmcnt(0)
    s_mov_b64 exec, s[68:69]
    s_cbranch_execz K2_G64
    v_lshl_add_u32 v98, v190, 3, v98
    ds_write_b64 v98, v[80:81]
K2_G64:
    s_mov_b64 exec, s[70:71]
    s_cbranch_execz K2_G65
    v_lshl_add_u32 v99, v191, 3, v99
    ds_write_b64 v99, v[82:83]
K2_G65:
    s_mov_b64 exec, s[72:73]
    s_cbranch_execz K2_G66
    v_lshl_add_u32 v100, v192, 3, v100
    ds_write_b64 v100, v[84:85]
K2_G66:
    s_mov_b64 exec, s[74:75]
    s_cbranch_execz K2_G67
    v_lshl_add_u32 v101, v193, 3, v101
    ds_write_b64 v101, v[86:87]
K2_G67:
    s_mov_b64 exec, s[76:77]
    s_cbranch_execz K2_G68
    v_lshl_add_u32 v102, v194, 3, v102
    ds_write_b64 v102, v[88:89]
K2_G68:
    s_mov_b64 exec, s[78:79]
    s_cbranch_execz K2_G69
    v_lshl_add_u32 v103, v195, 3, v103
    ds_write_b64 v103, v[90:91]
K2_G69:
    s_mov_b64 exec, s[80:81]
    s_cbranch_execz K2_G70
    v_lshl_add_u32 v104, v196, 3, v104
    ds_write_b64 v104, v[92:93]
K2_G70:
    s_mov_b64 exec, s[82:83]
    s_cbranch_execz K2_G71
    v_lshl_add_u32 v105, v197, 3, v105
    ds_write_b64 v105, v[94:95]
K2_G71:
    s_mov_b64 exec, s[84:85]
    s_cbranch_execz K2_G72
    v_lshl_add_u32 v106, v198, 3, v106
    ds_write_b64 v106, v[96:97]
K2_G72:
    s_branch K2_B3
K2_PLAN:
    s_mul_i32 s99, s98, 3
    s_lshr_b32 s99, s99, 9
    s_max_u32 s99, s99, 1
    v_cvt_f32_u32 v84, v76
    v_add_f32 v84, -0.5, v84
    v_max_f32 v104, v104, v84
    v_cvt_f32_u32 v85, v77
    v_add_f32 v85, -0.5, v85
    v_max_f32 v105, v105, v85
    v_cvt_f32_u32 v86, v78
    v_add_f32 v86, -0.5, v86
    v_max_f32 v106, v106, v86
    v_cvt_f32_u32 v87, v79
    v_add_f32 v87, -0.5, v87
    v_max_f32 v107, v107, v87
K2_DLOOP:
    v_cvt_f32_u32 v220, s99
    v_rcp_f32 v221, v220
    v_add_f32 v88, v104, v220
    v_add_f32 v89, v105, v220
    v_add_f32 v90, v106, v220
    v_add_f32 v91, v107, v220
    v_mul_f32 v88, v88, v221
    v_cvt_u32_f32 v88, v88
    v_mul_f32 v89, v89, v221
    v_cvt_u32_f32 v89, v89
    v_mul_f32 v90, v90, v221
    v_cvt_u32_f32 v90, v90
    v_mul_f32 v91, v91, v221
    v_cvt_u32_f32 v91, v91
    v_add_u32 v222, v88, v89
    v_add3_u32 v222, v222, v90, v91
    s_nop 1
    v_add_u32_dpp v222, v222, v222 row_shr:1 row_mask:0xf bank_mask:0xf
    s_nop 1
    v_add_u32_dpp v222, v222, v222 row_shr:2 row_mask:0xf bank_mask:0xf
    s_nop 1
    v_add_u32_dpp v222, v222, v222 row_shr:4 row_mask:0xf bank_mask:0xf
    s_nop 1
    v_add_u32_dpp v222, v222, v222 row_shr:8 row_mask:0xf bank_mask:0xf
    s_nop 1
    v_add_u32_dpp v222, v222, v222 row_bcast:15 row_mask:0xa bank_mask:0xf
    s_nop 1
    v_add_u32_dpp v222, v222, v222 row_bcast:31 row_mask:0xc bank_mask:0xf
    s_nop 0
    v_readlane_b32 s95, v222, 63
    s_add_u32 s99, s99, 1
    s_cmp_gt_u32 s95, 255
    s_cbranch_scc1 K2_DLOOP
    v_cvt_f32_u32 v92, v88
    v_rcp_f32 v96, v92
    v_add_f32 v92, v92, v84
    v_cmp_eq_u32_e64 s[48:49], 1, v88
    v_lshlrev_b32 v44, 16, v88
    v_cvt_f32_u32 v93, v89
    v_rcp_f32 v97, v93
    v_add_f32 v93, v93, v85
    v_cmp_eq_u32_e64 s[50:51], 1, v89
    v_lshlrev_b32 v45, 16, v89
    v_cvt_f32_u32 v94, v90
    v_rcp_f32 v98, v94
    v_add_f32 v94, v94, v86
    v_cmp_eq_u32_e64 s[52:53], 1, v90
    v_lshlrev_b32 v46, 16, v90
    v_cvt_f32_u32 v95, v91
    v_rcp_f32 v99, v95
    v_add_f32 v95, v95, v87
    v_cmp_eq_u32_e64 s[54:55], 1, v91
    v_lshlrev_b32 v47, 16, v91
    v_cndmask_b32_e64 v44, v44, 1, s[48:49]
    v_cndmask_b32_e64 v45, v45, 1, s[50:51]
    v_cndmask_b32_e64 v46, v46, 1, s[52:53]
    v_cndmask_b32_e64 v47, v47, 1, s[54:55]
    v_mul_f32 v92, v92, v96
    v_cvt_u32_f32 v92, v92
    v_sub_u32 v96, 63, v92
    v_lshlrev_b32 v96, 2, v96
    ds_add_rtn_u32 v100, v96, v44 offset:128
    v_mul_f32 v93, v93, v97
    v_cvt_u32_f32 v93, v93
    v_sub_u32 v97, 63, v93
    v_lshlrev_b32 v97, 2, v97
    ds_add_rtn_u32 v101, v97, v45 offset:128
    v_mul_f32 v94, v94, v98
    v_cvt_u32_f32 v94, v94
    v_sub_u32 v98, 63, v94
    v_lshlrev_b32 v98, 2, v98
    ds_add_rtn_u32 v102, v98, v46 offset:128
    v_mul_f32 v95, v95, v99
    v_cvt_u32_f32 v95, v95
    v_sub_u32 v99, 63, v95
    v_lshlrev_b32 v99, 2, v99
    ds_add_rtn_u32 v103, v99, v47 offset:128
    v_lshrrev_b32 v220, 2, v203
    ds_read_b32 v221, v220 offset:128
    v_add_u32 v222, 0, v250
    v_lshl_or_b32 v172, v222, 24, v60
    v_lshl_or_b32 v172, v92, 18, v172
    v_lshlrev_b32 v173, 3, v88
    v_sub_u32 v222, 1, v92
    v_mad_i32_i24 v76, v222, v88, v76
    v_add_u32 v222, 64, v250
    v_lshl_or_b32 v174, v222, 24, v64
    v_lshl_or_b32 v174, v93, 18, v174
    v_lshlrev_b32 v175, 3, v89
    v_sub_u32 v222, 1, v93
    v_mad_i32_i24 v77, v222, v89, v77
    v_add_u32 v222, 128, v250
    v_lshl_or_b32 v176, v222, 24, v68
    v_lshl_or_b32 v176, v94, 18, v176
    v_lshlrev_b32 v177, 3, v90
    v_sub_u32 v222, 1, v94
    v_mad_i32_i24 v78, v222, v90, v78
    v_add_u32 v222, 192, v250
    v_lshl_or_b32 v178, v222, 24, v72
    v_lshl_or_b32 v178, v95, 18, v178
    v_lshlrev_b32 v179, 3, v91
    v_sub_u32 v222, 1, v95
    v_mad_i32_i24 v79, v222, v91, v79
    v_max3_u32 v224, v88, v89, v90
    v_max_u32 v224, v224, v91
    v_mov_b32 v225, -262136
    s_mov_b32 s99, 0
    s_waitcnt lgkmcnt(0)
    v_mov_b32 v222, v221
    v_and_b32 v57, 0xffff, v221
    v_cmp_ne_u32 vcc, 0, v57
    v_and_b32 v52, 0xffff, v100
    v_lshrrev_b32 v100, 16, v100
    v_add_u32_dpp v222, v222, v222 row_shr:1 row_mask:0xf bank_mask:0xf
    v_min_u32 v48, 1, v52
    v_cndmask_b32_e64 v100, v100, v52, s[48:49]
    v_add_u32_dpp v222, v222, v222 row_shr:2 row_mask:0xf bank_mask:0xf
    v_mad_i32_i24 v48, v48, -10, 20
    v_cndmask_b32_e64 v48, 0, v48, s[48:49]
    v_add_u32_dpp v222, v222, v222 row_shr:4 row_mask:0xf bank_mask:0xf
    v_and_b32 v53, 0xffff, v101
    v_lshrrev_b32 v101, 16, v101
    v_add_u32_dpp v222, v222, v222 row_shr:8 row_mask:0xf bank_mask:0xf
    v_min_u32 v49, 1, v53
    v_cndmask_b32_e64 v101, v101, v53, s[50:51]
    v_add_u32_dpp v222, v222, v222 row_bcast:15 row_mask:0xa bank_mask:0xf
    v_mad_i32_i24 v49, v49, -10, 20
    v_cndmask_b32_e64 v49, 0, v49, s[50:51]
    v_add_u32_dpp v222, v222, v222 row_bcast:31 row_mask:0xc bank_mask:0xf
    v_lshrrev_b32 v58, 16, v222
    v_cndmask_b32 v56, 0, v58, vcc
    v_sub_u32 v222, v222, v221
    v_and_b32 v54, 0xffff, v102
    v_lshrrev_b32 v102, 16, v102
    v_max_u32_dpp v56, v56, v56 row_shr:1 row_mask:0xf bank_mask:0xf
    v_min_u32 v50, 1, v54
    v_cndmask_b32_e64 v102, v102, v54, s[52:53]
    v_max_u32_dpp v56, v56, v56 row_shr:2 row_mask:0xf bank_mask:0xf
    v_mad_i32_i24 v50, v50, -10, 20
    v_cndmask_b32_e64 v50, 0, v50, s[52:53]
    v_max_u32_dpp v56, v56, v56 row_shr:4 row_mask:0xf bank_mask:0xf
    v_and_b32 v55, 0xffff, v103
    v_lshrrev_b32 v103, 16, v103
    v_max_u32_dpp v56, v56, v56 row_shr:8 row_mask:0xf bank_mask:0xf
    v_min_u32 v51, 1, v55
    v_cndmask_b32_e64 v103, v103, v55, s[54:55]
    v_max_u32_dpp v56, v56, v56 row_bcast:15 row_mask:0xa bank_mask:0xf
    v_mad_i32_i24 v51, v51, -10, 20
    v_cndmask_b32_e64 v51, 0, v51, s[54:55]
    v_max_u32_dpp v56, v56, v56 row_bcast:31 row_mask:0xc bank_mask:0xf
    v_and_b32 v57, 0xffff, v222
    v_and_b32 v221, 1, v222
    v_mov_b32_dpp v56, v56 wave_shr:1 row_mask:0xf bank_mask:0xf
    v_cmp_eq_u32 vcc, 1, v221
    v_lshrrev_b32 v222, 16, v222
    v_add3_u32 v222, v222, v57, v221
    v_cndmask_b32 v56, v58, v56, vcc
    v_add_u32 v58, v58, v57
    v_add_u32 v56, v56, v57
    v_lshl_or_b32 v222, v58, 10, v222
    v_lshl_or_b32 v222, v56, 20, v222
    ds_bpermute_b32 v96, v96, v222
    ds_bpermute_b32 v97, v97, v222
    ds_bpermute_b32 v98, v98, v222
    ds_bpermute_b32 v99, v99, v222
    s_waitcnt lgkmcnt(3)
    v_bfe_u32 v96, v96, v48, 10
    v_add_lshl_u32 v96, v96, v100, 2
    v_lshl_or_b32 v222, v88, 16, v96
    v_lshlrev_b32 v96, 1, v96
    ds_write_b32 v220, v222 offset:32768
    s_waitcnt lgkmcnt(3)
    v_bfe_u32 v97, v97, v49, 10
    v_add_lshl_u32 v97, v97, v101, 2
    v_lshl_or_b32 v222, v89, 16, v97
    v_lshlrev_b32 v97, 1, v97
    ds_write_b32 v220, v222 offset:33024
    s_waitcnt lgkmcnt(3)
    v_bfe_u32 v98, v98, v50, 10
    v_add_lshl_u32 v98, v98, v102, 2
    v_lshl_or_b32 v222, v90, 16, v98
    v_lshlrev_b32 v98, 1, v98
    ds_write_b32 v220, v222 offset:33280
    s_waitcnt lgkmcnt(3)
    v_bfe_u32 v99, v99, v51, 10
    v_add_lshl_u32 v99, v99, v103, 2
    v_lshl_or_b32 v222, v91, 16, v99
    v_lshlrev_b32 v99, 1, v99
    ds_write_b32 v220, v222 offset:33536
K2_PLOOP:
    v_cmp_lt_u32_e64 s[32:33], s99, v88
    v_cmp_lt_u32_e64 s[34:35], s99, v89
    v_cmp_lt_u32_e64 s[36:37], s99, v90
    v_cmp_lt_u32_e64 s[38:39], s99, v91
    s_add_u32 s99, s99, 1
    v_cmp_eq_u32_e64 s[40:41], s99, v76
    v_cmp_eq_u32_e64 s[42:43], s99, v77
    v_cmp_eq_u32_e64 s[44:45], s99, v78
    v_cmp_eq_u32_e64 s[46:47], s99, v79
    s_mov_b64 exec, s[32:33]
    ds_write_b64 v96, v[172:173] offset:512
    s_mov_b64 exec, s[34:35]
    ds_write_b64 v97, v[174:175] offset:512
    s_mov_b64 exec, s[36:37]
    ds_write_b64 v98, v[176:177] offset:512
    s_mov_b64 exec, s[38:39]
    ds_write_b64 v99, v[178:179] offset:512
    s_mov_b64 exec, -1
    v_cmp_lt_u32 vcc, s99, v224
    v_cndmask_b32_e64 v222, 8, v225, s[40:41]
    v_add_u32 v172, v172, v222
    v_add_u32 v96, 8, v96
    v_cndmask_b32_e64 v222, 8, v225, s[42:43]
    v_add_u32 v174, v174, v222
    v_add_u32 v97, 8, v97
    v_cndmask_b32_e64 v222, 8, v225, s[44:45]
    v_add_u32 v176, v176, v222
    v_add_u32 v98, 8, v98
    v_cndmask_b32_e64 v222, 8, v225, s[46:47]
    v_add_u32 v178, v178, v222
    v_add_u32 v99, 8, v99
    s_cbranch_vccnz K2_PLOOP
    v_mov_b32 v222, s99
    ds_write_b32 v228, v222 offset:104
    s_waitcnt vmcnt(0)
K2_B3:
    s_mov_b64 exec, -1
    s_lshl_b32 s95, s100, 8
    v_and_b32 v220, 31, v250
    v_lshl_add_u32 v220, v220, 3, s95
    s_mov_b32 s6, 0
    s_waitcnt vmcnt(3) lgkmcnt(0)
    s_barrier
    ds_read_b64 v[220:221], v220 offset:512
    ds_read_b32 v222, v229 offset:104
    s_waitcnt lgkmcnt(0)
    v_bfe_u32 v235, v220, 18, 6
    v_and_b32 v207, 0x3ffff, v220
    v_lshrrev_b32 v249, 24, v220
    v_mov_b32 v206, v221
    v_readfirstlane_b32 s97, v222
    v_cmp_lt_u32_e64 s[28:29], s6, v235
    s_add_u32 s6, s6, 1
    v_add_u32 v221, s4, v249
    buffer_load_dwordx2 v[240:241], v221, s[16:19], 0 idxen
    v_cndmask_b32_e64 v203, 0, v207, s[28:29]
    v_add_u32 v207, v207, v206
    ds_read_b32 v218, v203
    ds_read_u16 v203, v203 offset:4
    v_bfe_u32 v220, v249, 1, 3
    v_lshlrev_b32 v220, 4, v220
    v_lshlrev_b32 v221, 2, v219
    v_xor_b32 v220, v220, v221
    v_lshl_add_u32 v220, v249, 7, v220
    v_add_u32 v220, 100352, v220
    v_xor_b32 v221, 16, v220
    v_xor_b32 v222, 32, v220
    v_xor_b32 v223, 48, v220
    s_waitcnt lgkmcnt(0)
    ds_bpermute_b32 v210, v239, v203 offset:0
    ds_bpermute_b32 v212, v239, v203 offset:32
    ds_bpermute_b32 v214, v239, v203 offset:64
    ds_bpermute_b32 v216, v239, v203 offset:96
    ds_read_b128 v[172:175], v220
    ds_read_b128 v[176:179], v221
    ds_read_b128 v[180:183], v222
    ds_read_b128 v[184:187], v223
    buffer_load_dwordx4 v[188:191], v[218:219], s[12:15], 0 idxen offen
    buffer_load_dwordx2 v[200:201], v203, s[16:19], 0 idxen
    v_cmp_lt_u32_e64 s[30:31], s6, v235
    s_add_u32 s6, s6, 1
    s_cmp_eq_u64 s[28:29], 0
    s_cbranch_scc1 K2_EMPTY
    s_waitcnt lgkmcnt(4)
    s_add_u32 m0, s94, 0
    s_nop 0
    buffer_load_dwordx4 v[210:211], s[8:11], 0 idxen offen lds
    s_add_u32 m0, s94, 1024
    s_nop 0
    buffer_load_dwordx4 v[212:213], s[8:11], 0 idxen offen lds
    s_add_u32 m0, s94, 2048
    s_nop 0
    buffer_load_dwordx4 v[214:215], s[8:11], 0 idxen offen lds
    s_add_u32 m0, s94, 3072
    s_nop 0
    buffer_load_dwordx4 v[216:217], s[8:11], 0 idxen offen lds
    v_cndmask_b32_e64 v203, 0, v207, s[30:31]
    v_add_u32 v207, v207, v206
    ds_read_b32 v218, v203
    ds_read_u16 v203, v203 offset:4
    s_waitcnt lgkmcnt(0)
    ds_bpermute_b32 v210, v239, v203 offset:0
    ds_bpermute_b32 v212, v239, v203 offset:32
    ds_bpermute_b32 v214, v239, v203 offset:64
    ds_bpermute_b32 v216, v239, v203 offset:96
    buffer_load_dwordx4 v[192:195], v[218:219], s[12:15], 0 idxen offen
    buffer_load_dwordx2 v[204:205], v203, s[16:19], 0 idxen
    v_cmp_lt_u32_e64 s[32:33], s6, v235
    s_add_u32 s6, s6, 1
    s_waitcnt lgkmcnt(0)
    s_add_u32 m0, s94, 32768
    s_nop 0
    buffer_load_dwordx4 v[210:211], s[8:11], 0 idxen offen lds
    s_add_u32 m0, s94, 33792
    s_nop 0
    buffer_load_dwordx4 v[212:213], s[8:11], 0 idxen offen lds
    s_add_u32 m0, s94, 34816
    s_nop 0
    buffer_load_dwordx4 v[214:215], s[8:11], 0 idxen offen lds
    s_add_u32 m0, s94, 35840
    s_nop 0
    buffer_load_dwordx4 v[216:217], s[8:11], 0 idxen offen lds
    v_cndmask_b32_e64 v203, 0, v207, s[32:33]
    v_add_u32 v207, v207, v206
    ds_read_b32 v218, v203
    ds_read_u16 v203, v203 offset:4
    s_waitcnt lgkmcnt(0)
    ds_bpermute_b32 v210, v239, v203 offset:0
    ds_bpermute_b32 v212, v239, v203 offset:32
    ds_bpermute_b32 v214, v239, v203 offset:64
    ds_bpermute_b32 v216, v239, v203 offset:96
    v_and_b32 v221, 63, v250
    v_lshlrev_b32 v220, 4, v221
    v_lshlrev_b32 v221, 2, v221
    v_add_u32 v220, 138240, v220
    v_lshlrev_b32 v222, 3, v219
    v_add_u32 v221, 156672, v221
    v_add_u32 v222, 157696, v222
    ds_read_b128 v[140:143], v220 offset:0
    ds_read_b128 v[144:147], v220 offset:1024
    ds_read_b128 v[148:151], v220 offset:2048
    ds_read_b128 v[152:155], v220 offset:3072
    ds_read_b128 v[156:159], v220 offset:4096
    ds_read_b128 v[160:163], v220 offset:5120
    ds_read_b128 v[164:167], v220 offset:6144
    ds_read_b128 v[168:171], v220 offset:7168
    ds_read_b128 v[0:3], v220 offset:8192
    ds_read_b128 v[4:7], v220 offset:9216
    ds_read_b128 v[8:11], v220 offset:10240
    ds_read_b128 v[12:15], v220 offset:11264
    ds_read_b128 v[16:19], v220 offset:12288
    ds_read_b128 v[20:23], v220 offset:13312
    ds_read_b128 v[24:27], v220 offset:14336
    ds_read_b128 v[28:31], v220 offset:15360
    ds_read_b128 v[32:35], v220 offset:16384
    ds_read_b128 v[36:39], v220 offset:17408
    ds_read_b32 v40, v221
    ds_read_b32 v42, v221 offset:256
    ds_read_b128 v[108:111], v222 offset:0
    ds_read_b128 v[112:115], v222 offset:16
    ds_read_b128 v[116:119], v222 offset:32
    ds_read_b128 v[120:123], v222 offset:48
    ds_read_b128 v[124:127], v222 offset:64
    ds_read_b128 v[128:131], v222 offset:80
    ds_read_b128 v[132:135], v222 offset:96
    ds_read_b128 v[136:139], v222 offset:112
    v_mov_b32 v76, 0
    v_mov_b32 v77, 0
    v_mov_b32 v78, 0
    v_mov_b32 v79, 0
    v_mov_b32 v80, 0
    v_mov_b32 v81, 0
    v_mov_b32 v82, 0
    v_mov_b32 v83, 0
    v_mov_b32 v84, 0
    v_mov_b32 v85, 0
    v_mov_b32 v86, 0
    v_mov_b32 v87, 0
    v_mov_b32 v88, 0
    v_mov_b32 v89, 0
    v_mov_b32 v90, 0
    v_mov_b32 v91, 0
    v_mov_b32 v92, 0
    v_mov_b32 v93, 0
    v_mov_b32 v94, 0
    v_mov_b32 v95, 0
    v_mov_b32 v96, 0
    v_mov_b32 v97, 0
    v_mov_b32 v98, 0
    v_mov_b32 v99, 0
    v_mov_b32 v100, 0
    v_mov_b32 v101, 0
    v_mov_b32 v102, 0
    v_mov_b32 v103, 0
    v_mov_b32 v104, 0
    v_mov_b32 v105, 0
    v_mov_b32 v106, 0
    v_mov_b32 v107, 0
    v_mov_b32 v244, 0
    v_mov_b32 v245, 0
    v_mov_b32 v246, 0
    v_mov_b32 v247, 0
    s_waitcnt lgkmcnt(0)
    v_mfma_f32_32x32x16_bf16 v[44:59], v[140:143], v[172:175], 0
    v_mfma_f32_32x32x16_bf16 v[60:75], v[156:159], v[172:175], 0
    v_mfma_f32_32x32x16_bf16 v[44:59], v[144:147], v[176:179], v[44:59]
    v_mfma_f32_32x32x16_bf16 v[60:75], v[160:163], v[176:179], v[60:75]
    v_mfma_f32_32x32x16_bf16 v[44:59], v[148:151], v[180:183], v[44:59]
    v_mfma_f32_32x32x16_bf16 v[60:75], v[164:167], v[180:183], v[60:75]
    v_mfma_f32_32x32x16_bf16 v[44:59], v[152:155], v[184:187], v[44:59]
    v_mfma_f32_32x32x16_bf16 v[60:75], v[168:171], v[184:187], v[60:75]
    s_waitcnt vmcnt(6)
    ds_read_b128 v[172:175], v251 offset:0
    ds_read_b128 v[176:179], v252 offset:0
    ds_read_b128 v[180:183], v253 offset:0
    ds_read_b128 v[184:187], v254 offset:0
    v_mov_b32 v242, v241
    v_and_b32 v241, 0xffff0000, v240
    v_lshlrev_b32 v240, 16, v240
    v_lshlrev_b32 v232, 16, v200
    v_and_b32 v233, 0xffff0000, v200
    v_sub_f32 v234, v242, v201
    v_pk_add_f32 v[232:233], v[240:241], v[232:233] neg_lo:[0,1] neg_hi:[0,1]
    v_mul_f32 v208, v232, v232
    v_fmac_f32 v208, v233, v233
    v_fmac_f32 v208, v234, v234
    v_cvt_pk_bf16_f32 v208, v208, v208
    s_waitcnt lgkmcnt(0)
    s_nop 0
    v_mfma_f32_32x32x8_bf16 v[140:155], v[40:41], v[208:209], v[44:59]
    v_mfma_f32_32x32x16_bf16 v[140:155], v[32:35], v[188:191], v[140:155]
    v_mfma_f32_32x32x16_bf16 v[140:155], v[0:3], v[172:175], v[140:155]
    v_mfma_f32_32x32x16_bf16 v[140:155], v[4:7], v[176:179], v[140:155]
    v_mfma_f32_32x32x16_bf16 v[140:155], v[8:11], v[180:183], v[140:155]
    v_mfma_f32_32x32x16_bf16 v[140:155], v[12:15], v[184:187], v[140:155]
    s_nop 7
K2_LOOP:
    v_mfma_f32_32x32x8_bf16 v[156:171], v[42:43], v[208:209], v[60:75]
    s_mov_b64 exec, s[28:29]
    s_nop 1
    v_exp_f32 v220, v140
    v_exp_f32 v221, v141
    v_exp_f32 v222, v142
    v_exp_f32 v223, v143
    v_mfma_f32_32x32x16_bf16 v[156:171], v[36:39], v[188:191], v[156:171]
    v_exp_f32 v224, v144
    v_exp_f32 v225, v145
    s_bitcmp1_b32 s5, 2
    s_cbranch_scc0 K2_VP1
    s_setprio 1
K2_VP1:
    s_waitcnt lgkmcnt(0)
    s_mov_b64 exec, -1
    s_add_u32 m0, s94, 0
    s_nop 0
    buffer_load_dwordx4 v[210:211], s[8:11], 0 idxen offen lds
    s_add_u32 m0, s94, 1024
    s_nop 0
    buffer_load_dwordx4 v[212:213], s[8:11], 0 idxen offen lds
    s_add_u32 m0, s94, 2048
    s_nop 0
    buffer_load_dwordx4 v[214:215], s[8:11], 0 idxen offen lds
    s_add_u32 m0, s94, 3072
    s_nop 0
    buffer_load_dwordx4 v[216:217], s[8:11], 0 idxen offen lds
    s_mov_b64 exec, s[28:29]
    s_setprio 0
    v_exp_f32 v226, v146
    v_exp_f32 v227, v147
    v_pk_add_f32 v[220:221], v[220:221], 1.0 op_sel_hi:[1,0]
    v_pk_add_f32 v[222:223], v[222:223], 1.0 op_sel_hi:[1,0]
    v_pk_add_f32 v[224:225], v[224:225], 1.0 op_sel_hi:[1,0]
    v_pk_add_f32 v[226:227], v[226:227], 1.0 op_sel_hi:[1,0]
    v_mfma_f32_32x32x16_bf16 v[156:171], v[16:19], v[172:175], v[156:171]
    v_rcp_f32 v220, v220
    v_rcp_f32 v221, v221
    v_rcp_f32 v222, v222
    v_rcp_f32 v223, v223
    v_mfma_f32_32x32x16_bf16 v[156:171], v[20:23], v[176:179], v[156:171]
    v_rcp_f32 v224, v224
    v_rcp_f32 v225, v225
    v_rcp_f32 v226, v226
    v_rcp_f32 v227, v227
    v_pk_fma_f32 v[76:77], v[140:141], v[220:221], v[76:77]
    v_pk_fma_f32 v[78:79], v[142:143], v[222:223], v[78:79]
    v_pk_fma_f32 v[80:81], v[144:145], v[224:225], v[80:81]
    v_pk_fma_f32 v[82:83], v[146:147], v[226:227], v[82:83]
    v_pk_mul_f32 v[228:229], v[76:77], v[108:109]
    v_pk_mul_f32 v[230:231], v[78:79], v[110:111]
    v_pk_fma_f32 v[228:229], v[80:81], v[112:113], v[228:229]
    v_pk_fma_f32 v[230:231], v[82:83], v[114:115], v[230:231]
    v_mfma_f32_32x32x16_bf16 v[156:171], v[24:27], v[180:183], v[156:171]
    v_exp_f32 v220, v148
    v_exp_f32 v221, v149
    v_exp_f32 v222, v150
    v_exp_f32 v223, v151
    v_mfma_f32_32x32x16_bf16 v[156:171], v[28:31], v[184:187], v[156:171]
    v_exp_f32 v224, v152
    v_exp_f32 v225, v153
    v_exp_f32 v226, v154
    buffer_load_dwordx4 v[196:199], v[218:219], s[12:15], 0 idxen offen
    buffer_load_dwordx2 v[200:201], v203, s[16:19], 0 idxen
    v_exp_f32 v227, v155
    s_waitcnt vmcnt(6)
    ds_read_b128 v[172:175], v251 offset:32768
    ds_read_b128 v[176:179], v252 offset:32768
    ds_read_b128 v[180:183], v253 offset:32768
    ds_read_b128 v[184:187], v254 offset:32768
    v_cmp_lt_u32_e64 s[34:35], s6, v235
    s_add_u32 s6, s6, 1
    v_lshlrev_b32 v236, 16, v204
    v_and_b32 v237, 0xffff0000, v204
    v_sub_f32 v238, v242, v205
    v_pk_add_f32 v[236:237], v[240:241], v[236:237] neg_lo:[0,1] neg_hi:[0,1]
    v_mul_f32 v208, v236, v236
    v_fmac_f32 v208, v237, v237
    v_fmac_f32 v208, v238, v238
    v_cvt_pk_bf16_f32 v208, v208, v208
    v_cndmask_b32_e64 v203, 0, v207, s[34:35]
    v_add_u32 v207, v207, v206
    ds_read_b32 v218, v203
    ds_read_u16 v203, v203 offset:4
    v_pk_add_f32 v[220:221], v[220:221], 1.0 op_sel_hi:[1,0]
    v_pk_add_f32 v[222:223], v[222:223], 1.0 op_sel_hi:[1,0]
    v_pk_add_f32 v[224:225], v[224:225], 1.0 op_sel_hi:[1,0]
    v_pk_add_f32 v[226:227], v[226:227], 1.0 op_sel_hi:[1,0]
    v_rcp_f32 v220, v220
    v_rcp_f32 v221, v221
    v_rcp_f32 v222, v222
    v_rcp_f32 v223, v223
    v_rcp_f32 v224, v224
    v_rcp_f32 v225, v225
    v_rcp_f32 v226, v226
    v_rcp_f32 v227, v227
    s_waitcnt lgkmcnt(0)
    s_mov_b64 exec, -1
    ds_bpermute_b32 v210, v239, v203 offset:0
    ds_bpermute_b32 v212, v239, v203 offset:32
    ds_bpermute_b32 v214, v239, v203 offset:64
    ds_bpermute_b32 v216, v239, v203 offset:96
    s_mov_b64 exec, s[28:29]
    v_pk_fma_f32 v[84:85], v[148:149], v[220:221], v[84:85]
    v_pk_fma_f32 v[86:87], v[150:151], v[222:223], v[86:87]
    v_pk_fma_f32 v[88:89], v[152:153], v[224:225], v[88:89]
    v_pk_fma_f32 v[90:91], v[154:155], v[226:227], v[90:91]
    v_pk_fma_f32 v[228:229], v[84:85], v[116:117], v[228:229]
    v_pk_fma_f32 v[230:231], v[86:87], v[118:119], v[230:231]
    v_pk_fma_f32 v[228:229], v[88:89], v[120:121], v[228:229]
    v_pk_fma_f32 v[230:231], v[90:91], v[122:123], v[230:231]
    v_mfma_f32_32x32x8_bf16 v[140:155], v[40:41], v[208:209], v[44:59]
    v_exp_f32 v220, v156
    v_exp_f32 v221, v157
    v_exp_f32 v222, v158
    v_exp_f32 v223, v159
    v_mfma_f32_32x32x16_bf16 v[140:155], v[32:35], v[192:195], v[140:155]
    v_exp_f32 v224, v160
    v_exp_f32 v225, v161
    v_exp_f32 v226, v162
    v_exp_f32 v227, v163
    v_pk_add_f32 v[220:221], v[220:221], 1.0 op_sel_hi:[1,0]
    v_pk_add_f32 v[222:223], v[222:223], 1.0 op_sel_hi:[1,0]
    v_pk_add_f32 v[224:225], v[224:225], 1.0 op_sel_hi:[1,0]
    v_pk_add_f32 v[226:227], v[226:227], 1.0 op_sel_hi:[1,0]
    v_mfma_f32_32x32x16_bf16 v[140:155], v[0:3], v[172:175], v[140:155]
    v_rcp_f32 v220, v220
    v_rcp_f32 v221, v221
    v_rcp_f32 v222, v222
    v_rcp_f32 v223, v223
    v_mfma_f32_32x32x16_bf16 v[140:155], v[4:7], v[176:179], v[140:155]
    v_rcp_f32 v224, v224
    v_rcp_f32 v225, v225
    v_rcp_f32 v226, v226
    v_rcp_f32 v227, v227
    v_pk_fma_f32 v[92:93], v[156:157], v[220:221], v[92:93]
    v_pk_fma_f32 v[94:95], v[158:159], v[222:223], v[94:95]
    v_pk_fma_f32 v[96:97], v[160:161], v[224:225], v[96:97]
    v_pk_fma_f32 v[98:99], v[162:163], v[226:227], v[98:99]
    v_pk_fma_f32 v[228:229], v[92:93], v[124:125], v[228:229]
    v_pk_fma_f32 v[230:231], v[94:95], v[126:127], v[230:231]
    v_pk_fma_f32 v[228:229], v[96:97], v[128:129], v[228:229]
    v_pk_fma_f32 v[230:231], v[98:99], v[130:131], v[230:231]
    v_mfma_f32_32x32x16_bf16 v[140:155], v[8:11], v[180:183], v[140:155]
    v_exp_f32 v220, v164
    v_exp_f32 v221, v165
    v_exp_f32 v222, v166
    v_exp_f32 v223, v167
    v_mfma_f32_32x32x16_bf16 v[140:155], v[12:15], v[184:187], v[140:155]
    v_exp_f32 v224, v168
    v_exp_f32 v225, v169
    v_exp_f32 v226, v170
    v_exp_f32 v227, v171
    v_pk_add_f32 v[220:221], v[220:221], 1.0 op_sel_hi:[1,0]
    v_pk_add_f32 v[222:223], v[222:223], 1.0 op_sel_hi:[1,0]
    v_pk_add_f32 v[224:225], v[224:225], 1.0 op_sel_hi:[1,0]
    v_pk_add_f32 v[226:227], v[226:227], 1.0 op_sel_hi:[1,0]
    v_rcp_f32 v220, v220
    v_rcp_f32 v221, v221
    v_rcp_f32 v222, v222
    v_rcp_f32 v223, v223
    v_rcp_f32 v224, v224
    v_rcp_f32 v225, v225
    v_rcp_f32 v226, v226
    v_rcp_f32 v227, v227
    v_pk_fma_f32 v[100:101], v[164:165], v[220:221], v[100:101]
    v_pk_fma_f32 v[102:103], v[166:167], v[222:223], v[102:103]
    v_pk_fma_f32 v[104:105], v[168:169], v[224:225], v[104:105]
    v_pk_fma_f32 v[106:107], v[170:171], v[226:227], v[106:107]
    v_pk_fma_f32 v[228:229], v[100:101], v[132:133], v[228:229]
    v_pk_fma_f32 v[230:231], v[102:103], v[134:135], v[230:231]
    v_pk_fma_f32 v[228:229], v[104:105], v[136:137], v[228:229]
    v_pk_fma_f32 v[230:231], v[106:107], v[138:139], v[230:231]
    v_pk_add_f32 v[228:229], v[228:229], v[230:231]
    s_cmp_eq_u64 s[30:31], 0
    v_add_f32 v243, v228, v229
    v_sub_f32 v248, v243, v247
    v_pk_fma_f32 v[244:245], v[232:233], v[248:249], v[244:245] op_sel_hi:[1,0,1]
    v_fmac_f32 v246, v234, v248
    s_mov_b64 exec, -1
    s_cbranch_scc1 K2_DONE
    v_mfma_f32_32x32x8_bf16 v[156:171], v[42:43], v[208:209], v[60:75]
    s_mov_b64 exec, s[30:31]
    v_exp_f32 v220, v140
    v_exp_f32 v221, v141
    v_exp_f32 v222, v142
    v_exp_f32 v223, v143
    v_mfma_f32_32x32x16_bf16 v[156:171], v[36:39], v[192:195], v[156:171]
    v_exp_f32 v224, v144
    v_exp_f32 v225, v145
    s_bitcmp1_b32 s5, 2
    s_cbranch_scc0 K2_VP3
    s_setprio 1
K2_VP3:
    s_waitcnt lgkmcnt(0)
    s_mov_b64 exec, -1
    s_add_u32 m0, s94, 32768
    s_nop 0
    buffer_load_dwordx4 v[210:211], s[8:11], 0 idxen offen lds
    s_add_u32 m0, s94, 33792
    s_nop 0
    buffer_load_dwordx4 v[212:213], s[8:11], 0 idxen offen lds
    s_add_u32 m0, s94, 34816
    s_nop 0
    buffer_load_dwordx4 v[214:215], s[8:11], 0 idxen offen lds
    s_add_u32 m0, s94, 35840
    s_nop 0
    buffer_load_dwordx4 v[216:217], s[8:11], 0 idxen offen lds
    s_mov_b64 exec, s[30:31]
    s_setprio 0
    v_exp_f32 v226, v146
    v_exp_f32 v227, v147
    v_pk_add_f32 v[220:221], v[220:221], 1.0 op_sel_hi:[1,0]
    v_pk_add_f32 v[222:223], v[222:223], 1.0 op_sel_hi:[1,0]
    v_pk_add_f32 v[224:225], v[224:225], 1.0 op_sel_hi:[1,0]
    v_pk_add_f32 v[226:227], v[226:227], 1.0 op_sel_hi:[1,0]
    v_mfma_f32_32x32x16_bf16 v[156:171], v[16:19], v[172:175], v[156:171]
    v_rcp_f32 v220, v220
    v_rcp_f32 v221, v221
    v_rcp_f32 v222, v222
    v_rcp_f32 v223, v223
    v_mfma_f32_32x32x16_bf16 v[156:171], v[20:23], v[176:179], v[156:171]
    v_rcp_f32 v224, v224
    v_rcp_f32 v225, v225
    v_rcp_f32 v226, v226
    v_rcp_f32 v227, v227
    v_pk_fma_f32 v[76:77], v[140:141], v[220:221], v[76:77]
    v_pk_fma_f32 v[78:79], v[142:143], v[222:223], v[78:79]
    v_pk_fma_f32 v[80:81], v[144:145], v[224:225], v[80:81]
    v_pk_fma_f32 v[82:83], v[146:147], v[226:227], v[82:83]
    v_pk_mul_f32 v[228:229], v[76:77], v[108:109]
    v_pk_mul_f32 v[230:231], v[78:79], v[110:111]
    v_pk_fma_f32 v[228:229], v[80:81], v[112:113], v[228:229]
    v_pk_fma_f32 v[230:231], v[82:83], v[114:115], v[230:231]
    v_mfma_f32_32x32x16_bf16 v[156:171], v[24:27], v[180:183], v[156:171]
    v_exp_f32 v220, v148
    v_exp_f32 v221, v149
    v_exp_f32 v222, v150
    v_exp_f32 v223, v151
    v_mfma_f32_32x32x16_bf16 v[156:171], v[28:31], v[184:187], v[156:171]
    v_exp_f32 v224, v152
    v_exp_f32 v225, v153
    v_exp_f32 v226, v154
    buffer_load_dwordx4 v[188:191], v[218:219], s[12:15], 0 idxen offen
    buffer_load_dwordx2 v[204:205], v203, s[16:19], 0 idxen
    v_exp_f32 v227, v155
    s_waitcnt vmcnt(6)
    ds_read_b128 v[172:175], v251 offset:0
    ds_read_b128 v[176:179], v252 offset:0
    ds_read_b128 v[180:183], v253 offset:0
    ds_read_b128 v[184:187], v254 offset:0
    v_cmp_lt_u32_e64 s[36:37], s6, v235
    s_add_u32 s6, s6, 1
    v_lshlrev_b32 v232, 16, v200
    v_and_b32 v233, 0xffff0000, v200
    v_sub_f32 v234, v242, v201
    v_pk_add_f32 v[232:233], v[240:241], v[232:233] neg_lo:[0,1] neg_hi:[0,1]
    v_mul_f32 v208, v232, v232
    v_fmac_f32 v208, v233, v233
    v_fmac_f32 v208, v234, v234
    v_cvt_pk_bf16_f32 v208, v208, v208
    v_cndmask_b32_e64 v203, 0, v207, s[36:37]
    v_add_u32 v207, v207, v206
    ds_read_b32 v218, v203
    ds_read_u16 v203, v203 offset:4
    v_pk_add_f32 v[220:221], v[220:221], 1.0 op_sel_hi:[1,0]
    v_pk_add_f32 v[222:223], v[222:223], 1.0 op_sel_hi:[1,0]
    v_pk_add_f32 v[224:225], v[224:225], 1.0 op_sel_hi:[1,0]
    v_pk_add_f32 v[226:227], v[226:227], 1.0 op_sel_hi:[1,0]
    v_rcp_f32 v220, v220
    v_rcp_f32 v221, v221
    v_rcp_f32 v222, v222
    v_rcp_f32 v223, v223
    v_rcp_f32 v224, v224
    v_rcp_f32 v225, v225
    v_rcp_f32 v226, v226
    v_rcp_f32 v227, v227
    s_waitcnt lgkmcnt(0)
    s_mov_b64 exec, -1
    ds_bpermute_b32 v210, v239, v203 offset:0
    ds_bpermute_b32 v212, v239, v203 offset:32
    ds_bpermute_b32 v214, v239, v203 offset:64
    ds_bpermute_b32 v216, v239, v203 offset:96
    s_mov_b64 exec, s[30:31]
    v_pk_fma_f32 v[84:85], v[148:149], v[220:221], v[84:85]
    v_pk_fma_f32 v[86:87], v[150:151], v[222:223], v[86:87]
    v_pk_fma_f32 v[88:89], v[152:153], v[224:225], v[88:89]
    v_pk_fma_f32 v[90:91], v[154:155], v[226:227], v[90:91]
    v_pk_fma_f32 v[228:229], v[84:85], v[116:117], v[228:229]
    v_pk_fma_f32 v[230:231], v[86:87], v[118:119], v[230:231]
    v_pk_fma_f32 v[228:229], v[88:89], v[120:121], v[228:229]
    v_pk_fma_f32 v[230:231], v[90:91], v[122:123], v[230:231]
    v_mfma_f32_32x32x8_bf16 v[140:155], v[40:41], v[208:209], v[44:59]
    v_exp_f32 v220, v156
    v_exp_f32 v221, v157
    v_exp_f32 v222, v158
    v_exp_f32 v223, v159
    v_mfma_f32_32x32x16_bf16 v[140:155], v[32:35], v[196:199], v[140:155]
    v_exp_f32 v224, v160
    v_exp_f32 v225, v161
    v_exp_f32 v226, v162
    v_exp_f32 v227, v163
    v_pk_add_f32 v[220:221], v[220:221], 1.0 op_sel_hi:[1,0]
    v_pk_add_f32 v[222:223], v[222:223], 1.0 op_sel_hi:[1,0]
    v_pk_add_f32 v[224:225], v[224:225], 1.0 op_sel_hi:[1,0]
    v_pk_add_f32 v[226:227], v[226:227], 1.0 op_sel_hi:[1,0]
    v_mfma_f32_32x32x16_bf16 v[140:155], v[0:3], v[172:175], v[140:155]
    v_rcp_f32 v220, v220
    v_rcp_f32 v221, v221
    v_rcp_f32 v222, v222
    v_rcp_f32 v223, v223
    v_mfma_f32_32x32x16_bf16 v[140:155], v[4:7], v[176:179], v[140:155]
    v_rcp_f32 v224, v224
    v_rcp_f32 v225, v225
    v_rcp_f32 v226, v226
    v_rcp_f32 v227, v227
    v_pk_fma_f32 v[92:93], v[156:157], v[220:221], v[92:93]
    v_pk_fma_f32 v[94:95], v[158:159], v[222:223], v[94:95]
    v_pk_fma_f32 v[96:97], v[160:161], v[224:225], v[96:97]
    v_pk_fma_f32 v[98:99], v[162:163], v[226:227], v[98:99]
    v_pk_fma_f32 v[228:229], v[92:93], v[124:125], v[228:229]
    v_pk_fma_f32 v[230:231], v[94:95], v[126:127], v[230:231]
    v_pk_fma_f32 v[228:229], v[96:97], v[128:129], v[228:229]
    v_pk_fma_f32 v[230:231], v[98:99], v[130:131], v[230:231]
    v_mfma_f32_32x32x16_bf16 v[140:155], v[8:11], v[180:183], v[140:155]
    v_exp_f32 v220, v164
    v_exp_f32 v221, v165
    v_exp_f32 v222, v166
    v_exp_f32 v223, v167
    v_mfma_f32_32x32x16_bf16 v[140:155], v[12:15], v[184:187], v[140:155]
    v_exp_f32 v224, v168
    v_exp_f32 v225, v169
    v_exp_f32 v226, v170
    v_exp_f32 v227, v171
    v_pk_add_f32 v[220:221], v[220:221], 1.0 op_sel_hi:[1,0]
    v_pk_add_f32 v[222:223], v[222:223], 1.0 op_sel_hi:[1,0]
    v_pk_add_f32 v[224:225], v[224:225], 1.0 op_sel_hi:[1,0]
    v_pk_add_f32 v[226:227], v[226:227], 1.0 op_sel_hi:[1,0]
    v_rcp_f32 v220, v220
    v_rcp_f32 v221, v221
    v_rcp_f32 v222, v222
    v_rcp_f32 v223, v223
    v_rcp_f32 v224, v224
    v_rcp_f32 v225, v225
    v_rcp_f32 v226, v226
    v_rcp_f32 v227, v227
    v_pk_fma_f32 v[100:101], v[164:165], v[220:221], v[100:101]
    v_pk_fma_f32 v[102:103], v[166:167], v[222:223], v[102:103]
    v_pk_fma_f32 v[104:105], v[168:169], v[224:225], v[104:105]
    v_pk_fma_f32 v[106:107], v[170:171], v[226:227], v[106:107]
    v_pk_fma_f32 v[228:229], v[100:101], v[132:133], v[228:229]
    v_pk_fma_f32 v[230:231], v[102:103], v[134:135], v[230:231]
    v_pk_fma_f32 v[228:229], v[104:105], v[136:137], v[228:229]
    v_pk_fma_f32 v[230:231], v[106:107], v[138:139], v[230:231]
    v_pk_add_f32 v[228:229], v[228:229], v[230:231]
    s_cmp_eq_u64 s[32:33], 0
    v_add_f32 v247, v228, v229
    v_sub_f32 v248, v247, v243
    v_pk_fma_f32 v[244:245], v[236:237], v[248:249], v[244:245] op_sel_hi:[1,0,1]
    v_fmac_f32 v246, v238, v248
    s_mov_b64 exec, -1
    s_cbranch_scc1 K2_DONE
    v_mfma_f32_32x32x8_bf16 v[156:171], v[42:43], v[208:209], v[60:75]
    s_mov_b64 exec, s[32:33]
    v_exp_f32 v220, v140
    v_exp_f32 v221, v141
    v_exp_f32 v222, v142
    v_exp_f32 v223, v143
    v_mfma_f32_32x32x16_bf16 v[156:171], v[36:39], v[196:199], v[156:171]
    v_exp_f32 v224, v144
    v_exp_f32 v225, v145
    s_bitcmp1_b32 s5, 2
    s_cbranch_scc0 K2_VP5
    s_setprio 1
K2_VP5:
    s_waitcnt lgkmcnt(0)
    s_mov_b64 exec, -1
    s_add_u32 m0, s94, 0
    s_nop 0
    buffer_load_dwordx4 v[210:211], s[8:11], 0 idxen offen lds
    s_add_u32 m0, s94, 1024
    s_nop 0
    buffer_load_dwordx4 v[212:213], s[8:11], 0 idxen offen lds
    s_add_u32 m0, s94, 2048
    s_nop 0
    buffer_load_dwordx4 v[214:215], s[8:11], 0 idxen offen lds
    s_add_u32 m0, s94, 3072
    s_nop 0
    buffer_load_dwordx4 v[216:217], s[8:11], 0 idxen offen lds
    s_mov_b64 exec, s[32:33]
    s_setprio 0
    v_exp_f32 v226, v146
    v_exp_f32 v227, v147
    v_pk_add_f32 v[220:221], v[220:221], 1.0 op_sel_hi:[1,0]
    v_pk_add_f32 v[222:223], v[222:223], 1.0 op_sel_hi:[1,0]
    v_pk_add_f32 v[224:225], v[224:225], 1.0 op_sel_hi:[1,0]
    v_pk_add_f32 v[226:227], v[226:227], 1.0 op_sel_hi:[1,0]
    v_mfma_f32_32x32x16_bf16 v[156:171], v[16:19], v[172:175], v[156:171]
    v_rcp_f32 v220, v220
    v_rcp_f32 v221, v221
    v_rcp_f32 v222, v222
    v_rcp_f32 v223, v223
    v_mfma_f32_32x32x16_bf16 v[156:171], v[20:23], v[176:179], v[156:171]
    v_rcp_f32 v224, v224
    v_rcp_f32 v225, v225
    v_rcp_f32 v226, v226
    v_rcp_f32 v227, v227
    v_pk_fma_f32 v[76:77], v[140:141], v[220:221], v[76:77]
    v_pk_fma_f32 v[78:79], v[142:143], v[222:223], v[78:79]
    v_pk_fma_f32 v[80:81], v[144:145], v[224:225], v[80:81]
    v_pk_fma_f32 v[82:83], v[146:147], v[226:227], v[82:83]
    v_pk_mul_f32 v[228:229], v[76:77], v[108:109]
    v_pk_mul_f32 v[230:231], v[78:79], v[110:111]
    v_pk_fma_f32 v[228:229], v[80:81], v[112:113], v[228:229]
    v_pk_fma_f32 v[230:231], v[82:83], v[114:115], v[230:231]
    v_mfma_f32_32x32x16_bf16 v[156:171], v[24:27], v[180:183], v[156:171]
    v_exp_f32 v220, v148
    v_exp_f32 v221, v149
    v_exp_f32 v222, v150
    v_exp_f32 v223, v151
    v_mfma_f32_32x32x16_bf16 v[156:171], v[28:31], v[184:187], v[156:171]
    v_exp_f32 v224, v152
    v_exp_f32 v225, v153
    v_exp_f32 v226, v154
    buffer_load_dwordx4 v[192:195], v[218:219], s[12:15], 0 idxen offen
    buffer_load_dwordx2 v[200:201], v203, s[16:19], 0 idxen
    v_exp_f32 v227, v155
    s_waitcnt vmcnt(6)
    ds_read_b128 v[172:175], v251 offset:32768
    ds_read_b128 v[176:179], v252 offset:32768
    ds_read_b128 v[180:183], v253 offset:32768
    ds_read_b128 v[184:187], v254 offset:32768
    v_cmp_lt_u32_e64 s[38:39], s6, v235
    s_add_u32 s6, s6, 1
    v_lshlrev_b32 v236, 16, v204
    v_and_b32 v237, 0xffff0000, v204
    v_sub_f32 v238, v242, v205
    v_pk_add_f32 v[236:237], v[240:241], v[236:237] neg_lo:[0,1] neg_hi:[0,1]
    v_mul_f32 v208, v236, v236
    v_fmac_f32 v208, v237, v237
    v_fmac_f32 v208, v238, v238
    v_cvt_pk_bf16_f32 v208, v208, v208
    v_cndmask_b32_e64 v203, 0, v207, s[38:39]
    v_add_u32 v207, v207, v206
    ds_read_b32 v218, v203
    ds_read_u16 v203, v203 offset:4
    v_pk_add_f32 v[220:221], v[220:221], 1.0 op_sel_hi:[1,0]
    v_pk_add_f32 v[222:223], v[222:223], 1.0 op_sel_hi:[1,0]
    v_pk_add_f32 v[224:225], v[224:225], 1.0 op_sel_hi:[1,0]
    v_pk_add_f32 v[226:227], v[226:227], 1.0 op_sel_hi:[1,0]
    v_rcp_f32 v220, v220
    v_rcp_f32 v221, v221
    v_rcp_f32 v222, v222
    v_rcp_f32 v223, v223
    v_rcp_f32 v224, v224
    v_rcp_f32 v225, v225
    v_rcp_f32 v226, v226
    v_rcp_f32 v227, v227
    s_waitcnt lgkmcnt(0)
    s_mov_b64 exec, -1
    ds_bpermute_b32 v210, v239, v203 offset:0
    ds_bpermute_b32 v212, v239, v203 offset:32
    ds_bpermute_b32 v214, v239, v203 offset:64
    ds_bpermute_b32 v216, v239, v203 offset:96
    s_mov_b64 exec, s[32:33]
    v_pk_fma_f32 v[84:85], v[148:149], v[220:221], v[84:85]
    v_pk_fma_f32 v[86:87], v[150:151], v[222:223], v[86:87]
    v_pk_fma_f32 v[88:89], v[152:153], v[224:225], v[88:89]
    v_pk_fma_f32 v[90:91], v[154:155], v[226:227], v[90:91]
    v_pk_fma_f32 v[228:229], v[84:85], v[116:117], v[228:229]
    v_pk_fma_f32 v[230:231], v[86:87], v[118:119], v[230:231]
    v_pk_fma_f32 v[228:229], v[88:89], v[120:121], v[228:229]
    v_pk_fma_f32 v[230:231], v[90:91], v[122:123], v[230:231]
    v_mfma_f32_32x32x8_bf16 v[140:155], v[40:41], v[208:209], v[44:59]
    v_exp_f32 v220, v156
    v_exp_f32 v221, v157
    v_exp_f32 v222, v158
    v_exp_f32 v223, v159
    v_mfma_f32_32x32x16_bf16 v[140:155], v[32:35], v[188:191], v[140:155]
    v_exp_f32 v224, v160
    v_exp_f32 v225, v161
    v_exp_f32 v226, v162
    v_exp_f32 v227, v163
    v_pk_add_f32 v[220:221], v[220:221], 1.0 op_sel_hi:[1,0]
    v_pk_add_f32 v[222:223], v[222:223], 1.0 op_sel_hi:[1,0]
    v_pk_add_f32 v[224:225], v[224:225], 1.0 op_sel_hi:[1,0]
    v_pk_add_f32 v[226:227], v[226:227], 1.0 op_sel_hi:[1,0]
    v_mfma_f32_32x32x16_bf16 v[140:155], v[0:3], v[172:175], v[140:155]
    v_rcp_f32 v220, v220
    v_rcp_f32 v221, v221
    v_rcp_f32 v222, v222
    v_rcp_f32 v223, v223
    v_mfma_f32_32x32x16_bf16 v[140:155], v[4:7], v[176:179], v[140:155]
    v_rcp_f32 v224, v224
    v_rcp_f32 v225, v225
    v_rcp_f32 v226, v226
    v_rcp_f32 v227, v227
    v_pk_fma_f32 v[92:93], v[156:157], v[220:221], v[92:93]
    v_pk_fma_f32 v[94:95], v[158:159], v[222:223], v[94:95]
    v_pk_fma_f32 v[96:97], v[160:161], v[224:225], v[96:97]
    v_pk_fma_f32 v[98:99], v[162:163], v[226:227], v[98:99]
    v_pk_fma_f32 v[228:229], v[92:93], v[124:125], v[228:229]
    v_pk_fma_f32 v[230:231], v[94:95], v[126:127], v[230:231]
    v_pk_fma_f32 v[228:229], v[96:97], v[128:129], v[228:229]
    v_pk_fma_f32 v[230:231], v[98:99], v[130:131], v[230:231]
    v_mfma_f32_32x32x16_bf16 v[140:155], v[8:11], v[180:183], v[140:155]
    v_exp_f32 v220, v164
    v_exp_f32 v221, v165
    v_exp_f32 v222, v166
    v_exp_f32 v223, v167
    v_mfma_f32_32x32x16_bf16 v[140:155], v[12:15], v[184:187], v[140:155]
    v_exp_f32 v224, v168
    v_exp_f32 v225, v169
    v_exp_f32 v226, v170
    v_exp_f32 v227, v171
    v_pk_add_f32 v[220:221], v[220:221], 1.0 op_sel_hi:[1,0]
    v_pk_add_f32 v[222:223], v[222:223], 1.0 op_sel_hi:[1,0]
    v_pk_add_f32 v[224:225], v[224:225], 1.0 op_sel_hi:[1,0]
    v_pk_add_f32 v[226:227], v[226:227], 1.0 op_sel_hi:[1,0]
    v_rcp_f32 v220, v220
    v_rcp_f32 v221, v221
    v_rcp_f32 v222, v222
    v_rcp_f32 v223, v223
    v_rcp_f32 v224, v224
    v_rcp_f32 v225, v225
    v_rcp_f32 v226, v226
    v_rcp_f32 v227, v227
    v_pk_fma_f32 v[100:101], v[164:165], v[220:221], v[100:101]
    v_pk_fma_f32 v[102:103], v[166:167], v[222:223], v[102:103]
    v_pk_fma_f32 v[104:105], v[168:169], v[224:225], v[104:105]
    v_pk_fma_f32 v[106:107], v[170:171], v[226:227], v[106:107]
    v_pk_fma_f32 v[228:229], v[100:101], v[132:133], v[228:229]
    v_pk_fma_f32 v[230:231], v[102:103], v[134:135], v[230:231]
    v_pk_fma_f32 v[228:229], v[104:105], v[136:137], v[228:229]
    v_pk_fma_f32 v[230:231], v[106:107], v[138:139], v[230:231]
    v_pk_add_f32 v[228:229], v[228:229], v[230:231]
    s_cmp_eq_u64 s[34:35], 0
    v_add_f32 v243, v228, v229
    v_sub_f32 v248, v243, v247
    v_pk_fma_f32 v[244:245], v[232:233], v[248:249], v[244:245] op_sel_hi:[1,0,1]
    v_fmac_f32 v246, v234, v248
    s_mov_b64 exec, -1
    s_cbranch_scc1 K2_DONE
    v_mfma_f32_32x32x8_bf16 v[156:171], v[42:43], v[208:209], v[60:75]
    s_mov_b64 exec, s[34:35]
    v_exp_f32 v220, v140
    v_exp_f32 v221, v141
    v_exp_f32 v222, v142
    v_exp_f32 v223, v143
    v_mfma_f32_32x32x16_bf16 v[156:171], v[36:39], v[188:191], v[156:171]
    v_exp_f32 v224, v144
    v_exp_f32 v225, v145
    s_bitcmp1_b32 s5, 2
    s_cbranch_scc0 K2_VP7
    s_setprio 1
K2_VP7:
    s_waitcnt lgkmcnt(0)
    s_mov_b64 exec, -1
    s_add_u32 m0, s94, 32768
    s_nop 0
    buffer_load_dwordx4 v[210:211], s[8:11], 0 idxen offen lds
    s_add_u32 m0, s94, 33792
    s_nop 0
    buffer_load_dwordx4 v[212:213], s[8:11], 0 idxen offen lds
    s_add_u32 m0, s94, 34816
    s_nop 0
    buffer_load_dwordx4 v[214:215], s[8:11], 0 idxen offen lds
    s_add_u32 m0, s94, 35840
    s_nop 0
    buffer_load_dwordx4 v[216:217], s[8:11], 0 idxen offen lds
    s_mov_b64 exec, s[34:35]
    s_setprio 0
    v_exp_f32 v226, v146
    v_exp_f32 v227, v147
    v_pk_add_f32 v[220:221], v[220:221], 1.0 op_sel_hi:[1,0]
    v_pk_add_f32 v[222:223], v[222:223], 1.0 op_sel_hi:[1,0]
    v_pk_add_f32 v[224:225], v[224:225], 1.0 op_sel_hi:[1,0]
    v_pk_add_f32 v[226:227], v[226:227], 1.0 op_sel_hi:[1,0]
    v_mfma_f32_32x32x16_bf16 v[156:171], v[16:19], v[172:175], v[156:171]
    v_rcp_f32 v220, v220
    v_rcp_f32 v221, v221
    v_rcp_f32 v222, v222
    v_rcp_f32 v223, v223
    v_mfma_f32_32x32x16_bf16 v[156:171], v[20:23], v[176:179], v[156:171]
    v_rcp_f32 v224, v224
    v_rcp_f32 v225, v225
    v_rcp_f32 v226, v226
    v_rcp_f32 v227, v227
    v_pk_fma_f32 v[76:77], v[140:141], v[220:221], v[76:77]
    v_pk_fma_f32 v[78:79], v[142:143], v[222:223], v[78:79]
    v_pk_fma_f32 v[80:81], v[144:145], v[224:225], v[80:81]
    v_pk_fma_f32 v[82:83], v[146:147], v[226:227], v[82:83]
    v_pk_mul_f32 v[228:229], v[76:77], v[108:109]
    v_pk_mul_f32 v[230:231], v[78:79], v[110:111]
    v_pk_fma_f32 v[228:229], v[80:81], v[112:113], v[228:229]
    v_pk_fma_f32 v[230:231], v[82:83], v[114:115], v[230:231]
    v_mfma_f32_32x32x16_bf16 v[156:171], v[24:27], v[180:183], v[156:171]
    v_exp_f32 v220, v148
    v_exp_f32 v221, v149
    v_exp_f32 v222, v150
    v_exp_f32 v223, v151
    v_mfma_f32_32x32x16_bf16 v[156:171], v[28:31], v[184:187], v[156:171]
    v_exp_f32 v224, v152
    v_exp_f32 v225, v153
    v_exp_f32 v226, v154
    buffer_load_dwordx4 v[196:199], v[218:219], s[12:15], 0 idxen offen
    buffer_load_dwordx2 v[204:205], v203, s[16:19], 0 idxen
    v_exp_f32 v227, v155
    s_waitcnt vmcnt(6)
    ds_read_b128 v[172:175], v251 offset:0
    ds_read_b128 v[176:179], v252 offset:0
    ds_read_b128 v[180:183], v253 offset:0
    ds_read_b128 v[184:187], v254 offset:0
    v_cmp_lt_u32_e64 s[28:29], s6, v235
    s_add_u32 s6, s6, 1
    v_lshlrev_b32 v232, 16, v200
    v_and_b32 v233, 0xffff0000, v200
    v_sub_f32 v234, v242, v201
    v_pk_add_f32 v[232:233], v[240:241], v[232:233] neg_lo:[0,1] neg_hi:[0,1]
    v_mul_f32 v208, v232, v232
    v_fmac_f32 v208, v233, v233
    v_fmac_f32 v208, v234, v234
    v_cvt_pk_bf16_f32 v208, v208, v208
    v_cndmask_b32_e64 v203, 0, v207, s[28:29]
    v_add_u32 v207, v207, v206
    ds_read_b32 v218, v203
    ds_read_u16 v203, v203 offset:4
    v_pk_add_f32 v[220:221], v[220:221], 1.0 op_sel_hi:[1,0]
    v_pk_add_f32 v[222:223], v[222:223], 1.0 op_sel_hi:[1,0]
    v_pk_add_f32 v[224:225], v[224:225], 1.0 op_sel_hi:[1,0]
    v_pk_add_f32 v[226:227], v[226:227], 1.0 op_sel_hi:[1,0]
    v_rcp_f32 v220, v220
    v_rcp_f32 v221, v221
    v_rcp_f32 v222, v222
    v_rcp_f32 v223, v223
    v_rcp_f32 v224, v224
    v_rcp_f32 v225, v225
    v_rcp_f32 v226, v226
    v_rcp_f32 v227, v227
    s_waitcnt lgkmcnt(0)
    s_mov_b64 exec, -1
    ds_bpermute_b32 v210, v239, v203 offset:0
    ds_bpermute_b32 v212, v239, v203 offset:32
    ds_bpermute_b32 v214, v239, v203 offset:64
    ds_bpermute_b32 v216, v239, v203 offset:96
    s_mov_b64 exec, s[34:35]
    v_pk_fma_f32 v[84:85], v[148:149], v[220:221], v[84:85]
    v_pk_fma_f32 v[86:87], v[150:151], v[222:223], v[86:87]
    v_pk_fma_f32 v[88:89], v[152:153], v[224:225], v[88:89]
    v_pk_fma_f32 v[90:91], v[154:155], v[226:227], v[90:91]
    v_pk_fma_f32 v[228:229], v[84:85], v[116:117], v[228:229]
    v_pk_fma_f32 v[230:231], v[86:87], v[118:119], v[230:231]
    v_pk_fma_f32 v[228:229], v[88:89], v[120:121], v[228:229]
    v_pk_fma_f32 v[230:231], v[90:91], v[122:123], v[230:231]
    v_mfma_f32_32x32x8_bf16 v[140:155], v[40:41], v[208:209], v[44:59]
    v_exp_f32 v220, v156
    v_exp_f32 v221, v157
    v_exp_f32 v222, v158
    v_exp_f32 v223, v159
    v_mfma_f32_32x32x16_bf16 v[140:155], v[32:35], v[192:195], v[140:155]
    v_exp_f32 v224, v160
    v_exp_f32 v225, v161
    v_exp_f32 v226, v162
    v_exp_f32 v227, v163
    v_pk_add_f32 v[220:221], v[220:221], 1.0 op_sel_hi:[1,0]
    v_pk_add_f32 v[222:223], v[222:223], 1.0 op_sel_hi:[1,0]
    v_pk_add_f32 v[224:225], v[224:225], 1.0 op_sel_hi:[1,0]
    v_pk_add_f32 v[226:227], v[226:227], 1.0 op_sel_hi:[1,0]
    v_mfma_f32_32x32x16_bf16 v[140:155], v[0:3], v[172:175], v[140:155]
    v_rcp_f32 v220, v220
    v_rcp_f32 v221, v221
    v_rcp_f32 v222, v222
    v_rcp_f32 v223, v223
    v_mfma_f32_32x32x16_bf16 v[140:155], v[4:7], v[176:179], v[140:155]
    v_rcp_f32 v224, v224
    v_rcp_f32 v225, v225
    v_rcp_f32 v226, v226
    v_rcp_f32 v227, v227
    v_pk_fma_f32 v[92:93], v[156:157], v[220:221], v[92:93]
    v_pk_fma_f32 v[94:95], v[158:159], v[222:223], v[94:95]
    v_pk_fma_f32 v[96:97], v[160:161], v[224:225], v[96:97]
    v_pk_fma_f32 v[98:99], v[162:163], v[226:227], v[98:99]
    v_pk_fma_f32 v[228:229], v[92:93], v[124:125], v[228:229]
    v_pk_fma_f32 v[230:231], v[94:95], v[126:127], v[230:231]
    v_pk_fma_f32 v[228:229], v[96:97], v[128:129], v[228:229]
    v_pk_fma_f32 v[230:231], v[98:99], v[130:131], v[230:231]
    v_mfma_f32_32x32x16_bf16 v[140:155], v[8:11], v[180:183], v[140:155]
    v_exp_f32 v220, v164
    v_exp_f32 v221, v165
    v_exp_f32 v222, v166
    v_exp_f32 v223, v167
    v_mfma_f32_32x32x16_bf16 v[140:155], v[12:15], v[184:187], v[140:155]
    v_exp_f32 v224, v168
    v_exp_f32 v225, v169
    v_exp_f32 v226, v170
    v_exp_f32 v227, v171
    v_pk_add_f32 v[220:221], v[220:221], 1.0 op_sel_hi:[1,0]
    v_pk_add_f32 v[222:223], v[222:223], 1.0 op_sel_hi:[1,0]
    v_pk_add_f32 v[224:225], v[224:225], 1.0 op_sel_hi:[1,0]
    v_pk_add_f32 v[226:227], v[226:227], 1.0 op_sel_hi:[1,0]
    v_rcp_f32 v220, v220
    v_rcp_f32 v221, v221
    v_rcp_f32 v222, v222
    v_rcp_f32 v223, v223
    v_rcp_f32 v224, v224
    v_rcp_f32 v225, v225
    v_rcp_f32 v226, v226
    v_rcp_f32 v227, v227
    v_pk_fma_f32 v[100:101], v[164:165], v[220:221], v[100:101]
    v_pk_fma_f32 v[102:103], v[166:167], v[222:223], v[102:103]
    v_pk_fma_f32 v[104:105], v[168:169], v[224:225], v[104:105]
    v_pk_fma_f32 v[106:107], v[170:171], v[226:227], v[106:107]
    v_pk_fma_f32 v[228:229], v[100:101], v[132:133], v[228:229]
    v_pk_fma_f32 v[230:231], v[102:103], v[134:135], v[230:231]
    v_pk_fma_f32 v[228:229], v[104:105], v[136:137], v[228:229]
    v_pk_fma_f32 v[230:231], v[106:107], v[138:139], v[230:231]
    v_pk_add_f32 v[228:229], v[228:229], v[230:231]
    s_cmp_eq_u64 s[36:37], 0
    v_add_f32 v247, v228, v229
    v_sub_f32 v248, v247, v243
    v_pk_fma_f32 v[244:245], v[236:237], v[248:249], v[244:245] op_sel_hi:[1,0,1]
    v_fmac_f32 v246, v238, v248
    s_mov_b64 exec, -1
    s_cbranch_scc1 K2_DONE
    v_mfma_f32_32x32x8_bf16 v[156:171], v[42:43], v[208:209], v[60:75]
    s_mov_b64 exec, s[36:37]
    v_exp_f32 v220, v140
    v_exp_f32 v221, v141
    v_exp_f32 v222, v142
    v_exp_f32 v223, v143
    v_mfma_f32_32x32x16_bf16 v[156:171], v[36:39], v[192:195], v[156:171]
    v_exp_f32 v224, v144
    v_exp_f32 v225, v145
    s_bitcmp1_b32 s5, 2
    s_cbranch_scc0 K2_VP9
    s_setprio 1
K2_VP9:
    s_waitcnt lgkmcnt(0)
    s_mov_b64 exec, -1
    s_add_u32 m0, s94, 0
    s_nop 0
    buffer_load_dwordx4 v[210:211], s[8:11], 0 idxen offen lds
    s_add_u32 m0, s94, 1024
    s_nop 0
    buffer_load_dwordx4 v[212:213], s[8:11], 0 idxen offen lds
    s_add_u32 m0, s94, 2048
    s_nop 0
    buffer_load_dwordx4 v[214:215], s[8:11], 0 idxen offen lds
    s_add_u32 m0, s94, 3072
    s_nop 0
    buffer_load_dwordx4 v[216:217], s[8:11], 0 idxen offen lds
    s_mov_b64 exec, s[36:37]
    s_setprio 0
    v_exp_f32 v226, v146
    v_exp_f32 v227, v147
    v_pk_add_f32 v[220:221], v[220:221], 1.0 op_sel_hi:[1,0]
    v_pk_add_f32 v[222:223], v[222:223], 1.0 op_sel_hi:[1,0]
    v_pk_add_f32 v[224:225], v[224:225], 1.0 op_sel_hi:[1,0]
    v_pk_add_f32 v[226:227], v[226:227], 1.0 op_sel_hi:[1,0]
    v_mfma_f32_32x32x16_bf16 v[156:171], v[16:19], v[172:175], v[156:171]
    v_rcp_f32 v220, v220
    v_rcp_f32 v221, v221
    v_rcp_f32 v222, v222
    v_rcp_f32 v223, v223
    v_mfma_f32_32x32x16_bf16 v[156:171], v[20:23], v[176:179], v[156:171]
    v_rcp_f32 v224, v224
    v_rcp_f32 v225, v225
    v_rcp_f32 v226, v226
    v_rcp_f32 v227, v227
    v_pk_fma_f32 v[76:77], v[140:141], v[220:221], v[76:77]
    v_pk_fma_f32 v[78:79], v[142:143], v[222:223], v[78:79]
    v_pk_fma_f32 v[80:81], v[144:145], v[224:225], v[80:81]
    v_pk_fma_f32 v[82:83], v[146:147], v[226:227], v[82:83]
    v_pk_mul_f32 v[228:229], v[76:77], v[108:109]
    v_pk_mul_f32 v[230:231], v[78:79], v[110:111]
    v_pk_fma_f32 v[228:229], v[80:81], v[112:113], v[228:229]
    v_pk_fma_f32 v[230:231], v[82:83], v[114:115], v[230:231]
    v_mfma_f32_32x32x16_bf16 v[156:171], v[24:27], v[180:183], v[156:171]
    v_exp_f32 v220, v148
    v_exp_f32 v221, v149
    v_exp_f32 v222, v150
    v_exp_f32 v223, v151
    v_mfma_f32_32x32x16_bf16 v[156:171], v[28:31], v[184:187], v[156:171]
    v_exp_f32 v224, v152
    v_exp_f32 v225, v153
    v_exp_f32 v226, v154
    buffer_load_dwordx4 v[188:191], v[218:219], s[12:15], 0 idxen offen
    buffer_load_dwordx2 v[200:201], v203, s[16:19], 0 idxen
    v_exp_f32 v227, v155
    s_waitcnt vmcnt(6)
    ds_read_b128 v[172:175], v251 offset:32768
    ds_read_b128 v[176:179], v252 offset:32768
    ds_read_b128 v[180:183], v253 offset:32768
    ds_read_b128 v[184:187], v254 offset:32768
    v_cmp_lt_u32_e64 s[30:31], s6, v235
    s_add_u32 s6, s6, 1
    v_lshlrev_b32 v236, 16, v204
    v_and_b32 v237, 0xffff0000, v204
    v_sub_f32 v238, v242, v205
    v_pk_add_f32 v[236:237], v[240:241], v[236:237] neg_lo:[0,1] neg_hi:[0,1]
    v_mul_f32 v208, v236, v236
    v_fmac_f32 v208, v237, v237
    v_fmac_f32 v208, v238, v238
    v_cvt_pk_bf16_f32 v208, v208, v208
    v_cndmask_b32_e64 v203, 0, v207, s[30:31]
    v_add_u32 v207, v207, v206
    ds_read_b32 v218, v203
    ds_read_u16 v203, v203 offset:4
    v_pk_add_f32 v[220:221], v[220:221], 1.0 op_sel_hi:[1,0]
    v_pk_add_f32 v[222:223], v[222:223], 1.0 op_sel_hi:[1,0]
    v_pk_add_f32 v[224:225], v[224:225], 1.0 op_sel_hi:[1,0]
    v_pk_add_f32 v[226:227], v[226:227], 1.0 op_sel_hi:[1,0]
    v_rcp_f32 v220, v220
    v_rcp_f32 v221, v221
    v_rcp_f32 v222, v222
    v_rcp_f32 v223, v223
    v_rcp_f32 v224, v224
    v_rcp_f32 v225, v225
    v_rcp_f32 v226, v226
    v_rcp_f32 v227, v227
    s_waitcnt lgkmcnt(0)
    s_mov_b64 exec, -1
    ds_bpermute_b32 v210, v239, v203 offset:0
    ds_bpermute_b32 v212, v239, v203 offset:32
    ds_bpermute_b32 v214, v239, v203 offset:64
    ds_bpermute_b32 v216, v239, v203 offset:96
    s_mov_b64 exec, s[36:37]
    v_pk_fma_f32 v[84:85], v[148:149], v[220:221], v[84:85]
    v_pk_fma_f32 v[86:87], v[150:151], v[222:223], v[86:87]
    v_pk_fma_f32 v[88:89], v[152:153], v[224:225], v[88:89]
    v_pk_fma_f32 v[90:91], v[154:155], v[226:227], v[90:91]
    v_pk_fma_f32 v[228:229], v[84:85], v[116:117], v[228:229]
    v_pk_fma_f32 v[230:231], v[86:87], v[118:119], v[230:231]
    v_pk_fma_f32 v[228:229], v[88:89], v[120:121], v[228:229]
    v_pk_fma_f32 v[230:231], v[90:91], v[122:123], v[230:231]
    v_mfma_f32_32x32x8_bf16 v[140:155], v[40:41], v[208:209], v[44:59]
    v_exp_f32 v220, v156
    v_exp_f32 v221, v157
    v_exp_f32 v222, v158
    v_exp_f32 v223, v159
    v_mfma_f32_32x32x16_bf16 v[140:155], v[32:35], v[196:199], v[140:155]
    v_exp_f32 v224, v160
    v_exp_f32 v225, v161
    v_exp_f32 v226, v162
    v_exp_f32 v227, v163
    v_pk_add_f32 v[220:221], v[220:221], 1.0 op_sel_hi:[1,0]
    v_pk_add_f32 v[222:223], v[222:223], 1.0 op_sel_hi:[1,0]
    v_pk_add_f32 v[224:225], v[224:225], 1.0 op_sel_hi:[1,0]
    v_pk_add_f32 v[226:227], v[226:227], 1.0 op_sel_hi:[1,0]
    v_mfma_f32_32x32x16_bf16 v[140:155], v[0:3], v[172:175], v[140:155]
    v_rcp_f32 v220, v220
    v_rcp_f32 v221, v221
    v_rcp_f32 v222, v222
    v_rcp_f32 v223, v223
    v_mfma_f32_32x32x16_bf16 v[140:155], v[4:7], v[176:179], v[140:155]
    v_rcp_f32 v224, v224
    v_rcp_f32 v225, v225
    v_rcp_f32 v226, v226
    v_rcp_f32 v227, v227
    v_pk_fma_f32 v[92:93], v[156:157], v[220:221], v[92:93]
    v_pk_fma_f32 v[94:95], v[158:159], v[222:223], v[94:95]
    v_pk_fma_f32 v[96:97], v[160:161], v[224:225], v[96:97]
    v_pk_fma_f32 v[98:99], v[162:163], v[226:227], v[98:99]
    v_pk_fma_f32 v[228:229], v[92:93], v[124:125], v[228:229]
    v_pk_fma_f32 v[230:231], v[94:95], v[126:127], v[230:231]
    v_pk_fma_f32 v[228:229], v[96:97], v[128:129], v[228:229]
    v_pk_fma_f32 v[230:231], v[98:99], v[130:131], v[230:231]
    v_mfma_f32_32x32x16_bf16 v[140:155], v[8:11], v[180:183], v[140:155]
    v_exp_f32 v220, v164
    v_exp_f32 v221, v165
    v_exp_f32 v222, v166
    v_exp_f32 v223, v167
    v_mfma_f32_32x32x16_bf16 v[140:155], v[12:15], v[184:187], v[140:155]
    v_exp_f32 v224, v168
    v_exp_f32 v225, v169
    v_exp_f32 v226, v170
    v_exp_f32 v227, v171
    v_pk_add_f32 v[220:221], v[220:221], 1.0 op_sel_hi:[1,0]
    v_pk_add_f32 v[222:223], v[222:223], 1.0 op_sel_hi:[1,0]
    v_pk_add_f32 v[224:225], v[224:225], 1.0 op_sel_hi:[1,0]
    v_pk_add_f32 v[226:227], v[226:227], 1.0 op_sel_hi:[1,0]
    v_rcp_f32 v220, v220
    v_rcp_f32 v221, v221
    v_rcp_f32 v222, v222
    v_rcp_f32 v223, v223
    v_rcp_f32 v224, v224
    v_rcp_f32 v225, v225
    v_rcp_f32 v226, v226
    v_rcp_f32 v227, v227
    v_pk_fma_f32 v[100:101], v[164:165], v[220:221], v[100:101]
    v_pk_fma_f32 v[102:103], v[166:167], v[222:223], v[102:103]
    v_pk_fma_f32 v[104:105], v[168:169], v[224:225], v[104:105]
    v_pk_fma_f32 v[106:107], v[170:171], v[226:227], v[106:107]
    v_pk_fma_f32 v[228:229], v[100:101], v[132:133], v[228:229]
    v_pk_fma_f32 v[230:231], v[102:103], v[134:135], v[230:231]
    v_pk_fma_f32 v[228:229], v[104:105], v[136:137], v[228:229]
    v_pk_fma_f32 v[230:231], v[106:107], v[138:139], v[230:231]
    v_pk_add_f32 v[228:229], v[228:229], v[230:231]
    s_cmp_eq_u64 s[38:39], 0
    v_add_f32 v243, v228, v229
    v_sub_f32 v248, v243, v247
    v_pk_fma_f32 v[244:245], v[232:233], v[248:249], v[244:245] op_sel_hi:[1,0,1]
    v_fmac_f32 v246, v234, v248
    s_mov_b64 exec, -1
    s_cbranch_scc1 K2_DONE
    v_mfma_f32_32x32x8_bf16 v[156:171], v[42:43], v[208:209], v[60:75]
    s_mov_b64 exec, s[38:39]
    v_exp_f32 v220, v140
    v_exp_f32 v221, v141
    v_exp_f32 v222, v142
    v_exp_f32 v223, v143
    v_mfma_f32_32x32x16_bf16 v[156:171], v[36:39], v[196:199], v[156:171]
    v_exp_f32 v224, v144
    v_exp_f32 v225, v145
    s_bitcmp1_b32 s5, 2
    s_cbranch_scc0 K2_VP11
    s_setprio 1
K2_VP11:
    s_waitcnt lgkmcnt(0)
    s_mov_b64 exec, -1
    s_add_u32 m0, s94, 32768
    s_nop 0
    buffer_load_dwordx4 v[210:211], s[8:11], 0 idxen offen lds
    s_add_u32 m0, s94, 33792
    s_nop 0
    buffer_load_dwordx4 v[212:213], s[8:11], 0 idxen offen lds
    s_add_u32 m0, s94, 34816
    s_nop 0
    buffer_load_dwordx4 v[214:215], s[8:11], 0 idxen offen lds
    s_add_u32 m0, s94, 35840
    s_nop 0
    buffer_load_dwordx4 v[216:217], s[8:11], 0 idxen offen lds
    s_mov_b64 exec, s[38:39]
    s_setprio 0
    v_exp_f32 v226, v146
    v_exp_f32 v227, v147
    v_pk_add_f32 v[220:221], v[220:221], 1.0 op_sel_hi:[1,0]
    v_pk_add_f32 v[222:223], v[222:223], 1.0 op_sel_hi:[1,0]
    v_pk_add_f32 v[224:225], v[224:225], 1.0 op_sel_hi:[1,0]
    v_pk_add_f32 v[226:227], v[226:227], 1.0 op_sel_hi:[1,0]
    v_mfma_f32_32x32x16_bf16 v[156:171], v[16:19], v[172:175], v[156:171]
    v_rcp_f32 v220, v220
    v_rcp_f32 v221, v221
    v_rcp_f32 v222, v222
    v_rcp_f32 v223, v223
    v_mfma_f32_32x32x16_bf16 v[156:171], v[20:23], v[176:179], v[156:171]
    v_rcp_f32 v224, v224
    v_rcp_f32 v225, v225
    v_rcp_f32 v226, v226
    v_rcp_f32 v227, v227
    v_pk_fma_f32 v[76:77], v[140:141], v[220:221], v[76:77]
    v_pk_fma_f32 v[78:79], v[142:143], v[222:223], v[78:79]
    v_pk_fma_f32 v[80:81], v[144:145], v[224:225], v[80:81]
    v_pk_fma_f32 v[82:83], v[146:147], v[226:227], v[82:83]
    v_pk_mul_f32 v[228:229], v[76:77], v[108:109]
    v_pk_mul_f32 v[230:231], v[78:79], v[110:111]
    v_pk_fma_f32 v[228:229], v[80:81], v[112:113], v[228:229]
    v_pk_fma_f32 v[230:231], v[82:83], v[114:115], v[230:231]
    v_mfma_f32_32x32x16_bf16 v[156:171], v[24:27], v[180:183], v[156:171]
    v_exp_f32 v220, v148
    v_exp_f32 v221, v149
    v_exp_f32 v222, v150
    v_exp_f32 v223, v151
    v_mfma_f32_32x32x16_bf16 v[156:171], v[28:31], v[184:187], v[156:171]
    v_exp_f32 v224, v152
    v_exp_f32 v225, v153
    v_exp_f32 v226, v154
    buffer_load_dwordx4 v[192:195], v[218:219], s[12:15], 0 idxen offen
    buffer_load_dwordx2 v[204:205], v203, s[16:19], 0 idxen
    v_exp_f32 v227, v155
    s_waitcnt vmcnt(6)
    ds_read_b128 v[172:175], v251 offset:0
    ds_read_b128 v[176:179], v252 offset:0
    ds_read_b128 v[180:183], v253 offset:0
    ds_read_b128 v[184:187], v254 offset:0
    v_cmp_lt_u32_e64 s[32:33], s6, v235
    s_add_u32 s6, s6, 1
    v_lshlrev_b32 v232, 16, v200
    v_and_b32 v233, 0xffff0000, v200
    v_sub_f32 v234, v242, v201
    v_pk_add_f32 v[232:233], v[240:241], v[232:233] neg_lo:[0,1] neg_hi:[0,1]
    v_mul_f32 v208, v232, v232
    v_fmac_f32 v208, v233, v233
    v_fmac_f32 v208, v234, v234
    v_cvt_pk_bf16_f32 v208, v208, v208
    v_cndmask_b32_e64 v203, 0, v207, s[32:33]
    v_add_u32 v207, v207, v206
    ds_read_b32 v218, v203
    ds_read_u16 v203, v203 offset:4
    v_pk_add_f32 v[220:221], v[220:221], 1.0 op_sel_hi:[1,0]
    v_pk_add_f32 v[222:223], v[222:223], 1.0 op_sel_hi:[1,0]
    v_pk_add_f32 v[224:225], v[224:225], 1.0 op_sel_hi:[1,0]
    v_pk_add_f32 v[226:227], v[226:227], 1.0 op_sel_hi:[1,0]
    v_rcp_f32 v220, v220
    v_rcp_f32 v221, v221
    v_rcp_f32 v222, v222
    v_rcp_f32 v223, v223
    v_rcp_f32 v224, v224
    v_rcp_f32 v225, v225
    v_rcp_f32 v226, v226
    v_rcp_f32 v227, v227
    s_waitcnt lgkmcnt(0)
    s_mov_b64 exec, -1
    ds_bpermute_b32 v210, v239, v203 offset:0
    ds_bpermute_b32 v212, v239, v203 offset:32
    ds_bpermute_b32 v214, v239, v203 offset:64
    ds_bpermute_b32 v216, v239, v203 offset:96
    s_mov_b64 exec, s[38:39]
    v_pk_fma_f32 v[84:85], v[148:149], v[220:221], v[84:85]
    v_pk_fma_f32 v[86:87], v[150:151], v[222:223], v[86:87]
    v_pk_fma_f32 v[88:89], v[152:153], v[224:225], v[88:89]
    v_pk_fma_f32 v[90:91], v[154:155], v[226:227], v[90:91]
    v_pk_fma_f32 v[228:229], v[84:85], v[116:117], v[228:229]
    v_pk_fma_f32 v[230:231], v[86:87], v[118:119], v[230:231]
    v_pk_fma_f32 v[228:229], v[88:89], v[120:121], v[228:229]
    v_pk_fma_f32 v[230:231], v[90:91], v[122:123], v[230:231]
    v_mfma_f32_32x32x8_bf16 v[140:155], v[40:41], v[208:209], v[44:59]
    v_exp_f32 v220, v156
    v_exp_f32 v221, v157
    v_exp_f32 v222, v158
    v_exp_f32 v223, v159
    v_mfma_f32_32x32x16_bf16 v[140:155], v[32:35], v[188:191], v[140:155]
    v_exp_f32 v224, v160
    v_exp_f32 v225, v161
    v_exp_f32 v226, v162
    v_exp_f32 v227, v163
    v_pk_add_f32 v[220:221], v[220:221], 1.0 op_sel_hi:[1,0]
    v_pk_add_f32 v[222:223], v[222:223], 1.0 op_sel_hi:[1,0]
    v_pk_add_f32 v[224:225], v[224:225], 1.0 op_sel_hi:[1,0]
    v_pk_add_f32 v[226:227], v[226:227], 1.0 op_sel_hi:[1,0]
    v_mfma_f32_32x32x16_bf16 v[140:155], v[0:3], v[172:175], v[140:155]
    v_rcp_f32 v220, v220
    v_rcp_f32 v221, v221
    v_rcp_f32 v222, v222
    v_rcp_f32 v223, v223
    v_mfma_f32_32x32x16_bf16 v[140:155], v[4:7], v[176:179], v[140:155]
    v_rcp_f32 v224, v224
    v_rcp_f32 v225, v225
    v_rcp_f32 v226, v226
    v_rcp_f32 v227, v227
    v_pk_fma_f32 v[92:93], v[156:157], v[220:221], v[92:93]
    v_pk_fma_f32 v[94:95], v[158:159], v[222:223], v[94:95]
    v_pk_fma_f32 v[96:97], v[160:161], v[224:225], v[96:97]
    v_pk_fma_f32 v[98:99], v[162:163], v[226:227], v[98:99]
    v_pk_fma_f32 v[228:229], v[92:93], v[124:125], v[228:229]
    v_pk_fma_f32 v[230:231], v[94:95], v[126:127], v[230:231]
    v_pk_fma_f32 v[228:229], v[96:97], v[128:129], v[228:229]
    v_pk_fma_f32 v[230:231], v[98:99], v[130:131], v[230:231]
    v_mfma_f32_32x32x16_bf16 v[140:155], v[8:11], v[180:183], v[140:155]
    v_exp_f32 v220, v164
    v_exp_f32 v221, v165
    v_exp_f32 v222, v166
    v_exp_f32 v223, v167
    v_mfma_f32_32x32x16_bf16 v[140:155], v[12:15], v[184:187], v[140:155]
    v_exp_f32 v224, v168
    v_exp_f32 v225, v169
    v_exp_f32 v226, v170
    v_exp_f32 v227, v171
    v_pk_add_f32 v[220:221], v[220:221], 1.0 op_sel_hi:[1,0]
    v_pk_add_f32 v[222:223], v[222:223], 1.0 op_sel_hi:[1,0]
    v_pk_add_f32 v[224:225], v[224:225], 1.0 op_sel_hi:[1,0]
    v_pk_add_f32 v[226:227], v[226:227], 1.0 op_sel_hi:[1,0]
    v_rcp_f32 v220, v220
    v_rcp_f32 v221, v221
    v_rcp_f32 v222, v222
    v_rcp_f32 v223, v223
    v_rcp_f32 v224, v224
    v_rcp_f32 v225, v225
    v_rcp_f32 v226, v226
    v_rcp_f32 v227, v227
    v_pk_fma_f32 v[100:101], v[164:165], v[220:221], v[100:101]
    v_pk_fma_f32 v[102:103], v[166:167], v[222:223], v[102:103]
    v_pk_fma_f32 v[104:105], v[168:169], v[224:225], v[104:105]
    v_pk_fma_f32 v[106:107], v[170:171], v[226:227], v[106:107]
    v_pk_fma_f32 v[228:229], v[100:101], v[132:133], v[228:229]
    v_pk_fma_f32 v[230:231], v[102:103], v[134:135], v[230:231]
    v_pk_fma_f32 v[228:229], v[104:105], v[136:137], v[228:229]
    v_pk_fma_f32 v[230:231], v[106:107], v[138:139], v[230:231]
    v_pk_add_f32 v[228:229], v[228:229], v[230:231]
    s_cmp_eq_u64 s[28:29], 0
    v_add_f32 v247, v228, v229
    v_sub_f32 v248, v247, v243
    v_pk_fma_f32 v[244:245], v[236:237], v[248:249], v[244:245] op_sel_hi:[1,0,1]
    v_fmac_f32 v246, v238, v248
    s_mov_b64 exec, -1
    s_cbranch_scc0 K2_LOOP
K2_DONE:
    v_and_b32 v203, 63, v250
    s_or_b32 s95, s7, s93
    s_cselect_b32 s97, 3, s97
    s_cmp_gt_u32 s97, 2
    v_lshlrev_b32 v203, 4, v203
    s_cbranch_scc1 K2_SLOW
    v_bfe_u32 v220, v249, 1, 3
    v_lshlrev_b32 v220, 4, v220
    v_lshlrev_b32 v221, 2, v219
    v_xor_b32 v220, v220, v221
    v_lshl_add_u32 v220, v249, 7, v220
    v_add_u32 v220, 100352, v220
    v_xor_b32 v221, 16, v220
    v_xor_b32 v222, 32, v220
    v_xor_b32 v223, 48, v220
    ds_read_b128 v[172:175], v220
    ds_read_b128 v[176:179], v221
    ds_read_b128 v[180:183], v222
    ds_read_b128 v[184:187], v223
    v_add_u32 v220, 125952, v203
    v_cmp_eq_u32_e64 s[46:47], 16, v206
    v_cmp_eq_u32_e64 s[44:45], 8, v206
    v_add_u32 v218, s4, v249
    ds_read_b128 v[0:3], v220 offset:32768
    ds_read_b128 v[4:7], v220 offset:33792
    ds_read_b128 v[8:11], v220 offset:34816
    ds_read_b128 v[12:15], v220 offset:35840
    ds_read_b128 v[16:19], v220 offset:0
    ds_read_b128 v[20:23], v220 offset:1024
    ds_read_b128 v[24:27], v220 offset:2048
    ds_read_b128 v[28:31], v220 offset:3072
    ds_read_b128 v[44:47], v220 offset:4096
    ds_read_b128 v[48:51], v220 offset:5120
    ds_read_b128 v[52:55], v220 offset:6144
    ds_read_b128 v[56:59], v220 offset:7168
    ds_read_b128 v[60:63], v220 offset:8192
    ds_read_b128 v[64:67], v220 offset:9216
    ds_read_b128 v[68:71], v220 offset:10240
    ds_read_b128 v[72:75], v220 offset:11264
    s_mov_b64 exec, s[46:47]
    s_and_b32 s46, s46, 0x55555555
    s_or_b32 s44, s44, s46
    s_mov_b32 s98, s94
    v_add_f32_dpp v244, v244, v244 quad_perm:[1,0,3,2] row_mask:0xf bank_mask:0xf
    v_add_f32_dpp v245, v245, v245 quad_perm:[1,0,3,2] row_mask:0xf bank_mask:0xf
    v_add_f32_dpp v246, v246, v246 quad_perm:[1,0,3,2] row_mask:0xf bank_mask:0xf
    v_add_f32_dpp v76, v76, v76 quad_perm:[1,0,3,2] row_mask:0xf bank_mask:0xf
    v_add_f32_dpp v77, v77, v77 quad_perm:[1,0,3,2] row_mask:0xf bank_mask:0xf
    v_add_f32_dpp v78, v78, v78 quad_perm:[1,0,3,2] row_mask:0xf bank_mask:0xf
    v_add_f32_dpp v79, v79, v79 quad_perm:[1,0,3,2] row_mask:0xf bank_mask:0xf
    v_add_f32_dpp v80, v80, v80 quad_perm:[1,0,3,2] row_mask:0xf bank_mask:0xf
    v_add_f32_dpp v81, v81, v81 quad_perm:[1,0,3,2] row_mask:0xf bank_mask:0xf
    v_add_f32_dpp v82, v82, v82 quad_perm:[1,0,3,2] row_mask:0xf bank_mask:0xf
    v_add_f32_dpp v83, v83, v83 quad_perm:[1,0,3,2] row_mask:0xf bank_mask:0xf
    v_add_f32_dpp v84, v84, v84 quad_perm:[1,0,3,2] row_mask:0xf bank_mask:0xf
    v_add_f32_dpp v85, v85, v85 quad_perm:[1,0,3,2] row_mask:0xf bank_mask:0xf
    v_add_f32_dpp v86, v86, v86 quad_perm:[1,0,3,2] row_mask:0xf bank_mask:0xf
    v_add_f32_dpp v87, v87, v87 quad_perm:[1,0,3,2] row_mask:0xf bank_mask:0xf
    v_add_f32_dpp v88, v88, v88 quad_perm:[1,0,3,2] row_mask:0xf bank_mask:0xf
    v_add_f32_dpp v89, v89, v89 quad_perm:[1,0,3,2] row_mask:0xf bank_mask:0xf
    v_add_f32_dpp v90, v90, v90 quad_perm:[1,0,3,2] row_mask:0xf bank_mask:0xf
    v_add_f32_dpp v91, v91, v91 quad_perm:[1,0,3,2] row_mask:0xf bank_mask:0xf
    v_add_f32_dpp v92, v92, v92 quad_perm:[1,0,3,2] row_mask:0xf bank_mask:0xf
    v_add_f32_dpp v93, v93, v93 quad_perm:[1,0,3,2] row_mask:0xf bank_mask:0xf
    v_add_f32_dpp v94, v94, v94 quad_perm:[1,0,3,2] row_mask:0xf bank_mask:0xf
    v_add_f32_dpp v95, v95, v95 quad_perm:[1,0,3,2] row_mask:0xf bank_mask:0xf
    v_add_f32_dpp v96, v96, v96 quad_perm:[1,0,3,2] row_mask:0xf bank_mask:0xf
    v_add_f32_dpp v97, v97, v97 quad_perm:[1,0,3,2] row_mask:0xf bank_mask:0xf
    v_add_f32_dpp v98, v98, v98 quad_perm:[1,0,3,2] row_mask:0xf bank_mask:0xf
    v_add_f32_dpp v99, v99, v99 quad_perm:[1,0,3,2] row_mask:0xf bank_mask:0xf
    v_add_f32_dpp v100, v100, v100 quad_perm:[1,0,3,2] row_mask:0xf bank_mask:0xf
    v_add_f32_dpp v101, v101, v101 quad_perm:[1,0,3,2] row_mask:0xf bank_mask:0xf
    v_add_f32_dpp v102, v102, v102 quad_perm:[1,0,3,2] row_mask:0xf bank_mask:0xf
    v_add_f32_dpp v103, v103, v103 quad_perm:[1,0,3,2] row_mask:0xf bank_mask:0xf
    v_add_f32_dpp v104, v104, v104 quad_perm:[1,0,3,2] row_mask:0xf bank_mask:0xf
    v_add_f32_dpp v105, v105, v105 quad_perm:[1,0,3,2] row_mask:0xf bank_mask:0xf
    v_add_f32_dpp v106, v106, v106 quad_perm:[1,0,3,2] row_mask:0xf bank_mask:0xf
    v_add_f32_dpp v107, v107, v107 quad_perm:[1,0,3,2] row_mask:0xf bank_mask:0xf
    s_mov_b64 exec, -1
    v_mov_b32 v224, v244
    v_mov_b32 v225, v245
    v_mov_b32 v226, v246
    s_nop 1
    v_permlane32_swap_b32 v224, v244
    v_permlane32_swap_b32 v225, v245
    v_permlane32_swap_b32 v226, v246
    s_nop 1
    v_add_f32 v244, v244, v224
    v_add_f32 v245, v245, v225
    v_add_f32 v246, v246, v226
    s_branch K2_TAIL
K2_EMPTY:
    s_waitcnt vmcnt(0) lgkmcnt(0)
    v_mov_b32 v244, 0
    v_mov_b32 v245, 0
    v_mov_b32 v246, 0
    v_mov_b32 v76, 0
    v_mov_b32 v77, 0
    v_mov_b32 v78, 0
    v_mov_b32 v79, 0
    v_mov_b32 v80, 0
    v_mov_b32 v81, 0
    v_mov_b32 v82, 0
    v_mov_b32 v83, 0
    v_mov_b32 v84, 0
    v_mov_b32 v85, 0
    v_mov_b32 v86, 0
    v_mov_b32 v87, 0
    v_mov_b32 v88, 0
    v_mov_b32 v89, 0
    v_mov_b32 v90, 0
    v_mov_b32 v91, 0
    v_mov_b32 v92, 0
    v_mov_b32 v93, 0
    v_mov_b32 v94, 0
    v_mov_b32 v95, 0
    v_mov_b32 v96, 0
    v_mov_b32 v97, 0
    v_mov_b32 v98, 0
    v_mov_b32 v99, 0
    v_mov_b32 v100, 0
    v_mov_b32 v101, 0
    v_mov_b32 v102, 0
    v_mov_b32 v103, 0
    v_mov_b32 v104, 0
    v_mov_b32 v105, 0
    v_mov_b32 v106, 0
    v_mov_b32 v107, 0
    v_mov_b32 v242, v241
    v_and_b32 v241, 0xffff0000, v240
    v_lshlrev_b32 v240, 16, v240
    s_branch K2_DONE
K2_SLOW:
    v_and_b32 v223, 31, v250
    v_lshlrev_b32 v220, 2, v219
    v_xor_b32 v220, v220, v251
    v_lshl_add_u32 v220, v219, 11, v220
    s_lshl_b32 s95, s100, 10
    s_add_u32 s95, s95, 129024
    v_lshl_add_u32 v221, v223, 5, v219
    v_add_u32 v221, s95, v221
    s_lshl_b32 s95, s5, 5
    v_add_u32 v223, s95, v223
    v_add_u32 v218, s4, v223
    v_min_u32 v222, 49999, v218
    s_waitcnt vmcnt(0)
    buffer_load_dwordx2 v[240:241], v222, s[16:19], 0 idxen
    v_xor_b32 v222, 0, v220
    ds_write_b128 v222, v[76:79]
    v_xor_b32 v222, 16, v220
    ds_write_b128 v222, v[80:83]
    v_xor_b32 v222, 32, v220
    ds_write_b128 v222, v[84:87]
    v_xor_b32 v222, 48, v220
    ds_write_b128 v222, v[88:91]
    v_xor_b32 v222, 64, v220
    ds_write_b128 v222, v[92:95]
    v_xor_b32 v222, 80, v220
    ds_write_b128 v222, v[96:99]
    v_xor_b32 v222, 96, v220
    ds_write_b128 v222, v[100:103]
    v_xor_b32 v222, 112, v220
    ds_write_b128 v222, v[104:107]
    ds_write_b128 v221, v[244:247]
    v_lshlrev_b32 v220, 2, v223
    ds_read_b32 v235, v220 offset:32768
    s_sub_u32 s99, s101, s94
    v_add_u32 v251, s99, v251
    v_add_u32 v252, s99, v252
    v_add_u32 v253, s99, v253
    v_add_u32 v254, s99, v254
    ds_read_b128 v[172:175], v251 offset:0
    ds_read_b128 v[176:179], v252 offset:0
    ds_read_b128 v[180:183], v253 offset:0
    ds_read_b128 v[184:187], v254 offset:0
    v_mov_b32 v76, 0
    v_mov_b32 v77, 0
    v_mov_b32 v78, 0
    v_mov_b32 v79, 0
    v_mov_b32 v80, 0
    v_mov_b32 v81, 0
    v_mov_b32 v82, 0
    v_mov_b32 v83, 0
    v_mov_b32 v84, 0
    v_mov_b32 v85, 0
    v_mov_b32 v86, 0
    v_mov_b32 v87, 0
    v_mov_b32 v88, 0
    v_mov_b32 v89, 0
    v_mov_b32 v90, 0
    v_mov_b32 v91, 0
    v_mov_b32 v92, 0
    v_mov_b32 v93, 0
    v_mov_b32 v94, 0
    v_mov_b32 v95, 0
    v_mov_b32 v96, 0
    v_mov_b32 v97, 0
    v_mov_b32 v98, 0
    v_mov_b32 v99, 0
    v_mov_b32 v100, 0
    v_mov_b32 v101, 0
    v_mov_b32 v102, 0
    v_mov_b32 v103, 0
    v_mov_b32 v104, 0
    v_mov_b32 v105, 0
    v_mov_b32 v106, 0
    v_mov_b32 v107, 0
    v_mov_b32 v244, 0
    v_mov_b32 v245, 0
    v_mov_b32 v246, 0
    s_lshl_b32 s99, s3, 8
    v_add_u32 v249, s99, v223
    v_mul_u32_u24 v249, 272, v249
    v_lshl_add_u32 v243, v219, 3, v249
    s_mov_b32 s99, 7602176
    s_cmp_eq_u32 s7, 0
    s_cbranch_scc1 K2_NOLD
    buffer_load_dwordx4 v[76:79], v243, s[20:23], s99 offen offset:0 sc0 sc1
    buffer_load_dwordx4 v[80:83], v243, s[20:23], s99 offen offset:16 sc0 sc1
    buffer_load_dwordx4 v[84:87], v243, s[20:23], s99 offen offset:32 sc0 sc1
    buffer_load_dwordx4 v[88:91], v243, s[20:23], s99 offen offset:48 sc0 sc1
    buffer_load_dwordx4 v[92:95], v243, s[20:23], s99 offen offset:64 sc0 sc1
    buffer_load_dwordx4 v[96:99], v243, s[20:23], s99 offen offset:80 sc0 sc1
    buffer_load_dwordx4 v[100:103], v243, s[20:23], s99 offen offset:96 sc0 sc1
    buffer_load_dwordx4 v[104:107], v243, s[20:23], s99 offen offset:112 sc0 sc1
    buffer_load_dwordx3 v[244:246], v249, s[20:23], s99 offen offset:256 sc0 sc1
    s_waitcnt vmcnt(0)
K2_NOLD:
    s_waitcnt lgkmcnt(0)
    v_and_b32 v207, 0xffff, v235
    v_lshrrev_b32 v235, 16, v235
    v_lshlrev_b32 v247, 11, v219
    v_add_u32 v247, 34816, v247
    v_add_u32 v220, 138240, v203
    v_cmp_lt_u32 vcc, 0, v235
    s_barrier
    s_cbranch_vccz K2_GDONE
K2_GLOOP:
    s_mov_b64 exec, vcc
    v_bfe_u32 v221, v207, 3, 3
    v_lshlrev_b32 v221, 4, v221
    v_lshl_add_u32 v221, v207, 5, v221
    v_add_u32 v221, v247, v221
    v_xor_b32 v222, 0, v221
    ds_read_b128 v[140:143], v222
    v_xor_b32 v222, 16, v221
    ds_read_b128 v[144:147], v222
    v_xor_b32 v222, 32, v221
    ds_read_b128 v[148:151], v222
    v_xor_b32 v222, 48, v221
    ds_read_b128 v[152:155], v222
    v_xor_b32 v222, 64, v221
    ds_read_b128 v[156:159], v222
    v_xor_b32 v222, 80, v221
    ds_read_b128 v[160:163], v222
    v_xor_b32 v222, 96, v221
    ds_read_b128 v[164:167], v222
    v_xor_b32 v222, 112, v221
    ds_read_b128 v[168:171], v222
    v_lshlrev_b32 v222, 3, v207
    v_add_u32 v222, 129024, v222
    ds_read_b128 v[188:191], v222
    ds_read_b128 v[192:195], v222 offset:16
    v_add_u32 v207, 4, v207
    v_subrev_u32 v235, 1, v235
    v_cmp_lt_u32 vcc, 0, v235
    s_waitcnt lgkmcnt(9)
    v_pk_add_f32 v[76:77], v[76:77], v[140:141]
    v_pk_add_f32 v[78:79], v[78:79], v[142:143]
    s_waitcnt lgkmcnt(8)
    v_pk_add_f32 v[80:81], v[80:81], v[144:145]
    v_pk_add_f32 v[82:83], v[82:83], v[146:147]
    s_waitcnt lgkmcnt(7)
    v_pk_add_f32 v[84:85], v[84:85], v[148:149]
    v_pk_add_f32 v[86:87], v[86:87], v[150:151]
    s_waitcnt lgkmcnt(6)
    v_pk_add_f32 v[88:89], v[88:89], v[152:153]
    v_pk_add_f32 v[90:91], v[90:91], v[154:155]
    s_waitcnt lgkmcnt(5)
    v_pk_add_f32 v[92:93], v[92:93], v[156:157]
    v_pk_add_f32 v[94:95], v[94:95], v[158:159]
    s_waitcnt lgkmcnt(4)
    v_pk_add_f32 v[96:97], v[96:97], v[160:161]
    v_pk_add_f32 v[98:99], v[98:99], v[162:163]
    s_waitcnt lgkmcnt(3)
    v_pk_add_f32 v[100:101], v[100:101], v[164:165]
    v_pk_add_f32 v[102:103], v[102:103], v[166:167]
    s_waitcnt lgkmcnt(2)
    v_pk_add_f32 v[104:105], v[104:105], v[168:169]
    v_pk_add_f32 v[106:107], v[106:107], v[170:171]
    s_waitcnt lgkmcnt(0)
    v_pk_add_f32 v[244:245], v[244:245], v[188:189]
    v_add_f32 v246, v246, v190
    v_pk_add_f32 v[244:245], v[244:245], v[192:193]
    v_add_f32 v246, v246, v194
    s_cbranch_vccnz K2_GLOOP
    s_mov_b64 exec, -1
K2_GDONE:
    s_cmp_eq_u32 s93, 0
    s_cbranch_scc1 K2_EPI
    buffer_store_dwordx4 v[76:79], v243, s[20:23], s99 offen offset:0
    buffer_store_dwordx4 v[80:83], v243, s[20:23], s99 offen offset:16
    buffer_store_dwordx4 v[84:87], v243, s[20:23], s99 offen offset:32
    buffer_store_dwordx4 v[88:91], v243, s[20:23], s99 offen offset:48
    buffer_store_dwordx4 v[92:95], v243, s[20:23], s99 offen offset:64
    buffer_store_dwordx4 v[96:99], v243, s[20:23], s99 offen offset:80
    buffer_store_dwordx4 v[100:103], v243, s[20:23], s99 offen offset:96
    buffer_store_dwordx4 v[104:107], v243, s[20:23], s99 offen offset:112
    buffer_store_dwordx3 v[244:246], v249, s[20:23], s99 offen offset:256
    s_add_u32 s7, s7, s92
    s_waitcnt vmcnt(0)
    s_barrier
    s_branch K2_TOP
K2_EPI:
    s_cmp_ge_u32 s5, 6
    s_cbranch_scc1 K2_NWH2
    s_mul_i32 s95, s5, 2048
    s_add_u32 m0, s95, 138240
    s_add_u32 s95, s95, 7561216
    buffer_load_dwordx4 v203, s[20:23], s95 offen offset:0 lds
    buffer_load_dwordx4 v203, s[20:23], s95 offen offset:1024 lds
K2_NWH2:
    s_lshl_b32 s95, s5, 5
    s_cmp_ge_u32 s95, s96
    s_waitcnt vmcnt(0)
    s_barrier
    s_cbranch_scc1 K2_END0
    ds_read_b128 v[0:3], v220 offset:20480
    ds_read_b128 v[4:7], v220 offset:21504
    ds_read_b128 v[8:11], v220 offset:22528
    ds_read_b128 v[12:15], v220 offset:23552
    ds_read_b128 v[16:19], v220 offset:0
    ds_read_b128 v[20:23], v220 offset:1024
    ds_read_b128 v[24:27], v220 offset:2048
    ds_read_b128 v[28:31], v220 offset:3072
    ds_read_b128 v[44:47], v220 offset:4096
    ds_read_b128 v[48:51], v220 offset:5120
    ds_read_b128 v[52:55], v220 offset:6144
    ds_read_b128 v[56:59], v220 offset:7168
    ds_read_b128 v[60:63], v220 offset:8192
    ds_read_b128 v[64:67], v220 offset:9216
    ds_read_b128 v[68:71], v220 offset:10240
    ds_read_b128 v[72:75], v220 offset:11264
    v_cmp_gt_u32_e64 s[44:45], s96, v223
    s_mov_b32 s98, s101
    s_waitcnt vmcnt(0)
    v_mov_b32 v242, v241
    v_and_b32 v241, 0xffff0000, v240
    v_lshlrev_b32 v240, 16, v240
K2_TAIL:
    v_add_u32 v235, s98, v203
    v_lshlrev_b32 v203, 7, v218
    v_cndmask_b32_e64 v203, 2.0, v203, s[44:45]
    s_waitcnt lgkmcnt(8)
    v_mfma_f32_32x32x16_bf16 v[140:155], v[0:3], v[172:175], 0
    v_cvt_pk_bf16_f32 v108, v76, v77
    v_cvt_pk_bf16_f32 v109, v78, v79
    v_mfma_f32_32x32x16_bf16 v[156:171], v[16:19], v[172:175], 0
    v_cvt_pk_bf16_f32 v110, v80, v81
    v_cvt_pk_bf16_f32 v111, v82, v83
    v_mfma_f32_32x32x16_bf16 v[140:155], v[4:7], v[176:179], v[140:155]
    v_cvt_pk_bf16_f32 v112, v84, v85
    v_cvt_pk_bf16_f32 v113, v86, v87
    v_mfma_f32_32x32x16_bf16 v[156:171], v[20:23], v[176:179], v[156:171]
    v_cvt_pk_bf16_f32 v114, v88, v89
    v_cvt_pk_bf16_f32 v115, v90, v91
    v_mfma_f32_32x32x16_bf16 v[140:155], v[8:11], v[180:183], v[140:155]
    v_cvt_pk_bf16_f32 v116, v92, v93
    v_cvt_pk_bf16_f32 v117, v94, v95
    v_mfma_f32_32x32x16_bf16 v[156:171], v[24:27], v[180:183], v[156:171]
    v_cvt_pk_bf16_f32 v118, v96, v97
    v_cvt_pk_bf16_f32 v119, v98, v99
    v_mfma_f32_32x32x16_bf16 v[140:155], v[12:15], v[184:187], v[140:155]
    v_cvt_pk_bf16_f32 v120, v100, v101
    v_cvt_pk_bf16_f32 v121, v102, v103
    v_mfma_f32_32x32x16_bf16 v[156:171], v[28:31], v[184:187], v[156:171]
    v_cvt_pk_bf16_f32 v122, v104, v105
    v_cvt_pk_bf16_f32 v123, v106, v107
    s_waitcnt lgkmcnt(0)
    ds_bpermute_b32 v210, v239, v203 offset:0
    ds_bpermute_b32 v212, v239, v203 offset:32
    ds_bpermute_b32 v214, v239, v203 offset:64
    ds_bpermute_b32 v216, v239, v203 offset:96
    v_mfma_f32_32x32x16_bf16 v[140:155], v[44:47], v[108:111], v[140:155]
    v_lshlrev_b32 v76, 16, v172
    v_and_b32 v77, 0xffff0000, v172
    v_lshlrev_b32 v78, 16, v173
    v_and_b32 v79, 0xffff0000, v173
    v_lshlrev_b32 v80, 16, v174
    v_and_b32 v81, 0xffff0000, v174
    v_lshlrev_b32 v82, 16, v175
    v_and_b32 v83, 0xffff0000, v175
    v_mfma_f32_32x32x16_bf16 v[140:155], v[48:51], v[112:115], v[140:155]
    v_lshlrev_b32 v84, 16, v176
    v_and_b32 v85, 0xffff0000, v176
    v_lshlrev_b32 v86, 16, v177
    v_and_b32 v87, 0xffff0000, v177
    v_lshlrev_b32 v88, 16, v178
    v_and_b32 v89, 0xffff0000, v178
    v_lshlrev_b32 v90, 16, v179
    v_and_b32 v91, 0xffff0000, v179
    v_mfma_f32_32x32x16_bf16 v[140:155], v[52:55], v[116:119], v[140:155]
    v_lshlrev_b32 v92, 16, v180
    v_and_b32 v93, 0xffff0000, v180
    v_lshlrev_b32 v94, 16, v181
    v_and_b32 v95, 0xffff0000, v181
    v_lshlrev_b32 v96, 16, v182
    v_and_b32 v97, 0xffff0000, v182
    v_lshlrev_b32 v98, 16, v183
    v_and_b32 v99, 0xffff0000, v183
    v_mfma_f32_32x32x16_bf16 v[140:155], v[56:59], v[120:123], v[140:155]
    v_lshlrev_b32 v100, 16, v184
    v_and_b32 v101, 0xffff0000, v184
    v_lshlrev_b32 v102, 16, v185
    v_and_b32 v103, 0xffff0000, v185
    v_lshlrev_b32 v104, 16, v186
    v_and_b32 v105, 0xffff0000, v186
    v_lshlrev_b32 v106, 16, v187
    v_and_b32 v107, 0xffff0000, v187
    v_mfma_f32_32x32x16_bf16 v[156:171], v[60:63], v[108:111], v[156:171]
    v_mov_b32 v243, 0
    v_pk_add_f32 v[244:245], v[244:245], v[240:241]
    v_add_f32 v246, v246, v242
    v_cvt_pk_bf16_f32 v244, v244, v245
    v_cvt_pk_bf16_f32 v246, v246, v246
    s_mov_b32 exec_lo, s44
    s_mov_b32 exec_hi, 0
    s_cmp_eq_u32 s98, s94
    s_cbranch_scc1 K2_PF
    v_mul_u32_u24 v220, 6, v218
    s_mov_b32 s99, 6400000
    buffer_store_short v244, v220, s[24:27], s99 offen
    buffer_store_short_d16_hi v244, v220, s[24:27], s99 offen offset:2
    buffer_store_short v246, v220, s[24:27], s99 offen offset:4
    s_branch K2_PD
K2_PF:
    s_mov_b32 s99, 32768
    v_mad_u32_u24 v220, v249, 6, s99
    ds_write_b16 v220, v244
    ds_write_b16_d16_hi v220, v244 offset:2
    ds_write_b16 v220, v246 offset:4
    s_mov_b64 exec, 1
    v_mov_b32 v220, 108
    v_mov_b32 v221, 1
    ds_add_rtn_u32 v243, v220, v221
K2_PD:
    s_mov_b64 exec, -1
    s_mov_b32 s40, 0xbf317218
    s_mov_b32 s41, 0xbf317218
    v_mfma_f32_32x32x16_bf16 v[156:171], v[64:67], v[112:115], v[156:171]
    v_exp_f32 v220, v140
    v_exp_f32 v221, v141
    v_exp_f32 v222, v142
    v_exp_f32 v223, v143
    v_mfma_f32_32x32x16_bf16 v[156:171], v[68:71], v[116:119], v[156:171]
    v_exp_f32 v224, v144
    v_exp_f32 v225, v145
    v_exp_f32 v226, v146
    v_exp_f32 v227, v147
    v_pk_add_f32 v[220:221], v[220:221], 1.0 op_sel_hi:[1,0]
    v_pk_add_f32 v[222:223], v[222:223], 1.0 op_sel_hi:[1,0]
    v_mfma_f32_32x32x16_bf16 v[156:171], v[72:75], v[120:123], v[156:171]
    v_pk_add_f32 v[224:225], v[224:225], 1.0 op_sel_hi:[1,0]
    v_pk_add_f32 v[226:227], v[226:227], 1.0 op_sel_hi:[1,0]
    v_rcp_f32 v220, v220
    v_rcp_f32 v221, v221
    v_rcp_f32 v222, v222
    v_rcp_f32 v223, v223
    v_rcp_f32 v224, v224
    v_rcp_f32 v225, v225
    v_rcp_f32 v226, v226
    v_rcp_f32 v227, v227
    s_waitcnt lgkmcnt(0)
    v_add_u32 v210, v210, v211
    v_add_u32 v212, v212, v213
    v_add_u32 v214, v214, v215
    v_add_u32 v216, v216, v217
    v_pk_mul_f32 v[220:221], v[220:221], v[140:141]
    v_pk_mul_f32 v[222:223], v[222:223], v[142:143]
    v_pk_mul_f32 v[224:225], v[224:225], v[144:145]
    v_pk_mul_f32 v[226:227], v[226:227], v[146:147]
    v_pk_fma_f32 v[220:221], v[220:221], s[40:41], v[76:77]
    v_pk_fma_f32 v[222:223], v[222:223], s[40:41], v[78:79]
    v_pk_fma_f32 v[224:225], v[224:225], s[40:41], v[80:81]
    v_pk_fma_f32 v[226:227], v[226:227], s[40:41], v[82:83]
    v_cvt_pk_bf16_f32 v172, v220, v221
    v_cvt_pk_bf16_f32 v173, v222, v223
    v_cvt_pk_bf16_f32 v174, v224, v225
    v_cvt_pk_bf16_f32 v175, v226, v227
    s_waitcnt vmcnt(0)
    ds_write_b128 v251, v[172:175]
    v_exp_f32 v220, v148
    v_exp_f32 v221, v149
    v_exp_f32 v222, v150
    v_exp_f32 v223, v151
    v_exp_f32 v224, v152
    v_exp_f32 v225, v153
    v_exp_f32 v226, v154
    v_exp_f32 v227, v155
    v_pk_add_f32 v[220:221], v[220:221], 1.0 op_sel_hi:[1,0]
    v_pk_add_f32 v[222:223], v[222:223], 1.0 op_sel_hi:[1,0]
    v_pk_add_f32 v[224:225], v[224:225], 1.0 op_sel_hi:[1,0]
    v_pk_add_f32 v[226:227], v[226:227], 1.0 op_sel_hi:[1,0]
    v_rcp_f32 v220, v220
    v_rcp_f32 v221, v221
    v_rcp_f32 v222, v222
    v_rcp_f32 v223, v223
    v_rcp_f32 v224, v224
    v_rcp_f32 v225, v225
    v_rcp_f32 v226, v226
    v_rcp_f32 v227, v227
    v_pk_mul_f32 v[220:221], v[220:221], v[148:149]
    v_pk_mul_f32 v[222:223], v[222:223], v[150:151]
    v_pk_mul_f32 v[224:225], v[224:225], v[152:153]
    v_pk_mul_f32 v[226:227], v[226:227], v[154:155]
    v_pk_fma_f32 v[220:221], v[220:221], s[40:41], v[84:85]
    v_pk_fma_f32 v[222:223], v[222:223], s[40:41], v[86:87]
    v_pk_fma_f32 v[224:225], v[224:225], s[40:41], v[88:89]
    v_pk_fma_f32 v[226:227], v[226:227], s[40:41], v[90:91]
    v_cvt_pk_bf16_f32 v176, v220, v221
    v_cvt_pk_bf16_f32 v177, v222, v223
    v_cvt_pk_bf16_f32 v178, v224, v225
    v_cvt_pk_bf16_f32 v179, v226, v227
    ds_write_b128 v252, v[176:179]
    v_exp_f32 v220, v156
    v_exp_f32 v221, v157
    v_exp_f32 v222, v158
    v_exp_f32 v223, v159
    v_exp_f32 v224, v160
    v_exp_f32 v225, v161
    v_exp_f32 v226, v162
    v_exp_f32 v227, v163
    v_pk_add_f32 v[220:221], v[220:221], 1.0 op_sel_hi:[1,0]
    v_pk_add_f32 v[222:223], v[222:223], 1.0 op_sel_hi:[1,0]
    v_pk_add_f32 v[224:225], v[224:225], 1.0 op_sel_hi:[1,0]
    v_pk_add_f32 v[226:227], v[226:227], 1.0 op_sel_hi:[1,0]
    v_rcp_f32 v220, v220
    v_rcp_f32 v221, v221
    v_rcp_f32 v222, v222
    v_rcp_f32 v223, v223
    v_rcp_f32 v224, v224
    v_rcp_f32 v225, v225
    v_rcp_f32 v226, v226
    v_rcp_f32 v227, v227
    v_pk_mul_f32 v[220:221], v[220:221], v[156:157]
    v_pk_mul_f32 v[222:223], v[222:223], v[158:159]
    v_pk_mul_f32 v[224:225], v[224:225], v[160:161]
    v_pk_mul_f32 v[226:227], v[226:227], v[162:163]
    v_pk_fma_f32 v[220:221], v[220:221], s[40:41], v[92:93]
    v_pk_fma_f32 v[222:223], v[222:223], s[40:41], v[94:95]
    v_pk_fma_f32 v[224:225], v[224:225], s[40:41], v[96:97]
    v_pk_fma_f32 v[226:227], v[226:227], s[40:41], v[98:99]
    v_cvt_pk_bf16_f32 v180, v220, v221
    v_cvt_pk_bf16_f32 v181, v222, v223
    v_cvt_pk_bf16_f32 v182, v224, v225
    v_cvt_pk_bf16_f32 v183, v226, v227
    ds_write_b128 v253, v[180:183]
    v_exp_f32 v220, v164
    v_exp_f32 v221, v165
    v_exp_f32 v222, v166
    v_exp_f32 v223, v167
    v_exp_f32 v224, v168
    v_exp_f32 v225, v169
    v_exp_f32 v226, v170
    v_exp_f32 v227, v171
    v_pk_add_f32 v[220:221], v[220:221], 1.0 op_sel_hi:[1,0]
    v_pk_add_f32 v[222:223], v[222:223], 1.0 op_sel_hi:[1,0]
    v_pk_add_f32 v[224:225], v[224:225], 1.0 op_sel_hi:[1,0]
    v_pk_add_f32 v[226:227], v[226:227], 1.0 op_sel_hi:[1,0]
    v_rcp_f32 v220, v220
    v_rcp_f32 v221, v221
    v_rcp_f32 v222, v222
    v_rcp_f32 v223, v223
    v_rcp_f32 v224, v224
    v_rcp_f32 v225, v225
    v_rcp_f32 v226, v226
    v_rcp_f32 v227, v227
    v_pk_mul_f32 v[220:221], v[220:221], v[164:165]
    v_pk_mul_f32 v[222:223], v[222:223], v[166:167]
    v_pk_mul_f32 v[224:225], v[224:225], v[168:169]
    v_pk_mul_f32 v[226:227], v[226:227], v[170:171]
    v_pk_fma_f32 v[220:221], v[220:221], s[40:41], v[100:101]
    v_pk_fma_f32 v[222:223], v[222:223], s[40:41], v[102:103]
    v_pk_fma_f32 v[224:225], v[224:225], s[40:41], v[104:105]
    v_pk_fma_f32 v[226:227], v[226:227], s[40:41], v[106:107]
    v_cvt_pk_bf16_f32 v184, v220, v221
    v_cvt_pk_bf16_f32 v185, v222, v223
    v_cvt_pk_bf16_f32 v186, v224, v225
    v_cvt_pk_bf16_f32 v187, v226, v227
    ds_write_b128 v254, v[184:187]
    ds_read_b128 v[140:143], v235 offset:0
    ds_read_b128 v[144:147], v235 offset:1024
    ds_read_b128 v[148:151], v235 offset:2048
    ds_read_b128 v[152:155], v235 offset:3072
    s_waitcnt lgkmcnt(3)
    buffer_store_dwordx4 v[140:143], v210, s[24:27], 0 offen sc1
    s_waitcnt lgkmcnt(2)
    buffer_store_dwordx4 v[144:147], v212, s[24:27], 0 offen sc1
    s_waitcnt lgkmcnt(1)
    buffer_store_dwordx4 v[148:151], v214, s[24:27], 0 offen sc1
    s_waitcnt lgkmcnt(0)
    buffer_store_dwordx4 v[152:155], v216, s[24:27], 0 offen sc1
    v_readfirstlane_b32 s95, v243
    v_and_b32 v220, 63, v250
    v_lshlrev_b32 v220, 3, v220
    s_cmp_lg_u32 s95, 7
    s_cbranch_scc1 K2_PE
    ds_read_b64 v[188:189], v220 offset:32768
    ds_read_b64 v[190:191], v220 offset:33280
    ds_read_b64 v[192:193], v220 offset:33792
    s_mul_i32 s99, s4, 6
    s_add_u32 s99, s99, 6400000
    s_mul_i32 s95, s96, 6
    v_cmp_gt_i32 vcc, s95, v220
    s_sub_i32 s95, s95, 512
    s_waitcnt lgkmcnt(2)
    s_mov_b64 exec, vcc
    buffer_store_dwordx2 v[188:189], v220, s[24:27], s99 offen offset:0 sc1
    v_cmp_gt_i32 vcc, s95, v220
    s_sub_i32 s95, s95, 512
    s_waitcnt lgkmcnt(1)
    s_mov_b64 exec, vcc
    buffer_store_dwordx2 v[190:191], v220, s[24:27], s99 offen offset:512 sc1
    v_cmp_gt_i32 vcc, s95, v220
    s_sub_i32 s95, s95, 512
    s_waitcnt lgkmcnt(0)
    s_mov_b64 exec, vcc
    buffer_store_dwordx2 v[192:193], v220, s[24:27], s99 offen offset:1024 sc1
    s_mov_b64 exec, -1
K2_PE:
    s_endpgm
K2_END0:
    s_waitcnt vmcnt(0)
K2_END:
    s_endpgm
.section .rodata,"a"
.p2align 6
.amdhsa_kernel egnn_sort_kernel
  .amdhsa_next_free_vgpr 56
  .amdhsa_next_free_sgpr 48
  .amdhsa_accum_offset 56
  .amdhsa_group_segment_fixed_size 0
  .amdhsa_kernarg_size 88
  .amdhsa_user_sgpr_count 2
  .amdhsa_user_sgpr_kernarg_segment_ptr 1
  .amdhsa_system_sgpr_workgroup_id_x 1
.end_amdhsa_kernel
.p2align 6
.amdhsa_kernel egnn_main_kernel
  .amdhsa_next_free_vgpr 256
  .amdhsa_next_free_sgpr 102
  .amdhsa_accum_offset 256
  .amdhsa_group_segment_fixed_size 0
  .amdhsa_kernarg_size 88
  .amdhsa_user_sgpr_count 2
  .amdhsa_user_sgpr_kernarg_segment_ptr 1
  .amdhsa_system_sgpr_workgroup_id_x 1
.end_amdhsa_kernel
```

```asm
; @launch kernel=egnn_sort_kernel grid=(250,1,1) block=(896,1,1) lds=27904
; @launch kernel=egnn_main_kernel grid=(256,1,1) block=(512,1,1) lds=162816
.amdgcn_target "amdgcn-amd-amdhsa--gfx950"
.text
.globl egnn_sort_kernel
.p2align 8
.type egnn_sort_kernel,@function
egnn_sort_kernel:
    s_cmp_ge_u32 s2, 250
    s_cbranch_scc1 K1_END
    s_load_dwordx2 s[38:39], s[0:1], 80
    v_lshrrev_b32 v1, 6, v0
    s_nop 0
    v_readfirstlane_b32 s3, v1
    s_cmp_ge_u32 s3, 13
    s_cbranch_scc1 K1_FRAG
    s_load_dwordx4 s[4:7], s[0:1], 24
    s_load_dwordx4 s[8:11], s[0:1], 8
    s_and_b32 s28, s2, 7
    s_min_u32 s29, s28, 2
    s_mul_i32 s28, s28, 31
    s_lshr_b32 s2, s2, 3
    s_add_u32 s2, s2, s28
    s_add_u32 s2, s2, s29
    v_lshlrev_b32 v1, 2, v0
    v_mov_b32 v2, 0
    v_mov_b32 v3, 1
    v_cmp_gt_u32 vcc, 288, v0
    s_mov_b64 exec, vcc
    ds_write_b32 v1, v2 offset:0
    s_mov_b64 exec, -1
    s_mul_i32 s28, s2, 12800
    s_mul_i32 s29, s2, 200
    s_mul_i32 s30, s2, 3200
    s_mov_b32 s31, 85599
    s_movk_i32 s32, -196
    v_add_u32 v12, s29, v0
    v_mul_u32_u24 v13, 6, v12
    v_lshlrev_b32 v14, 4, v0
    v_mov_b32 v15, 800
    v_cmp_gt_u32 s[34:35], v15, v0
    v_mov_b32 v15, 200
    v_cmp_gt_u32 s[36:37], v15, v0
    s_waitcnt lgkmcnt(0)
    s_mov_b32 s12, s4
    s_and_b32 s13, s5, 0xffff
    s_mov_b32 s14, 3200000
    s_mov_b32 s15, 0x20000
    s_mov_b32 s16, s6
    s_and_b32 s17, s7, 0xffff
    s_mov_b32 s18, 3200000
    s_mov_b32 s19, 0x20000
    s_mov_b32 s20, s8
    s_and_b32 s21, s9, 0xffff
    s_mov_b32 s22, 300000
    s_mov_b32 s23, 0x20000
    s_mov_b32 s24, s38
    s_and_b32 s25, s39, 0xffff
    s_mov_b32 s26, 25600000
    s_mov_b32 s27, 0x20000
    s_cmp_ge_u32 s3, 4
    s_cbranch_scc1 K1_NOPOS
    s_mov_b64 exec, s[36:37]
    buffer_load_ushort v16, v13, s[20:23], 0 offen
    buffer_load_ushort v17, v13, s[20:23], 0 offen offset:2
    buffer_load_ushort v18, v13, s[20:23], 0 offen offset:4
K1_NOPOS:
    s_mov_b64 exec, s[34:35]
    buffer_load_dwordx4 v[4:7], v14, s[16:19], s28 offen nt
    v_add_u32 v20, s30, v1
    v_add_u32 v22, 1, v20
    v_add_u32 v24, 2, v20
    v_add_u32 v26, 3, v20
    s_barrier
    s_waitcnt vmcnt(0)
    buffer_load_dwordx4 v[8:11], v14, s[12:15], s28 offen nt
    v_mul_u32_u24 v28, s31, v4
    v_lshrrev_b32 v28, 24, v28
    v_mad_i32_i24 v4, v28, s32, v4
    v_lshlrev_b32 v28, 2, v28
    ds_add_rtn_u32 v32, v28, v3 offset:0
    v_lshrrev_b32 v52, 7, v28
    v_mul_u32_u24 v29, s31, v5
    v_lshrrev_b32 v29, 24, v29
    v_mad_i32_i24 v5, v29, s32, v5
    v_lshlrev_b32 v29, 2, v29
    ds_add_rtn_u32 v33, v29, v3 offset:0
    v_lshrrev_b32 v53, 7, v29
    v_mul_u32_u24 v30, s31, v6
    v_lshrrev_b32 v30, 24, v30
    v_mad_i32_i24 v6, v30, s32, v6
    v_lshlrev_b32 v30, 2, v30
    ds_add_rtn_u32 v34, v30, v3 offset:0
    v_lshrrev_b32 v54, 7, v30
    v_mul_u32_u24 v31, s31, v7
    v_lshrrev_b32 v31, 24, v31
    v_mad_i32_i24 v7, v31, s32, v7
    v_lshlrev_b32 v31, 2, v31
    ds_add_rtn_u32 v35, v31, v3 offset:0
    v_lshrrev_b32 v55, 7, v31
    s_cmp_ge_u32 s3, 4
    s_cbranch_scc1 K1_P3
    s_mov_b64 exec, s[36:37]
    v_lshl_or_b32 v16, v17, 16, v16
    v_lshlrev_b32 v17, 16, v18
    v_lshlrev_b32 v12, 3, v12
    s_mov_b32 s33, 6684672
    buffer_store_dwordx2 v[16:17], v12, s[24:27], s33 offen
    s_mov_b64 exec, s[34:35]
K1_P3:
    s_mov_b64 exec, -1
    v_and_b32 v2, 63, v0
    v_lshlrev_b32 v2, 4, v2
    s_waitcnt lgkmcnt(0)
    s_barrier
    ds_read_b128 v[36:39], v2 offset:0
    s_waitcnt lgkmcnt(0)
    v_add_u32 v42, v36, v37
    v_add_u32 v43, v42, v38
    v_add_u32 v44, v43, v39
    v_mov_b32 v45, v44
    s_nop 1
    v_add_u32_dpp v45, v45, v45 row_shr:1 row_mask:0xf bank_mask:0xf
    s_nop 1
    v_add_u32_dpp v45, v45, v45 row_shr:2 row_mask:0xf bank_mask:0xf
    s_nop 1
    v_add_u32_dpp v45, v45, v45 row_shr:4 row_mask:0xf bank_mask:0xf
    s_nop 1
    v_add_u32_dpp v45, v45, v45 row_shr:8 row_mask:0xf bank_mask:0xf
    s_nop 1
    v_add_u32_dpp v45, v45, v45 row_bcast:15 row_mask:0xa bank_mask:0xf
    s_nop 1
    v_add_u32_dpp v45, v45, v45 row_bcast:31 row_mask:0xc bank_mask:0xf
    v_sub_u32 v40, v45, v44
    v_add_u32 v41, v40, v36
    v_add_u32 v42, v40, v42
    v_add_u32 v43, v40, v43
    v_lshlrev_b32 v48, 3, v40
    v_lshlrev_b32 v49, 3, v41
    v_lshlrev_b32 v50, 3, v42
    v_lshlrev_b32 v51, 3, v43
    ds_write_b128 v2, v[48:51] offset:1280
    s_mov_b64 exec, s[34:35]
    ds_read_b32 v28, v28 offset:1280
    ds_read_b32 v29, v29 offset:1280
    ds_read_b32 v30, v30 offset:1280
    ds_read_b32 v31, v31 offset:1280
    s_cmp_ge_u32 s3, 4
    s_cbranch_scc1 K1_SW0
    s_waitcnt vmcnt(1)
    s_branch K1_SW1
K1_SW0:
    s_waitcnt vmcnt(0)
K1_SW1:
    v_mul_u32_u24 v21, 2675, v8
    v_lshrrev_b32 v21, 24, v21
    v_sub_u32 v21, v21, v52
    v_and_b32 v21, 7, v21
    v_lshl_or_b32 v4, v4, 3, v21
    v_lshl_or_b32 v21, v4, 18, v8
    v_mul_u32_u24 v23, 2675, v9
    v_lshrrev_b32 v23, 24, v23
    v_sub_u32 v23, v23, v53
    v_and_b32 v23, 7, v23
    v_lshl_or_b32 v5, v5, 3, v23
    v_lshl_or_b32 v23, v5, 18, v9
    v_mul_u32_u24 v25, 2675, v10
    v_lshrrev_b32 v25, 24, v25
    v_sub_u32 v25, v25, v54
    v_and_b32 v25, 7, v25
    v_lshl_or_b32 v6, v6, 3, v25
    v_lshl_or_b32 v25, v6, 18, v10
    v_mul_u32_u24 v27, 2675, v11
    v_lshrrev_b32 v27, 24, v27
    v_sub_u32 v27, v27, v55
    v_and_b32 v27, 7, v27
    v_lshl_or_b32 v7, v7, 3, v27
    v_lshl_or_b32 v27, v7, 18, v11
    s_cmp_lg_u32 s3, 12
    s_cbranch_scc1 K1_NOOFF
    s_mov_b64 exec, -1
    v_lshl_or_b32 v40, v36, 16, v40
    v_lshl_or_b32 v41, v37, 16, v41
    v_lshl_or_b32 v42, v38, 16, v42
    v_lshl_or_b32 v43, v39, 16, v43
    v_lshlrev_b32 v2, 8, v2
    s_lshl_b32 s33, s2, 4
    s_add_u32 s33, s33, 6422528
    buffer_store_dwordx4 v[40:43], v2, s[24:27], s33 offen
    s_mov_b64 exec, s[34:35]
K1_NOOFF:
    s_waitcnt lgkmcnt(3)
    v_lshl_add_u32 v28, v32, 3, v28
    ds_write_b64 v28, v[20:21] offset:2304
    s_waitcnt lgkmcnt(3)
    v_lshl_add_u32 v29, v33, 3, v29
    ds_write_b64 v29, v[22:23] offset:2304
    s_waitcnt lgkmcnt(3)
    v_lshl_add_u32 v30, v34, 3, v30
    ds_write_b64 v30, v[24:25] offset:2304
    s_waitcnt lgkmcnt(3)
    v_lshl_add_u32 v31, v35, 3, v31
    ds_write_b64 v31, v[26:27] offset:2304
    s_mul_i32 s33, s2, 25600
    s_add_u32 s38, s33, 12800
    s_waitcnt lgkmcnt(0)
    s_barrier
    ds_read_b128 v[4:7], v14 offset:2304
    ds_read_b128 v[8:11], v14 offset:15104
    s_waitcnt lgkmcnt(1)
    buffer_store_dwordx4 v[4:7], v14, s[24:27], s33 offen sc1
    s_waitcnt lgkmcnt(0)
    buffer_store_dwordx4 v[8:11], v14, s[24:27], s38 offen sc1
    s_endpgm
K1_FRAG:
    s_cmp_ge_u32 s2, 144
    s_cbranch_scc1 K1_END
    s_load_dwordx4 s[4:7], s[0:1], 40
    s_load_dwordx2 s[8:9], s[0:1], 56
    s_lshr_b32 s28, s2, 2
    s_and_b32 s3, s2, 3
    s_lshl_b32 s3, s3, 6
    v_and_b32 v1, 63, v0
    v_add_u32 v1, s3, v1
    v_lshlrev_b32 v10, 2, v1
    s_lshl_b32 s33, s28, 10
    s_add_u32 s33, s33, 7536640
    s_mov_b32 s34, 0xbfb8aa3b
    s_waitcnt lgkmcnt(0)
    s_mov_b32 s12, s4
    s_and_b32 s13, s5, 0xffff
    s_mov_b32 s14, 18560
    s_mov_b32 s15, 0x20000
    s_mov_b32 s16, s6
    s_and_b32 s17, s7, 0xffff
    s_mov_b32 s18, 128
    s_mov_b32 s19, 0x20000
    s_mov_b32 s20, s8
    s_and_b32 s21, s9, 0xffff
    s_mov_b32 s22, 16384
    s_mov_b32 s23, 0x20000
    s_mov_b32 s24, s38
    s_and_b32 s25, s39, 0xffff
    s_mov_b32 s26, 25427968
    s_mov_b32 s27, 0x20000
    s_cmp_eq_u32 s28, 19
    s_cbranch_scc1 K1_WX
    s_cmp_eq_u32 s28, 18
    s_cbranch_scc1 K1_W3
    v_lshrrev_b32 v2, 2, v1
    v_and_b32 v3, 4, v2
    v_lshlrev_b32 v3, 3, v3
    v_bfe_u32 v4, v2, 3, 2
    v_lshl_add_u32 v3, v4, 2, v3
    v_and_b32 v4, 3, v2
    v_add_u32 v3, v3, v4
    v_lshrrev_b32 v5, 7, v1
    v_and_b32 v6, 3, v1
    s_mov_b32 s35, 32
    s_cmp_ge_u32 s28, 18
    s_cbranch_scc1 K1_FH
    s_cmp_ge_u32 s28, 16
    s_cbranch_scc1 K1_F4
    s_mov_b32 s36, s28
    s_branch K1_FC
K1_FH:
    s_sub_u32 s36, s28, 20
    s_mov_b32 s12, s20
    s_mov_b32 s13, s21
    s_mov_b32 s14, s22
    s_cmp_ge_u32 s36, 8
    s_cselect_b32 s34, 1.0, s34
K1_FC:
    s_lshr_b32 s37, s36, 3
    s_lshl_b32 s37, s37, 6
    s_and_b32 s38, s36, 3
    s_lshl_b32 s38, s38, 3
    s_add_u32 s37, s37, s38
    s_bfe_u32 s38, s36, 0x10002
    s_branch K1_FD
K1_F4:
    s_mov_b32 s35, 8
    s_movk_i32 s37, 129
    s_sub_u32 s38, s28, 16
K1_FD:
    s_lshl_b32 s38, s38, 4
    v_mul_u32_u24 v5, s35, v5
    v_lshl_add_u32 v5, v6, 1, v5
    v_add_u32 v5, s37, v5
    v_add_u32 v3, s38, v3
    v_lshlrev_b32 v3, 1, v3
    v_lshl_add_u32 v3, v5, 7, v3
    buffer_load_ushort v7, v3, s[12:15], 0 offen
    buffer_load_ushort v8, v3, s[12:15], 0 offen offset:128
    s_waitcnt vmcnt(0)
    v_lshlrev_b32 v7, 16, v7
    v_lshlrev_b32 v8, 16, v8
    v_mul_f32 v7, s34, v7
    v_mul_f32 v8, s34, v8
    v_cvt_pk_bf16_f32 v7, v7, v8
    buffer_store_dword v7, v10, s[24:27], s33 offen
    s_endpgm
K1_W3:
    v_and_b32 v2, 31, v1
    v_and_b32 v3, 4, v2
    v_lshlrev_b32 v3, 3, v3
    v_bfe_u32 v4, v2, 3, 2
    v_lshl_add_u32 v3, v4, 2, v3
    v_and_b32 v4, 3, v2
    v_add_u32 v3, v3, v4
    v_bfe_u32 v5, v1, 6, 1
    v_lshl_add_u32 v3, v5, 4, v3
    v_lshlrev_b32 v3, 1, v3
    s_movk_i32 s35, 16384
    buffer_load_ushort v7, v3, s[12:15], s35 offen
    v_and_b32 v6, 32, v1
    v_cmp_eq_u32 vcc, 0, v6
    s_waitcnt vmcnt(0)
    v_lshlrev_b32 v7, 16, v7
    v_mul_f32 v7, s34, v7
    v_cvt_pk_bf16_f32 v8, v7, v7
    v_lshlrev_b32 v8, 16, v8
    v_sub_f32 v9, v7, v8
    v_cvt_pk_bf16_f32 v7, v8, v9
    v_cndmask_b32 v7, 0, v7, vcc
    buffer_store_dword v7, v10, s[24:27], s33 offen
    s_endpgm
K1_WX:
    v_lshlrev_b32 v3, 1, v1
    buffer_load_ushort v7, v3, s[16:19], 0 offen
    s_waitcnt vmcnt(0)
    v_lshlrev_b32 v7, 16, v7
    v_mul_f32 v7, 0xbf317218, v7
    buffer_store_dword v7, v10, s[24:27], s33 offen
K1_END:
    s_endpgm
.globl egnn_main_kernel
.p2align 8
.type egnn_main_kernel,@function
egnn_main_kernel:
    s_cmp_ge_u32 s2, 256
    s_cbranch_scc1 K2_END
    s_load_dwordx2 s[28:29], s[0:1], 0
    s_load_dwordx2 s[30:31], s[0:1], 16
    s_load_dwordx2 s[32:33], s[0:1], 64
    s_load_dwordx2 s[34:35], s[0:1], 80
    v_mov_b32 v250, v0
    v_lshrrev_b32 v220, 6, v0
    s_and_b32 s3, s2, 7
    s_lshl_b32 s3, s3, 5
    v_readfirstlane_b32 s5, v220
    s_lshr_b32 s95, s2, 3
    s_add_u32 s3, s3, s95
    s_mul_i32 s4, s3, 196
    s_sub_u32 s96, 50000, s4
    s_min_u32 s96, s96, 196
    s_mov_b32 s7, 0
    s_mov_b32 s92, 48
    s_sub_u32 s100, 11, s5
    s_cmp_lt_u32 s5, 4
    s_cselect_b32 s100, s5, s100
    s_lshl_b32 s94, s100, 12
    s_add_u32 s94, s94, 34816
    s_waitcnt lgkmcnt(0)
    s_add_u32 s88, s34, 6422528
    s_addc_u32 s89, s35, 0
    s_and_b32 s89, s89, 0xffff
    s_mov_b32 s90, 262144
    s_mov_b32 s91, 0x20000
    s_mov_b32 s8, s28
    s_and_b32 s9, s29, 0xffff
    s_or_b32 s9, s9, 8388608
    s_mov_b32 s10, 50000
    s_mov_b32 s11, 0x20000
    s_mov_b32 s12, s30
    s_and_b32 s13, s31, 0xffff
    s_or_b32 s13, s13, 2097152
    s_mov_b32 s14, 800000
    s_mov_b32 s15, 0x20000
    s_add_u32 s16, s34, 6684672
    s_addc_u32 s17, s35, 0
    s_and_b32 s17, s17, 0xffff
    s_or_b32 s17, s17, 524288
    s_mov_b32 s18, 50000
    s_mov_b32 s19, 0x20000
    s_mov_b32 s20, s34
    s_and_b32 s21, s35, 0xffff
    s_mov_b32 s22, 25427968
    s_mov_b32 s23, 0x20000
    s_mov_b32 s24, s32
    s_and_b32 s25, s33, 0xffff
    s_mov_b32 s26, 6700000
    s_mov_b32 s27, 0x20000
K2_TOP:
    v_bfe_u32 v220, v250, 4, 2
    s_mul_i32 s95, s5, 36
    s_sub_u32 s95, s95, 36
    v_mad_u32_u24 v220, v220, 9, s95
    v_lshlrev_b32 v221, 4, v220
    s_and_b32 s95, s3, 3
    s_mul_i32 s95, s95, 1020
    s_lshl_b32 s99, s3, 10
    s_sub_u32 s95, s99, s95
    s_cmp_eq_u32 s5, 0
    s_cbranch_scc1 K2_NOOF
    buffer_load_dword v172, v221, s[88:91], s95 offen offset:0
    buffer_load_dword v173, v221, s[88:91], s95 offen offset:16
    buffer_load_dword v174, v221, s[88:91], s95 offen offset:32
    buffer_load_dword v175, v221, s[88:91], s95 offen offset:48
    buffer_load_dword v176, v221, s[88:91], s95 offen offset:64
    buffer_load_dword v177, v221, s[88:91], s95 offen offset:80
    buffer_load_dword v178, v221, s[88:91], s95 offen offset:96
    buffer_load_dword v179, v221, s[88:91], s95 offen offset:112
    buffer_load_dword v180, v221, s[88:91], s95 offen offset:128
K2_NOOF:
    v_and_b32 v222, 63, v250
    v_lshlrev_b32 v203, 4, v222
    v_lshrrev_b32 v239, 3, v222
    v_lshrrev_b32 v223, 4, v222
    v_xor_b32 v223, v223, v222
    v_and_b32 v223, 7, v223
    v_lshlrev_b32 v211, 4, v223
    v_xor_b32 v213, 64, v211
    v_mov_b32 v215, v211
    v_mov_b32 v217, v213
    s_lshl_b32 s95, s5, 5
    s_add_u32 s95, s95, s4
    v_add_u32 v210, s95, v239
    v_add_u32 v212, 8, v210
    v_add_u32 v214, 16, v210
    v_add_u32 v216, 24, v210
    s_add_u32 s99, s4, s96
    v_cmp_gt_u32 vcc, s99, v210
    s_nop 1
    v_cndmask_b32 v210, -1, v210, vcc
    v_cmp_gt_u32 vcc, s99, v212
    s_nop 1
    v_cndmask_b32 v212, -1, v212, vcc
    v_cmp_gt_u32 vcc, s99, v214
    s_nop 1
    v_cndmask_b32 v214, -1, v214, vcc
    v_cmp_gt_u32 vcc, s99, v216
    s_nop 1
    v_cndmask_b32 v216, -1, v216, vcc
    s_lshl_b32 s101, s5, 12
    s_add_u32 s101, s101, 100352
    s_barrier
    s_mul_i32 s95, s5, 3072
    s_add_u32 m0, s95, 138240
    s_add_u32 s95, s95, 7536640
    buffer_load_dwordx4 v203, s[20:23], s95 offen offset:0 lds
    buffer_load_dwordx4 v203, s[20:23], s95 offen offset:1024 lds
    buffer_load_dwordx4 v203, s[20:23], s95 offen offset:2048 lds
    v_mov_b32 v228, 0
    v_mov_b32 v229, 0
    v_mov_b32 v230, 0
    v_mov_b32 v231, 0
    s_lshl_b32 s95, s5, 10
    s_cmp_ge_u32 s5, 4
    s_cselect_b32 s99, 30720, 0
    s_add_u32 s95, s95, s99
    v_add_u32 v223, s95, v203
    ds_write_b128 v223, v[228:231]
    ds_write_b128 v223, v[228:231] offset:4096
    v_and_b32 v223, 2047, v223
    ds_write_b128 v223, v[228:231] offset:43008
    v_lshlrev_b32 v239, 2, v239
    v_mov_b32 v41, 0
    v_mov_b32 v43, 0
    v_mov_b32 v209, 0
    v_lshrrev_b32 v219, 5, v222
    v_lshlrev_b32 v219, 4, v219
    v_and_b32 v223, 31, v222
    v_bfe_u32 v251, v222, 1, 3
    v_lshlrev_b32 v251, 4, v251
    v_lshlrev_b32 v252, 2, v219
    v_xor_b32 v251, v251, v252
    v_lshl_add_u32 v251, v223, 7, v251
    v_add_u32 v251, s94, v251
    v_xor_b32 v252, 16, v251
    v_xor_b32 v253, 32, v251
    v_xor_b32 v254, 48, v251
    v_and_b32 v222, 15, v250
    v_cmp_gt_u32 vcc, 243, v220
    v_mul_u32_u24 v220, 3200, v220
    v_add3_u32 v220, v220, v222, s7
    v_add_u32 v221, 16, v222
    v_add_u32 v223, 32, v222
    v_cmp_gt_u32_e64 s[32:33], s92, v221
    v_cmp_gt_u32_e64 s[34:35], s92, v222
    s_nop 0
    v_cndmask_b32_e64 v221, 2.0, v221, s[32:33]
    v_cndmask_b32_e64 v223, 2.0, v223, s[32:33]
    v_cndmask_b32_e64 v222, 2.0, v222, s[34:35]
    s_cmp_eq_u32 s5, 0
    s_waitcnt vmcnt(3)
    s_cbranch_scc0 K2_MK
    s_branch K2_NOREC
K2_MK:
    v_cndmask_b32 v179, 0, v179, vcc
    v_cndmask_b32 v180, 0, v180, vcc
    v_and_b32 v98, 0xffff, v172
    v_lshrrev_b32 v172, 16, v172
    v_subrev_u32 v172, s7, v172
    v_cmp_gt_i32_e64 s[32:33], v172, v222
    v_add_lshl_u32 v98, v98, v220, 3
    s_mov_b32 s95, 0
    v_cndmask_b32_e64 v98, 2.0, v98, s[32:33]
    buffer_load_dwordx2 v[44:45], v98, s[20:23], s95 offen
    v_and_b32 v99, 0xffff, v173
    v_lshrrev_b32 v173, 16, v173
    v_subrev_u32 v173, s7, v173
    v_cmp_gt_i32_e64 s[34:35], v173, v222
    v_add_lshl_u32 v99, v99, v220, 3
    s_mov_b32 s95, 25600
    v_cndmask_b32_e64 v99, 2.0, v99, s[34:35]
    buffer_load_dwordx2 v[46:47], v99, s[20:23], s95 offen
    v_and_b32 v100, 0xffff, v174
    v_lshrrev_b32 v174, 16, v174
    v_subrev_u32 v174, s7, v174
    v_cmp_gt_i32_e64 s[36:37], v174, v222
    v_add_lshl_u32 v100, v100, v220, 3
    s_mov_b32 s95, 51200
    v_cndmask_b32_e64 v100, 2.0, v100, s[36:37]
    buffer_load_dwordx2 v[48:49], v100, s[20:23], s95 offen
    v_and_b32 v101, 0xffff, v175
    v_lshrrev_b32 v175, 16, v175
    v_subrev_u32 v175, s7, v175
    v_cmp_gt_i32_e64 s[38:39], v175, v222
    v_add_lshl_u32 v101, v101, v220, 3
    s_mov_b32 s95, 76800
    v_cndmask_b32_e64 v101, 2.0, v101, s[38:39]
    buffer_load_dwordx2 v[50:51], v101, s[20:23], s95 offen
    v_and_b32 v102, 0xffff, v176
    v_lshrrev_b32 v176, 16, v176
    v_subrev_u32 v176, s7, v176
    v_cmp_gt_i32_e64 s[40:41], v176, v222
    v_add_lshl_u32 v102, v102, v220, 3
    s_mov_b32 s95, 102400
    v_cndmask_b32_e64 v102, 2.0, v102, s[40:41]
    buffer_load_dwordx2 v[52:53], v102, s[20:23], s95 offen
    v_and_b32 v103, 0xffff, v177
    v_lshrrev_b32 v177, 16, v177
    v_subrev_u32 v177, s7, v177
    v_cmp_gt_i32_e64 s[42:43], v177, v222
    v_add_lshl_u32 v103, v103, v220, 3
    s_mov_b32 s95, 128000
    v_cndmask_b32_e64 v103, 2.0, v103, s[42:43]
    buffer_load_dwordx2 v[54:55], v103, s[20:23], s95 offen
    v_and_b32 v104, 0xffff, v178
    v_lshrrev_b32 v178, 16, v178
    v_subrev_u32 v178, s7, v178
    v_cmp_gt_i32_e64 s[44:45], v178, v222
    v_add_lshl_u32 v104, v104, v220, 3
    s_mov_b32 s95, 153600
    v_cndmask_b32_e64 v104, 2.0, v104, s[44:45]
    buffer_load_dwordx2 v[56:57], v104, s[20:23], s95 offen
    v_and_b32 v105, 0xffff, v179
    v_lshrrev_b32 v179, 16, v179
    v_subrev_u32 v179, s7, v179
    v_cmp_gt_i32_e64 s[46:47], v179, v222
    v_add_lshl_u32 v105, v105, v220, 3
    s_mov_b32 s95, 179200
    v_cndmask_b32_e64 v105, 2.0, v105, s[46:47]
    buffer_load_dwordx2 v[58:59], v105, s[20:23], s95 offen
    v_and_b32 v106, 0xffff, v180
    v_lshrrev_b32 v180, 16, v180
    v_subrev_u32 v180, s7, v180
    v_cmp_gt_i32_e64 s[48:49], v180, v222
    v_add_lshl_u32 v106, v106, v220, 3
    s_mov_b32 s95, 204800
    v_cndmask_b32_e64 v106, 2.0, v106, s[48:49]
    buffer_load_dwordx2 v[60:61], v106, s[20:23], s95 offen
    v_cmp_gt_i32_e64 s[50:51], v172, v221
    v_cmp_gt_i32_e64 s[68:69], v172, v223
    v_cmp_gt_i32_e64 s[52:53], v173, v221
    v_cmp_gt_i32_e64 s[70:71], v173, v223
    v_cmp_gt_i32_e64 s[54:55], v174, v221
    v_cmp_gt_i32_e64 s[72:73], v174, v223
    v_cmp_gt_i32_e64 s[56:57], v175, v221
    v_cmp_gt_i32_e64 s[74:75], v175, v223
    v_cmp_gt_i32_e64 s[58:59], v176, v221
    v_cmp_gt_i32_e64 s[76:77], v176, v223
    v_cmp_gt_i32_e64 s[60:61], v177, v221
    v_cmp_gt_i32_e64 s[78:79], v177, v223
    v_cmp_gt_i32_e64 s[62:63], v178, v221
    v_cmp_gt_i32_e64 s[80:81], v178, v223
    v_cmp_gt_i32_e64 s[64:65], v179, v221
    v_cmp_gt_i32_e64 s[82:83], v179, v223
    v_cmp_gt_i32_e64 s[66:67], v180, v221
    v_cmp_gt_i32_e64 s[84:85], v180, v223
    s_mov_b32 s95, 0
    s_mov_b64 exec, s[50:51]
    s_cbranch_execz K2_G1
    buffer_load_dwordx2 v[62:63], v98, s[20:23], s95 offen offset:128
K2_G1:
    s_mov_b32 s95, 25600
    s_mov_b64 exec, s[52:53]
    s_cbranch_execz K2_G2
    buffer_load_dwordx2 v[64:65], v99, s[20:23], s95 offen offset:128
K2_G2:
    s_mov_b32 s95, 51200
    s_mov_b64 exec, s[54:55]
    s_cbranch_execz K2_G3
    buffer_load_dwordx2 v[66:67], v100, s[20:23], s95 offen offset:128
K2_G3:
    s_mov_b32 s95, 76800
    s_mov_b64 exec, s[56:57]
    s_cbranch_execz K2_G4
    buffer_load_dwordx2 v[68:69], v101, s[20:23], s95 offen offset:128
K2_G4:
    s_mov_b32 s95, 102400
    s_mov_b64 exec, s[58:59]
    s_cbranch_execz K2_G5
    buffer_load_dwordx2 v[70:71], v102, s[20:23], s95 offen offset:128
K2_G5:
    s_mov_b32 s95, 128000
    s_mov_b64 exec, s[60:61]
    s_cbranch_execz K2_G6
    buffer_load_dwordx2 v[72:73], v103, s[20:23], s95 offen offset:128
K2_G6:
    s_mov_b32 s95, 153600
    s_mov_b64 exec, s[62:63]
    s_cbranch_execz K2_G7
    buffer_load_dwordx2 v[74:75], v104, s[20:23], s95 offen offset:128
K2_G7:
    s_mov_b32 s95, 179200
    s_mov_b64 exec, s[64:65]
    s_cbranch_execz K2_G8
    buffer_load_dwordx2 v[76:77], v105, s[20:23], s95 offen offset:128
K2_G8:
    s_mov_b32 s95, 204800
    s_mov_b64 exec, s[66:67]
    s_cbranch_execz K2_G9
    buffer_load_dwordx2 v[78:79], v106, s[20:23], s95 offen offset:128
K2_G9:
    s_or_b64 vcc, s[68:69], s[70:71]
    s_or_b64 vcc, vcc, s[72:73]
    s_or_b64 vcc, vcc, s[74:75]
    s_or_b64 vcc, vcc, s[76:77]
    s_or_b64 vcc, vcc, s[78:79]
    s_or_b64 vcc, vcc, s[80:81]
    s_or_b64 vcc, vcc, s[82:83]
    s_or_b64 vcc, vcc, s[84:85]
    s_cselect_b32 s97, 1, 0
    s_cbranch_scc0 K2_NP2A
    s_mov_b32 s95, 0
    s_mov_b64 exec, s[68:69]
    s_cbranch_execz K2_G10
    buffer_load_dwordx2 v[80:81], v98, s[20:23], s95 offen offset:256
K2_G10:
    s_mov_b32 s95, 25600
    s_mov_b64 exec, s[70:71]
    s_cbranch_execz K2_G11
    buffer_load_dwordx2 v[82:83], v99, s[20:23], s95 offen offset:256
K2_G11:
    s_mov_b32 s95, 51200
    s_mov_b64 exec, s[72:73]
    s_cbranch_execz K2_G12
    buffer_load_dwordx2 v[84:85], v100, s[20:23], s95 offen offset:256
K2_G12:
    s_mov_b32 s95, 76800
    s_mov_b64 exec, s[74:75]
    s_cbranch_execz K2_G13
    buffer_load_dwordx2 v[86:87], v101, s[20:23], s95 offen offset:256
K2_G13:
    s_mov_b32 s95, 102400
    s_mov_b64 exec, s[76:77]
    s_cbranch_execz K2_G14
    buffer_load_dwordx2 v[88:89], v102, s[20:23], s95 offen offset:256
K2_G14:
    s_mov_b32 s95, 128000
    s_mov_b64 exec, s[78:79]
    s_cbranch_execz K2_G15
    buffer_load_dwordx2 v[90:91], v103, s[20:23], s95 offen offset:256
K2_G15:
    s_mov_b32 s95, 153600
    s_mov_b64 exec, s[80:81]
    s_cbranch_execz K2_G16
    buffer_load_dwordx2 v[92:93], v104, s[20:23], s95 offen offset:256
K2_G16:
    s_mov_b32 s95, 179200
    s_mov_b64 exec, s[82:83]
    s_cbranch_execz K2_G17
    buffer_load_dwordx2 v[94:95], v105, s[20:23], s95 offen offset:256
K2_G17:
    s_mov_b32 s95, 204800
    s_mov_b64 exec, s[84:85]
    s_cbranch_execz K2_G18
    buffer_load_dwordx2 v[96:97], v106, s[20:23], s95 offen offset:256
K2_G18:
K2_NP2A:
    s_mov_b64 exec, -1
    v_max3_i32 v221, v172, v173, v174
    v_max3_i32 v221, v221, v175, v176
    v_max3_i32 v221, v221, v177, v178
    v_max3_i32 v221, v221, v179, v180
    v_mov_b32 v223, 1
    v_cmp_lt_i32_e64 s[86:87], s92, v221
K2_NOREC:
    s_waitcnt lgkmcnt(0)
    s_barrier
    s_add_u32 s95, s101, 0
    s_cmp_lt_u32 s95, 125952
    s_cselect_b32 m0, s95, 47104
    s_nop 0
    buffer_load_dwordx4 v[210:211], s[8:11], 0 idxen offen lds
    s_add_u32 s95, s101, 1024
    s_cmp_lt_u32 s95, 125952
    s_cselect_b32 m0, s95, 47104
    s_nop 0
    buffer_load_dwordx4 v[212:213], s[8:11], 0 idxen offen lds
    s_add_u32 s95, s101, 2048
    s_cmp_lt_u32 s95, 125952
    s_cselect_b32 m0, s95, 47104
    s_nop 0
    buffer_load_dwordx4 v[214:215], s[8:11], 0 idxen offen lds
    s_add_u32 s95, s101, 3072
    s_cmp_lt_u32 s95, 125952
    s_cselect_b32 m0, s95, 47104
    s_nop 0
    buffer_load_dwordx4 v[216:217], s[8:11], 0 idxen offen lds
    s_cmp_lg_u32 s5, 0
    s_cbranch_scc1 K2_NOPW
    s_lshr_b32 s95, s2, 3
    s_mul_i32 s99, s95, 0
    v_add_u32 v224, s99, v203
    s_mul_i32 s99, s95, 0
    v_add_u32 v225, s99, v250
    v_add_u32 v224, 0, v250
    v_cmp_gt_u32 vcc, s96, v224
    s_nop 1
    v_cndmask_b32_e64 v104, -0.5, 0.5, vcc
    v_add_u32 v224, 64, v250
    v_cmp_gt_u32 vcc, s96, v224
    s_nop 1
    v_cndmask_b32_e64 v105, -0.5, 0.5, vcc
    v_add_u32 v224, 128, v250
    v_cmp_gt_u32 vcc, s96, v224
    s_nop 1
    v_cndmask_b32_e64 v106, -0.5, 0.5, vcc
    v_add_u32 v224, 192, v250
    v_cmp_gt_u32 vcc, s96, v224
    s_nop 1
    v_cndmask_b32_e64 v107, -0.5, 0.5, vcc
    s_branch K2_B1
K2_NOPW:
    s_mov_b64 exec, s[86:87]
    ds_write_b32 v228, v223 offset:96
    s_mov_b64 exec, -1
    s_waitcnt vmcnt(4)
    s_mov_b64 exec, s[32:33]
    v_lshrrev_b32 v172, 16, v45
    ds_add_rtn_u32 v172, v172, v223 offset:34816
    s_mov_b64 exec, s[34:35]
    v_lshrrev_b32 v173, 16, v47
    ds_add_rtn_u32 v173, v173, v223 offset:34816
    s_mov_b64 exec, s[36:37]
    v_lshrrev_b32 v174, 16, v49
    ds_add_rtn_u32 v174, v174, v223 offset:34816
    s_mov_b64 exec, s[38:39]
    v_lshrrev_b32 v175, 16, v51
    ds_add_rtn_u32 v175, v175, v223 offset:34816
    s_mov_b64 exec, s[40:41]
    v_lshrrev_b32 v176, 16, v53
    ds_add_rtn_u32 v176, v176, v223 offset:34816
    s_mov_b64 exec, s[42:43]
    v_lshrrev_b32 v177, 16, v55
    ds_add_rtn_u32 v177, v177, v223 offset:34816
    s_mov_b64 exec, s[44:45]
    v_lshrrev_b32 v178, 16, v57
    ds_add_rtn_u32 v178, v178, v223 offset:34816
    s_mov_b64 exec, s[46:47]
    v_lshrrev_b32 v179, 16, v59
    ds_add_rtn_u32 v179, v179, v223 offset:34816
    s_mov_b64 exec, s[48:49]
    v_lshrrev_b32 v180, 16, v61
    ds_add_rtn_u32 v180, v180, v223 offset:34816
    s_mov_b64 exec, s[50:51]
    s_cbranch_execz K2_G19
    v_lshrrev_b32 v181, 16, v63
    ds_add_rtn_u32 v181, v181, v223 offset:34816
K2_G19:
    s_mov_b64 exec, s[52:53]
    s_cbranch_execz K2_G20
    v_lshrrev_b32 v182, 16, v65
    ds_add_rtn_u32 v182, v182, v223 offset:34816
K2_G20:
    s_mov_b64 exec, s[54:55]
    s_cbranch_execz K2_G21
    v_lshrrev_b32 v183, 16, v67
    ds_add_rtn_u32 v183, v183, v223 offset:34816
K2_G21:
    s_mov_b64 exec, s[56:57]
    s_cbranch_execz K2_G22
    v_lshrrev_b32 v184, 16, v69
    ds_add_rtn_u32 v184, v184, v223 offset:34816
K2_G22:
    s_mov_b64 exec, s[58:59]
    s_cbranch_execz K2_G23
    v_lshrrev_b32 v185, 16, v71
    ds_add_rtn_u32 v185, v185, v223 offset:34816
K2_G23:
    s_mov_b64 exec, s[60:61]
    s_cbranch_execz K2_G24
    v_lshrrev_b32 v186, 16, v73
    ds_add_rtn_u32 v186, v186, v223 offset:34816
K2_G24:
    s_mov_b64 exec, s[62:63]
    s_cbranch_execz K2_G25
    v_lshrrev_b32 v187, 16, v75
    ds_add_rtn_u32 v187, v187, v223 offset:34816
K2_G25:
    s_mov_b64 exec, s[64:65]
    s_cbranch_execz K2_G26
    v_lshrrev_b32 v188, 16, v77
    ds_add_rtn_u32 v188, v188, v223 offset:34816
K2_G26:
    s_mov_b64 exec, s[66:67]
    s_cbranch_execz K2_G27
    v_lshrrev_b32 v189, 16, v79
    ds_add_rtn_u32 v189, v189, v223 offset:34816
K2_G27:
    s_cmp_eq_u32 s97, 0
    s_cbranch_scc1 K2_NP2B
    s_mov_b64 exec, s[68:69]
    s_cbranch_execz K2_G28
    v_lshrrev_b32 v190, 16, v81
    ds_add_rtn_u32 v190, v190, v223 offset:34816
K2_G28:
    s_mov_b64 exec, s[70:71]
    s_cbranch_execz K2_G29
    v_lshrrev_b32 v191, 16, v83
    ds_add_rtn_u32 v191, v191, v223 offset:34816
K2_G29:
    s_mov_b64 exec, s[72:73]
    s_cbranch_execz K2_G30
    v_lshrrev_b32 v192, 16, v85
    ds_add_rtn_u32 v192, v192, v223 offset:34816
K2_G30:
    s_mov_b64 exec, s[74:75]
    s_cbranch_execz K2_G31
    v_lshrrev_b32 v193, 16, v87
    ds_add_rtn_u32 v193, v193, v223 offset:34816
K2_G31:
    s_mov_b64 exec, s[76:77]
    s_cbranch_execz K2_G32
    v_lshrrev_b32 v194, 16, v89
    ds_add_rtn_u32 v194, v194, v223 offset:34816
K2_G32:
    s_mov_b64 exec, s[78:79]
    s_cbranch_execz K2_G33
    v_lshrrev_b32 v195, 16, v91
    ds_add_rtn_u32 v195, v195, v223 offset:34816
K2_G33:
    s_mov_b64 exec, s[80:81]
    s_cbranch_execz K2_G34
    v_lshrrev_b32 v196, 16, v93
    ds_add_rtn_u32 v196, v196, v223 offset:34816
K2_G34:
    s_mov_b64 exec, s[82:83]
    s_cbranch_execz K2_G35
    v_lshrrev_b32 v197, 16, v95
    ds_add_rtn_u32 v197, v197, v223 offset:34816
K2_G35:
    s_mov_b64 exec, s[84:85]
    s_cbranch_execz K2_G36
    v_lshrrev_b32 v198, 16, v97
    ds_add_rtn_u32 v198, v198, v223 offset:34816
K2_G36:
K2_NP2B:
    s_mov_b64 exec, -1
K2_B1:
    s_cmp_lg_u32 s5, 0
    s_waitcnt lgkmcnt(0)
    s_barrier
    s_cbranch_scc1 K2_W2
    v_lshlrev_b32 v222, 1, v203
    ds_read_b128 v[0:3], v222 offset:34816
    ds_read_b128 v[4:7], v222 offset:34832
    ds_read_b128 v[8:11], v222 offset:36864
    ds_read_b128 v[12:15], v222 offset:36880
    ds_read_b128 v[16:19], v222 offset:38912
    ds_read_b128 v[20:23], v222 offset:38928
    ds_read_b128 v[24:27], v222 offset:40960
    ds_read_b128 v[28:31], v222 offset:40976
    s_waitcnt lgkmcnt(6)
    v_add3_u32 v76, v0, v1, v2
    v_add3_u32 v80, v3, v4, v5
    v_add3_u32 v76, v76, v6, v7
    v_add_u32 v76, v76, v80
    s_waitcnt lgkmcnt(4)
    v_add3_u32 v77, v8, v9, v10
    v_add3_u32 v81, v11, v12, v13
    v_add3_u32 v77, v77, v14, v15
    v_add_u32 v77, v77, v81
    s_waitcnt lgkmcnt(2)
    v_add3_u32 v78, v16, v17, v18
    v_add3_u32 v82, v19, v20, v21
    v_add3_u32 v78, v78, v22, v23
    v_add_u32 v78, v78, v82
    s_waitcnt lgkmcnt(0)
    v_add3_u32 v79, v24, v25, v26
    v_add3_u32 v83, v27, v28, v29
    v_add3_u32 v79, v79, v30, v31
    v_add_u32 v79, v79, v83
    v_add_u32 v82, v76, v77
    v_add_u32 v83, v82, v78
    v_add_u32 v220, v83, v79
    v_mov_b32 v221, v220
    s_nop 1
    v_add_u32_dpp v221, v221, v221 row_shr:1 row_mask:0xf bank_mask:0xf
    s_nop 1
    v_add_u32_dpp v221, v221, v221 row_shr:2 row_mask:0xf bank_mask:0xf
    s_nop 1
    v_add_u32_dpp v221, v221, v221 row_shr:4 row_mask:0xf bank_mask:0xf
    s_nop 1
    v_add_u32_dpp v221, v221, v221 row_shr:8 row_mask:0xf bank_mask:0xf
    s_nop 1
    v_add_u32_dpp v221, v221, v221 row_bcast:15 row_mask:0xa bank_mask:0xf
    s_nop 1
    v_add_u32_dpp v221, v221, v221 row_bcast:31 row_mask:0xc bank_mask:0xf
    v_sub_u32 v80, v221, v220
    v_add_u32 v81, v80, v76
    v_add_u32 v82, v80, v82
    v_add_u32 v83, v80, v83
    s_movk_i32 s95, 2560
    v_lshl_add_u32 v140, v80, 3, s95
    v_lshl_add_u32 v141, v0, 3, v140
    v_lshl_add_u32 v142, v1, 3, v141
    v_lshl_add_u32 v143, v2, 3, v142
    ds_write_b128 v222, v[140:143] offset:34816
    v_lshl_add_u32 v144, v3, 3, v143
    v_lshl_add_u32 v145, v4, 3, v144
    v_lshl_add_u32 v146, v5, 3, v145
    v_lshl_add_u32 v147, v6, 3, v146
    ds_write_b128 v222, v[144:147] offset:34832
    v_lshl_add_u32 v148, v81, 3, s95
    v_lshl_add_u32 v149, v8, 3, v148
    v_lshl_add_u32 v150, v9, 3, v149
    v_lshl_add_u32 v151, v10, 3, v150
    ds_write_b128 v222, v[148:151] offset:36864
    v_lshl_add_u32 v152, v11, 3, v151
    v_lshl_add_u32 v153, v12, 3, v152
    v_lshl_add_u32 v154, v13, 3, v153
    v_lshl_add_u32 v155, v14, 3, v154
    ds_write_b128 v222, v[152:155] offset:36880
    v_lshl_add_u32 v156, v82, 3, s95
    v_lshl_add_u32 v157, v16, 3, v156
    v_lshl_add_u32 v158, v17, 3, v157
    v_lshl_add_u32 v159, v18, 3, v158
    ds_write_b128 v222, v[156:159] offset:38912
    v_lshl_add_u32 v160, v19, 3, v159
    v_lshl_add_u32 v161, v20, 3, v160
    v_lshl_add_u32 v162, v21, 3, v161
    v_lshl_add_u32 v163, v22, 3, v162
    ds_write_b128 v222, v[160:163] offset:38928
    v_lshl_add_u32 v164, v83, 3, s95
    v_lshl_add_u32 v165, v24, 3, v164
    v_lshl_add_u32 v166, v25, 3, v165
    v_lshl_add_u32 v167, v26, 3, v166
    ds_write_b128 v222, v[164:167] offset:40960
    v_lshl_add_u32 v168, v27, 3, v167
    v_lshl_add_u32 v169, v28, 3, v168
    v_lshl_add_u32 v170, v29, 3, v169
    v_lshl_add_u32 v171, v30, 3, v170
    ds_write_b128 v222, v[168:171] offset:40976
    s_mov_b32 exec_lo, 0
    s_brev_b32 exec_hi, 1
    ds_write_b32 v228, v221 offset:100
    s_mov_b64 exec, -1
K2_W2:
    s_cmp_ge_u32 s5, 6
    s_cbranch_scc1 K2_NWH
    s_mul_i32 s95, s5, 2048
    s_add_u32 m0, s95, 125952
    s_add_u32 s95, s95, 7561216
    buffer_load_dwordx4 v203, s[20:23], s95 offen offset:0 lds
    buffer_load_dwordx4 v203, s[20:23], s95 offen offset:1024 lds
K2_NWH:
    s_cmp_eq_u32 s5, 0
    s_cbranch_scc1 K2_NFT
    s_mov_b32 s95, 1835008
    s_mov_b64 exec, s[32:33]
    v_and_or_b32 v140, v45, s95, v172
    v_lshrrev_b32 v141, 18, v45
    v_cmpx_gt_u32 vcc, 1, v140
    ds_write_b64 v141, v[44:45] offset:43008
    s_mov_b64 exec, s[34:35]
    v_and_or_b32 v142, v47, s95, v173
    v_lshrrev_b32 v143, 18, v47
    v_cmpx_gt_u32 vcc, 1, v142
    ds_write_b64 v143, v[46:47] offset:43008
    s_mov_b64 exec, s[36:37]
    v_and_or_b32 v144, v49, s95, v174
    v_lshrrev_b32 v145, 18, v49
    v_cmpx_gt_u32 vcc, 1, v144
    ds_write_b64 v145, v[48:49] offset:43008
    s_mov_b64 exec, s[38:39]
    v_and_or_b32 v146, v51, s95, v175
    v_lshrrev_b32 v147, 18, v51
    v_cmpx_gt_u32 vcc, 1, v146
    ds_write_b64 v147, v[50:51] offset:43008
    s_mov_b64 exec, s[40:41]
    v_and_or_b32 v148, v53, s95, v176
    v_lshrrev_b32 v149, 18, v53
    v_cmpx_gt_u32 vcc, 1, v148
    ds_write_b64 v149, v[52:53] offset:43008
    s_mov_b64 exec, s[42:43]
    v_and_or_b32 v150, v55, s95, v177
    v_lshrrev_b32 v151, 18, v55
    v_cmpx_gt_u32 vcc, 1, v150
    ds_write_b64 v151, v[54:55] offset:43008
    s_mov_b64 exec, s[44:45]
    v_and_or_b32 v152, v57, s95, v178
    v_lshrrev_b32 v153, 18, v57
    v_cmpx_gt_u32 vcc, 1, v152
    ds_write_b64 v153, v[56:57] offset:43008
    s_mov_b64 exec, s[46:47]
    v_and_or_b32 v154, v59, s95, v179
    v_lshrrev_b32 v155, 18, v59
    v_cmpx_gt_u32 vcc, 1, v154
    ds_write_b64 v155, v[58:59] offset:43008
    s_mov_b64 exec, s[48:49]
    v_and_or_b32 v156, v61, s95, v180
    v_lshrrev_b32 v157, 18, v61
    v_cmpx_gt_u32 vcc, 1, v156
    ds_write_b64 v157, v[60:61] offset:43008
    s_mov_b64 exec, -1
    s_mul_i32 s95, s5, 224
    v_lshrrev_b32 v140, 1, v203
    v_add_u32 v140, s95, v140
K2_NFT:
    s_cmp_eq_u32 s5, 0
    s_waitcnt lgkmcnt(0)
    s_barrier
    ds_read_b64 v[232:233], v228 offset:96
    s_cbranch_scc1 K2_NOS1
    ds_read_b64 v[140:141], v140 offset:42784
    s_mov_b64 exec, s[32:33]
    v_lshrrev_b32 v98, 16, v45
    ds_read_b32 v98, v98 offset:34816
    s_mov_b64 exec, s[34:35]
    v_lshrrev_b32 v99, 16, v47
    ds_read_b32 v99, v99 offset:34816
    s_mov_b64 exec, s[36:37]
    v_lshrrev_b32 v100, 16, v49
    ds_read_b32 v100, v100 offset:34816
    s_mov_b64 exec, s[38:39]
    v_lshrrev_b32 v101, 16, v51
    ds_read_b32 v101, v101 offset:34816
    s_mov_b64 exec, s[40:41]
    v_lshrrev_b32 v102, 16, v53
    ds_read_b32 v102, v102 offset:34816
    s_mov_b64 exec, s[42:43]
    v_lshrrev_b32 v103, 16, v55
    ds_read_b32 v103, v103 offset:34816
    s_mov_b64 exec, s[44:45]
    v_lshrrev_b32 v104, 16, v57
    ds_read_b32 v104, v104 offset:34816
    s_mov_b64 exec, s[46:47]
    v_lshrrev_b32 v105, 16, v59
    ds_read_b32 v105, v105 offset:34816
    s_mov_b64 exec, s[48:49]
    v_lshrrev_b32 v106, 16, v61
    ds_read_b32 v106, v106 offset:34816
    s_mov_b64 exec, -1
    s_waitcnt lgkmcnt(9)
    v_and_b32 v141, 0xffff, v141
    s_mov_b64 exec, 0xfffffff
    buffer_load_dword v202, v140, s[12:15], 0 idxen
    buffer_load_dword v202, v141, s[8:11], 0 idxen
    buffer_load_dword v202, v141, s[16:19], 0 idxen
    s_mov_b64 exec, s[50:51]
    s_cbranch_execz K2_G37
    v_lshrrev_b32 v220, 16, v63
    ds_read_b32 v220, v220 offset:34816
K2_G37:
    s_mov_b64 exec, s[52:53]
    s_cbranch_execz K2_G38
    v_lshrrev_b32 v221, 16, v65
    ds_read_b32 v221, v221 offset:34816
K2_G38:
    s_mov_b64 exec, s[54:55]
    s_cbranch_execz K2_G39
    v_lshrrev_b32 v222, 16, v67
    ds_read_b32 v222, v222 offset:34816
K2_G39:
    s_mov_b64 exec, s[56:57]
    s_cbranch_execz K2_G40
    v_lshrrev_b32 v223, 16, v69
    ds_read_b32 v223, v223 offset:34816
K2_G40:
    s_mov_b64 exec, s[58:59]
    s_cbranch_execz K2_G41
    v_lshrrev_b32 v224, 16, v71
    ds_read_b32 v224, v224 offset:34816
K2_G41:
    s_mov_b64 exec, s[60:61]
    s_cbranch_execz K2_G42
    v_lshrrev_b32 v225, 16, v73
    ds_read_b32 v225, v225 offset:34816
K2_G42:
    s_mov_b64 exec, s[62:63]
    s_cbranch_execz K2_G43
    v_lshrrev_b32 v226, 16, v75
    ds_read_b32 v226, v226 offset:34816
K2_G43:
    s_mov_b64 exec, s[64:65]
    s_cbranch_execz K2_G44
    v_lshrrev_b32 v227, 16, v77
    ds_read_b32 v227, v227 offset:34816
K2_G44:
    s_mov_b64 exec, s[66:67]
    s_cbranch_execz K2_G45
    v_lshrrev_b32 v228, 16, v79
    ds_read_b32 v228, v228 offset:34816
K2_G45:
    s_mov_b64 exec, -1
K2_NOS1:
    s_waitcnt lgkmcnt(0)
    v_readfirstlane_b32 s98, v233
    v_readfirstlane_b32 s93, v232
    s_cmp_le_u32 s98, 3776
    s_cbranch_scc1 K2_FITS
    s_cmp_eq_u32 s92, 15
    s_cbranch_scc1 K2_END0
    s_mov_b32 s92, 15
    s_waitcnt vmcnt(0)
    s_barrier
    s_branch K2_TOP
K2_FITS:
    s_cmp_eq_u32 s5, 0
    s_cbranch_scc1 K2_PLAN
    s_mov_b64 exec, s[32:33]
    v_lshl_add_u32 v98, v172, 3, v98
    ds_write_b64 v98, v[44:45]
    s_mov_b64 exec, s[34:35]
    v_lshl_add_u32 v99, v173, 3, v99
    ds_write_b64 v99, v[46:47]
    s_mov_b64 exec, s[36:37]
    v_lshl_add_u32 v100, v174, 3, v100
    ds_write_b64 v100, v[48:49]
    s_mov_b64 exec, s[38:39]
    v_lshl_add_u32 v101, v175, 3, v101
    ds_write_b64 v101, v[50:51]
    s_mov_b64 exec, s[40:41]
    v_lshl_add_u32 v102, v176, 3, v102
    ds_write_b64 v102, v[52:53]
    s_mov_b64 exec, s[42:43]
    v_lshl_add_u32 v103, v177, 3, v103
    ds_write_b64 v103, v[54:55]
    s_mov_b64 exec, s[44:45]
    v_lshl_add_u32 v104, v178, 3, v104
    ds_write_b64 v104, v[56:57]
    s_mov_b64 exec, s[46:47]
    v_lshl_add_u32 v105, v179, 3, v105
    ds_write_b64 v105, v[58:59]
    s_mov_b64 exec, s[48:49]
    v_lshl_add_u32 v106, v180, 3, v106
    ds_write_b64 v106, v[60:61]
    s_mov_b64 exec, s[50:51]
    s_cbranch_execz K2_G46
    v_lshl_add_u32 v220, v181, 3, v220
    ds_write_b64 v220, v[62:63]
K2_G46:
    s_mov_b64 exec, s[52:53]
    s_cbranch_execz K2_G47
    v_lshl_add_u32 v221, v182, 3, v221
    ds_write_b64 v221, v[64:65]
K2_G47:
    s_mov_b64 exec, s[54:55]
    s_cbranch_execz K2_G48
    v_lshl_add_u32 v222, v183, 3, v222
    ds_write_b64 v222, v[66:67]
K2_G48:
    s_mov_b64 exec, s[56:57]
    s_cbranch_execz K2_G49
    v_lshl_add_u32 v223, v184, 3, v223
    ds_write_b64 v223, v[68:69]
K2_G49:
    s_mov_b64 exec, s[58:59]
    s_cbranch_execz K2_G50
    v_lshl_add_u32 v224, v185, 3, v224
    ds_write_b64 v224, v[70:71]
K2_G50:
    s_mov_b64 exec, s[60:61]
    s_cbranch_execz K2_G51
    v_lshl_add_u32 v225, v186, 3, v225
    ds_write_b64 v225, v[72:73]
K2_G51:
    s_mov_b64 exec, s[62:63]
    s_cbranch_execz K2_G52
    v_lshl_add_u32 v226, v187, 3, v226
    ds_write_b64 v226, v[74:75]
K2_G52:
    s_mov_b64 exec, s[64:65]
    s_cbranch_execz K2_G53
    v_lshl_add_u32 v227, v188, 3, v227
    ds_write_b64 v227, v[76:77]
K2_G53:
    s_mov_b64 exec, s[66:67]
    s_cbranch_execz K2_G54
    v_lshl_add_u32 v228, v189, 3, v228
    ds_write_b64 v228, v[78:79]
K2_G54:
    s_cmp_eq_u32 s97, 0
    s_cbranch_scc1 K2_B3
    s_mov_b64 exec, s[68:69]
    s_cbranch_execz K2_G55
    v_lshrrev_b32 v98, 16, v81
    ds_read_b32 v98, v98 offset:34816
K2_G55:
    s_mov_b64 exec, s[70:71]
    s_cbranch_execz K2_G56
    v_lshrrev_b32 v99, 16, v83
    ds_read_b32 v99, v99 offset:34816
K2_G56:
    s_mov_b64 exec, s[72:73]
    s_cbranch_execz K2_G57
    v_lshrrev_b32 v100, 16, v85
    ds_read_b32 v100, v100 offset:34816
K2_G57:
    s_mov_b64 exec, s[74:75]
    s_cbranch_execz K2_G58
    v_lshrrev_b32 v101, 16, v87
    ds_read_b32 v101, v101 offset:34816
K2_G58:
    s_mov_b64 exec, s[76:77]
    s_cbranch_execz K2_G59
    v_lshrrev_b32 v102, 16, v89
    ds_read_b32 v102, v102 offset:34816
K2_G59:
    s_mov_b64 exec, s[78:79]
    s_cbranch_execz K2_G60
    v_lshrrev_b32 v103, 16, v91
    ds_read_b32 v103, v103 offset:34816
K2_G60:
    s_mov_b64 exec, s[80:81]
    s_cbranch_execz K2_G61
    v_lshrrev_b32 v104, 16, v93
    ds_read_b32 v104, v104 offset:34816
K2_G61:
    s_mov_b64 exec, s[82:83]
    s_cbranch_execz K2_G62
    v_lshrrev_b32 v105, 16, v95
    ds_read_b32 v105, v105 offset:34816
K2_G62:
    s_mov_b64 exec, s[84:85]
    s_cbranch_execz K2_G63
    v_lshrrev_b32 v106, 16, v97
    ds_read_b32 v106, v106 offset:34816
K2_G63:
    s_waitcnt lgkmcnt(0)
    s_mov_b64 exec, s[68:69]
    s_cbranch_execz K2_G64
    v_lshl_add_u32 v98, v190, 3, v98
    ds_write_b64 v98, v[80:81]
K2_G64:
    s_mov_b64 exec, s[70:71]
    s_cbranch_execz K2_G65
    v_lshl_add_u32 v99, v191, 3, v99
    ds_write_b64 v99, v[82:83]
K2_G65:
    s_mov_b64 exec, s[72:73]
    s_cbranch_execz K2_G66
    v_lshl_add_u32 v100, v192, 3, v100
    ds_write_b64 v100, v[84:85]
K2_G66:
    s_mov_b64 exec, s[74:75]
    s_cbranch_execz K2_G67
    v_lshl_add_u32 v101, v193, 3, v101
    ds_write_b64 v101, v[86:87]
K2_G67:
    s_mov_b64 exec, s[76:77]
    s_cbranch_execz K2_G68
    v_lshl_add_u32 v102, v194, 3, v102
    ds_write_b64 v102, v[88:89]
K2_G68:
    s_mov_b64 exec, s[78:79]
    s_cbranch_execz K2_G69
    v_lshl_add_u32 v103, v195, 3, v103
    ds_write_b64 v103, v[90:91]
K2_G69:
    s_mov_b64 exec, s[80:81]
    s_cbranch_execz K2_G70
    v_lshl_add_u32 v104, v196, 3, v104
    ds_write_b64 v104, v[92:93]
K2_G70:
    s_mov_b64 exec, s[82:83]
    s_cbranch_execz K2_G71
    v_lshl_add_u32 v105, v197, 3, v105
    ds_write_b64 v105, v[94:95]
K2_G71:
    s_mov_b64 exec, s[84:85]
    s_cbranch_execz K2_G72
    v_lshl_add_u32 v106, v198, 3, v106
    ds_write_b64 v106, v[96:97]
K2_G72:
    s_branch K2_B3
K2_PLAN:
    s_mul_i32 s99, s98, 3
    s_lshr_b32 s99, s99, 9
    s_max_u32 s99, s99, 1
    v_cvt_f32_u32 v84, v76
    v_add_f32 v84, -0.5, v84
    v_max_f32 v104, v104, v84
    v_cvt_f32_u32 v85, v77
    v_add_f32 v85, -0.5, v85
    v_max_f32 v105, v105, v85
    v_cvt_f32_u32 v86, v78
    v_add_f32 v86, -0.5, v86
    v_max_f32 v106, v106, v86
    v_cvt_f32_u32 v87, v79
    v_add_f32 v87, -0.5, v87
    v_max_f32 v107, v107, v87
K2_DLOOP:
    v_cvt_f32_u32 v220, s99
    v_rcp_f32 v221, v220
    v_add_f32 v88, v104, v220
    v_add_f32 v89, v105, v220
    v_add_f32 v90, v106, v220
    v_add_f32 v91, v107, v220
    v_mul_f32 v88, v88, v221
    v_cvt_u32_f32 v88, v88
    v_mul_f32 v89, v89, v221
    v_cvt_u32_f32 v89, v89
    v_mul_f32 v90, v90, v221
    v_cvt_u32_f32 v90, v90
    v_mul_f32 v91, v91, v221
    v_cvt_u32_f32 v91, v91
    v_add_u32 v222, v88, v89
    v_add3_u32 v222, v222, v90, v91
    s_nop 1
    v_add_u32_dpp v222, v222, v222 row_shr:1 row_mask:0xf bank_mask:0xf
    s_nop 1
    v_add_u32_dpp v222, v222, v222 row_shr:2 row_mask:0xf bank_mask:0xf
    s_nop 1
    v_add_u32_dpp v222, v222, v222 row_shr:4 row_mask:0xf bank_mask:0xf
    s_nop 1
    v_add_u32_dpp v222, v222, v222 row_shr:8 row_mask:0xf bank_mask:0xf
    s_nop 1
    v_add_u32_dpp v222, v222, v222 row_bcast:15 row_mask:0xa bank_mask:0xf
    s_nop 1
    v_add_u32_dpp v222, v222, v222 row_bcast:31 row_mask:0xc bank_mask:0xf
    s_nop 0
    v_readlane_b32 s95, v222, 63
    s_add_u32 s99, s99, 1
    s_cmp_gt_u32 s95, 255
    s_cbranch_scc1 K2_DLOOP
    v_cvt_f32_u32 v92, v88
    v_rcp_f32 v96, v92
    v_add_f32 v92, v92, v84
    v_cmp_eq_u32_e64 s[48:49], 1, v88
    v_lshlrev_b32 v44, 16, v88
    v_cvt_f32_u32 v93, v89
    v_rcp_f32 v97, v93
    v_add_f32 v93, v93, v85
    v_cmp_eq_u32_e64 s[50:51], 1, v89
    v_lshlrev_b32 v45, 16, v89
    v_cvt_f32_u32 v94, v90
    v_rcp_f32 v98, v94
    v_add_f32 v94, v94, v86
    v_cmp_eq_u32_e64 s[52:53], 1, v90
    v_lshlrev_b32 v46, 16, v90
    v_cvt_f32_u32 v95, v91
    v_rcp_f32 v99, v95
    v_add_f32 v95, v95, v87
    v_cmp_eq_u32_e64 s[54:55], 1, v91
    v_lshlrev_b32 v47, 16, v91
    v_cndmask_b32_e64 v44, v44, 1, s[48:49]
    v_cndmask_b32_e64 v45, v45, 1, s[50:51]
    v_cndmask_b32_e64 v46, v46, 1, s[52:53]
    v_cndmask_b32_e64 v47, v47, 1, s[54:55]
    v_mul_f32 v92, v92, v96
    v_cvt_u32_f32 v92, v92
    v_sub_u32 v96, 63, v92
    v_lshlrev_b32 v96, 2, v96
    ds_add_rtn_u32 v100, v96, v44 offset:128
    v_mul_f32 v93, v93, v97
    v_cvt_u32_f32 v93, v93
    v_sub_u32 v97, 63, v93
    v_lshlrev_b32 v97, 2, v97
    ds_add_rtn_u32 v101, v97, v45 offset:128
    v_mul_f32 v94, v94, v98
    v_cvt_u32_f32 v94, v94
    v_sub_u32 v98, 63, v94
    v_lshlrev_b32 v98, 2, v98
    ds_add_rtn_u32 v102, v98, v46 offset:128
    v_mul_f32 v95, v95, v99
    v_cvt_u32_f32 v95, v95
    v_sub_u32 v99, 63, v95
    v_lshlrev_b32 v99, 2, v99
    ds_add_rtn_u32 v103, v99, v47 offset:128
    v_lshrrev_b32 v220, 2, v203
    ds_read_b32 v221, v220 offset:128
    v_add_u32 v222, 0, v250
    v_lshl_or_b32 v172, v222, 24, v140
    v_lshl_or_b32 v172, v92, 18, v172
    v_lshlrev_b32 v173, 3, v88
    v_sub_u32 v222, 1, v92
    v_mad_i32_i24 v76, v222, v88, v76
    v_add_u32 v222, 64, v250
    v_lshl_or_b32 v174, v222, 24, v148
    v_lshl_or_b32 v174, v93, 18, v174
    v_lshlrev_b32 v175, 3, v89
    v_sub_u32 v222, 1, v93
    v_mad_i32_i24 v77, v222, v89, v77
    v_add_u32 v222, 128, v250
    v_lshl_or_b32 v176, v222, 24, v156
    v_lshl_or_b32 v176, v94, 18, v176
    v_lshlrev_b32 v177, 3, v90
    v_sub_u32 v222, 1, v94
    v_mad_i32_i24 v78, v222, v90, v78
    v_add_u32 v222, 192, v250
    v_lshl_or_b32 v178, v222, 24, v164
    v_lshl_or_b32 v178, v95, 18, v178
    v_lshlrev_b32 v179, 3, v91
    v_sub_u32 v222, 1, v95
    v_mad_i32_i24 v79, v222, v91, v79
    v_max3_u32 v224, v88, v89, v90
    v_max_u32 v224, v224, v91
    v_mov_b32 v225, -262136
    s_mov_b32 s99, 0
    s_waitcnt lgkmcnt(0)
    v_mov_b32 v222, v221
    v_and_b32 v57, 0xffff, v221
    v_cmp_ne_u32 vcc, 0, v57
    v_and_b32 v52, 0xffff, v100
    v_lshrrev_b32 v100, 16, v100
    v_add_u32_dpp v222, v222, v222 row_shr:1 row_mask:0xf bank_mask:0xf
    v_min_u32 v48, 1, v52
    v_cndmask_b32_e64 v100, v100, v52, s[48:49]
    v_add_u32_dpp v222, v222, v222 row_shr:2 row_mask:0xf bank_mask:0xf
    v_mad_i32_i24 v48, v48, -10, 20
    v_cndmask_b32_e64 v48, 0, v48, s[48:49]
    v_add_u32_dpp v222, v222, v222 row_shr:4 row_mask:0xf bank_mask:0xf
    v_and_b32 v53, 0xffff, v101
    v_lshrrev_b32 v101, 16, v101
    v_add_u32_dpp v222, v222, v222 row_shr:8 row_mask:0xf bank_mask:0xf
    v_min_u32 v49, 1, v53
    v_cndmask_b32_e64 v101, v101, v53, s[50:51]
    v_add_u32_dpp v222, v222, v222 row_bcast:15 row_mask:0xa bank_mask:0xf
    v_mad_i32_i24 v49, v49, -10, 20
    v_cndmask_b32_e64 v49, 0, v49, s[50:51]
    v_add_u32_dpp v222, v222, v222 row_bcast:31 row_mask:0xc bank_mask:0xf
    v_lshrrev_b32 v58, 16, v222
    v_cndmask_b32 v56, 0, v58, vcc
    v_sub_u32 v222, v222, v221
    v_and_b32 v54, 0xffff, v102
    v_lshrrev_b32 v102, 16, v102
    v_max_u32_dpp v56, v56, v56 row_shr:1 row_mask:0xf bank_mask:0xf
    v_min_u32 v50, 1, v54
    v_cndmask_b32_e64 v102, v102, v54, s[52:53]
    v_max_u32_dpp v56, v56, v56 row_shr:2 row_mask:0xf bank_mask:0xf
    v_mad_i32_i24 v50, v50, -10, 20
    v_cndmask_b32_e64 v50, 0, v50, s[52:53]
    v_max_u32_dpp v56, v56, v56 row_shr:4 row_mask:0xf bank_mask:0xf
    v_and_b32 v55, 0xffff, v103
    v_lshrrev_b32 v103, 16, v103
    v_max_u32_dpp v56, v56, v56 row_shr:8 row_mask:0xf bank_mask:0xf
    v_min_u32 v51, 1, v55
    v_cndmask_b32_e64 v103, v103, v55, s[54:55]
    v_max_u32_dpp v56, v56, v56 row_bcast:15 row_mask:0xa bank_mask:0xf
    v_mad_i32_i24 v51, v51, -10, 20
    v_cndmask_b32_e64 v51, 0, v51, s[54:55]
    v_max_u32_dpp v56, v56, v56 row_bcast:31 row_mask:0xc bank_mask:0xf
    v_and_b32 v57, 0xffff, v222
    v_and_b32 v221, 1, v222
    v_mov_b32_dpp v56, v56 wave_shr:1 row_mask:0xf bank_mask:0xf
    v_cmp_eq_u32 vcc, 1, v221
    v_lshrrev_b32 v222, 16, v222
    v_add3_u32 v222, v222, v57, v221
    v_cndmask_b32 v56, v58, v56, vcc
    v_add_u32 v58, v58, v57
    v_add_u32 v56, v56, v57
    v_lshl_or_b32 v222, v58, 10, v222
    v_lshl_or_b32 v222, v56, 20, v222
    ds_bpermute_b32 v96, v96, v222
    ds_bpermute_b32 v97, v97, v222
    ds_bpermute_b32 v98, v98, v222
    ds_bpermute_b32 v99, v99, v222
    s_waitcnt lgkmcnt(3)
    v_bfe_u32 v96, v96, v48, 10
    v_add_lshl_u32 v96, v96, v100, 2
    v_lshl_or_b32 v222, v88, 16, v96
    v_lshlrev_b32 v96, 1, v96
    ds_write_b32 v220, v222 offset:32768
    s_waitcnt lgkmcnt(3)
    v_bfe_u32 v97, v97, v49, 10
    v_add_lshl_u32 v97, v97, v101, 2
    v_lshl_or_b32 v222, v89, 16, v97
    v_lshlrev_b32 v97, 1, v97
    ds_write_b32 v220, v222 offset:33024
    s_waitcnt lgkmcnt(3)
    v_bfe_u32 v98, v98, v50, 10
    v_add_lshl_u32 v98, v98, v102, 2
    v_lshl_or_b32 v222, v90, 16, v98
    v_lshlrev_b32 v98, 1, v98
    ds_write_b32 v220, v222 offset:33280
    s_waitcnt lgkmcnt(3)
    v_bfe_u32 v99, v99, v51, 10
    v_add_lshl_u32 v99, v99, v103, 2
    v_lshl_or_b32 v222, v91, 16, v99
    v_lshlrev_b32 v99, 1, v99
    ds_write_b32 v220, v222 offset:33536
K2_PLOOP:
    v_cmp_lt_u32_e64 s[32:33], s99, v88
    v_cmp_lt_u32_e64 s[34:35], s99, v89
    v_cmp_lt_u32_e64 s[36:37], s99, v90
    v_cmp_lt_u32_e64 s[38:39], s99, v91
    s_add_u32 s99, s99, 1
    v_cmp_eq_u32_e64 s[40:41], s99, v76
    v_cmp_eq_u32_e64 s[42:43], s99, v77
    v_cmp_eq_u32_e64 s[44:45], s99, v78
    v_cmp_eq_u32_e64 s[46:47], s99, v79
    s_mov_b64 exec, s[32:33]
    ds_write_b64 v96, v[172:173] offset:512
    s_mov_b64 exec, s[34:35]
    ds_write_b64 v97, v[174:175] offset:512
    s_mov_b64 exec, s[36:37]
    ds_write_b64 v98, v[176:177] offset:512
    s_mov_b64 exec, s[38:39]
    ds_write_b64 v99, v[178:179] offset:512
    s_mov_b64 exec, -1
    v_cmp_lt_u32 vcc, s99, v224
    v_cndmask_b32_e64 v222, 8, v225, s[40:41]
    v_add_u32 v172, v172, v222
    v_add_u32 v96, 8, v96
    v_cndmask_b32_e64 v222, 8, v225, s[42:43]
    v_add_u32 v174, v174, v222
    v_add_u32 v97, 8, v97
    v_cndmask_b32_e64 v222, 8, v225, s[44:45]
    v_add_u32 v176, v176, v222
    v_add_u32 v98, 8, v98
    v_cndmask_b32_e64 v222, 8, v225, s[46:47]
    v_add_u32 v178, v178, v222
    v_add_u32 v99, 8, v99
    s_cbranch_vccnz K2_PLOOP
    v_mov_b32 v222, s99
    ds_write_b32 v228, v222 offset:104
    s_waitcnt vmcnt(0)
K2_B3:
    s_mov_b64 exec, -1
    s_lshl_b32 s95, s100, 8
    v_and_b32 v220, 31, v250
    v_lshl_add_u32 v220, v220, 3, s95
    s_mov_b32 s6, 0
    s_waitcnt vmcnt(3) lgkmcnt(0)
    s_barrier
    ds_read_b64 v[220:221], v220 offset:512
    ds_read_b32 v222, v229 offset:104
    s_waitcnt lgkmcnt(0)
    v_bfe_u32 v235, v220, 18, 6
    v_and_b32 v207, 0x3ffff, v220
    v_lshrrev_b32 v249, 24, v220
    v_mov_b32 v206, v221
    v_readfirstlane_b32 s97, v222
    v_cmp_lt_u32_e64 s[28:29], s6, v235
    s_add_u32 s6, s6, 1
    v_add_u32 v221, s4, v249
    buffer_load_dwordx2 v[240:241], v221, s[16:19], 0 idxen
    v_cndmask_b32_e64 v203, 0, v207, s[28:29]
    v_add_u32 v207, v207, v206
    ds_read_b32 v218, v203
    ds_read_u16 v203, v203 offset:4
    v_bfe_u32 v220, v249, 1, 3
    v_lshlrev_b32 v220, 4, v220
    v_lshlrev_b32 v221, 2, v219
    v_xor_b32 v220, v220, v221
    v_lshl_add_u32 v220, v249, 7, v220
    v_add_u32 v220, 100352, v220
    v_xor_b32 v221, 16, v220
    v_xor_b32 v222, 32, v220
    v_xor_b32 v223, 48, v220
    s_waitcnt lgkmcnt(0)
    ds_bpermute_b32 v210, v239, v203 offset:0
    ds_bpermute_b32 v212, v239, v203 offset:32
    ds_bpermute_b32 v214, v239, v203 offset:64
    ds_bpermute_b32 v216, v239, v203 offset:96
    ds_read_b128 v[172:175], v220
    ds_read_b128 v[176:179], v221
    ds_read_b128 v[180:183], v222
    ds_read_b128 v[184:187], v223
    buffer_load_dwordx4 v[188:191], v[218:219], s[12:15], 0 idxen offen
    buffer_load_dwordx2 v[200:201], v203, s[16:19], 0 idxen
    v_cmp_lt_u32_e64 s[30:31], s6, v235
    s_add_u32 s6, s6, 1
    s_cmp_eq_u64 s[28:29], 0
    s_cbranch_scc1 K2_EMPTY
    s_waitcnt lgkmcnt(4)
    s_add_u32 m0, s94, 0
    s_nop 0
    buffer_load_dwordx4 v[210:211], s[8:11], 0 idxen offen lds
    s_add_u32 m0, s94, 1024
    s_nop 0
    buffer_load_dwordx4 v[212:213], s[8:11], 0 idxen offen lds
    s_add_u32 m0, s94, 2048
    s_nop 0
    buffer_load_dwordx4 v[214:215], s[8:11], 0 idxen offen lds
    s_add_u32 m0, s94, 3072
    s_nop 0
    buffer_load_dwordx4 v[216:217], s[8:11], 0 idxen offen lds
    v_cndmask_b32_e64 v203, 0, v207, s[30:31]
    v_add_u32 v207, v207, v206
    ds_read_b32 v218, v203
    ds_read_u16 v203, v203 offset:4
    s_waitcnt lgkmcnt(0)
    ds_bpermute_b32 v210, v239, v203 offset:0
    ds_bpermute_b32 v212, v239, v203 offset:32
    ds_bpermute_b32 v214, v239, v203 offset:64
    ds_bpermute_b32 v216, v239, v203 offset:96
    buffer_load_dwordx4 v[192:195], v[218:219], s[12:15], 0 idxen offen
    buffer_load_dwordx2 v[204:205], v203, s[16:19], 0 idxen
    v_cmp_lt_u32_e64 s[32:33], s6, v235
    s_add_u32 s6, s6, 1
    s_waitcnt lgkmcnt(0)
    s_add_u32 m0, s94, 32768
    s_nop 0
    buffer_load_dwordx4 v[210:211], s[8:11], 0 idxen offen lds
    s_add_u32 m0, s94, 33792
    s_nop 0
    buffer_load_dwordx4 v[212:213], s[8:11], 0 idxen offen lds
    s_add_u32 m0, s94, 34816
    s_nop 0
    buffer_load_dwordx4 v[214:215], s[8:11], 0 idxen offen lds
    s_add_u32 m0, s94, 35840
    s_nop 0
    buffer_load_dwordx4 v[216:217], s[8:11], 0 idxen offen lds
    v_cndmask_b32_e64 v203, 0, v207, s[32:33]
    v_add_u32 v207, v207, v206
    ds_read_b32 v218, v203
    ds_read_u16 v203, v203 offset:4
    s_waitcnt lgkmcnt(0)
    ds_bpermute_b32 v210, v239, v203 offset:0
    ds_bpermute_b32 v212, v239, v203 offset:32
    ds_bpermute_b32 v214, v239, v203 offset:64
    ds_bpermute_b32 v216, v239, v203 offset:96
    v_and_b32 v221, 63, v250
    v_lshlrev_b32 v220, 4, v221
    v_lshlrev_b32 v221, 2, v221
    v_add_u32 v220, 138240, v220
    v_lshlrev_b32 v222, 3, v219
    v_add_u32 v221, 156672, v221
    v_add_u32 v222, 157696, v222
    ds_read_b128 v[140:143], v220 offset:0
    ds_read_b128 v[144:147], v220 offset:1024
    ds_read_b128 v[148:151], v220 offset:2048
    ds_read_b128 v[152:155], v220 offset:3072
    ds_read_b128 v[156:159], v220 offset:4096
    ds_read_b128 v[160:163], v220 offset:5120
    ds_read_b128 v[164:167], v220 offset:6144
    ds_read_b128 v[168:171], v220 offset:7168
    ds_read_b128 v[0:3], v220 offset:8192
    ds_read_b128 v[4:7], v220 offset:9216
    ds_read_b128 v[8:11], v220 offset:10240
    ds_read_b128 v[12:15], v220 offset:11264
    ds_read_b128 v[16:19], v220 offset:12288
    ds_read_b128 v[20:23], v220 offset:13312
    ds_read_b128 v[24:27], v220 offset:14336
    ds_read_b128 v[28:31], v220 offset:15360
    ds_read_b128 v[32:35], v220 offset:16384
    ds_read_b128 v[36:39], v220 offset:17408
    ds_read_b32 v40, v221
    ds_read_b32 v42, v221 offset:256
    ds_read_b128 v[108:111], v222 offset:0
    ds_read_b128 v[112:115], v222 offset:16
    ds_read_b128 v[116:119], v222 offset:32
    ds_read_b128 v[120:123], v222 offset:48
    ds_read_b128 v[124:127], v222 offset:64
    ds_read_b128 v[128:131], v222 offset:80
    ds_read_b128 v[132:135], v222 offset:96
    ds_read_b128 v[136:139], v222 offset:112
    v_mov_b32 v76, 0
    v_mov_b32 v77, 0
    v_mov_b32 v78, 0
    v_mov_b32 v79, 0
    v_mov_b32 v80, 0
    v_mov_b32 v81, 0
    v_mov_b32 v82, 0
    v_mov_b32 v83, 0
    v_mov_b32 v84, 0
    v_mov_b32 v85, 0
    v_mov_b32 v86, 0
    v_mov_b32 v87, 0
    v_mov_b32 v88, 0
    v_mov_b32 v89, 0
    v_mov_b32 v90, 0
    v_mov_b32 v91, 0
    v_mov_b32 v92, 0
    v_mov_b32 v93, 0
    v_mov_b32 v94, 0
    v_mov_b32 v95, 0
    v_mov_b32 v96, 0
    v_mov_b32 v97, 0
    v_mov_b32 v98, 0
    v_mov_b32 v99, 0
    v_mov_b32 v100, 0
    v_mov_b32 v101, 0
    v_mov_b32 v102, 0
    v_mov_b32 v103, 0
    v_mov_b32 v104, 0
    v_mov_b32 v105, 0
    v_mov_b32 v106, 0
    v_mov_b32 v107, 0
    v_mov_b32 v244, 0
    v_mov_b32 v245, 0
    v_mov_b32 v246, 0
    v_mov_b32 v247, 0
    s_waitcnt lgkmcnt(0)
    v_mfma_f32_32x32x16_bf16 v[44:59], v[140:143], v[172:175], 0
    v_mfma_f32_32x32x16_bf16 v[60:75], v[156:159], v[172:175], 0
    v_mfma_f32_32x32x16_bf16 v[44:59], v[144:147], v[176:179], v[44:59]
    v_mfma_f32_32x32x16_bf16 v[60:75], v[160:163], v[176:179], v[60:75]
    v_mfma_f32_32x32x16_bf16 v[44:59], v[148:151], v[180:183], v[44:59]
    v_mfma_f32_32x32x16_bf16 v[60:75], v[164:167], v[180:183], v[60:75]
    v_mfma_f32_32x32x16_bf16 v[44:59], v[152:155], v[184:187], v[44:59]
    v_mfma_f32_32x32x16_bf16 v[60:75], v[168:171], v[184:187], v[60:75]
    s_waitcnt vmcnt(6)
    ds_read_b128 v[172:175], v251 offset:0
    ds_read_b128 v[176:179], v252 offset:0
    ds_read_b128 v[180:183], v253 offset:0
    ds_read_b128 v[184:187], v254 offset:0
    v_mov_b32 v242, v241
    v_and_b32 v241, 0xffff0000, v240
    v_lshlrev_b32 v240, 16, v240
    v_lshlrev_b32 v232, 16, v200
    v_and_b32 v233, 0xffff0000, v200
    v_sub_f32 v234, v242, v201
    v_pk_add_f32 v[232:233], v[240:241], v[232:233] neg_lo:[0,1] neg_hi:[0,1]
    v_mul_f32 v208, v232, v232
    v_fmac_f32 v208, v233, v233
    v_fmac_f32 v208, v234, v234
    v_cvt_pk_bf16_f32 v208, v208, v208
    s_waitcnt lgkmcnt(0)
    s_nop 0
    v_mfma_f32_32x32x8_bf16 v[140:155], v[40:41], v[208:209], v[44:59]
    v_mfma_f32_32x32x16_bf16 v[140:155], v[32:35], v[188:191], v[140:155]
    v_mfma_f32_32x32x16_bf16 v[140:155], v[0:3], v[172:175], v[140:155]
    v_mfma_f32_32x32x16_bf16 v[140:155], v[4:7], v[176:179], v[140:155]
    v_mfma_f32_32x32x16_bf16 v[140:155], v[8:11], v[180:183], v[140:155]
    v_mfma_f32_32x32x16_bf16 v[140:155], v[12:15], v[184:187], v[140:155]
    s_nop 7
K2_LOOP:
    v_mfma_f32_32x32x8_bf16 v[156:171], v[42:43], v[208:209], v[60:75]
    s_mov_b64 exec, s[28:29]
    s_nop 1
    v_exp_f32 v220, v140
    v_exp_f32 v221, v141
    v_exp_f32 v222, v142
    v_exp_f32 v223, v143
    v_mfma_f32_32x32x16_bf16 v[156:171], v[36:39], v[188:191], v[156:171]
    v_exp_f32 v224, v144
    v_exp_f32 v225, v145
    s_bitcmp1_b32 s5, 2
    s_cbranch_scc0 K2_VP1
    s_setprio 1
K2_VP1:
    s_waitcnt lgkmcnt(0)
    s_mov_b64 exec, -1
    s_add_u32 m0, s94, 0
    s_nop 0
    buffer_load_dwordx4 v[210:211], s[8:11], 0 idxen offen lds
    s_add_u32 m0, s94, 1024
    s_nop 0
    buffer_load_dwordx4 v[212:213], s[8:11], 0 idxen offen lds
    s_add_u32 m0, s94, 2048
    s_nop 0
    buffer_load_dwordx4 v[214:215], s[8:11], 0 idxen offen lds
    s_add_u32 m0, s94, 3072
    s_nop 0
    buffer_load_dwordx4 v[216:217], s[8:11], 0 idxen offen lds
    s_mov_b64 exec, s[28:29]
    s_setprio 0
    v_exp_f32 v226, v146
    v_exp_f32 v227, v147
    v_pk_add_f32 v[220:221], v[220:221], 1.0 op_sel_hi:[1,0]
    v_pk_add_f32 v[222:223], v[222:223], 1.0 op_sel_hi:[1,0]
    v_pk_add_f32 v[224:225], v[224:225], 1.0 op_sel_hi:[1,0]
    v_pk_add_f32 v[226:227], v[226:227], 1.0 op_sel_hi:[1,0]
    v_mfma_f32_32x32x16_bf16 v[156:171], v[16:19], v[172:175], v[156:171]
    v_rcp_f32 v220, v220
    v_rcp_f32 v221, v221
    v_rcp_f32 v222, v222
    v_rcp_f32 v223, v223
    v_mfma_f32_32x32x16_bf16 v[156:171], v[20:23], v[176:179], v[156:171]
    v_rcp_f32 v224, v224
    v_rcp_f32 v225, v225
    v_rcp_f32 v226, v226
    v_rcp_f32 v227, v227
    v_pk_fma_f32 v[76:77], v[140:141], v[220:221], v[76:77]
    v_pk_fma_f32 v[78:79], v[142:143], v[222:223], v[78:79]
    v_pk_fma_f32 v[80:81], v[144:145], v[224:225], v[80:81]
    v_pk_fma_f32 v[82:83], v[146:147], v[226:227], v[82:83]
    v_pk_mul_f32 v[228:229], v[76:77], v[108:109]
    v_pk_mul_f32 v[230:231], v[78:79], v[110:111]
    v_pk_fma_f32 v[228:229], v[80:81], v[112:113], v[228:229]
    v_pk_fma_f32 v[230:231], v[82:83], v[114:115], v[230:231]
    v_mfma_f32_32x32x16_bf16 v[156:171], v[24:27], v[180:183], v[156:171]
    v_exp_f32 v220, v148
    v_exp_f32 v221, v149
    v_exp_f32 v222, v150
    v_exp_f32 v223, v151
    v_mfma_f32_32x32x16_bf16 v[156:171], v[28:31], v[184:187], v[156:171]
    v_exp_f32 v224, v152
    v_exp_f32 v225, v153
    v_exp_f32 v226, v154
    buffer_load_dwordx4 v[196:199], v[218:219], s[12:15], 0 idxen offen
    buffer_load_dwordx2 v[200:201], v203, s[16:19], 0 idxen
    v_exp_f32 v227, v155
    s_waitcnt vmcnt(6)
    ds_read_b128 v[172:175], v251 offset:32768
    ds_read_b128 v[176:179], v252 offset:32768
    ds_read_b128 v[180:183], v253 offset:32768
    ds_read_b128 v[184:187], v254 offset:32768
    v_cmp_lt_u32_e64 s[34:35], s6, v235
    s_add_u32 s6, s6, 1
    v_lshlrev_b32 v236, 16, v204
    v_and_b32 v237, 0xffff0000, v204
    v_sub_f32 v238, v242, v205
    v_pk_add_f32 v[236:237], v[240:241], v[236:237] neg_lo:[0,1] neg_hi:[0,1]
    v_mul_f32 v208, v236, v236
    v_fmac_f32 v208, v237, v237
    v_fmac_f32 v208, v238, v238
    v_cvt_pk_bf16_f32 v208, v208, v208
    v_cndmask_b32_e64 v203, 0, v207, s[34:35]
    v_add_u32 v207, v207, v206
    ds_read_b32 v218, v203
    ds_read_u16 v203, v203 offset:4
    v_pk_add_f32 v[220:221], v[220:221], 1.0 op_sel_hi:[1,0]
    v_pk_add_f32 v[222:223], v[222:223], 1.0 op_sel_hi:[1,0]
    v_pk_add_f32 v[224:225], v[224:225], 1.0 op_sel_hi:[1,0]
    v_pk_add_f32 v[226:227], v[226:227], 1.0 op_sel_hi:[1,0]
    v_rcp_f32 v220, v220
    v_rcp_f32 v221, v221
    v_rcp_f32 v222, v222
    v_rcp_f32 v223, v223
    v_rcp_f32 v224, v224
    v_rcp_f32 v225, v225
    v_rcp_f32 v226, v226
    v_rcp_f32 v227, v227
    s_waitcnt lgkmcnt(0)
    s_mov_b64 exec, -1
    ds_bpermute_b32 v210, v239, v203 offset:0
    ds_bpermute_b32 v212, v239, v203 offset:32
    ds_bpermute_b32 v214, v239, v203 offset:64
    ds_bpermute_b32 v216, v239, v203 offset:96
    s_mov_b64 exec, s[28:29]
    v_pk_fma_f32 v[84:85], v[148:149], v[220:221], v[84:85]
    v_pk_fma_f32 v[86:87], v[150:151], v[222:223], v[86:87]
    v_pk_fma_f32 v[88:89], v[152:153], v[224:225], v[88:89]
    v_pk_fma_f32 v[90:91], v[154:155], v[226:227], v[90:91]
    v_pk_fma_f32 v[228:229], v[84:85], v[116:117], v[228:229]
    v_pk_fma_f32 v[230:231], v[86:87], v[118:119], v[230:231]
    v_pk_fma_f32 v[228:229], v[88:89], v[120:121], v[228:229]
    v_pk_fma_f32 v[230:231], v[90:91], v[122:123], v[230:231]
    v_mfma_f32_32x32x8_bf16 v[140:155], v[40:41], v[208:209], v[44:59]
    v_exp_f32 v220, v156
    v_exp_f32 v221, v157
    v_exp_f32 v222, v158
    v_exp_f32 v223, v159
    v_mfma_f32_32x32x16_bf16 v[140:155], v[32:35], v[192:195], v[140:155]
    v_exp_f32 v224, v160
    v_exp_f32 v225, v161
    v_exp_f32 v226, v162
    v_exp_f32 v227, v163
    v_pk_add_f32 v[220:221], v[220:221], 1.0 op_sel_hi:[1,0]
    v_pk_add_f32 v[222:223], v[222:223], 1.0 op_sel_hi:[1,0]
    v_pk_add_f32 v[224:225], v[224:225], 1.0 op_sel_hi:[1,0]
    v_pk_add_f32 v[226:227], v[226:227], 1.0 op_sel_hi:[1,0]
    v_mfma_f32_32x32x16_bf16 v[140:155], v[0:3], v[172:175], v[140:155]
    v_rcp_f32 v220, v220
    v_rcp_f32 v221, v221
    v_rcp_f32 v222, v222
    v_rcp_f32 v223, v223
    v_mfma_f32_32x32x16_bf16 v[140:155], v[4:7], v[176:179], v[140:155]
    v_rcp_f32 v224, v224
    v_rcp_f32 v225, v225
    v_rcp_f32 v226, v226
    v_rcp_f32 v227, v227
    v_pk_fma_f32 v[92:93], v[156:157], v[220:221], v[92:93]
    v_pk_fma_f32 v[94:95], v[158:159], v[222:223], v[94:95]
    v_pk_fma_f32 v[96:97], v[160:161], v[224:225], v[96:97]
    v_pk_fma_f32 v[98:99], v[162:163], v[226:227], v[98:99]
    v_pk_fma_f32 v[228:229], v[92:93], v[124:125], v[228:229]
    v_pk_fma_f32 v[230:231], v[94:95], v[126:127], v[230:231]
    v_pk_fma_f32 v[228:229], v[96:97], v[128:129], v[228:229]
    v_pk_fma_f32 v[230:231], v[98:99], v[130:131], v[230:231]
    v_mfma_f32_32x32x16_bf16 v[140:155], v[8:11], v[180:183], v[140:155]
    v_exp_f32 v220, v164
    v_exp_f32 v221, v165
    v_exp_f32 v222, v166
    v_exp_f32 v223, v167
    v_mfma_f32_32x32x16_bf16 v[140:155], v[12:15], v[184:187], v[140:155]
    v_exp_f32 v224, v168
    v_exp_f32 v225, v169
    v_exp_f32 v226, v170
    v_exp_f32 v227, v171
    v_pk_add_f32 v[220:221], v[220:221], 1.0 op_sel_hi:[1,0]
    v_pk_add_f32 v[222:223], v[222:223], 1.0 op_sel_hi:[1,0]
    v_pk_add_f32 v[224:225], v[224:225], 1.0 op_sel_hi:[1,0]
    v_pk_add_f32 v[226:227], v[226:227], 1.0 op_sel_hi:[1,0]
    v_rcp_f32 v220, v220
    v_rcp_f32 v221, v221
    v_rcp_f32 v222, v222
    v_rcp_f32 v223, v223
    v_rcp_f32 v224, v224
    v_rcp_f32 v225, v225
    v_rcp_f32 v226, v226
    v_rcp_f32 v227, v227
    v_pk_fma_f32 v[100:101], v[164:165], v[220:221], v[100:101]
    v_pk_fma_f32 v[102:103], v[166:167], v[222:223], v[102:103]
    v_pk_fma_f32 v[104:105], v[168:169], v[224:225], v[104:105]
    v_pk_fma_f32 v[106:107], v[170:171], v[226:227], v[106:107]
    v_pk_fma_f32 v[228:229], v[100:101], v[132:133], v[228:229]
    v_pk_fma_f32 v[230:231], v[102:103], v[134:135], v[230:231]
    v_pk_fma_f32 v[228:229], v[104:105], v[136:137], v[228:229]
    v_pk_fma_f32 v[230:231], v[106:107], v[138:139], v[230:231]
    v_pk_add_f32 v[228:229], v[228:229], v[230:231]
    s_cmp_eq_u64 s[30:31], 0
    v_add_f32 v243, v228, v229
    v_sub_f32 v248, v243, v247
    v_pk_fma_f32 v[244:245], v[232:233], v[248:249], v[244:245] op_sel_hi:[1,0,1]
    v_fmac_f32 v246, v234, v248
    s_mov_b64 exec, -1
    s_cbranch_scc1 K2_DONE
    v_mfma_f32_32x32x8_bf16 v[156:171], v[42:43], v[208:209], v[60:75]
    s_mov_b64 exec, s[30:31]
    v_exp_f32 v220, v140
    v_exp_f32 v221, v141
    v_exp_f32 v222, v142
    v_exp_f32 v223, v143
    v_mfma_f32_32x32x16_bf16 v[156:171], v[36:39], v[192:195], v[156:171]
    v_exp_f32 v224, v144
    v_exp_f32 v225, v145
    s_bitcmp1_b32 s5, 2
    s_cbranch_scc0 K2_VP3
    s_setprio 1
K2_VP3:
    s_waitcnt lgkmcnt(0)
    s_mov_b64 exec, -1
    s_add_u32 m0, s94, 32768
    s_nop 0
    buffer_load_dwordx4 v[210:211], s[8:11], 0 idxen offen lds
    s_add_u32 m0, s94, 33792
    s_nop 0
    buffer_load_dwordx4 v[212:213], s[8:11], 0 idxen offen lds
    s_add_u32 m0, s94, 34816
    s_nop 0
    buffer_load_dwordx4 v[214:215], s[8:11], 0 idxen offen lds
    s_add_u32 m0, s94, 35840
    s_nop 0
    buffer_load_dwordx4 v[216:217], s[8:11], 0 idxen offen lds
    s_mov_b64 exec, s[30:31]
    s_setprio 0
    v_exp_f32 v226, v146
    v_exp_f32 v227, v147
    v_pk_add_f32 v[220:221], v[220:221], 1.0 op_sel_hi:[1,0]
    v_pk_add_f32 v[222:223], v[222:223], 1.0 op_sel_hi:[1,0]
    v_pk_add_f32 v[224:225], v[224:225], 1.0 op_sel_hi:[1,0]
    v_pk_add_f32 v[226:227], v[226:227], 1.0 op_sel_hi:[1,0]
    v_mfma_f32_32x32x16_bf16 v[156:171], v[16:19], v[172:175], v[156:171]
    v_rcp_f32 v220, v220
    v_rcp_f32 v221, v221
    v_rcp_f32 v222, v222
    v_rcp_f32 v223, v223
    v_mfma_f32_32x32x16_bf16 v[156:171], v[20:23], v[176:179], v[156:171]
    v_rcp_f32 v224, v224
    v_rcp_f32 v225, v225
    v_rcp_f32 v226, v226
    v_rcp_f32 v227, v227
    v_pk_fma_f32 v[76:77], v[140:141], v[220:221], v[76:77]
    v_pk_fma_f32 v[78:79], v[142:143], v[222:223], v[78:79]
    v_pk_fma_f32 v[80:81], v[144:145], v[224:225], v[80:81]
    v_pk_fma_f32 v[82:83], v[146:147], v[226:227], v[82:83]
    v_pk_mul_f32 v[228:229], v[76:77], v[108:109]
    v_pk_mul_f32 v[230:231], v[78:79], v[110:111]
    v_pk_fma_f32 v[228:229], v[80:81], v[112:113], v[228:229]
    v_pk_fma_f32 v[230:231], v[82:83], v[114:115], v[230:231]
    v_mfma_f32_32x32x16_bf16 v[156:171], v[24:27], v[180:183], v[156:171]
    v_exp_f32 v220, v148
    v_exp_f32 v221, v149
    v_exp_f32 v222, v150
    v_exp_f32 v223, v151
    v_mfma_f32_32x32x16_bf16 v[156:171], v[28:31], v[184:187], v[156:171]
    v_exp_f32 v224, v152
    v_exp_f32 v225, v153
    v_exp_f32 v226, v154
    buffer_load_dwordx4 v[188:191], v[218:219], s[12:15], 0 idxen offen
    buffer_load_dwordx2 v[204:205], v203, s[16:19], 0 idxen
    v_exp_f32 v227, v155
    s_waitcnt vmcnt(6)
    ds_read_b128 v[172:175], v251 offset:0
    ds_read_b128 v[176:179], v252 offset:0
    ds_read_b128 v[180:183], v253 offset:0
    ds_read_b128 v[184:187], v254 offset:0
    v_cmp_lt_u32_e64 s[36:37], s6, v235
    s_add_u32 s6, s6, 1
    v_lshlrev_b32 v232, 16, v200
    v_and_b32 v233, 0xffff0000, v200
    v_sub_f32 v234, v242, v201
    v_pk_add_f32 v[232:233], v[240:241], v[232:233] neg_lo:[0,1] neg_hi:[0,1]
    v_mul_f32 v208, v232, v232
    v_fmac_f32 v208, v233, v233
    v_fmac_f32 v208, v234, v234
    v_cvt_pk_bf16_f32 v208, v208, v208
    v_cndmask_b32_e64 v203, 0, v207, s[36:37]
    v_add_u32 v207, v207, v206
    ds_read_b32 v218, v203
    ds_read_u16 v203, v203 offset:4
    v_pk_add_f32 v[220:221], v[220:221], 1.0 op_sel_hi:[1,0]
    v_pk_add_f32 v[222:223], v[222:223], 1.0 op_sel_hi:[1,0]
    v_pk_add_f32 v[224:225], v[224:225], 1.0 op_sel_hi:[1,0]
    v_pk_add_f32 v[226:227], v[226:227], 1.0 op_sel_hi:[1,0]
    v_rcp_f32 v220, v220
    v_rcp_f32 v221, v221
    v_rcp_f32 v222, v222
    v_rcp_f32 v223, v223
    v_rcp_f32 v224, v224
    v_rcp_f32 v225, v225
    v_rcp_f32 v226, v226
    v_rcp_f32 v227, v227
    s_waitcnt lgkmcnt(0)
    s_mov_b64 exec, -1
    ds_bpermute_b32 v210, v239, v203 offset:0
    ds_bpermute_b32 v212, v239, v203 offset:32
    ds_bpermute_b32 v214, v239, v203 offset:64
    ds_bpermute_b32 v216, v239, v203 offset:96
    s_mov_b64 exec, s[30:31]
    v_pk_fma_f32 v[84:85], v[148:149], v[220:221], v[84:85]
    v_pk_fma_f32 v[86:87], v[150:151], v[222:223], v[86:87]
    v_pk_fma_f32 v[88:89], v[152:153], v[224:225], v[88:89]
    v_pk_fma_f32 v[90:91], v[154:155], v[226:227], v[90:91]
    v_pk_fma_f32 v[228:229], v[84:85], v[116:117], v[228:229]
    v_pk_fma_f32 v[230:231], v[86:87], v[118:119], v[230:231]
    v_pk_fma_f32 v[228:229], v[88:89], v[120:121], v[228:229]
    v_pk_fma_f32 v[230:231], v[90:91], v[122:123], v[230:231]
    v_mfma_f32_32x32x8_bf16 v[140:155], v[40:41], v[208:209], v[44:59]
    v_exp_f32 v220, v156
    v_exp_f32 v221, v157
    v_exp_f32 v222, v158
    v_exp_f32 v223, v159
    v_mfma_f32_32x32x16_bf16 v[140:155], v[32:35], v[196:199], v[140:155]
    v_exp_f32 v224, v160
    v_exp_f32 v225, v161
    v_exp_f32 v226, v162
    v_exp_f32 v227, v163
    v_pk_add_f32 v[220:221], v[220:221], 1.0 op_sel_hi:[1,0]
    v_pk_add_f32 v[222:223], v[222:223], 1.0 op_sel_hi:[1,0]
    v_pk_add_f32 v[224:225], v[224:225], 1.0 op_sel_hi:[1,0]
    v_pk_add_f32 v[226:227], v[226:227], 1.0 op_sel_hi:[1,0]
    v_mfma_f32_32x32x16_bf16 v[140:155], v[0:3], v[172:175], v[140:155]
    v_rcp_f32 v220, v220
    v_rcp_f32 v221, v221
    v_rcp_f32 v222, v222
    v_rcp_f32 v223, v223
    v_mfma_f32_32x32x16_bf16 v[140:155], v[4:7], v[176:179], v[140:155]
    v_rcp_f32 v224, v224
    v_rcp_f32 v225, v225
    v_rcp_f32 v226, v226
    v_rcp_f32 v227, v227
    v_pk_fma_f32 v[92:93], v[156:157], v[220:221], v[92:93]
    v_pk_fma_f32 v[94:95], v[158:159], v[222:223], v[94:95]
    v_pk_fma_f32 v[96:97], v[160:161], v[224:225], v[96:97]
    v_pk_fma_f32 v[98:99], v[162:163], v[226:227], v[98:99]
    v_pk_fma_f32 v[228:229], v[92:93], v[124:125], v[228:229]
    v_pk_fma_f32 v[230:231], v[94:95], v[126:127], v[230:231]
    v_pk_fma_f32 v[228:229], v[96:97], v[128:129], v[228:229]
    v_pk_fma_f32 v[230:231], v[98:99], v[130:131], v[230:231]
    v_mfma_f32_32x32x16_bf16 v[140:155], v[8:11], v[180:183], v[140:155]
    v_exp_f32 v220, v164
    v_exp_f32 v221, v165
    v_exp_f32 v222, v166
    v_exp_f32 v223, v167
    v_mfma_f32_32x32x16_bf16 v[140:155], v[12:15], v[184:187], v[140:155]
    v_exp_f32 v224, v168
    v_exp_f32 v225, v169
    v_exp_f32 v226, v170
    v_exp_f32 v227, v171
    v_pk_add_f32 v[220:221], v[220:221], 1.0 op_sel_hi:[1,0]
    v_pk_add_f32 v[222:223], v[222:223], 1.0 op_sel_hi:[1,0]
    v_pk_add_f32 v[224:225], v[224:225], 1.0 op_sel_hi:[1,0]
    v_pk_add_f32 v[226:227], v[226:227], 1.0 op_sel_hi:[1,0]
    v_rcp_f32 v220, v220
    v_rcp_f32 v221, v221
    v_rcp_f32 v222, v222
    v_rcp_f32 v223, v223
    v_rcp_f32 v224, v224
    v_rcp_f32 v225, v225
    v_rcp_f32 v226, v226
    v_rcp_f32 v227, v227
    v_pk_fma_f32 v[100:101], v[164:165], v[220:221], v[100:101]
    v_pk_fma_f32 v[102:103], v[166:167], v[222:223], v[102:103]
    v_pk_fma_f32 v[104:105], v[168:169], v[224:225], v[104:105]
    v_pk_fma_f32 v[106:107], v[170:171], v[226:227], v[106:107]
    v_pk_fma_f32 v[228:229], v[100:101], v[132:133], v[228:229]
    v_pk_fma_f32 v[230:231], v[102:103], v[134:135], v[230:231]
    v_pk_fma_f32 v[228:229], v[104:105], v[136:137], v[228:229]
    v_pk_fma_f32 v[230:231], v[106:107], v[138:139], v[230:231]
    v_pk_add_f32 v[228:229], v[228:229], v[230:231]
    s_cmp_eq_u64 s[32:33], 0
    v_add_f32 v247, v228, v229
    v_sub_f32 v248, v247, v243
    v_pk_fma_f32 v[244:245], v[236:237], v[248:249], v[244:245] op_sel_hi:[1,0,1]
    v_fmac_f32 v246, v238, v248
    s_mov_b64 exec, -1
    s_cbranch_scc1 K2_DONE
    v_mfma_f32_32x32x8_bf16 v[156:171], v[42:43], v[208:209], v[60:75]
    s_mov_b64 exec, s[32:33]
    v_exp_f32 v220, v140
    v_exp_f32 v221, v141
    v_exp_f32 v222, v142
    v_exp_f32 v223, v143
    v_mfma_f32_32x32x16_bf16 v[156:171], v[36:39], v[196:199], v[156:171]
    v_exp_f32 v224, v144
    v_exp_f32 v225, v145
    s_bitcmp1_b32 s5, 2
    s_cbranch_scc0 K2_VP5
    s_setprio 1
K2_VP5:
    s_waitcnt lgkmcnt(0)
    s_mov_b64 exec, -1
    s_add_u32 m0, s94, 0
    s_nop 0
    buffer_load_dwordx4 v[210:211], s[8:11], 0 idxen offen lds
    s_add_u32 m0, s94, 1024
    s_nop 0
    buffer_load_dwordx4 v[212:213], s[8:11], 0 idxen offen lds
    s_add_u32 m0, s94, 2048
    s_nop 0
    buffer_load_dwordx4 v[214:215], s[8:11], 0 idxen offen lds
    s_add_u32 m0, s94, 3072
    s_nop 0
    buffer_load_dwordx4 v[216:217], s[8:11], 0 idxen offen lds
    s_mov_b64 exec, s[32:33]
    s_setprio 0
    v_exp_f32 v226, v146
    v_exp_f32 v227, v147
    v_pk_add_f32 v[220:221], v[220:221], 1.0 op_sel_hi:[1,0]
    v_pk_add_f32 v[222:223], v[222:223], 1.0 op_sel_hi:[1,0]
    v_pk_add_f32 v[224:225], v[224:225], 1.0 op_sel_hi:[1,0]
    v_pk_add_f32 v[226:227], v[226:227], 1.0 op_sel_hi:[1,0]
    v_mfma_f32_32x32x16_bf16 v[156:171], v[16:19], v[172:175], v[156:171]
    v_rcp_f32 v220, v220
    v_rcp_f32 v221, v221
    v_rcp_f32 v222, v222
    v_rcp_f32 v223, v223
    v_mfma_f32_32x32x16_bf16 v[156:171], v[20:23], v[176:179], v[156:171]
    v_rcp_f32 v224, v224
    v_rcp_f32 v225, v225
    v_rcp_f32 v226, v226
    v_rcp_f32 v227, v227
    v_pk_fma_f32 v[76:77], v[140:141], v[220:221], v[76:77]
    v_pk_fma_f32 v[78:79], v[142:143], v[222:223], v[78:79]
    v_pk_fma_f32 v[80:81], v[144:145], v[224:225], v[80:81]
    v_pk_fma_f32 v[82:83], v[146:147], v[226:227], v[82:83]
    v_pk_mul_f32 v[228:229], v[76:77], v[108:109]
    v_pk_mul_f32 v[230:231], v[78:79], v[110:111]
    v_pk_fma_f32 v[228:229], v[80:81], v[112:113], v[228:229]
    v_pk_fma_f32 v[230:231], v[82:83], v[114:115], v[230:231]
    v_mfma_f32_32x32x16_bf16 v[156:171], v[24:27], v[180:183], v[156:171]
    v_exp_f32 v220, v148
    v_exp_f32 v221, v149
    v_exp_f32 v222, v150
    v_exp_f32 v223, v151
    v_mfma_f32_32x32x16_bf16 v[156:171], v[28:31], v[184:187], v[156:171]
    v_exp_f32 v224, v152
    v_exp_f32 v225, v153
    v_exp_f32 v226, v154
    buffer_load_dwordx4 v[192:195], v[218:219], s[12:15], 0 idxen offen
    buffer_load_dwordx2 v[200:201], v203, s[16:19], 0 idxen
    v_exp_f32 v227, v155
    s_waitcnt vmcnt(6)
    ds_read_b128 v[172:175], v251 offset:32768
    ds_read_b128 v[176:179], v252 offset:32768
    ds_read_b128 v[180:183], v253 offset:32768
    ds_read_b128 v[184:187], v254 offset:32768
    v_cmp_lt_u32_e64 s[38:39], s6, v235
    s_add_u32 s6, s6, 1
    v_lshlrev_b32 v236, 16, v204
    v_and_b32 v237, 0xffff0000, v204
    v_sub_f32 v238, v242, v205
    v_pk_add_f32 v[236:237], v[240:241], v[236:237] neg_lo:[0,1] neg_hi:[0,1]
    v_mul_f32 v208, v236, v236
    v_fmac_f32 v208, v237, v237
    v_fmac_f32 v208, v238, v238
    v_cvt_pk_bf16_f32 v208, v208, v208
    v_cndmask_b32_e64 v203, 0, v207, s[38:39]
    v_add_u32 v207, v207, v206
    ds_read_b32 v218, v203
    ds_read_u16 v203, v203 offset:4
    v_pk_add_f32 v[220:221], v[220:221], 1.0 op_sel_hi:[1,0]
    v_pk_add_f32 v[222:223], v[222:223], 1.0 op_sel_hi:[1,0]
    v_pk_add_f32 v[224:225], v[224:225], 1.0 op_sel_hi:[1,0]
    v_pk_add_f32 v[226:227], v[226:227], 1.0 op_sel_hi:[1,0]
    v_rcp_f32 v220, v220
    v_rcp_f32 v221, v221
    v_rcp_f32 v222, v222
    v_rcp_f32 v223, v223
    v_rcp_f32 v224, v224
    v_rcp_f32 v225, v225
    v_rcp_f32 v226, v226
    v_rcp_f32 v227, v227
    s_waitcnt lgkmcnt(0)
    s_mov_b64 exec, -1
    ds_bpermute_b32 v210, v239, v203 offset:0
    ds_bpermute_b32 v212, v239, v203 offset:32
    ds_bpermute_b32 v214, v239, v203 offset:64
    ds_bpermute_b32 v216, v239, v203 offset:96
    s_mov_b64 exec, s[32:33]
    v_pk_fma_f32 v[84:85], v[148:149], v[220:221], v[84:85]
    v_pk_fma_f32 v[86:87], v[150:151], v[222:223], v[86:87]
    v_pk_fma_f32 v[88:89], v[152:153], v[224:225], v[88:89]
    v_pk_fma_f32 v[90:91], v[154:155], v[226:227], v[90:91]
    v_pk_fma_f32 v[228:229], v[84:85], v[116:117], v[228:229]
    v_pk_fma_f32 v[230:231], v[86:87], v[118:119], v[230:231]
    v_pk_fma_f32 v[228:229], v[88:89], v[120:121], v[228:229]
    v_pk_fma_f32 v[230:231], v[90:91], v[122:123], v[230:231]
    v_mfma_f32_32x32x8_bf16 v[140:155], v[40:41], v[208:209], v[44:59]
    v_exp_f32 v220, v156
    v_exp_f32 v221, v157
    v_exp_f32 v222, v158
    v_exp_f32 v223, v159
    v_mfma_f32_32x32x16_bf16 v[140:155], v[32:35], v[188:191], v[140:155]
    v_exp_f32 v224, v160
    v_exp_f32 v225, v161
    v_exp_f32 v226, v162
    v_exp_f32 v227, v163
    v_pk_add_f32 v[220:221], v[220:221], 1.0 op_sel_hi:[1,0]
    v_pk_add_f32 v[222:223], v[222:223], 1.0 op_sel_hi:[1,0]
    v_pk_add_f32 v[224:225], v[224:225], 1.0 op_sel_hi:[1,0]
    v_pk_add_f32 v[226:227], v[226:227], 1.0 op_sel_hi:[1,0]
    v_mfma_f32_32x32x16_bf16 v[140:155], v[0:3], v[172:175], v[140:155]
    v_rcp_f32 v220, v220
    v_rcp_f32 v221, v221
    v_rcp_f32 v222, v222
    v_rcp_f32 v223, v223
    v_mfma_f32_32x32x16_bf16 v[140:155], v[4:7], v[176:179], v[140:155]
    v_rcp_f32 v224, v224
    v_rcp_f32 v225, v225
    v_rcp_f32 v226, v226
    v_rcp_f32 v227, v227
    v_pk_fma_f32 v[92:93], v[156:157], v[220:221], v[92:93]
    v_pk_fma_f32 v[94:95], v[158:159], v[222:223], v[94:95]
    v_pk_fma_f32 v[96:97], v[160:161], v[224:225], v[96:97]
    v_pk_fma_f32 v[98:99], v[162:163], v[226:227], v[98:99]
    v_pk_fma_f32 v[228:229], v[92:93], v[124:125], v[228:229]
    v_pk_fma_f32 v[230:231], v[94:95], v[126:127], v[230:231]
    v_pk_fma_f32 v[228:229], v[96:97], v[128:129], v[228:229]
    v_pk_fma_f32 v[230:231], v[98:99], v[130:131], v[230:231]
    v_mfma_f32_32x32x16_bf16 v[140:155], v[8:11], v[180:183], v[140:155]
    v_exp_f32 v220, v164
    v_exp_f32 v221, v165
    v_exp_f32 v222, v166
    v_exp_f32 v223, v167
    v_mfma_f32_32x32x16_bf16 v[140:155], v[12:15], v[184:187], v[140:155]
    v_exp_f32 v224, v168
    v_exp_f32 v225, v169
    v_exp_f32 v226, v170
    v_exp_f32 v227, v171
    v_pk_add_f32 v[220:221], v[220:221], 1.0 op_sel_hi:[1,0]
    v_pk_add_f32 v[222:223], v[222:223], 1.0 op_sel_hi:[1,0]
    v_pk_add_f32 v[224:225], v[224:225], 1.0 op_sel_hi:[1,0]
    v_pk_add_f32 v[226:227], v[226:227], 1.0 op_sel_hi:[1,0]
    v_rcp_f32 v220, v220
    v_rcp_f32 v221, v221
    v_rcp_f32 v222, v222
    v_rcp_f32 v223, v223
    v_rcp_f32 v224, v224
    v_rcp_f32 v225, v225
    v_rcp_f32 v226, v226
    v_rcp_f32 v227, v227
    v_pk_fma_f32 v[100:101], v[164:165], v[220:221], v[100:101]
    v_pk_fma_f32 v[102:103], v[166:167], v[222:223], v[102:103]
    v_pk_fma_f32 v[104:105], v[168:169], v[224:225], v[104:105]
    v_pk_fma_f32 v[106:107], v[170:171], v[226:227], v[106:107]
    v_pk_fma_f32 v[228:229], v[100:101], v[132:133], v[228:229]
    v_pk_fma_f32 v[230:231], v[102:103], v[134:135], v[230:231]
    v_pk_fma_f32 v[228:229], v[104:105], v[136:137], v[228:229]
    v_pk_fma_f32 v[230:231], v[106:107], v[138:139], v[230:231]
    v_pk_add_f32 v[228:229], v[228:229], v[230:231]
    s_cmp_eq_u64 s[34:35], 0
    v_add_f32 v243, v228, v229
    v_sub_f32 v248, v243, v247
    v_pk_fma_f32 v[244:245], v[232:233], v[248:249], v[244:245] op_sel_hi:[1,0,1]
    v_fmac_f32 v246, v234, v248
    s_mov_b64 exec, -1
    s_cbranch_scc1 K2_DONE
    v_mfma_f32_32x32x8_bf16 v[156:171], v[42:43], v[208:209], v[60:75]
    s_mov_b64 exec, s[34:35]
    v_exp_f32 v220, v140
    v_exp_f32 v221, v141
    v_exp_f32 v222, v142
    v_exp_f32 v223, v143
    v_mfma_f32_32x32x16_bf16 v[156:171], v[36:39], v[188:191], v[156:171]
    v_exp_f32 v224, v144
    v_exp_f32 v225, v145
    s_bitcmp1_b32 s5, 2
    s_cbranch_scc0 K2_VP7
    s_setprio 1
K2_VP7:
    s_waitcnt lgkmcnt(0)
    s_mov_b64 exec, -1
    s_add_u32 m0, s94, 32768
    s_nop 0
    buffer_load_dwordx4 v[210:211], s[8:11], 0 idxen offen lds
    s_add_u32 m0, s94, 33792
    s_nop 0
    buffer_load_dwordx4 v[212:213], s[8:11], 0 idxen offen lds
    s_add_u32 m0, s94, 34816
    s_nop 0
    buffer_load_dwordx4 v[214:215], s[8:11], 0 idxen offen lds
    s_add_u32 m0, s94, 35840
    s_nop 0
    buffer_load_dwordx4 v[216:217], s[8:11], 0 idxen offen lds
    s_mov_b64 exec, s[34:35]
    s_setprio 0
    v_exp_f32 v226, v146
    v_exp_f32 v227, v147
    v_pk_add_f32 v[220:221], v[220:221], 1.0 op_sel_hi:[1,0]
    v_pk_add_f32 v[222:223], v[222:223], 1.0 op_sel_hi:[1,0]
    v_pk_add_f32 v[224:225], v[224:225], 1.0 op_sel_hi:[1,0]
    v_pk_add_f32 v[226:227], v[226:227], 1.0 op_sel_hi:[1,0]
    v_mfma_f32_32x32x16_bf16 v[156:171], v[16:19], v[172:175], v[156:171]
    v_rcp_f32 v220, v220
    v_rcp_f32 v221, v221
    v_rcp_f32 v222, v222
    v_rcp_f32 v223, v223
    v_mfma_f32_32x32x16_bf16 v[156:171], v[20:23], v[176:179], v[156:171]
    v_rcp_f32 v224, v224
    v_rcp_f32 v225, v225
    v_rcp_f32 v226, v226
    v_rcp_f32 v227, v227
    v_pk_fma_f32 v[76:77], v[140:141], v[220:221], v[76:77]
    v_pk_fma_f32 v[78:79], v[142:143], v[222:223], v[78:79]
    v_pk_fma_f32 v[80:81], v[144:145], v[224:225], v[80:81]
    v_pk_fma_f32 v[82:83], v[146:147], v[226:227], v[82:83]
    v_pk_mul_f32 v[228:229], v[76:77], v[108:109]
    v_pk_mul_f32 v[230:231], v[78:79], v[110:111]
    v_pk_fma_f32 v[228:229], v[80:81], v[112:113], v[228:229]
    v_pk_fma_f32 v[230:231], v[82:83], v[114:115], v[230:231]
    v_mfma_f32_32x32x16_bf16 v[156:171], v[24:27], v[180:183], v[156:171]
    v_exp_f32 v220, v148
    v_exp_f32 v221, v149
    v_exp_f32 v222, v150
    v_exp_f32 v223, v151
    v_mfma_f32_32x32x16_bf16 v[156:171], v[28:31], v[184:187], v[156:171]
    v_exp_f32 v224, v152
    v_exp_f32 v225, v153
    v_exp_f32 v226, v154
    buffer_load_dwordx4 v[196:199], v[218:219], s[12:15], 0 idxen offen
    buffer_load_dwordx2 v[204:205], v203, s[16:19], 0 idxen
    v_exp_f32 v227, v155
    s_waitcnt vmcnt(6)
    ds_read_b128 v[172:175], v251 offset:0
    ds_read_b128 v[176:179], v252 offset:0
    ds_read_b128 v[180:183], v253 offset:0
    ds_read_b128 v[184:187], v254 offset:0
    v_cmp_lt_u32_e64 s[28:29], s6, v235
    s_add_u32 s6, s6, 1
    v_lshlrev_b32 v232, 16, v200
    v_and_b32 v233, 0xffff0000, v200
    v_sub_f32 v234, v242, v201
    v_pk_add_f32 v[232:233], v[240:241], v[232:233] neg_lo:[0,1] neg_hi:[0,1]
    v_mul_f32 v208, v232, v232
    v_fmac_f32 v208, v233, v233
    v_fmac_f32 v208, v234, v234
    v_cvt_pk_bf16_f32 v208, v208, v208
    v_cndmask_b32_e64 v203, 0, v207, s[28:29]
    v_add_u32 v207, v207, v206
    ds_read_b32 v218, v203
    ds_read_u16 v203, v203 offset:4
    v_pk_add_f32 v[220:221], v[220:221], 1.0 op_sel_hi:[1,0]
    v_pk_add_f32 v[222:223], v[222:223], 1.0 op_sel_hi:[1,0]
    v_pk_add_f32 v[224:225], v[224:225], 1.0 op_sel_hi:[1,0]
    v_pk_add_f32 v[226:227], v[226:227], 1.0 op_sel_hi:[1,0]
    v_rcp_f32 v220, v220
    v_rcp_f32 v221, v221
    v_rcp_f32 v222, v222
    v_rcp_f32 v223, v223
    v_rcp_f32 v224, v224
    v_rcp_f32 v225, v225
    v_rcp_f32 v226, v226
    v_rcp_f32 v227, v227
    s_waitcnt lgkmcnt(0)
    s_mov_b64 exec, -1
    ds_bpermute_b32 v210, v239, v203 offset:0
    ds_bpermute_b32 v212, v239, v203 offset:32
    ds_bpermute_b32 v214, v239, v203 offset:64
    ds_bpermute_b32 v216, v239, v203 offset:96
    s_mov_b64 exec, s[34:35]
    v_pk_fma_f32 v[84:85], v[148:149], v[220:221], v[84:85]
    v_pk_fma_f32 v[86:87], v[150:151], v[222:223], v[86:87]
    v_pk_fma_f32 v[88:89], v[152:153], v[224:225], v[88:89]
    v_pk_fma_f32 v[90:91], v[154:155], v[226:227], v[90:91]
    v_pk_fma_f32 v[228:229], v[84:85], v[116:117], v[228:229]
    v_pk_fma_f32 v[230:231], v[86:87], v[118:119], v[230:231]
    v_pk_fma_f32 v[228:229], v[88:89], v[120:121], v[228:229]
    v_pk_fma_f32 v[230:231], v[90:91], v[122:123], v[230:231]
    v_mfma_f32_32x32x8_bf16 v[140:155], v[40:41], v[208:209], v[44:59]
    v_exp_f32 v220, v156
    v_exp_f32 v221, v157
    v_exp_f32 v222, v158
    v_exp_f32 v223, v159
    v_mfma_f32_32x32x16_bf16 v[140:155], v[32:35], v[192:195], v[140:155]
    v_exp_f32 v224, v160
    v_exp_f32 v225, v161
    v_exp_f32 v226, v162
    v_exp_f32 v227, v163
    v_pk_add_f32 v[220:221], v[220:221], 1.0 op_sel_hi:[1,0]
    v_pk_add_f32 v[222:223], v[222:223], 1.0 op_sel_hi:[1,0]
    v_pk_add_f32 v[224:225], v[224:225], 1.0 op_sel_hi:[1,0]
    v_pk_add_f32 v[226:227], v[226:227], 1.0 op_sel_hi:[1,0]
    v_mfma_f32_32x32x16_bf16 v[140:155], v[0:3], v[172:175], v[140:155]
    v_rcp_f32 v220, v220
    v_rcp_f32 v221, v221
    v_rcp_f32 v222, v222
    v_rcp_f32 v223, v223
    v_mfma_f32_32x32x16_bf16 v[140:155], v[4:7], v[176:179], v[140:155]
    v_rcp_f32 v224, v224
    v_rcp_f32 v225, v225
    v_rcp_f32 v226, v226
    v_rcp_f32 v227, v227
    v_pk_fma_f32 v[92:93], v[156:157], v[220:221], v[92:93]
    v_pk_fma_f32 v[94:95], v[158:159], v[222:223], v[94:95]
    v_pk_fma_f32 v[96:97], v[160:161], v[224:225], v[96:97]
    v_pk_fma_f32 v[98:99], v[162:163], v[226:227], v[98:99]
    v_pk_fma_f32 v[228:229], v[92:93], v[124:125], v[228:229]
    v_pk_fma_f32 v[230:231], v[94:95], v[126:127], v[230:231]
    v_pk_fma_f32 v[228:229], v[96:97], v[128:129], v[228:229]
    v_pk_fma_f32 v[230:231], v[98:99], v[130:131], v[230:231]
    v_mfma_f32_32x32x16_bf16 v[140:155], v[8:11], v[180:183], v[140:155]
    v_exp_f32 v220, v164
    v_exp_f32 v221, v165
    v_exp_f32 v222, v166
    v_exp_f32 v223, v167
    v_mfma_f32_32x32x16_bf16 v[140:155], v[12:15], v[184:187], v[140:155]
    v_exp_f32 v224, v168
    v_exp_f32 v225, v169
    v_exp_f32 v226, v170
    v_exp_f32 v227, v171
    v_pk_add_f32 v[220:221], v[220:221], 1.0 op_sel_hi:[1,0]
    v_pk_add_f32 v[222:223], v[222:223], 1.0 op_sel_hi:[1,0]
    v_pk_add_f32 v[224:225], v[224:225], 1.0 op_sel_hi:[1,0]
    v_pk_add_f32 v[226:227], v[226:227], 1.0 op_sel_hi:[1,0]
    v_rcp_f32 v220, v220
    v_rcp_f32 v221, v221
    v_rcp_f32 v222, v222
    v_rcp_f32 v223, v223
    v_rcp_f32 v224, v224
    v_rcp_f32 v225, v225
    v_rcp_f32 v226, v226
    v_rcp_f32 v227, v227
    v_pk_fma_f32 v[100:101], v[164:165], v[220:221], v[100:101]
    v_pk_fma_f32 v[102:103], v[166:167], v[222:223], v[102:103]
    v_pk_fma_f32 v[104:105], v[168:169], v[224:225], v[104:105]
    v_pk_fma_f32 v[106:107], v[170:171], v[226:227], v[106:107]
    v_pk_fma_f32 v[228:229], v[100:101], v[132:133], v[228:229]
    v_pk_fma_f32 v[230:231], v[102:103], v[134:135], v[230:231]
    v_pk_fma_f32 v[228:229], v[104:105], v[136:137], v[228:229]
    v_pk_fma_f32 v[230:231], v[106:107], v[138:139], v[230:231]
    v_pk_add_f32 v[228:229], v[228:229], v[230:231]
    s_cmp_eq_u64 s[36:37], 0
    v_add_f32 v247, v228, v229
    v_sub_f32 v248, v247, v243
    v_pk_fma_f32 v[244:245], v[236:237], v[248:249], v[244:245] op_sel_hi:[1,0,1]
    v_fmac_f32 v246, v238, v248
    s_mov_b64 exec, -1
    s_cbranch_scc1 K2_DONE
    v_mfma_f32_32x32x8_bf16 v[156:171], v[42:43], v[208:209], v[60:75]
    s_mov_b64 exec, s[36:37]
    v_exp_f32 v220, v140
    v_exp_f32 v221, v141
    v_exp_f32 v222, v142
    v_exp_f32 v223, v143
    v_mfma_f32_32x32x16_bf16 v[156:171], v[36:39], v[192:195], v[156:171]
    v_exp_f32 v224, v144
    v_exp_f32 v225, v145
    s_bitcmp1_b32 s5, 2
    s_cbranch_scc0 K2_VP9
    s_setprio 1
K2_VP9:
    s_waitcnt lgkmcnt(0)
    s_mov_b64 exec, -1
    s_add_u32 m0, s94, 0
    s_nop 0
    buffer_load_dwordx4 v[210:211], s[8:11], 0 idxen offen lds
    s_add_u32 m0, s94, 1024
    s_nop 0
    buffer_load_dwordx4 v[212:213], s[8:11], 0 idxen offen lds
    s_add_u32 m0, s94, 2048
    s_nop 0
    buffer_load_dwordx4 v[214:215], s[8:11], 0 idxen offen lds
    s_add_u32 m0, s94, 3072
    s_nop 0
    buffer_load_dwordx4 v[216:217], s[8:11], 0 idxen offen lds
    s_mov_b64 exec, s[36:37]
    s_setprio 0
    v_exp_f32 v226, v146
    v_exp_f32 v227, v147
    v_pk_add_f32 v[220:221], v[220:221], 1.0 op_sel_hi:[1,0]
    v_pk_add_f32 v[222:223], v[222:223], 1.0 op_sel_hi:[1,0]
    v_pk_add_f32 v[224:225], v[224:225], 1.0 op_sel_hi:[1,0]
    v_pk_add_f32 v[226:227], v[226:227], 1.0 op_sel_hi:[1,0]
    v_mfma_f32_32x32x16_bf16 v[156:171], v[16:19], v[172:175], v[156:171]
    v_rcp_f32 v220, v220
    v_rcp_f32 v221, v221
    v_rcp_f32 v222, v222
    v_rcp_f32 v223, v223
    v_mfma_f32_32x32x16_bf16 v[156:171], v[20:23], v[176:179], v[156:171]
    v_rcp_f32 v224, v224
    v_rcp_f32 v225, v225
    v_rcp_f32 v226, v226
    v_rcp_f32 v227, v227
    v_pk_fma_f32 v[76:77], v[140:141], v[220:221], v[76:77]
    v_pk_fma_f32 v[78:79], v[142:143], v[222:223], v[78:79]
    v_pk_fma_f32 v[80:81], v[144:145], v[224:225], v[80:81]
    v_pk_fma_f32 v[82:83], v[146:147], v[226:227], v[82:83]
    v_pk_mul_f32 v[228:229], v[76:77], v[108:109]
    v_pk_mul_f32 v[230:231], v[78:79], v[110:111]
    v_pk_fma_f32 v[228:229], v[80:81], v[112:113], v[228:229]
    v_pk_fma_f32 v[230:231], v[82:83], v[114:115], v[230:231]
    v_mfma_f32_32x32x16_bf16 v[156:171], v[24:27], v[180:183], v[156:171]
    v_exp_f32 v220, v148
    v_exp_f32 v221, v149
    v_exp_f32 v222, v150
    v_exp_f32 v223, v151
    v_mfma_f32_32x32x16_bf16 v[156:171], v[28:31], v[184:187], v[156:171]
    v_exp_f32 v224, v152
    v_exp_f32 v225, v153
    v_exp_f32 v226, v154
    buffer_load_dwordx4 v[188:191], v[218:219], s[12:15], 0 idxen offen
    buffer_load_dwordx2 v[200:201], v203, s[16:19], 0 idxen
    v_exp_f32 v227, v155
    s_waitcnt vmcnt(6)
    ds_read_b128 v[172:175], v251 offset:32768
    ds_read_b128 v[176:179], v252 offset:32768
    ds_read_b128 v[180:183], v253 offset:32768
    ds_read_b128 v[184:187], v254 offset:32768
    v_cmp_lt_u32_e64 s[30:31], s6, v235
    s_add_u32 s6, s6, 1
    v_lshlrev_b32 v236, 16, v204
    v_and_b32 v237, 0xffff0000, v204
    v_sub_f32 v238, v242, v205
    v_pk_add_f32 v[236:237], v[240:241], v[236:237] neg_lo:[0,1] neg_hi:[0,1]
    v_mul_f32 v208, v236, v236
    v_fmac_f32 v208, v237, v237
    v_fmac_f32 v208, v238, v238
    v_cvt_pk_bf16_f32 v208, v208, v208
    v_cndmask_b32_e64 v203, 0, v207, s[30:31]
    v_add_u32 v207, v207, v206
    ds_read_b32 v218, v203
    ds_read_u16 v203, v203 offset:4
    v_pk_add_f32 v[220:221], v[220:221], 1.0 op_sel_hi:[1,0]
    v_pk_add_f32 v[222:223], v[222:223], 1.0 op_sel_hi:[1,0]
    v_pk_add_f32 v[224:225], v[224:225], 1.0 op_sel_hi:[1,0]
    v_pk_add_f32 v[226:227], v[226:227], 1.0 op_sel_hi:[1,0]
    v_rcp_f32 v220, v220
    v_rcp_f32 v221, v221
    v_rcp_f32 v222, v222
    v_rcp_f32 v223, v223
    v_rcp_f32 v224, v224
    v_rcp_f32 v225, v225
    v_rcp_f32 v226, v226
    v_rcp_f32 v227, v227
    s_waitcnt lgkmcnt(0)
    s_mov_b64 exec, -1
    ds_bpermute_b32 v210, v239, v203 offset:0
    ds_bpermute_b32 v212, v239, v203 offset:32
    ds_bpermute_b32 v214, v239, v203 offset:64
    ds_bpermute_b32 v216, v239, v203 offset:96
    s_mov_b64 exec, s[36:37]
    v_pk_fma_f32 v[84:85], v[148:149], v[220:221], v[84:85]
    v_pk_fma_f32 v[86:87], v[150:151], v[222:223], v[86:87]
    v_pk_fma_f32 v[88:89], v[152:153], v[224:225], v[88:89]
    v_pk_fma_f32 v[90:91], v[154:155], v[226:227], v[90:91]
    v_pk_fma_f32 v[228:229], v[84:85], v[116:117], v[228:229]
    v_pk_fma_f32 v[230:231], v[86:87], v[118:119], v[230:231]
    v_pk_fma_f32 v[228:229], v[88:89], v[120:121], v[228:229]
    v_pk_fma_f32 v[230:231], v[90:91], v[122:123], v[230:231]
    v_mfma_f32_32x32x8_bf16 v[140:155], v[40:41], v[208:209], v[44:59]
    v_exp_f32 v220, v156
    v_exp_f32 v221, v157
    v_exp_f32 v222, v158
    v_exp_f32 v223, v159
    v_mfma_f32_32x32x16_bf16 v[140:155], v[32:35], v[196:199], v[140:155]
    v_exp_f32 v224, v160
    v_exp_f32 v225, v161
    v_exp_f32 v226, v162
    v_exp_f32 v227, v163
    v_pk_add_f32 v[220:221], v[220:221], 1.0 op_sel_hi:[1,0]
    v_pk_add_f32 v[222:223], v[222:223], 1.0 op_sel_hi:[1,0]
    v_pk_add_f32 v[224:225], v[224:225], 1.0 op_sel_hi:[1,0]
    v_pk_add_f32 v[226:227], v[226:227], 1.0 op_sel_hi:[1,0]
    v_mfma_f32_32x32x16_bf16 v[140:155], v[0:3], v[172:175], v[140:155]
    v_rcp_f32 v220, v220
    v_rcp_f32 v221, v221
    v_rcp_f32 v222, v222
    v_rcp_f32 v223, v223
    v_mfma_f32_32x32x16_bf16 v[140:155], v[4:7], v[176:179], v[140:155]
    v_rcp_f32 v224, v224
    v_rcp_f32 v225, v225
    v_rcp_f32 v226, v226
    v_rcp_f32 v227, v227
    v_pk_fma_f32 v[92:93], v[156:157], v[220:221], v[92:93]
    v_pk_fma_f32 v[94:95], v[158:159], v[222:223], v[94:95]
    v_pk_fma_f32 v[96:97], v[160:161], v[224:225], v[96:97]
    v_pk_fma_f32 v[98:99], v[162:163], v[226:227], v[98:99]
    v_pk_fma_f32 v[228:229], v[92:93], v[124:125], v[228:229]
    v_pk_fma_f32 v[230:231], v[94:95], v[126:127], v[230:231]
    v_pk_fma_f32 v[228:229], v[96:97], v[128:129], v[228:229]
    v_pk_fma_f32 v[230:231], v[98:99], v[130:131], v[230:231]
    v_mfma_f32_32x32x16_bf16 v[140:155], v[8:11], v[180:183], v[140:155]
    v_exp_f32 v220, v164
    v_exp_f32 v221, v165
    v_exp_f32 v222, v166
    v_exp_f32 v223, v167
    v_mfma_f32_32x32x16_bf16 v[140:155], v[12:15], v[184:187], v[140:155]
    v_exp_f32 v224, v168
    v_exp_f32 v225, v169
    v_exp_f32 v226, v170
    v_exp_f32 v227, v171
    v_pk_add_f32 v[220:221], v[220:221], 1.0 op_sel_hi:[1,0]
    v_pk_add_f32 v[222:223], v[222:223], 1.0 op_sel_hi:[1,0]
    v_pk_add_f32 v[224:225], v[224:225], 1.0 op_sel_hi:[1,0]
    v_pk_add_f32 v[226:227], v[226:227], 1.0 op_sel_hi:[1,0]
    v_rcp_f32 v220, v220
    v_rcp_f32 v221, v221
    v_rcp_f32 v222, v222
    v_rcp_f32 v223, v223
    v_rcp_f32 v224, v224
    v_rcp_f32 v225, v225
    v_rcp_f32 v226, v226
    v_rcp_f32 v227, v227
    v_pk_fma_f32 v[100:101], v[164:165], v[220:221], v[100:101]
    v_pk_fma_f32 v[102:103], v[166:167], v[222:223], v[102:103]
    v_pk_fma_f32 v[104:105], v[168:169], v[224:225], v[104:105]
    v_pk_fma_f32 v[106:107], v[170:171], v[226:227], v[106:107]
    v_pk_fma_f32 v[228:229], v[100:101], v[132:133], v[228:229]
    v_pk_fma_f32 v[230:231], v[102:103], v[134:135], v[230:231]
    v_pk_fma_f32 v[228:229], v[104:105], v[136:137], v[228:229]
    v_pk_fma_f32 v[230:231], v[106:107], v[138:139], v[230:231]
    v_pk_add_f32 v[228:229], v[228:229], v[230:231]
    s_cmp_eq_u64 s[38:39], 0
    v_add_f32 v243, v228, v229
    v_sub_f32 v248, v243, v247
    v_pk_fma_f32 v[244:245], v[232:233], v[248:249], v[244:245] op_sel_hi:[1,0,1]
    v_fmac_f32 v246, v234, v248
    s_mov_b64 exec, -1
    s_cbranch_scc1 K2_DONE
    v_mfma_f32_32x32x8_bf16 v[156:171], v[42:43], v[208:209], v[60:75]
    s_mov_b64 exec, s[38:39]
    v_exp_f32 v220, v140
    v_exp_f32 v221, v141
    v_exp_f32 v222, v142
    v_exp_f32 v223, v143
    v_mfma_f32_32x32x16_bf16 v[156:171], v[36:39], v[196:199], v[156:171]
    v_exp_f32 v224, v144
    v_exp_f32 v225, v145
    s_bitcmp1_b32 s5, 2
    s_cbranch_scc0 K2_VP11
    s_setprio 1
K2_VP11:
    s_waitcnt lgkmcnt(0)
    s_mov_b64 exec, -1
    s_add_u32 m0, s94, 32768
    s_nop 0
    buffer_load_dwordx4 v[210:211], s[8:11], 0 idxen offen lds
    s_add_u32 m0, s94, 33792
    s_nop 0
    buffer_load_dwordx4 v[212:213], s[8:11], 0 idxen offen lds
    s_add_u32 m0, s94, 34816
    s_nop 0
    buffer_load_dwordx4 v[214:215], s[8:11], 0 idxen offen lds
    s_add_u32 m0, s94, 35840
    s_nop 0
    buffer_load_dwordx4 v[216:217], s[8:11], 0 idxen offen lds
    s_mov_b64 exec, s[38:39]
    s_setprio 0
    v_exp_f32 v226, v146
    v_exp_f32 v227, v147
    v_pk_add_f32 v[220:221], v[220:221], 1.0 op_sel_hi:[1,0]
    v_pk_add_f32 v[222:223], v[222:223], 1.0 op_sel_hi:[1,0]
    v_pk_add_f32 v[224:225], v[224:225], 1.0 op_sel_hi:[1,0]
    v_pk_add_f32 v[226:227], v[226:227], 1.0 op_sel_hi:[1,0]
    v_mfma_f32_32x32x16_bf16 v[156:171], v[16:19], v[172:175], v[156:171]
    v_rcp_f32 v220, v220
    v_rcp_f32 v221, v221
    v_rcp_f32 v222, v222
    v_rcp_f32 v223, v223
    v_mfma_f32_32x32x16_bf16 v[156:171], v[20:23], v[176:179], v[156:171]
    v_rcp_f32 v224, v224
    v_rcp_f32 v225, v225
    v_rcp_f32 v226, v226
    v_rcp_f32 v227, v227
    v_pk_fma_f32 v[76:77], v[140:141], v[220:221], v[76:77]
    v_pk_fma_f32 v[78:79], v[142:143], v[222:223], v[78:79]
    v_pk_fma_f32 v[80:81], v[144:145], v[224:225], v[80:81]
    v_pk_fma_f32 v[82:83], v[146:147], v[226:227], v[82:83]
    v_pk_mul_f32 v[228:229], v[76:77], v[108:109]
    v_pk_mul_f32 v[230:231], v[78:79], v[110:111]
    v_pk_fma_f32 v[228:229], v[80:81], v[112:113], v[228:229]
    v_pk_fma_f32 v[230:231], v[82:83], v[114:115], v[230:231]
    v_mfma_f32_32x32x16_bf16 v[156:171], v[24:27], v[180:183], v[156:171]
    v_exp_f32 v220, v148
    v_exp_f32 v221, v149
    v_exp_f32 v222, v150
    v_exp_f32 v223, v151
    v_mfma_f32_32x32x16_bf16 v[156:171], v[28:31], v[184:187], v[156:171]
    v_exp_f32 v224, v152
    v_exp_f32 v225, v153
    v_exp_f32 v226, v154
    buffer_load_dwordx4 v[192:195], v[218:219], s[12:15], 0 idxen offen
    buffer_load_dwordx2 v[204:205], v203, s[16:19], 0 idxen
    v_exp_f32 v227, v155
    s_waitcnt vmcnt(6)
    ds_read_b128 v[172:175], v251 offset:0
    ds_read_b128 v[176:179], v252 offset:0
    ds_read_b128 v[180:183], v253 offset:0
    ds_read_b128 v[184:187], v254 offset:0
    v_cmp_lt_u32_e64 s[32:33], s6, v235
    s_add_u32 s6, s6, 1
    v_lshlrev_b32 v232, 16, v200
    v_and_b32 v233, 0xffff0000, v200
    v_sub_f32 v234, v242, v201
    v_pk_add_f32 v[232:233], v[240:241], v[232:233] neg_lo:[0,1] neg_hi:[0,1]
    v_mul_f32 v208, v232, v232
    v_fmac_f32 v208, v233, v233
    v_fmac_f32 v208, v234, v234
    v_cvt_pk_bf16_f32 v208, v208, v208
    v_cndmask_b32_e64 v203, 0, v207, s[32:33]
    v_add_u32 v207, v207, v206
    ds_read_b32 v218, v203
    ds_read_u16 v203, v203 offset:4
    v_pk_add_f32 v[220:221], v[220:221], 1.0 op_sel_hi:[1,0]
    v_pk_add_f32 v[222:223], v[222:223], 1.0 op_sel_hi:[1,0]
    v_pk_add_f32 v[224:225], v[224:225], 1.0 op_sel_hi:[1,0]
    v_pk_add_f32 v[226:227], v[226:227], 1.0 op_sel_hi:[1,0]
    v_rcp_f32 v220, v220
    v_rcp_f32 v221, v221
    v_rcp_f32 v222, v222
    v_rcp_f32 v223, v223
    v_rcp_f32 v224, v224
    v_rcp_f32 v225, v225
    v_rcp_f32 v226, v226
    v_rcp_f32 v227, v227
    s_waitcnt lgkmcnt(0)
    s_mov_b64 exec, -1
    ds_bpermute_b32 v210, v239, v203 offset:0
    ds_bpermute_b32 v212, v239, v203 offset:32
    ds_bpermute_b32 v214, v239, v203 offset:64
    ds_bpermute_b32 v216, v239, v203 offset:96
    s_mov_b64 exec, s[38:39]
    v_pk_fma_f32 v[84:85], v[148:149], v[220:221], v[84:85]
    v_pk_fma_f32 v[86:87], v[150:151], v[222:223], v[86:87]
    v_pk_fma_f32 v[88:89], v[152:153], v[224:225], v[88:89]
    v_pk_fma_f32 v[90:91], v[154:155], v[226:227], v[90:91]
    v_pk_fma_f32 v[228:229], v[84:85], v[116:117], v[228:229]
    v_pk_fma_f32 v[230:231], v[86:87], v[118:119], v[230:231]
    v_pk_fma_f32 v[228:229], v[88:89], v[120:121], v[228:229]
    v_pk_fma_f32 v[230:231], v[90:91], v[122:123], v[230:231]
    v_mfma_f32_32x32x8_bf16 v[140:155], v[40:41], v[208:209], v[44:59]
    v_exp_f32 v220, v156
    v_exp_f32 v221, v157
    v_exp_f32 v222, v158
    v_exp_f32 v223, v159
    v_mfma_f32_32x32x16_bf16 v[140:155], v[32:35], v[188:191], v[140:155]
    v_exp_f32 v224, v160
    v_exp_f32 v225, v161
    v_exp_f32 v226, v162
    v_exp_f32 v227, v163
    v_pk_add_f32 v[220:221], v[220:221], 1.0 op_sel_hi:[1,0]
    v_pk_add_f32 v[222:223], v[222:223], 1.0 op_sel_hi:[1,0]
    v_pk_add_f32 v[224:225], v[224:225], 1.0 op_sel_hi:[1,0]
    v_pk_add_f32 v[226:227], v[226:227], 1.0 op_sel_hi:[1,0]
    v_mfma_f32_32x32x16_bf16 v[140:155], v[0:3], v[172:175], v[140:155]
    v_rcp_f32 v220, v220
    v_rcp_f32 v221, v221
    v_rcp_f32 v222, v222
    v_rcp_f32 v223, v223
    v_mfma_f32_32x32x16_bf16 v[140:155], v[4:7], v[176:179], v[140:155]
    v_rcp_f32 v224, v224
    v_rcp_f32 v225, v225
    v_rcp_f32 v226, v226
    v_rcp_f32 v227, v227
    v_pk_fma_f32 v[92:93], v[156:157], v[220:221], v[92:93]
    v_pk_fma_f32 v[94:95], v[158:159], v[222:223], v[94:95]
    v_pk_fma_f32 v[96:97], v[160:161], v[224:225], v[96:97]
    v_pk_fma_f32 v[98:99], v[162:163], v[226:227], v[98:99]
    v_pk_fma_f32 v[228:229], v[92:93], v[124:125], v[228:229]
    v_pk_fma_f32 v[230:231], v[94:95], v[126:127], v[230:231]
    v_pk_fma_f32 v[228:229], v[96:97], v[128:129], v[228:229]
    v_pk_fma_f32 v[230:231], v[98:99], v[130:131], v[230:231]
    v_mfma_f32_32x32x16_bf16 v[140:155], v[8:11], v[180:183], v[140:155]
    v_exp_f32 v220, v164
    v_exp_f32 v221, v165
    v_exp_f32 v222, v166
    v_exp_f32 v223, v167
    v_mfma_f32_32x32x16_bf16 v[140:155], v[12:15], v[184:187], v[140:155]
    v_exp_f32 v224, v168
    v_exp_f32 v225, v169
    v_exp_f32 v226, v170
    v_exp_f32 v227, v171
    v_pk_add_f32 v[220:221], v[220:221], 1.0 op_sel_hi:[1,0]
    v_pk_add_f32 v[222:223], v[222:223], 1.0 op_sel_hi:[1,0]
    v_pk_add_f32 v[224:225], v[224:225], 1.0 op_sel_hi:[1,0]
    v_pk_add_f32 v[226:227], v[226:227], 1.0 op_sel_hi:[1,0]
    v_rcp_f32 v220, v220
    v_rcp_f32 v221, v221
    v_rcp_f32 v222, v222
    v_rcp_f32 v223, v223
    v_rcp_f32 v224, v224
    v_rcp_f32 v225, v225
    v_rcp_f32 v226, v226
    v_rcp_f32 v227, v227
    v_pk_fma_f32 v[100:101], v[164:165], v[220:221], v[100:101]
    v_pk_fma_f32 v[102:103], v[166:167], v[222:223], v[102:103]
    v_pk_fma_f32 v[104:105], v[168:169], v[224:225], v[104:105]
    v_pk_fma_f32 v[106:107], v[170:171], v[226:227], v[106:107]
    v_pk_fma_f32 v[228:229], v[100:101], v[132:133], v[228:229]
    v_pk_fma_f32 v[230:231], v[102:103], v[134:135], v[230:231]
    v_pk_fma_f32 v[228:229], v[104:105], v[136:137], v[228:229]
    v_pk_fma_f32 v[230:231], v[106:107], v[138:139], v[230:231]
    v_pk_add_f32 v[228:229], v[228:229], v[230:231]
    s_cmp_eq_u64 s[28:29], 0
    v_add_f32 v247, v228, v229
    v_sub_f32 v248, v247, v243
    v_pk_fma_f32 v[244:245], v[236:237], v[248:249], v[244:245] op_sel_hi:[1,0,1]
    v_fmac_f32 v246, v238, v248
    s_mov_b64 exec, -1
    s_cbranch_scc0 K2_LOOP
K2_DONE:
    v_and_b32 v203, 63, v250
    s_or_b32 s95, s7, s93
    s_cselect_b32 s97, 3, s97
    s_cmp_gt_u32 s97, 2
    v_lshlrev_b32 v203, 4, v203
    s_cbranch_scc1 K2_SLOW
    v_bfe_u32 v220, v249, 1, 3
    v_lshlrev_b32 v220, 4, v220
    v_lshlrev_b32 v221, 2, v219
    v_xor_b32 v220, v220, v221
    v_lshl_add_u32 v220, v249, 7, v220
    v_add_u32 v220, 100352, v220
    v_xor_b32 v221, 16, v220
    v_xor_b32 v222, 32, v220
    v_xor_b32 v223, 48, v220
    ds_read_b128 v[172:175], v220
    ds_read_b128 v[176:179], v221
    ds_read_b128 v[180:183], v222
    ds_read_b128 v[184:187], v223
    v_add_u32 v220, 125952, v203
    v_cmp_eq_u32_e64 s[46:47], 16, v206
    v_cmp_eq_u32_e64 s[44:45], 8, v206
    v_add_u32 v218, s4, v249
    ds_read_b128 v[0:3], v220 offset:32768
    ds_read_b128 v[4:7], v220 offset:33792
    ds_read_b128 v[8:11], v220 offset:34816
    ds_read_b128 v[12:15], v220 offset:35840
    ds_read_b128 v[16:19], v220 offset:0
    ds_read_b128 v[20:23], v220 offset:1024
    ds_read_b128 v[24:27], v220 offset:2048
    ds_read_b128 v[28:31], v220 offset:3072
    ds_read_b128 v[44:47], v220 offset:4096
    ds_read_b128 v[48:51], v220 offset:5120
    ds_read_b128 v[52:55], v220 offset:6144
    ds_read_b128 v[56:59], v220 offset:7168
    ds_read_b128 v[60:63], v220 offset:8192
    ds_read_b128 v[64:67], v220 offset:9216
    ds_read_b128 v[68:71], v220 offset:10240
    ds_read_b128 v[72:75], v220 offset:11264
    s_mov_b64 exec, s[46:47]
    s_and_b32 s46, s46, 0x55555555
    s_or_b32 s44, s44, s46
    s_mov_b32 s98, s94
    v_add_f32_dpp v244, v244, v244 quad_perm:[1,0,3,2] row_mask:0xf bank_mask:0xf
    v_add_f32_dpp v245, v245, v245 quad_perm:[1,0,3,2] row_mask:0xf bank_mask:0xf
    v_add_f32_dpp v246, v246, v246 quad_perm:[1,0,3,2] row_mask:0xf bank_mask:0xf
    v_add_f32_dpp v76, v76, v76 quad_perm:[1,0,3,2] row_mask:0xf bank_mask:0xf
    v_add_f32_dpp v77, v77, v77 quad_perm:[1,0,3,2] row_mask:0xf bank_mask:0xf
    v_add_f32_dpp v78, v78, v78 quad_perm:[1,0,3,2] row_mask:0xf bank_mask:0xf
    v_add_f32_dpp v79, v79, v79 quad_perm:[1,0,3,2] row_mask:0xf bank_mask:0xf
    v_add_f32_dpp v80, v80, v80 quad_perm:[1,0,3,2] row_mask:0xf bank_mask:0xf
    v_add_f32_dpp v81, v81, v81 quad_perm:[1,0,3,2] row_mask:0xf bank_mask:0xf
    v_add_f32_dpp v82, v82, v82 quad_perm:[1,0,3,2] row_mask:0xf bank_mask:0xf
    v_add_f32_dpp v83, v83, v83 quad_perm:[1,0,3,2] row_mask:0xf bank_mask:0xf
    v_add_f32_dpp v84, v84, v84 quad_perm:[1,0,3,2] row_mask:0xf bank_mask:0xf
    v_add_f32_dpp v85, v85, v85 quad_perm:[1,0,3,2] row_mask:0xf bank_mask:0xf
    v_add_f32_dpp v86, v86, v86 quad_perm:[1,0,3,2] row_mask:0xf bank_mask:0xf
    v_add_f32_dpp v87, v87, v87 quad_perm:[1,0,3,2] row_mask:0xf bank_mask:0xf
    v_add_f32_dpp v88, v88, v88 quad_perm:[1,0,3,2] row_mask:0xf bank_mask:0xf
    v_add_f32_dpp v89, v89, v89 quad_perm:[1,0,3,2] row_mask:0xf bank_mask:0xf
    v_add_f32_dpp v90, v90, v90 quad_perm:[1,0,3,2] row_mask:0xf bank_mask:0xf
    v_add_f32_dpp v91, v91, v91 quad_perm:[1,0,3,2] row_mask:0xf bank_mask:0xf
    v_add_f32_dpp v92, v92, v92 quad_perm:[1,0,3,2] row_mask:0xf bank_mask:0xf
    v_add_f32_dpp v93, v93, v93 quad_perm:[1,0,3,2] row_mask:0xf bank_mask:0xf
    v_add_f32_dpp v94, v94, v94 quad_perm:[1,0,3,2] row_mask:0xf bank_mask:0xf
    v_add_f32_dpp v95, v95, v95 quad_perm:[1,0,3,2] row_mask:0xf bank_mask:0xf
    v_add_f32_dpp v96, v96, v96 quad_perm:[1,0,3,2] row_mask:0xf bank_mask:0xf
    v_add_f32_dpp v97, v97, v97 quad_perm:[1,0,3,2] row_mask:0xf bank_mask:0xf
    v_add_f32_dpp v98, v98, v98 quad_perm:[1,0,3,2] row_mask:0xf bank_mask:0xf
    v_add_f32_dpp v99, v99, v99 quad_perm:[1,0,3,2] row_mask:0xf bank_mask:0xf
    v_add_f32_dpp v100, v100, v100 quad_perm:[1,0,3,2] row_mask:0xf bank_mask:0xf
    v_add_f32_dpp v101, v101, v101 quad_perm:[1,0,3,2] row_mask:0xf bank_mask:0xf
    v_add_f32_dpp v102, v102, v102 quad_perm:[1,0,3,2] row_mask:0xf bank_mask:0xf
    v_add_f32_dpp v103, v103, v103 quad_perm:[1,0,3,2] row_mask:0xf bank_mask:0xf
    v_add_f32_dpp v104, v104, v104 quad_perm:[1,0,3,2] row_mask:0xf bank_mask:0xf
    v_add_f32_dpp v105, v105, v105 quad_perm:[1,0,3,2] row_mask:0xf bank_mask:0xf
    v_add_f32_dpp v106, v106, v106 quad_perm:[1,0,3,2] row_mask:0xf bank_mask:0xf
    v_add_f32_dpp v107, v107, v107 quad_perm:[1,0,3,2] row_mask:0xf bank_mask:0xf
    s_mov_b64 exec, -1
    v_mov_b32 v224, v244
    v_mov_b32 v225, v245
    v_mov_b32 v226, v246
    s_nop 1
    v_permlane32_swap_b32 v224, v244
    v_permlane32_swap_b32 v225, v245
    v_permlane32_swap_b32 v226, v246
    s_nop 1
    v_add_f32 v244, v244, v224
    v_add_f32 v245, v245, v225
    v_add_f32 v246, v246, v226
    s_branch K2_TAIL
K2_EMPTY:
    s_waitcnt vmcnt(0) lgkmcnt(0)
    v_mov_b32 v244, 0
    v_mov_b32 v245, 0
    v_mov_b32 v246, 0
    v_mov_b32 v76, 0
    v_mov_b32 v77, 0
    v_mov_b32 v78, 0
    v_mov_b32 v79, 0
    v_mov_b32 v80, 0
    v_mov_b32 v81, 0
    v_mov_b32 v82, 0
    v_mov_b32 v83, 0
    v_mov_b32 v84, 0
    v_mov_b32 v85, 0
    v_mov_b32 v86, 0
    v_mov_b32 v87, 0
    v_mov_b32 v88, 0
    v_mov_b32 v89, 0
    v_mov_b32 v90, 0
    v_mov_b32 v91, 0
    v_mov_b32 v92, 0
    v_mov_b32 v93, 0
    v_mov_b32 v94, 0
    v_mov_b32 v95, 0
    v_mov_b32 v96, 0
    v_mov_b32 v97, 0
    v_mov_b32 v98, 0
    v_mov_b32 v99, 0
    v_mov_b32 v100, 0
    v_mov_b32 v101, 0
    v_mov_b32 v102, 0
    v_mov_b32 v103, 0
    v_mov_b32 v104, 0
    v_mov_b32 v105, 0
    v_mov_b32 v106, 0
    v_mov_b32 v107, 0
    v_mov_b32 v242, v241
    v_and_b32 v241, 0xffff0000, v240
    v_lshlrev_b32 v240, 16, v240
    s_branch K2_DONE
K2_SLOW:
    v_and_b32 v223, 31, v250
    v_lshlrev_b32 v220, 2, v219
    v_xor_b32 v220, v220, v251
    v_lshl_add_u32 v220, v219, 11, v220
    s_lshl_b32 s95, s100, 10
    s_add_u32 s95, s95, 129024
    v_lshl_add_u32 v221, v223, 5, v219
    v_add_u32 v221, s95, v221
    s_lshl_b32 s95, s5, 5
    v_add_u32 v223, s95, v223
    v_add_u32 v218, s4, v223
    v_min_u32 v222, 49999, v218
    s_waitcnt vmcnt(0)
    buffer_load_dwordx2 v[240:241], v222, s[16:19], 0 idxen
    v_xor_b32 v222, 0, v220
    ds_write_b128 v222, v[76:79]
    v_xor_b32 v222, 16, v220
    ds_write_b128 v222, v[80:83]
    v_xor_b32 v222, 32, v220
    ds_write_b128 v222, v[84:87]
    v_xor_b32 v222, 48, v220
    ds_write_b128 v222, v[88:91]
    v_xor_b32 v222, 64, v220
    ds_write_b128 v222, v[92:95]
    v_xor_b32 v222, 80, v220
    ds_write_b128 v222, v[96:99]
    v_xor_b32 v222, 96, v220
    ds_write_b128 v222, v[100:103]
    v_xor_b32 v222, 112, v220
    ds_write_b128 v222, v[104:107]
    ds_write_b128 v221, v[244:247]
    v_lshlrev_b32 v220, 2, v223
    ds_read_b32 v235, v220 offset:32768
    s_sub_u32 s99, s101, s94
    v_add_u32 v251, s99, v251
    v_add_u32 v252, s99, v252
    v_add_u32 v253, s99, v253
    v_add_u32 v254, s99, v254
    ds_read_b128 v[172:175], v251 offset:0
    ds_read_b128 v[176:179], v252 offset:0
    ds_read_b128 v[180:183], v253 offset:0
    ds_read_b128 v[184:187], v254 offset:0
    v_mov_b32 v76, 0
    v_mov_b32 v77, 0
    v_mov_b32 v78, 0
    v_mov_b32 v79, 0
    v_mov_b32 v80, 0
    v_mov_b32 v81, 0
    v_mov_b32 v82, 0
    v_mov_b32 v83, 0
    v_mov_b32 v84, 0
    v_mov_b32 v85, 0
    v_mov_b32 v86, 0
    v_mov_b32 v87, 0
    v_mov_b32 v88, 0
    v_mov_b32 v89, 0
    v_mov_b32 v90, 0
    v_mov_b32 v91, 0
    v_mov_b32 v92, 0
    v_mov_b32 v93, 0
    v_mov_b32 v94, 0
    v_mov_b32 v95, 0
    v_mov_b32 v96, 0
    v_mov_b32 v97, 0
    v_mov_b32 v98, 0
    v_mov_b32 v99, 0
    v_mov_b32 v100, 0
    v_mov_b32 v101, 0
    v_mov_b32 v102, 0
    v_mov_b32 v103, 0
    v_mov_b32 v104, 0
    v_mov_b32 v105, 0
    v_mov_b32 v106, 0
    v_mov_b32 v107, 0
    v_mov_b32 v244, 0
    v_mov_b32 v245, 0
    v_mov_b32 v246, 0
    s_lshl_b32 s99, s3, 8
    v_add_u32 v249, s99, v223
    v_mul_u32_u24 v249, 272, v249
    v_lshl_add_u32 v243, v219, 3, v249
    s_mov_b32 s99, 7602176
    s_cmp_eq_u32 s7, 0
    s_cbranch_scc1 K2_NOLD
    buffer_load_dwordx4 v[76:79], v243, s[20:23], s99 offen offset:0 sc0 sc1
    buffer_load_dwordx4 v[80:83], v243, s[20:23], s99 offen offset:16 sc0 sc1
    buffer_load_dwordx4 v[84:87], v243, s[20:23], s99 offen offset:32 sc0 sc1
    buffer_load_dwordx4 v[88:91], v243, s[20:23], s99 offen offset:48 sc0 sc1
    buffer_load_dwordx4 v[92:95], v243, s[20:23], s99 offen offset:64 sc0 sc1
    buffer_load_dwordx4 v[96:99], v243, s[20:23], s99 offen offset:80 sc0 sc1
    buffer_load_dwordx4 v[100:103], v243, s[20:23], s99 offen offset:96 sc0 sc1
    buffer_load_dwordx4 v[104:107], v243, s[20:23], s99 offen offset:112 sc0 sc1
    buffer_load_dwordx3 v[244:246], v249, s[20:23], s99 offen offset:256 sc0 sc1
    s_waitcnt vmcnt(0)
K2_NOLD:
    s_waitcnt lgkmcnt(0)
    v_and_b32 v207, 0xffff, v235
    v_lshrrev_b32 v235, 16, v235
    v_lshlrev_b32 v247, 11, v219
    v_add_u32 v247, 34816, v247
    v_add_u32 v220, 138240, v203
    v_cmp_lt_u32 vcc, 0, v235
    s_barrier
    s_cbranch_vccz K2_GDONE
K2_GLOOP:
    s_mov_b64 exec, vcc
    v_bfe_u32 v221, v207, 3, 3
    v_lshlrev_b32 v221, 4, v221
    v_lshl_add_u32 v221, v207, 5, v221
    v_add_u32 v221, v247, v221
    v_xor_b32 v222, 0, v221
    ds_read_b128 v[140:143], v222
    v_xor_b32 v222, 16, v221
    ds_read_b128 v[144:147], v222
    v_xor_b32 v222, 32, v221
    ds_read_b128 v[148:151], v222
    v_xor_b32 v222, 48, v221
    ds_read_b128 v[152:155], v222
    v_xor_b32 v222, 64, v221
    ds_read_b128 v[156:159], v222
    v_xor_b32 v222, 80, v221
    ds_read_b128 v[160:163], v222
    v_xor_b32 v222, 96, v221
    ds_read_b128 v[164:167], v222
    v_xor_b32 v222, 112, v221
    ds_read_b128 v[168:171], v222
    v_lshlrev_b32 v222, 3, v207
    v_add_u32 v222, 129024, v222
    ds_read_b128 v[188:191], v222
    ds_read_b128 v[192:195], v222 offset:16
    v_add_u32 v207, 4, v207
    v_subrev_u32 v235, 1, v235
    v_cmp_lt_u32 vcc, 0, v235
    s_waitcnt lgkmcnt(9)
    v_pk_add_f32 v[76:77], v[76:77], v[140:141]
    v_pk_add_f32 v[78:79], v[78:79], v[142:143]
    s_waitcnt lgkmcnt(8)
    v_pk_add_f32 v[80:81], v[80:81], v[144:145]
    v_pk_add_f32 v[82:83], v[82:83], v[146:147]
    s_waitcnt lgkmcnt(7)
    v_pk_add_f32 v[84:85], v[84:85], v[148:149]
    v_pk_add_f32 v[86:87], v[86:87], v[150:151]
    s_waitcnt lgkmcnt(6)
    v_pk_add_f32 v[88:89], v[88:89], v[152:153]
    v_pk_add_f32 v[90:91], v[90:91], v[154:155]
    s_waitcnt lgkmcnt(5)
    v_pk_add_f32 v[92:93], v[92:93], v[156:157]
    v_pk_add_f32 v[94:95], v[94:95], v[158:159]
    s_waitcnt lgkmcnt(4)
    v_pk_add_f32 v[96:97], v[96:97], v[160:161]
    v_pk_add_f32 v[98:99], v[98:99], v[162:163]
    s_waitcnt lgkmcnt(3)
    v_pk_add_f32 v[100:101], v[100:101], v[164:165]
    v_pk_add_f32 v[102:103], v[102:103], v[166:167]
    s_waitcnt lgkmcnt(2)
    v_pk_add_f32 v[104:105], v[104:105], v[168:169]
    v_pk_add_f32 v[106:107], v[106:107], v[170:171]
    s_waitcnt lgkmcnt(0)
    v_pk_add_f32 v[244:245], v[244:245], v[188:189]
    v_add_f32 v246, v246, v190
    v_pk_add_f32 v[244:245], v[244:245], v[192:193]
    v_add_f32 v246, v246, v194
    s_cbranch_vccnz K2_GLOOP
    s_mov_b64 exec, -1
K2_GDONE:
    s_cmp_eq_u32 s93, 0
    s_cbranch_scc1 K2_EPI
    buffer_store_dwordx4 v[76:79], v243, s[20:23], s99 offen offset:0
    buffer_store_dwordx4 v[80:83], v243, s[20:23], s99 offen offset:16
    buffer_store_dwordx4 v[84:87], v243, s[20:23], s99 offen offset:32
    buffer_store_dwordx4 v[88:91], v243, s[20:23], s99 offen offset:48
    buffer_store_dwordx4 v[92:95], v243, s[20:23], s99 offen offset:64
    buffer_store_dwordx4 v[96:99], v243, s[20:23], s99 offen offset:80
    buffer_store_dwordx4 v[100:103], v243, s[20:23], s99 offen offset:96
    buffer_store_dwordx4 v[104:107], v243, s[20:23], s99 offen offset:112
    buffer_store_dwordx3 v[244:246], v249, s[20:23], s99 offen offset:256
    s_add_u32 s7, s7, s92
    s_waitcnt vmcnt(0)
    s_barrier
    s_branch K2_TOP
K2_EPI:
    s_cmp_ge_u32 s5, 6
    s_cbranch_scc1 K2_NWH2
    s_mul_i32 s95, s5, 2048
    s_add_u32 m0, s95, 138240
    s_add_u32 s95, s95, 7561216
    buffer_load_dwordx4 v203, s[20:23], s95 offen offset:0 lds
    buffer_load_dwordx4 v203, s[20:23], s95 offen offset:1024 lds
K2_NWH2:
    s_lshl_b32 s95, s5, 5
    s_cmp_ge_u32 s95, s96
    s_waitcnt vmcnt(0)
    s_barrier
    s_cbranch_scc1 K2_END0
    ds_read_b128 v[0:3], v220 offset:20480
    ds_read_b128 v[4:7], v220 offset:21504
    ds_read_b128 v[8:11], v220 offset:22528
    ds_read_b128 v[12:15], v220 offset:23552
    ds_read_b128 v[16:19], v220 offset:0
    ds_read_b128 v[20:23], v220 offset:1024
    ds_read_b128 v[24:27], v220 offset:2048
    ds_read_b128 v[28:31], v220 offset:3072
    ds_read_b128 v[44:47], v220 offset:4096
    ds_read_b128 v[48:51], v220 offset:5120
    ds_read_b128 v[52:55], v220 offset:6144
    ds_read_b128 v[56:59], v220 offset:7168
    ds_read_b128 v[60:63], v220 offset:8192
    ds_read_b128 v[64:67], v220 offset:9216
    ds_read_b128 v[68:71], v220 offset:10240
    ds_read_b128 v[72:75], v220 offset:11264
    v_cmp_gt_u32_e64 s[44:45], s96, v223
    s_mov_b32 s98, s101
    s_waitcnt vmcnt(0)
    v_mov_b32 v242, v241
    v_and_b32 v241, 0xffff0000, v240
    v_lshlrev_b32 v240, 16, v240
K2_TAIL:
    v_add_u32 v235, s98, v203
    v_lshlrev_b32 v203, 7, v218
    v_cndmask_b32_e64 v203, 2.0, v203, s[44:45]
    s_waitcnt lgkmcnt(8)
    v_mfma_f32_32x32x16_bf16 v[140:155], v[0:3], v[172:175], 0
    v_cvt_pk_bf16_f32 v108, v76, v77
    v_cvt_pk_bf16_f32 v109, v78, v79
    v_mfma_f32_32x32x16_bf16 v[156:171], v[16:19], v[172:175], 0
    v_cvt_pk_bf16_f32 v110, v80, v81
    v_cvt_pk_bf16_f32 v111, v82, v83
    v_mfma_f32_32x32x16_bf16 v[140:155], v[4:7], v[176:179], v[140:155]
    v_cvt_pk_bf16_f32 v112, v84, v85
    v_cvt_pk_bf16_f32 v113, v86, v87
    v_mfma_f32_32x32x16_bf16 v[156:171], v[20:23], v[176:179], v[156:171]
    v_cvt_pk_bf16_f32 v114, v88, v89
    v_cvt_pk_bf16_f32 v115, v90, v91
    v_mfma_f32_32x32x16_bf16 v[140:155], v[8:11], v[180:183], v[140:155]
    v_cvt_pk_bf16_f32 v116, v92, v93
    v_cvt_pk_bf16_f32 v117, v94, v95
    v_mfma_f32_32x32x16_bf16 v[156:171], v[24:27], v[180:183], v[156:171]
    v_cvt_pk_bf16_f32 v118, v96, v97
    v_cvt_pk_bf16_f32 v119, v98, v99
    v_mfma_f32_32x32x16_bf16 v[140:155], v[12:15], v[184:187], v[140:155]
    v_cvt_pk_bf16_f32 v120, v100, v101
    v_cvt_pk_bf16_f32 v121, v102, v103
    v_mfma_f32_32x32x16_bf16 v[156:171], v[28:31], v[184:187], v[156:171]
    v_cvt_pk_bf16_f32 v122, v104, v105
    v_cvt_pk_bf16_f32 v123, v106, v107
    s_waitcnt lgkmcnt(0)
    ds_bpermute_b32 v210, v239, v203 offset:0
    ds_bpermute_b32 v212, v239, v203 offset:32
    ds_bpermute_b32 v214, v239, v203 offset:64
    ds_bpermute_b32 v216, v239, v203 offset:96
    v_mfma_f32_32x32x16_bf16 v[140:155], v[44:47], v[108:111], v[140:155]
    v_lshlrev_b32 v76, 16, v172
    v_and_b32 v77, 0xffff0000, v172
    v_lshlrev_b32 v78, 16, v173
    v_and_b32 v79, 0xffff0000, v173
    v_lshlrev_b32 v80, 16, v174
    v_and_b32 v81, 0xffff0000, v174
    v_lshlrev_b32 v82, 16, v175
    v_and_b32 v83, 0xffff0000, v175
    v_mfma_f32_32x32x16_bf16 v[140:155], v[48:51], v[112:115], v[140:155]
    v_lshlrev_b32 v84, 16, v176
    v_and_b32 v85, 0xffff0000, v176
    v_lshlrev_b32 v86, 16, v177
    v_and_b32 v87, 0xffff0000, v177
    v_lshlrev_b32 v88, 16, v178
    v_and_b32 v89, 0xffff0000, v178
    v_lshlrev_b32 v90, 16, v179
    v_and_b32 v91, 0xffff0000, v179
    v_mfma_f32_32x32x16_bf16 v[140:155], v[52:55], v[116:119], v[140:155]
    v_lshlrev_b32 v92, 16, v180
    v_and_b32 v93, 0xffff0000, v180
    v_lshlrev_b32 v94, 16, v181
    v_and_b32 v95, 0xffff0000, v181
    v_lshlrev_b32 v96, 16, v182
    v_and_b32 v97, 0xffff0000, v182
    v_lshlrev_b32 v98, 16, v183
    v_and_b32 v99, 0xffff0000, v183
    v_mfma_f32_32x32x16_bf16 v[140:155], v[56:59], v[120:123], v[140:155]
    v_lshlrev_b32 v100, 16, v184
    v_and_b32 v101, 0xffff0000, v184
    v_lshlrev_b32 v102, 16, v185
    v_and_b32 v103, 0xffff0000, v185
    v_lshlrev_b32 v104, 16, v186
    v_and_b32 v105, 0xffff0000, v186
    v_lshlrev_b32 v106, 16, v187
    v_and_b32 v107, 0xffff0000, v187
    v_mfma_f32_32x32x16_bf16 v[156:171], v[60:63], v[108:111], v[156:171]
    v_mov_b32 v243, 0
    v_pk_add_f32 v[244:245], v[244:245], v[240:241]
    v_add_f32 v246, v246, v242
    v_cvt_pk_bf16_f32 v244, v244, v245
    v_cvt_pk_bf16_f32 v246, v246, v246
    s_mov_b32 exec_lo, s44
    s_mov_b32 exec_hi, 0
    s_cmp_eq_u32 s98, s94
    s_cbranch_scc1 K2_PF
    v_mul_u32_u24 v220, 6, v218
    s_mov_b32 s99, 6400000
    buffer_store_short v244, v220, s[24:27], s99 offen
    buffer_store_short_d16_hi v244, v220, s[24:27], s99 offen offset:2
    buffer_store_short v246, v220, s[24:27], s99 offen offset:4
    s_branch K2_PD
K2_PF:
    s_mov_b32 s99, 32768
    v_mad_u32_u24 v220, v249, 6, s99
    ds_write_b16 v220, v244
    ds_write_b16_d16_hi v220, v244 offset:2
    ds_write_b16 v220, v246 offset:4
    s_mov_b64 exec, 1
    v_mov_b32 v220, 108
    v_mov_b32 v221, 1
    ds_add_rtn_u32 v243, v220, v221
K2_PD:
    s_mov_b64 exec, -1
    s_mov_b32 s40, 0xbf317218
    s_mov_b32 s41, 0xbf317218
    v_mfma_f32_32x32x16_bf16 v[156:171], v[64:67], v[112:115], v[156:171]
    v_exp_f32 v220, v140
    v_exp_f32 v221, v141
    v_exp_f32 v222, v142
    v_exp_f32 v223, v143
    v_mfma_f32_32x32x16_bf16 v[156:171], v[68:71], v[116:119], v[156:171]
    v_exp_f32 v224, v144
    v_exp_f32 v225, v145
    v_exp_f32 v226, v146
    v_exp_f32 v227, v147
    v_pk_add_f32 v[220:221], v[220:221], 1.0 op_sel_hi:[1,0]
    v_pk_add_f32 v[222:223], v[222:223], 1.0 op_sel_hi:[1,0]
    v_mfma_f32_32x32x16_bf16 v[156:171], v[72:75], v[120:123], v[156:171]
    v_pk_add_f32 v[224:225], v[224:225], 1.0 op_sel_hi:[1,0]
    v_pk_add_f32 v[226:227], v[226:227], 1.0 op_sel_hi:[1,0]
    v_rcp_f32 v220, v220
    v_rcp_f32 v221, v221
    v_rcp_f32 v222, v222
    v_rcp_f32 v223, v223
    v_rcp_f32 v224, v224
    v_rcp_f32 v225, v225
    v_rcp_f32 v226, v226
    v_rcp_f32 v227, v227
    s_waitcnt lgkmcnt(0)
    v_add_u32 v210, v210, v211
    v_add_u32 v212, v212, v213
    v_add_u32 v214, v214, v215
    v_add_u32 v216, v216, v217
    v_pk_mul_f32 v[220:221], v[220:221], v[140:141]
    v_pk_mul_f32 v[222:223], v[222:223], v[142:143]
    v_pk_mul_f32 v[224:225], v[224:225], v[144:145]
    v_pk_mul_f32 v[226:227], v[226:227], v[146:147]
    v_pk_fma_f32 v[220:221], v[220:221], s[40:41], v[76:77]
    v_pk_fma_f32 v[222:223], v[222:223], s[40:41], v[78:79]
    v_pk_fma_f32 v[224:225], v[224:225], s[40:41], v[80:81]
    v_pk_fma_f32 v[226:227], v[226:227], s[40:41], v[82:83]
    v_cvt_pk_bf16_f32 v172, v220, v221
    v_cvt_pk_bf16_f32 v173, v222, v223
    v_cvt_pk_bf16_f32 v174, v224, v225
    v_cvt_pk_bf16_f32 v175, v226, v227
    s_waitcnt vmcnt(0)
    ds_write_b128 v251, v[172:175]
    v_exp_f32 v220, v148
    v_exp_f32 v221, v149
    v_exp_f32 v222, v150
    v_exp_f32 v223, v151
    v_exp_f32 v224, v152
    v_exp_f32 v225, v153
    v_exp_f32 v226, v154
    v_exp_f32 v227, v155
    v_pk_add_f32 v[220:221], v[220:221], 1.0 op_sel_hi:[1,0]
    v_pk_add_f32 v[222:223], v[222:223], 1.0 op_sel_hi:[1,0]
    v_pk_add_f32 v[224:225], v[224:225], 1.0 op_sel_hi:[1,0]
    v_pk_add_f32 v[226:227], v[226:227], 1.0 op_sel_hi:[1,0]
    v_rcp_f32 v220, v220
    v_rcp_f32 v221, v221
    v_rcp_f32 v222, v222
    v_rcp_f32 v223, v223
    v_rcp_f32 v224, v224
    v_rcp_f32 v225, v225
    v_rcp_f32 v226, v226
    v_rcp_f32 v227, v227
    v_pk_mul_f32 v[220:221], v[220:221], v[148:149]
    v_pk_mul_f32 v[222:223], v[222:223], v[150:151]
    v_pk_mul_f32 v[224:225], v[224:225], v[152:153]
    v_pk_mul_f32 v[226:227], v[226:227], v[154:155]
    v_pk_fma_f32 v[220:221], v[220:221], s[40:41], v[84:85]
    v_pk_fma_f32 v[222:223], v[222:223], s[40:41], v[86:87]
    v_pk_fma_f32 v[224:225], v[224:225], s[40:41], v[88:89]
    v_pk_fma_f32 v[226:227], v[226:227], s[40:41], v[90:91]
    v_cvt_pk_bf16_f32 v176, v220, v221
    v_cvt_pk_bf16_f32 v177, v222, v223
    v_cvt_pk_bf16_f32 v178, v224, v225
    v_cvt_pk_bf16_f32 v179, v226, v227
    ds_write_b128 v252, v[176:179]
    v_exp_f32 v220, v156
    v_exp_f32 v221, v157
    v_exp_f32 v222, v158
    v_exp_f32 v223, v159
    v_exp_f32 v224, v160
    v_exp_f32 v225, v161
    v_exp_f32 v226, v162
    v_exp_f32 v227, v163
    v_pk_add_f32 v[220:221], v[220:221], 1.0 op_sel_hi:[1,0]
    v_pk_add_f32 v[222:223], v[222:223], 1.0 op_sel_hi:[1,0]
    v_pk_add_f32 v[224:225], v[224:225], 1.0 op_sel_hi:[1,0]
    v_pk_add_f32 v[226:227], v[226:227], 1.0 op_sel_hi:[1,0]
    v_rcp_f32 v220, v220
    v_rcp_f32 v221, v221
    v_rcp_f32 v222, v222
    v_rcp_f32 v223, v223
    v_rcp_f32 v224, v224
    v_rcp_f32 v225, v225
    v_rcp_f32 v226, v226
    v_rcp_f32 v227, v227
    v_pk_mul_f32 v[220:221], v[220:221], v[156:157]
    v_pk_mul_f32 v[222:223], v[222:223], v[158:159]
    v_pk_mul_f32 v[224:225], v[224:225], v[160:161]
    v_pk_mul_f32 v[226:227], v[226:227], v[162:163]
    v_pk_fma_f32 v[220:221], v[220:221], s[40:41], v[92:93]
    v_pk_fma_f32 v[222:223], v[222:223], s[40:41], v[94:95]
    v_pk_fma_f32 v[224:225], v[224:225], s[40:41], v[96:97]
    v_pk_fma_f32 v[226:227], v[226:227], s[40:41], v[98:99]
    v_cvt_pk_bf16_f32 v180, v220, v221
    v_cvt_pk_bf16_f32 v181, v222, v223
    v_cvt_pk_bf16_f32 v182, v224, v225
    v_cvt_pk_bf16_f32 v183, v226, v227
    ds_write_b128 v253, v[180:183]
    v_exp_f32 v220, v164
    v_exp_f32 v221, v165
    v_exp_f32 v222, v166
    v_exp_f32 v223, v167
    v_exp_f32 v224, v168
    v_exp_f32 v225, v169
    v_exp_f32 v226, v170
    v_exp_f32 v227, v171
    v_pk_add_f32 v[220:221], v[220:221], 1.0 op_sel_hi:[1,0]
    v_pk_add_f32 v[222:223], v[222:223], 1.0 op_sel_hi:[1,0]
    v_pk_add_f32 v[224:225], v[224:225], 1.0 op_sel_hi:[1,0]
    v_pk_add_f32 v[226:227], v[226:227], 1.0 op_sel_hi:[1,0]
    v_rcp_f32 v220, v220
    v_rcp_f32 v221, v221
    v_rcp_f32 v222, v222
    v_rcp_f32 v223, v223
    v_rcp_f32 v224, v224
    v_rcp_f32 v225, v225
    v_rcp_f32 v226, v226
    v_rcp_f32 v227, v227
    v_pk_mul_f32 v[220:221], v[220:221], v[164:165]
    v_pk_mul_f32 v[222:223], v[222:223], v[166:167]
    v_pk_mul_f32 v[224:225], v[224:225], v[168:169]
    v_pk_mul_f32 v[226:227], v[226:227], v[170:171]
    v_pk_fma_f32 v[220:221], v[220:221], s[40:41], v[100:101]
    v_pk_fma_f32 v[222:223], v[222:223], s[40:41], v[102:103]
    v_pk_fma_f32 v[224:225], v[224:225], s[40:41], v[104:105]
    v_pk_fma_f32 v[226:227], v[226:227], s[40:41], v[106:107]
    v_cvt_pk_bf16_f32 v184, v220, v221
    v_cvt_pk_bf16_f32 v185, v222, v223
    v_cvt_pk_bf16_f32 v186, v224, v225
    v_cvt_pk_bf16_f32 v187, v226, v227
    ds_write_b128 v254, v[184:187]
    ds_read_b128 v[140:143], v235 offset:0
    ds_read_b128 v[144:147], v235 offset:1024
    ds_read_b128 v[148:151], v235 offset:2048
    ds_read_b128 v[152:155], v235 offset:3072
    s_waitcnt lgkmcnt(3)
    buffer_store_dwordx4 v[140:143], v210, s[24:27], 0 offen sc1
    s_waitcnt lgkmcnt(2)
    buffer_store_dwordx4 v[144:147], v212, s[24:27], 0 offen sc1
    s_waitcnt lgkmcnt(1)
    buffer_store_dwordx4 v[148:151], v214, s[24:27], 0 offen sc1
    s_waitcnt lgkmcnt(0)
    buffer_store_dwordx4 v[152:155], v216, s[24:27], 0 offen sc1
    v_readfirstlane_b32 s95, v243
    v_and_b32 v220, 63, v250
    v_lshlrev_b32 v220, 3, v220
    s_cmp_lg_u32 s95, 7
    s_cbranch_scc1 K2_PE
    ds_read_b64 v[188:189], v220 offset:32768
    ds_read_b64 v[190:191], v220 offset:33280
    ds_read_b64 v[192:193], v220 offset:33792
    s_mul_i32 s99, s4, 6
    s_add_u32 s99, s99, 6400000
    s_mul_i32 s95, s96, 6
    v_cmp_gt_i32 vcc, s95, v220
    s_sub_i32 s95, s95, 512
    s_waitcnt lgkmcnt(2)
    s_mov_b64 exec, vcc
    buffer_store_dwordx2 v[188:189], v220, s[24:27], s99 offen offset:0 sc1
    v_cmp_gt_i32 vcc, s95, v220
    s_sub_i32 s95, s95, 512
    s_waitcnt lgkmcnt(1)
    s_mov_b64 exec, vcc
    buffer_store_dwordx2 v[190:191], v220, s[24:27], s99 offen offset:512 sc1
    v_cmp_gt_i32 vcc, s95, v220
    s_sub_i32 s95, s95, 512
    s_waitcnt lgkmcnt(0)
    s_mov_b64 exec, vcc
    buffer_store_dwordx2 v[192:193], v220, s[24:27], s99 offen offset:1024 sc1
    s_mov_b64 exec, -1
K2_PE:
    s_endpgm
K2_END0:
    s_waitcnt vmcnt(0)
K2_END:
    s_endpgm
.section .rodata,"a"
.p2align 6
.amdhsa_kernel egnn_sort_kernel
  .amdhsa_next_free_vgpr 56
  .amdhsa_next_free_sgpr 48
  .amdhsa_accum_offset 56
  .amdhsa_group_segment_fixed_size 0
  .amdhsa_kernarg_size 88
  .amdhsa_user_sgpr_count 2
  .amdhsa_user_sgpr_kernarg_segment_ptr 1
  .amdhsa_system_sgpr_workgroup_id_x 1
.end_amdhsa_kernel
.p2align 6
.amdhsa_kernel egnn_main_kernel
  .amdhsa_next_free_vgpr 256
  .amdhsa_next_free_sgpr 102
  .amdhsa_accum_offset 256
  .amdhsa_group_segment_fixed_size 0
  .amdhsa_kernarg_size 88
  .amdhsa_user_sgpr_count 2
  .amdhsa_user_sgpr_kernarg_segment_ptr 1
  .amdhsa_system_sgpr_workgroup_id_x 1
.end_amdhsa_kernel
```

```asm
; @launch kernel=egnn_sort_kernel grid=(250,1,1) block=(896,1,1) lds=27904
; @launch kernel=egnn_main_kernel grid=(256,1,1) block=(512,1,1) lds=162816
.amdgcn_target "amdgcn-amd-amdhsa--gfx950"
.text
.globl egnn_sort_kernel
.p2align 8
.type egnn_sort_kernel,@function
egnn_sort_kernel:
    s_cmp_ge_u32 s2, 250
    s_cbranch_scc1 K1_END
    s_load_dwordx2 s[38:39], s[0:1], 80
    v_lshrrev_b32 v1, 6, v0
    s_nop 0
    v_readfirstlane_b32 s3, v1
    s_cmp_ge_u32 s3, 13
    s_cbranch_scc1 K1_FRAG
    s_load_dwordx4 s[4:7], s[0:1], 24
    s_load_dwordx4 s[8:11], s[0:1], 8
    s_and_b32 s28, s2, 7
    s_min_u32 s29, s28, 2
    s_mul_i32 s28, s28, 31
    s_lshr_b32 s2, s2, 3
    s_add_u32 s2, s2, s28
    s_add_u32 s2, s2, s29
    v_lshlrev_b32 v1, 2, v0
    v_mov_b32 v2, 0
    v_mov_b32 v3, 1
    v_cmp_gt_u32 vcc, 288, v0
    s_mov_b64 exec, vcc
    ds_write_b32 v1, v2 offset:0
    s_mov_b64 exec, -1
    s_mul_i32 s28, s2, 12800
    s_mul_i32 s29, s2, 200
    s_mul_i32 s30, s2, 3200
    s_mov_b32 s31, 85599
    s_movk_i32 s32, -196
    v_add_u32 v12, s29, v0
    v_mul_u32_u24 v13, 6, v12
    v_lshlrev_b32 v14, 4, v0
    v_mov_b32 v15, 800
    v_cmp_gt_u32 s[34:35], v15, v0
    v_mov_b32 v15, 200
    v_cmp_gt_u32 s[36:37], v15, v0
    s_waitcnt lgkmcnt(0)
    s_mov_b32 s12, s4
    s_and_b32 s13, s5, 0xffff
    s_mov_b32 s14, 3200000
    s_mov_b32 s15, 0x20000
    s_mov_b32 s16, s6
    s_and_b32 s17, s7, 0xffff
    s_mov_b32 s18, 3200000
    s_mov_b32 s19, 0x20000
    s_mov_b32 s20, s8
    s_and_b32 s21, s9, 0xffff
    s_mov_b32 s22, 300000
    s_mov_b32 s23, 0x20000
    s_mov_b32 s24, s38
    s_and_b32 s25, s39, 0xffff
    s_mov_b32 s26, 25600000
    s_mov_b32 s27, 0x20000
    s_cmp_ge_u32 s3, 4
    s_cbranch_scc1 K1_NOPOS
    s_mov_b64 exec, s[36:37]
    buffer_load_ushort v16, v13, s[20:23], 0 offen
    buffer_load_ushort v17, v13, s[20:23], 0 offen offset:2
    buffer_load_ushort v18, v13, s[20:23], 0 offen offset:4
K1_NOPOS:
    s_mov_b64 exec, s[34:35]
    buffer_load_dwordx4 v[4:7], v14, s[16:19], s28 offen nt
    v_add_u32 v20, s30, v1
    v_add_u32 v22, 1, v20
    v_add_u32 v24, 2, v20
    v_add_u32 v26, 3, v20
    s_barrier
    s_waitcnt vmcnt(0)
    buffer_load_dwordx4 v[8:11], v14, s[12:15], s28 offen nt
    v_mul_u32_u24 v28, s31, v4
    v_lshrrev_b32 v28, 24, v28
    v_mad_i32_i24 v4, v28, s32, v4
    v_lshlrev_b32 v28, 2, v28
    ds_add_rtn_u32 v32, v28, v3 offset:0
    v_lshrrev_b32 v52, 7, v28
    v_mul_u32_u24 v29, s31, v5
    v_lshrrev_b32 v29, 24, v29
    v_mad_i32_i24 v5, v29, s32, v5
    v_lshlrev_b32 v29, 2, v29
    ds_add_rtn_u32 v33, v29, v3 offset:0
    v_lshrrev_b32 v53, 7, v29
    v_mul_u32_u24 v30, s31, v6
    v_lshrrev_b32 v30, 24, v30
    v_mad_i32_i24 v6, v30, s32, v6
    v_lshlrev_b32 v30, 2, v30
    ds_add_rtn_u32 v34, v30, v3 offset:0
    v_lshrrev_b32 v54, 7, v30
    v_mul_u32_u24 v31, s31, v7
    v_lshrrev_b32 v31, 24, v31
    v_mad_i32_i24 v7, v31, s32, v7
    v_lshlrev_b32 v31, 2, v31
    ds_add_rtn_u32 v35, v31, v3 offset:0
    v_lshrrev_b32 v55, 7, v31
    s_cmp_ge_u32 s3, 4
    s_cbranch_scc1 K1_P3
    s_mov_b64 exec, s[36:37]
    v_lshl_or_b32 v16, v17, 16, v16
    v_lshlrev_b32 v17, 16, v18
    v_lshlrev_b32 v12, 3, v12
    s_mov_b32 s33, 6684672
    buffer_store_dwordx2 v[16:17], v12, s[24:27], s33 offen
    s_mov_b64 exec, s[34:35]
K1_P3:
    s_mov_b64 exec, -1
    v_and_b32 v2, 63, v0
    v_lshlrev_b32 v2, 4, v2
    s_waitcnt lgkmcnt(0)
    s_barrier
    ds_read_b128 v[36:39], v2 offset:0
    s_waitcnt lgkmcnt(0)
    v_add_u32 v42, v36, v37
    v_add_u32 v43, v42, v38
    v_add_u32 v44, v43, v39
    v_mov_b32 v45, v44
    s_nop 1
    v_add_u32_dpp v45, v45, v45 row_shr:1 row_mask:0xf bank_mask:0xf
    s_nop 1
    v_add_u32_dpp v45, v45, v45 row_shr:2 row_mask:0xf bank_mask:0xf
    s_nop 1
    v_add_u32_dpp v45, v45, v45 row_shr:4 row_mask:0xf bank_mask:0xf
    s_nop 1
    v_add_u32_dpp v45, v45, v45 row_shr:8 row_mask:0xf bank_mask:0xf
    s_nop 1
    v_add_u32_dpp v45, v45, v45 row_bcast:15 row_mask:0xa bank_mask:0xf
    s_nop 1
    v_add_u32_dpp v45, v45, v45 row_bcast:31 row_mask:0xc bank_mask:0xf
    v_sub_u32 v40, v45, v44
    v_add_u32 v41, v40, v36
    v_add_u32 v42, v40, v42
    v_add_u32 v43, v40, v43
    v_lshlrev_b32 v48, 3, v40
    v_lshlrev_b32 v49, 3, v41
    v_lshlrev_b32 v50, 3, v42
    v_lshlrev_b32 v51, 3, v43
    ds_write_b128 v2, v[48:51] offset:1280
    s_mov_b64 exec, s[34:35]
    ds_read_b32 v28, v28 offset:1280
    ds_read_b32 v29, v29 offset:1280
    ds_read_b32 v30, v30 offset:1280
    ds_read_b32 v31, v31 offset:1280
    s_cmp_ge_u32 s3, 4
    s_cbranch_scc1 K1_SW0
    s_waitcnt vmcnt(1)
    s_branch K1_SW1
K1_SW0:
    s_waitcnt vmcnt(0)
K1_SW1:
    v_mul_u32_u24 v21, 2675, v8
    v_lshrrev_b32 v21, 24, v21
    v_sub_u32 v21, v21, v52
    v_and_b32 v21, 7, v21
    v_lshl_or_b32 v4, v4, 3, v21
    v_lshl_or_b32 v21, v4, 18, v8
    v_mul_u32_u24 v23, 2675, v9
    v_lshrrev_b32 v23, 24, v23
    v_sub_u32 v23, v23, v53
    v_and_b32 v23, 7, v23
    v_lshl_or_b32 v5, v5, 3, v23
    v_lshl_or_b32 v23, v5, 18, v9
    v_mul_u32_u24 v25, 2675, v10
    v_lshrrev_b32 v25, 24, v25
    v_sub_u32 v25, v25, v54
    v_and_b32 v25, 7, v25
    v_lshl_or_b32 v6, v6, 3, v25
    v_lshl_or_b32 v25, v6, 18, v10
    v_mul_u32_u24 v27, 2675, v11
    v_lshrrev_b32 v27, 24, v27
    v_sub_u32 v27, v27, v55
    v_and_b32 v27, 7, v27
    v_lshl_or_b32 v7, v7, 3, v27
    v_lshl_or_b32 v27, v7, 18, v11
    s_cmp_lg_u32 s3, 12
    s_cbranch_scc1 K1_NOOFF
    s_mov_b64 exec, -1
    v_lshl_or_b32 v40, v36, 16, v40
    v_lshl_or_b32 v41, v37, 16, v41
    v_lshl_or_b32 v42, v38, 16, v42
    v_lshl_or_b32 v43, v39, 16, v43
    v_lshlrev_b32 v2, 8, v2
    s_lshl_b32 s33, s2, 4
    s_add_u32 s33, s33, 6422528
    buffer_store_dwordx4 v[40:43], v2, s[24:27], s33 offen
    s_mov_b64 exec, s[34:35]
K1_NOOFF:
    s_waitcnt lgkmcnt(3)
    v_lshl_add_u32 v28, v32, 3, v28
    ds_write_b64 v28, v[20:21] offset:2304
    s_waitcnt lgkmcnt(3)
    v_lshl_add_u32 v29, v33, 3, v29
    ds_write_b64 v29, v[22:23] offset:2304
    s_waitcnt lgkmcnt(3)
    v_lshl_add_u32 v30, v34, 3, v30
    ds_write_b64 v30, v[24:25] offset:2304
    s_waitcnt lgkmcnt(3)
    v_lshl_add_u32 v31, v35, 3, v31
    ds_write_b64 v31, v[26:27] offset:2304
    s_mul_i32 s33, s2, 25600
    s_add_u32 s38, s33, 12800
    s_waitcnt lgkmcnt(0)
    s_barrier
    ds_read_b128 v[4:7], v14 offset:2304
    ds_read_b128 v[8:11], v14 offset:15104
    s_waitcnt lgkmcnt(1)
    buffer_store_dwordx4 v[4:7], v14, s[24:27], s33 offen sc1
    s_waitcnt lgkmcnt(0)
    buffer_store_dwordx4 v[8:11], v14, s[24:27], s38 offen sc1
    s_endpgm
K1_FRAG:
    s_cmp_ge_u32 s2, 144
    s_cbranch_scc1 K1_END
    s_load_dwordx4 s[4:7], s[0:1], 40
    s_load_dwordx2 s[8:9], s[0:1], 56
    s_lshr_b32 s28, s2, 2
    s_and_b32 s3, s2, 3
    s_lshl_b32 s3, s3, 6
    v_and_b32 v1, 63, v0
    v_add_u32 v1, s3, v1
    v_lshlrev_b32 v10, 2, v1
    s_lshl_b32 s33, s28, 10
    s_add_u32 s33, s33, 7536640
    s_mov_b32 s34, 0xbfb8aa3b
    s_waitcnt lgkmcnt(0)
    s_mov_b32 s12, s4
    s_and_b32 s13, s5, 0xffff
    s_mov_b32 s14, 18560
    s_mov_b32 s15, 0x20000
    s_mov_b32 s16, s6
    s_and_b32 s17, s7, 0xffff
    s_mov_b32 s18, 128
    s_mov_b32 s19, 0x20000
    s_mov_b32 s20, s8
    s_and_b32 s21, s9, 0xffff
    s_mov_b32 s22, 16384
    s_mov_b32 s23, 0x20000
    s_mov_b32 s24, s38
    s_and_b32 s25, s39, 0xffff
    s_mov_b32 s26, 25427968
    s_mov_b32 s27, 0x20000
    s_cmp_eq_u32 s28, 19
    s_cbranch_scc1 K1_WX
    s_cmp_eq_u32 s28, 18
    s_cbranch_scc1 K1_W3
    v_lshrrev_b32 v2, 2, v1
    v_and_b32 v3, 4, v2
    v_lshlrev_b32 v3, 3, v3
    v_bfe_u32 v4, v2, 3, 2
    v_lshl_add_u32 v3, v4, 2, v3
    v_and_b32 v4, 3, v2
    v_add_u32 v3, v3, v4
    v_lshrrev_b32 v5, 7, v1
    v_and_b32 v6, 3, v1
    s_mov_b32 s35, 32
    s_cmp_ge_u32 s28, 18
    s_cbranch_scc1 K1_FH
    s_cmp_ge_u32 s28, 16
    s_cbranch_scc1 K1_F4
    s_mov_b32 s36, s28
    s_branch K1_FC
K1_FH:
    s_sub_u32 s36, s28, 20
    s_mov_b32 s12, s20
    s_mov_b32 s13, s21
    s_mov_b32 s14, s22
    s_cmp_ge_u32 s36, 8
    s_cselect_b32 s34, 1.0, s34
K1_FC:
    s_lshr_b32 s37, s36, 3
    s_lshl_b32 s37, s37, 6
    s_and_b32 s38, s36, 3
    s_lshl_b32 s38, s38, 3
    s_add_u32 s37, s37, s38
    s_bfe_u32 s38, s36, 0x10002
    s_branch K1_FD
K1_F4:
    s_mov_b32 s35, 8
    s_movk_i32 s37, 129
    s_sub_u32 s38, s28, 16
K1_FD:
    s_lshl_b32 s38, s38, 4
    v_mul_u32_u24 v5, s35, v5
    v_lshl_add_u32 v5, v6, 1, v5
    v_add_u32 v5, s37, v5
    v_add_u32 v3, s38, v3
    v_lshlrev_b32 v3, 1, v3
    v_lshl_add_u32 v3, v5, 7, v3
    buffer_load_ushort v7, v3, s[12:15], 0 offen
    buffer_load_ushort v8, v3, s[12:15], 0 offen offset:128
    s_waitcnt vmcnt(0)
    v_lshlrev_b32 v7, 16, v7
    v_lshlrev_b32 v8, 16, v8
    v_mul_f32 v7, s34, v7
    v_mul_f32 v8, s34, v8
    v_cvt_pk_bf16_f32 v7, v7, v8
    buffer_store_dword v7, v10, s[24:27], s33 offen
    s_endpgm
K1_W3:
    v_and_b32 v2, 31, v1
    v_and_b32 v3, 4, v2
    v_lshlrev_b32 v3, 3, v3
    v_bfe_u32 v4, v2, 3, 2
    v_lshl_add_u32 v3, v4, 2, v3
    v_and_b32 v4, 3, v2
    v_add_u32 v3, v3, v4
    v_bfe_u32 v5, v1, 6, 1
    v_lshl_add_u32 v3, v5, 4, v3
    v_lshlrev_b32 v3, 1, v3
    s_movk_i32 s35, 16384
    buffer_load_ushort v7, v3, s[12:15], s35 offen
    v_and_b32 v6, 32, v1
    v_cmp_eq_u32 vcc, 0, v6
    s_waitcnt vmcnt(0)
    v_lshlrev_b32 v7, 16, v7
    v_mul_f32 v7, s34, v7
    v_cvt_pk_bf16_f32 v8, v7, v7
    v_lshlrev_b32 v8, 16, v8
    v_sub_f32 v9, v7, v8
    v_cvt_pk_bf16_f32 v7, v8, v9
    v_cndmask_b32 v7, 0, v7, vcc
    buffer_store_dword v7, v10, s[24:27], s33 offen
    s_endpgm
K1_WX:
    v_lshlrev_b32 v3, 1, v1
    buffer_load_ushort v7, v3, s[16:19], 0 offen
    s_waitcnt vmcnt(0)
    v_lshlrev_b32 v7, 16, v7
    v_mul_f32 v7, 0xbf317218, v7
    buffer_store_dword v7, v10, s[24:27], s33 offen
K1_END:
    s_endpgm
.globl egnn_main_kernel
.p2align 8
.type egnn_main_kernel,@function
egnn_main_kernel:
    s_cmp_ge_u32 s2, 256
    s_cbranch_scc1 K2_END
    s_load_dwordx2 s[28:29], s[0:1], 0
    s_load_dwordx2 s[30:31], s[0:1], 16
    s_load_dwordx2 s[32:33], s[0:1], 64
    s_load_dwordx2 s[34:35], s[0:1], 80
    v_mov_b32 v250, v0
    v_lshrrev_b32 v220, 6, v0
    s_and_b32 s3, s2, 7
    s_lshl_b32 s3, s3, 5
    v_readfirstlane_b32 s5, v220
    s_lshr_b32 s95, s2, 3
    s_add_u32 s3, s3, s95
    s_mul_i32 s4, s3, 196
    s_sub_u32 s96, 50000, s4
    s_min_u32 s96, s96, 196
    s_mov_b32 s7, 0
    s_mov_b32 s92, 48
    s_sub_u32 s100, 11, s5
    s_cmp_lt_u32 s5, 4
    s_cselect_b32 s100, s5, s100
    s_lshl_b32 s94, s100, 12
    s_add_u32 s94, s94, 34816
    s_waitcnt lgkmcnt(0)
    s_add_u32 s88, s34, 6422528
    s_addc_u32 s89, s35, 0
    s_and_b32 s89, s89, 0xffff
    s_mov_b32 s90, 262144
    s_mov_b32 s91, 0x20000
    s_mov_b32 s8, s28
    s_and_b32 s9, s29, 0xffff
    s_or_b32 s9, s9, 8388608
    s_mov_b32 s10, 50000
    s_mov_b32 s11, 0x20000
    s_mov_b32 s12, s30
    s_and_b32 s13, s31, 0xffff
    s_or_b32 s13, s13, 2097152
    s_mov_b32 s14, 800000
    s_mov_b32 s15, 0x20000
    s_add_u32 s16, s34, 6684672
    s_addc_u32 s17, s35, 0
    s_and_b32 s17, s17, 0xffff
    s_or_b32 s17, s17, 524288
    s_mov_b32 s18, 50000
    s_mov_b32 s19, 0x20000
    s_mov_b32 s20, s34
    s_and_b32 s21, s35, 0xffff
    s_mov_b32 s22, 25427968
    s_mov_b32 s23, 0x20000
    s_mov_b32 s24, s32
    s_and_b32 s25, s33, 0xffff
    s_mov_b32 s26, 6700000
    s_mov_b32 s27, 0x20000
K2_TOP:
    v_bfe_u32 v220, v250, 4, 2
    s_mul_i32 s95, s5, 36
    s_sub_u32 s95, s95, 36
    v_mad_u32_u24 v220, v220, 9, s95
    v_lshlrev_b32 v221, 4, v220
    s_and_b32 s95, s3, 3
    s_mul_i32 s95, s95, 1020
    s_lshl_b32 s99, s3, 10
    s_sub_u32 s95, s99, s95
    s_cmp_eq_u32 s5, 0
    s_cbranch_scc1 K2_NOOF
    buffer_load_dword v172, v221, s[88:91], s95 offen offset:0
    buffer_load_dword v173, v221, s[88:91], s95 offen offset:16
    buffer_load_dword v174, v221, s[88:91], s95 offen offset:32
    buffer_load_dword v175, v221, s[88:91], s95 offen offset:48
    buffer_load_dword v176, v221, s[88:91], s95 offen offset:64
    buffer_load_dword v177, v221, s[88:91], s95 offen offset:80
    buffer_load_dword v178, v221, s[88:91], s95 offen offset:96
    buffer_load_dword v179, v221, s[88:91], s95 offen offset:112
    buffer_load_dword v180, v221, s[88:91], s95 offen offset:128
K2_NOOF:
    v_and_b32 v222, 63, v250
    v_lshlrev_b32 v203, 4, v222
    v_lshrrev_b32 v239, 3, v222
    v_lshrrev_b32 v223, 4, v222
    v_xor_b32 v223, v223, v222
    v_and_b32 v223, 7, v223
    v_lshlrev_b32 v211, 4, v223
    v_xor_b32 v213, 64, v211
    v_mov_b32 v215, v211
    v_mov_b32 v217, v213
    s_lshl_b32 s95, s5, 5
    s_add_u32 s95, s95, s4
    v_add_u32 v210, s95, v239
    v_add_u32 v212, 8, v210
    v_add_u32 v214, 16, v210
    v_add_u32 v216, 24, v210
    s_add_u32 s99, s4, s96
    v_cmp_gt_u32 vcc, s99, v210
    s_nop 1
    v_cndmask_b32 v210, -1, v210, vcc
    v_cmp_gt_u32 vcc, s99, v212
    s_nop 1
    v_cndmask_b32 v212, -1, v212, vcc
    v_cmp_gt_u32 vcc, s99, v214
    s_nop 1
    v_cndmask_b32 v214, -1, v214, vcc
    v_cmp_gt_u32 vcc, s99, v216
    s_nop 1
    v_cndmask_b32 v216, -1, v216, vcc
    s_lshl_b32 s101, s5, 12
    s_add_u32 s101, s101, 100352
    s_barrier
    s_mul_i32 s95, s5, 3072
    s_add_u32 m0, s95, 138240
    s_add_u32 s95, s95, 7536640
    buffer_load_dwordx4 v203, s[20:23], s95 offen offset:0 lds
    buffer_load_dwordx4 v203, s[20:23], s95 offen offset:1024 lds
    buffer_load_dwordx4 v203, s[20:23], s95 offen offset:2048 lds
    v_mov_b32 v228, 0
    v_mov_b32 v229, 0
    v_mov_b32 v230, 0
    v_mov_b32 v231, 0
    s_lshl_b32 s95, s5, 10
    s_cmp_ge_u32 s5, 4
    s_cselect_b32 s99, 30720, 0
    s_add_u32 s95, s95, s99
    v_add_u32 v223, s95, v203
    ds_write_b128 v223, v[228:231]
    ds_write_b128 v223, v[228:231] offset:4096
    v_and_b32 v223, 2047, v223
    ds_write_b128 v223, v[228:231] offset:43008
    v_lshlrev_b32 v239, 2, v239
    v_mov_b32 v41, 0
    v_mov_b32 v43, 0
    v_mov_b32 v209, 0
    v_lshrrev_b32 v219, 5, v222
    v_lshlrev_b32 v219, 4, v219
    v_and_b32 v223, 31, v222
    v_bfe_u32 v251, v222, 1, 3
    v_lshlrev_b32 v251, 4, v251
    v_lshlrev_b32 v252, 2, v219
    v_xor_b32 v251, v251, v252
    v_lshl_add_u32 v251, v223, 7, v251
    v_add_u32 v251, s94, v251
    v_xor_b32 v252, 16, v251
    v_xor_b32 v253, 32, v251
    v_xor_b32 v254, 48, v251
    v_and_b32 v222, 15, v250
    v_cmp_gt_u32 vcc, 243, v220
    v_mul_u32_u24 v220, 3200, v220
    v_add3_u32 v220, v220, v222, s7
    v_add_u32 v221, 16, v222
    v_add_u32 v223, 32, v222
    v_cmp_gt_u32_e64 s[32:33], s92, v221
    v_cmp_gt_u32_e64 s[34:35], s92, v222
    s_nop 0
    v_cndmask_b32_e64 v221, 2.0, v221, s[32:33]
    v_cndmask_b32_e64 v223, 2.0, v223, s[32:33]
    v_cndmask_b32_e64 v222, 2.0, v222, s[34:35]
    s_cmp_eq_u32 s5, 0
    s_waitcnt vmcnt(3)
    s_cbranch_scc0 K2_MK
    s_branch K2_NOREC
K2_MK:
    v_cndmask_b32 v179, 0, v179, vcc
    v_cndmask_b32 v180, 0, v180, vcc
    v_and_b32 v98, 0xffff, v172
    v_lshrrev_b32 v172, 16, v172
    v_subrev_u32 v172, s7, v172
    v_cmp_gt_i32_e64 s[32:33], v172, v222
    v_add_lshl_u32 v98, v98, v220, 3
    s_mov_b32 s95, 0
    v_cndmask_b32_e64 v98, 2.0, v98, s[32:33]
    buffer_load_dwordx2 v[44:45], v98, s[20:23], s95 offen
    v_and_b32 v99, 0xffff, v173
    v_lshrrev_b32 v173, 16, v173
    v_subrev_u32 v173, s7, v173
    v_cmp_gt_i32_e64 s[34:35], v173, v222
    v_add_lshl_u32 v99, v99, v220, 3
    s_mov_b32 s95, 25600
    v_cndmask_b32_e64 v99, 2.0, v99, s[34:35]
    buffer_load_dwordx2 v[46:47], v99, s[20:23], s95 offen
    v_and_b32 v100, 0xffff, v174
    v_lshrrev_b32 v174, 16, v174
    v_subrev_u32 v174, s7, v174
    v_cmp_gt_i32_e64 s[36:37], v174, v222
    v_add_lshl_u32 v100, v100, v220, 3
    s_mov_b32 s95, 51200
    v_cndmask_b32_e64 v100, 2.0, v100, s[36:37]
    buffer_load_dwordx2 v[48:49], v100, s[20:23], s95 offen
    v_and_b32 v101, 0xffff, v175
    v_lshrrev_b32 v175, 16, v175
    v_subrev_u32 v175, s7, v175
    v_cmp_gt_i32_e64 s[38:39], v175, v222
    v_add_lshl_u32 v101, v101, v220, 3
    s_mov_b32 s95, 76800
    v_cndmask_b32_e64 v101, 2.0, v101, s[38:39]
    buffer_load_dwordx2 v[50:51], v101, s[20:23], s95 offen
    v_and_b32 v102, 0xffff, v176
    v_lshrrev_b32 v176, 16, v176
    v_subrev_u32 v176, s7, v176
    v_cmp_gt_i32_e64 s[40:41], v176, v222
    v_add_lshl_u32 v102, v102, v220, 3
    s_mov_b32 s95, 102400
    v_cndmask_b32_e64 v102, 2.0, v102, s[40:41]
    buffer_load_dwordx2 v[52:53], v102, s[20:23], s95 offen
    v_and_b32 v103, 0xffff, v177
    v_lshrrev_b32 v177, 16, v177
    v_subrev_u32 v177, s7, v177
    v_cmp_gt_i32_e64 s[42:43], v177, v222
    v_add_lshl_u32 v103, v103, v220, 3
    s_mov_b32 s95, 128000
    v_cndmask_b32_e64 v103, 2.0, v103, s[42:43]
    buffer_load_dwordx2 v[54:55], v103, s[20:23], s95 offen
    v_and_b32 v104, 0xffff, v178
    v_lshrrev_b32 v178, 16, v178
    v_subrev_u32 v178, s7, v178
    v_cmp_gt_i32_e64 s[44:45], v178, v222
    v_add_lshl_u32 v104, v104, v220, 3
    s_mov_b32 s95, 153600
    v_cndmask_b32_e64 v104, 2.0, v104, s[44:45]
    buffer_load_dwordx2 v[56:57], v104, s[20:23], s95 offen
    v_and_b32 v105, 0xffff, v179
    v_lshrrev_b32 v179, 16, v179
    v_subrev_u32 v179, s7, v179
    v_cmp_gt_i32_e64 s[46:47], v179, v222
    v_add_lshl_u32 v105, v105, v220, 3
    s_mov_b32 s95, 179200
    v_cndmask_b32_e64 v105, 2.0, v105, s[46:47]
    buffer_load_dwordx2 v[58:59], v105, s[20:23], s95 offen
    v_and_b32 v106, 0xffff, v180
    v_lshrrev_b32 v180, 16, v180
    v_subrev_u32 v180, s7, v180
    v_cmp_gt_i32_e64 s[48:49], v180, v222
    v_add_lshl_u32 v106, v106, v220, 3
    s_mov_b32 s95, 204800
    v_cndmask_b32_e64 v106, 2.0, v106, s[48:49]
    buffer_load_dwordx2 v[60:61], v106, s[20:23], s95 offen
    v_cmp_gt_i32_e64 s[50:51], v172, v221
    v_cmp_gt_i32_e64 s[68:69], v172, v223
    v_cmp_gt_i32_e64 s[52:53], v173, v221
    v_cmp_gt_i32_e64 s[70:71], v173, v223
    v_cmp_gt_i32_e64 s[54:55], v174, v221
    v_cmp_gt_i32_e64 s[72:73], v174, v223
    v_cmp_gt_i32_e64 s[56:57], v175, v221
    v_cmp_gt_i32_e64 s[74:75], v175, v223
    v_cmp_gt_i32_e64 s[58:59], v176, v221
    v_cmp_gt_i32_e64 s[76:77], v176, v223
    v_cmp_gt_i32_e64 s[60:61], v177, v221
    v_cmp_gt_i32_e64 s[78:79], v177, v223
    v_cmp_gt_i32_e64 s[62:63], v178, v221
    v_cmp_gt_i32_e64 s[80:81], v178, v223
    v_cmp_gt_i32_e64 s[64:65], v179, v221
    v_cmp_gt_i32_e64 s[82:83], v179, v223
    v_cmp_gt_i32_e64 s[66:67], v180, v221
    v_cmp_gt_i32_e64 s[84:85], v180, v223
    s_mov_b32 s95, 0
    s_mov_b64 exec, s[50:51]
    s_cbranch_execz K2_G1
    buffer_load_dwordx2 v[62:63], v98, s[20:23], s95 offen offset:128
K2_G1:
    s_mov_b32 s95, 25600
    s_mov_b64 exec, s[52:53]
    s_cbranch_execz K2_G2
    buffer_load_dwordx2 v[64:65], v99, s[20:23], s95 offen offset:128
K2_G2:
    s_mov_b32 s95, 51200
    s_mov_b64 exec, s[54:55]
    s_cbranch_execz K2_G3
    buffer_load_dwordx2 v[66:67], v100, s[20:23], s95 offen offset:128
K2_G3:
    s_mov_b32 s95, 76800
    s_mov_b64 exec, s[56:57]
    s_cbranch_execz K2_G4
    buffer_load_dwordx2 v[68:69], v101, s[20:23], s95 offen offset:128
K2_G4:
    s_mov_b32 s95, 102400
    s_mov_b64 exec, s[58:59]
    s_cbranch_execz K2_G5
    buffer_load_dwordx2 v[70:71], v102, s[20:23], s95 offen offset:128
K2_G5:
    s_mov_b32 s95, 128000
    s_mov_b64 exec, s[60:61]
    s_cbranch_execz K2_G6
    buffer_load_dwordx2 v[72:73], v103, s[20:23], s95 offen offset:128
K2_G6:
    s_mov_b32 s95, 153600
    s_mov_b64 exec, s[62:63]
    s_cbranch_execz K2_G7
    buffer_load_dwordx2 v[74:75], v104, s[20:23], s95 offen offset:128
K2_G7:
    s_mov_b32 s95, 179200
    s_mov_b64 exec, s[64:65]
    s_cbranch_execz K2_G8
    buffer_load_dwordx2 v[76:77], v105, s[20:23], s95 offen offset:128
K2_G8:
    s_mov_b32 s95, 204800
    s_mov_b64 exec, s[66:67]
    s_cbranch_execz K2_G9
    buffer_load_dwordx2 v[78:79], v106, s[20:23], s95 offen offset:128
K2_G9:
    s_or_b64 vcc, s[68:69], s[70:71]
    s_or_b64 vcc, vcc, s[72:73]
    s_or_b64 vcc, vcc, s[74:75]
    s_or_b64 vcc, vcc, s[76:77]
    s_or_b64 vcc, vcc, s[78:79]
    s_or_b64 vcc, vcc, s[80:81]
    s_or_b64 vcc, vcc, s[82:83]
    s_or_b64 vcc, vcc, s[84:85]
    s_cselect_b32 s97, 1, 0
    s_cbranch_scc0 K2_NP2A
    s_mov_b32 s95, 0
    s_mov_b64 exec, s[68:69]
    s_cbranch_execz K2_G10
    buffer_load_dwordx2 v[80:81], v98, s[20:23], s95 offen offset:256
K2_G10:
    s_mov_b32 s95, 25600
    s_mov_b64 exec, s[70:71]
    s_cbranch_execz K2_G11
    buffer_load_dwordx2 v[82:83], v99, s[20:23], s95 offen offset:256
K2_G11:
    s_mov_b32 s95, 51200
    s_mov_b64 exec, s[72:73]
    s_cbranch_execz K2_G12
    buffer_load_dwordx2 v[84:85], v100, s[20:23], s95 offen offset:256
K2_G12:
    s_mov_b32 s95, 76800
    s_mov_b64 exec, s[74:75]
    s_cbranch_execz K2_G13
    buffer_load_dwordx2 v[86:87], v101, s[20:23], s95 offen offset:256
K2_G13:
    s_mov_b32 s95, 102400
    s_mov_b64 exec, s[76:77]
    s_cbranch_execz K2_G14
    buffer_load_dwordx2 v[88:89], v102, s[20:23], s95 offen offset:256
K2_G14:
    s_mov_b32 s95, 128000
    s_mov_b64 exec, s[78:79]
    s_cbranch_execz K2_G15
    buffer_load_dwordx2 v[90:91], v103, s[20:23], s95 offen offset:256
K2_G15:
    s_mov_b32 s95, 153600
    s_mov_b64 exec, s[80:81]
    s_cbranch_execz K2_G16
    buffer_load_dwordx2 v[92:93], v104, s[20:23], s95 offen offset:256
K2_G16:
    s_mov_b32 s95, 179200
    s_mov_b64 exec, s[82:83]
    s_cbranch_execz K2_G17
    buffer_load_dwordx2 v[94:95], v105, s[20:23], s95 offen offset:256
K2_G17:
    s_mov_b32 s95, 204800
    s_mov_b64 exec, s[84:85]
    s_cbranch_execz K2_G18
    buffer_load_dwordx2 v[96:97], v106, s[20:23], s95 offen offset:256
K2_G18:
K2_NP2A:
    s_mov_b64 exec, -1
    v_max3_i32 v221, v172, v173, v174
    v_max3_i32 v221, v221, v175, v176
    v_max3_i32 v221, v221, v177, v178
    v_max3_i32 v221, v221, v179, v180
    v_mov_b32 v223, 1
    v_cmp_lt_i32_e64 s[86:87], s92, v221
K2_NOREC:
    s_waitcnt lgkmcnt(0)
    s_barrier
    s_add_u32 s95, s101, 0
    s_cmp_lt_u32 s95, 125952
    s_cselect_b32 m0, s95, 47104
    s_nop 0
    buffer_load_dwordx4 v[210:211], s[8:11], 0 idxen offen lds
    s_add_u32 s95, s101, 1024
    s_cmp_lt_u32 s95, 125952
    s_cselect_b32 m0, s95, 47104
    s_nop 0
    buffer_load_dwordx4 v[212:213], s[8:11], 0 idxen offen lds
    s_add_u32 s95, s101, 2048
    s_cmp_lt_u32 s95, 125952
    s_cselect_b32 m0, s95, 47104
    s_nop 0
    buffer_load_dwordx4 v[214:215], s[8:11], 0 idxen offen lds
    s_add_u32 s95, s101, 3072
    s_cmp_lt_u32 s95, 125952
    s_cselect_b32 m0, s95, 47104
    s_nop 0
    buffer_load_dwordx4 v[216:217], s[8:11], 0 idxen offen lds
    s_cmp_lg_u32 s5, 0
    s_cbranch_scc1 K2_NOPW
    s_lshr_b32 s95, s2, 3
    s_mul_i32 s99, s95, 0
    v_add_u32 v224, s99, v203
    s_mul_i32 s99, s95, 0
    v_add_u32 v225, s99, v250
    v_add_u32 v224, 0, v250
    v_cmp_gt_u32 vcc, s96, v224
    s_nop 1
    v_cndmask_b32_e64 v104, -0.5, 0.5, vcc
    v_add_u32 v224, 64, v250
    v_cmp_gt_u32 vcc, s96, v224
    s_nop 1
    v_cndmask_b32_e64 v105, -0.5, 0.5, vcc
    v_add_u32 v224, 128, v250
    v_cmp_gt_u32 vcc, s96, v224
    s_nop 1
    v_cndmask_b32_e64 v106, -0.5, 0.5, vcc
    v_add_u32 v224, 192, v250
    v_cmp_gt_u32 vcc, s96, v224
    s_nop 1
    v_cndmask_b32_e64 v107, -0.5, 0.5, vcc
    s_branch K2_B1
K2_NOPW:
    s_mov_b64 exec, s[86:87]
    ds_write_b32 v228, v223 offset:96
    s_mov_b64 exec, -1
    s_waitcnt vmcnt(12)
    s_mov_b64 exec, s[32:33]
    v_lshrrev_b32 v172, 16, v45
    ds_add_rtn_u32 v172, v172, v223 offset:34816
    s_waitcnt vmcnt(11)
    s_mov_b64 exec, s[34:35]
    v_lshrrev_b32 v173, 16, v47
    ds_add_rtn_u32 v173, v173, v223 offset:34816
    s_waitcnt vmcnt(10)
    s_mov_b64 exec, s[36:37]
    v_lshrrev_b32 v174, 16, v49
    ds_add_rtn_u32 v174, v174, v223 offset:34816
    s_waitcnt vmcnt(9)
    s_mov_b64 exec, s[38:39]
    v_lshrrev_b32 v175, 16, v51
    ds_add_rtn_u32 v175, v175, v223 offset:34816
    s_waitcnt vmcnt(8)
    s_mov_b64 exec, s[40:41]
    v_lshrrev_b32 v176, 16, v53
    ds_add_rtn_u32 v176, v176, v223 offset:34816
    s_waitcnt vmcnt(7)
    s_mov_b64 exec, s[42:43]
    v_lshrrev_b32 v177, 16, v55
    ds_add_rtn_u32 v177, v177, v223 offset:34816
    s_waitcnt vmcnt(6)
    s_mov_b64 exec, s[44:45]
    v_lshrrev_b32 v178, 16, v57
    ds_add_rtn_u32 v178, v178, v223 offset:34816
    s_waitcnt vmcnt(5)
    s_mov_b64 exec, s[46:47]
    v_lshrrev_b32 v179, 16, v59
    ds_add_rtn_u32 v179, v179, v223 offset:34816
    s_waitcnt vmcnt(4)
    s_mov_b64 exec, s[48:49]
    v_lshrrev_b32 v180, 16, v61
    ds_add_rtn_u32 v180, v180, v223 offset:34816
    s_mov_b64 exec, s[50:51]
    s_cbranch_execz K2_G19
    v_lshrrev_b32 v181, 16, v63
    ds_add_rtn_u32 v181, v181, v223 offset:34816
K2_G19:
    s_mov_b64 exec, s[52:53]
    s_cbranch_execz K2_G20
    v_lshrrev_b32 v182, 16, v65
    ds_add_rtn_u32 v182, v182, v223 offset:34816
K2_G20:
    s_mov_b64 exec, s[54:55]
    s_cbranch_execz K2_G21
    v_lshrrev_b32 v183, 16, v67
    ds_add_rtn_u32 v183, v183, v223 offset:34816
K2_G21:
    s_mov_b64 exec, s[56:57]
    s_cbranch_execz K2_G22
    v_lshrrev_b32 v184, 16, v69
    ds_add_rtn_u32 v184, v184, v223 offset:34816
K2_G22:
    s_mov_b64 exec, s[58:59]
    s_cbranch_execz K2_G23
    v_lshrrev_b32 v185, 16, v71
    ds_add_rtn_u32 v185, v185, v223 offset:34816
K2_G23:
    s_mov_b64 exec, s[60:61]
    s_cbranch_execz K2_G24
    v_lshrrev_b32 v186, 16, v73
    ds_add_rtn_u32 v186, v186, v223 offset:34816
K2_G24:
    s_mov_b64 exec, s[62:63]
    s_cbranch_execz K2_G25
    v_lshrrev_b32 v187, 16, v75
    ds_add_rtn_u32 v187, v187, v223 offset:34816
K2_G25:
    s_mov_b64 exec, s[64:65]
    s_cbranch_execz K2_G26
    v_lshrrev_b32 v188, 16, v77
    ds_add_rtn_u32 v188, v188, v223 offset:34816
K2_G26:
    s_mov_b64 exec, s[66:67]
    s_cbranch_execz K2_G27
    v_lshrrev_b32 v189, 16, v79
    ds_add_rtn_u32 v189, v189, v223 offset:34816
K2_G27:
    s_cmp_eq_u32 s97, 0
    s_cbranch_scc1 K2_NP2B
    s_mov_b64 exec, s[68:69]
    s_cbranch_execz K2_G28
    v_lshrrev_b32 v190, 16, v81
    ds_add_rtn_u32 v190, v190, v223 offset:34816
K2_G28:
    s_mov_b64 exec, s[70:71]
    s_cbranch_execz K2_G29
    v_lshrrev_b32 v191, 16, v83
    ds_add_rtn_u32 v191, v191, v223 offset:34816
K2_G29:
    s_mov_b64 exec, s[72:73]
    s_cbranch_execz K2_G30
    v_lshrrev_b32 v192, 16, v85
    ds_add_rtn_u32 v192, v192, v223 offset:34816
K2_G30:
    s_mov_b64 exec, s[74:75]
    s_cbranch_execz K2_G31
    v_lshrrev_b32 v193, 16, v87
    ds_add_rtn_u32 v193, v193, v223 offset:34816
K2_G31:
    s_mov_b64 exec, s[76:77]
    s_cbranch_execz K2_G32
    v_lshrrev_b32 v194, 16, v89
    ds_add_rtn_u32 v194, v194, v223 offset:34816
K2_G32:
    s_mov_b64 exec, s[78:79]
    s_cbranch_execz K2_G33
    v_lshrrev_b32 v195, 16, v91
    ds_add_rtn_u32 v195, v195, v223 offset:34816
K2_G33:
    s_mov_b64 exec, s[80:81]
    s_cbranch_execz K2_G34
    v_lshrrev_b32 v196, 16, v93
    ds_add_rtn_u32 v196, v196, v223 offset:34816
K2_G34:
    s_mov_b64 exec, s[82:83]
    s_cbranch_execz K2_G35
    v_lshrrev_b32 v197, 16, v95
    ds_add_rtn_u32 v197, v197, v223 offset:34816
K2_G35:
    s_mov_b64 exec, s[84:85]
    s_cbranch_execz K2_G36
    v_lshrrev_b32 v198, 16, v97
    ds_add_rtn_u32 v198, v198, v223 offset:34816
K2_G36:
K2_NP2B:
    s_mov_b64 exec, -1
K2_B1:
    s_cmp_lg_u32 s5, 0
    s_waitcnt lgkmcnt(0)
    s_barrier
    s_cbranch_scc1 K2_W2
    v_lshlrev_b32 v222, 1, v203
    ds_read_b128 v[0:3], v222 offset:34816
    ds_read_b128 v[4:7], v222 offset:34832
    ds_read_b128 v[8:11], v222 offset:36864
    ds_read_b128 v[12:15], v222 offset:36880
    ds_read_b128 v[16:19], v222 offset:38912
    ds_read_b128 v[20:23], v222 offset:38928
    ds_read_b128 v[24:27], v222 offset:40960
    ds_read_b128 v[28:31], v222 offset:40976
    s_waitcnt lgkmcnt(6)
    v_add3_u32 v76, v0, v1, v2
    v_add3_u32 v80, v3, v4, v5
    v_add3_u32 v76, v76, v6, v7
    v_add_u32 v76, v76, v80
    s_waitcnt lgkmcnt(4)
    v_add3_u32 v77, v8, v9, v10
    v_add3_u32 v81, v11, v12, v13
    v_add3_u32 v77, v77, v14, v15
    v_add_u32 v77, v77, v81
    s_waitcnt lgkmcnt(2)
    v_add3_u32 v78, v16, v17, v18
    v_add3_u32 v82, v19, v20, v21
    v_add3_u32 v78, v78, v22, v23
    v_add_u32 v78, v78, v82
    s_waitcnt lgkmcnt(0)
    v_add3_u32 v79, v24, v25, v26
    v_add3_u32 v83, v27, v28, v29
    v_add3_u32 v79, v79, v30, v31
    v_add_u32 v79, v79, v83
    v_add_u32 v82, v76, v77
    v_add_u32 v83, v82, v78
    v_add_u32 v220, v83, v79
    v_mov_b32 v221, v220
    s_nop 1
    v_add_u32_dpp v221, v221, v221 row_shr:1 row_mask:0xf bank_mask:0xf
    s_nop 1
    v_add_u32_dpp v221, v221, v221 row_shr:2 row_mask:0xf bank_mask:0xf
    s_nop 1
    v_add_u32_dpp v221, v221, v221 row_shr:4 row_mask:0xf bank_mask:0xf
    s_nop 1
    v_add_u32_dpp v221, v221, v221 row_shr:8 row_mask:0xf bank_mask:0xf
    s_nop 1
    v_add_u32_dpp v221, v221, v221 row_bcast:15 row_mask:0xa bank_mask:0xf
    s_nop 1
    v_add_u32_dpp v221, v221, v221 row_bcast:31 row_mask:0xc bank_mask:0xf
    v_sub_u32 v80, v221, v220
    v_add_u32 v81, v80, v76
    v_add_u32 v82, v80, v82
    v_add_u32 v83, v80, v83
    s_movk_i32 s95, 2560
    v_lshl_add_u32 v140, v80, 3, s95
    v_lshl_add_u32 v141, v0, 3, v140
    v_lshl_add_u32 v142, v1, 3, v141
    v_lshl_add_u32 v143, v2, 3, v142
    ds_write_b128 v222, v[140:143] offset:34816
    v_lshl_add_u32 v144, v3, 3, v143
    v_lshl_add_u32 v145, v4, 3, v144
    v_lshl_add_u32 v146, v5, 3, v145
    v_lshl_add_u32 v147, v6, 3, v146
    ds_write_b128 v222, v[144:147] offset:34832
    v_lshl_add_u32 v148, v81, 3, s95
    v_lshl_add_u32 v149, v8, 3, v148
    v_lshl_add_u32 v150, v9, 3, v149
    v_lshl_add_u32 v151, v10, 3, v150
    ds_write_b128 v222, v[148:151] offset:36864
    v_lshl_add_u32 v152, v11, 3, v151
    v_lshl_add_u32 v153, v12, 3, v152
    v_lshl_add_u32 v154, v13, 3, v153
    v_lshl_add_u32 v155, v14, 3, v154
    ds_write_b128 v222, v[152:155] offset:36880
    v_lshl_add_u32 v156, v82, 3, s95
    v_lshl_add_u32 v157, v16, 3, v156
    v_lshl_add_u32 v158, v17, 3, v157
    v_lshl_add_u32 v159, v18, 3, v158
    ds_write_b128 v222, v[156:159] offset:38912
    v_lshl_add_u32 v160, v19, 3, v159
    v_lshl_add_u32 v161, v20, 3, v160
    v_lshl_add_u32 v162, v21, 3, v161
    v_lshl_add_u32 v163, v22, 3, v162
    ds_write_b128 v222, v[160:163] offset:38928
    v_lshl_add_u32 v164, v83, 3, s95
    v_lshl_add_u32 v165, v24, 3, v164
    v_lshl_add_u32 v166, v25, 3, v165
    v_lshl_add_u32 v167, v26, 3, v166
    ds_write_b128 v222, v[164:167] offset:40960
    v_lshl_add_u32 v168, v27, 3, v167
    v_lshl_add_u32 v169, v28, 3, v168
    v_lshl_add_u32 v170, v29, 3, v169
    v_lshl_add_u32 v171, v30, 3, v170
    ds_write_b128 v222, v[168:171] offset:40976
    s_mov_b32 exec_lo, 0
    s_brev_b32 exec_hi, 1
    ds_write_b32 v228, v221 offset:100
    s_mov_b64 exec, -1
K2_W2:
    s_cmp_ge_u32 s5, 6
    s_cbranch_scc1 K2_NWH
    s_mul_i32 s95, s5, 2048
    s_add_u32 m0, s95, 125952
    s_add_u32 s95, s95, 7561216
    buffer_load_dwordx4 v203, s[20:23], s95 offen offset:0 lds
    buffer_load_dwordx4 v203, s[20:23], s95 offen offset:1024 lds
K2_NWH:
    s_cmp_eq_u32 s5, 0
    s_cbranch_scc1 K2_NFT
    s_mov_b32 s95, 1835008
    s_mov_b64 exec, s[32:33]
    v_and_or_b32 v140, v45, s95, v172
    v_lshrrev_b32 v141, 18, v45
    v_cmpx_gt_u32 vcc, 1, v140
    ds_write_b64 v141, v[44:45] offset:43008
    s_mov_b64 exec, s[34:35]
    v_and_or_b32 v142, v47, s95, v173
    v_lshrrev_b32 v143, 18, v47
    v_cmpx_gt_u32 vcc, 1, v142
    ds_write_b64 v143, v[46:47] offset:43008
    s_mov_b64 exec, s[36:37]
    v_and_or_b32 v144, v49, s95, v174
    v_lshrrev_b32 v145, 18, v49
    v_cmpx_gt_u32 vcc, 1, v144
    ds_write_b64 v145, v[48:49] offset:43008
    s_mov_b64 exec, s[38:39]
    v_and_or_b32 v146, v51, s95, v175
    v_lshrrev_b32 v147, 18, v51
    v_cmpx_gt_u32 vcc, 1, v146
    ds_write_b64 v147, v[50:51] offset:43008
    s_mov_b64 exec, s[40:41]
    v_and_or_b32 v148, v53, s95, v176
    v_lshrrev_b32 v149, 18, v53
    v_cmpx_gt_u32 vcc, 1, v148
    ds_write_b64 v149, v[52:53] offset:43008
    s_mov_b64 exec, s[42:43]
    v_and_or_b32 v150, v55, s95, v177
    v_lshrrev_b32 v151, 18, v55
    v_cmpx_gt_u32 vcc, 1, v150
    ds_write_b64 v151, v[54:55] offset:43008
    s_mov_b64 exec, s[44:45]
    v_and_or_b32 v152, v57, s95, v178
    v_lshrrev_b32 v153, 18, v57
    v_cmpx_gt_u32 vcc, 1, v152
    ds_write_b64 v153, v[56:57] offset:43008
    s_mov_b64 exec, s[46:47]
    v_and_or_b32 v154, v59, s95, v179
    v_lshrrev_b32 v155, 18, v59
    v_cmpx_gt_u32 vcc, 1, v154
    ds_write_b64 v155, v[58:59] offset:43008
    s_mov_b64 exec, s[48:49]
    v_and_or_b32 v156, v61, s95, v180
    v_lshrrev_b32 v157, 18, v61
    v_cmpx_gt_u32 vcc, 1, v156
    ds_write_b64 v157, v[60:61] offset:43008
    s_mov_b64 exec, -1
    s_mul_i32 s95, s5, 224
    v_lshrrev_b32 v140, 1, v203
    v_add_u32 v140, s95, v140
K2_NFT:
    s_cmp_eq_u32 s5, 0
    s_waitcnt lgkmcnt(0)
    s_barrier
    ds_read_b64 v[232:233], v228 offset:96
    s_cbranch_scc1 K2_NOS1
    ds_read_b64 v[140:141], v140 offset:42784
    s_mov_b64 exec, s[32:33]
    v_lshrrev_b32 v98, 16, v45
    ds_read_b32 v98, v98 offset:34816
    s_mov_b64 exec, s[34:35]
    v_lshrrev_b32 v99, 16, v47
    ds_read_b32 v99, v99 offset:34816
    s_mov_b64 exec, s[36:37]
    v_lshrrev_b32 v100, 16, v49
    ds_read_b32 v100, v100 offset:34816
    s_mov_b64 exec, s[38:39]
    v_lshrrev_b32 v101, 16, v51
    ds_read_b32 v101, v101 offset:34816
    s_mov_b64 exec, s[40:41]
    v_lshrrev_b32 v102, 16, v53
    ds_read_b32 v102, v102 offset:34816
    s_mov_b64 exec, s[42:43]
    v_lshrrev_b32 v103, 16, v55
    ds_read_b32 v103, v103 offset:34816
    s_mov_b64 exec, s[44:45]
    v_lshrrev_b32 v104, 16, v57
    ds_read_b32 v104, v104 offset:34816
    s_mov_b64 exec, s[46:47]
    v_lshrrev_b32 v105, 16, v59
    ds_read_b32 v105, v105 offset:34816
    s_mov_b64 exec, s[48:49]
    v_lshrrev_b32 v106, 16, v61
    ds_read_b32 v106, v106 offset:34816
    s_mov_b64 exec, -1
    s_waitcnt lgkmcnt(9)
    v_and_b32 v141, 0xffff, v141
    s_mov_b64 exec, 0xfffffff
    buffer_load_dword v202, v140, s[12:15], 0 idxen
    buffer_load_dword v202, v141, s[8:11], 0 idxen
    buffer_load_dword v202, v141, s[16:19], 0 idxen
    s_mov_b64 exec, s[50:51]
    s_cbranch_execz K2_G37
    v_lshrrev_b32 v220, 16, v63
    ds_read_b32 v220, v220 offset:34816
K2_G37:
    s_mov_b64 exec, s[52:53]
    s_cbranch_execz K2_G38
    v_lshrrev_b32 v221, 16, v65
    ds_read_b32 v221, v221 offset:34816
K2_G38:
    s_mov_b64 exec, s[54:55]
    s_cbranch_execz K2_G39
    v_lshrrev_b32 v222, 16, v67
    ds_read_b32 v222, v222 offset:34816
K2_G39:
    s_mov_b64 exec, s[56:57]
    s_cbranch_execz K2_G40
    v_lshrrev_b32 v223, 16, v69
    ds_read_b32 v223, v223 offset:34816
K2_G40:
    s_mov_b64 exec, s[58:59]
    s_cbranch_execz K2_G41
    v_lshrrev_b32 v224, 16, v71
    ds_read_b32 v224, v224 offset:34816
K2_G41:
    s_mov_b64 exec, s[60:61]
    s_cbranch_execz K2_G42
    v_lshrrev_b32 v225, 16, v73
    ds_read_b32 v225, v225 offset:34816
K2_G42:
    s_mov_b64 exec, s[62:63]
    s_cbranch_execz K2_G43
    v_lshrrev_b32 v226, 16, v75
    ds_read_b32 v226, v226 offset:34816
K2_G43:
    s_mov_b64 exec, s[64:65]
    s_cbranch_execz K2_G44
    v_lshrrev_b32 v227, 16, v77
    ds_read_b32 v227, v227 offset:34816
K2_G44:
    s_mov_b64 exec, s[66:67]
    s_cbranch_execz K2_G45
    v_lshrrev_b32 v228, 16, v79
    ds_read_b32 v228, v228 offset:34816
K2_G45:
    s_mov_b64 exec, -1
K2_NOS1:
    s_waitcnt lgkmcnt(0)
    v_readfirstlane_b32 s98, v233
    v_readfirstlane_b32 s93, v232
    s_cmp_le_u32 s98, 3776
    s_cbranch_scc1 K2_FITS
    s_cmp_eq_u32 s92, 15
    s_cbranch_scc1 K2_END0
    s_mov_b32 s92, 15
    s_waitcnt vmcnt(0)
    s_barrier
    s_branch K2_TOP
K2_FITS:
    s_cmp_eq_u32 s5, 0
    s_cbranch_scc1 K2_PLAN
    s_mov_b64 exec, s[32:33]
    v_lshl_add_u32 v98, v172, 3, v98
    ds_write_b64 v98, v[44:45]
    s_mov_b64 exec, s[34:35]
    v_lshl_add_u32 v99, v173, 3, v99
    ds_write_b64 v99, v[46:47]
    s_mov_b64 exec, s[36:37]
    v_lshl_add_u32 v100, v174, 3, v100
    ds_write_b64 v100, v[48:49]
    s_mov_b64 exec, s[38:39]
    v_lshl_add_u32 v101, v175, 3, v101
    ds_write_b64 v101, v[50:51]
    s_mov_b64 exec, s[40:41]
    v_lshl_add_u32 v102, v176, 3, v102
    ds_write_b64 v102, v[52:53]
    s_mov_b64 exec, s[42:43]
    v_lshl_add_u32 v103, v177, 3, v103
    ds_write_b64 v103, v[54:55]
    s_mov_b64 exec, s[44:45]
    v_lshl_add_u32 v104, v178, 3, v104
    ds_write_b64 v104, v[56:57]
    s_mov_b64 exec, s[46:47]
    v_lshl_add_u32 v105, v179, 3, v105
    ds_write_b64 v105, v[58:59]
    s_mov_b64 exec, s[48:49]
    v_lshl_add_u32 v106, v180, 3, v106
    ds_write_b64 v106, v[60:61]
    s_mov_b64 exec, s[50:51]
    s_cbranch_execz K2_G46
    v_lshl_add_u32 v220, v181, 3, v220
    ds_write_b64 v220, v[62:63]
K2_G46:
    s_mov_b64 exec, s[52:53]
    s_cbranch_execz K2_G47
    v_lshl_add_u32 v221, v182, 3, v221
    ds_write_b64 v221, v[64:65]
K2_G47:
    s_mov_b64 exec, s[54:55]
    s_cbranch_execz K2_G48
    v_lshl_add_u32 v222, v183, 3, v222
    ds_write_b64 v222, v[66:67]
K2_G48:
    s_mov_b64 exec, s[56:57]
    s_cbranch_execz K2_G49
    v_lshl_add_u32 v223, v184, 3, v223
    ds_write_b64 v223, v[68:69]
K2_G49:
    s_mov_b64 exec, s[58:59]
    s_cbranch_execz K2_G50
    v_lshl_add_u32 v224, v185, 3, v224
    ds_write_b64 v224, v[70:71]
K2_G50:
    s_mov_b64 exec, s[60:61]
    s_cbranch_execz K2_G51
    v_lshl_add_u32 v225, v186, 3, v225
    ds_write_b64 v225, v[72:73]
K2_G51:
    s_mov_b64 exec, s[62:63]
    s_cbranch_execz K2_G52
    v_lshl_add_u32 v226, v187, 3, v226
    ds_write_b64 v226, v[74:75]
K2_G52:
    s_mov_b64 exec, s[64:65]
    s_cbranch_execz K2_G53
    v_lshl_add_u32 v227, v188, 3, v227
    ds_write_b64 v227, v[76:77]
K2_G53:
    s_mov_b64 exec, s[66:67]
    s_cbranch_execz K2_G54
    v_lshl_add_u32 v228, v189, 3, v228
    ds_write_b64 v228, v[78:79]
K2_G54:
    s_cmp_eq_u32 s97, 0
    s_cbranch_scc1 K2_B3
    s_mov_b64 exec, s[68:69]
    s_cbranch_execz K2_G55
    v_lshrrev_b32 v98, 16, v81
    ds_read_b32 v98, v98 offset:34816
K2_G55:
    s_mov_b64 exec, s[70:71]
    s_cbranch_execz K2_G56
    v_lshrrev_b32 v99, 16, v83
    ds_read_b32 v99, v99 offset:34816
K2_G56:
    s_mov_b64 exec, s[72:73]
    s_cbranch_execz K2_G57
    v_lshrrev_b32 v100, 16, v85
    ds_read_b32 v100, v100 offset:34816
K2_G57:
    s_mov_b64 exec, s[74:75]
    s_cbranch_execz K2_G58
    v_lshrrev_b32 v101, 16, v87
    ds_read_b32 v101, v101 offset:34816
K2_G58:
    s_mov_b64 exec, s[76:77]
    s_cbranch_execz K2_G59
    v_lshrrev_b32 v102, 16, v89
    ds_read_b32 v102, v102 offset:34816
K2_G59:
    s_mov_b64 exec, s[78:79]
    s_cbranch_execz K2_G60
    v_lshrrev_b32 v103, 16, v91
    ds_read_b32 v103, v103 offset:34816
K2_G60:
    s_mov_b64 exec, s[80:81]
    s_cbranch_execz K2_G61
    v_lshrrev_b32 v104, 16, v93
    ds_read_b32 v104, v104 offset:34816
K2_G61:
    s_mov_b64 exec, s[82:83]
    s_cbranch_execz K2_G62
    v_lshrrev_b32 v105, 16, v95
    ds_read_b32 v105, v105 offset:34816
K2_G62:
    s_mov_b64 exec, s[84:85]
    s_cbranch_execz K2_G63
    v_lshrrev_b32 v106, 16, v97
    ds_read_b32 v106, v106 offset:34816
K2_G63:
    s_waitcnt lgkmcnt(0)
    s_mov_b64 exec, s[68:69]
    s_cbranch_execz K2_G64
    v_lshl_add_u32 v98, v190, 3, v98
    ds_write_b64 v98, v[80:81]
K2_G64:
    s_mov_b64 exec, s[70:71]
    s_cbranch_execz K2_G65
    v_lshl_add_u32 v99, v191, 3, v99
    ds_write_b64 v99, v[82:83]
K2_G65:
    s_mov_b64 exec, s[72:73]
    s_cbranch_execz K2_G66
    v_lshl_add_u32 v100, v192, 3, v100
    ds_write_b64 v100, v[84:85]
K2_G66:
    s_mov_b64 exec, s[74:75]
    s_cbranch_execz K2_G67
    v_lshl_add_u32 v101, v193, 3, v101
    ds_write_b64 v101, v[86:87]
K2_G67:
    s_mov_b64 exec, s[76:77]
    s_cbranch_execz K2_G68
    v_lshl_add_u32 v102, v194, 3, v102
    ds_write_b64 v102, v[88:89]
K2_G68:
    s_mov_b64 exec, s[78:79]
    s_cbranch_execz K2_G69
    v_lshl_add_u32 v103, v195, 3, v103
    ds_write_b64 v103, v[90:91]
K2_G69:
    s_mov_b64 exec, s[80:81]
    s_cbranch_execz K2_G70
    v_lshl_add_u32 v104, v196, 3, v104
    ds_write_b64 v104, v[92:93]
K2_G70:
    s_mov_b64 exec, s[82:83]
    s_cbranch_execz K2_G71
    v_lshl_add_u32 v105, v197, 3, v105
    ds_write_b64 v105, v[94:95]
K2_G71:
    s_mov_b64 exec, s[84:85]
    s_cbranch_execz K2_G72
    v_lshl_add_u32 v106, v198, 3, v106
    ds_write_b64 v106, v[96:97]
K2_G72:
    s_branch K2_B3
K2_PLAN:
    s_mul_i32 s99, s98, 3
    s_lshr_b32 s99, s99, 9
    s_max_u32 s99, s99, 1
    v_cvt_f32_u32 v84, v76
    v_add_f32 v84, -0.5, v84
    v_max_f32 v104, v104, v84
    v_cvt_f32_u32 v85, v77
    v_add_f32 v85, -0.5, v85
    v_max_f32 v105, v105, v85
    v_cvt_f32_u32 v86, v78
    v_add_f32 v86, -0.5, v86
    v_max_f32 v106, v106, v86
    v_cvt_f32_u32 v87, v79
    v_add_f32 v87, -0.5, v87
    v_max_f32 v107, v107, v87
K2_DLOOP:
    v_cvt_f32_u32 v220, s99
    v_rcp_f32 v221, v220
    v_add_f32 v88, v104, v220
    v_add_f32 v89, v105, v220
    v_add_f32 v90, v106, v220
    v_add_f32 v91, v107, v220
    v_mul_f32 v88, v88, v221
    v_cvt_u32_f32 v88, v88
    v_mul_f32 v89, v89, v221
    v_cvt_u32_f32 v89, v89
    v_mul_f32 v90, v90, v221
    v_cvt_u32_f32 v90, v90
    v_mul_f32 v91, v91, v221
    v_cvt_u32_f32 v91, v91
    v_add_u32 v222, v88, v89
    v_add3_u32 v222, v222, v90, v91
    s_nop 1
    v_add_u32_dpp v222, v222, v222 row_shr:1 row_mask:0xf bank_mask:0xf
    s_nop 1
    v_add_u32_dpp v222, v222, v222 row_shr:2 row_mask:0xf bank_mask:0xf
    s_nop 1
    v_add_u32_dpp v222, v222, v222 row_shr:4 row_mask:0xf bank_mask:0xf
    s_nop 1
    v_add_u32_dpp v222, v222, v222 row_shr:8 row_mask:0xf bank_mask:0xf
    s_nop 1
    v_add_u32_dpp v222, v222, v222 row_bcast:15 row_mask:0xa bank_mask:0xf
    s_nop 1
    v_add_u32_dpp v222, v222, v222 row_bcast:31 row_mask:0xc bank_mask:0xf
    s_nop 0
    v_readlane_b32 s95, v222, 63
    s_add_u32 s99, s99, 1
    s_cmp_gt_u32 s95, 255
    s_cbranch_scc1 K2_DLOOP
    v_cvt_f32_u32 v92, v88
    v_rcp_f32 v96, v92
    v_add_f32 v92, v92, v84
    v_cmp_eq_u32_e64 s[48:49], 1, v88
    v_lshlrev_b32 v44, 16, v88
    v_cvt_f32_u32 v93, v89
    v_rcp_f32 v97, v93
    v_add_f32 v93, v93, v85
    v_cmp_eq_u32_e64 s[50:51], 1, v89
    v_lshlrev_b32 v45, 16, v89
    v_cvt_f32_u32 v94, v90
    v_rcp_f32 v98, v94
    v_add_f32 v94, v94, v86
    v_cmp_eq_u32_e64 s[52:53], 1, v90
    v_lshlrev_b32 v46, 16, v90
    v_cvt_f32_u32 v95, v91
    v_rcp_f32 v99, v95
    v_add_f32 v95, v95, v87
    v_cmp_eq_u32_e64 s[54:55], 1, v91
    v_lshlrev_b32 v47, 16, v91
    v_cndmask_b32_e64 v44, v44, 1, s[48:49]
    v_cndmask_b32_e64 v45, v45, 1, s[50:51]
    v_cndmask_b32_e64 v46, v46, 1, s[52:53]
    v_cndmask_b32_e64 v47, v47, 1, s[54:55]
    v_mul_f32 v92, v92, v96
    v_cvt_u32_f32 v92, v92
    v_sub_u32 v96, 63, v92
    v_lshlrev_b32 v96, 2, v96
    ds_add_rtn_u32 v100, v96, v44 offset:128
    v_mul_f32 v93, v93, v97
    v_cvt_u32_f32 v93, v93
    v_sub_u32 v97, 63, v93
    v_lshlrev_b32 v97, 2, v97
    ds_add_rtn_u32 v101, v97, v45 offset:128
    v_mul_f32 v94, v94, v98
    v_cvt_u32_f32 v94, v94
    v_sub_u32 v98, 63, v94
    v_lshlrev_b32 v98, 2, v98
    ds_add_rtn_u32 v102, v98, v46 offset:128
    v_mul_f32 v95, v95, v99
    v_cvt_u32_f32 v95, v95
    v_sub_u32 v99, 63, v95
    v_lshlrev_b32 v99, 2, v99
    ds_add_rtn_u32 v103, v99, v47 offset:128
    v_lshrrev_b32 v220, 2, v203
    ds_read_b32 v221, v220 offset:128
    v_add_u32 v222, 0, v250
    v_lshl_or_b32 v172, v222, 24, v140
    v_lshl_or_b32 v172, v92, 18, v172
    v_lshlrev_b32 v173, 3, v88
    v_sub_u32 v222, 1, v92
    v_mad_i32_i24 v76, v222, v88, v76
    v_add_u32 v222, 64, v250
    v_lshl_or_b32 v174, v222, 24, v148
    v_lshl_or_b32 v174, v93, 18, v174
    v_lshlrev_b32 v175, 3, v89
    v_sub_u32 v222, 1, v93
    v_mad_i32_i24 v77, v222, v89, v77
    v_add_u32 v222, 128, v250
    v_lshl_or_b32 v176, v222, 24, v156
    v_lshl_or_b32 v176, v94, 18, v176
    v_lshlrev_b32 v177, 3, v90
    v_sub_u32 v222, 1, v94
    v_mad_i32_i24 v78, v222, v90, v78
    v_add_u32 v222, 192, v250
    v_lshl_or_b32 v178, v222, 24, v164
    v_lshl_or_b32 v178, v95, 18, v178
    v_lshlrev_b32 v179, 3, v91
    v_sub_u32 v222, 1, v95
    v_mad_i32_i24 v79, v222, v91, v79
    v_max3_u32 v224, v88, v89, v90
    v_max_u32 v224, v224, v91
    v_mov_b32 v225, -262136
    s_mov_b32 s99, 0
    s_waitcnt lgkmcnt(0)
    v_mov_b32 v222, v221
    v_and_b32 v57, 0xffff, v221
    v_cmp_ne_u32 vcc, 0, v57
    v_and_b32 v52, 0xffff, v100
    v_lshrrev_b32 v100, 16, v100
    v_add_u32_dpp v222, v222, v222 row_shr:1 row_mask:0xf bank_mask:0xf
    v_min_u32 v48, 1, v52
    v_cndmask_b32_e64 v100, v100, v52, s[48:49]
    v_add_u32_dpp v222, v222, v222 row_shr:2 row_mask:0xf bank_mask:0xf
    v_mad_i32_i24 v48, v48, -10, 20
    v_cndmask_b32_e64 v48, 0, v48, s[48:49]
    v_add_u32_dpp v222, v222, v222 row_shr:4 row_mask:0xf bank_mask:0xf
    v_and_b32 v53, 0xffff, v101
    v_lshrrev_b32 v101, 16, v101
    v_add_u32_dpp v222, v222, v222 row_shr:8 row_mask:0xf bank_mask:0xf
    v_min_u32 v49, 1, v53
    v_cndmask_b32_e64 v101, v101, v53, s[50:51]
    v_add_u32_dpp v222, v222, v222 row_bcast:15 row_mask:0xa bank_mask:0xf
    v_mad_i32_i24 v49, v49, -10, 20
    v_cndmask_b32_e64 v49, 0, v49, s[50:51]
    v_add_u32_dpp v222, v222, v222 row_bcast:31 row_mask:0xc bank_mask:0xf
    v_lshrrev_b32 v58, 16, v222
    v_cndmask_b32 v56, 0, v58, vcc
    v_sub_u32 v222, v222, v221
    v_and_b32 v54, 0xffff, v102
    v_lshrrev_b32 v102, 16, v102
    v_max_u32_dpp v56, v56, v56 row_shr:1 row_mask:0xf bank_mask:0xf
    v_min_u32 v50, 1, v54
    v_cndmask_b32_e64 v102, v102, v54, s[52:53]
    v_max_u32_dpp v56, v56, v56 row_shr:2 row_mask:0xf bank_mask:0xf
    v_mad_i32_i24 v50, v50, -10, 20
    v_cndmask_b32_e64 v50, 0, v50, s[52:53]
    v_max_u32_dpp v56, v56, v56 row_shr:4 row_mask:0xf bank_mask:0xf
    v_and_b32 v55, 0xffff, v103
    v_lshrrev_b32 v103, 16, v103
    v_max_u32_dpp v56, v56, v56 row_shr:8 row_mask:0xf bank_mask:0xf
    v_min_u32 v51, 1, v55
    v_cndmask_b32_e64 v103, v103, v55, s[54:55]
    v_max_u32_dpp v56, v56, v56 row_bcast:15 row_mask:0xa bank_mask:0xf
    v_mad_i32_i24 v51, v51, -10, 20
    v_cndmask_b32_e64 v51, 0, v51, s[54:55]
    v_max_u32_dpp v56, v56, v56 row_bcast:31 row_mask:0xc bank_mask:0xf
    v_and_b32 v57, 0xffff, v222
    v_and_b32 v221, 1, v222
    v_mov_b32_dpp v56, v56 wave_shr:1 row_mask:0xf bank_mask:0xf
    v_cmp_eq_u32 vcc, 1, v221
    v_lshrrev_b32 v222, 16, v222
    v_add3_u32 v222, v222, v57, v221
    v_cndmask_b32 v56, v58, v56, vcc
    v_add_u32 v58, v58, v57
    v_add_u32 v56, v56, v57
    v_lshl_or_b32 v222, v58, 10, v222
    v_lshl_or_b32 v222, v56, 20, v222
    ds_bpermute_b32 v96, v96, v222
    ds_bpermute_b32 v97, v97, v222
    ds_bpermute_b32 v98, v98, v222
    ds_bpermute_b32 v99, v99, v222
    s_waitcnt lgkmcnt(3)
    v_bfe_u32 v96, v96, v48, 10
    v_add_lshl_u32 v96, v96, v100, 2
    v_lshl_or_b32 v222, v88, 16, v96
    v_lshlrev_b32 v96, 1, v96
    ds_write_b32 v220, v222 offset:32768
    s_waitcnt lgkmcnt(3)
    v_bfe_u32 v97, v97, v49, 10
    v_add_lshl_u32 v97, v97, v101, 2
    v_lshl_or_b32 v222, v89, 16, v97
    v_lshlrev_b32 v97, 1, v97
    ds_write_b32 v220, v222 offset:33024
    s_waitcnt lgkmcnt(3)
    v_bfe_u32 v98, v98, v50, 10
    v_add_lshl_u32 v98, v98, v102, 2
    v_lshl_or_b32 v222, v90, 16, v98
    v_lshlrev_b32 v98, 1, v98
    ds_write_b32 v220, v222 offset:33280
    s_waitcnt lgkmcnt(3)
    v_bfe_u32 v99, v99, v51, 10
    v_add_lshl_u32 v99, v99, v103, 2
    v_lshl_or_b32 v222, v91, 16, v99
    v_lshlrev_b32 v99, 1, v99
    ds_write_b32 v220, v222 offset:33536
K2_PLOOP:
    v_cmp_lt_u32_e64 s[32:33], s99, v88
    v_cmp_lt_u32_e64 s[34:35], s99, v89
    v_cmp_lt_u32_e64 s[36:37], s99, v90
    v_cmp_lt_u32_e64 s[38:39], s99, v91
    s_add_u32 s99, s99, 1
    v_cmp_eq_u32_e64 s[40:41], s99, v76
    v_cmp_eq_u32_e64 s[42:43], s99, v77
    v_cmp_eq_u32_e64 s[44:45], s99, v78
    v_cmp_eq_u32_e64 s[46:47], s99, v79
    s_mov_b64 exec, s[32:33]
    ds_write_b64 v96, v[172:173] offset:512
    s_mov_b64 exec, s[34:35]
    ds_write_b64 v97, v[174:175] offset:512
    s_mov_b64 exec, s[36:37]
    ds_write_b64 v98, v[176:177] offset:512
    s_mov_b64 exec, s[38:39]
    ds_write_b64 v99, v[178:179] offset:512
    s_mov_b64 exec, -1
    v_cmp_lt_u32 vcc, s99, v224
    v_cndmask_b32_e64 v222, 8, v225, s[40:41]
    v_add_u32 v172, v172, v222
    v_add_u32 v96, 8, v96
    v_cndmask_b32_e64 v222, 8, v225, s[42:43]
    v_add_u32 v174, v174, v222
    v_add_u32 v97, 8, v97
    v_cndmask_b32_e64 v222, 8, v225, s[44:45]
    v_add_u32 v176, v176, v222
    v_add_u32 v98, 8, v98
    v_cndmask_b32_e64 v222, 8, v225, s[46:47]
    v_add_u32 v178, v178, v222
    v_add_u32 v99, 8, v99
    s_cbranch_vccnz K2_PLOOP
    v_mov_b32 v222, s99
    ds_write_b32 v228, v222 offset:104
    s_waitcnt vmcnt(0)
K2_B3:
    s_mov_b64 exec, -1
    s_lshl_b32 s95, s100, 8
    v_and_b32 v220, 31, v250
    v_lshl_add_u32 v220, v220, 3, s95
    s_mov_b32 s6, 0
    s_waitcnt vmcnt(3) lgkmcnt(0)
    s_barrier
    ds_read_b64 v[220:221], v220 offset:512
    ds_read_b32 v222, v229 offset:104
    s_waitcnt lgkmcnt(0)
    v_bfe_u32 v235, v220, 18, 6
    v_and_b32 v207, 0x3ffff, v220
    v_lshrrev_b32 v249, 24, v220
    v_mov_b32 v206, v221
    v_readfirstlane_b32 s97, v222
    v_cmp_lt_u32_e64 s[28:29], s6, v235
    s_add_u32 s6, s6, 1
    v_add_u32 v221, s4, v249
    buffer_load_dwordx2 v[240:241], v221, s[16:19], 0 idxen
    v_cndmask_b32_e64 v203, 0, v207, s[28:29]
    v_add_u32 v207, v207, v206
    ds_read_b32 v218, v203
    ds_read_u16 v203, v203 offset:4
    v_bfe_u32 v220, v249, 1, 3
    v_lshlrev_b32 v220, 4, v220
    v_lshlrev_b32 v221, 2, v219
    v_xor_b32 v220, v220, v221
    v_lshl_add_u32 v220, v249, 7, v220
    v_add_u32 v220, 100352, v220
    v_xor_b32 v221, 16, v220
    v_xor_b32 v222, 32, v220
    v_xor_b32 v223, 48, v220
    s_waitcnt lgkmcnt(0)
    ds_bpermute_b32 v210, v239, v203 offset:0
    ds_bpermute_b32 v212, v239, v203 offset:32
    ds_bpermute_b32 v214, v239, v203 offset:64
    ds_bpermute_b32 v216, v239, v203 offset:96
    ds_read_b128 v[172:175], v220
    ds_read_b128 v[176:179], v221
    ds_read_b128 v[180:183], v222
    ds_read_b128 v[184:187], v223
    buffer_load_dwordx4 v[188:191], v[218:219], s[12:15], 0 idxen offen
    buffer_load_dwordx2 v[200:201], v203, s[16:19], 0 idxen
    v_cmp_lt_u32_e64 s[30:31], s6, v235
    s_add_u32 s6, s6, 1
    s_cmp_eq_u64 s[28:29], 0
    s_cbranch_scc1 K2_EMPTY
    s_waitcnt lgkmcnt(4)
    s_add_u32 m0, s94, 0
    s_nop 0
    buffer_load_dwordx4 v[210:211], s[8:11], 0 idxen offen lds
    s_add_u32 m0, s94, 1024
    s_nop 0
    buffer_load_dwordx4 v[212:213], s[8:11], 0 idxen offen lds
    s_add_u32 m0, s94, 2048
    s_nop 0
    buffer_load_dwordx4 v[214:215], s[8:11], 0 idxen offen lds
    s_add_u32 m0, s94, 3072
    s_nop 0
    buffer_load_dwordx4 v[216:217], s[8:11], 0 idxen offen lds
    v_cndmask_b32_e64 v203, 0, v207, s[30:31]
    v_add_u32 v207, v207, v206
    ds_read_b32 v218, v203
    ds_read_u16 v203, v203 offset:4
    s_waitcnt lgkmcnt(0)
    ds_bpermute_b32 v210, v239, v203 offset:0
    ds_bpermute_b32 v212, v239, v203 offset:32
    ds_bpermute_b32 v214, v239, v203 offset:64
    ds_bpermute_b32 v216, v239, v203 offset:96
    buffer_load_dwordx4 v[192:195], v[218:219], s[12:15], 0 idxen offen
    buffer_load_dwordx2 v[204:205], v203, s[16:19], 0 idxen
    v_cmp_lt_u32_e64 s[32:33], s6, v235
    s_add_u32 s6, s6, 1
    s_waitcnt lgkmcnt(0)
    s_add_u32 m0, s94, 32768
    s_nop 0
    buffer_load_dwordx4 v[210:211], s[8:11], 0 idxen offen lds
    s_add_u32 m0, s94, 33792
    s_nop 0
    buffer_load_dwordx4 v[212:213], s[8:11], 0 idxen offen lds
    s_add_u32 m0, s94, 34816
    s_nop 0
    buffer_load_dwordx4 v[214:215], s[8:11], 0 idxen offen lds
    s_add_u32 m0, s94, 35840
    s_nop 0
    buffer_load_dwordx4 v[216:217], s[8:11], 0 idxen offen lds
    v_cndmask_b32_e64 v203, 0, v207, s[32:33]
    v_add_u32 v207, v207, v206
    ds_read_b32 v218, v203
    ds_read_u16 v203, v203 offset:4
    s_waitcnt lgkmcnt(0)
    ds_bpermute_b32 v210, v239, v203 offset:0
    ds_bpermute_b32 v212, v239, v203 offset:32
    ds_bpermute_b32 v214, v239, v203 offset:64
    ds_bpermute_b32 v216, v239, v203 offset:96
    v_and_b32 v221, 63, v250
    v_lshlrev_b32 v220, 4, v221
    v_lshlrev_b32 v221, 2, v221
    v_add_u32 v220, 138240, v220
    v_lshlrev_b32 v222, 3, v219
    v_add_u32 v221, 156672, v221
    v_add_u32 v222, 157696, v222
    ds_read_b128 v[140:143], v220 offset:0
    ds_read_b128 v[144:147], v220 offset:1024
    ds_read_b128 v[148:151], v220 offset:2048
    ds_read_b128 v[152:155], v220 offset:3072
    ds_read_b128 v[156:159], v220 offset:4096
    ds_read_b128 v[160:163], v220 offset:5120
    ds_read_b128 v[164:167], v220 offset:6144
    ds_read_b128 v[168:171], v220 offset:7168
    ds_read_b128 v[0:3], v220 offset:8192
    ds_read_b128 v[4:7], v220 offset:9216
    ds_read_b128 v[8:11], v220 offset:10240
    ds_read_b128 v[12:15], v220 offset:11264
    ds_read_b128 v[16:19], v220 offset:12288
    ds_read_b128 v[20:23], v220 offset:13312
    ds_read_b128 v[24:27], v220 offset:14336
    ds_read_b128 v[28:31], v220 offset:15360
    ds_read_b128 v[32:35], v220 offset:16384
    ds_read_b128 v[36:39], v220 offset:17408
    ds_read_b32 v40, v221
    ds_read_b32 v42, v221 offset:256
    ds_read_b128 v[108:111], v222 offset:0
    ds_read_b128 v[112:115], v222 offset:16
    ds_read_b128 v[116:119], v222 offset:32
    ds_read_b128 v[120:123], v222 offset:48
    ds_read_b128 v[124:127], v222 offset:64
    ds_read_b128 v[128:131], v222 offset:80
    ds_read_b128 v[132:135], v222 offset:96
    ds_read_b128 v[136:139], v222 offset:112
    v_mov_b32 v76, 0
    v_mov_b32 v77, 0
    v_mov_b32 v78, 0
    v_mov_b32 v79, 0
    v_mov_b32 v80, 0
    v_mov_b32 v81, 0
    v_mov_b32 v82, 0
    v_mov_b32 v83, 0
    v_mov_b32 v84, 0
    v_mov_b32 v85, 0
    v_mov_b32 v86, 0
    v_mov_b32 v87, 0
    v_mov_b32 v88, 0
    v_mov_b32 v89, 0
    v_mov_b32 v90, 0
    v_mov_b32 v91, 0
    v_mov_b32 v92, 0
    v_mov_b32 v93, 0
    v_mov_b32 v94, 0
    v_mov_b32 v95, 0
    v_mov_b32 v96, 0
    v_mov_b32 v97, 0
    v_mov_b32 v98, 0
    v_mov_b32 v99, 0
    v_mov_b32 v100, 0
    v_mov_b32 v101, 0
    v_mov_b32 v102, 0
    v_mov_b32 v103, 0
    v_mov_b32 v104, 0
    v_mov_b32 v105, 0
    v_mov_b32 v106, 0
    v_mov_b32 v107, 0
    v_mov_b32 v244, 0
    v_mov_b32 v245, 0
    v_mov_b32 v246, 0
    v_mov_b32 v247, 0
    s_waitcnt lgkmcnt(0)
    v_mfma_f32_32x32x16_bf16 v[44:59], v[140:143], v[172:175], 0
    v_mfma_f32_32x32x16_bf16 v[60:75], v[156:159], v[172:175], 0
    v_mfma_f32_32x32x16_bf16 v[44:59], v[144:147], v[176:179], v[44:59]
    v_mfma_f32_32x32x16_bf16 v[60:75], v[160:163], v[176:179], v[60:75]
    v_mfma_f32_32x32x16_bf16 v[44:59], v[148:151], v[180:183], v[44:59]
    v_mfma_f32_32x32x16_bf16 v[60:75], v[164:167], v[180:183], v[60:75]
    v_mfma_f32_32x32x16_bf16 v[44:59], v[152:155], v[184:187], v[44:59]
    v_mfma_f32_32x32x16_bf16 v[60:75], v[168:171], v[184:187], v[60:75]
    s_waitcnt vmcnt(6)
    ds_read_b128 v[172:175], v251 offset:0
    ds_read_b128 v[176:179], v252 offset:0
    ds_read_b128 v[180:183], v253 offset:0
    ds_read_b128 v[184:187], v254 offset:0
    v_mov_b32 v242, v241
    v_and_b32 v241, 0xffff0000, v240
    v_lshlrev_b32 v240, 16, v240
    v_lshlrev_b32 v232, 16, v200
    v_and_b32 v233, 0xffff0000, v200
    v_sub_f32 v234, v242, v201
    v_pk_add_f32 v[232:233], v[240:241], v[232:233] neg_lo:[0,1] neg_hi:[0,1]
    v_mul_f32 v208, v232, v232
    v_fmac_f32 v208, v233, v233
    v_fmac_f32 v208, v234, v234
    v_cvt_pk_bf16_f32 v208, v208, v208
    s_waitcnt lgkmcnt(0)
    s_nop 0
    v_mfma_f32_32x32x8_bf16 v[140:155], v[40:41], v[208:209], v[44:59]
    v_mfma_f32_32x32x16_bf16 v[140:155], v[32:35], v[188:191], v[140:155]
    v_mfma_f32_32x32x16_bf16 v[140:155], v[0:3], v[172:175], v[140:155]
    v_mfma_f32_32x32x16_bf16 v[140:155], v[4:7], v[176:179], v[140:155]
    v_mfma_f32_32x32x16_bf16 v[140:155], v[8:11], v[180:183], v[140:155]
    v_mfma_f32_32x32x16_bf16 v[140:155], v[12:15], v[184:187], v[140:155]
    s_nop 7
K2_LOOP:
    v_mfma_f32_32x32x8_bf16 v[156:171], v[42:43], v[208:209], v[60:75]
    s_mov_b64 exec, s[28:29]
    s_nop 1
    v_exp_f32 v220, v140
    v_exp_f32 v221, v141
    v_exp_f32 v222, v142
    v_exp_f32 v223, v143
    v_mfma_f32_32x32x16_bf16 v[156:171], v[36:39], v[188:191], v[156:171]
    v_exp_f32 v224, v144
    v_exp_f32 v225, v145
    s_bitcmp1_b32 s5, 2
    s_cbranch_scc0 K2_VP1
    s_setprio 1
K2_VP1:
    s_waitcnt lgkmcnt(0)
    s_mov_b64 exec, -1
    s_add_u32 m0, s94, 0
    s_nop 0
    buffer_load_dwordx4 v[210:211], s[8:11], 0 idxen offen lds
    s_add_u32 m0, s94, 1024
    s_nop 0
    buffer_load_dwordx4 v[212:213], s[8:11], 0 idxen offen lds
    s_add_u32 m0, s94, 2048
    s_nop 0
    buffer_load_dwordx4 v[214:215], s[8:11], 0 idxen offen lds
    s_add_u32 m0, s94, 3072
    s_nop 0
    buffer_load_dwordx4 v[216:217], s[8:11], 0 idxen offen lds
    s_mov_b64 exec, s[28:29]
    s_setprio 0
    v_exp_f32 v226, v146
    v_exp_f32 v227, v147
    v_pk_add_f32 v[220:221], v[220:221], 1.0 op_sel_hi:[1,0]
    v_pk_add_f32 v[222:223], v[222:223], 1.0 op_sel_hi:[1,0]
    v_pk_add_f32 v[224:225], v[224:225], 1.0 op_sel_hi:[1,0]
    v_pk_add_f32 v[226:227], v[226:227], 1.0 op_sel_hi:[1,0]
    v_mfma_f32_32x32x16_bf16 v[156:171], v[16:19], v[172:175], v[156:171]
    v_rcp_f32 v220, v220
    v_rcp_f32 v221, v221
    v_rcp_f32 v222, v222
    v_rcp_f32 v223, v223
    v_mfma_f32_32x32x16_bf16 v[156:171], v[20:23], v[176:179], v[156:171]
    v_rcp_f32 v224, v224
    v_rcp_f32 v225, v225
    v_rcp_f32 v226, v226
    v_rcp_f32 v227, v227
    v_pk_fma_f32 v[76:77], v[140:141], v[220:221], v[76:77]
    v_pk_fma_f32 v[78:79], v[142:143], v[222:223], v[78:79]
    v_pk_fma_f32 v[80:81], v[144:145], v[224:225], v[80:81]
    v_pk_fma_f32 v[82:83], v[146:147], v[226:227], v[82:83]
    v_pk_mul_f32 v[228:229], v[76:77], v[108:109]
    v_pk_mul_f32 v[230:231], v[78:79], v[110:111]
    v_pk_fma_f32 v[228:229], v[80:81], v[112:113], v[228:229]
    v_pk_fma_f32 v[230:231], v[82:83], v[114:115], v[230:231]
    v_mfma_f32_32x32x16_bf16 v[156:171], v[24:27], v[180:183], v[156:171]
    v_exp_f32 v220, v148
    v_exp_f32 v221, v149
    v_exp_f32 v222, v150
    v_exp_f32 v223, v151
    v_mfma_f32_32x32x16_bf16 v[156:171], v[28:31], v[184:187], v[156:171]
    v_exp_f32 v224, v152
    v_exp_f32 v225, v153
    v_exp_f32 v226, v154
    buffer_load_dwordx4 v[196:199], v[218:219], s[12:15], 0 idxen offen
    buffer_load_dwordx2 v[200:201], v203, s[16:19], 0 idxen
    v_exp_f32 v227, v155
    s_waitcnt vmcnt(6)
    ds_read_b128 v[172:175], v251 offset:32768
    ds_read_b128 v[176:179], v252 offset:32768
    ds_read_b128 v[180:183], v253 offset:32768
    ds_read_b128 v[184:187], v254 offset:32768
    v_cmp_lt_u32_e64 s[34:35], s6, v235
    s_add_u32 s6, s6, 1
    v_lshlrev_b32 v236, 16, v204
    v_and_b32 v237, 0xffff0000, v204
    v_sub_f32 v238, v242, v205
    v_pk_add_f32 v[236:237], v[240:241], v[236:237] neg_lo:[0,1] neg_hi:[0,1]
    v_mul_f32 v208, v236, v236
    v_fmac_f32 v208, v237, v237
    v_fmac_f32 v208, v238, v238
    v_cvt_pk_bf16_f32 v208, v208, v208
    v_cndmask_b32_e64 v203, 0, v207, s[34:35]
    v_add_u32 v207, v207, v206
    ds_read_b32 v218, v203
    ds_read_u16 v203, v203 offset:4
    v_pk_add_f32 v[220:221], v[220:221], 1.0 op_sel_hi:[1,0]
    v_pk_add_f32 v[222:223], v[222:223], 1.0 op_sel_hi:[1,0]
    v_pk_add_f32 v[224:225], v[224:225], 1.0 op_sel_hi:[1,0]
    v_pk_add_f32 v[226:227], v[226:227], 1.0 op_sel_hi:[1,0]
    v_rcp_f32 v220, v220
    v_rcp_f32 v221, v221
    v_rcp_f32 v222, v222
    v_rcp_f32 v223, v223
    v_rcp_f32 v224, v224
    v_rcp_f32 v225, v225
    v_rcp_f32 v226, v226
    v_rcp_f32 v227, v227
    s_waitcnt lgkmcnt(0)
    s_mov_b64 exec, -1
    ds_bpermute_b32 v210, v239, v203 offset:0
    ds_bpermute_b32 v212, v239, v203 offset:32
    ds_bpermute_b32 v214, v239, v203 offset:64
    ds_bpermute_b32 v216, v239, v203 offset:96
    s_mov_b64 exec, s[28:29]
    v_pk_fma_f32 v[84:85], v[148:149], v[220:221], v[84:85]
    v_pk_fma_f32 v[86:87], v[150:151], v[222:223], v[86:87]
    v_pk_fma_f32 v[88:89], v[152:153], v[224:225], v[88:89]
    v_pk_fma_f32 v[90:91], v[154:155], v[226:227], v[90:91]
    v_pk_fma_f32 v[228:229], v[84:85], v[116:117], v[228:229]
    v_pk_fma_f32 v[230:231], v[86:87], v[118:119], v[230:231]
    v_pk_fma_f32 v[228:229], v[88:89], v[120:121], v[228:229]
    v_pk_fma_f32 v[230:231], v[90:91], v[122:123], v[230:231]
    v_mfma_f32_32x32x8_bf16 v[140:155], v[40:41], v[208:209], v[44:59]
    v_exp_f32 v220, v156
    v_exp_f32 v221, v157
    v_exp_f32 v222, v158
    v_exp_f32 v223, v159
    v_mfma_f32_32x32x16_bf16 v[140:155], v[32:35], v[192:195], v[140:155]
    v_exp_f32 v224, v160
    v_exp_f32 v225, v161
    v_exp_f32 v226, v162
    v_exp_f32 v227, v163
    v_pk_add_f32 v[220:221], v[220:221], 1.0 op_sel_hi:[1,0]
    v_pk_add_f32 v[222:223], v[222:223], 1.0 op_sel_hi:[1,0]
    v_pk_add_f32 v[224:225], v[224:225], 1.0 op_sel_hi:[1,0]
    v_pk_add_f32 v[226:227], v[226:227], 1.0 op_sel_hi:[1,0]
    v_mfma_f32_32x32x16_bf16 v[140:155], v[0:3], v[172:175], v[140:155]
    v_rcp_f32 v220, v220
    v_rcp_f32 v221, v221
    v_rcp_f32 v222, v222
    v_rcp_f32 v223, v223
    v_mfma_f32_32x32x16_bf16 v[140:155], v[4:7], v[176:179], v[140:155]
    v_rcp_f32 v224, v224
    v_rcp_f32 v225, v225
    v_rcp_f32 v226, v226
    v_rcp_f32 v227, v227
    v_pk_fma_f32 v[92:93], v[156:157], v[220:221], v[92:93]
    v_pk_fma_f32 v[94:95], v[158:159], v[222:223], v[94:95]
    v_pk_fma_f32 v[96:97], v[160:161], v[224:225], v[96:97]
    v_pk_fma_f32 v[98:99], v[162:163], v[226:227], v[98:99]
    v_pk_fma_f32 v[228:229], v[92:93], v[124:125], v[228:229]
    v_pk_fma_f32 v[230:231], v[94:95], v[126:127], v[230:231]
    v_pk_fma_f32 v[228:229], v[96:97], v[128:129], v[228:229]
    v_pk_fma_f32 v[230:231], v[98:99], v[130:131], v[230:231]
    v_mfma_f32_32x32x16_bf16 v[140:155], v[8:11], v[180:183], v[140:155]
    v_exp_f32 v220, v164
    v_exp_f32 v221, v165
    v_exp_f32 v222, v166
    v_exp_f32 v223, v167
    v_mfma_f32_32x32x16_bf16 v[140:155], v[12:15], v[184:187], v[140:155]
    v_exp_f32 v224, v168
    v_exp_f32 v225, v169
    v_exp_f32 v226, v170
    v_exp_f32 v227, v171
    v_pk_add_f32 v[220:221], v[220:221], 1.0 op_sel_hi:[1,0]
    v_pk_add_f32 v[222:223], v[222:223], 1.0 op_sel_hi:[1,0]
    v_pk_add_f32 v[224:225], v[224:225], 1.0 op_sel_hi:[1,0]
    v_pk_add_f32 v[226:227], v[226:227], 1.0 op_sel_hi:[1,0]
    v_rcp_f32 v220, v220
    v_rcp_f32 v221, v221
    v_rcp_f32 v222, v222
    v_rcp_f32 v223, v223
    v_rcp_f32 v224, v224
    v_rcp_f32 v225, v225
    v_rcp_f32 v226, v226
    v_rcp_f32 v227, v227
    v_pk_fma_f32 v[100:101], v[164:165], v[220:221], v[100:101]
    v_pk_fma_f32 v[102:103], v[166:167], v[222:223], v[102:103]
    v_pk_fma_f32 v[104:105], v[168:169], v[224:225], v[104:105]
    v_pk_fma_f32 v[106:107], v[170:171], v[226:227], v[106:107]
    v_pk_fma_f32 v[228:229], v[100:101], v[132:133], v[228:229]
    v_pk_fma_f32 v[230:231], v[102:103], v[134:135], v[230:231]
    v_pk_fma_f32 v[228:229], v[104:105], v[136:137], v[228:229]
    v_pk_fma_f32 v[230:231], v[106:107], v[138:139], v[230:231]
    v_pk_add_f32 v[228:229], v[228:229], v[230:231]
    s_cmp_eq_u64 s[30:31], 0
    v_add_f32 v243, v228, v229
    v_sub_f32 v248, v243, v247
    v_pk_fma_f32 v[244:245], v[232:233], v[248:249], v[244:245] op_sel_hi:[1,0,1]
    v_fmac_f32 v246, v234, v248
    s_mov_b64 exec, -1
    s_cbranch_scc1 K2_DONE
    v_mfma_f32_32x32x8_bf16 v[156:171], v[42:43], v[208:209], v[60:75]
    s_mov_b64 exec, s[30:31]
    v_exp_f32 v220, v140
    v_exp_f32 v221, v141
    v_exp_f32 v222, v142
    v_exp_f32 v223, v143
    v_mfma_f32_32x32x16_bf16 v[156:171], v[36:39], v[192:195], v[156:171]
    v_exp_f32 v224, v144
    v_exp_f32 v225, v145
    s_bitcmp1_b32 s5, 2
    s_cbranch_scc0 K2_VP3
    s_setprio 1
K2_VP3:
    s_waitcnt lgkmcnt(0)
    s_mov_b64 exec, -1
    s_add_u32 m0, s94, 32768
    s_nop 0
    buffer_load_dwordx4 v[210:211], s[8:11], 0 idxen offen lds
    s_add_u32 m0, s94, 33792
    s_nop 0
    buffer_load_dwordx4 v[212:213], s[8:11], 0 idxen offen lds
    s_add_u32 m0, s94, 34816
    s_nop 0
    buffer_load_dwordx4 v[214:215], s[8:11], 0 idxen offen lds
    s_add_u32 m0, s94, 35840
    s_nop 0
    buffer_load_dwordx4 v[216:217], s[8:11], 0 idxen offen lds
    s_mov_b64 exec, s[30:31]
    s_setprio 0
    v_exp_f32 v226, v146
    v_exp_f32 v227, v147
    v_pk_add_f32 v[220:221], v[220:221], 1.0 op_sel_hi:[1,0]
    v_pk_add_f32 v[222:223], v[222:223], 1.0 op_sel_hi:[1,0]
    v_pk_add_f32 v[224:225], v[224:225], 1.0 op_sel_hi:[1,0]
    v_pk_add_f32 v[226:227], v[226:227], 1.0 op_sel_hi:[1,0]
    v_mfma_f32_32x32x16_bf16 v[156:171], v[16:19], v[172:175], v[156:171]
    v_rcp_f32 v220, v220
    v_rcp_f32 v221, v221
    v_rcp_f32 v222, v222
    v_rcp_f32 v223, v223
    v_mfma_f32_32x32x16_bf16 v[156:171], v[20:23], v[176:179], v[156:171]
    v_rcp_f32 v224, v224
    v_rcp_f32 v225, v225
    v_rcp_f32 v226, v226
    v_rcp_f32 v227, v227
    v_pk_fma_f32 v[76:77], v[140:141], v[220:221], v[76:77]
    v_pk_fma_f32 v[78:79], v[142:143], v[222:223], v[78:79]
    v_pk_fma_f32 v[80:81], v[144:145], v[224:225], v[80:81]
    v_pk_fma_f32 v[82:83], v[146:147], v[226:227], v[82:83]
    v_pk_mul_f32 v[228:229], v[76:77], v[108:109]
    v_pk_mul_f32 v[230:231], v[78:79], v[110:111]
    v_pk_fma_f32 v[228:229], v[80:81], v[112:113], v[228:229]
    v_pk_fma_f32 v[230:231], v[82:83], v[114:115], v[230:231]
    v_mfma_f32_32x32x16_bf16 v[156:171], v[24:27], v[180:183], v[156:171]
    v_exp_f32 v220, v148
    v_exp_f32 v221, v149
    v_exp_f32 v222, v150
    v_exp_f32 v223, v151
    v_mfma_f32_32x32x16_bf16 v[156:171], v[28:31], v[184:187], v[156:171]
    v_exp_f32 v224, v152
    v_exp_f32 v225, v153
    v_exp_f32 v226, v154
    buffer_load_dwordx4 v[188:191], v[218:219], s[12:15], 0 idxen offen
    buffer_load_dwordx2 v[204:205], v203, s[16:19], 0 idxen
    v_exp_f32 v227, v155
    s_waitcnt vmcnt(6)
    ds_read_b128 v[172:175], v251 offset:0
    ds_read_b128 v[176:179], v252 offset:0
    ds_read_b128 v[180:183], v253 offset:0
    ds_read_b128 v[184:187], v254 offset:0
    v_cmp_lt_u32_e64 s[36:37], s6, v235
    s_add_u32 s6, s6, 1
    v_lshlrev_b32 v232, 16, v200
    v_and_b32 v233, 0xffff0000, v200
    v_sub_f32 v234, v242, v201
    v_pk_add_f32 v[232:233], v[240:241], v[232:233] neg_lo:[0,1] neg_hi:[0,1]
    v_mul_f32 v208, v232, v232
    v_fmac_f32 v208, v233, v233
    v_fmac_f32 v208, v234, v234
    v_cvt_pk_bf16_f32 v208, v208, v208
    v_cndmask_b32_e64 v203, 0, v207, s[36:37]
    v_add_u32 v207, v207, v206
    ds_read_b32 v218, v203
    ds_read_u16 v203, v203 offset:4
    v_pk_add_f32 v[220:221], v[220:221], 1.0 op_sel_hi:[1,0]
    v_pk_add_f32 v[222:223], v[222:223], 1.0 op_sel_hi:[1,0]
    v_pk_add_f32 v[224:225], v[224:225], 1.0 op_sel_hi:[1,0]
    v_pk_add_f32 v[226:227], v[226:227], 1.0 op_sel_hi:[1,0]
    v_rcp_f32 v220, v220
    v_rcp_f32 v221, v221
    v_rcp_f32 v222, v222
    v_rcp_f32 v223, v223
    v_rcp_f32 v224, v224
    v_rcp_f32 v225, v225
    v_rcp_f32 v226, v226
    v_rcp_f32 v227, v227
    s_waitcnt lgkmcnt(0)
    s_mov_b64 exec, -1
    ds_bpermute_b32 v210, v239, v203 offset:0
    ds_bpermute_b32 v212, v239, v203 offset:32
    ds_bpermute_b32 v214, v239, v203 offset:64
    ds_bpermute_b32 v216, v239, v203 offset:96
    s_mov_b64 exec, s[30:31]
    v_pk_fma_f32 v[84:85], v[148:149], v[220:221], v[84:85]
    v_pk_fma_f32 v[86:87], v[150:151], v[222:223], v[86:87]
    v_pk_fma_f32 v[88:89], v[152:153], v[224:225], v[88:89]
    v_pk_fma_f32 v[90:91], v[154:155], v[226:227], v[90:91]
    v_pk_fma_f32 v[228:229], v[84:85], v[116:117], v[228:229]
    v_pk_fma_f32 v[230:231], v[86:87], v[118:119], v[230:231]
    v_pk_fma_f32 v[228:229], v[88:89], v[120:121], v[228:229]
    v_pk_fma_f32 v[230:231], v[90:91], v[122:123], v[230:231]
    v_mfma_f32_32x32x8_bf16 v[140:155], v[40:41], v[208:209], v[44:59]
    v_exp_f32 v220, v156
    v_exp_f32 v221, v157
    v_exp_f32 v222, v158
    v_exp_f32 v223, v159
    v_mfma_f32_32x32x16_bf16 v[140:155], v[32:35], v[196:199], v[140:155]
    v_exp_f32 v224, v160
    v_exp_f32 v225, v161
    v_exp_f32 v226, v162
    v_exp_f32 v227, v163
    v_pk_add_f32 v[220:221], v[220:221], 1.0 op_sel_hi:[1,0]
    v_pk_add_f32 v[222:223], v[222:223], 1.0 op_sel_hi:[1,0]
    v_pk_add_f32 v[224:225], v[224:225], 1.0 op_sel_hi:[1,0]
    v_pk_add_f32 v[226:227], v[226:227], 1.0 op_sel_hi:[1,0]
    v_mfma_f32_32x32x16_bf16 v[140:155], v[0:3], v[172:175], v[140:155]
    v_rcp_f32 v220, v220
    v_rcp_f32 v221, v221
    v_rcp_f32 v222, v222
    v_rcp_f32 v223, v223
    v_mfma_f32_32x32x16_bf16 v[140:155], v[4:7], v[176:179], v[140:155]
    v_rcp_f32 v224, v224
    v_rcp_f32 v225, v225
    v_rcp_f32 v226, v226
    v_rcp_f32 v227, v227
    v_pk_fma_f32 v[92:93], v[156:157], v[220:221], v[92:93]
    v_pk_fma_f32 v[94:95], v[158:159], v[222:223], v[94:95]
    v_pk_fma_f32 v[96:97], v[160:161], v[224:225], v[96:97]
    v_pk_fma_f32 v[98:99], v[162:163], v[226:227], v[98:99]
    v_pk_fma_f32 v[228:229], v[92:93], v[124:125], v[228:229]
    v_pk_fma_f32 v[230:231], v[94:95], v[126:127], v[230:231]
    v_pk_fma_f32 v[228:229], v[96:97], v[128:129], v[228:229]
    v_pk_fma_f32 v[230:231], v[98:99], v[130:131], v[230:231]
    v_mfma_f32_32x32x16_bf16 v[140:155], v[8:11], v[180:183], v[140:155]
    v_exp_f32 v220, v164
    v_exp_f32 v221, v165
    v_exp_f32 v222, v166
    v_exp_f32 v223, v167
    v_mfma_f32_32x32x16_bf16 v[140:155], v[12:15], v[184:187], v[140:155]
    v_exp_f32 v224, v168
    v_exp_f32 v225, v169
    v_exp_f32 v226, v170
    v_exp_f32 v227, v171
    v_pk_add_f32 v[220:221], v[220:221], 1.0 op_sel_hi:[1,0]
    v_pk_add_f32 v[222:223], v[222:223], 1.0 op_sel_hi:[1,0]
    v_pk_add_f32 v[224:225], v[224:225], 1.0 op_sel_hi:[1,0]
    v_pk_add_f32 v[226:227], v[226:227], 1.0 op_sel_hi:[1,0]
    v_rcp_f32 v220, v220
    v_rcp_f32 v221, v221
    v_rcp_f32 v222, v222
    v_rcp_f32 v223, v223
    v_rcp_f32 v224, v224
    v_rcp_f32 v225, v225
    v_rcp_f32 v226, v226
    v_rcp_f32 v227, v227
    v_pk_fma_f32 v[100:101], v[164:165], v[220:221], v[100:101]
    v_pk_fma_f32 v[102:103], v[166:167], v[222:223], v[102:103]
    v_pk_fma_f32 v[104:105], v[168:169], v[224:225], v[104:105]
    v_pk_fma_f32 v[106:107], v[170:171], v[226:227], v[106:107]
    v_pk_fma_f32 v[228:229], v[100:101], v[132:133], v[228:229]
    v_pk_fma_f32 v[230:231], v[102:103], v[134:135], v[230:231]
    v_pk_fma_f32 v[228:229], v[104:105], v[136:137], v[228:229]
    v_pk_fma_f32 v[230:231], v[106:107], v[138:139], v[230:231]
    v_pk_add_f32 v[228:229], v[228:229], v[230:231]
    s_cmp_eq_u64 s[32:33], 0
    v_add_f32 v247, v228, v229
    v_sub_f32 v248, v247, v243
    v_pk_fma_f32 v[244:245], v[236:237], v[248:249], v[244:245] op_sel_hi:[1,0,1]
    v_fmac_f32 v246, v238, v248
    s_mov_b64 exec, -1
    s_cbranch_scc1 K2_DONE
    v_mfma_f32_32x32x8_bf16 v[156:171], v[42:43], v[208:209], v[60:75]
    s_mov_b64 exec, s[32:33]
    v_exp_f32 v220, v140
    v_exp_f32 v221, v141
    v_exp_f32 v222, v142
    v_exp_f32 v223, v143
    v_mfma_f32_32x32x16_bf16 v[156:171], v[36:39], v[196:199], v[156:171]
    v_exp_f32 v224, v144
    v_exp_f32 v225, v145
    s_bitcmp1_b32 s5, 2
    s_cbranch_scc0 K2_VP5
    s_setprio 1
K2_VP5:
    s_waitcnt lgkmcnt(0)
    s_mov_b64 exec, -1
    s_add_u32 m0, s94, 0
    s_nop 0
    buffer_load_dwordx4 v[210:211], s[8:11], 0 idxen offen lds
    s_add_u32 m0, s94, 1024
    s_nop 0
    buffer_load_dwordx4 v[212:213], s[8:11], 0 idxen offen lds
    s_add_u32 m0, s94, 2048
    s_nop 0
    buffer_load_dwordx4 v[214:215], s[8:11], 0 idxen offen lds
    s_add_u32 m0, s94, 3072
    s_nop 0
    buffer_load_dwordx4 v[216:217], s[8:11], 0 idxen offen lds
    s_mov_b64 exec, s[32:33]
    s_setprio 0
    v_exp_f32 v226, v146
    v_exp_f32 v227, v147
    v_pk_add_f32 v[220:221], v[220:221], 1.0 op_sel_hi:[1,0]
    v_pk_add_f32 v[222:223], v[222:223], 1.0 op_sel_hi:[1,0]
    v_pk_add_f32 v[224:225], v[224:225], 1.0 op_sel_hi:[1,0]
    v_pk_add_f32 v[226:227], v[226:227], 1.0 op_sel_hi:[1,0]
    v_mfma_f32_32x32x16_bf16 v[156:171], v[16:19], v[172:175], v[156:171]
    v_rcp_f32 v220, v220
    v_rcp_f32 v221, v221
    v_rcp_f32 v222, v222
    v_rcp_f32 v223, v223
    v_mfma_f32_32x32x16_bf16 v[156:171], v[20:23], v[176:179], v[156:171]
    v_rcp_f32 v224, v224
    v_rcp_f32 v225, v225
    v_rcp_f32 v226, v226
    v_rcp_f32 v227, v227
    v_pk_fma_f32 v[76:77], v[140:141], v[220:221], v[76:77]
    v_pk_fma_f32 v[78:79], v[142:143], v[222:223], v[78:79]
    v_pk_fma_f32 v[80:81], v[144:145], v[224:225], v[80:81]
    v_pk_fma_f32 v[82:83], v[146:147], v[226:227], v[82:83]
    v_pk_mul_f32 v[228:229], v[76:77], v[108:109]
    v_pk_mul_f32 v[230:231], v[78:79], v[110:111]
    v_pk_fma_f32 v[228:229], v[80:81], v[112:113], v[228:229]
    v_pk_fma_f32 v[230:231], v[82:83], v[114:115], v[230:231]
    v_mfma_f32_32x32x16_bf16 v[156:171], v[24:27], v[180:183], v[156:171]
    v_exp_f32 v220, v148
    v_exp_f32 v221, v149
    v_exp_f32 v222, v150
    v_exp_f32 v223, v151
    v_mfma_f32_32x32x16_bf16 v[156:171], v[28:31], v[184:187], v[156:171]
    v_exp_f32 v224, v152
    v_exp_f32 v225, v153
    v_exp_f32 v226, v154
    buffer_load_dwordx4 v[192:195], v[218:219], s[12:15], 0 idxen offen
    buffer_load_dwordx2 v[200:201], v203, s[16:19], 0 idxen
    v_exp_f32 v227, v155
    s_waitcnt vmcnt(6)
    ds_read_b128 v[172:175], v251 offset:32768
    ds_read_b128 v[176:179], v252 offset:32768
    ds_read_b128 v[180:183], v253 offset:32768
    ds_read_b128 v[184:187], v254 offset:32768
    v_cmp_lt_u32_e64 s[38:39], s6, v235
    s_add_u32 s6, s6, 1
    v_lshlrev_b32 v236, 16, v204
    v_and_b32 v237, 0xffff0000, v204
    v_sub_f32 v238, v242, v205
    v_pk_add_f32 v[236:237], v[240:241], v[236:237] neg_lo:[0,1] neg_hi:[0,1]
    v_mul_f32 v208, v236, v236
    v_fmac_f32 v208, v237, v237
    v_fmac_f32 v208, v238, v238
    v_cvt_pk_bf16_f32 v208, v208, v208
    v_cndmask_b32_e64 v203, 0, v207, s[38:39]
    v_add_u32 v207, v207, v206
    ds_read_b32 v218, v203
    ds_read_u16 v203, v203 offset:4
    v_pk_add_f32 v[220:221], v[220:221], 1.0 op_sel_hi:[1,0]
    v_pk_add_f32 v[222:223], v[222:223], 1.0 op_sel_hi:[1,0]
    v_pk_add_f32 v[224:225], v[224:225], 1.0 op_sel_hi:[1,0]
    v_pk_add_f32 v[226:227], v[226:227], 1.0 op_sel_hi:[1,0]
    v_rcp_f32 v220, v220
    v_rcp_f32 v221, v221
    v_rcp_f32 v222, v222
    v_rcp_f32 v223, v223
    v_rcp_f32 v224, v224
    v_rcp_f32 v225, v225
    v_rcp_f32 v226, v226
    v_rcp_f32 v227, v227
    s_waitcnt lgkmcnt(0)
    s_mov_b64 exec, -1
    ds_bpermute_b32 v210, v239, v203 offset:0
    ds_bpermute_b32 v212, v239, v203 offset:32
    ds_bpermute_b32 v214, v239, v203 offset:64
    ds_bpermute_b32 v216, v239, v203 offset:96
    s_mov_b64 exec, s[32:33]
    v_pk_fma_f32 v[84:85], v[148:149], v[220:221], v[84:85]
    v_pk_fma_f32 v[86:87], v[150:151], v[222:223], v[86:87]
    v_pk_fma_f32 v[88:89], v[152:153], v[224:225], v[88:89]
    v_pk_fma_f32 v[90:91], v[154:155], v[226:227], v[90:91]
    v_pk_fma_f32 v[228:229], v[84:85], v[116:117], v[228:229]
    v_pk_fma_f32 v[230:231], v[86:87], v[118:119], v[230:231]
    v_pk_fma_f32 v[228:229], v[88:89], v[120:121], v[228:229]
    v_pk_fma_f32 v[230:231], v[90:91], v[122:123], v[230:231]
    v_mfma_f32_32x32x8_bf16 v[140:155], v[40:41], v[208:209], v[44:59]
    v_exp_f32 v220, v156
    v_exp_f32 v221, v157
    v_exp_f32 v222, v158
    v_exp_f32 v223, v159
    v_mfma_f32_32x32x16_bf16 v[140:155], v[32:35], v[188:191], v[140:155]
    v_exp_f32 v224, v160
    v_exp_f32 v225, v161
    v_exp_f32 v226, v162
    v_exp_f32 v227, v163
    v_pk_add_f32 v[220:221], v[220:221], 1.0 op_sel_hi:[1,0]
    v_pk_add_f32 v[222:223], v[222:223], 1.0 op_sel_hi:[1,0]
    v_pk_add_f32 v[224:225], v[224:225], 1.0 op_sel_hi:[1,0]
    v_pk_add_f32 v[226:227], v[226:227], 1.0 op_sel_hi:[1,0]
    v_mfma_f32_32x32x16_bf16 v[140:155], v[0:3], v[172:175], v[140:155]
    v_rcp_f32 v220, v220
    v_rcp_f32 v221, v221
    v_rcp_f32 v222, v222
    v_rcp_f32 v223, v223
    v_mfma_f32_32x32x16_bf16 v[140:155], v[4:7], v[176:179], v[140:155]
    v_rcp_f32 v224, v224
    v_rcp_f32 v225, v225
    v_rcp_f32 v226, v226
    v_rcp_f32 v227, v227
    v_pk_fma_f32 v[92:93], v[156:157], v[220:221], v[92:93]
    v_pk_fma_f32 v[94:95], v[158:159], v[222:223], v[94:95]
    v_pk_fma_f32 v[96:97], v[160:161], v[224:225], v[96:97]
    v_pk_fma_f32 v[98:99], v[162:163], v[226:227], v[98:99]
    v_pk_fma_f32 v[228:229], v[92:93], v[124:125], v[228:229]
    v_pk_fma_f32 v[230:231], v[94:95], v[126:127], v[230:231]
    v_pk_fma_f32 v[228:229], v[96:97], v[128:129], v[228:229]
    v_pk_fma_f32 v[230:231], v[98:99], v[130:131], v[230:231]
    v_mfma_f32_32x32x16_bf16 v[140:155], v[8:11], v[180:183], v[140:155]
    v_exp_f32 v220, v164
    v_exp_f32 v221, v165
    v_exp_f32 v222, v166
    v_exp_f32 v223, v167
    v_mfma_f32_32x32x16_bf16 v[140:155], v[12:15], v[184:187], v[140:155]
    v_exp_f32 v224, v168
    v_exp_f32 v225, v169
    v_exp_f32 v226, v170
    v_exp_f32 v227, v171
    v_pk_add_f32 v[220:221], v[220:221], 1.0 op_sel_hi:[1,0]
    v_pk_add_f32 v[222:223], v[222:223], 1.0 op_sel_hi:[1,0]
    v_pk_add_f32 v[224:225], v[224:225], 1.0 op_sel_hi:[1,0]
    v_pk_add_f32 v[226:227], v[226:227], 1.0 op_sel_hi:[1,0]
    v_rcp_f32 v220, v220
    v_rcp_f32 v221, v221
    v_rcp_f32 v222, v222
    v_rcp_f32 v223, v223
    v_rcp_f32 v224, v224
    v_rcp_f32 v225, v225
    v_rcp_f32 v226, v226
    v_rcp_f32 v227, v227
    v_pk_fma_f32 v[100:101], v[164:165], v[220:221], v[100:101]
    v_pk_fma_f32 v[102:103], v[166:167], v[222:223], v[102:103]
    v_pk_fma_f32 v[104:105], v[168:169], v[224:225], v[104:105]
    v_pk_fma_f32 v[106:107], v[170:171], v[226:227], v[106:107]
    v_pk_fma_f32 v[228:229], v[100:101], v[132:133], v[228:229]
    v_pk_fma_f32 v[230:231], v[102:103], v[134:135], v[230:231]
    v_pk_fma_f32 v[228:229], v[104:105], v[136:137], v[228:229]
    v_pk_fma_f32 v[230:231], v[106:107], v[138:139], v[230:231]
    v_pk_add_f32 v[228:229], v[228:229], v[230:231]
    s_cmp_eq_u64 s[34:35], 0
    v_add_f32 v243, v228, v229
    v_sub_f32 v248, v243, v247
    v_pk_fma_f32 v[244:245], v[232:233], v[248:249], v[244:245] op_sel_hi:[1,0,1]
    v_fmac_f32 v246, v234, v248
    s_mov_b64 exec, -1
    s_cbranch_scc1 K2_DONE
    v_mfma_f32_32x32x8_bf16 v[156:171], v[42:43], v[208:209], v[60:75]
    s_mov_b64 exec, s[34:35]
    v_exp_f32 v220, v140
    v_exp_f32 v221, v141
    v_exp_f32 v222, v142
    v_exp_f32 v223, v143
    v_mfma_f32_32x32x16_bf16 v[156:171], v[36:39], v[188:191], v[156:171]
    v_exp_f32 v224, v144
    v_exp_f32 v225, v145
    s_bitcmp1_b32 s5, 2
    s_cbranch_scc0 K2_VP7
    s_setprio 1
K2_VP7:
    s_waitcnt lgkmcnt(0)
    s_mov_b64 exec, -1
    s_add_u32 m0, s94, 32768
    s_nop 0
    buffer_load_dwordx4 v[210:211], s[8:11], 0 idxen offen lds
    s_add_u32 m0, s94, 33792
    s_nop 0
    buffer_load_dwordx4 v[212:213], s[8:11], 0 idxen offen lds
    s_add_u32 m0, s94, 34816
    s_nop 0
    buffer_load_dwordx4 v[214:215], s[8:11], 0 idxen offen lds
    s_add_u32 m0, s94, 35840
    s_nop 0
    buffer_load_dwordx4 v[216:217], s[8:11], 0 idxen offen lds
    s_mov_b64 exec, s[34:35]
    s_setprio 0
    v_exp_f32 v226, v146
    v_exp_f32 v227, v147
    v_pk_add_f32 v[220:221], v[220:221], 1.0 op_sel_hi:[1,0]
    v_pk_add_f32 v[222:223], v[222:223], 1.0 op_sel_hi:[1,0]
    v_pk_add_f32 v[224:225], v[224:225], 1.0 op_sel_hi:[1,0]
    v_pk_add_f32 v[226:227], v[226:227], 1.0 op_sel_hi:[1,0]
    v_mfma_f32_32x32x16_bf16 v[156:171], v[16:19], v[172:175], v[156:171]
    v_rcp_f32 v220, v220
    v_rcp_f32 v221, v221
    v_rcp_f32 v222, v222
    v_rcp_f32 v223, v223
    v_mfma_f32_32x32x16_bf16 v[156:171], v[20:23], v[176:179], v[156:171]
    v_rcp_f32 v224, v224
    v_rcp_f32 v225, v225
    v_rcp_f32 v226, v226
    v_rcp_f32 v227, v227
    v_pk_fma_f32 v[76:77], v[140:141], v[220:221], v[76:77]
    v_pk_fma_f32 v[78:79], v[142:143], v[222:223], v[78:79]
    v_pk_fma_f32 v[80:81], v[144:145], v[224:225], v[80:81]
    v_pk_fma_f32 v[82:83], v[146:147], v[226:227], v[82:83]
    v_pk_mul_f32 v[228:229], v[76:77], v[108:109]
    v_pk_mul_f32 v[230:231], v[78:79], v[110:111]
    v_pk_fma_f32 v[228:229], v[80:81], v[112:113], v[228:229]
    v_pk_fma_f32 v[230:231], v[82:83], v[114:115], v[230:231]
    v_mfma_f32_32x32x16_bf16 v[156:171], v[24:27], v[180:183], v[156:171]
    v_exp_f32 v220, v148
    v_exp_f32 v221, v149
    v_exp_f32 v222, v150
    v_exp_f32 v223, v151
    v_mfma_f32_32x32x16_bf16 v[156:171], v[28:31], v[184:187], v[156:171]
    v_exp_f32 v224, v152
    v_exp_f32 v225, v153
    v_exp_f32 v226, v154
    buffer_load_dwordx4 v[196:199], v[218:219], s[12:15], 0 idxen offen
    buffer_load_dwordx2 v[204:205], v203, s[16:19], 0 idxen
    v_exp_f32 v227, v155
    s_waitcnt vmcnt(6)
    ds_read_b128 v[172:175], v251 offset:0
    ds_read_b128 v[176:179], v252 offset:0
    ds_read_b128 v[180:183], v253 offset:0
    ds_read_b128 v[184:187], v254 offset:0
    v_cmp_lt_u32_e64 s[28:29], s6, v235
    s_add_u32 s6, s6, 1
    v_lshlrev_b32 v232, 16, v200
    v_and_b32 v233, 0xffff0000, v200
    v_sub_f32 v234, v242, v201
    v_pk_add_f32 v[232:233], v[240:241], v[232:233] neg_lo:[0,1] neg_hi:[0,1]
    v_mul_f32 v208, v232, v232
    v_fmac_f32 v208, v233, v233
    v_fmac_f32 v208, v234, v234
    v_cvt_pk_bf16_f32 v208, v208, v208
    v_cndmask_b32_e64 v203, 0, v207, s[28:29]
    v_add_u32 v207, v207, v206
    ds_read_b32 v218, v203
    ds_read_u16 v203, v203 offset:4
    v_pk_add_f32 v[220:221], v[220:221], 1.0 op_sel_hi:[1,0]
    v_pk_add_f32 v[222:223], v[222:223], 1.0 op_sel_hi:[1,0]
    v_pk_add_f32 v[224:225], v[224:225], 1.0 op_sel_hi:[1,0]
    v_pk_add_f32 v[226:227], v[226:227], 1.0 op_sel_hi:[1,0]
    v_rcp_f32 v220, v220
    v_rcp_f32 v221, v221
    v_rcp_f32 v222, v222
    v_rcp_f32 v223, v223
    v_rcp_f32 v224, v224
    v_rcp_f32 v225, v225
    v_rcp_f32 v226, v226
    v_rcp_f32 v227, v227
    s_waitcnt lgkmcnt(0)
    s_mov_b64 exec, -1
    ds_bpermute_b32 v210, v239, v203 offset:0
    ds_bpermute_b32 v212, v239, v203 offset:32
    ds_bpermute_b32 v214, v239, v203 offset:64
    ds_bpermute_b32 v216, v239, v203 offset:96
    s_mov_b64 exec, s[34:35]
    v_pk_fma_f32 v[84:85], v[148:149], v[220:221], v[84:85]
    v_pk_fma_f32 v[86:87], v[150:151], v[222:223], v[86:87]
    v_pk_fma_f32 v[88:89], v[152:153], v[224:225], v[88:89]
    v_pk_fma_f32 v[90:91], v[154:155], v[226:227], v[90:91]
    v_pk_fma_f32 v[228:229], v[84:85], v[116:117], v[228:229]
    v_pk_fma_f32 v[230:231], v[86:87], v[118:119], v[230:231]
    v_pk_fma_f32 v[228:229], v[88:89], v[120:121], v[228:229]
    v_pk_fma_f32 v[230:231], v[90:91], v[122:123], v[230:231]
    v_mfma_f32_32x32x8_bf16 v[140:155], v[40:41], v[208:209], v[44:59]
    v_exp_f32 v220, v156
    v_exp_f32 v221, v157
    v_exp_f32 v222, v158
    v_exp_f32 v223, v159
    v_mfma_f32_32x32x16_bf16 v[140:155], v[32:35], v[192:195], v[140:155]
    v_exp_f32 v224, v160
    v_exp_f32 v225, v161
    v_exp_f32 v226, v162
    v_exp_f32 v227, v163
    v_pk_add_f32 v[220:221], v[220:221], 1.0 op_sel_hi:[1,0]
    v_pk_add_f32 v[222:223], v[222:223], 1.0 op_sel_hi:[1,0]
    v_pk_add_f32 v[224:225], v[224:225], 1.0 op_sel_hi:[1,0]
    v_pk_add_f32 v[226:227], v[226:227], 1.0 op_sel_hi:[1,0]
    v_mfma_f32_32x32x16_bf16 v[140:155], v[0:3], v[172:175], v[140:155]
    v_rcp_f32 v220, v220
    v_rcp_f32 v221, v221
    v_rcp_f32 v222, v222
    v_rcp_f32 v223, v223
    v_mfma_f32_32x32x16_bf16 v[140:155], v[4:7], v[176:179], v[140:155]
    v_rcp_f32 v224, v224
    v_rcp_f32 v225, v225
    v_rcp_f32 v226, v226
    v_rcp_f32 v227, v227
    v_pk_fma_f32 v[92:93], v[156:157], v[220:221], v[92:93]
    v_pk_fma_f32 v[94:95], v[158:159], v[222:223], v[94:95]
    v_pk_fma_f32 v[96:97], v[160:161], v[224:225], v[96:97]
    v_pk_fma_f32 v[98:99], v[162:163], v[226:227], v[98:99]
    v_pk_fma_f32 v[228:229], v[92:93], v[124:125], v[228:229]
    v_pk_fma_f32 v[230:231], v[94:95], v[126:127], v[230:231]
    v_pk_fma_f32 v[228:229], v[96:97], v[128:129], v[228:229]
    v_pk_fma_f32 v[230:231], v[98:99], v[130:131], v[230:231]
    v_mfma_f32_32x32x16_bf16 v[140:155], v[8:11], v[180:183], v[140:155]
    v_exp_f32 v220, v164
    v_exp_f32 v221, v165
    v_exp_f32 v222, v166
    v_exp_f32 v223, v167
    v_mfma_f32_32x32x16_bf16 v[140:155], v[12:15], v[184:187], v[140:155]
    v_exp_f32 v224, v168
    v_exp_f32 v225, v169
    v_exp_f32 v226, v170
    v_exp_f32 v227, v171
    v_pk_add_f32 v[220:221], v[220:221], 1.0 op_sel_hi:[1,0]
    v_pk_add_f32 v[222:223], v[222:223], 1.0 op_sel_hi:[1,0]
    v_pk_add_f32 v[224:225], v[224:225], 1.0 op_sel_hi:[1,0]
    v_pk_add_f32 v[226:227], v[226:227], 1.0 op_sel_hi:[1,0]
    v_rcp_f32 v220, v220
    v_rcp_f32 v221, v221
    v_rcp_f32 v222, v222
    v_rcp_f32 v223, v223
    v_rcp_f32 v224, v224
    v_rcp_f32 v225, v225
    v_rcp_f32 v226, v226
    v_rcp_f32 v227, v227
    v_pk_fma_f32 v[100:101], v[164:165], v[220:221], v[100:101]
    v_pk_fma_f32 v[102:103], v[166:167], v[222:223], v[102:103]
    v_pk_fma_f32 v[104:105], v[168:169], v[224:225], v[104:105]
    v_pk_fma_f32 v[106:107], v[170:171], v[226:227], v[106:107]
    v_pk_fma_f32 v[228:229], v[100:101], v[132:133], v[228:229]
    v_pk_fma_f32 v[230:231], v[102:103], v[134:135], v[230:231]
    v_pk_fma_f32 v[228:229], v[104:105], v[136:137], v[228:229]
    v_pk_fma_f32 v[230:231], v[106:107], v[138:139], v[230:231]
    v_pk_add_f32 v[228:229], v[228:229], v[230:231]
    s_cmp_eq_u64 s[36:37], 0
    v_add_f32 v247, v228, v229
    v_sub_f32 v248, v247, v243
    v_pk_fma_f32 v[244:245], v[236:237], v[248:249], v[244:245] op_sel_hi:[1,0,1]
    v_fmac_f32 v246, v238, v248
    s_mov_b64 exec, -1
    s_cbranch_scc1 K2_DONE
    v_mfma_f32_32x32x8_bf16 v[156:171], v[42:43], v[208:209], v[60:75]
    s_mov_b64 exec, s[36:37]
    v_exp_f32 v220, v140
    v_exp_f32 v221, v141
    v_exp_f32 v222, v142
    v_exp_f32 v223, v143
    v_mfma_f32_32x32x16_bf16 v[156:171], v[36:39], v[192:195], v[156:171]
    v_exp_f32 v224, v144
    v_exp_f32 v225, v145
    s_bitcmp1_b32 s5, 2
    s_cbranch_scc0 K2_VP9
    s_setprio 1
K2_VP9:
    s_waitcnt lgkmcnt(0)
    s_mov_b64 exec, -1
    s_add_u32 m0, s94, 0
    s_nop 0
    buffer_load_dwordx4 v[210:211], s[8:11], 0 idxen offen lds
    s_add_u32 m0, s94, 1024
    s_nop 0
    buffer_load_dwordx4 v[212:213], s[8:11], 0 idxen offen lds
    s_add_u32 m0, s94, 2048
    s_nop 0
    buffer_load_dwordx4 v[214:215], s[8:11], 0 idxen offen lds
    s_add_u32 m0, s94, 3072
    s_nop 0
    buffer_load_dwordx4 v[216:217], s[8:11], 0 idxen offen lds
    s_mov_b64 exec, s[36:37]
    s_setprio 0
    v_exp_f32 v226, v146
    v_exp_f32 v227, v147
    v_pk_add_f32 v[220:221], v[220:221], 1.0 op_sel_hi:[1,0]
    v_pk_add_f32 v[222:223], v[222:223], 1.0 op_sel_hi:[1,0]
    v_pk_add_f32 v[224:225], v[224:225], 1.0 op_sel_hi:[1,0]
    v_pk_add_f32 v[226:227], v[226:227], 1.0 op_sel_hi:[1,0]
    v_mfma_f32_32x32x16_bf16 v[156:171], v[16:19], v[172:175], v[156:171]
    v_rcp_f32 v220, v220
    v_rcp_f32 v221, v221
    v_rcp_f32 v222, v222
    v_rcp_f32 v223, v223
    v_mfma_f32_32x32x16_bf16 v[156:171], v[20:23], v[176:179], v[156:171]
    v_rcp_f32 v224, v224
    v_rcp_f32 v225, v225
    v_rcp_f32 v226, v226
    v_rcp_f32 v227, v227
    v_pk_fma_f32 v[76:77], v[140:141], v[220:221], v[76:77]
    v_pk_fma_f32 v[78:79], v[142:143], v[222:223], v[78:79]
    v_pk_fma_f32 v[80:81], v[144:145], v[224:225], v[80:81]
    v_pk_fma_f32 v[82:83], v[146:147], v[226:227], v[82:83]
    v_pk_mul_f32 v[228:229], v[76:77], v[108:109]
    v_pk_mul_f32 v[230:231], v[78:79], v[110:111]
    v_pk_fma_f32 v[228:229], v[80:81], v[112:113], v[228:229]
    v_pk_fma_f32 v[230:231], v[82:83], v[114:115], v[230:231]
    v_mfma_f32_32x32x16_bf16 v[156:171], v[24:27], v[180:183], v[156:171]
    v_exp_f32 v220, v148
    v_exp_f32 v221, v149
    v_exp_f32 v222, v150
    v_exp_f32 v223, v151
    v_mfma_f32_32x32x16_bf16 v[156:171], v[28:31], v[184:187], v[156:171]
    v_exp_f32 v224, v152
    v_exp_f32 v225, v153
    v_exp_f32 v226, v154
    buffer_load_dwordx4 v[188:191], v[218:219], s[12:15], 0 idxen offen
    buffer_load_dwordx2 v[200:201], v203, s[16:19], 0 idxen
    v_exp_f32 v227, v155
    s_waitcnt vmcnt(6)
    ds_read_b128 v[172:175], v251 offset:32768
    ds_read_b128 v[176:179], v252 offset:32768
    ds_read_b128 v[180:183], v253 offset:32768
    ds_read_b128 v[184:187], v254 offset:32768
    v_cmp_lt_u32_e64 s[30:31], s6, v235
    s_add_u32 s6, s6, 1
    v_lshlrev_b32 v236, 16, v204
    v_and_b32 v237, 0xffff0000, v204
    v_sub_f32 v238, v242, v205
    v_pk_add_f32 v[236:237], v[240:241], v[236:237] neg_lo:[0,1] neg_hi:[0,1]
    v_mul_f32 v208, v236, v236
    v_fmac_f32 v208, v237, v237
    v_fmac_f32 v208, v238, v238
    v_cvt_pk_bf16_f32 v208, v208, v208
    v_cndmask_b32_e64 v203, 0, v207, s[30:31]
    v_add_u32 v207, v207, v206
    ds_read_b32 v218, v203
    ds_read_u16 v203, v203 offset:4
    v_pk_add_f32 v[220:221], v[220:221], 1.0 op_sel_hi:[1,0]
    v_pk_add_f32 v[222:223], v[222:223], 1.0 op_sel_hi:[1,0]
    v_pk_add_f32 v[224:225], v[224:225], 1.0 op_sel_hi:[1,0]
    v_pk_add_f32 v[226:227], v[226:227], 1.0 op_sel_hi:[1,0]
    v_rcp_f32 v220, v220
    v_rcp_f32 v221, v221
    v_rcp_f32 v222, v222
    v_rcp_f32 v223, v223
    v_rcp_f32 v224, v224
    v_rcp_f32 v225, v225
    v_rcp_f32 v226, v226
    v_rcp_f32 v227, v227
    s_waitcnt lgkmcnt(0)
    s_mov_b64 exec, -1
    ds_bpermute_b32 v210, v239, v203 offset:0
    ds_bpermute_b32 v212, v239, v203 offset:32
    ds_bpermute_b32 v214, v239, v203 offset:64
    ds_bpermute_b32 v216, v239, v203 offset:96
    s_mov_b64 exec, s[36:37]
    v_pk_fma_f32 v[84:85], v[148:149], v[220:221], v[84:85]
    v_pk_fma_f32 v[86:87], v[150:151], v[222:223], v[86:87]
    v_pk_fma_f32 v[88:89], v[152:153], v[224:225], v[88:89]
    v_pk_fma_f32 v[90:91], v[154:155], v[226:227], v[90:91]
    v_pk_fma_f32 v[228:229], v[84:85], v[116:117], v[228:229]
    v_pk_fma_f32 v[230:231], v[86:87], v[118:119], v[230:231]
    v_pk_fma_f32 v[228:229], v[88:89], v[120:121], v[228:229]
    v_pk_fma_f32 v[230:231], v[90:91], v[122:123], v[230:231]
    v_mfma_f32_32x32x8_bf16 v[140:155], v[40:41], v[208:209], v[44:59]
    v_exp_f32 v220, v156
    v_exp_f32 v221, v157
    v_exp_f32 v222, v158
    v_exp_f32 v223, v159
    v_mfma_f32_32x32x16_bf16 v[140:155], v[32:35], v[196:199], v[140:155]
    v_exp_f32 v224, v160
    v_exp_f32 v225, v161
    v_exp_f32 v226, v162
    v_exp_f32 v227, v163
    v_pk_add_f32 v[220:221], v[220:221], 1.0 op_sel_hi:[1,0]
    v_pk_add_f32 v[222:223], v[222:223], 1.0 op_sel_hi:[1,0]
    v_pk_add_f32 v[224:225], v[224:225], 1.0 op_sel_hi:[1,0]
    v_pk_add_f32 v[226:227], v[226:227], 1.0 op_sel_hi:[1,0]
    v_mfma_f32_32x32x16_bf16 v[140:155], v[0:3], v[172:175], v[140:155]
    v_rcp_f32 v220, v220
    v_rcp_f32 v221, v221
    v_rcp_f32 v222, v222
    v_rcp_f32 v223, v223
    v_mfma_f32_32x32x16_bf16 v[140:155], v[4:7], v[176:179], v[140:155]
    v_rcp_f32 v224, v224
    v_rcp_f32 v225, v225
    v_rcp_f32 v226, v226
    v_rcp_f32 v227, v227
    v_pk_fma_f32 v[92:93], v[156:157], v[220:221], v[92:93]
    v_pk_fma_f32 v[94:95], v[158:159], v[222:223], v[94:95]
    v_pk_fma_f32 v[96:97], v[160:161], v[224:225], v[96:97]
    v_pk_fma_f32 v[98:99], v[162:163], v[226:227], v[98:99]
    v_pk_fma_f32 v[228:229], v[92:93], v[124:125], v[228:229]
    v_pk_fma_f32 v[230:231], v[94:95], v[126:127], v[230:231]
    v_pk_fma_f32 v[228:229], v[96:97], v[128:129], v[228:229]
    v_pk_fma_f32 v[230:231], v[98:99], v[130:131], v[230:231]
    v_mfma_f32_32x32x16_bf16 v[140:155], v[8:11], v[180:183], v[140:155]
    v_exp_f32 v220, v164
    v_exp_f32 v221, v165
    v_exp_f32 v222, v166
    v_exp_f32 v223, v167
    v_mfma_f32_32x32x16_bf16 v[140:155], v[12:15], v[184:187], v[140:155]
    v_exp_f32 v224, v168
    v_exp_f32 v225, v169
    v_exp_f32 v226, v170
    v_exp_f32 v227, v171
    v_pk_add_f32 v[220:221], v[220:221], 1.0 op_sel_hi:[1,0]
    v_pk_add_f32 v[222:223], v[222:223], 1.0 op_sel_hi:[1,0]
    v_pk_add_f32 v[224:225], v[224:225], 1.0 op_sel_hi:[1,0]
    v_pk_add_f32 v[226:227], v[226:227], 1.0 op_sel_hi:[1,0]
    v_rcp_f32 v220, v220
    v_rcp_f32 v221, v221
    v_rcp_f32 v222, v222
    v_rcp_f32 v223, v223
    v_rcp_f32 v224, v224
    v_rcp_f32 v225, v225
    v_rcp_f32 v226, v226
    v_rcp_f32 v227, v227
    v_pk_fma_f32 v[100:101], v[164:165], v[220:221], v[100:101]
    v_pk_fma_f32 v[102:103], v[166:167], v[222:223], v[102:103]
    v_pk_fma_f32 v[104:105], v[168:169], v[224:225], v[104:105]
    v_pk_fma_f32 v[106:107], v[170:171], v[226:227], v[106:107]
    v_pk_fma_f32 v[228:229], v[100:101], v[132:133], v[228:229]
    v_pk_fma_f32 v[230:231], v[102:103], v[134:135], v[230:231]
    v_pk_fma_f32 v[228:229], v[104:105], v[136:137], v[228:229]
    v_pk_fma_f32 v[230:231], v[106:107], v[138:139], v[230:231]
    v_pk_add_f32 v[228:229], v[228:229], v[230:231]
    s_cmp_eq_u64 s[38:39], 0
    v_add_f32 v243, v228, v229
    v_sub_f32 v248, v243, v247
    v_pk_fma_f32 v[244:245], v[232:233], v[248:249], v[244:245] op_sel_hi:[1,0,1]
    v_fmac_f32 v246, v234, v248
    s_mov_b64 exec, -1
    s_cbranch_scc1 K2_DONE
    v_mfma_f32_32x32x8_bf16 v[156:171], v[42:43], v[208:209], v[60:75]
    s_mov_b64 exec, s[38:39]
    v_exp_f32 v220, v140
    v_exp_f32 v221, v141
    v_exp_f32 v222, v142
    v_exp_f32 v223, v143
    v_mfma_f32_32x32x16_bf16 v[156:171], v[36:39], v[196:199], v[156:171]
    v_exp_f32 v224, v144
    v_exp_f32 v225, v145
    s_bitcmp1_b32 s5, 2
    s_cbranch_scc0 K2_VP11
    s_setprio 1
K2_VP11:
    s_waitcnt lgkmcnt(0)
    s_mov_b64 exec, -1
    s_add_u32 m0, s94, 32768
    s_nop 0
    buffer_load_dwordx4 v[210:211], s[8:11], 0 idxen offen lds
    s_add_u32 m0, s94, 33792
    s_nop 0
    buffer_load_dwordx4 v[212:213], s[8:11], 0 idxen offen lds
    s_add_u32 m0, s94, 34816
    s_nop 0
    buffer_load_dwordx4 v[214:215], s[8:11], 0 idxen offen lds
    s_add_u32 m0, s94, 35840
    s_nop 0
    buffer_load_dwordx4 v[216:217], s[8:11], 0 idxen offen lds
    s_mov_b64 exec, s[38:39]
    s_setprio 0
    v_exp_f32 v226, v146
    v_exp_f32 v227, v147
    v_pk_add_f32 v[220:221], v[220:221], 1.0 op_sel_hi:[1,0]
    v_pk_add_f32 v[222:223], v[222:223], 1.0 op_sel_hi:[1,0]
    v_pk_add_f32 v[224:225], v[224:225], 1.0 op_sel_hi:[1,0]
    v_pk_add_f32 v[226:227], v[226:227], 1.0 op_sel_hi:[1,0]
    v_mfma_f32_32x32x16_bf16 v[156:171], v[16:19], v[172:175], v[156:171]
    v_rcp_f32 v220, v220
    v_rcp_f32 v221, v221
    v_rcp_f32 v222, v222
    v_rcp_f32 v223, v223
    v_mfma_f32_32x32x16_bf16 v[156:171], v[20:23], v[176:179], v[156:171]
    v_rcp_f32 v224, v224
    v_rcp_f32 v225, v225
    v_rcp_f32 v226, v226
    v_rcp_f32 v227, v227
    v_pk_fma_f32 v[76:77], v[140:141], v[220:221], v[76:77]
    v_pk_fma_f32 v[78:79], v[142:143], v[222:223], v[78:79]
    v_pk_fma_f32 v[80:81], v[144:145], v[224:225], v[80:81]
    v_pk_fma_f32 v[82:83], v[146:147], v[226:227], v[82:83]
    v_pk_mul_f32 v[228:229], v[76:77], v[108:109]
    v_pk_mul_f32 v[230:231], v[78:79], v[110:111]
    v_pk_fma_f32 v[228:229], v[80:81], v[112:113], v[228:229]
    v_pk_fma_f32 v[230:231], v[82:83], v[114:115], v[230:231]
    v_mfma_f32_32x32x16_bf16 v[156:171], v[24:27], v[180:183], v[156:171]
    v_exp_f32 v220, v148
    v_exp_f32 v221, v149
    v_exp_f32 v222, v150
    v_exp_f32 v223, v151
    v_mfma_f32_32x32x16_bf16 v[156:171], v[28:31], v[184:187], v[156:171]
    v_exp_f32 v224, v152
    v_exp_f32 v225, v153
    v_exp_f32 v226, v154
    buffer_load_dwordx4 v[192:195], v[218:219], s[12:15], 0 idxen offen
    buffer_load_dwordx2 v[204:205], v203, s[16:19], 0 idxen
    v_exp_f32 v227, v155
    s_waitcnt vmcnt(6)
    ds_read_b128 v[172:175], v251 offset:0
    ds_read_b128 v[176:179], v252 offset:0
    ds_read_b128 v[180:183], v253 offset:0
    ds_read_b128 v[184:187], v254 offset:0
    v_cmp_lt_u32_e64 s[32:33], s6, v235
    s_add_u32 s6, s6, 1
    v_lshlrev_b32 v232, 16, v200
    v_and_b32 v233, 0xffff0000, v200
    v_sub_f32 v234, v242, v201
    v_pk_add_f32 v[232:233], v[240:241], v[232:233] neg_lo:[0,1] neg_hi:[0,1]
    v_mul_f32 v208, v232, v232
    v_fmac_f32 v208, v233, v233
    v_fmac_f32 v208, v234, v234
    v_cvt_pk_bf16_f32 v208, v208, v208
    v_cndmask_b32_e64 v203, 0, v207, s[32:33]
    v_add_u32 v207, v207, v206
    ds_read_b32 v218, v203
    ds_read_u16 v203, v203 offset:4
    v_pk_add_f32 v[220:221], v[220:221], 1.0 op_sel_hi:[1,0]
    v_pk_add_f32 v[222:223], v[222:223], 1.0 op_sel_hi:[1,0]
    v_pk_add_f32 v[224:225], v[224:225], 1.0 op_sel_hi:[1,0]
    v_pk_add_f32 v[226:227], v[226:227], 1.0 op_sel_hi:[1,0]
    v_rcp_f32 v220, v220
    v_rcp_f32 v221, v221
    v_rcp_f32 v222, v222
    v_rcp_f32 v223, v223
    v_rcp_f32 v224, v224
    v_rcp_f32 v225, v225
    v_rcp_f32 v226, v226
    v_rcp_f32 v227, v227
    s_waitcnt lgkmcnt(0)
    s_mov_b64 exec, -1
    ds_bpermute_b32 v210, v239, v203 offset:0
    ds_bpermute_b32 v212, v239, v203 offset:32
    ds_bpermute_b32 v214, v239, v203 offset:64
    ds_bpermute_b32 v216, v239, v203 offset:96
    s_mov_b64 exec, s[38:39]
    v_pk_fma_f32 v[84:85], v[148:149], v[220:221], v[84:85]
    v_pk_fma_f32 v[86:87], v[150:151], v[222:223], v[86:87]
    v_pk_fma_f32 v[88:89], v[152:153], v[224:225], v[88:89]
    v_pk_fma_f32 v[90:91], v[154:155], v[226:227], v[90:91]
    v_pk_fma_f32 v[228:229], v[84:85], v[116:117], v[228:229]
    v_pk_fma_f32 v[230:231], v[86:87], v[118:119], v[230:231]
    v_pk_fma_f32 v[228:229], v[88:89], v[120:121], v[228:229]
    v_pk_fma_f32 v[230:231], v[90:91], v[122:123], v[230:231]
    v_mfma_f32_32x32x8_bf16 v[140:155], v[40:41], v[208:209], v[44:59]
    v_exp_f32 v220, v156
    v_exp_f32 v221, v157
    v_exp_f32 v222, v158
    v_exp_f32 v223, v159
    v_mfma_f32_32x32x16_bf16 v[140:155], v[32:35], v[188:191], v[140:155]
    v_exp_f32 v224, v160
    v_exp_f32 v225, v161
    v_exp_f32 v226, v162
    v_exp_f32 v227, v163
    v_pk_add_f32 v[220:221], v[220:221], 1.0 op_sel_hi:[1,0]
    v_pk_add_f32 v[222:223], v[222:223], 1.0 op_sel_hi:[1,0]
    v_pk_add_f32 v[224:225], v[224:225], 1.0 op_sel_hi:[1,0]
    v_pk_add_f32 v[226:227], v[226:227], 1.0 op_sel_hi:[1,0]
    v_mfma_f32_32x32x16_bf16 v[140:155], v[0:3], v[172:175], v[140:155]
    v_rcp_f32 v220, v220
    v_rcp_f32 v221, v221
    v_rcp_f32 v222, v222
    v_rcp_f32 v223, v223
    v_mfma_f32_32x32x16_bf16 v[140:155], v[4:7], v[176:179], v[140:155]
    v_rcp_f32 v224, v224
    v_rcp_f32 v225, v225
    v_rcp_f32 v226, v226
    v_rcp_f32 v227, v227
    v_pk_fma_f32 v[92:93], v[156:157], v[220:221], v[92:93]
    v_pk_fma_f32 v[94:95], v[158:159], v[222:223], v[94:95]
    v_pk_fma_f32 v[96:97], v[160:161], v[224:225], v[96:97]
    v_pk_fma_f32 v[98:99], v[162:163], v[226:227], v[98:99]
    v_pk_fma_f32 v[228:229], v[92:93], v[124:125], v[228:229]
    v_pk_fma_f32 v[230:231], v[94:95], v[126:127], v[230:231]
    v_pk_fma_f32 v[228:229], v[96:97], v[128:129], v[228:229]
    v_pk_fma_f32 v[230:231], v[98:99], v[130:131], v[230:231]
    v_mfma_f32_32x32x16_bf16 v[140:155], v[8:11], v[180:183], v[140:155]
    v_exp_f32 v220, v164
    v_exp_f32 v221, v165
    v_exp_f32 v222, v166
    v_exp_f32 v223, v167
    v_mfma_f32_32x32x16_bf16 v[140:155], v[12:15], v[184:187], v[140:155]
    v_exp_f32 v224, v168
    v_exp_f32 v225, v169
    v_exp_f32 v226, v170
    v_exp_f32 v227, v171
    v_pk_add_f32 v[220:221], v[220:221], 1.0 op_sel_hi:[1,0]
    v_pk_add_f32 v[222:223], v[222:223], 1.0 op_sel_hi:[1,0]
    v_pk_add_f32 v[224:225], v[224:225], 1.0 op_sel_hi:[1,0]
    v_pk_add_f32 v[226:227], v[226:227], 1.0 op_sel_hi:[1,0]
    v_rcp_f32 v220, v220
    v_rcp_f32 v221, v221
    v_rcp_f32 v222, v222
    v_rcp_f32 v223, v223
    v_rcp_f32 v224, v224
    v_rcp_f32 v225, v225
    v_rcp_f32 v226, v226
    v_rcp_f32 v227, v227
    v_pk_fma_f32 v[100:101], v[164:165], v[220:221], v[100:101]
    v_pk_fma_f32 v[102:103], v[166:167], v[222:223], v[102:103]
    v_pk_fma_f32 v[104:105], v[168:169], v[224:225], v[104:105]
    v_pk_fma_f32 v[106:107], v[170:171], v[226:227], v[106:107]
    v_pk_fma_f32 v[228:229], v[100:101], v[132:133], v[228:229]
    v_pk_fma_f32 v[230:231], v[102:103], v[134:135], v[230:231]
    v_pk_fma_f32 v[228:229], v[104:105], v[136:137], v[228:229]
    v_pk_fma_f32 v[230:231], v[106:107], v[138:139], v[230:231]
    v_pk_add_f32 v[228:229], v[228:229], v[230:231]
    s_cmp_eq_u64 s[28:29], 0
    v_add_f32 v247, v228, v229
    v_sub_f32 v248, v247, v243
    v_pk_fma_f32 v[244:245], v[236:237], v[248:249], v[244:245] op_sel_hi:[1,0,1]
    v_fmac_f32 v246, v238, v248
    s_mov_b64 exec, -1
    s_cbranch_scc0 K2_LOOP
K2_DONE:
    v_and_b32 v203, 63, v250
    s_or_b32 s95, s7, s93
    s_cselect_b32 s97, 3, s97
    s_cmp_gt_u32 s97, 2
    v_lshlrev_b32 v203, 4, v203
    s_cbranch_scc1 K2_SLOW
    v_bfe_u32 v220, v249, 1, 3
    v_lshlrev_b32 v220, 4, v220
    v_lshlrev_b32 v221, 2, v219
    v_xor_b32 v220, v220, v221
    v_lshl_add_u32 v220, v249, 7, v220
    v_add_u32 v220, 100352, v220
    v_xor_b32 v221, 16, v220
    v_xor_b32 v222, 32, v220
    v_xor_b32 v223, 48, v220
    ds_read_b128 v[172:175], v220
    ds_read_b128 v[176:179], v221
    ds_read_b128 v[180:183], v222
    ds_read_b128 v[184:187], v223
    v_add_u32 v220, 125952, v203
    v_cmp_eq_u32_e64 s[46:47], 16, v206
    v_cmp_eq_u32_e64 s[44:45], 8, v206
    v_add_u32 v218, s4, v249
    ds_read_b128 v[0:3], v220 offset:32768
    ds_read_b128 v[4:7], v220 offset:33792
    ds_read_b128 v[8:11], v220 offset:34816
    ds_read_b128 v[12:15], v220 offset:35840
    ds_read_b128 v[16:19], v220 offset:0
    ds_read_b128 v[20:23], v220 offset:1024
    ds_read_b128 v[24:27], v220 offset:2048
    ds_read_b128 v[28:31], v220 offset:3072
    ds_read_b128 v[44:47], v220 offset:4096
    ds_read_b128 v[48:51], v220 offset:5120
    ds_read_b128 v[52:55], v220 offset:6144
    ds_read_b128 v[56:59], v220 offset:7168
    ds_read_b128 v[60:63], v220 offset:8192
    ds_read_b128 v[64:67], v220 offset:9216
    ds_read_b128 v[68:71], v220 offset:10240
    ds_read_b128 v[72:75], v220 offset:11264
    s_mov_b64 exec, s[46:47]
    s_and_b32 s46, s46, 0x55555555
    s_or_b32 s44, s44, s46
    s_mov_b32 s98, s94
    v_add_f32_dpp v244, v244, v244 quad_perm:[1,0,3,2] row_mask:0xf bank_mask:0xf
    v_add_f32_dpp v245, v245, v245 quad_perm:[1,0,3,2] row_mask:0xf bank_mask:0xf
    v_add_f32_dpp v246, v246, v246 quad_perm:[1,0,3,2] row_mask:0xf bank_mask:0xf
    v_add_f32_dpp v76, v76, v76 quad_perm:[1,0,3,2] row_mask:0xf bank_mask:0xf
    v_add_f32_dpp v77, v77, v77 quad_perm:[1,0,3,2] row_mask:0xf bank_mask:0xf
    v_add_f32_dpp v78, v78, v78 quad_perm:[1,0,3,2] row_mask:0xf bank_mask:0xf
    v_add_f32_dpp v79, v79, v79 quad_perm:[1,0,3,2] row_mask:0xf bank_mask:0xf
    v_add_f32_dpp v80, v80, v80 quad_perm:[1,0,3,2] row_mask:0xf bank_mask:0xf
    v_add_f32_dpp v81, v81, v81 quad_perm:[1,0,3,2] row_mask:0xf bank_mask:0xf
    v_add_f32_dpp v82, v82, v82 quad_perm:[1,0,3,2] row_mask:0xf bank_mask:0xf
    v_add_f32_dpp v83, v83, v83 quad_perm:[1,0,3,2] row_mask:0xf bank_mask:0xf
    v_add_f32_dpp v84, v84, v84 quad_perm:[1,0,3,2] row_mask:0xf bank_mask:0xf
    v_add_f32_dpp v85, v85, v85 quad_perm:[1,0,3,2] row_mask:0xf bank_mask:0xf
    v_add_f32_dpp v86, v86, v86 quad_perm:[1,0,3,2] row_mask:0xf bank_mask:0xf
    v_add_f32_dpp v87, v87, v87 quad_perm:[1,0,3,2] row_mask:0xf bank_mask:0xf
    v_add_f32_dpp v88, v88, v88 quad_perm:[1,0,3,2] row_mask:0xf bank_mask:0xf
    v_add_f32_dpp v89, v89, v89 quad_perm:[1,0,3,2] row_mask:0xf bank_mask:0xf
    v_add_f32_dpp v90, v90, v90 quad_perm:[1,0,3,2] row_mask:0xf bank_mask:0xf
    v_add_f32_dpp v91, v91, v91 quad_perm:[1,0,3,2] row_mask:0xf bank_mask:0xf
    v_add_f32_dpp v92, v92, v92 quad_perm:[1,0,3,2] row_mask:0xf bank_mask:0xf
    v_add_f32_dpp v93, v93, v93 quad_perm:[1,0,3,2] row_mask:0xf bank_mask:0xf
    v_add_f32_dpp v94, v94, v94 quad_perm:[1,0,3,2] row_mask:0xf bank_mask:0xf
    v_add_f32_dpp v95, v95, v95 quad_perm:[1,0,3,2] row_mask:0xf bank_mask:0xf
    v_add_f32_dpp v96, v96, v96 quad_perm:[1,0,3,2] row_mask:0xf bank_mask:0xf
    v_add_f32_dpp v97, v97, v97 quad_perm:[1,0,3,2] row_mask:0xf bank_mask:0xf
    v_add_f32_dpp v98, v98, v98 quad_perm:[1,0,3,2] row_mask:0xf bank_mask:0xf
    v_add_f32_dpp v99, v99, v99 quad_perm:[1,0,3,2] row_mask:0xf bank_mask:0xf
    v_add_f32_dpp v100, v100, v100 quad_perm:[1,0,3,2] row_mask:0xf bank_mask:0xf
    v_add_f32_dpp v101, v101, v101 quad_perm:[1,0,3,2] row_mask:0xf bank_mask:0xf
    v_add_f32_dpp v102, v102, v102 quad_perm:[1,0,3,2] row_mask:0xf bank_mask:0xf
    v_add_f32_dpp v103, v103, v103 quad_perm:[1,0,3,2] row_mask:0xf bank_mask:0xf
    v_add_f32_dpp v104, v104, v104 quad_perm:[1,0,3,2] row_mask:0xf bank_mask:0xf
    v_add_f32_dpp v105, v105, v105 quad_perm:[1,0,3,2] row_mask:0xf bank_mask:0xf
    v_add_f32_dpp v106, v106, v106 quad_perm:[1,0,3,2] row_mask:0xf bank_mask:0xf
    v_add_f32_dpp v107, v107, v107 quad_perm:[1,0,3,2] row_mask:0xf bank_mask:0xf
    s_mov_b64 exec, -1
    v_mov_b32 v224, v244
    v_mov_b32 v225, v245
    v_mov_b32 v226, v246
    s_nop 1
    v_permlane32_swap_b32 v224, v244
    v_permlane32_swap_b32 v225, v245
    v_permlane32_swap_b32 v226, v246
    s_nop 1
    v_add_f32 v244, v244, v224
    v_add_f32 v245, v245, v225
    v_add_f32 v246, v246, v226
    s_branch K2_TAIL
K2_EMPTY:
    s_waitcnt vmcnt(0) lgkmcnt(0)
    v_mov_b32 v244, 0
    v_mov_b32 v245, 0
    v_mov_b32 v246, 0
    v_mov_b32 v76, 0
    v_mov_b32 v77, 0
    v_mov_b32 v78, 0
    v_mov_b32 v79, 0
    v_mov_b32 v80, 0
    v_mov_b32 v81, 0
    v_mov_b32 v82, 0
    v_mov_b32 v83, 0
    v_mov_b32 v84, 0
    v_mov_b32 v85, 0
    v_mov_b32 v86, 0
    v_mov_b32 v87, 0
    v_mov_b32 v88, 0
    v_mov_b32 v89, 0
    v_mov_b32 v90, 0
    v_mov_b32 v91, 0
    v_mov_b32 v92, 0
    v_mov_b32 v93, 0
    v_mov_b32 v94, 0
    v_mov_b32 v95, 0
    v_mov_b32 v96, 0
    v_mov_b32 v97, 0
    v_mov_b32 v98, 0
    v_mov_b32 v99, 0
    v_mov_b32 v100, 0
    v_mov_b32 v101, 0
    v_mov_b32 v102, 0
    v_mov_b32 v103, 0
    v_mov_b32 v104, 0
    v_mov_b32 v105, 0
    v_mov_b32 v106, 0
    v_mov_b32 v107, 0
    v_mov_b32 v242, v241
    v_and_b32 v241, 0xffff0000, v240
    v_lshlrev_b32 v240, 16, v240
    s_branch K2_DONE
K2_SLOW:
    v_and_b32 v223, 31, v250
    v_lshlrev_b32 v220, 2, v219
    v_xor_b32 v220, v220, v251
    v_lshl_add_u32 v220, v219, 11, v220
    s_lshl_b32 s95, s100, 10
    s_add_u32 s95, s95, 129024
    v_lshl_add_u32 v221, v223, 5, v219
    v_add_u32 v221, s95, v221
    s_lshl_b32 s95, s5, 5
    v_add_u32 v223, s95, v223
    v_add_u32 v218, s4, v223
    v_min_u32 v222, 49999, v218
    s_waitcnt vmcnt(0)
    buffer_load_dwordx2 v[240:241], v222, s[16:19], 0 idxen
    v_xor_b32 v222, 0, v220
    ds_write_b128 v222, v[76:79]
    v_xor_b32 v222, 16, v220
    ds_write_b128 v222, v[80:83]
    v_xor_b32 v222, 32, v220
    ds_write_b128 v222, v[84:87]
    v_xor_b32 v222, 48, v220
    ds_write_b128 v222, v[88:91]
    v_xor_b32 v222, 64, v220
    ds_write_b128 v222, v[92:95]
    v_xor_b32 v222, 80, v220
    ds_write_b128 v222, v[96:99]
    v_xor_b32 v222, 96, v220
    ds_write_b128 v222, v[100:103]
    v_xor_b32 v222, 112, v220
    ds_write_b128 v222, v[104:107]
    ds_write_b128 v221, v[244:247]
    v_lshlrev_b32 v220, 2, v223
    ds_read_b32 v235, v220 offset:32768
    s_sub_u32 s99, s101, s94
    v_add_u32 v251, s99, v251
    v_add_u32 v252, s99, v252
    v_add_u32 v253, s99, v253
    v_add_u32 v254, s99, v254
    ds_read_b128 v[172:175], v251 offset:0
    ds_read_b128 v[176:179], v252 offset:0
    ds_read_b128 v[180:183], v253 offset:0
    ds_read_b128 v[184:187], v254 offset:0
    v_mov_b32 v76, 0
    v_mov_b32 v77, 0
    v_mov_b32 v78, 0
    v_mov_b32 v79, 0
    v_mov_b32 v80, 0
    v_mov_b32 v81, 0
    v_mov_b32 v82, 0
    v_mov_b32 v83, 0
    v_mov_b32 v84, 0
    v_mov_b32 v85, 0
    v_mov_b32 v86, 0
    v_mov_b32 v87, 0
    v_mov_b32 v88, 0
    v_mov_b32 v89, 0
    v_mov_b32 v90, 0
    v_mov_b32 v91, 0
    v_mov_b32 v92, 0
    v_mov_b32 v93, 0
    v_mov_b32 v94, 0
    v_mov_b32 v95, 0
    v_mov_b32 v96, 0
    v_mov_b32 v97, 0
    v_mov_b32 v98, 0
    v_mov_b32 v99, 0
    v_mov_b32 v100, 0
    v_mov_b32 v101, 0
    v_mov_b32 v102, 0
    v_mov_b32 v103, 0
    v_mov_b32 v104, 0
    v_mov_b32 v105, 0
    v_mov_b32 v106, 0
    v_mov_b32 v107, 0
    v_mov_b32 v244, 0
    v_mov_b32 v245, 0
    v_mov_b32 v246, 0
    s_lshl_b32 s99, s3, 8
    v_add_u32 v249, s99, v223
    v_mul_u32_u24 v249, 272, v249
    v_lshl_add_u32 v243, v219, 3, v249
    s_mov_b32 s99, 7602176
    s_cmp_eq_u32 s7, 0
    s_cbranch_scc1 K2_NOLD
    buffer_load_dwordx4 v[76:79], v243, s[20:23], s99 offen offset:0 sc0 sc1
    buffer_load_dwordx4 v[80:83], v243, s[20:23], s99 offen offset:16 sc0 sc1
    buffer_load_dwordx4 v[84:87], v243, s[20:23], s99 offen offset:32 sc0 sc1
    buffer_load_dwordx4 v[88:91], v243, s[20:23], s99 offen offset:48 sc0 sc1
    buffer_load_dwordx4 v[92:95], v243, s[20:23], s99 offen offset:64 sc0 sc1
    buffer_load_dwordx4 v[96:99], v243, s[20:23], s99 offen offset:80 sc0 sc1
    buffer_load_dwordx4 v[100:103], v243, s[20:23], s99 offen offset:96 sc0 sc1
    buffer_load_dwordx4 v[104:107], v243, s[20:23], s99 offen offset:112 sc0 sc1
    buffer_load_dwordx3 v[244:246], v249, s[20:23], s99 offen offset:256 sc0 sc1
    s_waitcnt vmcnt(0)
K2_NOLD:
    s_waitcnt lgkmcnt(0)
    v_and_b32 v207, 0xffff, v235
    v_lshrrev_b32 v235, 16, v235
    v_lshlrev_b32 v247, 11, v219
    v_add_u32 v247, 34816, v247
    v_add_u32 v220, 138240, v203
    v_cmp_lt_u32 vcc, 0, v235
    s_barrier
    s_cbranch_vccz K2_GDONE
K2_GLOOP:
    s_mov_b64 exec, vcc
    v_bfe_u32 v221, v207, 3, 3
    v_lshlrev_b32 v221, 4, v221
    v_lshl_add_u32 v221, v207, 5, v221
    v_add_u32 v221, v247, v221
    v_xor_b32 v222, 0, v221
    ds_read_b128 v[140:143], v222
    v_xor_b32 v222, 16, v221
    ds_read_b128 v[144:147], v222
    v_xor_b32 v222, 32, v221
    ds_read_b128 v[148:151], v222
    v_xor_b32 v222, 48, v221
    ds_read_b128 v[152:155], v222
    v_xor_b32 v222, 64, v221
    ds_read_b128 v[156:159], v222
    v_xor_b32 v222, 80, v221
    ds_read_b128 v[160:163], v222
    v_xor_b32 v222, 96, v221
    ds_read_b128 v[164:167], v222
    v_xor_b32 v222, 112, v221
    ds_read_b128 v[168:171], v222
    v_lshlrev_b32 v222, 3, v207
    v_add_u32 v222, 129024, v222
    ds_read_b128 v[188:191], v222
    ds_read_b128 v[192:195], v222 offset:16
    v_add_u32 v207, 4, v207
    v_subrev_u32 v235, 1, v235
    v_cmp_lt_u32 vcc, 0, v235
    s_waitcnt lgkmcnt(9)
    v_pk_add_f32 v[76:77], v[76:77], v[140:141]
    v_pk_add_f32 v[78:79], v[78:79], v[142:143]
    s_waitcnt lgkmcnt(8)
    v_pk_add_f32 v[80:81], v[80:81], v[144:145]
    v_pk_add_f32 v[82:83], v[82:83], v[146:147]
    s_waitcnt lgkmcnt(7)
    v_pk_add_f32 v[84:85], v[84:85], v[148:149]
    v_pk_add_f32 v[86:87], v[86:87], v[150:151]
    s_waitcnt lgkmcnt(6)
    v_pk_add_f32 v[88:89], v[88:89], v[152:153]
    v_pk_add_f32 v[90:91], v[90:91], v[154:155]
    s_waitcnt lgkmcnt(5)
    v_pk_add_f32 v[92:93], v[92:93], v[156:157]
    v_pk_add_f32 v[94:95], v[94:95], v[158:159]
    s_waitcnt lgkmcnt(4)
    v_pk_add_f32 v[96:97], v[96:97], v[160:161]
    v_pk_add_f32 v[98:99], v[98:99], v[162:163]
    s_waitcnt lgkmcnt(3)
    v_pk_add_f32 v[100:101], v[100:101], v[164:165]
    v_pk_add_f32 v[102:103], v[102:103], v[166:167]
    s_waitcnt lgkmcnt(2)
    v_pk_add_f32 v[104:105], v[104:105], v[168:169]
    v_pk_add_f32 v[106:107], v[106:107], v[170:171]
    s_waitcnt lgkmcnt(0)
    v_pk_add_f32 v[244:245], v[244:245], v[188:189]
    v_add_f32 v246, v246, v190
    v_pk_add_f32 v[244:245], v[244:245], v[192:193]
    v_add_f32 v246, v246, v194
    s_cbranch_vccnz K2_GLOOP
    s_mov_b64 exec, -1
K2_GDONE:
    s_cmp_eq_u32 s93, 0
    s_cbranch_scc1 K2_EPI
    buffer_store_dwordx4 v[76:79], v243, s[20:23], s99 offen offset:0
    buffer_store_dwordx4 v[80:83], v243, s[20:23], s99 offen offset:16
    buffer_store_dwordx4 v[84:87], v243, s[20:23], s99 offen offset:32
    buffer_store_dwordx4 v[88:91], v243, s[20:23], s99 offen offset:48
    buffer_store_dwordx4 v[92:95], v243, s[20:23], s99 offen offset:64
    buffer_store_dwordx4 v[96:99], v243, s[20:23], s99 offen offset:80
    buffer_store_dwordx4 v[100:103], v243, s[20:23], s99 offen offset:96
    buffer_store_dwordx4 v[104:107], v243, s[20:23], s99 offen offset:112
    buffer_store_dwordx3 v[244:246], v249, s[20:23], s99 offen offset:256
    s_add_u32 s7, s7, s92
    s_waitcnt vmcnt(0)
    s_barrier
    s_branch K2_TOP
K2_EPI:
    s_cmp_ge_u32 s5, 6
    s_cbranch_scc1 K2_NWH2
    s_mul_i32 s95, s5, 2048
    s_add_u32 m0, s95, 138240
    s_add_u32 s95, s95, 7561216
    buffer_load_dwordx4 v203, s[20:23], s95 offen offset:0 lds
    buffer_load_dwordx4 v203, s[20:23], s95 offen offset:1024 lds
K2_NWH2:
    s_lshl_b32 s95, s5, 5
    s_cmp_ge_u32 s95, s96
    s_waitcnt vmcnt(0)
    s_barrier
    s_cbranch_scc1 K2_END0
    ds_read_b128 v[0:3], v220 offset:20480
    ds_read_b128 v[4:7], v220 offset:21504
    ds_read_b128 v[8:11], v220 offset:22528
    ds_read_b128 v[12:15], v220 offset:23552
    ds_read_b128 v[16:19], v220 offset:0
    ds_read_b128 v[20:23], v220 offset:1024
    ds_read_b128 v[24:27], v220 offset:2048
    ds_read_b128 v[28:31], v220 offset:3072
    ds_read_b128 v[44:47], v220 offset:4096
    ds_read_b128 v[48:51], v220 offset:5120
    ds_read_b128 v[52:55], v220 offset:6144
    ds_read_b128 v[56:59], v220 offset:7168
    ds_read_b128 v[60:63], v220 offset:8192
    ds_read_b128 v[64:67], v220 offset:9216
    ds_read_b128 v[68:71], v220 offset:10240
    ds_read_b128 v[72:75], v220 offset:11264
    v_cmp_gt_u32_e64 s[44:45], s96, v223
    s_mov_b32 s98, s101
    s_waitcnt vmcnt(0)
    v_mov_b32 v242, v241
    v_and_b32 v241, 0xffff0000, v240
    v_lshlrev_b32 v240, 16, v240
K2_TAIL:
    v_add_u32 v235, s98, v203
    v_lshlrev_b32 v203, 7, v218
    v_cndmask_b32_e64 v203, 2.0, v203, s[44:45]
    s_waitcnt lgkmcnt(8)
    v_mfma_f32_32x32x16_bf16 v[140:155], v[0:3], v[172:175], 0
    v_cvt_pk_bf16_f32 v108, v76, v77
    v_cvt_pk_bf16_f32 v109, v78, v79
    v_mfma_f32_32x32x16_bf16 v[156:171], v[16:19], v[172:175], 0
    v_cvt_pk_bf16_f32 v110, v80, v81
    v_cvt_pk_bf16_f32 v111, v82, v83
    v_mfma_f32_32x32x16_bf16 v[140:155], v[4:7], v[176:179], v[140:155]
    v_cvt_pk_bf16_f32 v112, v84, v85
    v_cvt_pk_bf16_f32 v113, v86, v87
    v_mfma_f32_32x32x16_bf16 v[156:171], v[20:23], v[176:179], v[156:171]
    v_cvt_pk_bf16_f32 v114, v88, v89
    v_cvt_pk_bf16_f32 v115, v90, v91
    v_mfma_f32_32x32x16_bf16 v[140:155], v[8:11], v[180:183], v[140:155]
    v_cvt_pk_bf16_f32 v116, v92, v93
    v_cvt_pk_bf16_f32 v117, v94, v95
    v_mfma_f32_32x32x16_bf16 v[156:171], v[24:27], v[180:183], v[156:171]
    v_cvt_pk_bf16_f32 v118, v96, v97
    v_cvt_pk_bf16_f32 v119, v98, v99
    v_mfma_f32_32x32x16_bf16 v[140:155], v[12:15], v[184:187], v[140:155]
    v_cvt_pk_bf16_f32 v120, v100, v101
    v_cvt_pk_bf16_f32 v121, v102, v103
    v_mfma_f32_32x32x16_bf16 v[156:171], v[28:31], v[184:187], v[156:171]
    v_cvt_pk_bf16_f32 v122, v104, v105
    v_cvt_pk_bf16_f32 v123, v106, v107
    s_waitcnt lgkmcnt(0)
    ds_bpermute_b32 v210, v239, v203 offset:0
    ds_bpermute_b32 v212, v239, v203 offset:32
    ds_bpermute_b32 v214, v239, v203 offset:64
    ds_bpermute_b32 v216, v239, v203 offset:96
    v_mfma_f32_32x32x16_bf16 v[140:155], v[44:47], v[108:111], v[140:155]
    v_lshlrev_b32 v76, 16, v172
    v_and_b32 v77, 0xffff0000, v172
    v_lshlrev_b32 v78, 16, v173
    v_and_b32 v79, 0xffff0000, v173
    v_lshlrev_b32 v80, 16, v174
    v_and_b32 v81, 0xffff0000, v174
    v_lshlrev_b32 v82, 16, v175
    v_and_b32 v83, 0xffff0000, v175
    v_mfma_f32_32x32x16_bf16 v[140:155], v[48:51], v[112:115], v[140:155]
    v_lshlrev_b32 v84, 16, v176
    v_and_b32 v85, 0xffff0000, v176
    v_lshlrev_b32 v86, 16, v177
    v_and_b32 v87, 0xffff0000, v177
    v_lshlrev_b32 v88, 16, v178
    v_and_b32 v89, 0xffff0000, v178
    v_lshlrev_b32 v90, 16, v179
    v_and_b32 v91, 0xffff0000, v179
    v_mfma_f32_32x32x16_bf16 v[140:155], v[52:55], v[116:119], v[140:155]
    v_lshlrev_b32 v92, 16, v180
    v_and_b32 v93, 0xffff0000, v180
    v_lshlrev_b32 v94, 16, v181
    v_and_b32 v95, 0xffff0000, v181
    v_lshlrev_b32 v96, 16, v182
    v_and_b32 v97, 0xffff0000, v182
    v_lshlrev_b32 v98, 16, v183
    v_and_b32 v99, 0xffff0000, v183
    v_mfma_f32_32x32x16_bf16 v[140:155], v[56:59], v[120:123], v[140:155]
    v_lshlrev_b32 v100, 16, v184
    v_and_b32 v101, 0xffff0000, v184
    v_lshlrev_b32 v102, 16, v185
    v_and_b32 v103, 0xffff0000, v185
    v_lshlrev_b32 v104, 16, v186
    v_and_b32 v105, 0xffff0000, v186
    v_lshlrev_b32 v106, 16, v187
    v_and_b32 v107, 0xffff0000, v187
    v_mfma_f32_32x32x16_bf16 v[156:171], v[60:63], v[108:111], v[156:171]
    v_mov_b32 v243, 0
    v_pk_add_f32 v[244:245], v[244:245], v[240:241]
    v_add_f32 v246, v246, v242
    v_cvt_pk_bf16_f32 v244, v244, v245
    v_cvt_pk_bf16_f32 v246, v246, v246
    s_mov_b32 exec_lo, s44
    s_mov_b32 exec_hi, 0
    s_cmp_eq_u32 s98, s94
    s_cbranch_scc1 K2_PF
    v_mul_u32_u24 v220, 6, v218
    s_mov_b32 s99, 6400000
    buffer_store_short v244, v220, s[24:27], s99 offen
    buffer_store_short_d16_hi v244, v220, s[24:27], s99 offen offset:2
    buffer_store_short v246, v220, s[24:27], s99 offen offset:4
    s_branch K2_PD
K2_PF:
    s_mov_b32 s99, 32768
    v_mad_u32_u24 v220, v249, 6, s99
    ds_write_b16 v220, v244
    ds_write_b16_d16_hi v220, v244 offset:2
    ds_write_b16 v220, v246 offset:4
    s_mov_b64 exec, 1
    v_mov_b32 v220, 108
    v_mov_b32 v221, 1
    ds_add_rtn_u32 v243, v220, v221
K2_PD:
    s_mov_b64 exec, -1
    s_mov_b32 s40, 0xbf317218
    s_mov_b32 s41, 0xbf317218
    v_mfma_f32_32x32x16_bf16 v[156:171], v[64:67], v[112:115], v[156:171]
    v_exp_f32 v220, v140
    v_exp_f32 v221, v141
    v_exp_f32 v222, v142
    v_exp_f32 v223, v143
    v_mfma_f32_32x32x16_bf16 v[156:171], v[68:71], v[116:119], v[156:171]
    v_exp_f32 v224, v144
    v_exp_f32 v225, v145
    v_exp_f32 v226, v146
    v_exp_f32 v227, v147
    v_pk_add_f32 v[220:221], v[220:221], 1.0 op_sel_hi:[1,0]
    v_pk_add_f32 v[222:223], v[222:223], 1.0 op_sel_hi:[1,0]
    v_mfma_f32_32x32x16_bf16 v[156:171], v[72:75], v[120:123], v[156:171]
    v_pk_add_f32 v[224:225], v[224:225], 1.0 op_sel_hi:[1,0]
    v_pk_add_f32 v[226:227], v[226:227], 1.0 op_sel_hi:[1,0]
    v_rcp_f32 v220, v220
    v_rcp_f32 v221, v221
    v_rcp_f32 v222, v222
    v_rcp_f32 v223, v223
    v_rcp_f32 v224, v224
    v_rcp_f32 v225, v225
    v_rcp_f32 v226, v226
    v_rcp_f32 v227, v227
    s_waitcnt lgkmcnt(0)
    v_add_u32 v210, v210, v211
    v_add_u32 v212, v212, v213
    v_add_u32 v214, v214, v215
    v_add_u32 v216, v216, v217
    v_pk_mul_f32 v[220:221], v[220:221], v[140:141]
    v_pk_mul_f32 v[222:223], v[222:223], v[142:143]
    v_pk_mul_f32 v[224:225], v[224:225], v[144:145]
    v_pk_mul_f32 v[226:227], v[226:227], v[146:147]
    v_pk_fma_f32 v[220:221], v[220:221], s[40:41], v[76:77]
    v_pk_fma_f32 v[222:223], v[222:223], s[40:41], v[78:79]
    v_pk_fma_f32 v[224:225], v[224:225], s[40:41], v[80:81]
    v_pk_fma_f32 v[226:227], v[226:227], s[40:41], v[82:83]
    v_cvt_pk_bf16_f32 v172, v220, v221
    v_cvt_pk_bf16_f32 v173, v222, v223
    v_cvt_pk_bf16_f32 v174, v224, v225
    v_cvt_pk_bf16_f32 v175, v226, v227
    s_waitcnt vmcnt(0)
    ds_write_b128 v251, v[172:175]
    v_exp_f32 v220, v148
    v_exp_f32 v221, v149
    v_exp_f32 v222, v150
    v_exp_f32 v223, v151
    v_exp_f32 v224, v152
    v_exp_f32 v225, v153
    v_exp_f32 v226, v154
    v_exp_f32 v227, v155
    v_pk_add_f32 v[220:221], v[220:221], 1.0 op_sel_hi:[1,0]
    v_pk_add_f32 v[222:223], v[222:223], 1.0 op_sel_hi:[1,0]
    v_pk_add_f32 v[224:225], v[224:225], 1.0 op_sel_hi:[1,0]
    v_pk_add_f32 v[226:227], v[226:227], 1.0 op_sel_hi:[1,0]
    v_rcp_f32 v220, v220
    v_rcp_f32 v221, v221
    v_rcp_f32 v222, v222
    v_rcp_f32 v223, v223
    v_rcp_f32 v224, v224
    v_rcp_f32 v225, v225
    v_rcp_f32 v226, v226
    v_rcp_f32 v227, v227
    v_pk_mul_f32 v[220:221], v[220:221], v[148:149]
    v_pk_mul_f32 v[222:223], v[222:223], v[150:151]
    v_pk_mul_f32 v[224:225], v[224:225], v[152:153]
    v_pk_mul_f32 v[226:227], v[226:227], v[154:155]
    v_pk_fma_f32 v[220:221], v[220:221], s[40:41], v[84:85]
    v_pk_fma_f32 v[222:223], v[222:223], s[40:41], v[86:87]
    v_pk_fma_f32 v[224:225], v[224:225], s[40:41], v[88:89]
    v_pk_fma_f32 v[226:227], v[226:227], s[40:41], v[90:91]
    v_cvt_pk_bf16_f32 v176, v220, v221
    v_cvt_pk_bf16_f32 v177, v222, v223
    v_cvt_pk_bf16_f32 v178, v224, v225
    v_cvt_pk_bf16_f32 v179, v226, v227
    ds_write_b128 v252, v[176:179]
    v_exp_f32 v220, v156
    v_exp_f32 v221, v157
    v_exp_f32 v222, v158
    v_exp_f32 v223, v159
    v_exp_f32 v224, v160
    v_exp_f32 v225, v161
    v_exp_f32 v226, v162
    v_exp_f32 v227, v163
    v_pk_add_f32 v[220:221], v[220:221], 1.0 op_sel_hi:[1,0]
    v_pk_add_f32 v[222:223], v[222:223], 1.0 op_sel_hi:[1,0]
    v_pk_add_f32 v[224:225], v[224:225], 1.0 op_sel_hi:[1,0]
    v_pk_add_f32 v[226:227], v[226:227], 1.0 op_sel_hi:[1,0]
    v_rcp_f32 v220, v220
    v_rcp_f32 v221, v221
    v_rcp_f32 v222, v222
    v_rcp_f32 v223, v223
    v_rcp_f32 v224, v224
    v_rcp_f32 v225, v225
    v_rcp_f32 v226, v226
    v_rcp_f32 v227, v227
    v_pk_mul_f32 v[220:221], v[220:221], v[156:157]
    v_pk_mul_f32 v[222:223], v[222:223], v[158:159]
    v_pk_mul_f32 v[224:225], v[224:225], v[160:161]
    v_pk_mul_f32 v[226:227], v[226:227], v[162:163]
    v_pk_fma_f32 v[220:221], v[220:221], s[40:41], v[92:93]
    v_pk_fma_f32 v[222:223], v[222:223], s[40:41], v[94:95]
    v_pk_fma_f32 v[224:225], v[224:225], s[40:41], v[96:97]
    v_pk_fma_f32 v[226:227], v[226:227], s[40:41], v[98:99]
    v_cvt_pk_bf16_f32 v180, v220, v221
    v_cvt_pk_bf16_f32 v181, v222, v223
    v_cvt_pk_bf16_f32 v182, v224, v225
    v_cvt_pk_bf16_f32 v183, v226, v227
    ds_write_b128 v253, v[180:183]
    v_exp_f32 v220, v164
    v_exp_f32 v221, v165
    v_exp_f32 v222, v166
    v_exp_f32 v223, v167
    v_exp_f32 v224, v168
    v_exp_f32 v225, v169
    v_exp_f32 v226, v170
    v_exp_f32 v227, v171
    v_pk_add_f32 v[220:221], v[220:221], 1.0 op_sel_hi:[1,0]
    v_pk_add_f32 v[222:223], v[222:223], 1.0 op_sel_hi:[1,0]
    v_pk_add_f32 v[224:225], v[224:225], 1.0 op_sel_hi:[1,0]
    v_pk_add_f32 v[226:227], v[226:227], 1.0 op_sel_hi:[1,0]
    v_rcp_f32 v220, v220
    v_rcp_f32 v221, v221
    v_rcp_f32 v222, v222
    v_rcp_f32 v223, v223
    v_rcp_f32 v224, v224
    v_rcp_f32 v225, v225
    v_rcp_f32 v226, v226
    v_rcp_f32 v227, v227
    v_pk_mul_f32 v[220:221], v[220:221], v[164:165]
    v_pk_mul_f32 v[222:223], v[222:223], v[166:167]
    v_pk_mul_f32 v[224:225], v[224:225], v[168:169]
    v_pk_mul_f32 v[226:227], v[226:227], v[170:171]
    v_pk_fma_f32 v[220:221], v[220:221], s[40:41], v[100:101]
    v_pk_fma_f32 v[222:223], v[222:223], s[40:41], v[102:103]
    v_pk_fma_f32 v[224:225], v[224:225], s[40:41], v[104:105]
    v_pk_fma_f32 v[226:227], v[226:227], s[40:41], v[106:107]
    v_cvt_pk_bf16_f32 v184, v220, v221
    v_cvt_pk_bf16_f32 v185, v222, v223
    v_cvt_pk_bf16_f32 v186, v224, v225
    v_cvt_pk_bf16_f32 v187, v226, v227
    ds_write_b128 v254, v[184:187]
    ds_read_b128 v[140:143], v235 offset:0
    ds_read_b128 v[144:147], v235 offset:1024
    ds_read_b128 v[148:151], v235 offset:2048
    ds_read_b128 v[152:155], v235 offset:3072
    s_waitcnt lgkmcnt(3)
    buffer_store_dwordx4 v[140:143], v210, s[24:27], 0 offen sc1
    s_waitcnt lgkmcnt(2)
    buffer_store_dwordx4 v[144:147], v212, s[24:27], 0 offen sc1
    s_waitcnt lgkmcnt(1)
    buffer_store_dwordx4 v[148:151], v214, s[24:27], 0 offen sc1
    s_waitcnt lgkmcnt(0)
    buffer_store_dwordx4 v[152:155], v216, s[24:27], 0 offen sc1
    v_readfirstlane_b32 s95, v243
    v_and_b32 v220, 63, v250
    v_lshlrev_b32 v220, 3, v220
    s_cmp_lg_u32 s95, 7
    s_cbranch_scc1 K2_PE
    ds_read_b64 v[188:189], v220 offset:32768
    ds_read_b64 v[190:191], v220 offset:33280
    ds_read_b64 v[192:193], v220 offset:33792
    s_mul_i32 s99, s4, 6
    s_add_u32 s99, s99, 6400000
    s_mul_i32 s95, s96, 6
    v_cmp_gt_i32 vcc, s95, v220
    s_sub_i32 s95, s95, 512
    s_waitcnt lgkmcnt(2)
    s_mov_b64 exec, vcc
    buffer_store_dwordx2 v[188:189], v220, s[24:27], s99 offen offset:0 sc1
    v_cmp_gt_i32 vcc, s95, v220
    s_sub_i32 s95, s95, 512
    s_waitcnt lgkmcnt(1)
    s_mov_b64 exec, vcc
    buffer_store_dwordx2 v[190:191], v220, s[24:27], s99 offen offset:512 sc1
    v_cmp_gt_i32 vcc, s95, v220
    s_sub_i32 s95, s95, 512
    s_waitcnt lgkmcnt(0)
    s_mov_b64 exec, vcc
    buffer_store_dwordx2 v[192:193], v220, s[24:27], s99 offen offset:1024 sc1
    s_mov_b64 exec, -1
K2_PE:
    s_endpgm
K2_END0:
    s_waitcnt vmcnt(0)
K2_END:
    s_endpgm
.section .rodata,"a"
.p2align 6
.amdhsa_kernel egnn_sort_kernel
  .amdhsa_next_free_vgpr 56
  .amdhsa_next_free_sgpr 48
  .amdhsa_accum_offset 56
  .amdhsa_group_segment_fixed_size 0
  .amdhsa_kernarg_size 88
  .amdhsa_user_sgpr_count 2
  .amdhsa_user_sgpr_kernarg_segment_ptr 1
  .amdhsa_system_sgpr_workgroup_id_x 1
.end_amdhsa_kernel
.p2align 6
.amdhsa_kernel egnn_main_kernel
  .amdhsa_next_free_vgpr 256
  .amdhsa_next_free_sgpr 102
  .amdhsa_accum_offset 256
  .amdhsa_group_segment_fixed_size 0
  .amdhsa_kernarg_size 88
  .amdhsa_user_sgpr_count 2
  .amdhsa_user_sgpr_kernarg_segment_ptr 1
  .amdhsa_system_sgpr_workgroup_id_x 1
.end_amdhsa_kernel
```

```asm
; @launch kernel=egnn_sort_kernel grid=(250,1,1) block=(512,1,1) lds=27904
; @launch kernel=egnn_main_kernel grid=(256,1,1) block=(512,1,1) lds=162816
.amdgcn_target "amdgcn-amd-amdhsa--gfx950"
.text
.globl egnn_sort_kernel
.p2align 8
.type egnn_sort_kernel,@function
egnn_sort_kernel:
    s_cmp_ge_u32 s2, 250
    s_cbranch_scc1 K1_END
    s_load_dwordx2 s[38:39], s[0:1], 80
    v_lshrrev_b32 v1, 6, v0
    s_nop 0
    v_readfirstlane_b32 s3, v1
    s_cmp_ge_u32 s3, 7
    s_cbranch_scc1 K1_FRAG
    s_load_dwordx4 s[4:7], s[0:1], 24
    s_load_dwordx4 s[8:11], s[0:1], 8
    s_and_b32 s28, s2, 7
    s_min_u32 s29, s28, 2
    s_mul_i32 s28, s28, 31
    s_lshr_b32 s2, s2, 3
    s_add_u32 s2, s2, s28
    s_add_u32 s2, s2, s29
    v_lshlrev_b32 v1, 2, v0
    v_mov_b32 v2, 0
    v_mov_b32 v3, 1
    v_cmp_gt_u32 vcc, 288, v0
    s_mov_b64 exec, vcc
    ds_write_b32 v1, v2 offset:0
    s_mov_b64 exec, -1
    s_mul_i32 s28, s2, 12800
    s_add_u32 s42, s28, 6400
    s_mul_i32 s29, s2, 200
    s_mul_i32 s30, s2, 3200
    s_mov_b32 s31, 85599
    s_movk_i32 s32, -196
    v_add_u32 v12, s29, v0
    v_mul_u32_u24 v13, 6, v12
    v_lshlrev_b32 v14, 4, v0
    v_mov_b32 v15, 400
    v_cmp_gt_u32 s[34:35], v15, v0
    v_mov_b32 v15, 200
    v_cmp_gt_u32 s[36:37], v15, v0
    s_waitcnt lgkmcnt(0)
    s_mov_b32 s12, s4
    s_and_b32 s13, s5, 0xffff
    s_mov_b32 s14, 3200000
    s_mov_b32 s15, 0x20000
    s_mov_b32 s16, s6
    s_and_b32 s17, s7, 0xffff
    s_mov_b32 s18, 3200000
    s_mov_b32 s19, 0x20000
    s_mov_b32 s20, s8
    s_and_b32 s21, s9, 0xffff
    s_mov_b32 s22, 300000
    s_mov_b32 s23, 0x20000
    s_mov_b32 s24, s38
    s_and_b32 s25, s39, 0xffff
    s_mov_b32 s26, 25600000
    s_mov_b32 s27, 0x20000
    s_cmp_ge_u32 s3, 4
    s_cbranch_scc1 K1_NOPOS
    s_mov_b64 exec, s[36:37]
    buffer_load_ushort v16, v13, s[20:23], 0 offen
    buffer_load_ushort v17, v13, s[20:23], 0 offen offset:2
    buffer_load_ushort v18, v13, s[20:23], 0 offen offset:4
K1_NOPOS:
    s_mov_b64 exec, s[34:35]
    buffer_load_dwordx4 v[60:63], v14, s[16:19], s28 offen nt
    buffer_load_dwordx4 v[64:67], v14, s[16:19], s42 offen nt
    v_add_u32 v76, s30, v1
    v_add_u32 v78, 1, v76
    v_add_u32 v80, 2, v76
    v_add_u32 v82, 3, v76
    v_add_u32 v84, 1600, v76
    v_add_u32 v86, 1601, v76
    v_add_u32 v88, 1602, v76
    v_add_u32 v90, 1603, v76
    s_barrier
    s_waitcnt vmcnt(0)
    buffer_load_dwordx4 v[68:71], v14, s[12:15], s28 offen nt
    buffer_load_dwordx4 v[72:75], v14, s[12:15], s42 offen nt
    v_mul_u32_u24 v92, s31, v60
    v_lshrrev_b32 v92, 24, v92
    v_mad_i32_i24 v60, v92, s32, v60
    v_lshlrev_b32 v92, 2, v92
    ds_add_rtn_u32 v100, v92, v3 offset:0
    v_lshrrev_b32 v108, 7, v92
    v_mul_u32_u24 v93, s31, v61
    v_lshrrev_b32 v93, 24, v93
    v_mad_i32_i24 v61, v93, s32, v61
    v_lshlrev_b32 v93, 2, v93
    ds_add_rtn_u32 v101, v93, v3 offset:0
    v_lshrrev_b32 v109, 7, v93
    v_mul_u32_u24 v94, s31, v62
    v_lshrrev_b32 v94, 24, v94
    v_mad_i32_i24 v62, v94, s32, v62
    v_lshlrev_b32 v94, 2, v94
    ds_add_rtn_u32 v102, v94, v3 offset:0
    v_lshrrev_b32 v110, 7, v94
    v_mul_u32_u24 v95, s31, v63
    v_lshrrev_b32 v95, 24, v95
    v_mad_i32_i24 v63, v95, s32, v63
    v_lshlrev_b32 v95, 2, v95
    ds_add_rtn_u32 v103, v95, v3 offset:0
    v_lshrrev_b32 v111, 7, v95
    v_mul_u32_u24 v96, s31, v64
    v_lshrrev_b32 v96, 24, v96
    v_mad_i32_i24 v64, v96, s32, v64
    v_lshlrev_b32 v96, 2, v96
    ds_add_rtn_u32 v104, v96, v3 offset:0
    v_lshrrev_b32 v112, 7, v96
    v_mul_u32_u24 v97, s31, v65
    v_lshrrev_b32 v97, 24, v97
    v_mad_i32_i24 v65, v97, s32, v65
    v_lshlrev_b32 v97, 2, v97
    ds_add_rtn_u32 v105, v97, v3 offset:0
    v_lshrrev_b32 v113, 7, v97
    v_mul_u32_u24 v98, s31, v66
    v_lshrrev_b32 v98, 24, v98
    v_mad_i32_i24 v66, v98, s32, v66
    v_lshlrev_b32 v98, 2, v98
    ds_add_rtn_u32 v106, v98, v3 offset:0
    v_lshrrev_b32 v114, 7, v98
    v_mul_u32_u24 v99, s31, v67
    v_lshrrev_b32 v99, 24, v99
    v_mad_i32_i24 v67, v99, s32, v67
    v_lshlrev_b32 v99, 2, v99
    ds_add_rtn_u32 v107, v99, v3 offset:0
    v_lshrrev_b32 v115, 7, v99
    s_cmp_ge_u32 s3, 4
    s_cbranch_scc1 K1_P3
    s_mov_b64 exec, s[36:37]
    v_lshl_or_b32 v16, v17, 16, v16
    v_lshlrev_b32 v17, 16, v18
    v_lshlrev_b32 v12, 3, v12
    s_mov_b32 s33, 6684672
    buffer_store_dwordx2 v[16:17], v12, s[24:27], s33 offen
K1_P3:
    s_mov_b64 exec, -1
    v_and_b32 v2, 63, v0
    v_lshlrev_b32 v2, 4, v2
    s_waitcnt lgkmcnt(0)
    s_barrier
    ds_read_b128 v[36:39], v2 offset:0
    s_waitcnt lgkmcnt(0)
    v_add_u32 v42, v36, v37
    v_add_u32 v43, v42, v38
    v_add_u32 v44, v43, v39
    v_mov_b32 v45, v44
    s_nop 1
    v_add_u32_dpp v45, v45, v45 row_shr:1 row_mask:0xf bank_mask:0xf
    s_nop 1
    v_add_u32_dpp v45, v45, v45 row_shr:2 row_mask:0xf bank_mask:0xf
    s_nop 1
    v_add_u32_dpp v45, v45, v45 row_shr:4 row_mask:0xf bank_mask:0xf
    s_nop 1
    v_add_u32_dpp v45, v45, v45 row_shr:8 row_mask:0xf bank_mask:0xf
    s_nop 1
    v_add_u32_dpp v45, v45, v45 row_bcast:15 row_mask:0xa bank_mask:0xf
    s_nop 1
    v_add_u32_dpp v45, v45, v45 row_bcast:31 row_mask:0xc bank_mask:0xf
    v_sub_u32 v40, v45, v44
    v_add_u32 v41, v40, v36
    v_add_u32 v42, v40, v42
    v_add_u32 v43, v40, v43
    v_lshlrev_b32 v48, 3, v40
    v_lshlrev_b32 v49, 3, v41
    v_lshlrev_b32 v50, 3, v42
    v_lshlrev_b32 v51, 3, v43
    ds_write_b128 v2, v[48:51] offset:1280
    s_mov_b64 exec, s[34:35]
    ds_read_b32 v92, v92 offset:1280
    ds_read_b32 v93, v93 offset:1280
    ds_read_b32 v94, v94 offset:1280
    ds_read_b32 v95, v95 offset:1280
    ds_read_b32 v96, v96 offset:1280
    ds_read_b32 v97, v97 offset:1280
    ds_read_b32 v98, v98 offset:1280
    ds_read_b32 v99, v99 offset:1280
    s_cmp_ge_u32 s3, 4
    s_cbranch_scc1 K1_SW0
    s_waitcnt vmcnt(1)
    s_branch K1_SW1
K1_SW0:
    s_waitcnt vmcnt(0)
K1_SW1:
    v_mul_u32_u24 v77, 2675, v68
    v_lshrrev_b32 v77, 24, v77
    v_sub_u32 v77, v77, v108
    v_and_b32 v77, 7, v77
    v_lshl_or_b32 v60, v60, 3, v77
    v_lshl_or_b32 v77, v60, 18, v68
    v_mul_u32_u24 v79, 2675, v69
    v_lshrrev_b32 v79, 24, v79
    v_sub_u32 v79, v79, v109
    v_and_b32 v79, 7, v79
    v_lshl_or_b32 v61, v61, 3, v79
    v_lshl_or_b32 v79, v61, 18, v69
    v_mul_u32_u24 v81, 2675, v70
    v_lshrrev_b32 v81, 24, v81
    v_sub_u32 v81, v81, v110
    v_and_b32 v81, 7, v81
    v_lshl_or_b32 v62, v62, 3, v81
    v_lshl_or_b32 v81, v62, 18, v70
    v_mul_u32_u24 v83, 2675, v71
    v_lshrrev_b32 v83, 24, v83
    v_sub_u32 v83, v83, v111
    v_and_b32 v83, 7, v83
    v_lshl_or_b32 v63, v63, 3, v83
    v_lshl_or_b32 v83, v63, 18, v71
    v_mul_u32_u24 v85, 2675, v72
    v_lshrrev_b32 v85, 24, v85
    v_sub_u32 v85, v85, v112
    v_and_b32 v85, 7, v85
    v_lshl_or_b32 v64, v64, 3, v85
    v_lshl_or_b32 v85, v64, 18, v72
    v_mul_u32_u24 v87, 2675, v73
    v_lshrrev_b32 v87, 24, v87
    v_sub_u32 v87, v87, v113
    v_and_b32 v87, 7, v87
    v_lshl_or_b32 v65, v65, 3, v87
    v_lshl_or_b32 v87, v65, 18, v73
    v_mul_u32_u24 v89, 2675, v74
    v_lshrrev_b32 v89, 24, v89
    v_sub_u32 v89, v89, v114
    v_and_b32 v89, 7, v89
    v_lshl_or_b32 v66, v66, 3, v89
    v_lshl_or_b32 v89, v66, 18, v74
    v_mul_u32_u24 v91, 2675, v75
    v_lshrrev_b32 v91, 24, v91
    v_sub_u32 v91, v91, v115
    v_and_b32 v91, 7, v91
    v_lshl_or_b32 v67, v67, 3, v91
    v_lshl_or_b32 v91, v67, 18, v75
    s_cmp_lg_u32 s3, 6
    s_cbranch_scc1 K1_NOOFF
    s_mov_b64 exec, -1
    v_lshl_or_b32 v40, v36, 16, v40
    v_lshl_or_b32 v41, v37, 16, v41
    v_lshl_or_b32 v42, v38, 16, v42
    v_lshl_or_b32 v43, v39, 16, v43
    v_lshlrev_b32 v2, 8, v2
    s_lshl_b32 s33, s2, 4
    s_add_u32 s33, s33, 6422528
    buffer_store_dwordx4 v[40:43], v2, s[24:27], s33 offen
    s_mov_b64 exec, s[34:35]
K1_NOOFF:
    s_waitcnt lgkmcnt(7)
    v_lshl_add_u32 v92, v100, 3, v92
    ds_write_b64 v92, v[76:77] offset:2304
    s_waitcnt lgkmcnt(7)
    v_lshl_add_u32 v93, v101, 3, v93
    ds_write_b64 v93, v[78:79] offset:2304
    s_waitcnt lgkmcnt(7)
    v_lshl_add_u32 v94, v102, 3, v94
    ds_write_b64 v94, v[80:81] offset:2304
    s_waitcnt lgkmcnt(7)
    v_lshl_add_u32 v95, v103, 3, v95
    ds_write_b64 v95, v[82:83] offset:2304
    s_waitcnt lgkmcnt(7)
    v_lshl_add_u32 v96, v104, 3, v96
    ds_write_b64 v96, v[84:85] offset:2304
    s_waitcnt lgkmcnt(7)
    v_lshl_add_u32 v97, v105, 3, v97
    ds_write_b64 v97, v[86:87] offset:2304
    s_waitcnt lgkmcnt(7)
    v_lshl_add_u32 v98, v106, 3, v98
    ds_write_b64 v98, v[88:89] offset:2304
    s_waitcnt lgkmcnt(7)
    v_lshl_add_u32 v99, v107, 3, v99
    ds_write_b64 v99, v[90:91] offset:2304
    s_mul_i32 s33, s2, 25600
    s_waitcnt lgkmcnt(0)
    s_barrier
    ds_read_b128 v[60:63], v14 offset:2304
    ds_read_b128 v[64:67], v14 offset:8704
    ds_read_b128 v[68:71], v14 offset:15104
    ds_read_b128 v[72:75], v14 offset:21504
    s_waitcnt lgkmcnt(3)
    buffer_store_dwordx4 v[60:63], v14, s[24:27], s33 offen sc1
    s_add_u32 s33, s33, 6400
    s_waitcnt lgkmcnt(2)
    buffer_store_dwordx4 v[64:67], v14, s[24:27], s33 offen sc1
    s_add_u32 s33, s33, 6400
    s_waitcnt lgkmcnt(1)
    buffer_store_dwordx4 v[68:71], v14, s[24:27], s33 offen sc1
    s_add_u32 s33, s33, 6400
    s_waitcnt lgkmcnt(0)
    buffer_store_dwordx4 v[72:75], v14, s[24:27], s33 offen sc1
    s_endpgm
K1_FRAG:
    s_cmp_ge_u32 s2, 144
    s_cbranch_scc1 K1_END
    s_load_dwordx4 s[4:7], s[0:1], 40
    s_load_dwordx2 s[8:9], s[0:1], 56
    s_lshr_b32 s28, s2, 2
    s_and_b32 s3, s2, 3
    s_lshl_b32 s3, s3, 6
    v_and_b32 v1, 63, v0
    v_add_u32 v1, s3, v1
    v_lshlrev_b32 v10, 2, v1
    s_lshl_b32 s33, s28, 10
    s_add_u32 s33, s33, 7536640
    s_mov_b32 s34, 0xbfb8aa3b
    s_waitcnt lgkmcnt(0)
    s_mov_b32 s12, s4
    s_and_b32 s13, s5, 0xffff
    s_mov_b32 s14, 18560
    s_mov_b32 s15, 0x20000
    s_mov_b32 s16, s6
    s_and_b32 s17, s7, 0xffff
    s_mov_b32 s18, 128
    s_mov_b32 s19, 0x20000
    s_mov_b32 s20, s8
    s_and_b32 s21, s9, 0xffff
    s_mov_b32 s22, 16384
    s_mov_b32 s23, 0x20000
    s_mov_b32 s24, s38
    s_and_b32 s25, s39, 0xffff
    s_mov_b32 s26, 25427968
    s_mov_b32 s27, 0x20000
    s_cmp_eq_u32 s28, 19
    s_cbranch_scc1 K1_WX
    s_cmp_eq_u32 s28, 18
    s_cbranch_scc1 K1_W3
    v_lshrrev_b32 v2, 2, v1
    v_and_b32 v3, 4, v2
    v_lshlrev_b32 v3, 3, v3
    v_bfe_u32 v4, v2, 3, 2
    v_lshl_add_u32 v3, v4, 2, v3
    v_and_b32 v4, 3, v2
    v_add_u32 v3, v3, v4
    v_lshrrev_b32 v5, 7, v1
    v_and_b32 v6, 3, v1
    s_mov_b32 s35, 32
    s_cmp_ge_u32 s28, 18
    s_cbranch_scc1 K1_FH
    s_cmp_ge_u32 s28, 16
    s_cbranch_scc1 K1_F4
    s_mov_b32 s36, s28
    s_branch K1_FC
K1_FH:
    s_sub_u32 s36, s28, 20
    s_mov_b32 s12, s20
    s_mov_b32 s13, s21
    s_mov_b32 s14, s22
    s_cmp_ge_u32 s36, 8
    s_cselect_b32 s34, 1.0, s34
K1_FC:
    s_lshr_b32 s37, s36, 3
    s_lshl_b32 s37, s37, 6
    s_and_b32 s38, s36, 3
    s_lshl_b32 s38, s38, 3
    s_add_u32 s37, s37, s38
    s_bfe_u32 s38, s36, 0x10002
    s_branch K1_FD
K1_F4:
    s_mov_b32 s35, 8
    s_movk_i32 s37, 129
    s_sub_u32 s38, s28, 16
K1_FD:
    s_lshl_b32 s38, s38, 4
    v_mul_u32_u24 v5, s35, v5
    v_lshl_add_u32 v5, v6, 1, v5
    v_add_u32 v5, s37, v5
    v_add_u32 v3, s38, v3
    v_lshlrev_b32 v3, 1, v3
    v_lshl_add_u32 v3, v5, 7, v3
    buffer_load_ushort v7, v3, s[12:15], 0 offen
    buffer_load_ushort v8, v3, s[12:15], 0 offen offset:128
    s_waitcnt vmcnt(0)
    v_lshlrev_b32 v7, 16, v7
    v_lshlrev_b32 v8, 16, v8
    v_mul_f32 v7, s34, v7
    v_mul_f32 v8, s34, v8
    v_cvt_pk_bf16_f32 v7, v7, v8
    buffer_store_dword v7, v10, s[24:27], s33 offen
    s_endpgm
K1_W3:
    v_and_b32 v2, 31, v1
    v_and_b32 v3, 4, v2
    v_lshlrev_b32 v3, 3, v3
    v_bfe_u32 v4, v2, 3, 2
    v_lshl_add_u32 v3, v4, 2, v3
    v_and_b32 v4, 3, v2
    v_add_u32 v3, v3, v4
    v_bfe_u32 v5, v1, 6, 1
    v_lshl_add_u32 v3, v5, 4, v3
    v_lshlrev_b32 v3, 1, v3
    s_movk_i32 s35, 16384
    buffer_load_ushort v7, v3, s[12:15], s35 offen
    v_and_b32 v6, 32, v1
    v_cmp_eq_u32 vcc, 0, v6
    s_waitcnt vmcnt(0)
    v_lshlrev_b32 v7, 16, v7
    v_mul_f32 v7, s34, v7
    v_cvt_pk_bf16_f32 v8, v7, v7
    v_lshlrev_b32 v8, 16, v8
    v_sub_f32 v9, v7, v8
    v_cvt_pk_bf16_f32 v7, v8, v9
    v_cndmask_b32 v7, 0, v7, vcc
    buffer_store_dword v7, v10, s[24:27], s33 offen
    s_endpgm
K1_WX:
    v_lshlrev_b32 v3, 1, v1
    buffer_load_ushort v7, v3, s[16:19], 0 offen
    s_waitcnt vmcnt(0)
    v_lshlrev_b32 v7, 16, v7
    v_mul_f32 v7, 0xbf317218, v7
    buffer_store_dword v7, v10, s[24:27], s33 offen
K1_END:
    s_endpgm
.globl egnn_main_kernel
.p2align 8
.type egnn_main_kernel,@function
egnn_main_kernel:
    s_cmp_ge_u32 s2, 256
    s_cbranch_scc1 K2_END
    s_load_dwordx2 s[28:29], s[0:1], 0
    s_load_dwordx2 s[30:31], s[0:1], 16
    s_load_dwordx2 s[32:33], s[0:1], 64
    s_load_dwordx2 s[34:35], s[0:1], 80
    v_mov_b32 v250, v0
    v_lshrrev_b32 v220, 6, v0
    s_and_b32 s3, s2, 7
    s_lshl_b32 s3, s3, 5
    v_readfirstlane_b32 s5, v220
    s_lshr_b32 s95, s2, 3
    s_add_u32 s3, s3, s95
    s_mul_i32 s4, s3, 196
    s_sub_u32 s96, 50000, s4
    s_min_u32 s96, s96, 196
    s_mov_b32 s7, 0
    s_mov_b32 s92, 48
    s_sub_u32 s100, 11, s5
    s_cmp_lt_u32 s5, 4
    s_cselect_b32 s100, s5, s100
    s_lshl_b32 s94, s100, 12
    s_add_u32 s94, s94, 34816
    s_waitcnt lgkmcnt(0)
    s_add_u32 s88, s34, 6422528
    s_addc_u32 s89, s35, 0
    s_and_b32 s89, s89, 0xffff
    s_mov_b32 s90, 262144
    s_mov_b32 s91, 0x20000
    s_mov_b32 s8, s28
    s_and_b32 s9, s29, 0xffff
    s_or_b32 s9, s9, 8388608
    s_mov_b32 s10, 50000
    s_mov_b32 s11, 0x20000
    s_mov_b32 s12, s30
    s_and_b32 s13, s31, 0xffff
    s_or_b32 s13, s13, 2097152
    s_mov_b32 s14, 800000
    s_mov_b32 s15, 0x20000
    s_add_u32 s16, s34, 6684672
    s_addc_u32 s17, s35, 0
    s_and_b32 s17, s17, 0xffff
    s_or_b32 s17, s17, 524288
    s_mov_b32 s18, 50000
    s_mov_b32 s19, 0x20000
    s_mov_b32 s20, s34
    s_and_b32 s21, s35, 0xffff
    s_mov_b32 s22, 25427968
    s_mov_b32 s23, 0x20000
    s_mov_b32 s24, s32
    s_and_b32 s25, s33, 0xffff
    s_mov_b32 s26, 6700000
    s_mov_b32 s27, 0x20000
K2_TOP:
    v_bfe_u32 v220, v250, 4, 2
    s_mul_i32 s95, s5, 36
    s_sub_u32 s95, s95, 36
    v_mad_u32_u24 v220, v220, 9, s95
    v_lshlrev_b32 v221, 4, v220
    s_and_b32 s95, s3, 3
    s_mul_i32 s95, s95, 1020
    s_lshl_b32 s99, s3, 10
    s_sub_u32 s95, s99, s95
    s_cmp_eq_u32 s5, 0
    s_cbranch_scc1 K2_NOOF
    buffer_load_dword v172, v221, s[88:91], s95 offen offset:0
    buffer_load_dword v173, v221, s[88:91], s95 offen offset:16
    buffer_load_dword v174, v221, s[88:91], s95 offen offset:32
    buffer_load_dword v175, v221, s[88:91], s95 offen offset:48
    buffer_load_dword v176, v221, s[88:91], s95 offen offset:64
    buffer_load_dword v177, v221, s[88:91], s95 offen offset:80
    buffer_load_dword v178, v221, s[88:91], s95 offen offset:96
    buffer_load_dword v179, v221, s[88:91], s95 offen offset:112
    buffer_load_dword v180, v221, s[88:91], s95 offen offset:128
K2_NOOF:
    v_and_b32 v222, 63, v250
    v_lshlrev_b32 v203, 4, v222
    v_lshrrev_b32 v239, 3, v222
    v_lshrrev_b32 v223, 4, v222
    v_xor_b32 v223, v223, v222
    v_and_b32 v223, 7, v223
    v_lshlrev_b32 v211, 4, v223
    v_xor_b32 v213, 64, v211
    v_mov_b32 v215, v211
    v_mov_b32 v217, v213
    s_lshl_b32 s95, s5, 5
    s_add_u32 s95, s95, s4
    v_add_u32 v210, s95, v239
    v_add_u32 v212, 8, v210
    v_add_u32 v214, 16, v210
    v_add_u32 v216, 24, v210
    s_add_u32 s99, s4, s96
    v_cmp_gt_u32 vcc, s99, v210
    s_nop 1
    v_cndmask_b32 v210, -1, v210, vcc
    v_cmp_gt_u32 vcc, s99, v212
    s_nop 1
    v_cndmask_b32 v212, -1, v212, vcc
    v_cmp_gt_u32 vcc, s99, v214
    s_nop 1
    v_cndmask_b32 v214, -1, v214, vcc
    v_cmp_gt_u32 vcc, s99, v216
    s_nop 1
    v_cndmask_b32 v216, -1, v216, vcc
    s_lshl_b32 s101, s5, 12
    s_add_u32 s101, s101, 100352
    s_barrier
    s_mul_i32 s95, s5, 3072
    s_add_u32 m0, s95, 138240
    s_add_u32 s95, s95, 7536640
    buffer_load_dwordx4 v203, s[20:23], s95 offen offset:0 lds
    buffer_load_dwordx4 v203, s[20:23], s95 offen offset:1024 lds
    buffer_load_dwordx4 v203, s[20:23], s95 offen offset:2048 lds
    v_mov_b32 v228, 0
    v_mov_b32 v229, 0
    v_mov_b32 v230, 0
    v_mov_b32 v231, 0
    s_lshl_b32 s95, s5, 10
    s_cmp_ge_u32 s5, 4
    s_cselect_b32 s99, 30720, 0
    s_add_u32 s95, s95, s99
    v_add_u32 v223, s95, v203
    ds_write_b128 v223, v[228:231]
    ds_write_b128 v223, v[228:231] offset:4096
    v_and_b32 v223, 2047, v223
    ds_write_b128 v223, v[228:231] offset:43008
    v_lshlrev_b32 v239, 2, v239
    v_mov_b32 v41, 0
    v_mov_b32 v43, 0
    v_mov_b32 v209, 0
    v_lshrrev_b32 v219, 5, v222
    v_lshlrev_b32 v219, 4, v219
    v_and_b32 v223, 31, v222
    v_bfe_u32 v251, v222, 1, 3
    v_lshlrev_b32 v251, 4, v251
    v_lshlrev_b32 v252, 2, v219
    v_xor_b32 v251, v251, v252
    v_lshl_add_u32 v251, v223, 7, v251
    v_add_u32 v251, s94, v251
    v_xor_b32 v252, 16, v251
    v_xor_b32 v253, 32, v251
    v_xor_b32 v254, 48, v251
    v_and_b32 v222, 15, v250
    v_cmp_gt_u32 vcc, 243, v220
    v_mul_u32_u24 v220, 3200, v220
    v_add3_u32 v220, v220, v222, s7
    v_add_u32 v221, 16, v222
    v_add_u32 v223, 32, v222
    v_cmp_gt_u32_e64 s[32:33], s92, v221
    v_cmp_gt_u32_e64 s[34:35], s92, v222
    s_nop 0
    v_cndmask_b32_e64 v221, 2.0, v221, s[32:33]
    v_cndmask_b32_e64 v223, 2.0, v223, s[32:33]
    v_cndmask_b32_e64 v222, 2.0, v222, s[34:35]
    s_cmp_eq_u32 s5, 0
    s_waitcnt vmcnt(3)
    s_cbranch_scc0 K2_MK
    s_branch K2_NOREC
K2_MK:
    v_cndmask_b32 v179, 0, v179, vcc
    v_cndmask_b32 v180, 0, v180, vcc
    v_and_b32 v98, 0xffff, v172
    v_lshrrev_b32 v172, 16, v172
    v_subrev_u32 v172, s7, v172
    v_cmp_gt_i32_e64 s[32:33], v172, v222
    v_add_lshl_u32 v98, v98, v220, 3
    s_mov_b32 s95, 0
    v_cndmask_b32_e64 v98, 2.0, v98, s[32:33]
    buffer_load_dwordx2 v[44:45], v98, s[20:23], s95 offen
    v_and_b32 v99, 0xffff, v173
    v_lshrrev_b32 v173, 16, v173
    v_subrev_u32 v173, s7, v173
    v_cmp_gt_i32_e64 s[34:35], v173, v222
    v_add_lshl_u32 v99, v99, v220, 3
    s_mov_b32 s95, 25600
    v_cndmask_b32_e64 v99, 2.0, v99, s[34:35]
    buffer_load_dwordx2 v[46:47], v99, s[20:23], s95 offen
    v_and_b32 v100, 0xffff, v174
    v_lshrrev_b32 v174, 16, v174
    v_subrev_u32 v174, s7, v174
    v_cmp_gt_i32_e64 s[36:37], v174, v222
    v_add_lshl_u32 v100, v100, v220, 3
    s_mov_b32 s95, 51200
    v_cndmask_b32_e64 v100, 2.0, v100, s[36:37]
    buffer_load_dwordx2 v[48:49], v100, s[20:23], s95 offen
    v_and_b32 v101, 0xffff, v175
    v_lshrrev_b32 v175, 16, v175
    v_subrev_u32 v175, s7, v175
    v_cmp_gt_i32_e64 s[38:39], v175, v222
    v_add_lshl_u32 v101, v101, v220, 3
    s_mov_b32 s95, 76800
    v_cndmask_b32_e64 v101, 2.0, v101, s[38:39]
    buffer_load_dwordx2 v[50:51], v101, s[20:23], s95 offen
    v_and_b32 v102, 0xffff, v176
    v_lshrrev_b32 v176, 16, v176
    v_subrev_u32 v176, s7, v176
    v_cmp_gt_i32_e64 s[40:41], v176, v222
    v_add_lshl_u32 v102, v102, v220, 3
    s_mov_b32 s95, 102400
    v_cndmask_b32_e64 v102, 2.0, v102, s[40:41]
    buffer_load_dwordx2 v[52:53], v102, s[20:23], s95 offen
    v_and_b32 v103, 0xffff, v177
    v_lshrrev_b32 v177, 16, v177
    v_subrev_u32 v177, s7, v177
    v_cmp_gt_i32_e64 s[42:43], v177, v222
    v_add_lshl_u32 v103, v103, v220, 3
    s_mov_b32 s95, 128000
    v_cndmask_b32_e64 v103, 2.0, v103, s[42:43]
    buffer_load_dwordx2 v[54:55], v103, s[20:23], s95 offen
    v_and_b32 v104, 0xffff, v178
    v_lshrrev_b32 v178, 16, v178
    v_subrev_u32 v178, s7, v178
    v_cmp_gt_i32_e64 s[44:45], v178, v222
    v_add_lshl_u32 v104, v104, v220, 3
    s_mov_b32 s95, 153600
    v_cndmask_b32_e64 v104, 2.0, v104, s[44:45]
    buffer_load_dwordx2 v[56:57], v104, s[20:23], s95 offen
    v_and_b32 v105, 0xffff, v179
    v_lshrrev_b32 v179, 16, v179
    v_subrev_u32 v179, s7, v179
    v_cmp_gt_i32_e64 s[46:47], v179, v222
    v_add_lshl_u32 v105, v105, v220, 3
    s_mov_b32 s95, 179200
    v_cndmask_b32_e64 v105, 2.0, v105, s[46:47]
    buffer_load_dwordx2 v[58:59], v105, s[20:23], s95 offen
    v_and_b32 v106, 0xffff, v180
    v_lshrrev_b32 v180, 16, v180
    v_subrev_u32 v180, s7, v180
    v_cmp_gt_i32_e64 s[48:49], v180, v222
    v_add_lshl_u32 v106, v106, v220, 3
    s_mov_b32 s95, 204800
    v_cndmask_b32_e64 v106, 2.0, v106, s[48:49]
    buffer_load_dwordx2 v[60:61], v106, s[20:23], s95 offen
    v_cmp_gt_i32_e64 s[50:51], v172, v221
    v_cmp_gt_i32_e64 s[68:69], v172, v223
    v_cmp_gt_i32_e64 s[52:53], v173, v221
    v_cmp_gt_i32_e64 s[70:71], v173, v223
    v_cmp_gt_i32_e64 s[54:55], v174, v221
    v_cmp_gt_i32_e64 s[72:73], v174, v223
    v_cmp_gt_i32_e64 s[56:57], v175, v221
    v_cmp_gt_i32_e64 s[74:75], v175, v223
    v_cmp_gt_i32_e64 s[58:59], v176, v221
    v_cmp_gt_i32_e64 s[76:77], v176, v223
    v_cmp_gt_i32_e64 s[60:61], v177, v221
    v_cmp_gt_i32_e64 s[78:79], v177, v223
    v_cmp_gt_i32_e64 s[62:63], v178, v221
    v_cmp_gt_i32_e64 s[80:81], v178, v223
    v_cmp_gt_i32_e64 s[64:65], v179, v221
    v_cmp_gt_i32_e64 s[82:83], v179, v223
    v_cmp_gt_i32_e64 s[66:67], v180, v221
    v_cmp_gt_i32_e64 s[84:85], v180, v223
    s_mov_b32 s95, 0
    s_mov_b64 exec, s[50:51]
    s_cbranch_execz K2_G1
    buffer_load_dwordx2 v[62:63], v98, s[20:23], s95 offen offset:128
K2_G1:
    s_mov_b32 s95, 25600
    s_mov_b64 exec, s[52:53]
    s_cbranch_execz K2_G2
    buffer_load_dwordx2 v[64:65], v99, s[20:23], s95 offen offset:128
K2_G2:
    s_mov_b32 s95, 51200
    s_mov_b64 exec, s[54:55]
    s_cbranch_execz K2_G3
    buffer_load_dwordx2 v[66:67], v100, s[20:23], s95 offen offset:128
K2_G3:
    s_mov_b32 s95, 76800
    s_mov_b64 exec, s[56:57]
    s_cbranch_execz K2_G4
    buffer_load_dwordx2 v[68:69], v101, s[20:23], s95 offen offset:128
K2_G4:
    s_mov_b32 s95, 102400
    s_mov_b64 exec, s[58:59]
    s_cbranch_execz K2_G5
    buffer_load_dwordx2 v[70:71], v102, s[20:23], s95 offen offset:128
K2_G5:
    s_mov_b32 s95, 128000
    s_mov_b64 exec, s[60:61]
    s_cbranch_execz K2_G6
    buffer_load_dwordx2 v[72:73], v103, s[20:23], s95 offen offset:128
K2_G6:
    s_mov_b32 s95, 153600
    s_mov_b64 exec, s[62:63]
    s_cbranch_execz K2_G7
    buffer_load_dwordx2 v[74:75], v104, s[20:23], s95 offen offset:128
K2_G7:
    s_mov_b32 s95, 179200
    s_mov_b64 exec, s[64:65]
    s_cbranch_execz K2_G8
    buffer_load_dwordx2 v[76:77], v105, s[20:23], s95 offen offset:128
K2_G8:
    s_mov_b32 s95, 204800
    s_mov_b64 exec, s[66:67]
    s_cbranch_execz K2_G9
    buffer_load_dwordx2 v[78:79], v106, s[20:23], s95 offen offset:128
K2_G9:
    s_or_b64 vcc, s[68:69], s[70:71]
    s_or_b64 vcc, vcc, s[72:73]
    s_or_b64 vcc, vcc, s[74:75]
    s_or_b64 vcc, vcc, s[76:77]
    s_or_b64 vcc, vcc, s[78:79]
    s_or_b64 vcc, vcc, s[80:81]
    s_or_b64 vcc, vcc, s[82:83]
    s_or_b64 vcc, vcc, s[84:85]
    s_cselect_b32 s97, 1, 0
    s_cbranch_scc0 K2_NP2A
    s_mov_b32 s95, 0
    s_mov_b64 exec, s[68:69]
    s_cbranch_execz K2_G10
    buffer_load_dwordx2 v[80:81], v98, s[20:23], s95 offen offset:256
K2_G10:
    s_mov_b32 s95, 25600
    s_mov_b64 exec, s[70:71]
    s_cbranch_execz K2_G11
    buffer_load_dwordx2 v[82:83], v99, s[20:23], s95 offen offset:256
K2_G11:
    s_mov_b32 s95, 51200
    s_mov_b64 exec, s[72:73]
    s_cbranch_execz K2_G12
    buffer_load_dwordx2 v[84:85], v100, s[20:23], s95 offen offset:256
K2_G12:
    s_mov_b32 s95, 76800
    s_mov_b64 exec, s[74:75]
    s_cbranch_execz K2_G13
    buffer_load_dwordx2 v[86:87], v101, s[20:23], s95 offen offset:256
K2_G13:
    s_mov_b32 s95, 102400
    s_mov_b64 exec, s[76:77]
    s_cbranch_execz K2_G14
    buffer_load_dwordx2 v[88:89], v102, s[20:23], s95 offen offset:256
K2_G14:
    s_mov_b32 s95, 128000
    s_mov_b64 exec, s[78:79]
    s_cbranch_execz K2_G15
    buffer_load_dwordx2 v[90:91], v103, s[20:23], s95 offen offset:256
K2_G15:
    s_mov_b32 s95, 153600
    s_mov_b64 exec, s[80:81]
    s_cbranch_execz K2_G16
    buffer_load_dwordx2 v[92:93], v104, s[20:23], s95 offen offset:256
K2_G16:
    s_mov_b32 s95, 179200
    s_mov_b64 exec, s[82:83]
    s_cbranch_execz K2_G17
    buffer_load_dwordx2 v[94:95], v105, s[20:23], s95 offen offset:256
K2_G17:
    s_mov_b32 s95, 204800
    s_mov_b64 exec, s[84:85]
    s_cbranch_execz K2_G18
    buffer_load_dwordx2 v[96:97], v106, s[20:23], s95 offen offset:256
K2_G18:
K2_NP2A:
    s_mov_b64 exec, -1
    v_max3_i32 v221, v172, v173, v174
    v_max3_i32 v221, v221, v175, v176
    v_max3_i32 v221, v221, v177, v178
    v_max3_i32 v221, v221, v179, v180
    v_mov_b32 v223, 1
    v_cmp_lt_i32_e64 s[86:87], s92, v221
K2_NOREC:
    s_waitcnt lgkmcnt(0)
    s_barrier
    s_add_u32 s95, s101, 0
    s_cmp_lt_u32 s95, 125952
    s_cselect_b32 m0, s95, 47104
    s_nop 0
    buffer_load_dwordx4 v[210:211], s[8:11], 0 idxen offen lds
    s_add_u32 s95, s101, 1024
    s_cmp_lt_u32 s95, 125952
    s_cselect_b32 m0, s95, 47104
    s_nop 0
    buffer_load_dwordx4 v[212:213], s[8:11], 0 idxen offen lds
    s_add_u32 s95, s101, 2048
    s_cmp_lt_u32 s95, 125952
    s_cselect_b32 m0, s95, 47104
    s_nop 0
    buffer_load_dwordx4 v[214:215], s[8:11], 0 idxen offen lds
    s_add_u32 s95, s101, 3072
    s_cmp_lt_u32 s95, 125952
    s_cselect_b32 m0, s95, 47104
    s_nop 0
    buffer_load_dwordx4 v[216:217], s[8:11], 0 idxen offen lds
    s_cmp_lg_u32 s5, 0
    s_cbranch_scc1 K2_NOPW
    s_lshr_b32 s95, s2, 3
    s_mul_i32 s99, s95, 0
    v_add_u32 v224, s99, v203
    s_mul_i32 s99, s95, 0
    v_add_u32 v225, s99, v250
    v_add_u32 v224, 0, v250
    v_cmp_gt_u32 vcc, s96, v224
    s_nop 1
    v_cndmask_b32_e64 v104, -0.5, 0.5, vcc
    v_add_u32 v224, 64, v250
    v_cmp_gt_u32 vcc, s96, v224
    s_nop 1
    v_cndmask_b32_e64 v105, -0.5, 0.5, vcc
    v_add_u32 v224, 128, v250
    v_cmp_gt_u32 vcc, s96, v224
    s_nop 1
    v_cndmask_b32_e64 v106, -0.5, 0.5, vcc
    v_add_u32 v224, 192, v250
    v_cmp_gt_u32 vcc, s96, v224
    s_nop 1
    v_cndmask_b32_e64 v107, -0.5, 0.5, vcc
    s_branch K2_B1
K2_NOPW:
    s_mov_b64 exec, s[86:87]
    ds_write_b32 v228, v223 offset:96
    s_mov_b64 exec, -1
    s_waitcnt vmcnt(12)
    s_mov_b64 exec, s[32:33]
    v_lshrrev_b32 v172, 16, v45
    ds_add_rtn_u32 v172, v172, v223 offset:34816
    s_waitcnt vmcnt(11)
    s_mov_b64 exec, s[34:35]
    v_lshrrev_b32 v173, 16, v47
    ds_add_rtn_u32 v173, v173, v223 offset:34816
    s_waitcnt vmcnt(10)
    s_mov_b64 exec, s[36:37]
    v_lshrrev_b32 v174, 16, v49
    ds_add_rtn_u32 v174, v174, v223 offset:34816
    s_waitcnt vmcnt(9)
    s_mov_b64 exec, s[38:39]
    v_lshrrev_b32 v175, 16, v51
    ds_add_rtn_u32 v175, v175, v223 offset:34816
    s_waitcnt vmcnt(8)
    s_mov_b64 exec, s[40:41]
    v_lshrrev_b32 v176, 16, v53
    ds_add_rtn_u32 v176, v176, v223 offset:34816
    s_waitcnt vmcnt(7)
    s_mov_b64 exec, s[42:43]
    v_lshrrev_b32 v177, 16, v55
    ds_add_rtn_u32 v177, v177, v223 offset:34816
    s_waitcnt vmcnt(6)
    s_mov_b64 exec, s[44:45]
    v_lshrrev_b32 v178, 16, v57
    ds_add_rtn_u32 v178, v178, v223 offset:34816
    s_waitcnt vmcnt(5)
    s_mov_b64 exec, s[46:47]
    v_lshrrev_b32 v179, 16, v59
    ds_add_rtn_u32 v179, v179, v223 offset:34816
    s_waitcnt vmcnt(4)
    s_mov_b64 exec, s[48:49]
    v_lshrrev_b32 v180, 16, v61
    ds_add_rtn_u32 v180, v180, v223 offset:34816
    s_mov_b64 exec, s[50:51]
    s_cbranch_execz K2_G19
    v_lshrrev_b32 v181, 16, v63
    ds_add_rtn_u32 v181, v181, v223 offset:34816
K2_G19:
    s_mov_b64 exec, s[52:53]
    s_cbranch_execz K2_G20
    v_lshrrev_b32 v182, 16, v65
    ds_add_rtn_u32 v182, v182, v223 offset:34816
K2_G20:
    s_mov_b64 exec, s[54:55]
    s_cbranch_execz K2_G21
    v_lshrrev_b32 v183, 16, v67
    ds_add_rtn_u32 v183, v183, v223 offset:34816
K2_G21:
    s_mov_b64 exec, s[56:57]
    s_cbranch_execz K2_G22
    v_lshrrev_b32 v184, 16, v69
    ds_add_rtn_u32 v184, v184, v223 offset:34816
K2_G22:
    s_mov_b64 exec, s[58:59]
    s_cbranch_execz K2_G23
    v_lshrrev_b32 v185, 16, v71
    ds_add_rtn_u32 v185, v185, v223 offset:34816
K2_G23:
    s_mov_b64 exec, s[60:61]
    s_cbranch_execz K2_G24
    v_lshrrev_b32 v186, 16, v73
    ds_add_rtn_u32 v186, v186, v223 offset:34816
K2_G24:
    s_mov_b64 exec, s[62:63]
    s_cbranch_execz K2_G25
    v_lshrrev_b32 v187, 16, v75
    ds_add_rtn_u32 v187, v187, v223 offset:34816
K2_G25:
    s_mov_b64 exec, s[64:65]
    s_cbranch_execz K2_G26
    v_lshrrev_b32 v188, 16, v77
    ds_add_rtn_u32 v188, v188, v223 offset:34816
K2_G26:
    s_mov_b64 exec, s[66:67]
    s_cbranch_execz K2_G27
    v_lshrrev_b32 v189, 16, v79
    ds_add_rtn_u32 v189, v189, v223 offset:34816
K2_G27:
    s_cmp_eq_u32 s97, 0
    s_cbranch_scc1 K2_NP2B
    s_mov_b64 exec, s[68:69]
    s_cbranch_execz K2_G28
    v_lshrrev_b32 v190, 16, v81
    ds_add_rtn_u32 v190, v190, v223 offset:34816
K2_G28:
    s_mov_b64 exec, s[70:71]
    s_cbranch_execz K2_G29
    v_lshrrev_b32 v191, 16, v83
    ds_add_rtn_u32 v191, v191, v223 offset:34816
K2_G29:
    s_mov_b64 exec, s[72:73]
    s_cbranch_execz K2_G30
    v_lshrrev_b32 v192, 16, v85
    ds_add_rtn_u32 v192, v192, v223 offset:34816
K2_G30:
    s_mov_b64 exec, s[74:75]
    s_cbranch_execz K2_G31
    v_lshrrev_b32 v193, 16, v87
    ds_add_rtn_u32 v193, v193, v223 offset:34816
K2_G31:
    s_mov_b64 exec, s[76:77]
    s_cbranch_execz K2_G32
    v_lshrrev_b32 v194, 16, v89
    ds_add_rtn_u32 v194, v194, v223 offset:34816
K2_G32:
    s_mov_b64 exec, s[78:79]
    s_cbranch_execz K2_G33
    v_lshrrev_b32 v195, 16, v91
    ds_add_rtn_u32 v195, v195, v223 offset:34816
K2_G33:
    s_mov_b64 exec, s[80:81]
    s_cbranch_execz K2_G34
    v_lshrrev_b32 v196, 16, v93
    ds_add_rtn_u32 v196, v196, v223 offset:34816
K2_G34:
    s_mov_b64 exec, s[82:83]
    s_cbranch_execz K2_G35
    v_lshrrev_b32 v197, 16, v95
    ds_add_rtn_u32 v197, v197, v223 offset:34816
K2_G35:
    s_mov_b64 exec, s[84:85]
    s_cbranch_execz K2_G36
    v_lshrrev_b32 v198, 16, v97
    ds_add_rtn_u32 v198, v198, v223 offset:34816
K2_G36:
K2_NP2B:
    s_mov_b64 exec, -1
K2_B1:
    s_cmp_lg_u32 s5, 0
    s_waitcnt lgkmcnt(0)
    s_barrier
    s_cbranch_scc1 K2_W2
    v_lshlrev_b32 v222, 1, v203
    ds_read_b128 v[0:3], v222 offset:34816
    ds_read_b128 v[4:7], v222 offset:34832
    ds_read_b128 v[8:11], v222 offset:36864
    ds_read_b128 v[12:15], v222 offset:36880
    ds_read_b128 v[16:19], v222 offset:38912
    ds_read_b128 v[20:23], v222 offset:38928
    ds_read_b128 v[24:27], v222 offset:40960
    ds_read_b128 v[28:31], v222 offset:40976
    s_waitcnt lgkmcnt(6)
    v_add3_u32 v76, v0, v1, v2
    v_add3_u32 v80, v3, v4, v5
    v_add3_u32 v76, v76, v6, v7
    v_add_u32 v76, v76, v80
    s_waitcnt lgkmcnt(4)
    v_add3_u32 v77, v8, v9, v10
    v_add3_u32 v81, v11, v12, v13
    v_add3_u32 v77, v77, v14, v15
    v_add_u32 v77, v77, v81
    s_waitcnt lgkmcnt(2)
    v_add3_u32 v78, v16, v17, v18
    v_add3_u32 v82, v19, v20, v21
    v_add3_u32 v78, v78, v22, v23
    v_add_u32 v78, v78, v82
    s_waitcnt lgkmcnt(0)
    v_add3_u32 v79, v24, v25, v26
    v_add3_u32 v83, v27, v28, v29
    v_add3_u32 v79, v79, v30, v31
    v_add_u32 v79, v79, v83
    v_add_u32 v82, v76, v77
    v_add_u32 v83, v82, v78
    v_add_u32 v220, v83, v79
    v_mov_b32 v221, v220
    s_nop 1
    v_add_u32_dpp v221, v221, v221 row_shr:1 row_mask:0xf bank_mask:0xf
    s_nop 1
    v_add_u32_dpp v221, v221, v221 row_shr:2 row_mask:0xf bank_mask:0xf
    s_nop 1
    v_add_u32_dpp v221, v221, v221 row_shr:4 row_mask:0xf bank_mask:0xf
    s_nop 1
    v_add_u32_dpp v221, v221, v221 row_shr:8 row_mask:0xf bank_mask:0xf
    s_nop 1
    v_add_u32_dpp v221, v221, v221 row_bcast:15 row_mask:0xa bank_mask:0xf
    s_nop 1
    v_add_u32_dpp v221, v221, v221 row_bcast:31 row_mask:0xc bank_mask:0xf
    v_sub_u32 v80, v221, v220
    v_add_u32 v81, v80, v76
    v_add_u32 v82, v80, v82
    v_add_u32 v83, v80, v83
    s_movk_i32 s95, 2560
    v_lshl_add_u32 v140, v80, 3, s95
    v_lshl_add_u32 v141, v0, 3, v140
    v_lshl_add_u32 v142, v1, 3, v141
    v_lshl_add_u32 v143, v2, 3, v142
    ds_write_b128 v222, v[140:143] offset:34816
    v_lshl_add_u32 v144, v3, 3, v143
    v_lshl_add_u32 v145, v4, 3, v144
    v_lshl_add_u32 v146, v5, 3, v145
    v_lshl_add_u32 v147, v6, 3, v146
    ds_write_b128 v222, v[144:147] offset:34832
    v_lshl_add_u32 v148, v81, 3, s95
    v_lshl_add_u32 v149, v8, 3, v148
    v_lshl_add_u32 v150, v9, 3, v149
    v_lshl_add_u32 v151, v10, 3, v150
    ds_write_b128 v222, v[148:151] offset:36864
    v_lshl_add_u32 v152, v11, 3, v151
    v_lshl_add_u32 v153, v12, 3, v152
    v_lshl_add_u32 v154, v13, 3, v153
    v_lshl_add_u32 v155, v14, 3, v154
    ds_write_b128 v222, v[152:155] offset:36880
    v_lshl_add_u32 v156, v82, 3, s95
    v_lshl_add_u32 v157, v16, 3, v156
    v_lshl_add_u32 v158, v17, 3, v157
    v_lshl_add_u32 v159, v18, 3, v158
    ds_write_b128 v222, v[156:159] offset:38912
    v_lshl_add_u32 v160, v19, 3, v159
    v_lshl_add_u32 v161, v20, 3, v160
    v_lshl_add_u32 v162, v21, 3, v161
    v_lshl_add_u32 v163, v22, 3, v162
    ds_write_b128 v222, v[160:163] offset:38928
    v_lshl_add_u32 v164, v83, 3, s95
    v_lshl_add_u32 v165, v24, 3, v164
    v_lshl_add_u32 v166, v25, 3, v165
    v_lshl_add_u32 v167, v26, 3, v166
    ds_write_b128 v222, v[164:167] offset:40960
    v_lshl_add_u32 v168, v27, 3, v167
    v_lshl_add_u32 v169, v28, 3, v168
    v_lshl_add_u32 v170, v29, 3, v169
    v_lshl_add_u32 v171, v30, 3, v170
    ds_write_b128 v222, v[168:171] offset:40976
    s_mov_b32 exec_lo, 0
    s_brev_b32 exec_hi, 1
    ds_write_b32 v228, v221 offset:100
    s_mov_b64 exec, -1
K2_W2:
    s_cmp_ge_u32 s5, 6
    s_cbranch_scc1 K2_NWH
    s_mul_i32 s95, s5, 2048
    s_add_u32 m0, s95, 125952
    s_add_u32 s95, s95, 7561216
    buffer_load_dwordx4 v203, s[20:23], s95 offen offset:0 lds
    buffer_load_dwordx4 v203, s[20:23], s95 offen offset:1024 lds
K2_NWH:
    s_cmp_eq_u32 s5, 0
    s_cbranch_scc1 K2_NFT
    s_mov_b32 s95, 1835008
    s_mov_b64 exec, s[32:33]
    v_and_or_b32 v140, v45, s95, v172
    v_lshrrev_b32 v141, 18, v45
    v_cmpx_gt_u32 vcc, 1, v140
    ds_write_b64 v141, v[44:45] offset:43008
    s_mov_b64 exec, s[34:35]
    v_and_or_b32 v142, v47, s95, v173
    v_lshrrev_b32 v143, 18, v47
    v_cmpx_gt_u32 vcc, 1, v142
    ds_write_b64 v143, v[46:47] offset:43008
    s_mov_b64 exec, s[36:37]
    v_and_or_b32 v144, v49, s95, v174
    v_lshrrev_b32 v145, 18, v49
    v_cmpx_gt_u32 vcc, 1, v144
    ds_write_b64 v145, v[48:49] offset:43008
    s_mov_b64 exec, s[38:39]
    v_and_or_b32 v146, v51, s95, v175
    v_lshrrev_b32 v147, 18, v51
    v_cmpx_gt_u32 vcc, 1, v146
    ds_write_b64 v147, v[50:51] offset:43008
    s_mov_b64 exec, s[40:41]
    v_and_or_b32 v148, v53, s95, v176
    v_lshrrev_b32 v149, 18, v53
    v_cmpx_gt_u32 vcc, 1, v148
    ds_write_b64 v149, v[52:53] offset:43008
    s_mov_b64 exec, s[42:43]
    v_and_or_b32 v150, v55, s95, v177
    v_lshrrev_b32 v151, 18, v55
    v_cmpx_gt_u32 vcc, 1, v150
    ds_write_b64 v151, v[54:55] offset:43008
    s_mov_b64 exec, s[44:45]
    v_and_or_b32 v152, v57, s95, v178
    v_lshrrev_b32 v153, 18, v57
    v_cmpx_gt_u32 vcc, 1, v152
    ds_write_b64 v153, v[56:57] offset:43008
    s_mov_b64 exec, s[46:47]
    v_and_or_b32 v154, v59, s95, v179
    v_lshrrev_b32 v155, 18, v59
    v_cmpx_gt_u32 vcc, 1, v154
    ds_write_b64 v155, v[58:59] offset:43008
    s_mov_b64 exec, s[48:49]
    v_and_or_b32 v156, v61, s95, v180
    v_lshrrev_b32 v157, 18, v61
    v_cmpx_gt_u32 vcc, 1, v156
    ds_write_b64 v157, v[60:61] offset:43008
    s_mov_b64 exec, -1
    s_mul_i32 s95, s5, 224
    v_lshrrev_b32 v140, 1, v203
    v_add_u32 v140, s95, v140
K2_NFT:
    s_cmp_eq_u32 s5, 0
    s_waitcnt lgkmcnt(0)
    s_barrier
    ds_read_b64 v[232:233], v228 offset:96
    s_cbranch_scc1 K2_NOS1
    ds_read_b64 v[140:141], v140 offset:42784
    s_mov_b64 exec, s[32:33]
    v_lshrrev_b32 v98, 16, v45
    ds_read_b32 v98, v98 offset:34816
    s_mov_b64 exec, s[34:35]
    v_lshrrev_b32 v99, 16, v47
    ds_read_b32 v99, v99 offset:34816
    s_mov_b64 exec, s[36:37]
    v_lshrrev_b32 v100, 16, v49
    ds_read_b32 v100, v100 offset:34816
    s_mov_b64 exec, s[38:39]
    v_lshrrev_b32 v101, 16, v51
    ds_read_b32 v101, v101 offset:34816
    s_mov_b64 exec, s[40:41]
    v_lshrrev_b32 v102, 16, v53
    ds_read_b32 v102, v102 offset:34816
    s_mov_b64 exec, s[42:43]
    v_lshrrev_b32 v103, 16, v55
    ds_read_b32 v103, v103 offset:34816
    s_mov_b64 exec, s[44:45]
    v_lshrrev_b32 v104, 16, v57
    ds_read_b32 v104, v104 offset:34816
    s_mov_b64 exec, s[46:47]
    v_lshrrev_b32 v105, 16, v59
    ds_read_b32 v105, v105 offset:34816
    s_mov_b64 exec, s[48:49]
    v_lshrrev_b32 v106, 16, v61
    ds_read_b32 v106, v106 offset:34816
    s_mov_b64 exec, -1
    s_waitcnt lgkmcnt(9)
    v_and_b32 v141, 0xffff, v141
    s_mov_b64 exec, 0xfffffff
    buffer_load_dword v202, v140, s[12:15], 0 idxen
    buffer_load_dword v202, v141, s[8:11], 0 idxen
    buffer_load_dword v202, v141, s[16:19], 0 idxen
    s_mov_b64 exec, s[50:51]
    s_cbranch_execz K2_G37
    v_lshrrev_b32 v220, 16, v63
    ds_read_b32 v220, v220 offset:34816
K2_G37:
    s_mov_b64 exec, s[52:53]
    s_cbranch_execz K2_G38
    v_lshrrev_b32 v221, 16, v65
    ds_read_b32 v221, v221 offset:34816
K2_G38:
    s_mov_b64 exec, s[54:55]
    s_cbranch_execz K2_G39
    v_lshrrev_b32 v222, 16, v67
    ds_read_b32 v222, v222 offset:34816
K2_G39:
    s_mov_b64 exec, s[56:57]
    s_cbranch_execz K2_G40
    v_lshrrev_b32 v223, 16, v69
    ds_read_b32 v223, v223 offset:34816
K2_G40:
    s_mov_b64 exec, s[58:59]
    s_cbranch_execz K2_G41
    v_lshrrev_b32 v224, 16, v71
    ds_read_b32 v224, v224 offset:34816
K2_G41:
    s_mov_b64 exec, s[60:61]
    s_cbranch_execz K2_G42
    v_lshrrev_b32 v225, 16, v73
    ds_read_b32 v225, v225 offset:34816
K2_G42:
    s_mov_b64 exec, s[62:63]
    s_cbranch_execz K2_G43
    v_lshrrev_b32 v226, 16, v75
    ds_read_b32 v226, v226 offset:34816
K2_G43:
    s_mov_b64 exec, s[64:65]
    s_cbranch_execz K2_G44
    v_lshrrev_b32 v227, 16, v77
    ds_read_b32 v227, v227 offset:34816
K2_G44:
    s_mov_b64 exec, s[66:67]
    s_cbranch_execz K2_G45
    v_lshrrev_b32 v228, 16, v79
    ds_read_b32 v228, v228 offset:34816
K2_G45:
    s_mov_b64 exec, -1
K2_NOS1:
    s_waitcnt lgkmcnt(0)
    v_readfirstlane_b32 s98, v233
    v_readfirstlane_b32 s93, v232
    s_cmp_le_u32 s98, 3776
    s_cbranch_scc1 K2_FITS
    s_cmp_eq_u32 s92, 15
    s_cbranch_scc1 K2_END0
    s_mov_b32 s92, 15
    s_waitcnt vmcnt(0)
    s_barrier
    s_branch K2_TOP
K2_FITS:
    s_cmp_eq_u32 s5, 0
    s_cbranch_scc1 K2_PLAN
    s_mov_b64 exec, s[32:33]
    v_lshl_add_u32 v98, v172, 3, v98
    ds_write_b64 v98, v[44:45]
    s_mov_b64 exec, s[34:35]
    v_lshl_add_u32 v99, v173, 3, v99
    ds_write_b64 v99, v[46:47]
    s_mov_b64 exec, s[36:37]
    v_lshl_add_u32 v100, v174, 3, v100
    ds_write_b64 v100, v[48:49]
    s_mov_b64 exec, s[38:39]
    v_lshl_add_u32 v101, v175, 3, v101
    ds_write_b64 v101, v[50:51]
    s_mov_b64 exec, s[40:41]
    v_lshl_add_u32 v102, v176, 3, v102
    ds_write_b64 v102, v[52:53]
    s_mov_b64 exec, s[42:43]
    v_lshl_add_u32 v103, v177, 3, v103
    ds_write_b64 v103, v[54:55]
    s_mov_b64 exec, s[44:45]
    v_lshl_add_u32 v104, v178, 3, v104
    ds_write_b64 v104, v[56:57]
    s_mov_b64 exec, s[46:47]
    v_lshl_add_u32 v105, v179, 3, v105
    ds_write_b64 v105, v[58:59]
    s_mov_b64 exec, s[48:49]
    v_lshl_add_u32 v106, v180, 3, v106
    ds_write_b64 v106, v[60:61]
    s_mov_b64 exec, s[50:51]
    s_cbranch_execz K2_G46
    v_lshl_add_u32 v220, v181, 3, v220
    ds_write_b64 v220, v[62:63]
K2_G46:
    s_mov_b64 exec, s[52:53]
    s_cbranch_execz K2_G47
    v_lshl_add_u32 v221, v182, 3, v221
    ds_write_b64 v221, v[64:65]
K2_G47:
    s_mov_b64 exec, s[54:55]
    s_cbranch_execz K2_G48
    v_lshl_add_u32 v222, v183, 3, v222
    ds_write_b64 v222, v[66:67]
K2_G48:
    s_mov_b64 exec, s[56:57]
    s_cbranch_execz K2_G49
    v_lshl_add_u32 v223, v184, 3, v223
    ds_write_b64 v223, v[68:69]
K2_G49:
    s_mov_b64 exec, s[58:59]
    s_cbranch_execz K2_G50
    v_lshl_add_u32 v224, v185, 3, v224
    ds_write_b64 v224, v[70:71]
K2_G50:
    s_mov_b64 exec, s[60:61]
    s_cbranch_execz K2_G51
    v_lshl_add_u32 v225, v186, 3, v225
    ds_write_b64 v225, v[72:73]
K2_G51:
    s_mov_b64 exec, s[62:63]
    s_cbranch_execz K2_G52
    v_lshl_add_u32 v226, v187, 3, v226
    ds_write_b64 v226, v[74:75]
K2_G52:
    s_mov_b64 exec, s[64:65]
    s_cbranch_execz K2_G53
    v_lshl_add_u32 v227, v188, 3, v227
    ds_write_b64 v227, v[76:77]
K2_G53:
    s_mov_b64 exec, s[66:67]
    s_cbranch_execz K2_G54
    v_lshl_add_u32 v228, v189, 3, v228
    ds_write_b64 v228, v[78:79]
K2_G54:
    s_cmp_eq_u32 s97, 0
    s_cbranch_scc1 K2_B3
    s_mov_b64 exec, s[68:69]
    s_cbranch_execz K2_G55
    v_lshrrev_b32 v98, 16, v81
    ds_read_b32 v98, v98 offset:34816
K2_G55:
    s_mov_b64 exec, s[70:71]
    s_cbranch_execz K2_G56
    v_lshrrev_b32 v99, 16, v83
    ds_read_b32 v99, v99 offset:34816
K2_G56:
    s_mov_b64 exec, s[72:73]
    s_cbranch_execz K2_G57
    v_lshrrev_b32 v100, 16, v85
    ds_read_b32 v100, v100 offset:34816
K2_G57:
    s_mov_b64 exec, s[74:75]
    s_cbranch_execz K2_G58
    v_lshrrev_b32 v101, 16, v87
    ds_read_b32 v101, v101 offset:34816
K2_G58:
    s_mov_b64 exec, s[76:77]
    s_cbranch_execz K2_G59
    v_lshrrev_b32 v102, 16, v89
    ds_read_b32 v102, v102 offset:34816
K2_G59:
    s_mov_b64 exec, s[78:79]
    s_cbranch_execz K2_G60
    v_lshrrev_b32 v103, 16, v91
    ds_read_b32 v103, v103 offset:34816
K2_G60:
    s_mov_b64 exec, s[80:81]
    s_cbranch_execz K2_G61
    v_lshrrev_b32 v104, 16, v93
    ds_read_b32 v104, v104 offset:34816
K2_G61:
    s_mov_b64 exec, s[82:83]
    s_cbranch_execz K2_G62
    v_lshrrev_b32 v105, 16, v95
    ds_read_b32 v105, v105 offset:34816
K2_G62:
    s_mov_b64 exec, s[84:85]
    s_cbranch_execz K2_G63
    v_lshrrev_b32 v106, 16, v97
    ds_read_b32 v106, v106 offset:34816
K2_G63:
    s_waitcnt lgkmcnt(0)
    s_mov_b64 exec, s[68:69]
    s_cbranch_execz K2_G64
    v_lshl_add_u32 v98, v190, 3, v98
    ds_write_b64 v98, v[80:81]
K2_G64:
    s_mov_b64 exec, s[70:71]
    s_cbranch_execz K2_G65
    v_lshl_add_u32 v99, v191, 3, v99
    ds_write_b64 v99, v[82:83]
K2_G65:
    s_mov_b64 exec, s[72:73]
    s_cbranch_execz K2_G66
    v_lshl_add_u32 v100, v192, 3, v100
    ds_write_b64 v100, v[84:85]
K2_G66:
    s_mov_b64 exec, s[74:75]
    s_cbranch_execz K2_G67
    v_lshl_add_u32 v101, v193, 3, v101
    ds_write_b64 v101, v[86:87]
K2_G67:
    s_mov_b64 exec, s[76:77]
    s_cbranch_execz K2_G68
    v_lshl_add_u32 v102, v194, 3, v102
    ds_write_b64 v102, v[88:89]
K2_G68:
    s_mov_b64 exec, s[78:79]
    s_cbranch_execz K2_G69
    v_lshl_add_u32 v103, v195, 3, v103
    ds_write_b64 v103, v[90:91]
K2_G69:
    s_mov_b64 exec, s[80:81]
    s_cbranch_execz K2_G70
    v_lshl_add_u32 v104, v196, 3, v104
    ds_write_b64 v104, v[92:93]
K2_G70:
    s_mov_b64 exec, s[82:83]
    s_cbranch_execz K2_G71
    v_lshl_add_u32 v105, v197, 3, v105
    ds_write_b64 v105, v[94:95]
K2_G71:
    s_mov_b64 exec, s[84:85]
    s_cbranch_execz K2_G72
    v_lshl_add_u32 v106, v198, 3, v106
    ds_write_b64 v106, v[96:97]
K2_G72:
    s_branch K2_B3
K2_PLAN:
    s_mul_i32 s99, s98, 3
    s_lshr_b32 s99, s99, 9
    s_max_u32 s99, s99, 1
    v_cvt_f32_u32 v84, v76
    v_add_f32 v84, -0.5, v84
    v_max_f32 v104, v104, v84
    v_cvt_f32_u32 v85, v77
    v_add_f32 v85, -0.5, v85
    v_max_f32 v105, v105, v85
    v_cvt_f32_u32 v86, v78
    v_add_f32 v86, -0.5, v86
    v_max_f32 v106, v106, v86
    v_cvt_f32_u32 v87, v79
    v_add_f32 v87, -0.5, v87
    v_max_f32 v107, v107, v87
K2_DLOOP:
    v_cvt_f32_u32 v220, s99
    v_rcp_f32 v221, v220
    v_add_f32 v88, v104, v220
    v_add_f32 v89, v105, v220
    v_add_f32 v90, v106, v220
    v_add_f32 v91, v107, v220
    v_mul_f32 v88, v88, v221
    v_cvt_u32_f32 v88, v88
    v_mul_f32 v89, v89, v221
    v_cvt_u32_f32 v89, v89
    v_mul_f32 v90, v90, v221
    v_cvt_u32_f32 v90, v90
    v_mul_f32 v91, v91, v221
    v_cvt_u32_f32 v91, v91
    v_add_u32 v222, v88, v89
    v_add3_u32 v222, v222, v90, v91
    s_nop 1
    v_add_u32_dpp v222, v222, v222 row_shr:1 row_mask:0xf bank_mask:0xf
    s_nop 1
    v_add_u32_dpp v222, v222, v222 row_shr:2 row_mask:0xf bank_mask:0xf
    s_nop 1
    v_add_u32_dpp v222, v222, v222 row_shr:4 row_mask:0xf bank_mask:0xf
    s_nop 1
    v_add_u32_dpp v222, v222, v222 row_shr:8 row_mask:0xf bank_mask:0xf
    s_nop 1
    v_add_u32_dpp v222, v222, v222 row_bcast:15 row_mask:0xa bank_mask:0xf
    s_nop 1
    v_add_u32_dpp v222, v222, v222 row_bcast:31 row_mask:0xc bank_mask:0xf
    s_nop 0
    v_readlane_b32 s95, v222, 63
    s_add_u32 s99, s99, 1
    s_cmp_gt_u32 s95, 255
    s_cbranch_scc1 K2_DLOOP
    v_cvt_f32_u32 v92, v88
    v_rcp_f32 v96, v92
    v_add_f32 v92, v92, v84
    v_cmp_eq_u32_e64 s[48:49], 1, v88
    v_lshlrev_b32 v44, 16, v88
    v_cvt_f32_u32 v93, v89
    v_rcp_f32 v97, v93
    v_add_f32 v93, v93, v85
    v_cmp_eq_u32_e64 s[50:51], 1, v89
    v_lshlrev_b32 v45, 16, v89
    v_cvt_f32_u32 v94, v90
    v_rcp_f32 v98, v94
    v_add_f32 v94, v94, v86
    v_cmp_eq_u32_e64 s[52:53], 1, v90
    v_lshlrev_b32 v46, 16, v90
    v_cvt_f32_u32 v95, v91
    v_rcp_f32 v99, v95
    v_add_f32 v95, v95, v87
    v_cmp_eq_u32_e64 s[54:55], 1, v91
    v_lshlrev_b32 v47, 16, v91
    v_cndmask_b32_e64 v44, v44, 1, s[48:49]
    v_cndmask_b32_e64 v45, v45, 1, s[50:51]
    v_cndmask_b32_e64 v46, v46, 1, s[52:53]
    v_cndmask_b32_e64 v47, v47, 1, s[54:55]
    v_mul_f32 v92, v92, v96
    v_cvt_u32_f32 v92, v92
    v_sub_u32 v96, 63, v92
    v_lshlrev_b32 v96, 2, v96
    ds_add_rtn_u32 v100, v96, v44 offset:128
    v_mul_f32 v93, v93, v97
    v_cvt_u32_f32 v93, v93
    v_sub_u32 v97, 63, v93
    v_lshlrev_b32 v97, 2, v97
    ds_add_rtn_u32 v101, v97, v45 offset:128
    v_mul_f32 v94, v94, v98
    v_cvt_u32_f32 v94, v94
    v_sub_u32 v98, 63, v94
    v_lshlrev_b32 v98, 2, v98
    ds_add_rtn_u32 v102, v98, v46 offset:128
    v_mul_f32 v95, v95, v99
    v_cvt_u32_f32 v95, v95
    v_sub_u32 v99, 63, v95
    v_lshlrev_b32 v99, 2, v99
    ds_add_rtn_u32 v103, v99, v47 offset:128
    v_lshrrev_b32 v220, 2, v203
    ds_read_b32 v221, v220 offset:128
    v_add_u32 v222, 0, v250
    v_lshl_or_b32 v172, v222, 24, v140
    v_lshl_or_b32 v172, v92, 18, v172
    v_lshlrev_b32 v173, 3, v88
    v_sub_u32 v222, 1, v92
    v_mad_i32_i24 v76, v222, v88, v76
    v_add_u32 v222, 64, v250
    v_lshl_or_b32 v174, v222, 24, v148
    v_lshl_or_b32 v174, v93, 18, v174
    v_lshlrev_b32 v175, 3, v89
    v_sub_u32 v222, 1, v93
    v_mad_i32_i24 v77, v222, v89, v77
    v_add_u32 v222, 128, v250
    v_lshl_or_b32 v176, v222, 24, v156
    v_lshl_or_b32 v176, v94, 18, v176
    v_lshlrev_b32 v177, 3, v90
    v_sub_u32 v222, 1, v94
    v_mad_i32_i24 v78, v222, v90, v78
    v_add_u32 v222, 192, v250
    v_lshl_or_b32 v178, v222, 24, v164
    v_lshl_or_b32 v178, v95, 18, v178
    v_lshlrev_b32 v179, 3, v91
    v_sub_u32 v222, 1, v95
    v_mad_i32_i24 v79, v222, v91, v79
    v_max3_u32 v224, v88, v89, v90
    v_max_u32 v224, v224, v91
    v_mov_b32 v225, -262136
    s_mov_b32 s99, 0
    s_waitcnt lgkmcnt(0)
    v_mov_b32 v222, v221
    v_and_b32 v57, 0xffff, v221
    v_cmp_ne_u32 vcc, 0, v57
    v_and_b32 v52, 0xffff, v100
    v_lshrrev_b32 v100, 16, v100
    v_add_u32_dpp v222, v222, v222 row_shr:1 row_mask:0xf bank_mask:0xf
    v_min_u32 v48, 1, v52
    v_cndmask_b32_e64 v100, v100, v52, s[48:49]
    v_add_u32_dpp v222, v222, v222 row_shr:2 row_mask:0xf bank_mask:0xf
    v_mad_i32_i24 v48, v48, -10, 20
    v_cndmask_b32_e64 v48, 0, v48, s[48:49]
    v_add_u32_dpp v222, v222, v222 row_shr:4 row_mask:0xf bank_mask:0xf
    v_and_b32 v53, 0xffff, v101
    v_lshrrev_b32 v101, 16, v101
    v_add_u32_dpp v222, v222, v222 row_shr:8 row_mask:0xf bank_mask:0xf
    v_min_u32 v49, 1, v53
    v_cndmask_b32_e64 v101, v101, v53, s[50:51]
    v_add_u32_dpp v222, v222, v222 row_bcast:15 row_mask:0xa bank_mask:0xf
    v_mad_i32_i24 v49, v49, -10, 20
    v_cndmask_b32_e64 v49, 0, v49, s[50:51]
    v_add_u32_dpp v222, v222, v222 row_bcast:31 row_mask:0xc bank_mask:0xf
    v_lshrrev_b32 v58, 16, v222
    v_cndmask_b32 v56, 0, v58, vcc
    v_sub_u32 v222, v222, v221
    v_and_b32 v54, 0xffff, v102
    v_lshrrev_b32 v102, 16, v102
    v_max_u32_dpp v56, v56, v56 row_shr:1 row_mask:0xf bank_mask:0xf
    v_min_u32 v50, 1, v54
    v_cndmask_b32_e64 v102, v102, v54, s[52:53]
    v_max_u32_dpp v56, v56, v56 row_shr:2 row_mask:0xf bank_mask:0xf
    v_mad_i32_i24 v50, v50, -10, 20
    v_cndmask_b32_e64 v50, 0, v50, s[52:53]
    v_max_u32_dpp v56, v56, v56 row_shr:4 row_mask:0xf bank_mask:0xf
    v_and_b32 v55, 0xffff, v103
    v_lshrrev_b32 v103, 16, v103
    v_max_u32_dpp v56, v56, v56 row_shr:8 row_mask:0xf bank_mask:0xf
    v_min_u32 v51, 1, v55
    v_cndmask_b32_e64 v103, v103, v55, s[54:55]
    v_max_u32_dpp v56, v56, v56 row_bcast:15 row_mask:0xa bank_mask:0xf
    v_mad_i32_i24 v51, v51, -10, 20
    v_cndmask_b32_e64 v51, 0, v51, s[54:55]
    v_max_u32_dpp v56, v56, v56 row_bcast:31 row_mask:0xc bank_mask:0xf
    v_and_b32 v57, 0xffff, v222
    v_and_b32 v221, 1, v222
    v_mov_b32_dpp v56, v56 wave_shr:1 row_mask:0xf bank_mask:0xf
    v_cmp_eq_u32 vcc, 1, v221
    v_lshrrev_b32 v222, 16, v222
    v_add3_u32 v222, v222, v57, v221
    v_cndmask_b32 v56, v58, v56, vcc
    v_add_u32 v58, v58, v57
    v_add_u32 v56, v56, v57
    v_lshl_or_b32 v222, v58, 10, v222
    v_lshl_or_b32 v222, v56, 20, v222
    ds_bpermute_b32 v96, v96, v222
    ds_bpermute_b32 v97, v97, v222
    ds_bpermute_b32 v98, v98, v222
    ds_bpermute_b32 v99, v99, v222
    s_waitcnt lgkmcnt(3)
    v_bfe_u32 v96, v96, v48, 10
    v_add_lshl_u32 v96, v96, v100, 2
    v_lshl_or_b32 v222, v88, 16, v96
    v_lshlrev_b32 v96, 1, v96
    ds_write_b32 v220, v222 offset:32768
    s_waitcnt lgkmcnt(3)
    v_bfe_u32 v97, v97, v49, 10
    v_add_lshl_u32 v97, v97, v101, 2
    v_lshl_or_b32 v222, v89, 16, v97
    v_lshlrev_b32 v97, 1, v97
    ds_write_b32 v220, v222 offset:33024
    s_waitcnt lgkmcnt(3)
    v_bfe_u32 v98, v98, v50, 10
    v_add_lshl_u32 v98, v98, v102, 2
    v_lshl_or_b32 v222, v90, 16, v98
    v_lshlrev_b32 v98, 1, v98
    ds_write_b32 v220, v222 offset:33280
    s_waitcnt lgkmcnt(3)
    v_bfe_u32 v99, v99, v51, 10
    v_add_lshl_u32 v99, v99, v103, 2
    v_lshl_or_b32 v222, v91, 16, v99
    v_lshlrev_b32 v99, 1, v99
    ds_write_b32 v220, v222 offset:33536
K2_PLOOP:
    v_cmp_lt_u32_e64 s[32:33], s99, v88
    v_cmp_lt_u32_e64 s[34:35], s99, v89
    v_cmp_lt_u32_e64 s[36:37], s99, v90
    v_cmp_lt_u32_e64 s[38:39], s99, v91
    s_add_u32 s99, s99, 1
    v_cmp_eq_u32_e64 s[40:41], s99, v76
    v_cmp_eq_u32_e64 s[42:43], s99, v77
    v_cmp_eq_u32_e64 s[44:45], s99, v78
    v_cmp_eq_u32_e64 s[46:47], s99, v79
    s_mov_b64 exec, s[32:33]
    ds_write_b64 v96, v[172:173] offset:512
    s_mov_b64 exec, s[34:35]
    ds_write_b64 v97, v[174:175] offset:512
    s_mov_b64 exec, s[36:37]
    ds_write_b64 v98, v[176:177] offset:512
    s_mov_b64 exec, s[38:39]
    ds_write_b64 v99, v[178:179] offset:512
    s_mov_b64 exec, -1
    v_cmp_lt_u32 vcc, s99, v224
    v_cndmask_b32_e64 v222, 8, v225, s[40:41]
    v_add_u32 v172, v172, v222
    v_add_u32 v96, 8, v96
    v_cndmask_b32_e64 v222, 8, v225, s[42:43]
    v_add_u32 v174, v174, v222
    v_add_u32 v97, 8, v97
    v_cndmask_b32_e64 v222, 8, v225, s[44:45]
    v_add_u32 v176, v176, v222
    v_add_u32 v98, 8, v98
    v_cndmask_b32_e64 v222, 8, v225, s[46:47]
    v_add_u32 v178, v178, v222
    v_add_u32 v99, 8, v99
    s_cbranch_vccnz K2_PLOOP
    v_mov_b32 v222, s99
    ds_write_b32 v228, v222 offset:104
    s_waitcnt vmcnt(0)
K2_B3:
    s_mov_b64 exec, -1
    s_lshl_b32 s95, s100, 8
    v_and_b32 v220, 31, v250
    v_lshl_add_u32 v220, v220, 3, s95
    s_mov_b32 s6, 0
    s_waitcnt vmcnt(3) lgkmcnt(0)
    s_barrier
    ds_read_b64 v[220:221], v220 offset:512
    ds_read_b32 v222, v229 offset:104
    s_waitcnt lgkmcnt(0)
    v_bfe_u32 v235, v220, 18, 6
    v_and_b32 v207, 0x3ffff, v220
    v_lshrrev_b32 v249, 24, v220
    v_mov_b32 v206, v221
    v_readfirstlane_b32 s97, v222
    v_cmp_lt_u32_e64 s[28:29], s6, v235
    s_add_u32 s6, s6, 1
    v_add_u32 v221, s4, v249
    buffer_load_dwordx2 v[240:241], v221, s[16:19], 0 idxen
    v_cndmask_b32_e64 v203, 0, v207, s[28:29]
    v_add_u32 v207, v207, v206
    ds_read_b32 v218, v203
    ds_read_u16 v203, v203 offset:4
    v_bfe_u32 v220, v249, 1, 3
    v_lshlrev_b32 v220, 4, v220
    v_lshlrev_b32 v221, 2, v219
    v_xor_b32 v220, v220, v221
    v_lshl_add_u32 v220, v249, 7, v220
    v_add_u32 v220, 100352, v220
    v_xor_b32 v221, 16, v220
    v_xor_b32 v222, 32, v220
    v_xor_b32 v223, 48, v220
    s_waitcnt lgkmcnt(0)
    ds_bpermute_b32 v210, v239, v203 offset:0
    ds_bpermute_b32 v212, v239, v203 offset:32
    ds_bpermute_b32 v214, v239, v203 offset:64
    ds_bpermute_b32 v216, v239, v203 offset:96
    ds_read_b128 v[172:175], v220
    ds_read_b128 v[176:179], v221
    ds_read_b128 v[180:183], v222
    ds_read_b128 v[184:187], v223
    buffer_load_dwordx4 v[188:191], v[218:219], s[12:15], 0 idxen offen
    buffer_load_dwordx2 v[200:201], v203, s[16:19], 0 idxen
    v_cmp_lt_u32_e64 s[30:31], s6, v235
    s_add_u32 s6, s6, 1
    s_cmp_eq_u64 s[28:29], 0
    s_cbranch_scc1 K2_EMPTY
    s_waitcnt lgkmcnt(4)
    s_add_u32 m0, s94, 0
    s_nop 0
    buffer_load_dwordx4 v[210:211], s[8:11], 0 idxen offen lds
    s_add_u32 m0, s94, 1024
    s_nop 0
    buffer_load_dwordx4 v[212:213], s[8:11], 0 idxen offen lds
    s_add_u32 m0, s94, 2048
    s_nop 0
    buffer_load_dwordx4 v[214:215], s[8:11], 0 idxen offen lds
    s_add_u32 m0, s94, 3072
    s_nop 0
    buffer_load_dwordx4 v[216:217], s[8:11], 0 idxen offen lds
    v_cndmask_b32_e64 v203, 0, v207, s[30:31]
    v_add_u32 v207, v207, v206
    ds_read_b32 v218, v203
    ds_read_u16 v203, v203 offset:4
    s_waitcnt lgkmcnt(0)
    ds_bpermute_b32 v210, v239, v203 offset:0
    ds_bpermute_b32 v212, v239, v203 offset:32
    ds_bpermute_b32 v214, v239, v203 offset:64
    ds_bpermute_b32 v216, v239, v203 offset:96
    buffer_load_dwordx4 v[192:195], v[218:219], s[12:15], 0 idxen offen
    buffer_load_dwordx2 v[204:205], v203, s[16:19], 0 idxen
    v_cmp_lt_u32_e64 s[32:33], s6, v235
    s_add_u32 s6, s6, 1
    s_waitcnt lgkmcnt(0)
    s_add_u32 m0, s94, 32768
    s_nop 0
    buffer_load_dwordx4 v[210:211], s[8:11], 0 idxen offen lds
    s_add_u32 m0, s94, 33792
    s_nop 0
    buffer_load_dwordx4 v[212:213], s[8:11], 0 idxen offen lds
    s_add_u32 m0, s94, 34816
    s_nop 0
    buffer_load_dwordx4 v[214:215], s[8:11], 0 idxen offen lds
    s_add_u32 m0, s94, 35840
    s_nop 0
    buffer_load_dwordx4 v[216:217], s[8:11], 0 idxen offen lds
    v_cndmask_b32_e64 v203, 0, v207, s[32:33]
    v_add_u32 v207, v207, v206
    ds_read_b32 v218, v203
    ds_read_u16 v203, v203 offset:4
    s_waitcnt lgkmcnt(0)
    ds_bpermute_b32 v210, v239, v203 offset:0
    ds_bpermute_b32 v212, v239, v203 offset:32
    ds_bpermute_b32 v214, v239, v203 offset:64
    ds_bpermute_b32 v216, v239, v203 offset:96
    v_and_b32 v221, 63, v250
    v_lshlrev_b32 v220, 4, v221
    v_lshlrev_b32 v221, 2, v221
    v_add_u32 v220, 138240, v220
    v_lshlrev_b32 v222, 3, v219
    v_add_u32 v221, 156672, v221
    v_add_u32 v222, 157696, v222
    ds_read_b128 v[140:143], v220 offset:0
    ds_read_b128 v[144:147], v220 offset:1024
    ds_read_b128 v[148:151], v220 offset:2048
    ds_read_b128 v[152:155], v220 offset:3072
    ds_read_b128 v[156:159], v220 offset:4096
    ds_read_b128 v[160:163], v220 offset:5120
    ds_read_b128 v[164:167], v220 offset:6144
    ds_read_b128 v[168:171], v220 offset:7168
    ds_read_b128 v[0:3], v220 offset:8192
    ds_read_b128 v[4:7], v220 offset:9216
    ds_read_b128 v[8:11], v220 offset:10240
    ds_read_b128 v[12:15], v220 offset:11264
    ds_read_b128 v[16:19], v220 offset:12288
    ds_read_b128 v[20:23], v220 offset:13312
    ds_read_b128 v[24:27], v220 offset:14336
    ds_read_b128 v[28:31], v220 offset:15360
    ds_read_b128 v[32:35], v220 offset:16384
    ds_read_b128 v[36:39], v220 offset:17408
    ds_read_b32 v40, v221
    ds_read_b32 v42, v221 offset:256
    ds_read_b128 v[108:111], v222 offset:0
    ds_read_b128 v[112:115], v222 offset:16
    ds_read_b128 v[116:119], v222 offset:32
    ds_read_b128 v[120:123], v222 offset:48
    ds_read_b128 v[124:127], v222 offset:64
    ds_read_b128 v[128:131], v222 offset:80
    ds_read_b128 v[132:135], v222 offset:96
    ds_read_b128 v[136:139], v222 offset:112
    v_mov_b32 v76, 0
    v_mov_b32 v77, 0
    v_mov_b32 v78, 0
    v_mov_b32 v79, 0
    v_mov_b32 v80, 0
    v_mov_b32 v81, 0
    v_mov_b32 v82, 0
    v_mov_b32 v83, 0
    v_mov_b32 v84, 0
    v_mov_b32 v85, 0
    v_mov_b32 v86, 0
    v_mov_b32 v87, 0
    v_mov_b32 v88, 0
    v_mov_b32 v89, 0
    v_mov_b32 v90, 0
    v_mov_b32 v91, 0
    v_mov_b32 v92, 0
    v_mov_b32 v93, 0
    v_mov_b32 v94, 0
    v_mov_b32 v95, 0
    v_mov_b32 v96, 0
    v_mov_b32 v97, 0
    v_mov_b32 v98, 0
    v_mov_b32 v99, 0
    v_mov_b32 v100, 0
    v_mov_b32 v101, 0
    v_mov_b32 v102, 0
    v_mov_b32 v103, 0
    v_mov_b32 v104, 0
    v_mov_b32 v105, 0
    v_mov_b32 v106, 0
    v_mov_b32 v107, 0
    v_mov_b32 v244, 0
    v_mov_b32 v245, 0
    v_mov_b32 v246, 0
    v_mov_b32 v247, 0
    s_waitcnt lgkmcnt(0)
    v_mfma_f32_32x32x16_bf16 v[44:59], v[140:143], v[172:175], 0
    v_mfma_f32_32x32x16_bf16 v[60:75], v[156:159], v[172:175], 0
    v_mfma_f32_32x32x16_bf16 v[44:59], v[144:147], v[176:179], v[44:59]
    v_mfma_f32_32x32x16_bf16 v[60:75], v[160:163], v[176:179], v[60:75]
    v_mfma_f32_32x32x16_bf16 v[44:59], v[148:151], v[180:183], v[44:59]
    v_mfma_f32_32x32x16_bf16 v[60:75], v[164:167], v[180:183], v[60:75]
    v_mfma_f32_32x32x16_bf16 v[44:59], v[152:155], v[184:187], v[44:59]
    v_mfma_f32_32x32x16_bf16 v[60:75], v[168:171], v[184:187], v[60:75]
    s_waitcnt vmcnt(6)
    ds_read_b128 v[172:175], v251 offset:0
    ds_read_b128 v[176:179], v252 offset:0
    ds_read_b128 v[180:183], v253 offset:0
    ds_read_b128 v[184:187], v254 offset:0
    v_mov_b32 v242, v241
    v_and_b32 v241, 0xffff0000, v240
    v_lshlrev_b32 v240, 16, v240
    v_lshlrev_b32 v232, 16, v200
    v_and_b32 v233, 0xffff0000, v200
    v_sub_f32 v234, v242, v201
    v_pk_add_f32 v[232:233], v[240:241], v[232:233] neg_lo:[0,1] neg_hi:[0,1]
    v_mul_f32 v208, v232, v232
    v_fmac_f32 v208, v233, v233
    v_fmac_f32 v208, v234, v234
    v_cvt_pk_bf16_f32 v208, v208, v208
    s_waitcnt lgkmcnt(0)
    s_nop 0
    v_mfma_f32_32x32x8_bf16 v[140:155], v[40:41], v[208:209], v[44:59]
    v_mfma_f32_32x32x16_bf16 v[140:155], v[32:35], v[188:191], v[140:155]
    v_mfma_f32_32x32x16_bf16 v[140:155], v[0:3], v[172:175], v[140:155]
    v_mfma_f32_32x32x16_bf16 v[140:155], v[4:7], v[176:179], v[140:155]
    v_mfma_f32_32x32x16_bf16 v[140:155], v[8:11], v[180:183], v[140:155]
    v_mfma_f32_32x32x16_bf16 v[140:155], v[12:15], v[184:187], v[140:155]
    s_nop 7
K2_LOOP:
    v_mfma_f32_32x32x8_bf16 v[156:171], v[42:43], v[208:209], v[60:75]
    s_mov_b64 exec, s[28:29]
    s_nop 1
    v_exp_f32 v220, v140
    v_exp_f32 v221, v141
    v_exp_f32 v222, v142
    v_exp_f32 v223, v143
    v_mfma_f32_32x32x16_bf16 v[156:171], v[36:39], v[188:191], v[156:171]
    v_exp_f32 v224, v144
    v_exp_f32 v225, v145
    s_bitcmp1_b32 s5, 2
    s_cbranch_scc0 K2_VP1
    s_setprio 1
K2_VP1:
    s_waitcnt lgkmcnt(0)
    s_mov_b64 exec, -1
    s_add_u32 m0, s94, 0
    s_nop 0
    buffer_load_dwordx4 v[210:211], s[8:11], 0 idxen offen lds
    s_add_u32 m0, s94, 1024
    s_nop 0
    buffer_load_dwordx4 v[212:213], s[8:11], 0 idxen offen lds
    s_add_u32 m0, s94, 2048
    s_nop 0
    buffer_load_dwordx4 v[214:215], s[8:11], 0 idxen offen lds
    s_add_u32 m0, s94, 3072
    s_nop 0
    buffer_load_dwordx4 v[216:217], s[8:11], 0 idxen offen lds
    s_mov_b64 exec, s[28:29]
    s_setprio 0
    v_exp_f32 v226, v146
    v_exp_f32 v227, v147
    v_pk_add_f32 v[220:221], v[220:221], 1.0 op_sel_hi:[1,0]
    v_pk_add_f32 v[222:223], v[222:223], 1.0 op_sel_hi:[1,0]
    v_pk_add_f32 v[224:225], v[224:225], 1.0 op_sel_hi:[1,0]
    v_pk_add_f32 v[226:227], v[226:227], 1.0 op_sel_hi:[1,0]
    v_mfma_f32_32x32x16_bf16 v[156:171], v[16:19], v[172:175], v[156:171]
    v_rcp_f32 v220, v220
    v_rcp_f32 v221, v221
    v_rcp_f32 v222, v222
    v_rcp_f32 v223, v223
    v_mfma_f32_32x32x16_bf16 v[156:171], v[20:23], v[176:179], v[156:171]
    v_rcp_f32 v224, v224
    v_rcp_f32 v225, v225
    v_rcp_f32 v226, v226
    v_rcp_f32 v227, v227
    v_pk_fma_f32 v[76:77], v[140:141], v[220:221], v[76:77]
    v_pk_fma_f32 v[78:79], v[142:143], v[222:223], v[78:79]
    v_pk_fma_f32 v[80:81], v[144:145], v[224:225], v[80:81]
    v_pk_fma_f32 v[82:83], v[146:147], v[226:227], v[82:83]
    v_pk_mul_f32 v[228:229], v[76:77], v[108:109]
    v_pk_mul_f32 v[230:231], v[78:79], v[110:111]
    v_pk_fma_f32 v[228:229], v[80:81], v[112:113], v[228:229]
    v_pk_fma_f32 v[230:231], v[82:83], v[114:115], v[230:231]
    v_mfma_f32_32x32x16_bf16 v[156:171], v[24:27], v[180:183], v[156:171]
    v_exp_f32 v220, v148
    v_exp_f32 v221, v149
    v_exp_f32 v222, v150
    v_exp_f32 v223, v151
    v_mfma_f32_32x32x16_bf16 v[156:171], v[28:31], v[184:187], v[156:171]
    v_exp_f32 v224, v152
    v_exp_f32 v225, v153
    v_exp_f32 v226, v154
    buffer_load_dwordx4 v[196:199], v[218:219], s[12:15], 0 idxen offen
    buffer_load_dwordx2 v[200:201], v203, s[16:19], 0 idxen
    v_exp_f32 v227, v155
    s_waitcnt vmcnt(6)
    ds_read_b128 v[172:175], v251 offset:32768
    ds_read_b128 v[176:179], v252 offset:32768
    ds_read_b128 v[180:183], v253 offset:32768
    ds_read_b128 v[184:187], v254 offset:32768
    v_cmp_lt_u32_e64 s[34:35], s6, v235
    s_add_u32 s6, s6, 1
    v_lshlrev_b32 v236, 16, v204
    v_and_b32 v237, 0xffff0000, v204
    v_sub_f32 v238, v242, v205
    v_pk_add_f32 v[236:237], v[240:241], v[236:237] neg_lo:[0,1] neg_hi:[0,1]
    v_mul_f32 v208, v236, v236
    v_fmac_f32 v208, v237, v237
    v_fmac_f32 v208, v238, v238
    v_cvt_pk_bf16_f32 v208, v208, v208
    v_cndmask_b32_e64 v203, 0, v207, s[34:35]
    v_add_u32 v207, v207, v206
    ds_read_b32 v218, v203
    ds_read_u16 v203, v203 offset:4
    v_pk_add_f32 v[220:221], v[220:221], 1.0 op_sel_hi:[1,0]
    v_pk_add_f32 v[222:223], v[222:223], 1.0 op_sel_hi:[1,0]
    v_pk_add_f32 v[224:225], v[224:225], 1.0 op_sel_hi:[1,0]
    v_pk_add_f32 v[226:227], v[226:227], 1.0 op_sel_hi:[1,0]
    v_rcp_f32 v220, v220
    v_rcp_f32 v221, v221
    v_rcp_f32 v222, v222
    v_rcp_f32 v223, v223
    v_rcp_f32 v224, v224
    v_rcp_f32 v225, v225
    v_rcp_f32 v226, v226
    v_rcp_f32 v227, v227
    s_waitcnt lgkmcnt(0)
    s_mov_b64 exec, -1
    ds_bpermute_b32 v210, v239, v203 offset:0
    ds_bpermute_b32 v212, v239, v203 offset:32
    ds_bpermute_b32 v214, v239, v203 offset:64
    ds_bpermute_b32 v216, v239, v203 offset:96
    s_mov_b64 exec, s[28:29]
    v_pk_fma_f32 v[84:85], v[148:149], v[220:221], v[84:85]
    v_pk_fma_f32 v[86:87], v[150:151], v[222:223], v[86:87]
    v_pk_fma_f32 v[88:89], v[152:153], v[224:225], v[88:89]
    v_pk_fma_f32 v[90:91], v[154:155], v[226:227], v[90:91]
    v_pk_fma_f32 v[228:229], v[84:85], v[116:117], v[228:229]
    v_pk_fma_f32 v[230:231], v[86:87], v[118:119], v[230:231]
    v_pk_fma_f32 v[228:229], v[88:89], v[120:121], v[228:229]
    v_pk_fma_f32 v[230:231], v[90:91], v[122:123], v[230:231]
    v_mfma_f32_32x32x8_bf16 v[140:155], v[40:41], v[208:209], v[44:59]
    v_exp_f32 v220, v156
    v_exp_f32 v221, v157
    v_exp_f32 v222, v158
    v_exp_f32 v223, v159
    v_mfma_f32_32x32x16_bf16 v[140:155], v[32:35], v[192:195], v[140:155]
    v_exp_f32 v224, v160
    v_exp_f32 v225, v161
    v_exp_f32 v226, v162
    v_exp_f32 v227, v163
    v_pk_add_f32 v[220:221], v[220:221], 1.0 op_sel_hi:[1,0]
    v_pk_add_f32 v[222:223], v[222:223], 1.0 op_sel_hi:[1,0]
    v_pk_add_f32 v[224:225], v[224:225], 1.0 op_sel_hi:[1,0]
    v_pk_add_f32 v[226:227], v[226:227], 1.0 op_sel_hi:[1,0]
    v_mfma_f32_32x32x16_bf16 v[140:155], v[0:3], v[172:175], v[140:155]
    v_rcp_f32 v220, v220
    v_rcp_f32 v221, v221
    v_rcp_f32 v222, v222
    v_rcp_f32 v223, v223
    v_mfma_f32_32x32x16_bf16 v[140:155], v[4:7], v[176:179], v[140:155]
    v_rcp_f32 v224, v224
    v_rcp_f32 v225, v225
    v_rcp_f32 v226, v226
    v_rcp_f32 v227, v227
    v_pk_fma_f32 v[92:93], v[156:157], v[220:221], v[92:93]
    v_pk_fma_f32 v[94:95], v[158:159], v[222:223], v[94:95]
    v_pk_fma_f32 v[96:97], v[160:161], v[224:225], v[96:97]
    v_pk_fma_f32 v[98:99], v[162:163], v[226:227], v[98:99]
    v_pk_fma_f32 v[228:229], v[92:93], v[124:125], v[228:229]
    v_pk_fma_f32 v[230:231], v[94:95], v[126:127], v[230:231]
    v_pk_fma_f32 v[228:229], v[96:97], v[128:129], v[228:229]
    v_pk_fma_f32 v[230:231], v[98:99], v[130:131], v[230:231]
    v_mfma_f32_32x32x16_bf16 v[140:155], v[8:11], v[180:183], v[140:155]
    v_exp_f32 v220, v164
    v_exp_f32 v221, v165
    v_exp_f32 v222, v166
    v_exp_f32 v223, v167
    v_mfma_f32_32x32x16_bf16 v[140:155], v[12:15], v[184:187], v[140:155]
    v_exp_f32 v224, v168
    v_exp_f32 v225, v169
    v_exp_f32 v226, v170
    v_exp_f32 v227, v171
    v_pk_add_f32 v[220:221], v[220:221], 1.0 op_sel_hi:[1,0]
    v_pk_add_f32 v[222:223], v[222:223], 1.0 op_sel_hi:[1,0]
    v_pk_add_f32 v[224:225], v[224:225], 1.0 op_sel_hi:[1,0]
    v_pk_add_f32 v[226:227], v[226:227], 1.0 op_sel_hi:[1,0]
    v_rcp_f32 v220, v220
    v_rcp_f32 v221, v221
    v_rcp_f32 v222, v222
    v_rcp_f32 v223, v223
    v_rcp_f32 v224, v224
    v_rcp_f32 v225, v225
    v_rcp_f32 v226, v226
    v_rcp_f32 v227, v227
    v_pk_fma_f32 v[100:101], v[164:165], v[220:221], v[100:101]
    v_pk_fma_f32 v[102:103], v[166:167], v[222:223], v[102:103]
    v_pk_fma_f32 v[104:105], v[168:169], v[224:225], v[104:105]
    v_pk_fma_f32 v[106:107], v[170:171], v[226:227], v[106:107]
    v_pk_fma_f32 v[228:229], v[100:101], v[132:133], v[228:229]
    v_pk_fma_f32 v[230:231], v[102:103], v[134:135], v[230:231]
    v_pk_fma_f32 v[228:229], v[104:105], v[136:137], v[228:229]
    v_pk_fma_f32 v[230:231], v[106:107], v[138:139], v[230:231]
    v_pk_add_f32 v[228:229], v[228:229], v[230:231]
    s_cmp_eq_u64 s[30:31], 0
    v_add_f32 v243, v228, v229
    v_sub_f32 v248, v243, v247
    v_pk_fma_f32 v[244:245], v[232:233], v[248:249], v[244:245] op_sel_hi:[1,0,1]
    v_fmac_f32 v246, v234, v248
    s_mov_b64 exec, -1
    s_cbranch_scc1 K2_DONE
    v_mfma_f32_32x32x8_bf16 v[156:171], v[42:43], v[208:209], v[60:75]
    s_mov_b64 exec, s[30:31]
    v_exp_f32 v220, v140
    v_exp_f32 v221, v141
    v_exp_f32 v222, v142
    v_exp_f32 v223, v143
    v_mfma_f32_32x32x16_bf16 v[156:171], v[36:39], v[192:195], v[156:171]
    v_exp_f32 v224, v144
    v_exp_f32 v225, v145
    s_bitcmp1_b32 s5, 2
    s_cbranch_scc0 K2_VP3
    s_setprio 1
K2_VP3:
    s_waitcnt lgkmcnt(0)
    s_mov_b64 exec, -1
    s_add_u32 m0, s94, 32768
    s_nop 0
    buffer_load_dwordx4 v[210:211], s[8:11], 0 idxen offen lds
    s_add_u32 m0, s94, 33792
    s_nop 0
    buffer_load_dwordx4 v[212:213], s[8:11], 0 idxen offen lds
    s_add_u32 m0, s94, 34816
    s_nop 0
    buffer_load_dwordx4 v[214:215], s[8:11], 0 idxen offen lds
    s_add_u32 m0, s94, 35840
    s_nop 0
    buffer_load_dwordx4 v[216:217], s[8:11], 0 idxen offen lds
    s_mov_b64 exec, s[30:31]
    s_setprio 0
    v_exp_f32 v226, v146
    v_exp_f32 v227, v147
    v_pk_add_f32 v[220:221], v[220:221], 1.0 op_sel_hi:[1,0]
    v_pk_add_f32 v[222:223], v[222:223], 1.0 op_sel_hi:[1,0]
    v_pk_add_f32 v[224:225], v[224:225], 1.0 op_sel_hi:[1,0]
    v_pk_add_f32 v[226:227], v[226:227], 1.0 op_sel_hi:[1,0]
    v_mfma_f32_32x32x16_bf16 v[156:171], v[16:19], v[172:175], v[156:171]
    v_rcp_f32 v220, v220
    v_rcp_f32 v221, v221
    v_rcp_f32 v222, v222
    v_rcp_f32 v223, v223
    v_mfma_f32_32x32x16_bf16 v[156:171], v[20:23], v[176:179], v[156:171]
    v_rcp_f32 v224, v224
    v_rcp_f32 v225, v225
    v_rcp_f32 v226, v226
    v_rcp_f32 v227, v227
    v_pk_fma_f32 v[76:77], v[140:141], v[220:221], v[76:77]
    v_pk_fma_f32 v[78:79], v[142:143], v[222:223], v[78:79]
    v_pk_fma_f32 v[80:81], v[144:145], v[224:225], v[80:81]
    v_pk_fma_f32 v[82:83], v[146:147], v[226:227], v[82:83]
    v_pk_mul_f32 v[228:229], v[76:77], v[108:109]
    v_pk_mul_f32 v[230:231], v[78:79], v[110:111]
    v_pk_fma_f32 v[228:229], v[80:81], v[112:113], v[228:229]
    v_pk_fma_f32 v[230:231], v[82:83], v[114:115], v[230:231]
    v_mfma_f32_32x32x16_bf16 v[156:171], v[24:27], v[180:183], v[156:171]
    v_exp_f32 v220, v148
    v_exp_f32 v221, v149
    v_exp_f32 v222, v150
    v_exp_f32 v223, v151
    v_mfma_f32_32x32x16_bf16 v[156:171], v[28:31], v[184:187], v[156:171]
    v_exp_f32 v224, v152
    v_exp_f32 v225, v153
    v_exp_f32 v226, v154
    buffer_load_dwordx4 v[188:191], v[218:219], s[12:15], 0 idxen offen
    buffer_load_dwordx2 v[204:205], v203, s[16:19], 0 idxen
    v_exp_f32 v227, v155
    s_waitcnt vmcnt(6)
    ds_read_b128 v[172:175], v251 offset:0
    ds_read_b128 v[176:179], v252 offset:0
    ds_read_b128 v[180:183], v253 offset:0
    ds_read_b128 v[184:187], v254 offset:0
    v_cmp_lt_u32_e64 s[36:37], s6, v235
    s_add_u32 s6, s6, 1
    v_lshlrev_b32 v232, 16, v200
    v_and_b32 v233, 0xffff0000, v200
    v_sub_f32 v234, v242, v201
    v_pk_add_f32 v[232:233], v[240:241], v[232:233] neg_lo:[0,1] neg_hi:[0,1]
    v_mul_f32 v208, v232, v232
    v_fmac_f32 v208, v233, v233
    v_fmac_f32 v208, v234, v234
    v_cvt_pk_bf16_f32 v208, v208, v208
    v_cndmask_b32_e64 v203, 0, v207, s[36:37]
    v_add_u32 v207, v207, v206
    ds_read_b32 v218, v203
    ds_read_u16 v203, v203 offset:4
    v_pk_add_f32 v[220:221], v[220:221], 1.0 op_sel_hi:[1,0]
    v_pk_add_f32 v[222:223], v[222:223], 1.0 op_sel_hi:[1,0]
    v_pk_add_f32 v[224:225], v[224:225], 1.0 op_sel_hi:[1,0]
    v_pk_add_f32 v[226:227], v[226:227], 1.0 op_sel_hi:[1,0]
    v_rcp_f32 v220, v220
    v_rcp_f32 v221, v221
    v_rcp_f32 v222, v222
    v_rcp_f32 v223, v223
    v_rcp_f32 v224, v224
    v_rcp_f32 v225, v225
    v_rcp_f32 v226, v226
    v_rcp_f32 v227, v227
    s_waitcnt lgkmcnt(0)
    s_mov_b64 exec, -1
    ds_bpermute_b32 v210, v239, v203 offset:0
    ds_bpermute_b32 v212, v239, v203 offset:32
    ds_bpermute_b32 v214, v239, v203 offset:64
    ds_bpermute_b32 v216, v239, v203 offset:96
    s_mov_b64 exec, s[30:31]
    v_pk_fma_f32 v[84:85], v[148:149], v[220:221], v[84:85]
    v_pk_fma_f32 v[86:87], v[150:151], v[222:223], v[86:87]
    v_pk_fma_f32 v[88:89], v[152:153], v[224:225], v[88:89]
    v_pk_fma_f32 v[90:91], v[154:155], v[226:227], v[90:91]
    v_pk_fma_f32 v[228:229], v[84:85], v[116:117], v[228:229]
    v_pk_fma_f32 v[230:231], v[86:87], v[118:119], v[230:231]
    v_pk_fma_f32 v[228:229], v[88:89], v[120:121], v[228:229]
    v_pk_fma_f32 v[230:231], v[90:91], v[122:123], v[230:231]
    v_mfma_f32_32x32x8_bf16 v[140:155], v[40:41], v[208:209], v[44:59]
    v_exp_f32 v220, v156
    v_exp_f32 v221, v157
    v_exp_f32 v222, v158
    v_exp_f32 v223, v159
    v_mfma_f32_32x32x16_bf16 v[140:155], v[32:35], v[196:199], v[140:155]
    v_exp_f32 v224, v160
    v_exp_f32 v225, v161
    v_exp_f32 v226, v162
    v_exp_f32 v227, v163
    v_pk_add_f32 v[220:221], v[220:221], 1.0 op_sel_hi:[1,0]
    v_pk_add_f32 v[222:223], v[222:223], 1.0 op_sel_hi:[1,0]
    v_pk_add_f32 v[224:225], v[224:225], 1.0 op_sel_hi:[1,0]
    v_pk_add_f32 v[226:227], v[226:227], 1.0 op_sel_hi:[1,0]
    v_mfma_f32_32x32x16_bf16 v[140:155], v[0:3], v[172:175], v[140:155]
    v_rcp_f32 v220, v220
    v_rcp_f32 v221, v221
    v_rcp_f32 v222, v222
    v_rcp_f32 v223, v223
    v_mfma_f32_32x32x16_bf16 v[140:155], v[4:7], v[176:179], v[140:155]
    v_rcp_f32 v224, v224
    v_rcp_f32 v225, v225
    v_rcp_f32 v226, v226
    v_rcp_f32 v227, v227
    v_pk_fma_f32 v[92:93], v[156:157], v[220:221], v[92:93]
    v_pk_fma_f32 v[94:95], v[158:159], v[222:223], v[94:95]
    v_pk_fma_f32 v[96:97], v[160:161], v[224:225], v[96:97]
    v_pk_fma_f32 v[98:99], v[162:163], v[226:227], v[98:99]
    v_pk_fma_f32 v[228:229], v[92:93], v[124:125], v[228:229]
    v_pk_fma_f32 v[230:231], v[94:95], v[126:127], v[230:231]
    v_pk_fma_f32 v[228:229], v[96:97], v[128:129], v[228:229]
    v_pk_fma_f32 v[230:231], v[98:99], v[130:131], v[230:231]
    v_mfma_f32_32x32x16_bf16 v[140:155], v[8:11], v[180:183], v[140:155]
    v_exp_f32 v220, v164
    v_exp_f32 v221, v165
    v_exp_f32 v222, v166
    v_exp_f32 v223, v167
    v_mfma_f32_32x32x16_bf16 v[140:155], v[12:15], v[184:187], v[140:155]
    v_exp_f32 v224, v168
    v_exp_f32 v225, v169
    v_exp_f32 v226, v170
    v_exp_f32 v227, v171
    v_pk_add_f32 v[220:221], v[220:221], 1.0 op_sel_hi:[1,0]
    v_pk_add_f32 v[222:223], v[222:223], 1.0 op_sel_hi:[1,0]
    v_pk_add_f32 v[224:225], v[224:225], 1.0 op_sel_hi:[1,0]
    v_pk_add_f32 v[226:227], v[226:227], 1.0 op_sel_hi:[1,0]
    v_rcp_f32 v220, v220
    v_rcp_f32 v221, v221
    v_rcp_f32 v222, v222
    v_rcp_f32 v223, v223
    v_rcp_f32 v224, v224
    v_rcp_f32 v225, v225
    v_rcp_f32 v226, v226
    v_rcp_f32 v227, v227
    v_pk_fma_f32 v[100:101], v[164:165], v[220:221], v[100:101]
    v_pk_fma_f32 v[102:103], v[166:167], v[222:223], v[102:103]
    v_pk_fma_f32 v[104:105], v[168:169], v[224:225], v[104:105]
    v_pk_fma_f32 v[106:107], v[170:171], v[226:227], v[106:107]
    v_pk_fma_f32 v[228:229], v[100:101], v[132:133], v[228:229]
    v_pk_fma_f32 v[230:231], v[102:103], v[134:135], v[230:231]
    v_pk_fma_f32 v[228:229], v[104:105], v[136:137], v[228:229]
    v_pk_fma_f32 v[230:231], v[106:107], v[138:139], v[230:231]
    v_pk_add_f32 v[228:229], v[228:229], v[230:231]
    s_cmp_eq_u64 s[32:33], 0
    v_add_f32 v247, v228, v229
    v_sub_f32 v248, v247, v243
    v_pk_fma_f32 v[244:245], v[236:237], v[248:249], v[244:245] op_sel_hi:[1,0,1]
    v_fmac_f32 v246, v238, v248
    s_mov_b64 exec, -1
    s_cbranch_scc1 K2_DONE
    v_mfma_f32_32x32x8_bf16 v[156:171], v[42:43], v[208:209], v[60:75]
    s_mov_b64 exec, s[32:33]
    v_exp_f32 v220, v140
    v_exp_f32 v221, v141
    v_exp_f32 v222, v142
    v_exp_f32 v223, v143
    v_mfma_f32_32x32x16_bf16 v[156:171], v[36:39], v[196:199], v[156:171]
    v_exp_f32 v224, v144
    v_exp_f32 v225, v145
    s_bitcmp1_b32 s5, 2
    s_cbranch_scc0 K2_VP5
    s_setprio 1
K2_VP5:
    s_waitcnt lgkmcnt(0)
    s_mov_b64 exec, -1
    s_add_u32 m0, s94, 0
    s_nop 0
    buffer_load_dwordx4 v[210:211], s[8:11], 0 idxen offen lds
    s_add_u32 m0, s94, 1024
    s_nop 0
    buffer_load_dwordx4 v[212:213], s[8:11], 0 idxen offen lds
    s_add_u32 m0, s94, 2048
    s_nop 0
    buffer_load_dwordx4 v[214:215], s[8:11], 0 idxen offen lds
    s_add_u32 m0, s94, 3072
    s_nop 0
    buffer_load_dwordx4 v[216:217], s[8:11], 0 idxen offen lds
    s_mov_b64 exec, s[32:33]
    s_setprio 0
    v_exp_f32 v226, v146
    v_exp_f32 v227, v147
    v_pk_add_f32 v[220:221], v[220:221], 1.0 op_sel_hi:[1,0]
    v_pk_add_f32 v[222:223], v[222:223], 1.0 op_sel_hi:[1,0]
    v_pk_add_f32 v[224:225], v[224:225], 1.0 op_sel_hi:[1,0]
    v_pk_add_f32 v[226:227], v[226:227], 1.0 op_sel_hi:[1,0]
    v_mfma_f32_32x32x16_bf16 v[156:171], v[16:19], v[172:175], v[156:171]
    v_rcp_f32 v220, v220
    v_rcp_f32 v221, v221
    v_rcp_f32 v222, v222
    v_rcp_f32 v223, v223
    v_mfma_f32_32x32x16_bf16 v[156:171], v[20:23], v[176:179], v[156:171]
    v_rcp_f32 v224, v224
    v_rcp_f32 v225, v225
    v_rcp_f32 v226, v226
    v_rcp_f32 v227, v227
    v_pk_fma_f32 v[76:77], v[140:141], v[220:221], v[76:77]
    v_pk_fma_f32 v[78:79], v[142:143], v[222:223], v[78:79]
    v_pk_fma_f32 v[80:81], v[144:145], v[224:225], v[80:81]
    v_pk_fma_f32 v[82:83], v[146:147], v[226:227], v[82:83]
    v_pk_mul_f32 v[228:229], v[76:77], v[108:109]
    v_pk_mul_f32 v[230:231], v[78:79], v[110:111]
    v_pk_fma_f32 v[228:229], v[80:81], v[112:113], v[228:229]
    v_pk_fma_f32 v[230:231], v[82:83], v[114:115], v[230:231]
    v_mfma_f32_32x32x16_bf16 v[156:171], v[24:27], v[180:183], v[156:171]
    v_exp_f32 v220, v148
    v_exp_f32 v221, v149
    v_exp_f32 v222, v150
    v_exp_f32 v223, v151
    v_mfma_f32_32x32x16_bf16 v[156:171], v[28:31], v[184:187], v[156:171]
    v_exp_f32 v224, v152
    v_exp_f32 v225, v153
    v_exp_f32 v226, v154
    buffer_load_dwordx4 v[192:195], v[218:219], s[12:15], 0 idxen offen
    buffer_load_dwordx2 v[200:201], v203, s[16:19], 0 idxen
    v_exp_f32 v227, v155
    s_waitcnt vmcnt(6)
    ds_read_b128 v[172:175], v251 offset:32768
    ds_read_b128 v[176:179], v252 offset:32768
    ds_read_b128 v[180:183], v253 offset:32768
    ds_read_b128 v[184:187], v254 offset:32768
    v_cmp_lt_u32_e64 s[38:39], s6, v235
    s_add_u32 s6, s6, 1
    v_lshlrev_b32 v236, 16, v204
    v_and_b32 v237, 0xffff0000, v204
    v_sub_f32 v238, v242, v205
    v_pk_add_f32 v[236:237], v[240:241], v[236:237] neg_lo:[0,1] neg_hi:[0,1]
    v_mul_f32 v208, v236, v236
    v_fmac_f32 v208, v237, v237
    v_fmac_f32 v208, v238, v238
    v_cvt_pk_bf16_f32 v208, v208, v208
    v_cndmask_b32_e64 v203, 0, v207, s[38:39]
    v_add_u32 v207, v207, v206
    ds_read_b32 v218, v203
    ds_read_u16 v203, v203 offset:4
    v_pk_add_f32 v[220:221], v[220:221], 1.0 op_sel_hi:[1,0]
    v_pk_add_f32 v[222:223], v[222:223], 1.0 op_sel_hi:[1,0]
    v_pk_add_f32 v[224:225], v[224:225], 1.0 op_sel_hi:[1,0]
    v_pk_add_f32 v[226:227], v[226:227], 1.0 op_sel_hi:[1,0]
    v_rcp_f32 v220, v220
    v_rcp_f32 v221, v221
    v_rcp_f32 v222, v222
    v_rcp_f32 v223, v223
    v_rcp_f32 v224, v224
    v_rcp_f32 v225, v225
    v_rcp_f32 v226, v226
    v_rcp_f32 v227, v227
    s_waitcnt lgkmcnt(0)
    s_mov_b64 exec, -1
    ds_bpermute_b32 v210, v239, v203 offset:0
    ds_bpermute_b32 v212, v239, v203 offset:32
    ds_bpermute_b32 v214, v239, v203 offset:64
    ds_bpermute_b32 v216, v239, v203 offset:96
    s_mov_b64 exec, s[32:33]
    v_pk_fma_f32 v[84:85], v[148:149], v[220:221], v[84:85]
    v_pk_fma_f32 v[86:87], v[150:151], v[222:223], v[86:87]
    v_pk_fma_f32 v[88:89], v[152:153], v[224:225], v[88:89]
    v_pk_fma_f32 v[90:91], v[154:155], v[226:227], v[90:91]
    v_pk_fma_f32 v[228:229], v[84:85], v[116:117], v[228:229]
    v_pk_fma_f32 v[230:231], v[86:87], v[118:119], v[230:231]
    v_pk_fma_f32 v[228:229], v[88:89], v[120:121], v[228:229]
    v_pk_fma_f32 v[230:231], v[90:91], v[122:123], v[230:231]
    v_mfma_f32_32x32x8_bf16 v[140:155], v[40:41], v[208:209], v[44:59]
    v_exp_f32 v220, v156
    v_exp_f32 v221, v157
    v_exp_f32 v222, v158
    v_exp_f32 v223, v159
    v_mfma_f32_32x32x16_bf16 v[140:155], v[32:35], v[188:191], v[140:155]
    v_exp_f32 v224, v160
    v_exp_f32 v225, v161
    v_exp_f32 v226, v162
    v_exp_f32 v227, v163
    v_pk_add_f32 v[220:221], v[220:221], 1.0 op_sel_hi:[1,0]
    v_pk_add_f32 v[222:223], v[222:223], 1.0 op_sel_hi:[1,0]
    v_pk_add_f32 v[224:225], v[224:225], 1.0 op_sel_hi:[1,0]
    v_pk_add_f32 v[226:227], v[226:227], 1.0 op_sel_hi:[1,0]
    v_mfma_f32_32x32x16_bf16 v[140:155], v[0:3], v[172:175], v[140:155]
    v_rcp_f32 v220, v220
    v_rcp_f32 v221, v221
    v_rcp_f32 v222, v222
    v_rcp_f32 v223, v223
    v_mfma_f32_32x32x16_bf16 v[140:155], v[4:7], v[176:179], v[140:155]
    v_rcp_f32 v224, v224
    v_rcp_f32 v225, v225
    v_rcp_f32 v226, v226
    v_rcp_f32 v227, v227
    v_pk_fma_f32 v[92:93], v[156:157], v[220:221], v[92:93]
    v_pk_fma_f32 v[94:95], v[158:159], v[222:223], v[94:95]
    v_pk_fma_f32 v[96:97], v[160:161], v[224:225], v[96:97]
    v_pk_fma_f32 v[98:99], v[162:163], v[226:227], v[98:99]
    v_pk_fma_f32 v[228:229], v[92:93], v[124:125], v[228:229]
    v_pk_fma_f32 v[230:231], v[94:95], v[126:127], v[230:231]
    v_pk_fma_f32 v[228:229], v[96:97], v[128:129], v[228:229]
    v_pk_fma_f32 v[230:231], v[98:99], v[130:131], v[230:231]
    v_mfma_f32_32x32x16_bf16 v[140:155], v[8:11], v[180:183], v[140:155]
    v_exp_f32 v220, v164
    v_exp_f32 v221, v165
    v_exp_f32 v222, v166
    v_exp_f32 v223, v167
    v_mfma_f32_32x32x16_bf16 v[140:155], v[12:15], v[184:187], v[140:155]
    v_exp_f32 v224, v168
    v_exp_f32 v225, v169
    v_exp_f32 v226, v170
    v_exp_f32 v227, v171
    v_pk_add_f32 v[220:221], v[220:221], 1.0 op_sel_hi:[1,0]
    v_pk_add_f32 v[222:223], v[222:223], 1.0 op_sel_hi:[1,0]
    v_pk_add_f32 v[224:225], v[224:225], 1.0 op_sel_hi:[1,0]
    v_pk_add_f32 v[226:227], v[226:227], 1.0 op_sel_hi:[1,0]
    v_rcp_f32 v220, v220
    v_rcp_f32 v221, v221
    v_rcp_f32 v222, v222
    v_rcp_f32 v223, v223
    v_rcp_f32 v224, v224
    v_rcp_f32 v225, v225
    v_rcp_f32 v226, v226
    v_rcp_f32 v227, v227
    v_pk_fma_f32 v[100:101], v[164:165], v[220:221], v[100:101]
    v_pk_fma_f32 v[102:103], v[166:167], v[222:223], v[102:103]
    v_pk_fma_f32 v[104:105], v[168:169], v[224:225], v[104:105]
    v_pk_fma_f32 v[106:107], v[170:171], v[226:227], v[106:107]
    v_pk_fma_f32 v[228:229], v[100:101], v[132:133], v[228:229]
    v_pk_fma_f32 v[230:231], v[102:103], v[134:135], v[230:231]
    v_pk_fma_f32 v[228:229], v[104:105], v[136:137], v[228:229]
    v_pk_fma_f32 v[230:231], v[106:107], v[138:139], v[230:231]
    v_pk_add_f32 v[228:229], v[228:229], v[230:231]
    s_cmp_eq_u64 s[34:35], 0
    v_add_f32 v243, v228, v229
    v_sub_f32 v248, v243, v247
    v_pk_fma_f32 v[244:245], v[232:233], v[248:249], v[244:245] op_sel_hi:[1,0,1]
    v_fmac_f32 v246, v234, v248
    s_mov_b64 exec, -1
    s_cbranch_scc1 K2_DONE
    v_mfma_f32_32x32x8_bf16 v[156:171], v[42:43], v[208:209], v[60:75]
    s_mov_b64 exec, s[34:35]
    v_exp_f32 v220, v140
    v_exp_f32 v221, v141
    v_exp_f32 v222, v142
    v_exp_f32 v223, v143
    v_mfma_f32_32x32x16_bf16 v[156:171], v[36:39], v[188:191], v[156:171]
    v_exp_f32 v224, v144
    v_exp_f32 v225, v145
    s_bitcmp1_b32 s5, 2
    s_cbranch_scc0 K2_VP7
    s_setprio 1
K2_VP7:
    s_waitcnt lgkmcnt(0)
    s_mov_b64 exec, -1
    s_add_u32 m0, s94, 32768
    s_nop 0
    buffer_load_dwordx4 v[210:211], s[8:11], 0 idxen offen lds
    s_add_u32 m0, s94, 33792
    s_nop 0
    buffer_load_dwordx4 v[212:213], s[8:11], 0 idxen offen lds
    s_add_u32 m0, s94, 34816
    s_nop 0
    buffer_load_dwordx4 v[214:215], s[8:11], 0 idxen offen lds
    s_add_u32 m0, s94, 35840
    s_nop 0
    buffer_load_dwordx4 v[216:217], s[8:11], 0 idxen offen lds
    s_mov_b64 exec, s[34:35]
    s_setprio 0
    v_exp_f32 v226, v146
    v_exp_f32 v227, v147
    v_pk_add_f32 v[220:221], v[220:221], 1.0 op_sel_hi:[1,0]
    v_pk_add_f32 v[222:223], v[222:223], 1.0 op_sel_hi:[1,0]
    v_pk_add_f32 v[224:225], v[224:225], 1.0 op_sel_hi:[1,0]
    v_pk_add_f32 v[226:227], v[226:227], 1.0 op_sel_hi:[1,0]
    v_mfma_f32_32x32x16_bf16 v[156:171], v[16:19], v[172:175], v[156:171]
    v_rcp_f32 v220, v220
    v_rcp_f32 v221, v221
    v_rcp_f32 v222, v222
    v_rcp_f32 v223, v223
    v_mfma_f32_32x32x16_bf16 v[156:171], v[20:23], v[176:179], v[156:171]
    v_rcp_f32 v224, v224
    v_rcp_f32 v225, v225
    v_rcp_f32 v226, v226
    v_rcp_f32 v227, v227
    v_pk_fma_f32 v[76:77], v[140:141], v[220:221], v[76:77]
    v_pk_fma_f32 v[78:79], v[142:143], v[222:223], v[78:79]
    v_pk_fma_f32 v[80:81], v[144:145], v[224:225], v[80:81]
    v_pk_fma_f32 v[82:83], v[146:147], v[226:227], v[82:83]
    v_pk_mul_f32 v[228:229], v[76:77], v[108:109]
    v_pk_mul_f32 v[230:231], v[78:79], v[110:111]
    v_pk_fma_f32 v[228:229], v[80:81], v[112:113], v[228:229]
    v_pk_fma_f32 v[230:231], v[82:83], v[114:115], v[230:231]
    v_mfma_f32_32x32x16_bf16 v[156:171], v[24:27], v[180:183], v[156:171]
    v_exp_f32 v220, v148
    v_exp_f32 v221, v149
    v_exp_f32 v222, v150
    v_exp_f32 v223, v151
    v_mfma_f32_32x32x16_bf16 v[156:171], v[28:31], v[184:187], v[156:171]
    v_exp_f32 v224, v152
    v_exp_f32 v225, v153
    v_exp_f32 v226, v154
    buffer_load_dwordx4 v[196:199], v[218:219], s[12:15], 0 idxen offen
    buffer_load_dwordx2 v[204:205], v203, s[16:19], 0 idxen
    v_exp_f32 v227, v155
    s_waitcnt vmcnt(6)
    ds_read_b128 v[172:175], v251 offset:0
    ds_read_b128 v[176:179], v252 offset:0
    ds_read_b128 v[180:183], v253 offset:0
    ds_read_b128 v[184:187], v254 offset:0
    v_cmp_lt_u32_e64 s[28:29], s6, v235
    s_add_u32 s6, s6, 1
    v_lshlrev_b32 v232, 16, v200
    v_and_b32 v233, 0xffff0000, v200
    v_sub_f32 v234, v242, v201
    v_pk_add_f32 v[232:233], v[240:241], v[232:233] neg_lo:[0,1] neg_hi:[0,1]
    v_mul_f32 v208, v232, v232
    v_fmac_f32 v208, v233, v233
    v_fmac_f32 v208, v234, v234
    v_cvt_pk_bf16_f32 v208, v208, v208
    v_cndmask_b32_e64 v203, 0, v207, s[28:29]
    v_add_u32 v207, v207, v206
    ds_read_b32 v218, v203
    ds_read_u16 v203, v203 offset:4
    v_pk_add_f32 v[220:221], v[220:221], 1.0 op_sel_hi:[1,0]
    v_pk_add_f32 v[222:223], v[222:223], 1.0 op_sel_hi:[1,0]
    v_pk_add_f32 v[224:225], v[224:225], 1.0 op_sel_hi:[1,0]
    v_pk_add_f32 v[226:227], v[226:227], 1.0 op_sel_hi:[1,0]
    v_rcp_f32 v220, v220
    v_rcp_f32 v221, v221
    v_rcp_f32 v222, v222
    v_rcp_f32 v223, v223
    v_rcp_f32 v224, v224
    v_rcp_f32 v225, v225
    v_rcp_f32 v226, v226
    v_rcp_f32 v227, v227
    s_waitcnt lgkmcnt(0)
    s_mov_b64 exec, -1
    ds_bpermute_b32 v210, v239, v203 offset:0
    ds_bpermute_b32 v212, v239, v203 offset:32
    ds_bpermute_b32 v214, v239, v203 offset:64
    ds_bpermute_b32 v216, v239, v203 offset:96
    s_mov_b64 exec, s[34:35]
    v_pk_fma_f32 v[84:85], v[148:149], v[220:221], v[84:85]
    v_pk_fma_f32 v[86:87], v[150:151], v[222:223], v[86:87]
    v_pk_fma_f32 v[88:89], v[152:153], v[224:225], v[88:89]
    v_pk_fma_f32 v[90:91], v[154:155], v[226:227], v[90:91]
    v_pk_fma_f32 v[228:229], v[84:85], v[116:117], v[228:229]
    v_pk_fma_f32 v[230:231], v[86:87], v[118:119], v[230:231]
    v_pk_fma_f32 v[228:229], v[88:89], v[120:121], v[228:229]
    v_pk_fma_f32 v[230:231], v[90:91], v[122:123], v[230:231]
    v_mfma_f32_32x32x8_bf16 v[140:155], v[40:41], v[208:209], v[44:59]
    v_exp_f32 v220, v156
    v_exp_f32 v221, v157
    v_exp_f32 v222, v158
    v_exp_f32 v223, v159
    v_mfma_f32_32x32x16_bf16 v[140:155], v[32:35], v[192:195], v[140:155]
    v_exp_f32 v224, v160
    v_exp_f32 v225, v161
    v_exp_f32 v226, v162
    v_exp_f32 v227, v163
    v_pk_add_f32 v[220:221], v[220:221], 1.0 op_sel_hi:[1,0]
    v_pk_add_f32 v[222:223], v[222:223], 1.0 op_sel_hi:[1,0]
    v_pk_add_f32 v[224:225], v[224:225], 1.0 op_sel_hi:[1,0]
    v_pk_add_f32 v[226:227], v[226:227], 1.0 op_sel_hi:[1,0]
    v_mfma_f32_32x32x16_bf16 v[140:155], v[0:3], v[172:175], v[140:155]
    v_rcp_f32 v220, v220
    v_rcp_f32 v221, v221
    v_rcp_f32 v222, v222
    v_rcp_f32 v223, v223
    v_mfma_f32_32x32x16_bf16 v[140:155], v[4:7], v[176:179], v[140:155]
    v_rcp_f32 v224, v224
    v_rcp_f32 v225, v225
    v_rcp_f32 v226, v226
    v_rcp_f32 v227, v227
    v_pk_fma_f32 v[92:93], v[156:157], v[220:221], v[92:93]
    v_pk_fma_f32 v[94:95], v[158:159], v[222:223], v[94:95]
    v_pk_fma_f32 v[96:97], v[160:161], v[224:225], v[96:97]
    v_pk_fma_f32 v[98:99], v[162:163], v[226:227], v[98:99]
    v_pk_fma_f32 v[228:229], v[92:93], v[124:125], v[228:229]
    v_pk_fma_f32 v[230:231], v[94:95], v[126:127], v[230:231]
    v_pk_fma_f32 v[228:229], v[96:97], v[128:129], v[228:229]
    v_pk_fma_f32 v[230:231], v[98:99], v[130:131], v[230:231]
    v_mfma_f32_32x32x16_bf16 v[140:155], v[8:11], v[180:183], v[140:155]
    v_exp_f32 v220, v164
    v_exp_f32 v221, v165
    v_exp_f32 v222, v166
    v_exp_f32 v223, v167
    v_mfma_f32_32x32x16_bf16 v[140:155], v[12:15], v[184:187], v[140:155]
    v_exp_f32 v224, v168
    v_exp_f32 v225, v169
    v_exp_f32 v226, v170
    v_exp_f32 v227, v171
    v_pk_add_f32 v[220:221], v[220:221], 1.0 op_sel_hi:[1,0]
    v_pk_add_f32 v[222:223], v[222:223], 1.0 op_sel_hi:[1,0]
    v_pk_add_f32 v[224:225], v[224:225], 1.0 op_sel_hi:[1,0]
    v_pk_add_f32 v[226:227], v[226:227], 1.0 op_sel_hi:[1,0]
    v_rcp_f32 v220, v220
    v_rcp_f32 v221, v221
    v_rcp_f32 v222, v222
    v_rcp_f32 v223, v223
    v_rcp_f32 v224, v224
    v_rcp_f32 v225, v225
    v_rcp_f32 v226, v226
    v_rcp_f32 v227, v227
    v_pk_fma_f32 v[100:101], v[164:165], v[220:221], v[100:101]
    v_pk_fma_f32 v[102:103], v[166:167], v[222:223], v[102:103]
    v_pk_fma_f32 v[104:105], v[168:169], v[224:225], v[104:105]
    v_pk_fma_f32 v[106:107], v[170:171], v[226:227], v[106:107]
    v_pk_fma_f32 v[228:229], v[100:101], v[132:133], v[228:229]
    v_pk_fma_f32 v[230:231], v[102:103], v[134:135], v[230:231]
    v_pk_fma_f32 v[228:229], v[104:105], v[136:137], v[228:229]
    v_pk_fma_f32 v[230:231], v[106:107], v[138:139], v[230:231]
    v_pk_add_f32 v[228:229], v[228:229], v[230:231]
    s_cmp_eq_u64 s[36:37], 0
    v_add_f32 v247, v228, v229
    v_sub_f32 v248, v247, v243
    v_pk_fma_f32 v[244:245], v[236:237], v[248:249], v[244:245] op_sel_hi:[1,0,1]
    v_fmac_f32 v246, v238, v248
    s_mov_b64 exec, -1
    s_cbranch_scc1 K2_DONE
    v_mfma_f32_32x32x8_bf16 v[156:171], v[42:43], v[208:209], v[60:75]
    s_mov_b64 exec, s[36:37]
    v_exp_f32 v220, v140
    v_exp_f32 v221, v141
    v_exp_f32 v222, v142
    v_exp_f32 v223, v143
    v_mfma_f32_32x32x16_bf16 v[156:171], v[36:39], v[192:195], v[156:171]
    v_exp_f32 v224, v144
    v_exp_f32 v225, v145
    s_bitcmp1_b32 s5, 2
    s_cbranch_scc0 K2_VP9
    s_setprio 1
K2_VP9:
    s_waitcnt lgkmcnt(0)
    s_mov_b64 exec, -1
    s_add_u32 m0, s94, 0
    s_nop 0
    buffer_load_dwordx4 v[210:211], s[8:11], 0 idxen offen lds
    s_add_u32 m0, s94, 1024
    s_nop 0
    buffer_load_dwordx4 v[212:213], s[8:11], 0 idxen offen lds
    s_add_u32 m0, s94, 2048
    s_nop 0
    buffer_load_dwordx4 v[214:215], s[8:11], 0 idxen offen lds
    s_add_u32 m0, s94, 3072
    s_nop 0
    buffer_load_dwordx4 v[216:217], s[8:11], 0 idxen offen lds
    s_mov_b64 exec, s[36:37]
    s_setprio 0
    v_exp_f32 v226, v146
    v_exp_f32 v227, v147
    v_pk_add_f32 v[220:221], v[220:221], 1.0 op_sel_hi:[1,0]
    v_pk_add_f32 v[222:223], v[222:223], 1.0 op_sel_hi:[1,0]
    v_pk_add_f32 v[224:225], v[224:225], 1.0 op_sel_hi:[1,0]
    v_pk_add_f32 v[226:227], v[226:227], 1.0 op_sel_hi:[1,0]
    v_mfma_f32_32x32x16_bf16 v[156:171], v[16:19], v[172:175], v[156:171]
    v_rcp_f32 v220, v220
    v_rcp_f32 v221, v221
    v_rcp_f32 v222, v222
    v_rcp_f32 v223, v223
    v_mfma_f32_32x32x16_bf16 v[156:171], v[20:23], v[176:179], v[156:171]
    v_rcp_f32 v224, v224
    v_rcp_f32 v225, v225
    v_rcp_f32 v226, v226
    v_rcp_f32 v227, v227
    v_pk_fma_f32 v[76:77], v[140:141], v[220:221], v[76:77]
    v_pk_fma_f32 v[78:79], v[142:143], v[222:223], v[78:79]
    v_pk_fma_f32 v[80:81], v[144:145], v[224:225], v[80:81]
    v_pk_fma_f32 v[82:83], v[146:147], v[226:227], v[82:83]
    v_pk_mul_f32 v[228:229], v[76:77], v[108:109]
    v_pk_mul_f32 v[230:231], v[78:79], v[110:111]
    v_pk_fma_f32 v[228:229], v[80:81], v[112:113], v[228:229]
    v_pk_fma_f32 v[230:231], v[82:83], v[114:115], v[230:231]
    v_mfma_f32_32x32x16_bf16 v[156:171], v[24:27], v[180:183], v[156:171]
    v_exp_f32 v220, v148
    v_exp_f32 v221, v149
    v_exp_f32 v222, v150
    v_exp_f32 v223, v151
    v_mfma_f32_32x32x16_bf16 v[156:171], v[28:31], v[184:187], v[156:171]
    v_exp_f32 v224, v152
    v_exp_f32 v225, v153
    v_exp_f32 v226, v154
    buffer_load_dwordx4 v[188:191], v[218:219], s[12:15], 0 idxen offen
    buffer_load_dwordx2 v[200:201], v203, s[16:19], 0 idxen
    v_exp_f32 v227, v155
    s_waitcnt vmcnt(6)
    ds_read_b128 v[172:175], v251 offset:32768
    ds_read_b128 v[176:179], v252 offset:32768
    ds_read_b128 v[180:183], v253 offset:32768
    ds_read_b128 v[184:187], v254 offset:32768
    v_cmp_lt_u32_e64 s[30:31], s6, v235
    s_add_u32 s6, s6, 1
    v_lshlrev_b32 v236, 16, v204
    v_and_b32 v237, 0xffff0000, v204
    v_sub_f32 v238, v242, v205
    v_pk_add_f32 v[236:237], v[240:241], v[236:237] neg_lo:[0,1] neg_hi:[0,1]
    v_mul_f32 v208, v236, v236
    v_fmac_f32 v208, v237, v237
    v_fmac_f32 v208, v238, v238
    v_cvt_pk_bf16_f32 v208, v208, v208
    v_cndmask_b32_e64 v203, 0, v207, s[30:31]
    v_add_u32 v207, v207, v206
    ds_read_b32 v218, v203
    ds_read_u16 v203, v203 offset:4
    v_pk_add_f32 v[220:221], v[220:221], 1.0 op_sel_hi:[1,0]
    v_pk_add_f32 v[222:223], v[222:223], 1.0 op_sel_hi:[1,0]
    v_pk_add_f32 v[224:225], v[224:225], 1.0 op_sel_hi:[1,0]
    v_pk_add_f32 v[226:227], v[226:227], 1.0 op_sel_hi:[1,0]
    v_rcp_f32 v220, v220
    v_rcp_f32 v221, v221
    v_rcp_f32 v222, v222
    v_rcp_f32 v223, v223
    v_rcp_f32 v224, v224
    v_rcp_f32 v225, v225
    v_rcp_f32 v226, v226
    v_rcp_f32 v227, v227
    s_waitcnt lgkmcnt(0)
    s_mov_b64 exec, -1
    ds_bpermute_b32 v210, v239, v203 offset:0
    ds_bpermute_b32 v212, v239, v203 offset:32
    ds_bpermute_b32 v214, v239, v203 offset:64
    ds_bpermute_b32 v216, v239, v203 offset:96
    s_mov_b64 exec, s[36:37]
    v_pk_fma_f32 v[84:85], v[148:149], v[220:221], v[84:85]
    v_pk_fma_f32 v[86:87], v[150:151], v[222:223], v[86:87]
    v_pk_fma_f32 v[88:89], v[152:153], v[224:225], v[88:89]
    v_pk_fma_f32 v[90:91], v[154:155], v[226:227], v[90:91]
    v_pk_fma_f32 v[228:229], v[84:85], v[116:117], v[228:229]
    v_pk_fma_f32 v[230:231], v[86:87], v[118:119], v[230:231]
    v_pk_fma_f32 v[228:229], v[88:89], v[120:121], v[228:229]
    v_pk_fma_f32 v[230:231], v[90:91], v[122:123], v[230:231]
    v_mfma_f32_32x32x8_bf16 v[140:155], v[40:41], v[208:209], v[44:59]
    v_exp_f32 v220, v156
    v_exp_f32 v221, v157
    v_exp_f32 v222, v158
    v_exp_f32 v223, v159
    v_mfma_f32_32x32x16_bf16 v[140:155], v[32:35], v[196:199], v[140:155]
    v_exp_f32 v224, v160
    v_exp_f32 v225, v161
    v_exp_f32 v226, v162
    v_exp_f32 v227, v163
    v_pk_add_f32 v[220:221], v[220:221], 1.0 op_sel_hi:[1,0]
    v_pk_add_f32 v[222:223], v[222:223], 1.0 op_sel_hi:[1,0]
    v_pk_add_f32 v[224:225], v[224:225], 1.0 op_sel_hi:[1,0]
    v_pk_add_f32 v[226:227], v[226:227], 1.0 op_sel_hi:[1,0]
    v_mfma_f32_32x32x16_bf16 v[140:155], v[0:3], v[172:175], v[140:155]
    v_rcp_f32 v220, v220
    v_rcp_f32 v221, v221
    v_rcp_f32 v222, v222
    v_rcp_f32 v223, v223
    v_mfma_f32_32x32x16_bf16 v[140:155], v[4:7], v[176:179], v[140:155]
    v_rcp_f32 v224, v224
    v_rcp_f32 v225, v225
    v_rcp_f32 v226, v226
    v_rcp_f32 v227, v227
    v_pk_fma_f32 v[92:93], v[156:157], v[220:221], v[92:93]
    v_pk_fma_f32 v[94:95], v[158:159], v[222:223], v[94:95]
    v_pk_fma_f32 v[96:97], v[160:161], v[224:225], v[96:97]
    v_pk_fma_f32 v[98:99], v[162:163], v[226:227], v[98:99]
    v_pk_fma_f32 v[228:229], v[92:93], v[124:125], v[228:229]
    v_pk_fma_f32 v[230:231], v[94:95], v[126:127], v[230:231]
    v_pk_fma_f32 v[228:229], v[96:97], v[128:129], v[228:229]
    v_pk_fma_f32 v[230:231], v[98:99], v[130:131], v[230:231]
    v_mfma_f32_32x32x16_bf16 v[140:155], v[8:11], v[180:183], v[140:155]
    v_exp_f32 v220, v164
    v_exp_f32 v221, v165
    v_exp_f32 v222, v166
    v_exp_f32 v223, v167
    v_mfma_f32_32x32x16_bf16 v[140:155], v[12:15], v[184:187], v[140:155]
    v_exp_f32 v224, v168
    v_exp_f32 v225, v169
    v_exp_f32 v226, v170
    v_exp_f32 v227, v171
    v_pk_add_f32 v[220:221], v[220:221], 1.0 op_sel_hi:[1,0]
    v_pk_add_f32 v[222:223], v[222:223], 1.0 op_sel_hi:[1,0]
    v_pk_add_f32 v[224:225], v[224:225], 1.0 op_sel_hi:[1,0]
    v_pk_add_f32 v[226:227], v[226:227], 1.0 op_sel_hi:[1,0]
    v_rcp_f32 v220, v220
    v_rcp_f32 v221, v221
    v_rcp_f32 v222, v222
    v_rcp_f32 v223, v223
    v_rcp_f32 v224, v224
    v_rcp_f32 v225, v225
    v_rcp_f32 v226, v226
    v_rcp_f32 v227, v227
    v_pk_fma_f32 v[100:101], v[164:165], v[220:221], v[100:101]
    v_pk_fma_f32 v[102:103], v[166:167], v[222:223], v[102:103]
    v_pk_fma_f32 v[104:105], v[168:169], v[224:225], v[104:105]
    v_pk_fma_f32 v[106:107], v[170:171], v[226:227], v[106:107]
    v_pk_fma_f32 v[228:229], v[100:101], v[132:133], v[228:229]
    v_pk_fma_f32 v[230:231], v[102:103], v[134:135], v[230:231]
    v_pk_fma_f32 v[228:229], v[104:105], v[136:137], v[228:229]
    v_pk_fma_f32 v[230:231], v[106:107], v[138:139], v[230:231]
    v_pk_add_f32 v[228:229], v[228:229], v[230:231]
    s_cmp_eq_u64 s[38:39], 0
    v_add_f32 v243, v228, v229
    v_sub_f32 v248, v243, v247
    v_pk_fma_f32 v[244:245], v[232:233], v[248:249], v[244:245] op_sel_hi:[1,0,1]
    v_fmac_f32 v246, v234, v248
    s_mov_b64 exec, -1
    s_cbranch_scc1 K2_DONE
    v_mfma_f32_32x32x8_bf16 v[156:171], v[42:43], v[208:209], v[60:75]
    s_mov_b64 exec, s[38:39]
    v_exp_f32 v220, v140
    v_exp_f32 v221, v141
    v_exp_f32 v222, v142
    v_exp_f32 v223, v143
    v_mfma_f32_32x32x16_bf16 v[156:171], v[36:39], v[196:199], v[156:171]
    v_exp_f32 v224, v144
    v_exp_f32 v225, v145
    s_bitcmp1_b32 s5, 2
    s_cbranch_scc0 K2_VP11
    s_setprio 1
K2_VP11:
    s_waitcnt lgkmcnt(0)
    s_mov_b64 exec, -1
    s_add_u32 m0, s94, 32768
    s_nop 0
    buffer_load_dwordx4 v[210:211], s[8:11], 0 idxen offen lds
    s_add_u32 m0, s94, 33792
    s_nop 0
    buffer_load_dwordx4 v[212:213], s[8:11], 0 idxen offen lds
    s_add_u32 m0, s94, 34816
    s_nop 0
    buffer_load_dwordx4 v[214:215], s[8:11], 0 idxen offen lds
    s_add_u32 m0, s94, 35840
    s_nop 0
    buffer_load_dwordx4 v[216:217], s[8:11], 0 idxen offen lds
    s_mov_b64 exec, s[38:39]
    s_setprio 0
    v_exp_f32 v226, v146
    v_exp_f32 v227, v147
    v_pk_add_f32 v[220:221], v[220:221], 1.0 op_sel_hi:[1,0]
    v_pk_add_f32 v[222:223], v[222:223], 1.0 op_sel_hi:[1,0]
    v_pk_add_f32 v[224:225], v[224:225], 1.0 op_sel_hi:[1,0]
    v_pk_add_f32 v[226:227], v[226:227], 1.0 op_sel_hi:[1,0]
    v_mfma_f32_32x32x16_bf16 v[156:171], v[16:19], v[172:175], v[156:171]
    v_rcp_f32 v220, v220
    v_rcp_f32 v221, v221
    v_rcp_f32 v222, v222
    v_rcp_f32 v223, v223
    v_mfma_f32_32x32x16_bf16 v[156:171], v[20:23], v[176:179], v[156:171]
    v_rcp_f32 v224, v224
    v_rcp_f32 v225, v225
    v_rcp_f32 v226, v226
    v_rcp_f32 v227, v227
    v_pk_fma_f32 v[76:77], v[140:141], v[220:221], v[76:77]
    v_pk_fma_f32 v[78:79], v[142:143], v[222:223], v[78:79]
    v_pk_fma_f32 v[80:81], v[144:145], v[224:225], v[80:81]
    v_pk_fma_f32 v[82:83], v[146:147], v[226:227], v[82:83]
    v_pk_mul_f32 v[228:229], v[76:77], v[108:109]
    v_pk_mul_f32 v[230:231], v[78:79], v[110:111]
    v_pk_fma_f32 v[228:229], v[80:81], v[112:113], v[228:229]
    v_pk_fma_f32 v[230:231], v[82:83], v[114:115], v[230:231]
    v_mfma_f32_32x32x16_bf16 v[156:171], v[24:27], v[180:183], v[156:171]
    v_exp_f32 v220, v148
    v_exp_f32 v221, v149
    v_exp_f32 v222, v150
    v_exp_f32 v223, v151
    v_mfma_f32_32x32x16_bf16 v[156:171], v[28:31], v[184:187], v[156:171]
    v_exp_f32 v224, v152
    v_exp_f32 v225, v153
    v_exp_f32 v226, v154
    buffer_load_dwordx4 v[192:195], v[218:219], s[12:15], 0 idxen offen
    buffer_load_dwordx2 v[204:205], v203, s[16:19], 0 idxen
    v_exp_f32 v227, v155
    s_waitcnt vmcnt(6)
    ds_read_b128 v[172:175], v251 offset:0
    ds_read_b128 v[176:179], v252 offset:0
    ds_read_b128 v[180:183], v253 offset:0
    ds_read_b128 v[184:187], v254 offset:0
    v_cmp_lt_u32_e64 s[32:33], s6, v235
    s_add_u32 s6, s6, 1
    v_lshlrev_b32 v232, 16, v200
    v_and_b32 v233, 0xffff0000, v200
    v_sub_f32 v234, v242, v201
    v_pk_add_f32 v[232:233], v[240:241], v[232:233] neg_lo:[0,1] neg_hi:[0,1]
    v_mul_f32 v208, v232, v232
    v_fmac_f32 v208, v233, v233
    v_fmac_f32 v208, v234, v234
    v_cvt_pk_bf16_f32 v208, v208, v208
    v_cndmask_b32_e64 v203, 0, v207, s[32:33]
    v_add_u32 v207, v207, v206
    ds_read_b32 v218, v203
    ds_read_u16 v203, v203 offset:4
    v_pk_add_f32 v[220:221], v[220:221], 1.0 op_sel_hi:[1,0]
    v_pk_add_f32 v[222:223], v[222:223], 1.0 op_sel_hi:[1,0]
    v_pk_add_f32 v[224:225], v[224:225], 1.0 op_sel_hi:[1,0]
    v_pk_add_f32 v[226:227], v[226:227], 1.0 op_sel_hi:[1,0]
    v_rcp_f32 v220, v220
    v_rcp_f32 v221, v221
    v_rcp_f32 v222, v222
    v_rcp_f32 v223, v223
    v_rcp_f32 v224, v224
    v_rcp_f32 v225, v225
    v_rcp_f32 v226, v226
    v_rcp_f32 v227, v227
    s_waitcnt lgkmcnt(0)
    s_mov_b64 exec, -1
    ds_bpermute_b32 v210, v239, v203 offset:0
    ds_bpermute_b32 v212, v239, v203 offset:32
    ds_bpermute_b32 v214, v239, v203 offset:64
    ds_bpermute_b32 v216, v239, v203 offset:96
    s_mov_b64 exec, s[38:39]
    v_pk_fma_f32 v[84:85], v[148:149], v[220:221], v[84:85]
    v_pk_fma_f32 v[86:87], v[150:151], v[222:223], v[86:87]
    v_pk_fma_f32 v[88:89], v[152:153], v[224:225], v[88:89]
    v_pk_fma_f32 v[90:91], v[154:155], v[226:227], v[90:91]
    v_pk_fma_f32 v[228:229], v[84:85], v[116:117], v[228:229]
    v_pk_fma_f32 v[230:231], v[86:87], v[118:119], v[230:231]
    v_pk_fma_f32 v[228:229], v[88:89], v[120:121], v[228:229]
    v_pk_fma_f32 v[230:231], v[90:91], v[122:123], v[230:231]
    v_mfma_f32_32x32x8_bf16 v[140:155], v[40:41], v[208:209], v[44:59]
    v_exp_f32 v220, v156
    v_exp_f32 v221, v157
    v_exp_f32 v222, v158
    v_exp_f32 v223, v159
    v_mfma_f32_32x32x16_bf16 v[140:155], v[32:35], v[188:191], v[140:155]
    v_exp_f32 v224, v160
    v_exp_f32 v225, v161
    v_exp_f32 v226, v162
    v_exp_f32 v227, v163
    v_pk_add_f32 v[220:221], v[220:221], 1.0 op_sel_hi:[1,0]
    v_pk_add_f32 v[222:223], v[222:223], 1.0 op_sel_hi:[1,0]
    v_pk_add_f32 v[224:225], v[224:225], 1.0 op_sel_hi:[1,0]
    v_pk_add_f32 v[226:227], v[226:227], 1.0 op_sel_hi:[1,0]
    v_mfma_f32_32x32x16_bf16 v[140:155], v[0:3], v[172:175], v[140:155]
    v_rcp_f32 v220, v220
    v_rcp_f32 v221, v221
    v_rcp_f32 v222, v222
    v_rcp_f32 v223, v223
    v_mfma_f32_32x32x16_bf16 v[140:155], v[4:7], v[176:179], v[140:155]
    v_rcp_f32 v224, v224
    v_rcp_f32 v225, v225
    v_rcp_f32 v226, v226
    v_rcp_f32 v227, v227
    v_pk_fma_f32 v[92:93], v[156:157], v[220:221], v[92:93]
    v_pk_fma_f32 v[94:95], v[158:159], v[222:223], v[94:95]
    v_pk_fma_f32 v[96:97], v[160:161], v[224:225], v[96:97]
    v_pk_fma_f32 v[98:99], v[162:163], v[226:227], v[98:99]
    v_pk_fma_f32 v[228:229], v[92:93], v[124:125], v[228:229]
    v_pk_fma_f32 v[230:231], v[94:95], v[126:127], v[230:231]
    v_pk_fma_f32 v[228:229], v[96:97], v[128:129], v[228:229]
    v_pk_fma_f32 v[230:231], v[98:99], v[130:131], v[230:231]
    v_mfma_f32_32x32x16_bf16 v[140:155], v[8:11], v[180:183], v[140:155]
    v_exp_f32 v220, v164
    v_exp_f32 v221, v165
    v_exp_f32 v222, v166
    v_exp_f32 v223, v167
    v_mfma_f32_32x32x16_bf16 v[140:155], v[12:15], v[184:187], v[140:155]
    v_exp_f32 v224, v168
    v_exp_f32 v225, v169
    v_exp_f32 v226, v170
    v_exp_f32 v227, v171
    v_pk_add_f32 v[220:221], v[220:221], 1.0 op_sel_hi:[1,0]
    v_pk_add_f32 v[222:223], v[222:223], 1.0 op_sel_hi:[1,0]
    v_pk_add_f32 v[224:225], v[224:225], 1.0 op_sel_hi:[1,0]
    v_pk_add_f32 v[226:227], v[226:227], 1.0 op_sel_hi:[1,0]
    v_rcp_f32 v220, v220
    v_rcp_f32 v221, v221
    v_rcp_f32 v222, v222
    v_rcp_f32 v223, v223
    v_rcp_f32 v224, v224
    v_rcp_f32 v225, v225
    v_rcp_f32 v226, v226
    v_rcp_f32 v227, v227
    v_pk_fma_f32 v[100:101], v[164:165], v[220:221], v[100:101]
    v_pk_fma_f32 v[102:103], v[166:167], v[222:223], v[102:103]
    v_pk_fma_f32 v[104:105], v[168:169], v[224:225], v[104:105]
    v_pk_fma_f32 v[106:107], v[170:171], v[226:227], v[106:107]
    v_pk_fma_f32 v[228:229], v[100:101], v[132:133], v[228:229]
    v_pk_fma_f32 v[230:231], v[102:103], v[134:135], v[230:231]
    v_pk_fma_f32 v[228:229], v[104:105], v[136:137], v[228:229]
    v_pk_fma_f32 v[230:231], v[106:107], v[138:139], v[230:231]
    v_pk_add_f32 v[228:229], v[228:229], v[230:231]
    s_cmp_eq_u64 s[28:29], 0
    v_add_f32 v247, v228, v229
    v_sub_f32 v248, v247, v243
    v_pk_fma_f32 v[244:245], v[236:237], v[248:249], v[244:245] op_sel_hi:[1,0,1]
    v_fmac_f32 v246, v238, v248
    s_mov_b64 exec, -1
    s_cbranch_scc0 K2_LOOP
K2_DONE:
    v_and_b32 v203, 63, v250
    s_or_b32 s95, s7, s93
    s_cselect_b32 s97, 3, s97
    s_cmp_gt_u32 s97, 2
    v_lshlrev_b32 v203, 4, v203
    s_cbranch_scc1 K2_SLOW
    v_bfe_u32 v220, v249, 1, 3
    v_lshlrev_b32 v220, 4, v220
    v_lshlrev_b32 v221, 2, v219
    v_xor_b32 v220, v220, v221
    v_lshl_add_u32 v220, v249, 7, v220
    v_add_u32 v220, 100352, v220
    v_xor_b32 v221, 16, v220
    v_xor_b32 v222, 32, v220
    v_xor_b32 v223, 48, v220
    ds_read_b128 v[172:175], v220
    ds_read_b128 v[176:179], v221
    ds_read_b128 v[180:183], v222
    ds_read_b128 v[184:187], v223
    v_add_u32 v220, 125952, v203
    v_cmp_eq_u32_e64 s[46:47], 16, v206
    v_cmp_eq_u32_e64 s[44:45], 8, v206
    v_add_u32 v218, s4, v249
    ds_read_b128 v[0:3], v220 offset:32768
    ds_read_b128 v[4:7], v220 offset:33792
    ds_read_b128 v[8:11], v220 offset:34816
    ds_read_b128 v[12:15], v220 offset:35840
    ds_read_b128 v[16:19], v220 offset:0
    ds_read_b128 v[20:23], v220 offset:1024
    ds_read_b128 v[24:27], v220 offset:2048
    ds_read_b128 v[28:31], v220 offset:3072
    ds_read_b128 v[44:47], v220 offset:4096
    ds_read_b128 v[48:51], v220 offset:5120
    ds_read_b128 v[52:55], v220 offset:6144
    ds_read_b128 v[56:59], v220 offset:7168
    ds_read_b128 v[60:63], v220 offset:8192
    ds_read_b128 v[64:67], v220 offset:9216
    ds_read_b128 v[68:71], v220 offset:10240
    ds_read_b128 v[72:75], v220 offset:11264
    s_mov_b64 exec, s[46:47]
    s_and_b32 s46, s46, 0x55555555
    s_or_b32 s44, s44, s46
    s_mov_b32 s98, s94
    v_add_f32_dpp v244, v244, v244 quad_perm:[1,0,3,2] row_mask:0xf bank_mask:0xf
    v_add_f32_dpp v245, v245, v245 quad_perm:[1,0,3,2] row_mask:0xf bank_mask:0xf
    v_add_f32_dpp v246, v246, v246 quad_perm:[1,0,3,2] row_mask:0xf bank_mask:0xf
    v_add_f32_dpp v76, v76, v76 quad_perm:[1,0,3,2] row_mask:0xf bank_mask:0xf
    v_add_f32_dpp v77, v77, v77 quad_perm:[1,0,3,2] row_mask:0xf bank_mask:0xf
    v_add_f32_dpp v78, v78, v78 quad_perm:[1,0,3,2] row_mask:0xf bank_mask:0xf
    v_add_f32_dpp v79, v79, v79 quad_perm:[1,0,3,2] row_mask:0xf bank_mask:0xf
    v_add_f32_dpp v80, v80, v80 quad_perm:[1,0,3,2] row_mask:0xf bank_mask:0xf
    v_add_f32_dpp v81, v81, v81 quad_perm:[1,0,3,2] row_mask:0xf bank_mask:0xf
    v_add_f32_dpp v82, v82, v82 quad_perm:[1,0,3,2] row_mask:0xf bank_mask:0xf
    v_add_f32_dpp v83, v83, v83 quad_perm:[1,0,3,2] row_mask:0xf bank_mask:0xf
    v_add_f32_dpp v84, v84, v84 quad_perm:[1,0,3,2] row_mask:0xf bank_mask:0xf
    v_add_f32_dpp v85, v85, v85 quad_perm:[1,0,3,2] row_mask:0xf bank_mask:0xf
    v_add_f32_dpp v86, v86, v86 quad_perm:[1,0,3,2] row_mask:0xf bank_mask:0xf
    v_add_f32_dpp v87, v87, v87 quad_perm:[1,0,3,2] row_mask:0xf bank_mask:0xf
    v_add_f32_dpp v88, v88, v88 quad_perm:[1,0,3,2] row_mask:0xf bank_mask:0xf
    v_add_f32_dpp v89, v89, v89 quad_perm:[1,0,3,2] row_mask:0xf bank_mask:0xf
    v_add_f32_dpp v90, v90, v90 quad_perm:[1,0,3,2] row_mask:0xf bank_mask:0xf
    v_add_f32_dpp v91, v91, v91 quad_perm:[1,0,3,2] row_mask:0xf bank_mask:0xf
    v_add_f32_dpp v92, v92, v92 quad_perm:[1,0,3,2] row_mask:0xf bank_mask:0xf
    v_add_f32_dpp v93, v93, v93 quad_perm:[1,0,3,2] row_mask:0xf bank_mask:0xf
    v_add_f32_dpp v94, v94, v94 quad_perm:[1,0,3,2] row_mask:0xf bank_mask:0xf
    v_add_f32_dpp v95, v95, v95 quad_perm:[1,0,3,2] row_mask:0xf bank_mask:0xf
    v_add_f32_dpp v96, v96, v96 quad_perm:[1,0,3,2] row_mask:0xf bank_mask:0xf
    v_add_f32_dpp v97, v97, v97 quad_perm:[1,0,3,2] row_mask:0xf bank_mask:0xf
    v_add_f32_dpp v98, v98, v98 quad_perm:[1,0,3,2] row_mask:0xf bank_mask:0xf
    v_add_f32_dpp v99, v99, v99 quad_perm:[1,0,3,2] row_mask:0xf bank_mask:0xf
    v_add_f32_dpp v100, v100, v100 quad_perm:[1,0,3,2] row_mask:0xf bank_mask:0xf
    v_add_f32_dpp v101, v101, v101 quad_perm:[1,0,3,2] row_mask:0xf bank_mask:0xf
    v_add_f32_dpp v102, v102, v102 quad_perm:[1,0,3,2] row_mask:0xf bank_mask:0xf
    v_add_f32_dpp v103, v103, v103 quad_perm:[1,0,3,2] row_mask:0xf bank_mask:0xf
    v_add_f32_dpp v104, v104, v104 quad_perm:[1,0,3,2] row_mask:0xf bank_mask:0xf
    v_add_f32_dpp v105, v105, v105 quad_perm:[1,0,3,2] row_mask:0xf bank_mask:0xf
    v_add_f32_dpp v106, v106, v106 quad_perm:[1,0,3,2] row_mask:0xf bank_mask:0xf
    v_add_f32_dpp v107, v107, v107 quad_perm:[1,0,3,2] row_mask:0xf bank_mask:0xf
    s_mov_b64 exec, -1
    v_mov_b32 v224, v244
    v_mov_b32 v225, v245
    v_mov_b32 v226, v246
    s_nop 1
    v_permlane32_swap_b32 v224, v244
    v_permlane32_swap_b32 v225, v245
    v_permlane32_swap_b32 v226, v246
    s_nop 1
    v_add_f32 v244, v244, v224
    v_add_f32 v245, v245, v225
    v_add_f32 v246, v246, v226
    s_branch K2_TAIL
K2_EMPTY:
    s_waitcnt vmcnt(0) lgkmcnt(0)
    v_mov_b32 v244, 0
    v_mov_b32 v245, 0
    v_mov_b32 v246, 0
    v_mov_b32 v76, 0
    v_mov_b32 v77, 0
    v_mov_b32 v78, 0
    v_mov_b32 v79, 0
    v_mov_b32 v80, 0
    v_mov_b32 v81, 0
    v_mov_b32 v82, 0
    v_mov_b32 v83, 0
    v_mov_b32 v84, 0
    v_mov_b32 v85, 0
    v_mov_b32 v86, 0
    v_mov_b32 v87, 0
    v_mov_b32 v88, 0
    v_mov_b32 v89, 0
    v_mov_b32 v90, 0
    v_mov_b32 v91, 0
    v_mov_b32 v92, 0
    v_mov_b32 v93, 0
    v_mov_b32 v94, 0
    v_mov_b32 v95, 0
    v_mov_b32 v96, 0
    v_mov_b32 v97, 0
    v_mov_b32 v98, 0
    v_mov_b32 v99, 0
    v_mov_b32 v100, 0
    v_mov_b32 v101, 0
    v_mov_b32 v102, 0
    v_mov_b32 v103, 0
    v_mov_b32 v104, 0
    v_mov_b32 v105, 0
    v_mov_b32 v106, 0
    v_mov_b32 v107, 0
    v_mov_b32 v242, v241
    v_and_b32 v241, 0xffff0000, v240
    v_lshlrev_b32 v240, 16, v240
    s_branch K2_DONE
K2_SLOW:
    v_and_b32 v223, 31, v250
    v_lshlrev_b32 v220, 2, v219
    v_xor_b32 v220, v220, v251
    v_lshl_add_u32 v220, v219, 11, v220
    s_lshl_b32 s95, s100, 10
    s_add_u32 s95, s95, 129024
    v_lshl_add_u32 v221, v223, 5, v219
    v_add_u32 v221, s95, v221
    s_lshl_b32 s95, s5, 5
    v_add_u32 v223, s95, v223
    v_add_u32 v218, s4, v223
    v_min_u32 v222, 49999, v218
    s_waitcnt vmcnt(0)
    buffer_load_dwordx2 v[240:241], v222, s[16:19], 0 idxen
    v_xor_b32 v222, 0, v220
    ds_write_b128 v222, v[76:79]
    v_xor_b32 v222, 16, v220
    ds_write_b128 v222, v[80:83]
    v_xor_b32 v222, 32, v220
    ds_write_b128 v222, v[84:87]
    v_xor_b32 v222, 48, v220
    ds_write_b128 v222, v[88:91]
    v_xor_b32 v222, 64, v220
    ds_write_b128 v222, v[92:95]
    v_xor_b32 v222, 80, v220
    ds_write_b128 v222, v[96:99]
    v_xor_b32 v222, 96, v220
    ds_write_b128 v222, v[100:103]
    v_xor_b32 v222, 112, v220
    ds_write_b128 v222, v[104:107]
    ds_write_b128 v221, v[244:247]
    v_lshlrev_b32 v220, 2, v223
    ds_read_b32 v235, v220 offset:32768
    s_sub_u32 s99, s101, s94
    v_add_u32 v251, s99, v251
    v_add_u32 v252, s99, v252
    v_add_u32 v253, s99, v253
    v_add_u32 v254, s99, v254
    ds_read_b128 v[172:175], v251 offset:0
    ds_read_b128 v[176:179], v252 offset:0
    ds_read_b128 v[180:183], v253 offset:0
    ds_read_b128 v[184:187], v254 offset:0
    v_mov_b32 v76, 0
    v_mov_b32 v77, 0
    v_mov_b32 v78, 0
    v_mov_b32 v79, 0
    v_mov_b32 v80, 0
    v_mov_b32 v81, 0
    v_mov_b32 v82, 0
    v_mov_b32 v83, 0
    v_mov_b32 v84, 0
    v_mov_b32 v85, 0
    v_mov_b32 v86, 0
    v_mov_b32 v87, 0
    v_mov_b32 v88, 0
    v_mov_b32 v89, 0
    v_mov_b32 v90, 0
    v_mov_b32 v91, 0
    v_mov_b32 v92, 0
    v_mov_b32 v93, 0
    v_mov_b32 v94, 0
    v_mov_b32 v95, 0
    v_mov_b32 v96, 0
    v_mov_b32 v97, 0
    v_mov_b32 v98, 0
    v_mov_b32 v99, 0
    v_mov_b32 v100, 0
    v_mov_b32 v101, 0
    v_mov_b32 v102, 0
    v_mov_b32 v103, 0
    v_mov_b32 v104, 0
    v_mov_b32 v105, 0
    v_mov_b32 v106, 0
    v_mov_b32 v107, 0
    v_mov_b32 v244, 0
    v_mov_b32 v245, 0
    v_mov_b32 v246, 0
    s_lshl_b32 s99, s3, 8
    v_add_u32 v249, s99, v223
    v_mul_u32_u24 v249, 272, v249
    v_lshl_add_u32 v243, v219, 3, v249
    s_mov_b32 s99, 7602176
    s_cmp_eq_u32 s7, 0
    s_cbranch_scc1 K2_NOLD
    buffer_load_dwordx4 v[76:79], v243, s[20:23], s99 offen offset:0 sc0 sc1
    buffer_load_dwordx4 v[80:83], v243, s[20:23], s99 offen offset:16 sc0 sc1
    buffer_load_dwordx4 v[84:87], v243, s[20:23], s99 offen offset:32 sc0 sc1
    buffer_load_dwordx4 v[88:91], v243, s[20:23], s99 offen offset:48 sc0 sc1
    buffer_load_dwordx4 v[92:95], v243, s[20:23], s99 offen offset:64 sc0 sc1
    buffer_load_dwordx4 v[96:99], v243, s[20:23], s99 offen offset:80 sc0 sc1
    buffer_load_dwordx4 v[100:103], v243, s[20:23], s99 offen offset:96 sc0 sc1
    buffer_load_dwordx4 v[104:107], v243, s[20:23], s99 offen offset:112 sc0 sc1
    buffer_load_dwordx3 v[244:246], v249, s[20:23], s99 offen offset:256 sc0 sc1
    s_waitcnt vmcnt(0)
K2_NOLD:
    s_waitcnt lgkmcnt(0)
    v_and_b32 v207, 0xffff, v235
    v_lshrrev_b32 v235, 16, v235
    v_lshlrev_b32 v247, 11, v219
    v_add_u32 v247, 34816, v247
    v_add_u32 v220, 138240, v203
    v_cmp_lt_u32 vcc, 0, v235
    s_barrier
    s_cbranch_vccz K2_GDONE
K2_GLOOP:
    s_mov_b64 exec, vcc
    v_bfe_u32 v221, v207, 3, 3
    v_lshlrev_b32 v221, 4, v221
    v_lshl_add_u32 v221, v207, 5, v221
    v_add_u32 v221, v247, v221
    v_xor_b32 v222, 0, v221
    ds_read_b128 v[140:143], v222
    v_xor_b32 v222, 16, v221
    ds_read_b128 v[144:147], v222
    v_xor_b32 v222, 32, v221
    ds_read_b128 v[148:151], v222
    v_xor_b32 v222, 48, v221
    ds_read_b128 v[152:155], v222
    v_xor_b32 v222, 64, v221
    ds_read_b128 v[156:159], v222
    v_xor_b32 v222, 80, v221
    ds_read_b128 v[160:163], v222
    v_xor_b32 v222, 96, v221
    ds_read_b128 v[164:167], v222
    v_xor_b32 v222, 112, v221
    ds_read_b128 v[168:171], v222
    v_lshlrev_b32 v222, 3, v207
    v_add_u32 v222, 129024, v222
    ds_read_b128 v[188:191], v222
    ds_read_b128 v[192:195], v222 offset:16
    v_add_u32 v207, 4, v207
    v_subrev_u32 v235, 1, v235
    v_cmp_lt_u32 vcc, 0, v235
    s_waitcnt lgkmcnt(9)
    v_pk_add_f32 v[76:77], v[76:77], v[140:141]
    v_pk_add_f32 v[78:79], v[78:79], v[142:143]
    s_waitcnt lgkmcnt(8)
    v_pk_add_f32 v[80:81], v[80:81], v[144:145]
    v_pk_add_f32 v[82:83], v[82:83], v[146:147]
    s_waitcnt lgkmcnt(7)
    v_pk_add_f32 v[84:85], v[84:85], v[148:149]
    v_pk_add_f32 v[86:87], v[86:87], v[150:151]
    s_waitcnt lgkmcnt(6)
    v_pk_add_f32 v[88:89], v[88:89], v[152:153]
    v_pk_add_f32 v[90:91], v[90:91], v[154:155]
    s_waitcnt lgkmcnt(5)
    v_pk_add_f32 v[92:93], v[92:93], v[156:157]
    v_pk_add_f32 v[94:95], v[94:95], v[158:159]
    s_waitcnt lgkmcnt(4)
    v_pk_add_f32 v[96:97], v[96:97], v[160:161]
    v_pk_add_f32 v[98:99], v[98:99], v[162:163]
    s_waitcnt lgkmcnt(3)
    v_pk_add_f32 v[100:101], v[100:101], v[164:165]
    v_pk_add_f32 v[102:103], v[102:103], v[166:167]
    s_waitcnt lgkmcnt(2)
    v_pk_add_f32 v[104:105], v[104:105], v[168:169]
    v_pk_add_f32 v[106:107], v[106:107], v[170:171]
    s_waitcnt lgkmcnt(0)
    v_pk_add_f32 v[244:245], v[244:245], v[188:189]
    v_add_f32 v246, v246, v190
    v_pk_add_f32 v[244:245], v[244:245], v[192:193]
    v_add_f32 v246, v246, v194
    s_cbranch_vccnz K2_GLOOP
    s_mov_b64 exec, -1
K2_GDONE:
    s_cmp_eq_u32 s93, 0
    s_cbranch_scc1 K2_EPI
    buffer_store_dwordx4 v[76:79], v243, s[20:23], s99 offen offset:0
    buffer_store_dwordx4 v[80:83], v243, s[20:23], s99 offen offset:16
    buffer_store_dwordx4 v[84:87], v243, s[20:23], s99 offen offset:32
    buffer_store_dwordx4 v[88:91], v243, s[20:23], s99 offen offset:48
    buffer_store_dwordx4 v[92:95], v243, s[20:23], s99 offen offset:64
    buffer_store_dwordx4 v[96:99], v243, s[20:23], s99 offen offset:80
    buffer_store_dwordx4 v[100:103], v243, s[20:23], s99 offen offset:96
    buffer_store_dwordx4 v[104:107], v243, s[20:23], s99 offen offset:112
    buffer_store_dwordx3 v[244:246], v249, s[20:23], s99 offen offset:256
    s_add_u32 s7, s7, s92
    s_waitcnt vmcnt(0)
    s_barrier
    s_branch K2_TOP
K2_EPI:
    s_cmp_ge_u32 s5, 6
    s_cbranch_scc1 K2_NWH2
    s_mul_i32 s95, s5, 2048
    s_add_u32 m0, s95, 138240
    s_add_u32 s95, s95, 7561216
    buffer_load_dwordx4 v203, s[20:23], s95 offen offset:0 lds
    buffer_load_dwordx4 v203, s[20:23], s95 offen offset:1024 lds
K2_NWH2:
    s_lshl_b32 s95, s5, 5
    s_cmp_ge_u32 s95, s96
    s_waitcnt vmcnt(0)
    s_barrier
    s_cbranch_scc1 K2_END0
    ds_read_b128 v[0:3], v220 offset:20480
    ds_read_b128 v[4:7], v220 offset:21504
    ds_read_b128 v[8:11], v220 offset:22528
    ds_read_b128 v[12:15], v220 offset:23552
    ds_read_b128 v[16:19], v220 offset:0
    ds_read_b128 v[20:23], v220 offset:1024
    ds_read_b128 v[24:27], v220 offset:2048
    ds_read_b128 v[28:31], v220 offset:3072
    ds_read_b128 v[44:47], v220 offset:4096
    ds_read_b128 v[48:51], v220 offset:5120
    ds_read_b128 v[52:55], v220 offset:6144
    ds_read_b128 v[56:59], v220 offset:7168
    ds_read_b128 v[60:63], v220 offset:8192
    ds_read_b128 v[64:67], v220 offset:9216
    ds_read_b128 v[68:71], v220 offset:10240
    ds_read_b128 v[72:75], v220 offset:11264
    v_cmp_gt_u32_e64 s[44:45], s96, v223
    s_mov_b32 s98, s101
    s_waitcnt vmcnt(0)
    v_mov_b32 v242, v241
    v_and_b32 v241, 0xffff0000, v240
    v_lshlrev_b32 v240, 16, v240
K2_TAIL:
    v_add_u32 v235, s98, v203
    v_lshlrev_b32 v203, 7, v218
    v_cndmask_b32_e64 v203, 2.0, v203, s[44:45]
    s_waitcnt lgkmcnt(8)
    v_mfma_f32_32x32x16_bf16 v[140:155], v[0:3], v[172:175], 0
    v_cvt_pk_bf16_f32 v108, v76, v77
    v_cvt_pk_bf16_f32 v109, v78, v79
    v_mfma_f32_32x32x16_bf16 v[156:171], v[16:19], v[172:175], 0
    v_cvt_pk_bf16_f32 v110, v80, v81
    v_cvt_pk_bf16_f32 v111, v82, v83
    v_mfma_f32_32x32x16_bf16 v[140:155], v[4:7], v[176:179], v[140:155]
    v_cvt_pk_bf16_f32 v112, v84, v85
    v_cvt_pk_bf16_f32 v113, v86, v87
    v_mfma_f32_32x32x16_bf16 v[156:171], v[20:23], v[176:179], v[156:171]
    v_cvt_pk_bf16_f32 v114, v88, v89
    v_cvt_pk_bf16_f32 v115, v90, v91
    v_mfma_f32_32x32x16_bf16 v[140:155], v[8:11], v[180:183], v[140:155]
    v_cvt_pk_bf16_f32 v116, v92, v93
    v_cvt_pk_bf16_f32 v117, v94, v95
    v_mfma_f32_32x32x16_bf16 v[156:171], v[24:27], v[180:183], v[156:171]
    v_cvt_pk_bf16_f32 v118, v96, v97
    v_cvt_pk_bf16_f32 v119, v98, v99
    v_mfma_f32_32x32x16_bf16 v[140:155], v[12:15], v[184:187], v[140:155]
    v_cvt_pk_bf16_f32 v120, v100, v101
    v_cvt_pk_bf16_f32 v121, v102, v103
    v_mfma_f32_32x32x16_bf16 v[156:171], v[28:31], v[184:187], v[156:171]
    v_cvt_pk_bf16_f32 v122, v104, v105
    v_cvt_pk_bf16_f32 v123, v106, v107
    s_waitcnt lgkmcnt(0)
    ds_bpermute_b32 v210, v239, v203 offset:0
    ds_bpermute_b32 v212, v239, v203 offset:32
    ds_bpermute_b32 v214, v239, v203 offset:64
    ds_bpermute_b32 v216, v239, v203 offset:96
    v_mfma_f32_32x32x16_bf16 v[140:155], v[44:47], v[108:111], v[140:155]
    v_lshlrev_b32 v76, 16, v172
    v_and_b32 v77, 0xffff0000, v172
    v_lshlrev_b32 v78, 16, v173
    v_and_b32 v79, 0xffff0000, v173
    v_lshlrev_b32 v80, 16, v174
    v_and_b32 v81, 0xffff0000, v174
    v_lshlrev_b32 v82, 16, v175
    v_and_b32 v83, 0xffff0000, v175
    v_mfma_f32_32x32x16_bf16 v[140:155], v[48:51], v[112:115], v[140:155]
    v_lshlrev_b32 v84, 16, v176
    v_and_b32 v85, 0xffff0000, v176
    v_lshlrev_b32 v86, 16, v177
    v_and_b32 v87, 0xffff0000, v177
    v_lshlrev_b32 v88, 16, v178
    v_and_b32 v89, 0xffff0000, v178
    v_lshlrev_b32 v90, 16, v179
    v_and_b32 v91, 0xffff0000, v179
    v_mfma_f32_32x32x16_bf16 v[140:155], v[52:55], v[116:119], v[140:155]
    v_lshlrev_b32 v92, 16, v180
    v_and_b32 v93, 0xffff0000, v180
    v_lshlrev_b32 v94, 16, v181
    v_and_b32 v95, 0xffff0000, v181
    v_lshlrev_b32 v96, 16, v182
    v_and_b32 v97, 0xffff0000, v182
    v_lshlrev_b32 v98, 16, v183
    v_and_b32 v99, 0xffff0000, v183
    v_mfma_f32_32x32x16_bf16 v[140:155], v[56:59], v[120:123], v[140:155]
    v_lshlrev_b32 v100, 16, v184
    v_and_b32 v101, 0xffff0000, v184
    v_lshlrev_b32 v102, 16, v185
    v_and_b32 v103, 0xffff0000, v185
    v_lshlrev_b32 v104, 16, v186
    v_and_b32 v105, 0xffff0000, v186
    v_lshlrev_b32 v106, 16, v187
    v_and_b32 v107, 0xffff0000, v187
    v_mfma_f32_32x32x16_bf16 v[156:171], v[60:63], v[108:111], v[156:171]
    v_mov_b32 v243, 0
    v_pk_add_f32 v[244:245], v[244:245], v[240:241]
    v_add_f32 v246, v246, v242
    v_cvt_pk_bf16_f32 v244, v244, v245
    v_cvt_pk_bf16_f32 v246, v246, v246
    s_mov_b32 exec_lo, s44
    s_mov_b32 exec_hi, 0
    s_cmp_eq_u32 s98, s94
    s_cbranch_scc1 K2_PF
    v_mul_u32_u24 v220, 6, v218
    s_mov_b32 s99, 6400000
    buffer_store_short v244, v220, s[24:27], s99 offen
    buffer_store_short_d16_hi v244, v220, s[24:27], s99 offen offset:2
    buffer_store_short v246, v220, s[24:27], s99 offen offset:4
    s_branch K2_PD
K2_PF:
    s_mov_b32 s99, 32768
    v_mad_u32_u24 v220, v249, 6, s99
    ds_write_b16 v220, v244
    ds_write_b16_d16_hi v220, v244 offset:2
    ds_write_b16 v220, v246 offset:4
    s_mov_b64 exec, 1
    v_mov_b32 v220, 108
    v_mov_b32 v221, 1
    ds_add_rtn_u32 v243, v220, v221
K2_PD:
    s_mov_b64 exec, -1
    s_mov_b32 s40, 0xbf317218
    s_mov_b32 s41, 0xbf317218
    v_mfma_f32_32x32x16_bf16 v[156:171], v[64:67], v[112:115], v[156:171]
    v_exp_f32 v220, v140
    v_exp_f32 v221, v141
    v_exp_f32 v222, v142
    v_exp_f32 v223, v143
    v_mfma_f32_32x32x16_bf16 v[156:171], v[68:71], v[116:119], v[156:171]
    v_exp_f32 v224, v144
    v_exp_f32 v225, v145
    v_exp_f32 v226, v146
    v_exp_f32 v227, v147
    v_pk_add_f32 v[220:221], v[220:221], 1.0 op_sel_hi:[1,0]
    v_pk_add_f32 v[222:223], v[222:223], 1.0 op_sel_hi:[1,0]
    v_mfma_f32_32x32x16_bf16 v[156:171], v[72:75], v[120:123], v[156:171]
    v_pk_add_f32 v[224:225], v[224:225], 1.0 op_sel_hi:[1,0]
    v_pk_add_f32 v[226:227], v[226:227], 1.0 op_sel_hi:[1,0]
    v_rcp_f32 v220, v220
    v_rcp_f32 v221, v221
    v_rcp_f32 v222, v222
    v_rcp_f32 v223, v223
    v_rcp_f32 v224, v224
    v_rcp_f32 v225, v225
    v_rcp_f32 v226, v226
    v_rcp_f32 v227, v227
    s_waitcnt lgkmcnt(0)
    v_add_u32 v210, v210, v211
    v_add_u32 v212, v212, v213
    v_add_u32 v214, v214, v215
    v_add_u32 v216, v216, v217
    v_pk_mul_f32 v[220:221], v[220:221], v[140:141]
    v_pk_mul_f32 v[222:223], v[222:223], v[142:143]
    v_pk_mul_f32 v[224:225], v[224:225], v[144:145]
    v_pk_mul_f32 v[226:227], v[226:227], v[146:147]
    v_pk_fma_f32 v[220:221], v[220:221], s[40:41], v[76:77]
    v_pk_fma_f32 v[222:223], v[222:223], s[40:41], v[78:79]
    v_pk_fma_f32 v[224:225], v[224:225], s[40:41], v[80:81]
    v_pk_fma_f32 v[226:227], v[226:227], s[40:41], v[82:83]
    v_cvt_pk_bf16_f32 v172, v220, v221
    v_cvt_pk_bf16_f32 v173, v222, v223
    v_cvt_pk_bf16_f32 v174, v224, v225
    v_cvt_pk_bf16_f32 v175, v226, v227
    s_waitcnt vmcnt(0)
    ds_write_b128 v251, v[172:175]
    v_exp_f32 v220, v148
    v_exp_f32 v221, v149
    v_exp_f32 v222, v150
    v_exp_f32 v223, v151
    v_exp_f32 v224, v152
    v_exp_f32 v225, v153
    v_exp_f32 v226, v154
    v_exp_f32 v227, v155
    v_pk_add_f32 v[220:221], v[220:221], 1.0 op_sel_hi:[1,0]
    v_pk_add_f32 v[222:223], v[222:223], 1.0 op_sel_hi:[1,0]
    v_pk_add_f32 v[224:225], v[224:225], 1.0 op_sel_hi:[1,0]
    v_pk_add_f32 v[226:227], v[226:227], 1.0 op_sel_hi:[1,0]
    v_rcp_f32 v220, v220
    v_rcp_f32 v221, v221
    v_rcp_f32 v222, v222
    v_rcp_f32 v223, v223
    v_rcp_f32 v224, v224
    v_rcp_f32 v225, v225
    v_rcp_f32 v226, v226
    v_rcp_f32 v227, v227
    v_pk_mul_f32 v[220:221], v[220:221], v[148:149]
    v_pk_mul_f32 v[222:223], v[222:223], v[150:151]
    v_pk_mul_f32 v[224:225], v[224:225], v[152:153]
    v_pk_mul_f32 v[226:227], v[226:227], v[154:155]
    v_pk_fma_f32 v[220:221], v[220:221], s[40:41], v[84:85]
    v_pk_fma_f32 v[222:223], v[222:223], s[40:41], v[86:87]
    v_pk_fma_f32 v[224:225], v[224:225], s[40:41], v[88:89]
    v_pk_fma_f32 v[226:227], v[226:227], s[40:41], v[90:91]
    v_cvt_pk_bf16_f32 v176, v220, v221
    v_cvt_pk_bf16_f32 v177, v222, v223
    v_cvt_pk_bf16_f32 v178, v224, v225
    v_cvt_pk_bf16_f32 v179, v226, v227
    ds_write_b128 v252, v[176:179]
    v_exp_f32 v220, v156
    v_exp_f32 v221, v157
    v_exp_f32 v222, v158
    v_exp_f32 v223, v159
    v_exp_f32 v224, v160
    v_exp_f32 v225, v161
    v_exp_f32 v226, v162
    v_exp_f32 v227, v163
    v_pk_add_f32 v[220:221], v[220:221], 1.0 op_sel_hi:[1,0]
    v_pk_add_f32 v[222:223], v[222:223], 1.0 op_sel_hi:[1,0]
    v_pk_add_f32 v[224:225], v[224:225], 1.0 op_sel_hi:[1,0]
    v_pk_add_f32 v[226:227], v[226:227], 1.0 op_sel_hi:[1,0]
    v_rcp_f32 v220, v220
    v_rcp_f32 v221, v221
    v_rcp_f32 v222, v222
    v_rcp_f32 v223, v223
    v_rcp_f32 v224, v224
    v_rcp_f32 v225, v225
    v_rcp_f32 v226, v226
    v_rcp_f32 v227, v227
    v_pk_mul_f32 v[220:221], v[220:221], v[156:157]
    v_pk_mul_f32 v[222:223], v[222:223], v[158:159]
    v_pk_mul_f32 v[224:225], v[224:225], v[160:161]
    v_pk_mul_f32 v[226:227], v[226:227], v[162:163]
    v_pk_fma_f32 v[220:221], v[220:221], s[40:41], v[92:93]
    v_pk_fma_f32 v[222:223], v[222:223], s[40:41], v[94:95]
    v_pk_fma_f32 v[224:225], v[224:225], s[40:41], v[96:97]
    v_pk_fma_f32 v[226:227], v[226:227], s[40:41], v[98:99]
    v_cvt_pk_bf16_f32 v180, v220, v221
    v_cvt_pk_bf16_f32 v181, v222, v223
    v_cvt_pk_bf16_f32 v182, v224, v225
    v_cvt_pk_bf16_f32 v183, v226, v227
    ds_write_b128 v253, v[180:183]
    v_exp_f32 v220, v164
    v_exp_f32 v221, v165
    v_exp_f32 v222, v166
    v_exp_f32 v223, v167
    v_exp_f32 v224, v168
    v_exp_f32 v225, v169
    v_exp_f32 v226, v170
    v_exp_f32 v227, v171
    v_pk_add_f32 v[220:221], v[220:221], 1.0 op_sel_hi:[1,0]
    v_pk_add_f32 v[222:223], v[222:223], 1.0 op_sel_hi:[1,0]
    v_pk_add_f32 v[224:225], v[224:225], 1.0 op_sel_hi:[1,0]
    v_pk_add_f32 v[226:227], v[226:227], 1.0 op_sel_hi:[1,0]
    v_rcp_f32 v220, v220
    v_rcp_f32 v221, v221
    v_rcp_f32 v222, v222
    v_rcp_f32 v223, v223
    v_rcp_f32 v224, v224
    v_rcp_f32 v225, v225
    v_rcp_f32 v226, v226
    v_rcp_f32 v227, v227
    v_pk_mul_f32 v[220:221], v[220:221], v[164:165]
    v_pk_mul_f32 v[222:223], v[222:223], v[166:167]
    v_pk_mul_f32 v[224:225], v[224:225], v[168:169]
    v_pk_mul_f32 v[226:227], v[226:227], v[170:171]
    v_pk_fma_f32 v[220:221], v[220:221], s[40:41], v[100:101]
    v_pk_fma_f32 v[222:223], v[222:223], s[40:41], v[102:103]
    v_pk_fma_f32 v[224:225], v[224:225], s[40:41], v[104:105]
    v_pk_fma_f32 v[226:227], v[226:227], s[40:41], v[106:107]
    v_cvt_pk_bf16_f32 v184, v220, v221
    v_cvt_pk_bf16_f32 v185, v222, v223
    v_cvt_pk_bf16_f32 v186, v224, v225
    v_cvt_pk_bf16_f32 v187, v226, v227
    ds_write_b128 v254, v[184:187]
    ds_read_b128 v[140:143], v235 offset:0
    ds_read_b128 v[144:147], v235 offset:1024
    ds_read_b128 v[148:151], v235 offset:2048
    ds_read_b128 v[152:155], v235 offset:3072
    s_waitcnt lgkmcnt(3)
    buffer_store_dwordx4 v[140:143], v210, s[24:27], 0 offen sc1
    s_waitcnt lgkmcnt(2)
    buffer_store_dwordx4 v[144:147], v212, s[24:27], 0 offen sc1
    s_waitcnt lgkmcnt(1)
    buffer_store_dwordx4 v[148:151], v214, s[24:27], 0 offen sc1
    s_waitcnt lgkmcnt(0)
    buffer_store_dwordx4 v[152:155], v216, s[24:27], 0 offen sc1
    v_readfirstlane_b32 s95, v243
    v_and_b32 v220, 63, v250
    v_lshlrev_b32 v220, 3, v220
    s_cmp_lg_u32 s95, 7
    s_cbranch_scc1 K2_PE
    ds_read_b64 v[188:189], v220 offset:32768
    ds_read_b64 v[190:191], v220 offset:33280
    ds_read_b64 v[192:193], v220 offset:33792
    s_mul_i32 s99, s4, 6
    s_add_u32 s99, s99, 6400000
    s_mul_i32 s95, s96, 6
    v_cmp_gt_i32 vcc, s95, v220
    s_sub_i32 s95, s95, 512
    s_waitcnt lgkmcnt(2)
    s_mov_b64 exec, vcc
    buffer_store_dwordx2 v[188:189], v220, s[24:27], s99 offen offset:0 sc1
    v_cmp_gt_i32 vcc, s95, v220
    s_sub_i32 s95, s95, 512
    s_waitcnt lgkmcnt(1)
    s_mov_b64 exec, vcc
    buffer_store_dwordx2 v[190:191], v220, s[24:27], s99 offen offset:512 sc1
    v_cmp_gt_i32 vcc, s95, v220
    s_sub_i32 s95, s95, 512
    s_waitcnt lgkmcnt(0)
    s_mov_b64 exec, vcc
    buffer_store_dwordx2 v[192:193], v220, s[24:27], s99 offen offset:1024 sc1
    s_mov_b64 exec, -1
K2_PE:
    s_endpgm
K2_END0:
    s_waitcnt vmcnt(0)
K2_END:
    s_endpgm
.section .rodata,"a"
.p2align 6
.amdhsa_kernel egnn_sort_kernel
  .amdhsa_next_free_vgpr 120
  .amdhsa_next_free_sgpr 48
  .amdhsa_accum_offset 120
  .amdhsa_group_segment_fixed_size 0
  .amdhsa_kernarg_size 88
  .amdhsa_user_sgpr_count 2
  .amdhsa_user_sgpr_kernarg_segment_ptr 1
  .amdhsa_system_sgpr_workgroup_id_x 1
.end_amdhsa_kernel
.p2align 6
.amdhsa_kernel egnn_main_kernel
  .amdhsa_next_free_vgpr 256
  .amdhsa_next_free_sgpr 102
  .amdhsa_accum_offset 256
  .amdhsa_group_segment_fixed_size 0
  .amdhsa_kernarg_size 88
  .amdhsa_user_sgpr_count 2
  .amdhsa_user_sgpr_kernarg_segment_ptr 1
  .amdhsa_system_sgpr_workgroup_id_x 1
.end_amdhsa_kernel
```

```asm
; @launch kernel=egnn_sort_kernel grid=(250,1,1) block=(512,1,1) lds=27904
; @launch kernel=egnn_main_kernel grid=(256,1,1) block=(512,1,1) lds=162816
.amdgcn_target "amdgcn-amd-amdhsa--gfx950"
.text
.globl egnn_sort_kernel
.p2align 8
.type egnn_sort_kernel,@function
egnn_sort_kernel:
    s_cmp_ge_u32 s2, 250
    s_cbranch_scc1 K1_END
    s_load_dwordx2 s[38:39], s[0:1], 80
    v_lshrrev_b32 v1, 6, v0
    s_nop 0
    v_readfirstlane_b32 s3, v1
    s_cmp_ge_u32 s3, 7
    s_cbranch_scc1 K1_FRAG
    s_load_dwordx4 s[4:7], s[0:1], 24
    s_load_dwordx4 s[8:11], s[0:1], 8
    s_and_b32 s28, s2, 7
    s_min_u32 s29, s28, 2
    s_mul_i32 s28, s28, 31
    s_lshr_b32 s2, s2, 3
    s_add_u32 s2, s2, s28
    s_add_u32 s2, s2, s29
    v_lshlrev_b32 v1, 2, v0
    v_lshlrev_b32 v15, 3, v0
    v_mov_b32 v2, 0
    v_mov_b32 v3, 0
    v_cmp_gt_u32 vcc, 144, v0
    s_mov_b64 exec, vcc
    ds_write_b64 v15, v[2:3] offset:0
    s_mov_b64 exec, -1
    v_mov_b32 v3, 1
    s_mul_i32 s28, s2, 12800
    s_mul_i32 s29, s2, 200
    s_mul_i32 s30, s2, 3200
    s_mov_b32 s31, 85599
    s_movk_i32 s32, -196
    v_add_u32 v12, s29, v0
    v_mul_u32_u24 v13, 6, v12
    v_lshlrev_b32 v14, 4, v0
    v_mov_b32 v15, 400
    v_cmp_gt_u32 s[34:35], v15, v0
    v_mov_b32 v15, 200
    v_cmp_gt_u32 s[36:37], v15, v0
    s_waitcnt lgkmcnt(0)
    s_mov_b32 s12, s4
    s_and_b32 s13, s5, 0xffff
    s_mov_b32 s14, 3200000
    s_mov_b32 s15, 0x20000
    s_mov_b32 s16, s6
    s_and_b32 s17, s7, 0xffff
    s_mov_b32 s18, 3200000
    s_mov_b32 s19, 0x20000
    s_mov_b32 s20, s8
    s_and_b32 s21, s9, 0xffff
    s_mov_b32 s22, 300000
    s_mov_b32 s23, 0x20000
    s_mov_b32 s24, s38
    s_and_b32 s25, s39, 0xffff
    s_mov_b32 s26, 25600000
    s_mov_b32 s27, 0x20000
    s_cmp_ge_u32 s3, 4
    s_cbranch_scc1 K1_NOPOS
    s_mov_b64 exec, s[36:37]
    buffer_load_ushort v16, v13, s[20:23], 0 offen
    buffer_load_ushort v17, v13, s[20:23], 0 offen offset:2
    buffer_load_ushort v18, v13, s[20:23], 0 offen offset:4
K1_NOPOS:
    s_mov_b64 exec, s[34:35]
    s_mov_b32 s42, s28
    buffer_load_dwordx4 v[60:63], v14, s[16:19], s42 offen nt
    s_add_u32 s42, s42, 6400
    buffer_load_dwordx4 v[64:67], v14, s[16:19], s42 offen nt
    v_add_u32 v76, s30, v1
    v_add_u32 v78, 1, v76
    v_add_u32 v80, 2, v76
    v_add_u32 v82, 3, v76
    v_add_u32 v84, 1600, v76
    v_add_u32 v86, 1601, v76
    v_add_u32 v88, 1602, v76
    v_add_u32 v90, 1603, v76
    s_barrier
    s_waitcnt vmcnt(0)
    s_mov_b32 s42, s28
    buffer_load_dwordx4 v[68:71], v14, s[12:15], s42 offen nt
    s_add_u32 s42, s42, 6400
    buffer_load_dwordx4 v[72:75], v14, s[12:15], s42 offen nt
    v_mul_u32_u24 v92, s31, v60
    v_lshrrev_b32 v92, 24, v92
    v_mad_i32_i24 v60, v92, s32, v60
    v_lshlrev_b32 v92, 2, v92
    ds_add_rtn_u32 v100, v92, v3 offset:0
    v_lshrrev_b32 v108, 7, v92
    v_mul_u32_u24 v93, s31, v61
    v_lshrrev_b32 v93, 24, v93
    v_mad_i32_i24 v61, v93, s32, v61
    v_lshlrev_b32 v93, 2, v93
    ds_add_rtn_u32 v101, v93, v3 offset:0
    v_lshrrev_b32 v109, 7, v93
    v_mul_u32_u24 v94, s31, v62
    v_lshrrev_b32 v94, 24, v94
    v_mad_i32_i24 v62, v94, s32, v62
    v_lshlrev_b32 v94, 2, v94
    ds_add_rtn_u32 v102, v94, v3 offset:0
    v_lshrrev_b32 v110, 7, v94
    v_mul_u32_u24 v95, s31, v63
    v_lshrrev_b32 v95, 24, v95
    v_mad_i32_i24 v63, v95, s32, v63
    v_lshlrev_b32 v95, 2, v95
    ds_add_rtn_u32 v103, v95, v3 offset:0
    v_lshrrev_b32 v111, 7, v95
    v_mul_u32_u24 v96, s31, v64
    v_lshrrev_b32 v96, 24, v96
    v_mad_i32_i24 v64, v96, s32, v64
    v_lshlrev_b32 v96, 2, v96
    ds_add_rtn_u32 v104, v96, v3 offset:0
    v_lshrrev_b32 v112, 7, v96
    v_mul_u32_u24 v97, s31, v65
    v_lshrrev_b32 v97, 24, v97
    v_mad_i32_i24 v65, v97, s32, v65
    v_lshlrev_b32 v97, 2, v97
    ds_add_rtn_u32 v105, v97, v3 offset:0
    v_lshrrev_b32 v113, 7, v97
    v_mul_u32_u24 v98, s31, v66
    v_lshrrev_b32 v98, 24, v98
    v_mad_i32_i24 v66, v98, s32, v66
    v_lshlrev_b32 v98, 2, v98
    ds_add_rtn_u32 v106, v98, v3 offset:0
    v_lshrrev_b32 v114, 7, v98
    v_mul_u32_u24 v99, s31, v67
    v_lshrrev_b32 v99, 24, v99
    v_mad_i32_i24 v67, v99, s32, v67
    v_lshlrev_b32 v99, 2, v99
    ds_add_rtn_u32 v107, v99, v3 offset:0
    v_lshrrev_b32 v115, 7, v99
    s_cmp_ge_u32 s3, 4
    s_cbranch_scc1 K1_P3
    s_mov_b64 exec, s[36:37]
    v_lshl_or_b32 v16, v17, 16, v16
    v_lshlrev_b32 v17, 16, v18
    v_lshlrev_b32 v12, 3, v12
    s_mov_b32 s33, 6684672
    buffer_store_dwordx2 v[16:17], v12, s[24:27], s33 offen
K1_P3:
    s_mov_b64 exec, -1
    v_and_b32 v2, 63, v0
    v_lshlrev_b32 v2, 4, v2
    s_waitcnt lgkmcnt(0)
    s_barrier
    ds_read_b128 v[36:39], v2 offset:0
    s_waitcnt lgkmcnt(0)
    v_add_u32 v42, v36, v37
    v_add_u32 v43, v42, v38
    v_add_u32 v44, v43, v39
    v_mov_b32 v45, v44
    s_nop 1
    v_add_u32_dpp v45, v45, v45 row_shr:1 row_mask:0xf bank_mask:0xf
    s_nop 1
    v_add_u32_dpp v45, v45, v45 row_shr:2 row_mask:0xf bank_mask:0xf
    s_nop 1
    v_add_u32_dpp v45, v45, v45 row_shr:4 row_mask:0xf bank_mask:0xf
    s_nop 1
    v_add_u32_dpp v45, v45, v45 row_shr:8 row_mask:0xf bank_mask:0xf
    s_nop 1
    v_add_u32_dpp v45, v45, v45 row_bcast:15 row_mask:0xa bank_mask:0xf
    s_nop 1
    v_add_u32_dpp v45, v45, v45 row_bcast:31 row_mask:0xc bank_mask:0xf
    v_sub_u32 v40, v45, v44
    v_add_u32 v41, v40, v36
    v_add_u32 v42, v40, v42
    v_add_u32 v43, v40, v43
    v_lshlrev_b32 v48, 3, v40
    v_lshlrev_b32 v49, 3, v41
    v_lshlrev_b32 v50, 3, v42
    v_lshlrev_b32 v51, 3, v43
    ds_write_b128 v2, v[48:51] offset:1280
    s_mov_b64 exec, s[34:35]
    ds_read_b32 v92, v92 offset:1280
    ds_read_b32 v93, v93 offset:1280
    ds_read_b32 v94, v94 offset:1280
    ds_read_b32 v95, v95 offset:1280
    ds_read_b32 v96, v96 offset:1280
    ds_read_b32 v97, v97 offset:1280
    ds_read_b32 v98, v98 offset:1280
    ds_read_b32 v99, v99 offset:1280
    s_cmp_ge_u32 s3, 4
    s_cbranch_scc1 K1_SW0
    s_waitcnt vmcnt(1)
    s_branch K1_SW1
K1_SW0:
    s_waitcnt vmcnt(0)
K1_SW1:
    v_mul_u32_u24 v77, 2675, v68
    v_lshrrev_b32 v77, 24, v77
    v_sub_u32 v77, v77, v108
    v_and_b32 v77, 7, v77
    v_lshl_or_b32 v60, v60, 3, v77
    v_lshl_or_b32 v77, v60, 18, v68
    v_mul_u32_u24 v79, 2675, v69
    v_lshrrev_b32 v79, 24, v79
    v_sub_u32 v79, v79, v109
    v_and_b32 v79, 7, v79
    v_lshl_or_b32 v61, v61, 3, v79
    v_lshl_or_b32 v79, v61, 18, v69
    v_mul_u32_u24 v81, 2675, v70
    v_lshrrev_b32 v81, 24, v81
    v_sub_u32 v81, v81, v110
    v_and_b32 v81, 7, v81
    v_lshl_or_b32 v62, v62, 3, v81
    v_lshl_or_b32 v81, v62, 18, v70
    v_mul_u32_u24 v83, 2675, v71
    v_lshrrev_b32 v83, 24, v83
    v_sub_u32 v83, v83, v111
    v_and_b32 v83, 7, v83
    v_lshl_or_b32 v63, v63, 3, v83
    v_lshl_or_b32 v83, v63, 18, v71
    v_mul_u32_u24 v85, 2675, v72
    v_lshrrev_b32 v85, 24, v85
    v_sub_u32 v85, v85, v112
    v_and_b32 v85, 7, v85
    v_lshl_or_b32 v64, v64, 3, v85
    v_lshl_or_b32 v85, v64, 18, v72
    v_mul_u32_u24 v87, 2675, v73
    v_lshrrev_b32 v87, 24, v87
    v_sub_u32 v87, v87, v113
    v_and_b32 v87, 7, v87
    v_lshl_or_b32 v65, v65, 3, v87
    v_lshl_or_b32 v87, v65, 18, v73
    v_mul_u32_u24 v89, 2675, v74
    v_lshrrev_b32 v89, 24, v89
    v_sub_u32 v89, v89, v114
    v_and_b32 v89, 7, v89
    v_lshl_or_b32 v66, v66, 3, v89
    v_lshl_or_b32 v89, v66, 18, v74
    v_mul_u32_u24 v91, 2675, v75
    v_lshrrev_b32 v91, 24, v91
    v_sub_u32 v91, v91, v115
    v_and_b32 v91, 7, v91
    v_lshl_or_b32 v67, v67, 3, v91
    v_lshl_or_b32 v91, v67, 18, v75
    s_cmp_lg_u32 s3, 6
    s_cbranch_scc1 K1_NOOFF
    s_mov_b64 exec, -1
    v_lshl_or_b32 v40, v36, 16, v40
    v_lshl_or_b32 v41, v37, 16, v41
    v_lshl_or_b32 v42, v38, 16, v42
    v_lshl_or_b32 v43, v39, 16, v43
    v_lshlrev_b32 v2, 8, v2
    s_lshl_b32 s33, s2, 4
    s_add_u32 s33, s33, 6422528
    buffer_store_dwordx4 v[40:43], v2, s[24:27], s33 offen
    s_mov_b64 exec, s[34:35]
K1_NOOFF:
    s_waitcnt lgkmcnt(7)
    v_lshl_add_u32 v92, v100, 3, v92
    ds_write_b64 v92, v[76:77] offset:2304
    s_waitcnt lgkmcnt(7)
    v_lshl_add_u32 v93, v101, 3, v93
    ds_write_b64 v93, v[78:79] offset:2304
    s_waitcnt lgkmcnt(7)
    v_lshl_add_u32 v94, v102, 3, v94
    ds_write_b64 v94, v[80:81] offset:2304
    s_waitcnt lgkmcnt(7)
    v_lshl_add_u32 v95, v103, 3, v95
    ds_write_b64 v95, v[82:83] offset:2304
    s_waitcnt lgkmcnt(7)
    v_lshl_add_u32 v96, v104, 3, v96
    ds_write_b64 v96, v[84:85] offset:2304
    s_waitcnt lgkmcnt(7)
    v_lshl_add_u32 v97, v105, 3, v97
    ds_write_b64 v97, v[86:87] offset:2304
    s_waitcnt lgkmcnt(7)
    v_lshl_add_u32 v98, v106, 3, v98
    ds_write_b64 v98, v[88:89] offset:2304
    s_waitcnt lgkmcnt(7)
    v_lshl_add_u32 v99, v107, 3, v99
    ds_write_b64 v99, v[90:91] offset:2304
    s_mul_i32 s33, s2, 25600
    s_waitcnt lgkmcnt(0)
    s_barrier
    ds_read_b128 v[60:63], v14 offset:2304
    ds_read_b128 v[64:67], v14 offset:8704
    ds_read_b128 v[68:71], v14 offset:15104
    ds_read_b128 v[72:75], v14 offset:21504
    s_waitcnt lgkmcnt(3)
    buffer_store_dwordx4 v[60:63], v14, s[24:27], s33 offen sc1
    s_add_u32 s33, s33, 6400
    s_waitcnt lgkmcnt(2)
    buffer_store_dwordx4 v[64:67], v14, s[24:27], s33 offen sc1
    s_add_u32 s33, s33, 6400
    s_waitcnt lgkmcnt(1)
    buffer_store_dwordx4 v[68:71], v14, s[24:27], s33 offen sc1
    s_add_u32 s33, s33, 6400
    s_waitcnt lgkmcnt(0)
    buffer_store_dwordx4 v[72:75], v14, s[24:27], s33 offen sc1
    s_endpgm
K1_FRAG:
    s_cmp_ge_u32 s2, 144
    s_cbranch_scc1 K1_END
    s_load_dwordx4 s[4:7], s[0:1], 40
    s_load_dwordx2 s[8:9], s[0:1], 56
    s_lshr_b32 s28, s2, 2
    s_and_b32 s3, s2, 3
    s_lshl_b32 s3, s3, 6
    v_and_b32 v1, 63, v0
    v_add_u32 v1, s3, v1
    v_lshlrev_b32 v10, 2, v1
    s_lshl_b32 s33, s28, 10
    s_add_u32 s33, s33, 7536640
    s_mov_b32 s34, 0xbfb8aa3b
    s_waitcnt lgkmcnt(0)
    s_mov_b32 s12, s4
    s_and_b32 s13, s5, 0xffff
    s_mov_b32 s14, 18560
    s_mov_b32 s15, 0x20000
    s_mov_b32 s16, s6
    s_and_b32 s17, s7, 0xffff
    s_mov_b32 s18, 128
    s_mov_b32 s19, 0x20000
    s_mov_b32 s20, s8
    s_and_b32 s21, s9, 0xffff
    s_mov_b32 s22, 16384
    s_mov_b32 s23, 0x20000
    s_mov_b32 s24, s38
    s_and_b32 s25, s39, 0xffff
    s_mov_b32 s26, 25427968
    s_mov_b32 s27, 0x20000
    s_cmp_eq_u32 s28, 19
    s_cbranch_scc1 K1_WX
    s_cmp_eq_u32 s28, 18
    s_cbranch_scc1 K1_W3
    v_lshrrev_b32 v2, 2, v1
    v_and_b32 v3, 4, v2
    v_lshlrev_b32 v3, 3, v3
    v_bfe_u32 v4, v2, 3, 2
    v_lshl_add_u32 v3, v4, 2, v3
    v_and_b32 v4, 3, v2
    v_add_u32 v3, v3, v4
    v_lshrrev_b32 v5, 7, v1
    v_and_b32 v6, 3, v1
    s_mov_b32 s35, 32
    s_cmp_ge_u32 s28, 18
    s_cbranch_scc1 K1_FH
    s_cmp_ge_u32 s28, 16
    s_cbranch_scc1 K1_F4
    s_mov_b32 s36, s28
    s_branch K1_FC
K1_FH:
    s_sub_u32 s36, s28, 20
    s_mov_b32 s12, s20
    s_mov_b32 s13, s21
    s_mov_b32 s14, s22
    s_cmp_ge_u32 s36, 8
    s_cselect_b32 s34, 1.0, s34
K1_FC:
    s_lshr_b32 s37, s36, 3
    s_lshl_b32 s37, s37, 6
    s_and_b32 s38, s36, 3
    s_lshl_b32 s38, s38, 3
    s_add_u32 s37, s37, s38
    s_bfe_u32 s38, s36, 0x10002
    s_branch K1_FD
K1_F4:
    s_mov_b32 s35, 8
    s_movk_i32 s37, 129
    s_sub_u32 s38, s28, 16
K1_FD:
    s_lshl_b32 s38, s38, 4
    v_mul_u32_u24 v5, s35, v5
    v_lshl_add_u32 v5, v6, 1, v5
    v_add_u32 v5, s37, v5
    v_add_u32 v3, s38, v3
    v_lshlrev_b32 v3, 1, v3
    v_lshl_add_u32 v3, v5, 7, v3
    buffer_load_ushort v7, v3, s[12:15], 0 offen
    buffer_load_ushort v8, v3, s[12:15], 0 offen offset:128
    s_waitcnt vmcnt(0)
    v_lshlrev_b32 v7, 16, v7
    v_lshlrev_b32 v8, 16, v8
    v_mul_f32 v7, s34, v7
    v_mul_f32 v8, s34, v8
    v_cvt_pk_bf16_f32 v7, v7, v8
    buffer_store_dword v7, v10, s[24:27], s33 offen
    s_endpgm
K1_W3:
    v_and_b32 v2, 31, v1
    v_and_b32 v3, 4, v2
    v_lshlrev_b32 v3, 3, v3
    v_bfe_u32 v4, v2, 3, 2
    v_lshl_add_u32 v3, v4, 2, v3
    v_and_b32 v4, 3, v2
    v_add_u32 v3, v3, v4
    v_bfe_u32 v5, v1, 6, 1
    v_lshl_add_u32 v3, v5, 4, v3
    v_lshlrev_b32 v3, 1, v3
    s_movk_i32 s35, 16384
    buffer_load_ushort v7, v3, s[12:15], s35 offen
    v_and_b32 v6, 32, v1
    v_cmp_eq_u32 vcc, 0, v6
    s_waitcnt vmcnt(0)
    v_lshlrev_b32 v7, 16, v7
    v_mul_f32 v7, s34, v7
    v_cvt_pk_bf16_f32 v8, v7, v7
    v_lshlrev_b32 v8, 16, v8
    v_sub_f32 v9, v7, v8
    v_cvt_pk_bf16_f32 v7, v8, v9
    v_cndmask_b32 v7, 0, v7, vcc
    buffer_store_dword v7, v10, s[24:27], s33 offen
    s_endpgm
K1_WX:
    v_lshlrev_b32 v3, 1, v1
    buffer_load_ushort v7, v3, s[16:19], 0 offen
    s_waitcnt vmcnt(0)
    v_lshlrev_b32 v7, 16, v7
    v_mul_f32 v7, 0xbf317218, v7
    buffer_store_dword v7, v10, s[24:27], s33 offen
K1_END:
    s_endpgm
.globl egnn_main_kernel
.p2align 8
.type egnn_main_kernel,@function
egnn_main_kernel:
    s_cmp_ge_u32 s2, 256
    s_cbranch_scc1 K2_END
    s_load_dwordx2 s[28:29], s[0:1], 0
    s_load_dwordx2 s[30:31], s[0:1], 16
    s_load_dwordx2 s[32:33], s[0:1], 64
    s_load_dwordx2 s[34:35], s[0:1], 80
    v_mov_b32 v250, v0
    v_lshrrev_b32 v220, 6, v0
    s_and_b32 s3, s2, 7
    s_lshl_b32 s3, s3, 5
    v_readfirstlane_b32 s5, v220
    s_lshr_b32 s95, s2, 3
    s_add_u32 s3, s3, s95
    s_mul_i32 s4, s3, 196
    s_sub_u32 s96, 50000, s4
    s_min_u32 s96, s96, 196
    s_mov_b32 s7, 0
    s_mov_b32 s92, 48
    s_sub_u32 s100, 11, s5
    s_cmp_lt_u32 s5, 4
    s_cselect_b32 s100, s5, s100
    s_lshl_b32 s94, s100, 12
    s_add_u32 s94, s94, 34816
    s_waitcnt lgkmcnt(0)
    s_add_u32 s88, s34, 6422528
    s_addc_u32 s89, s35, 0
    s_and_b32 s89, s89, 0xffff
    s_mov_b32 s90, 262144
    s_mov_b32 s91, 0x20000
    s_mov_b32 s8, s28
    s_and_b32 s9, s29, 0xffff
    s_or_b32 s9, s9, 8388608
    s_mov_b32 s10, 50000
    s_mov_b32 s11, 0x20000
    s_mov_b32 s12, s30
    s_and_b32 s13, s31, 0xffff
    s_or_b32 s13, s13, 2097152
    s_mov_b32 s14, 800000
    s_mov_b32 s15, 0x20000
    s_add_u32 s16, s34, 6684672
    s_addc_u32 s17, s35, 0
    s_and_b32 s17, s17, 0xffff
    s_or_b32 s17, s17, 524288
    s_mov_b32 s18, 50000
    s_mov_b32 s19, 0x20000
    s_mov_b32 s20, s34
    s_and_b32 s21, s35, 0xffff
    s_mov_b32 s22, 25427968
    s_mov_b32 s23, 0x20000
    s_mov_b32 s24, s32
    s_and_b32 s25, s33, 0xffff
    s_mov_b32 s26, 6700000
    s_mov_b32 s27, 0x20000
K2_TOP:
    v_bfe_u32 v220, v250, 4, 2
    s_mul_i32 s95, s5, 36
    s_sub_u32 s95, s95, 36
    v_mad_u32_u24 v220, v220, 9, s95
    v_lshlrev_b32 v221, 4, v220
    s_and_b32 s95, s3, 3
    s_mul_i32 s95, s95, 1020
    s_lshl_b32 s99, s3, 10
    s_sub_u32 s95, s99, s95
    s_cmp_eq_u32 s5, 0
    s_cbranch_scc1 K2_NOOF
    buffer_load_dword v172, v221, s[88:91], s95 offen offset:0
    buffer_load_dword v173, v221, s[88:91], s95 offen offset:16
    buffer_load_dword v174, v221, s[88:91], s95 offen offset:32
    buffer_load_dword v175, v221, s[88:91], s95 offen offset:48
    buffer_load_dword v176, v221, s[88:91], s95 offen offset:64
    buffer_load_dword v177, v221, s[88:91], s95 offen offset:80
    buffer_load_dword v178, v221, s[88:91], s95 offen offset:96
    buffer_load_dword v179, v221, s[88:91], s95 offen offset:112
    buffer_load_dword v180, v221, s[88:91], s95 offen offset:128
K2_NOOF:
    v_and_b32 v222, 63, v250
    v_lshlrev_b32 v203, 4, v222
    v_lshrrev_b32 v239, 3, v222
    v_lshrrev_b32 v223, 4, v222
    v_xor_b32 v223, v223, v222
    v_and_b32 v223, 7, v223
    v_lshlrev_b32 v211, 4, v223
    v_xor_b32 v213, 64, v211
    v_mov_b32 v215, v211
    v_mov_b32 v217, v213
    s_lshl_b32 s95, s5, 5
    s_add_u32 s95, s95, s4
    v_add_u32 v210, s95, v239
    v_add_u32 v212, 8, v210
    v_add_u32 v214, 16, v210
    v_add_u32 v216, 24, v210
    s_add_u32 s99, s4, s96
    v_cmp_gt_u32 vcc, s99, v210
    s_nop 1
    v_cndmask_b32 v210, -1, v210, vcc
    v_cmp_gt_u32 vcc, s99, v212
    s_nop 1
    v_cndmask_b32 v212, -1, v212, vcc
    v_cmp_gt_u32 vcc, s99, v214
    s_nop 1
    v_cndmask_b32 v214, -1, v214, vcc
    v_cmp_gt_u32 vcc, s99, v216
    s_nop 1
    v_cndmask_b32 v216, -1, v216, vcc
    s_lshl_b32 s101, s5, 12
    s_add_u32 s101, s101, 100352
    s_barrier
    s_mul_i32 s95, s5, 3072
    s_add_u32 m0, s95, 138240
    s_add_u32 s95, s95, 7536640
    buffer_load_dwordx4 v203, s[20:23], s95 offen offset:0 lds
    buffer_load_dwordx4 v203, s[20:23], s95 offen offset:1024 lds
    buffer_load_dwordx4 v203, s[20:23], s95 offen offset:2048 lds
    v_mov_b32 v228, 0
    v_mov_b32 v229, 0
    v_mov_b32 v230, 0
    v_mov_b32 v231, 0
    s_lshl_b32 s95, s5, 10
    s_cmp_ge_u32 s5, 4
    s_cselect_b32 s99, 30720, 0
    s_add_u32 s95, s95, s99
    v_add_u32 v223, s95, v203
    ds_write_b128 v223, v[228:231]
    ds_write_b128 v223, v[228:231] offset:4096
    v_and_b32 v223, 2047, v223
    ds_write_b128 v223, v[228:231] offset:43008
    v_lshlrev_b32 v239, 2, v239
    v_mov_b32 v41, 0
    v_mov_b32 v43, 0
    v_mov_b32 v209, 0
    v_lshrrev_b32 v219, 5, v222
    v_lshlrev_b32 v219, 4, v219
    v_and_b32 v223, 31, v222
    v_bfe_u32 v251, v222, 1, 3
    v_lshlrev_b32 v251, 4, v251
    v_lshlrev_b32 v252, 2, v219
    v_xor_b32 v251, v251, v252
    v_lshl_add_u32 v251, v223, 7, v251
    v_add_u32 v251, s94, v251
    v_xor_b32 v252, 16, v251
    v_xor_b32 v253, 32, v251
    v_xor_b32 v254, 48, v251
    v_and_b32 v222, 15, v250
    v_cmp_gt_u32 vcc, 243, v220
    v_mul_u32_u24 v220, 3200, v220
    v_add3_u32 v220, v220, v222, s7
    v_add_u32 v221, 16, v222
    v_add_u32 v223, 32, v222
    v_cmp_gt_u32_e64 s[32:33], s92, v221
    v_cmp_gt_u32_e64 s[34:35], s92, v222
    s_nop 0
    v_cndmask_b32_e64 v221, 2.0, v221, s[32:33]
    v_cndmask_b32_e64 v223, 2.0, v223, s[32:33]
    v_cndmask_b32_e64 v222, 2.0, v222, s[34:35]
    s_cmp_eq_u32 s5, 0
    s_waitcnt vmcnt(3)
    s_cbranch_scc0 K2_MK
    s_branch K2_NOREC
K2_MK:
    v_cndmask_b32 v179, 0, v179, vcc
    v_cndmask_b32 v180, 0, v180, vcc
    v_and_b32 v98, 0xffff, v172
    v_lshrrev_b32 v172, 16, v172
    v_subrev_u32 v172, s7, v172
    v_cmp_gt_i32_e64 s[32:33], v172, v222
    v_add_lshl_u32 v98, v98, v220, 3
    s_mov_b32 s95, 0
    v_cndmask_b32_e64 v98, 2.0, v98, s[32:33]
    buffer_load_dwordx2 v[44:45], v98, s[20:23], s95 offen
    v_and_b32 v99, 0xffff, v173
    v_lshrrev_b32 v173, 16, v173
    v_subrev_u32 v173, s7, v173
    v_cmp_gt_i32_e64 s[34:35], v173, v222
    v_add_lshl_u32 v99, v99, v220, 3
    s_mov_b32 s95, 25600
    v_cndmask_b32_e64 v99, 2.0, v99, s[34:35]
    buffer_load_dwordx2 v[46:47], v99, s[20:23], s95 offen
    v_and_b32 v100, 0xffff, v174
    v_lshrrev_b32 v174, 16, v174
    v_subrev_u32 v174, s7, v174
    v_cmp_gt_i32_e64 s[36:37], v174, v222
    v_add_lshl_u32 v100, v100, v220, 3
    s_mov_b32 s95, 51200
    v_cndmask_b32_e64 v100, 2.0, v100, s[36:37]
    buffer_load_dwordx2 v[48:49], v100, s[20:23], s95 offen
    v_and_b32 v101, 0xffff, v175
    v_lshrrev_b32 v175, 16, v175
    v_subrev_u32 v175, s7, v175
    v_cmp_gt_i32_e64 s[38:39], v175, v222
    v_add_lshl_u32 v101, v101, v220, 3
    s_mov_b32 s95, 76800
    v_cndmask_b32_e64 v101, 2.0, v101, s[38:39]
    buffer_load_dwordx2 v[50:51], v101, s[20:23], s95 offen
    v_and_b32 v102, 0xffff, v176
    v_lshrrev_b32 v176, 16, v176
    v_subrev_u32 v176, s7, v176
    v_cmp_gt_i32_e64 s[40:41], v176, v222
    v_add_lshl_u32 v102, v102, v220, 3
    s_mov_b32 s95, 102400
    v_cndmask_b32_e64 v102, 2.0, v102, s[40:41]
    buffer_load_dwordx2 v[52:53], v102, s[20:23], s95 offen
    v_and_b32 v103, 0xffff, v177
    v_lshrrev_b32 v177, 16, v177
    v_subrev_u32 v177, s7, v177
    v_cmp_gt_i32_e64 s[42:43], v177, v222
    v_add_lshl_u32 v103, v103, v220, 3
    s_mov_b32 s95, 128000
    v_cndmask_b32_e64 v103, 2.0, v103, s[42:43]
    buffer_load_dwordx2 v[54:55], v103, s[20:23], s95 offen
    v_and_b32 v104, 0xffff, v178
    v_lshrrev_b32 v178, 16, v178
    v_subrev_u32 v178, s7, v178
    v_cmp_gt_i32_e64 s[44:45], v178, v222
    v_add_lshl_u32 v104, v104, v220, 3
    s_mov_b32 s95, 153600
    v_cndmask_b32_e64 v104, 2.0, v104, s[44:45]
    buffer_load_dwordx2 v[56:57], v104, s[20:23], s95 offen
    v_and_b32 v105, 0xffff, v179
    v_lshrrev_b32 v179, 16, v179
    v_subrev_u32 v179, s7, v179
    v_cmp_gt_i32_e64 s[46:47], v179, v222
    v_add_lshl_u32 v105, v105, v220, 3
    s_mov_b32 s95, 179200
    v_cndmask_b32_e64 v105, 2.0, v105, s[46:47]
    buffer_load_dwordx2 v[58:59], v105, s[20:23], s95 offen
    v_and_b32 v106, 0xffff, v180
    v_lshrrev_b32 v180, 16, v180
    v_subrev_u32 v180, s7, v180
    v_cmp_gt_i32_e64 s[48:49], v180, v222
    v_add_lshl_u32 v106, v106, v220, 3
    s_mov_b32 s95, 204800
    v_cndmask_b32_e64 v106, 2.0, v106, s[48:49]
    buffer_load_dwordx2 v[60:61], v106, s[20:23], s95 offen
    v_cmp_gt_i32_e64 s[50:51], v172, v221
    v_cmp_gt_i32_e64 s[68:69], v172, v223
    v_cmp_gt_i32_e64 s[52:53], v173, v221
    v_cmp_gt_i32_e64 s[70:71], v173, v223
    v_cmp_gt_i32_e64 s[54:55], v174, v221
    v_cmp_gt_i32_e64 s[72:73], v174, v223
    v_cmp_gt_i32_e64 s[56:57], v175, v221
    v_cmp_gt_i32_e64 s[74:75], v175, v223
    v_cmp_gt_i32_e64 s[58:59], v176, v221
    v_cmp_gt_i32_e64 s[76:77], v176, v223
    v_cmp_gt_i32_e64 s[60:61], v177, v221
    v_cmp_gt_i32_e64 s[78:79], v177, v223
    v_cmp_gt_i32_e64 s[62:63], v178, v221
    v_cmp_gt_i32_e64 s[80:81], v178, v223
    v_cmp_gt_i32_e64 s[64:65], v179, v221
    v_cmp_gt_i32_e64 s[82:83], v179, v223
    v_cmp_gt_i32_e64 s[66:67], v180, v221
    v_cmp_gt_i32_e64 s[84:85], v180, v223
    s_mov_b32 s95, 0
    s_mov_b64 exec, s[50:51]
    s_cbranch_execz K2_G1
    buffer_load_dwordx2 v[62:63], v98, s[20:23], s95 offen offset:128
K2_G1:
    s_mov_b32 s95, 25600
    s_mov_b64 exec, s[52:53]
    s_cbranch_execz K2_G2
    buffer_load_dwordx2 v[64:65], v99, s[20:23], s95 offen offset:128
K2_G2:
    s_mov_b32 s95, 51200
    s_mov_b64 exec, s[54:55]
    s_cbranch_execz K2_G3
    buffer_load_dwordx2 v[66:67], v100, s[20:23], s95 offen offset:128
K2_G3:
    s_mov_b32 s95, 76800
    s_mov_b64 exec, s[56:57]
    s_cbranch_execz K2_G4
    buffer_load_dwordx2 v[68:69], v101, s[20:23], s95 offen offset:128
K2_G4:
    s_mov_b32 s95, 102400
    s_mov_b64 exec, s[58:59]
    s_cbranch_execz K2_G5
    buffer_load_dwordx2 v[70:71], v102, s[20:23], s95 offen offset:128
K2_G5:
    s_mov_b32 s95, 128000
    s_mov_b64 exec, s[60:61]
    s_cbranch_execz K2_G6
    buffer_load_dwordx2 v[72:73], v103, s[20:23], s95 offen offset:128
K2_G6:
    s_mov_b32 s95, 153600
    s_mov_b64 exec, s[62:63]
    s_cbranch_execz K2_G7
    buffer_load_dwordx2 v[74:75], v104, s[20:23], s95 offen offset:128
K2_G7:
    s_mov_b32 s95, 179200
    s_mov_b64 exec, s[64:65]
    s_cbranch_execz K2_G8
    buffer_load_dwordx2 v[76:77], v105, s[20:23], s95 offen offset:128
K2_G8:
    s_mov_b32 s95, 204800
    s_mov_b64 exec, s[66:67]
    s_cbranch_execz K2_G9
    buffer_load_dwordx2 v[78:79], v106, s[20:23], s95 offen offset:128
K2_G9:
    s_or_b64 vcc, s[68:69], s[70:71]
    s_or_b64 vcc, vcc, s[72:73]
    s_or_b64 vcc, vcc, s[74:75]
    s_or_b64 vcc, vcc, s[76:77]
    s_or_b64 vcc, vcc, s[78:79]
    s_or_b64 vcc, vcc, s[80:81]
    s_or_b64 vcc, vcc, s[82:83]
    s_or_b64 vcc, vcc, s[84:85]
    s_cselect_b32 s97, 1, 0
    s_cbranch_scc0 K2_NP2A
    s_mov_b32 s95, 0
    s_mov_b64 exec, s[68:69]
    s_cbranch_execz K2_G10
    buffer_load_dwordx2 v[80:81], v98, s[20:23], s95 offen offset:256
K2_G10:
    s_mov_b32 s95, 25600
    s_mov_b64 exec, s[70:71]
    s_cbranch_execz K2_G11
    buffer_load_dwordx2 v[82:83], v99, s[20:23], s95 offen offset:256
K2_G11:
    s_mov_b32 s95, 51200
    s_mov_b64 exec, s[72:73]
    s_cbranch_execz K2_G12
    buffer_load_dwordx2 v[84:85], v100, s[20:23], s95 offen offset:256
K2_G12:
    s_mov_b32 s95, 76800
    s_mov_b64 exec, s[74:75]
    s_cbranch_execz K2_G13
    buffer_load_dwordx2 v[86:87], v101, s[20:23], s95 offen offset:256
K2_G13:
    s_mov_b32 s95, 102400
    s_mov_b64 exec, s[76:77]
    s_cbranch_execz K2_G14
    buffer_load_dwordx2 v[88:89], v102, s[20:23], s95 offen offset:256
K2_G14:
    s_mov_b32 s95, 128000
    s_mov_b64 exec, s[78:79]
    s_cbranch_execz K2_G15
    buffer_load_dwordx2 v[90:91], v103, s[20:23], s95 offen offset:256
K2_G15:
    s_mov_b32 s95, 153600
    s_mov_b64 exec, s[80:81]
    s_cbranch_execz K2_G16
    buffer_load_dwordx2 v[92:93], v104, s[20:23], s95 offen offset:256
K2_G16:
    s_mov_b32 s95, 179200
    s_mov_b64 exec, s[82:83]
    s_cbranch_execz K2_G17
    buffer_load_dwordx2 v[94:95], v105, s[20:23], s95 offen offset:256
K2_G17:
    s_mov_b32 s95, 204800
    s_mov_b64 exec, s[84:85]
    s_cbranch_execz K2_G18
    buffer_load_dwordx2 v[96:97], v106, s[20:23], s95 offen offset:256
K2_G18:
K2_NP2A:
    s_mov_b64 exec, -1
    v_max3_i32 v221, v172, v173, v174
    v_max3_i32 v221, v221, v175, v176
    v_max3_i32 v221, v221, v177, v178
    v_max3_i32 v221, v221, v179, v180
    v_mov_b32 v223, 1
    v_cmp_lt_i32_e64 s[86:87], s92, v221
K2_NOREC:
    s_waitcnt lgkmcnt(0)
    s_barrier
    s_add_u32 s95, s101, 0
    s_cmp_lt_u32 s95, 125952
    s_cselect_b32 m0, s95, 47104
    s_nop 0
    buffer_load_dwordx4 v[210:211], s[8:11], 0 idxen offen lds
    s_add_u32 s95, s101, 1024
    s_cmp_lt_u32 s95, 125952
    s_cselect_b32 m0, s95, 47104
    s_nop 0
    buffer_load_dwordx4 v[212:213], s[8:11], 0 idxen offen lds
    s_add_u32 s95, s101, 2048
    s_cmp_lt_u32 s95, 125952
    s_cselect_b32 m0, s95, 47104
    s_nop 0
    buffer_load_dwordx4 v[214:215], s[8:11], 0 idxen offen lds
    s_add_u32 s95, s101, 3072
    s_cmp_lt_u32 s95, 125952
    s_cselect_b32 m0, s95, 47104
    s_nop 0
    buffer_load_dwordx4 v[216:217], s[8:11], 0 idxen offen lds
    s_cmp_lg_u32 s5, 0
    s_cbranch_scc1 K2_NOPW
    s_lshr_b32 s95, s2, 3
    s_mul_i32 s99, s95, 0
    v_add_u32 v224, s99, v203
    s_mul_i32 s99, s95, 0
    v_add_u32 v225, s99, v250
    v_add_u32 v224, 0, v250
    v_cmp_gt_u32 vcc, s96, v224
    s_nop 1
    v_cndmask_b32_e64 v104, -0.5, 0.5, vcc
    v_add_u32 v224, 64, v250
    v_cmp_gt_u32 vcc, s96, v224
    s_nop 1
    v_cndmask_b32_e64 v105, -0.5, 0.5, vcc
    v_add_u32 v224, 128, v250
    v_cmp_gt_u32 vcc, s96, v224
    s_nop 1
    v_cndmask_b32_e64 v106, -0.5, 0.5, vcc
    v_add_u32 v224, 192, v250
    v_cmp_gt_u32 vcc, s96, v224
    s_nop 1
    v_cndmask_b32_e64 v107, -0.5, 0.5, vcc
    s_branch K2_B1
K2_NOPW:
    s_mov_b64 exec, s[86:87]
    ds_write_b32 v228, v223 offset:96
    s_mov_b64 exec, -1
    s_waitcnt vmcnt(12)
    s_mov_b64 exec, s[32:33]
    v_lshrrev_b32 v172, 16, v45
    ds_add_rtn_u32 v172, v172, v223 offset:34816
    s_waitcnt vmcnt(11)
    s_mov_b64 exec, s[34:35]
    v_lshrrev_b32 v173, 16, v47
    ds_add_rtn_u32 v173, v173, v223 offset:34816
    s_waitcnt vmcnt(10)
    s_mov_b64 exec, s[36:37]
    v_lshrrev_b32 v174, 16, v49
    ds_add_rtn_u32 v174, v174, v223 offset:34816
    s_waitcnt vmcnt(9)
    s_mov_b64 exec, s[38:39]
    v_lshrrev_b32 v175, 16, v51
    ds_add_rtn_u32 v175, v175, v223 offset:34816
    s_waitcnt vmcnt(8)
    s_mov_b64 exec, s[40:41]
    v_lshrrev_b32 v176, 16, v53
    ds_add_rtn_u32 v176, v176, v223 offset:34816
    s_waitcnt vmcnt(7)
    s_mov_b64 exec, s[42:43]
    v_lshrrev_b32 v177, 16, v55
    ds_add_rtn_u32 v177, v177, v223 offset:34816
    s_waitcnt vmcnt(6)
    s_mov_b64 exec, s[44:45]
    v_lshrrev_b32 v178, 16, v57
    ds_add_rtn_u32 v178, v178, v223 offset:34816
    s_waitcnt vmcnt(5)
    s_mov_b64 exec, s[46:47]
    v_lshrrev_b32 v179, 16, v59
    ds_add_rtn_u32 v179, v179, v223 offset:34816
    s_waitcnt vmcnt(4)
    s_mov_b64 exec, s[48:49]
    v_lshrrev_b32 v180, 16, v61
    ds_add_rtn_u32 v180, v180, v223 offset:34816
    s_mov_b64 exec, s[50:51]
    s_cbranch_execz K2_G19
    v_lshrrev_b32 v181, 16, v63
    ds_add_rtn_u32 v181, v181, v223 offset:34816
K2_G19:
    s_mov_b64 exec, s[52:53]
    s_cbranch_execz K2_G20
    v_lshrrev_b32 v182, 16, v65
    ds_add_rtn_u32 v182, v182, v223 offset:34816
K2_G20:
    s_mov_b64 exec, s[54:55]
    s_cbranch_execz K2_G21
    v_lshrrev_b32 v183, 16, v67
    ds_add_rtn_u32 v183, v183, v223 offset:34816
K2_G21:
    s_mov_b64 exec, s[56:57]
    s_cbranch_execz K2_G22
    v_lshrrev_b32 v184, 16, v69
    ds_add_rtn_u32 v184, v184, v223 offset:34816
K2_G22:
    s_mov_b64 exec, s[58:59]
    s_cbranch_execz K2_G23
    v_lshrrev_b32 v185, 16, v71
    ds_add_rtn_u32 v185, v185, v223 offset:34816
K2_G23:
    s_mov_b64 exec, s[60:61]
    s_cbranch_execz K2_G24
    v_lshrrev_b32 v186, 16, v73
    ds_add_rtn_u32 v186, v186, v223 offset:34816
K2_G24:
    s_mov_b64 exec, s[62:63]
    s_cbranch_execz K2_G25
    v_lshrrev_b32 v187, 16, v75
    ds_add_rtn_u32 v187, v187, v223 offset:34816
K2_G25:
    s_mov_b64 exec, s[64:65]
    s_cbranch_execz K2_G26
    v_lshrrev_b32 v188, 16, v77
    ds_add_rtn_u32 v188, v188, v223 offset:34816
K2_G26:
    s_mov_b64 exec, s[66:67]
    s_cbranch_execz K2_G27
    v_lshrrev_b32 v189, 16, v79
    ds_add_rtn_u32 v189, v189, v223 offset:34816
K2_G27:
    s_cmp_eq_u32 s97, 0
    s_cbranch_scc1 K2_NP2B
    s_mov_b64 exec, s[68:69]
    s_cbranch_execz K2_G28
    v_lshrrev_b32 v190, 16, v81
    ds_add_rtn_u32 v190, v190, v223 offset:34816
K2_G28:
    s_mov_b64 exec, s[70:71]
    s_cbranch_execz K2_G29
    v_lshrrev_b32 v191, 16, v83
    ds_add_rtn_u32 v191, v191, v223 offset:34816
K2_G29:
    s_mov_b64 exec, s[72:73]
    s_cbranch_execz K2_G30
    v_lshrrev_b32 v192, 16, v85
    ds_add_rtn_u32 v192, v192, v223 offset:34816
K2_G30:
    s_mov_b64 exec, s[74:75]
    s_cbranch_execz K2_G31
    v_lshrrev_b32 v193, 16, v87
    ds_add_rtn_u32 v193, v193, v223 offset:34816
K2_G31:
    s_mov_b64 exec, s[76:77]
    s_cbranch_execz K2_G32
    v_lshrrev_b32 v194, 16, v89
    ds_add_rtn_u32 v194, v194, v223 offset:34816
K2_G32:
    s_mov_b64 exec, s[78:79]
    s_cbranch_execz K2_G33
    v_lshrrev_b32 v195, 16, v91
    ds_add_rtn_u32 v195, v195, v223 offset:34816
K2_G33:
    s_mov_b64 exec, s[80:81]
    s_cbranch_execz K2_G34
    v_lshrrev_b32 v196, 16, v93
    ds_add_rtn_u32 v196, v196, v223 offset:34816
K2_G34:
    s_mov_b64 exec, s[82:83]
    s_cbranch_execz K2_G35
    v_lshrrev_b32 v197, 16, v95
    ds_add_rtn_u32 v197, v197, v223 offset:34816
K2_G35:
    s_mov_b64 exec, s[84:85]
    s_cbranch_execz K2_G36
    v_lshrrev_b32 v198, 16, v97
    ds_add_rtn_u32 v198, v198, v223 offset:34816
K2_G36:
K2_NP2B:
    s_mov_b64 exec, -1
K2_B1:
    s_cmp_lg_u32 s5, 0
    s_waitcnt lgkmcnt(0)
    s_barrier
    s_cbranch_scc1 K2_W2
    v_lshlrev_b32 v222, 1, v203
    ds_read_b128 v[0:3], v222 offset:34816
    ds_read_b128 v[4:7], v222 offset:34832
    ds_read_b128 v[8:11], v222 offset:36864
    ds_read_b128 v[12:15], v222 offset:36880
    ds_read_b128 v[16:19], v222 offset:38912
    ds_read_b128 v[20:23], v222 offset:38928
    ds_read_b128 v[24:27], v222 offset:40960
    ds_read_b128 v[28:31], v222 offset:40976
    s_waitcnt lgkmcnt(6)
    v_add3_u32 v76, v0, v1, v2
    v_add3_u32 v80, v3, v4, v5
    v_add3_u32 v76, v76, v6, v7
    v_add_u32 v76, v76, v80
    s_waitcnt lgkmcnt(4)
    v_add3_u32 v77, v8, v9, v10
    v_add3_u32 v81, v11, v12, v13
    v_add3_u32 v77, v77, v14, v15
    v_add_u32 v77, v77, v81
    s_waitcnt lgkmcnt(2)
    v_add3_u32 v78, v16, v17, v18
    v_add3_u32 v82, v19, v20, v21
    v_add3_u32 v78, v78, v22, v23
    v_add_u32 v78, v78, v82
    s_waitcnt lgkmcnt(0)
    v_add3_u32 v79, v24, v25, v26
    v_add3_u32 v83, v27, v28, v29
    v_add3_u32 v79, v79, v30, v31
    v_add_u32 v79, v79, v83
    v_add_u32 v82, v76, v77
    v_add_u32 v83, v82, v78
    v_add_u32 v220, v83, v79
    v_mov_b32 v221, v220
    s_nop 1
    v_add_u32_dpp v221, v221, v221 row_shr:1 row_mask:0xf bank_mask:0xf
    s_nop 1
    v_add_u32_dpp v221, v221, v221 row_shr:2 row_mask:0xf bank_mask:0xf
    s_nop 1
    v_add_u32_dpp v221, v221, v221 row_shr:4 row_mask:0xf bank_mask:0xf
    s_nop 1
    v_add_u32_dpp v221, v221, v221 row_shr:8 row_mask:0xf bank_mask:0xf
    s_nop 1
    v_add_u32_dpp v221, v221, v221 row_bcast:15 row_mask:0xa bank_mask:0xf
    s_nop 1
    v_add_u32_dpp v221, v221, v221 row_bcast:31 row_mask:0xc bank_mask:0xf
    v_sub_u32 v80, v221, v220
    v_add_u32 v81, v80, v76
    v_add_u32 v82, v80, v82
    v_add_u32 v83, v80, v83
    s_movk_i32 s95, 2560
    v_lshl_add_u32 v140, v80, 3, s95
    v_lshl_add_u32 v141, v0, 3, v140
    v_lshl_add_u32 v142, v1, 3, v141
    v_lshl_add_u32 v143, v2, 3, v142
    ds_write_b128 v222, v[140:143] offset:34816
    v_lshl_add_u32 v144, v3, 3, v143
    v_lshl_add_u32 v145, v4, 3, v144
    v_lshl_add_u32 v146, v5, 3, v145
    v_lshl_add_u32 v147, v6, 3, v146
    ds_write_b128 v222, v[144:147] offset:34832
    v_lshl_add_u32 v148, v81, 3, s95
    v_lshl_add_u32 v149, v8, 3, v148
    v_lshl_add_u32 v150, v9, 3, v149
    v_lshl_add_u32 v151, v10, 3, v150
    ds_write_b128 v222, v[148:151] offset:36864
    v_lshl_add_u32 v152, v11, 3, v151
    v_lshl_add_u32 v153, v12, 3, v152
    v_lshl_add_u32 v154, v13, 3, v153
    v_lshl_add_u32 v155, v14, 3, v154
    ds_write_b128 v222, v[152:155] offset:36880
    v_lshl_add_u32 v156, v82, 3, s95
    v_lshl_add_u32 v157, v16, 3, v156
    v_lshl_add_u32 v158, v17, 3, v157
    v_lshl_add_u32 v159, v18, 3, v158
    ds_write_b128 v222, v[156:159] offset:38912
    v_lshl_add_u32 v160, v19, 3, v159
    v_lshl_add_u32 v161, v20, 3, v160
    v_lshl_add_u32 v162, v21, 3, v161
    v_lshl_add_u32 v163, v22, 3, v162
    ds_write_b128 v222, v[160:163] offset:38928
    v_lshl_add_u32 v164, v83, 3, s95
    v_lshl_add_u32 v165, v24, 3, v164
    v_lshl_add_u32 v166, v25, 3, v165
    v_lshl_add_u32 v167, v26, 3, v166
    ds_write_b128 v222, v[164:167] offset:40960
    v_lshl_add_u32 v168, v27, 3, v167
    v_lshl_add_u32 v169, v28, 3, v168
    v_lshl_add_u32 v170, v29, 3, v169
    v_lshl_add_u32 v171, v30, 3, v170
    ds_write_b128 v222, v[168:171] offset:40976
    s_mov_b32 exec_lo, 0
    s_brev_b32 exec_hi, 1
    ds_write_b32 v228, v221 offset:100
    s_mov_b64 exec, -1
K2_W2:
    s_cmp_ge_u32 s5, 6
    s_cbranch_scc1 K2_NWH
    s_mul_i32 s95, s5, 2048
    s_add_u32 m0, s95, 125952
    s_add_u32 s95, s95, 7561216
    buffer_load_dwordx4 v203, s[20:23], s95 offen offset:0 lds
    buffer_load_dwordx4 v203, s[20:23], s95 offen offset:1024 lds
K2_NWH:
    s_cmp_eq_u32 s5, 0
    s_cbranch_scc1 K2_NFT
    s_mov_b32 s95, 1835008
    s_mov_b64 exec, s[32:33]
    v_and_or_b32 v140, v45, s95, v172
    v_lshrrev_b32 v141, 18, v45
    v_cmpx_gt_u32 vcc, 1, v140
    ds_write_b64 v141, v[44:45] offset:43008
    s_mov_b64 exec, s[34:35]
    v_and_or_b32 v142, v47, s95, v173
    v_lshrrev_b32 v143, 18, v47
    v_cmpx_gt_u32 vcc, 1, v142
    ds_write_b64 v143, v[46:47] offset:43008
    s_mov_b64 exec, s[36:37]
    v_and_or_b32 v144, v49, s95, v174
    v_lshrrev_b32 v145, 18, v49
    v_cmpx_gt_u32 vcc, 1, v144
    ds_write_b64 v145, v[48:49] offset:43008
    s_mov_b64 exec, s[38:39]
    v_and_or_b32 v146, v51, s95, v175
    v_lshrrev_b32 v147, 18, v51
    v_cmpx_gt_u32 vcc, 1, v146
    ds_write_b64 v147, v[50:51] offset:43008
    s_mov_b64 exec, s[40:41]
    v_and_or_b32 v148, v53, s95, v176
    v_lshrrev_b32 v149, 18, v53
    v_cmpx_gt_u32 vcc, 1, v148
    ds_write_b64 v149, v[52:53] offset:43008
    s_mov_b64 exec, s[42:43]
    v_and_or_b32 v150, v55, s95, v177
    v_lshrrev_b32 v151, 18, v55
    v_cmpx_gt_u32 vcc, 1, v150
    ds_write_b64 v151, v[54:55] offset:43008
    s_mov_b64 exec, s[44:45]
    v_and_or_b32 v152, v57, s95, v178
    v_lshrrev_b32 v153, 18, v57
    v_cmpx_gt_u32 vcc, 1, v152
    ds_write_b64 v153, v[56:57] offset:43008
    s_mov_b64 exec, s[46:47]
    v_and_or_b32 v154, v59, s95, v179
    v_lshrrev_b32 v155, 18, v59
    v_cmpx_gt_u32 vcc, 1, v154
    ds_write_b64 v155, v[58:59] offset:43008
    s_mov_b64 exec, s[48:49]
    v_and_or_b32 v156, v61, s95, v180
    v_lshrrev_b32 v157, 18, v61
    v_cmpx_gt_u32 vcc, 1, v156
    ds_write_b64 v157, v[60:61] offset:43008
    s_mov_b64 exec, -1
    s_mul_i32 s95, s5, 224
    v_lshrrev_b32 v140, 1, v203
    v_add_u32 v140, s95, v140
K2_NFT:
    s_cmp_eq_u32 s5, 0
    s_waitcnt lgkmcnt(0)
    s_barrier
    ds_read_b64 v[232:233], v228 offset:96
    s_cbranch_scc1 K2_NOS1
    ds_read_b64 v[140:141], v140 offset:42784
    s_mov_b64 exec, s[32:33]
    v_lshrrev_b32 v98, 16, v45
    ds_read_b32 v98, v98 offset:34816
    s_mov_b64 exec, s[34:35]
    v_lshrrev_b32 v99, 16, v47
    ds_read_b32 v99, v99 offset:34816
    s_mov_b64 exec, s[36:37]
    v_lshrrev_b32 v100, 16, v49
    ds_read_b32 v100, v100 offset:34816
    s_mov_b64 exec, s[38:39]
    v_lshrrev_b32 v101, 16, v51
    ds_read_b32 v101, v101 offset:34816
    s_mov_b64 exec, s[40:41]
    v_lshrrev_b32 v102, 16, v53
    ds_read_b32 v102, v102 offset:34816
    s_mov_b64 exec, s[42:43]
    v_lshrrev_b32 v103, 16, v55
    ds_read_b32 v103, v103 offset:34816
    s_mov_b64 exec, s[44:45]
    v_lshrrev_b32 v104, 16, v57
    ds_read_b32 v104, v104 offset:34816
    s_mov_b64 exec, s[46:47]
    v_lshrrev_b32 v105, 16, v59
    ds_read_b32 v105, v105 offset:34816
    s_mov_b64 exec, s[48:49]
    v_lshrrev_b32 v106, 16, v61
    ds_read_b32 v106, v106 offset:34816
    s_mov_b64 exec, -1
    s_waitcnt lgkmcnt(9)
    v_and_b32 v141, 0xffff, v141
    s_mov_b64 exec, 0xfffffff
    buffer_load_dword v202, v140, s[12:15], 0 idxen
    buffer_load_dword v202, v141, s[8:11], 0 idxen
    buffer_load_dword v202, v141, s[16:19], 0 idxen
    s_mov_b64 exec, s[50:51]
    s_cbranch_execz K2_G37
    v_lshrrev_b32 v220, 16, v63
    ds_read_b32 v220, v220 offset:34816
K2_G37:
    s_mov_b64 exec, s[52:53]
    s_cbranch_execz K2_G38
    v_lshrrev_b32 v221, 16, v65
    ds_read_b32 v221, v221 offset:34816
K2_G38:
    s_mov_b64 exec, s[54:55]
    s_cbranch_execz K2_G39
    v_lshrrev_b32 v222, 16, v67
    ds_read_b32 v222, v222 offset:34816
K2_G39:
    s_mov_b64 exec, s[56:57]
    s_cbranch_execz K2_G40
    v_lshrrev_b32 v223, 16, v69
    ds_read_b32 v223, v223 offset:34816
K2_G40:
    s_mov_b64 exec, s[58:59]
    s_cbranch_execz K2_G41
    v_lshrrev_b32 v224, 16, v71
    ds_read_b32 v224, v224 offset:34816
K2_G41:
    s_mov_b64 exec, s[60:61]
    s_cbranch_execz K2_G42
    v_lshrrev_b32 v225, 16, v73
    ds_read_b32 v225, v225 offset:34816
K2_G42:
    s_mov_b64 exec, s[62:63]
    s_cbranch_execz K2_G43
    v_lshrrev_b32 v226, 16, v75
    ds_read_b32 v226, v226 offset:34816
K2_G43:
    s_mov_b64 exec, s[64:65]
    s_cbranch_execz K2_G44
    v_lshrrev_b32 v227, 16, v77
    ds_read_b32 v227, v227 offset:34816
K2_G44:
    s_mov_b64 exec, s[66:67]
    s_cbranch_execz K2_G45
    v_lshrrev_b32 v228, 16, v79
    ds_read_b32 v228, v228 offset:34816
K2_G45:
    s_mov_b64 exec, -1
K2_NOS1:
    s_waitcnt lgkmcnt(0)
    v_readfirstlane_b32 s98, v233
    v_readfirstlane_b32 s93, v232
    s_cmp_le_u32 s98, 3776
    s_cbranch_scc1 K2_FITS
    s_cmp_eq_u32 s92, 15
    s_cbranch_scc1 K2_END0
    s_mov_b32 s92, 15
    s_waitcnt vmcnt(0)
    s_barrier
    s_branch K2_TOP
K2_FITS:
    s_cmp_eq_u32 s5, 0
    s_cbranch_scc1 K2_PLAN
    s_mov_b64 exec, s[32:33]
    v_lshl_add_u32 v98, v172, 3, v98
    ds_write_b64 v98, v[44:45]
    s_mov_b64 exec, s[34:35]
    v_lshl_add_u32 v99, v173, 3, v99
    ds_write_b64 v99, v[46:47]
    s_mov_b64 exec, s[36:37]
    v_lshl_add_u32 v100, v174, 3, v100
    ds_write_b64 v100, v[48:49]
    s_mov_b64 exec, s[38:39]
    v_lshl_add_u32 v101, v175, 3, v101
    ds_write_b64 v101, v[50:51]
    s_mov_b64 exec, s[40:41]
    v_lshl_add_u32 v102, v176, 3, v102
    ds_write_b64 v102, v[52:53]
    s_mov_b64 exec, s[42:43]
    v_lshl_add_u32 v103, v177, 3, v103
    ds_write_b64 v103, v[54:55]
    s_mov_b64 exec, s[44:45]
    v_lshl_add_u32 v104, v178, 3, v104
    ds_write_b64 v104, v[56:57]
    s_mov_b64 exec, s[46:47]
    v_lshl_add_u32 v105, v179, 3, v105
    ds_write_b64 v105, v[58:59]
    s_mov_b64 exec, s[48:49]
    v_lshl_add_u32 v106, v180, 3, v106
    ds_write_b64 v106, v[60:61]
    s_mov_b64 exec, s[50:51]
    s_cbranch_execz K2_G46
    v_lshl_add_u32 v220, v181, 3, v220
    ds_write_b64 v220, v[62:63]
K2_G46:
    s_mov_b64 exec, s[52:53]
    s_cbranch_execz K2_G47
    v_lshl_add_u32 v221, v182, 3, v221
    ds_write_b64 v221, v[64:65]
K2_G47:
    s_mov_b64 exec, s[54:55]
    s_cbranch_execz K2_G48
    v_lshl_add_u32 v222, v183, 3, v222
    ds_write_b64 v222, v[66:67]
K2_G48:
    s_mov_b64 exec, s[56:57]
    s_cbranch_execz K2_G49
    v_lshl_add_u32 v223, v184, 3, v223
    ds_write_b64 v223, v[68:69]
K2_G49:
    s_mov_b64 exec, s[58:59]
    s_cbranch_execz K2_G50
    v_lshl_add_u32 v224, v185, 3, v224
    ds_write_b64 v224, v[70:71]
K2_G50:
    s_mov_b64 exec, s[60:61]
    s_cbranch_execz K2_G51
    v_lshl_add_u32 v225, v186, 3, v225
    ds_write_b64 v225, v[72:73]
K2_G51:
    s_mov_b64 exec, s[62:63]
    s_cbranch_execz K2_G52
    v_lshl_add_u32 v226, v187, 3, v226
    ds_write_b64 v226, v[74:75]
K2_G52:
    s_mov_b64 exec, s[64:65]
    s_cbranch_execz K2_G53
    v_lshl_add_u32 v227, v188, 3, v227
    ds_write_b64 v227, v[76:77]
K2_G53:
    s_mov_b64 exec, s[66:67]
    s_cbranch_execz K2_G54
    v_lshl_add_u32 v228, v189, 3, v228
    ds_write_b64 v228, v[78:79]
K2_G54:
    s_cmp_eq_u32 s97, 0
    s_cbranch_scc1 K2_B3
    s_mov_b64 exec, s[68:69]
    s_cbranch_execz K2_G55
    v_lshrrev_b32 v98, 16, v81
    ds_read_b32 v98, v98 offset:34816
K2_G55:
    s_mov_b64 exec, s[70:71]
    s_cbranch_execz K2_G56
    v_lshrrev_b32 v99, 16, v83
    ds_read_b32 v99, v99 offset:34816
K2_G56:
    s_mov_b64 exec, s[72:73]
    s_cbranch_execz K2_G57
    v_lshrrev_b32 v100, 16, v85
    ds_read_b32 v100, v100 offset:34816
K2_G57:
    s_mov_b64 exec, s[74:75]
    s_cbranch_execz K2_G58
    v_lshrrev_b32 v101, 16, v87
    ds_read_b32 v101, v101 offset:34816
K2_G58:
    s_mov_b64 exec, s[76:77]
    s_cbranch_execz K2_G59
    v_lshrrev_b32 v102, 16, v89
    ds_read_b32 v102, v102 offset:34816
K2_G59:
    s_mov_b64 exec, s[78:79]
    s_cbranch_execz K2_G60
    v_lshrrev_b32 v103, 16, v91
    ds_read_b32 v103, v103 offset:34816
K2_G60:
    s_mov_b64 exec, s[80:81]
    s_cbranch_execz K2_G61
    v_lshrrev_b32 v104, 16, v93
    ds_read_b32 v104, v104 offset:34816
K2_G61:
    s_mov_b64 exec, s[82:83]
    s_cbranch_execz K2_G62
    v_lshrrev_b32 v105, 16, v95
    ds_read_b32 v105, v105 offset:34816
K2_G62:
    s_mov_b64 exec, s[84:85]
    s_cbranch_execz K2_G63
    v_lshrrev_b32 v106, 16, v97
    ds_read_b32 v106, v106 offset:34816
K2_G63:
    s_waitcnt lgkmcnt(0)
    s_mov_b64 exec, s[68:69]
    s_cbranch_execz K2_G64
    v_lshl_add_u32 v98, v190, 3, v98
    ds_write_b64 v98, v[80:81]
K2_G64:
    s_mov_b64 exec, s[70:71]
    s_cbranch_execz K2_G65
    v_lshl_add_u32 v99, v191, 3, v99
    ds_write_b64 v99, v[82:83]
K2_G65:
    s_mov_b64 exec, s[72:73]
    s_cbranch_execz K2_G66
    v_lshl_add_u32 v100, v192, 3, v100
    ds_write_b64 v100, v[84:85]
K2_G66:
    s_mov_b64 exec, s[74:75]
    s_cbranch_execz K2_G67
    v_lshl_add_u32 v101, v193, 3, v101
    ds_write_b64 v101, v[86:87]
K2_G67:
    s_mov_b64 exec, s[76:77]
    s_cbranch_execz K2_G68
    v_lshl_add_u32 v102, v194, 3, v102
    ds_write_b64 v102, v[88:89]
K2_G68:
    s_mov_b64 exec, s[78:79]
    s_cbranch_execz K2_G69
    v_lshl_add_u32 v103, v195, 3, v103
    ds_write_b64 v103, v[90:91]
K2_G69:
    s_mov_b64 exec, s[80:81]
    s_cbranch_execz K2_G70
    v_lshl_add_u32 v104, v196, 3, v104
    ds_write_b64 v104, v[92:93]
K2_G70:
    s_mov_b64 exec, s[82:83]
    s_cbranch_execz K2_G71
    v_lshl_add_u32 v105, v197, 3, v105
    ds_write_b64 v105, v[94:95]
K2_G71:
    s_mov_b64 exec, s[84:85]
    s_cbranch_execz K2_G72
    v_lshl_add_u32 v106, v198, 3, v106
    ds_write_b64 v106, v[96:97]
K2_G72:
    s_branch K2_B3
K2_PLAN:
    s_mul_i32 s99, s98, 3
    s_lshr_b32 s99, s99, 9
    s_max_u32 s99, s99, 1
    v_cvt_f32_u32 v84, v76
    v_add_f32 v84, -0.5, v84
    v_max_f32 v104, v104, v84
    v_cvt_f32_u32 v85, v77
    v_add_f32 v85, -0.5, v85
    v_max_f32 v105, v105, v85
    v_cvt_f32_u32 v86, v78
    v_add_f32 v86, -0.5, v86
    v_max_f32 v106, v106, v86
    v_cvt_f32_u32 v87, v79
    v_add_f32 v87, -0.5, v87
    v_max_f32 v107, v107, v87
K2_DLOOP:
    v_cvt_f32_u32 v220, s99
    v_rcp_f32 v221, v220
    v_add_f32 v88, v104, v220
    v_add_f32 v89, v105, v220
    v_add_f32 v90, v106, v220
    v_add_f32 v91, v107, v220
    v_mul_f32 v88, v88, v221
    v_cvt_u32_f32 v88, v88
    v_mul_f32 v89, v89, v221
    v_cvt_u32_f32 v89, v89
    v_mul_f32 v90, v90, v221
    v_cvt_u32_f32 v90, v90
    v_mul_f32 v91, v91, v221
    v_cvt_u32_f32 v91, v91
    v_add_u32 v222, v88, v89
    v_add3_u32 v222, v222, v90, v91
    s_nop 1
    v_add_u32_dpp v222, v222, v222 row_shr:1 row_mask:0xf bank_mask:0xf
    s_nop 1
    v_add_u32_dpp v222, v222, v222 row_shr:2 row_mask:0xf bank_mask:0xf
    s_nop 1
    v_add_u32_dpp v222, v222, v222 row_shr:4 row_mask:0xf bank_mask:0xf
    s_nop 1
    v_add_u32_dpp v222, v222, v222 row_shr:8 row_mask:0xf bank_mask:0xf
    s_nop 1
    v_add_u32_dpp v222, v222, v222 row_bcast:15 row_mask:0xa bank_mask:0xf
    s_nop 1
    v_add_u32_dpp v222, v222, v222 row_bcast:31 row_mask:0xc bank_mask:0xf
    s_nop 0
    v_readlane_b32 s95, v222, 63
    s_add_u32 s99, s99, 1
    s_cmp_gt_u32 s95, 255
    s_cbranch_scc1 K2_DLOOP
    v_cvt_f32_u32 v92, v88
    v_rcp_f32 v96, v92
    v_add_f32 v92, v92, v84
    v_cmp_eq_u32_e64 s[48:49], 1, v88
    v_lshlrev_b32 v44, 16, v88
    v_cvt_f32_u32 v93, v89
    v_rcp_f32 v97, v93
    v_add_f32 v93, v93, v85
    v_cmp_eq_u32_e64 s[50:51], 1, v89
    v_lshlrev_b32 v45, 16, v89
    v_cvt_f32_u32 v94, v90
    v_rcp_f32 v98, v94
    v_add_f32 v94, v94, v86
    v_cmp_eq_u32_e64 s[52:53], 1, v90
    v_lshlrev_b32 v46, 16, v90
    v_cvt_f32_u32 v95, v91
    v_rcp_f32 v99, v95
    v_add_f32 v95, v95, v87
    v_cmp_eq_u32_e64 s[54:55], 1, v91
    v_lshlrev_b32 v47, 16, v91
    v_cndmask_b32_e64 v44, v44, 1, s[48:49]
    v_cndmask_b32_e64 v45, v45, 1, s[50:51]
    v_cndmask_b32_e64 v46, v46, 1, s[52:53]
    v_cndmask_b32_e64 v47, v47, 1, s[54:55]
    v_mul_f32 v92, v92, v96
    v_cvt_u32_f32 v92, v92
    v_sub_u32 v96, 63, v92
    v_lshlrev_b32 v96, 2, v96
    ds_add_rtn_u32 v100, v96, v44 offset:128
    v_mul_f32 v93, v93, v97
    v_cvt_u32_f32 v93, v93
    v_sub_u32 v97, 63, v93
    v_lshlrev_b32 v97, 2, v97
    ds_add_rtn_u32 v101, v97, v45 offset:128
    v_mul_f32 v94, v94, v98
    v_cvt_u32_f32 v94, v94
    v_sub_u32 v98, 63, v94
    v_lshlrev_b32 v98, 2, v98
    ds_add_rtn_u32 v102, v98, v46 offset:128
    v_mul_f32 v95, v95, v99
    v_cvt_u32_f32 v95, v95
    v_sub_u32 v99, 63, v95
    v_lshlrev_b32 v99, 2, v99
    ds_add_rtn_u32 v103, v99, v47 offset:128
    v_lshrrev_b32 v220, 2, v203
    ds_read_b32 v221, v220 offset:128
    v_add_u32 v222, 0, v250
    v_lshl_or_b32 v172, v222, 24, v140
    v_lshl_or_b32 v172, v92, 18, v172
    v_lshlrev_b32 v173, 3, v88
    v_sub_u32 v222, 1, v92
    v_mad_i32_i24 v76, v222, v88, v76
    v_add_u32 v222, 64, v250
    v_lshl_or_b32 v174, v222, 24, v148
    v_lshl_or_b32 v174, v93, 18, v174
    v_lshlrev_b32 v175, 3, v89
    v_sub_u32 v222, 1, v93
    v_mad_i32_i24 v77, v222, v89, v77
    v_add_u32 v222, 128, v250
    v_lshl_or_b32 v176, v222, 24, v156
    v_lshl_or_b32 v176, v94, 18, v176
    v_lshlrev_b32 v177, 3, v90
    v_sub_u32 v222, 1, v94
    v_mad_i32_i24 v78, v222, v90, v78
    v_add_u32 v222, 192, v250
    v_lshl_or_b32 v178, v222, 24, v164
    v_lshl_or_b32 v178, v95, 18, v178
    v_lshlrev_b32 v179, 3, v91
    v_sub_u32 v222, 1, v95
    v_mad_i32_i24 v79, v222, v91, v79
    v_max3_u32 v224, v88, v89, v90
    v_max_u32 v224, v224, v91
    v_mov_b32 v225, -262136
    s_mov_b32 s99, 0
    s_waitcnt lgkmcnt(0)
    v_mov_b32 v222, v221
    v_and_b32 v57, 0xffff, v221
    v_cmp_ne_u32 vcc, 0, v57
    v_and_b32 v52, 0xffff, v100
    v_lshrrev_b32 v100, 16, v100
    v_add_u32_dpp v222, v222, v222 row_shr:1 row_mask:0xf bank_mask:0xf
    v_min_u32 v48, 1, v52
    v_cndmask_b32_e64 v100, v100, v52, s[48:49]
    v_add_u32_dpp v222, v222, v222 row_shr:2 row_mask:0xf bank_mask:0xf
    v_mad_i32_i24 v48, v48, -10, 20
    v_cndmask_b32_e64 v48, 0, v48, s[48:49]
    v_add_u32_dpp v222, v222, v222 row_shr:4 row_mask:0xf bank_mask:0xf
    v_and_b32 v53, 0xffff, v101
    v_lshrrev_b32 v101, 16, v101
    v_add_u32_dpp v222, v222, v222 row_shr:8 row_mask:0xf bank_mask:0xf
    v_min_u32 v49, 1, v53
    v_cndmask_b32_e64 v101, v101, v53, s[50:51]
    v_add_u32_dpp v222, v222, v222 row_bcast:15 row_mask:0xa bank_mask:0xf
    v_mad_i32_i24 v49, v49, -10, 20
    v_cndmask_b32_e64 v49, 0, v49, s[50:51]
    v_add_u32_dpp v222, v222, v222 row_bcast:31 row_mask:0xc bank_mask:0xf
    v_lshrrev_b32 v58, 16, v222
    v_cndmask_b32 v56, 0, v58, vcc
    v_sub_u32 v222, v222, v221
    v_and_b32 v54, 0xffff, v102
    v_lshrrev_b32 v102, 16, v102
    v_max_u32_dpp v56, v56, v56 row_shr:1 row_mask:0xf bank_mask:0xf
    v_min_u32 v50, 1, v54
    v_cndmask_b32_e64 v102, v102, v54, s[52:53]
    v_max_u32_dpp v56, v56, v56 row_shr:2 row_mask:0xf bank_mask:0xf
    v_mad_i32_i24 v50, v50, -10, 20
    v_cndmask_b32_e64 v50, 0, v50, s[52:53]
    v_max_u32_dpp v56, v56, v56 row_shr:4 row_mask:0xf bank_mask:0xf
    v_and_b32 v55, 0xffff, v103
    v_lshrrev_b32 v103, 16, v103
    v_max_u32_dpp v56, v56, v56 row_shr:8 row_mask:0xf bank_mask:0xf
    v_min_u32 v51, 1, v55
    v_cndmask_b32_e64 v103, v103, v55, s[54:55]
    v_max_u32_dpp v56, v56, v56 row_bcast:15 row_mask:0xa bank_mask:0xf
    v_mad_i32_i24 v51, v51, -10, 20
    v_cndmask_b32_e64 v51, 0, v51, s[54:55]
    v_max_u32_dpp v56, v56, v56 row_bcast:31 row_mask:0xc bank_mask:0xf
    v_and_b32 v57, 0xffff, v222
    v_and_b32 v221, 1, v222
    v_mov_b32_dpp v56, v56 wave_shr:1 row_mask:0xf bank_mask:0xf
    v_cmp_eq_u32 vcc, 1, v221
    v_lshrrev_b32 v222, 16, v222
    v_add3_u32 v222, v222, v57, v221
    v_cndmask_b32 v56, v58, v56, vcc
    v_add_u32 v58, v58, v57
    v_add_u32 v56, v56, v57
    v_lshl_or_b32 v222, v58, 10, v222
    v_lshl_or_b32 v222, v56, 20, v222
    ds_bpermute_b32 v96, v96, v222
    ds_bpermute_b32 v97, v97, v222
    ds_bpermute_b32 v98, v98, v222
    ds_bpermute_b32 v99, v99, v222
    s_waitcnt lgkmcnt(3)
    v_bfe_u32 v96, v96, v48, 10
    v_add_lshl_u32 v96, v96, v100, 2
    v_lshl_or_b32 v222, v88, 16, v96
    v_lshlrev_b32 v96, 1, v96
    ds_write_b32 v220, v222 offset:32768
    s_waitcnt lgkmcnt(3)
    v_bfe_u32 v97, v97, v49, 10
    v_add_lshl_u32 v97, v97, v101, 2
    v_lshl_or_b32 v222, v89, 16, v97
    v_lshlrev_b32 v97, 1, v97
    ds_write_b32 v220, v222 offset:33024
    s_waitcnt lgkmcnt(3)
    v_bfe_u32 v98, v98, v50, 10
    v_add_lshl_u32 v98, v98, v102, 2
    v_lshl_or_b32 v222, v90, 16, v98
    v_lshlrev_b32 v98, 1, v98
    ds_write_b32 v220, v222 offset:33280
    s_waitcnt lgkmcnt(3)
    v_bfe_u32 v99, v99, v51, 10
    v_add_lshl_u32 v99, v99, v103, 2
    v_lshl_or_b32 v222, v91, 16, v99
    v_lshlrev_b32 v99, 1, v99
    ds_write_b32 v220, v222 offset:33536
K2_PLOOP:
    v_cmp_lt_u32_e64 s[32:33], s99, v88
    v_cmp_lt_u32_e64 s[34:35], s99, v89
    v_cmp_lt_u32_e64 s[36:37], s99, v90
    v_cmp_lt_u32_e64 s[38:39], s99, v91
    s_add_u32 s99, s99, 1
    v_cmp_eq_u32_e64 s[40:41], s99, v76
    v_cmp_eq_u32_e64 s[42:43], s99, v77
    v_cmp_eq_u32_e64 s[44:45], s99, v78
    v_cmp_eq_u32_e64 s[46:47], s99, v79
    s_mov_b64 exec, s[32:33]
    ds_write_b64 v96, v[172:173] offset:512
    s_mov_b64 exec, s[34:35]
    ds_write_b64 v97, v[174:175] offset:512
    s_mov_b64 exec, s[36:37]
    ds_write_b64 v98, v[176:177] offset:512
    s_mov_b64 exec, s[38:39]
    ds_write_b64 v99, v[178:179] offset:512
    s_mov_b64 exec, -1
    v_cmp_lt_u32 vcc, s99, v224
    v_cndmask_b32_e64 v222, 8, v225, s[40:41]
    v_add_u32 v172, v172, v222
    v_add_u32 v96, 8, v96
    v_cndmask_b32_e64 v222, 8, v225, s[42:43]
    v_add_u32 v174, v174, v222
    v_add_u32 v97, 8, v97
    v_cndmask_b32_e64 v222, 8, v225, s[44:45]
    v_add_u32 v176, v176, v222
    v_add_u32 v98, 8, v98
    v_cndmask_b32_e64 v222, 8, v225, s[46:47]
    v_add_u32 v178, v178, v222
    v_add_u32 v99, 8, v99
    s_cbranch_vccnz K2_PLOOP
    v_mov_b32 v222, s99
    ds_write_b32 v228, v222 offset:104
    s_waitcnt vmcnt(0)
K2_B3:
    s_mov_b64 exec, -1
    s_lshl_b32 s95, s100, 8
    v_and_b32 v220, 31, v250
    v_lshl_add_u32 v220, v220, 3, s95
    s_mov_b32 s6, 0
    s_waitcnt vmcnt(3) lgkmcnt(0)
    s_barrier
    ds_read_b64 v[220:221], v220 offset:512
    ds_read_b32 v222, v229 offset:104
    s_waitcnt lgkmcnt(0)
    v_bfe_u32 v235, v220, 18, 6
    v_and_b32 v207, 0x3ffff, v220
    v_lshrrev_b32 v249, 24, v220
    v_mov_b32 v206, v221
    v_readfirstlane_b32 s97, v222
    v_cmp_lt_u32_e64 s[28:29], s6, v235
    s_add_u32 s6, s6, 1
    v_add_u32 v221, s4, v249
    buffer_load_dwordx2 v[240:241], v221, s[16:19], 0 idxen
    v_cndmask_b32_e64 v203, 0, v207, s[28:29]
    v_add_u32 v207, v207, v206
    ds_read_b32 v218, v203
    ds_read_u16 v203, v203 offset:4
    v_bfe_u32 v220, v249, 1, 3
    v_lshlrev_b32 v220, 4, v220
    v_lshlrev_b32 v221, 2, v219
    v_xor_b32 v220, v220, v221
    v_lshl_add_u32 v220, v249, 7, v220
    v_add_u32 v220, 100352, v220
    v_xor_b32 v221, 16, v220
    v_xor_b32 v222, 32, v220
    v_xor_b32 v223, 48, v220
    s_waitcnt lgkmcnt(0)
    ds_bpermute_b32 v210, v239, v203 offset:0
    ds_bpermute_b32 v212, v239, v203 offset:32
    ds_bpermute_b32 v214, v239, v203 offset:64
    ds_bpermute_b32 v216, v239, v203 offset:96
    ds_read_b128 v[172:175], v220
    ds_read_b128 v[176:179], v221
    ds_read_b128 v[180:183], v222
    ds_read_b128 v[184:187], v223
    buffer_load_dwordx4 v[188:191], v[218:219], s[12:15], 0 idxen offen
    buffer_load_dwordx2 v[200:201], v203, s[16:19], 0 idxen
    v_cmp_lt_u32_e64 s[30:31], s6, v235
    s_add_u32 s6, s6, 1
    s_cmp_eq_u64 s[28:29], 0
    s_cbranch_scc1 K2_EMPTY
    s_waitcnt lgkmcnt(4)
    s_add_u32 m0, s94, 0
    s_nop 0
    buffer_load_dwordx4 v[210:211], s[8:11], 0 idxen offen lds
    s_add_u32 m0, s94, 1024
    s_nop 0
    buffer_load_dwordx4 v[212:213], s[8:11], 0 idxen offen lds
    s_add_u32 m0, s94, 2048
    s_nop 0
    buffer_load_dwordx4 v[214:215], s[8:11], 0 idxen offen lds
    s_add_u32 m0, s94, 3072
    s_nop 0
    buffer_load_dwordx4 v[216:217], s[8:11], 0 idxen offen lds
    v_cndmask_b32_e64 v203, 0, v207, s[30:31]
    v_add_u32 v207, v207, v206
    ds_read_b32 v218, v203
    ds_read_u16 v203, v203 offset:4
    s_waitcnt lgkmcnt(0)
    ds_bpermute_b32 v210, v239, v203 offset:0
    ds_bpermute_b32 v212, v239, v203 offset:32
    ds_bpermute_b32 v214, v239, v203 offset:64
    ds_bpermute_b32 v216, v239, v203 offset:96
    buffer_load_dwordx4 v[192:195], v[218:219], s[12:15], 0 idxen offen
    buffer_load_dwordx2 v[204:205], v203, s[16:19], 0 idxen
    v_cmp_lt_u32_e64 s[32:33], s6, v235
    s_add_u32 s6, s6, 1
    s_waitcnt lgkmcnt(0)
    s_add_u32 m0, s94, 32768
    s_nop 0
    buffer_load_dwordx4 v[210:211], s[8:11], 0 idxen offen lds
    s_add_u32 m0, s94, 33792
    s_nop 0
    buffer_load_dwordx4 v[212:213], s[8:11], 0 idxen offen lds
    s_add_u32 m0, s94, 34816
    s_nop 0
    buffer_load_dwordx4 v[214:215], s[8:11], 0 idxen offen lds
    s_add_u32 m0, s94, 35840
    s_nop 0
    buffer_load_dwordx4 v[216:217], s[8:11], 0 idxen offen lds
    v_cndmask_b32_e64 v203, 0, v207, s[32:33]
    v_add_u32 v207, v207, v206
    ds_read_b32 v218, v203
    ds_read_u16 v203, v203 offset:4
    s_waitcnt lgkmcnt(0)
    ds_bpermute_b32 v210, v239, v203 offset:0
    ds_bpermute_b32 v212, v239, v203 offset:32
    ds_bpermute_b32 v214, v239, v203 offset:64
    ds_bpermute_b32 v216, v239, v203 offset:96
    v_and_b32 v221, 63, v250
    v_lshlrev_b32 v220, 4, v221
    v_lshlrev_b32 v221, 2, v221
    v_add_u32 v220, 138240, v220
    v_lshlrev_b32 v222, 3, v219
    v_add_u32 v221, 156672, v221
    v_add_u32 v222, 157696, v222
    ds_read_b128 v[140:143], v220 offset:0
    ds_read_b128 v[144:147], v220 offset:1024
    ds_read_b128 v[148:151], v220 offset:2048
    ds_read_b128 v[152:155], v220 offset:3072
    ds_read_b128 v[156:159], v220 offset:4096
    ds_read_b128 v[160:163], v220 offset:5120
    ds_read_b128 v[164:167], v220 offset:6144
    ds_read_b128 v[168:171], v220 offset:7168
    ds_read_b128 v[0:3], v220 offset:8192
    ds_read_b128 v[4:7], v220 offset:9216
    ds_read_b128 v[8:11], v220 offset:10240
    ds_read_b128 v[12:15], v220 offset:11264
    ds_read_b128 v[16:19], v220 offset:12288
    ds_read_b128 v[20:23], v220 offset:13312
    ds_read_b128 v[24:27], v220 offset:14336
    ds_read_b128 v[28:31], v220 offset:15360
    ds_read_b128 v[32:35], v220 offset:16384
    ds_read_b128 v[36:39], v220 offset:17408
    ds_read_b32 v40, v221
    ds_read_b32 v42, v221 offset:256
    ds_read_b128 v[108:111], v222 offset:0
    ds_read_b128 v[112:115], v222 offset:16
    ds_read_b128 v[116:119], v222 offset:32
    ds_read_b128 v[120:123], v222 offset:48
    ds_read_b128 v[124:127], v222 offset:64
    ds_read_b128 v[128:131], v222 offset:80
    ds_read_b128 v[132:135], v222 offset:96
    ds_read_b128 v[136:139], v222 offset:112
    v_mov_b32 v76, 0
    v_mov_b32 v77, 0
    v_mov_b32 v78, 0
    v_mov_b32 v79, 0
    v_mov_b32 v80, 0
    v_mov_b32 v81, 0
    v_mov_b32 v82, 0
    v_mov_b32 v83, 0
    v_mov_b32 v84, 0
    v_mov_b32 v85, 0
    v_mov_b32 v86, 0
    v_mov_b32 v87, 0
    v_mov_b32 v88, 0
    v_mov_b32 v89, 0
    v_mov_b32 v90, 0
    v_mov_b32 v91, 0
    v_mov_b32 v92, 0
    v_mov_b32 v93, 0
    v_mov_b32 v94, 0
    v_mov_b32 v95, 0
    v_mov_b32 v96, 0
    v_mov_b32 v97, 0
    v_mov_b32 v98, 0
    v_mov_b32 v99, 0
    v_mov_b32 v100, 0
    v_mov_b32 v101, 0
    v_mov_b32 v102, 0
    v_mov_b32 v103, 0
    v_mov_b32 v104, 0
    v_mov_b32 v105, 0
    v_mov_b32 v106, 0
    v_mov_b32 v107, 0
    v_mov_b32 v244, 0
    v_mov_b32 v245, 0
    v_mov_b32 v246, 0
    v_mov_b32 v247, 0
    s_waitcnt lgkmcnt(0)
    v_mfma_f32_32x32x16_bf16 v[44:59], v[140:143], v[172:175], 0
    v_mfma_f32_32x32x16_bf16 v[60:75], v[156:159], v[172:175], 0
    v_mfma_f32_32x32x16_bf16 v[44:59], v[144:147], v[176:179], v[44:59]
    v_mfma_f32_32x32x16_bf16 v[60:75], v[160:163], v[176:179], v[60:75]
    v_mfma_f32_32x32x16_bf16 v[44:59], v[148:151], v[180:183], v[44:59]
    v_mfma_f32_32x32x16_bf16 v[60:75], v[164:167], v[180:183], v[60:75]
    v_mfma_f32_32x32x16_bf16 v[44:59], v[152:155], v[184:187], v[44:59]
    v_mfma_f32_32x32x16_bf16 v[60:75], v[168:171], v[184:187], v[60:75]
    s_waitcnt vmcnt(6)
    ds_read_b128 v[172:175], v251 offset:0
    ds_read_b128 v[176:179], v252 offset:0
    ds_read_b128 v[180:183], v253 offset:0
    ds_read_b128 v[184:187], v254 offset:0
    v_mov_b32 v242, v241
    v_and_b32 v241, 0xffff0000, v240
    v_lshlrev_b32 v240, 16, v240
    v_lshlrev_b32 v232, 16, v200
    v_and_b32 v233, 0xffff0000, v200
    v_sub_f32 v234, v242, v201
    v_pk_add_f32 v[232:233], v[240:241], v[232:233] neg_lo:[0,1] neg_hi:[0,1]
    v_mul_f32 v208, v232, v232
    v_fmac_f32 v208, v233, v233
    v_fmac_f32 v208, v234, v234
    v_cvt_pk_bf16_f32 v208, v208, v208
    s_waitcnt lgkmcnt(0)
    s_nop 0
    v_mfma_f32_32x32x8_bf16 v[140:155], v[40:41], v[208:209], v[44:59]
    v_mfma_f32_32x32x16_bf16 v[140:155], v[32:35], v[188:191], v[140:155]
    v_mfma_f32_32x32x16_bf16 v[140:155], v[0:3], v[172:175], v[140:155]
    v_mfma_f32_32x32x16_bf16 v[140:155], v[4:7], v[176:179], v[140:155]
    v_mfma_f32_32x32x16_bf16 v[140:155], v[8:11], v[180:183], v[140:155]
    v_mfma_f32_32x32x16_bf16 v[140:155], v[12:15], v[184:187], v[140:155]
    s_nop 7
K2_LOOP:
    v_mfma_f32_32x32x8_bf16 v[156:171], v[42:43], v[208:209], v[60:75]
    s_mov_b64 exec, s[28:29]
    s_nop 1
    v_exp_f32 v220, v140
    v_exp_f32 v221, v141
    v_exp_f32 v222, v142
    v_exp_f32 v223, v143
    v_mfma_f32_32x32x16_bf16 v[156:171], v[36:39], v[188:191], v[156:171]
    v_exp_f32 v224, v144
    v_exp_f32 v225, v145
    s_bitcmp1_b32 s5, 2
    s_cbranch_scc0 K2_VP1
    s_setprio 1
K2_VP1:
    s_waitcnt lgkmcnt(0)
    s_mov_b64 exec, -1
    s_add_u32 m0, s94, 0
    s_nop 0
    buffer_load_dwordx4 v[210:211], s[8:11], 0 idxen offen lds
    s_add_u32 m0, s94, 1024
    s_nop 0
    buffer_load_dwordx4 v[212:213], s[8:11], 0 idxen offen lds
    s_add_u32 m0, s94, 2048
    s_nop 0
    buffer_load_dwordx4 v[214:215], s[8:11], 0 idxen offen lds
    s_add_u32 m0, s94, 3072
    s_nop 0
    buffer_load_dwordx4 v[216:217], s[8:11], 0 idxen offen lds
    s_mov_b64 exec, s[28:29]
    s_setprio 0
    v_exp_f32 v226, v146
    v_exp_f32 v227, v147
    v_pk_add_f32 v[220:221], v[220:221], 1.0 op_sel_hi:[1,0]
    v_pk_add_f32 v[222:223], v[222:223], 1.0 op_sel_hi:[1,0]
    v_pk_add_f32 v[224:225], v[224:225], 1.0 op_sel_hi:[1,0]
    v_pk_add_f32 v[226:227], v[226:227], 1.0 op_sel_hi:[1,0]
    v_mfma_f32_32x32x16_bf16 v[156:171], v[16:19], v[172:175], v[156:171]
    v_rcp_f32 v220, v220
    v_rcp_f32 v221, v221
    v_rcp_f32 v222, v222
    v_rcp_f32 v223, v223
    v_mfma_f32_32x32x16_bf16 v[156:171], v[20:23], v[176:179], v[156:171]
    v_rcp_f32 v224, v224
    v_rcp_f32 v225, v225
    v_rcp_f32 v226, v226
    v_rcp_f32 v227, v227
    v_pk_fma_f32 v[76:77], v[140:141], v[220:221], v[76:77]
    v_pk_fma_f32 v[78:79], v[142:143], v[222:223], v[78:79]
    v_pk_fma_f32 v[80:81], v[144:145], v[224:225], v[80:81]
    v_pk_fma_f32 v[82:83], v[146:147], v[226:227], v[82:83]
    v_pk_mul_f32 v[228:229], v[76:77], v[108:109]
    v_pk_mul_f32 v[230:231], v[78:79], v[110:111]
    v_pk_fma_f32 v[228:229], v[80:81], v[112:113], v[228:229]
    v_pk_fma_f32 v[230:231], v[82:83], v[114:115], v[230:231]
    v_mfma_f32_32x32x16_bf16 v[156:171], v[24:27], v[180:183], v[156:171]
    v_exp_f32 v220, v148
    v_exp_f32 v221, v149
    v_exp_f32 v222, v150
    v_exp_f32 v223, v151
    v_mfma_f32_32x32x16_bf16 v[156:171], v[28:31], v[184:187], v[156:171]
    v_exp_f32 v224, v152
    v_exp_f32 v225, v153
    v_exp_f32 v226, v154
    buffer_load_dwordx4 v[196:199], v[218:219], s[12:15], 0 idxen offen
    buffer_load_dwordx2 v[200:201], v203, s[16:19], 0 idxen
    v_exp_f32 v227, v155
    s_waitcnt vmcnt(6)
    ds_read_b128 v[172:175], v251 offset:32768
    ds_read_b128 v[176:179], v252 offset:32768
    ds_read_b128 v[180:183], v253 offset:32768
    ds_read_b128 v[184:187], v254 offset:32768
    v_cmp_lt_u32_e64 s[34:35], s6, v235
    s_add_u32 s6, s6, 1
    v_lshlrev_b32 v236, 16, v204
    v_and_b32 v237, 0xffff0000, v204
    v_sub_f32 v238, v242, v205
    v_pk_add_f32 v[236:237], v[240:241], v[236:237] neg_lo:[0,1] neg_hi:[0,1]
    v_mul_f32 v208, v236, v236
    v_fmac_f32 v208, v237, v237
    v_fmac_f32 v208, v238, v238
    v_cvt_pk_bf16_f32 v208, v208, v208
    v_cndmask_b32_e64 v203, 0, v207, s[34:35]
    v_add_u32 v207, v207, v206
    ds_read_b32 v218, v203
    ds_read_u16 v203, v203 offset:4
    v_pk_add_f32 v[220:221], v[220:221], 1.0 op_sel_hi:[1,0]
    v_pk_add_f32 v[222:223], v[222:223], 1.0 op_sel_hi:[1,0]
    v_pk_add_f32 v[224:225], v[224:225], 1.0 op_sel_hi:[1,0]
    v_pk_add_f32 v[226:227], v[226:227], 1.0 op_sel_hi:[1,0]
    v_rcp_f32 v220, v220
    v_rcp_f32 v221, v221
    v_rcp_f32 v222, v222
    v_rcp_f32 v223, v223
    v_rcp_f32 v224, v224
    v_rcp_f32 v225, v225
    v_rcp_f32 v226, v226
    v_rcp_f32 v227, v227
    s_waitcnt lgkmcnt(0)
    s_mov_b64 exec, -1
    ds_bpermute_b32 v210, v239, v203 offset:0
    ds_bpermute_b32 v212, v239, v203 offset:32
    ds_bpermute_b32 v214, v239, v203 offset:64
    ds_bpermute_b32 v216, v239, v203 offset:96
    s_mov_b64 exec, s[28:29]
    v_pk_fma_f32 v[84:85], v[148:149], v[220:221], v[84:85]
    v_pk_fma_f32 v[86:87], v[150:151], v[222:223], v[86:87]
    v_pk_fma_f32 v[88:89], v[152:153], v[224:225], v[88:89]
    v_pk_fma_f32 v[90:91], v[154:155], v[226:227], v[90:91]
    v_pk_fma_f32 v[228:229], v[84:85], v[116:117], v[228:229]
    v_pk_fma_f32 v[230:231], v[86:87], v[118:119], v[230:231]
    v_pk_fma_f32 v[228:229], v[88:89], v[120:121], v[228:229]
    v_pk_fma_f32 v[230:231], v[90:91], v[122:123], v[230:231]
    v_mfma_f32_32x32x8_bf16 v[140:155], v[40:41], v[208:209], v[44:59]
    v_exp_f32 v220, v156
    v_exp_f32 v221, v157
    v_exp_f32 v222, v158
    v_exp_f32 v223, v159
    v_mfma_f32_32x32x16_bf16 v[140:155], v[32:35], v[192:195], v[140:155]
    v_exp_f32 v224, v160
    v_exp_f32 v225, v161
    v_exp_f32 v226, v162
    v_exp_f32 v227, v163
    v_pk_add_f32 v[220:221], v[220:221], 1.0 op_sel_hi:[1,0]
    v_pk_add_f32 v[222:223], v[222:223], 1.0 op_sel_hi:[1,0]
    v_pk_add_f32 v[224:225], v[224:225], 1.0 op_sel_hi:[1,0]
    v_pk_add_f32 v[226:227], v[226:227], 1.0 op_sel_hi:[1,0]
    v_mfma_f32_32x32x16_bf16 v[140:155], v[0:3], v[172:175], v[140:155]
    v_rcp_f32 v220, v220
    v_rcp_f32 v221, v221
    v_rcp_f32 v222, v222
    v_rcp_f32 v223, v223
    v_mfma_f32_32x32x16_bf16 v[140:155], v[4:7], v[176:179], v[140:155]
    v_rcp_f32 v224, v224
    v_rcp_f32 v225, v225
    v_rcp_f32 v226, v226
    v_rcp_f32 v227, v227
    v_pk_fma_f32 v[92:93], v[156:157], v[220:221], v[92:93]
    v_pk_fma_f32 v[94:95], v[158:159], v[222:223], v[94:95]
    v_pk_fma_f32 v[96:97], v[160:161], v[224:225], v[96:97]
    v_pk_fma_f32 v[98:99], v[162:163], v[226:227], v[98:99]
    v_pk_fma_f32 v[228:229], v[92:93], v[124:125], v[228:229]
    v_pk_fma_f32 v[230:231], v[94:95], v[126:127], v[230:231]
    v_pk_fma_f32 v[228:229], v[96:97], v[128:129], v[228:229]
    v_pk_fma_f32 v[230:231], v[98:99], v[130:131], v[230:231]
    v_mfma_f32_32x32x16_bf16 v[140:155], v[8:11], v[180:183], v[140:155]
    v_exp_f32 v220, v164
    v_exp_f32 v221, v165
    v_exp_f32 v222, v166
    v_exp_f32 v223, v167
    v_mfma_f32_32x32x16_bf16 v[140:155], v[12:15], v[184:187], v[140:155]
    v_exp_f32 v224, v168
    v_exp_f32 v225, v169
    v_exp_f32 v226, v170
    v_exp_f32 v227, v171
    v_pk_add_f32 v[220:221], v[220:221], 1.0 op_sel_hi:[1,0]
    v_pk_add_f32 v[222:223], v[222:223], 1.0 op_sel_hi:[1,0]
    v_pk_add_f32 v[224:225], v[224:225], 1.0 op_sel_hi:[1,0]
    v_pk_add_f32 v[226:227], v[226:227], 1.0 op_sel_hi:[1,0]
    v_rcp_f32 v220, v220
    v_rcp_f32 v221, v221
    v_rcp_f32 v222, v222
    v_rcp_f32 v223, v223
    v_rcp_f32 v224, v224
    v_rcp_f32 v225, v225
    v_rcp_f32 v226, v226
    v_rcp_f32 v227, v227
    v_pk_fma_f32 v[100:101], v[164:165], v[220:221], v[100:101]
    v_pk_fma_f32 v[102:103], v[166:167], v[222:223], v[102:103]
    v_pk_fma_f32 v[104:105], v[168:169], v[224:225], v[104:105]
    v_pk_fma_f32 v[106:107], v[170:171], v[226:227], v[106:107]
    v_pk_fma_f32 v[228:229], v[100:101], v[132:133], v[228:229]
    v_pk_fma_f32 v[230:231], v[102:103], v[134:135], v[230:231]
    v_pk_fma_f32 v[228:229], v[104:105], v[136:137], v[228:229]
    v_pk_fma_f32 v[230:231], v[106:107], v[138:139], v[230:231]
    v_pk_add_f32 v[228:229], v[228:229], v[230:231]
    s_cmp_eq_u64 s[30:31], 0
    v_add_f32 v243, v228, v229
    v_sub_f32 v248, v243, v247
    v_pk_fma_f32 v[244:245], v[232:233], v[248:249], v[244:245] op_sel_hi:[1,0,1]
    v_fmac_f32 v246, v234, v248
    s_mov_b64 exec, -1
    s_cbranch_scc1 K2_DONE
    v_mfma_f32_32x32x8_bf16 v[156:171], v[42:43], v[208:209], v[60:75]
    s_mov_b64 exec, s[30:31]
    v_exp_f32 v220, v140
    v_exp_f32 v221, v141
    v_exp_f32 v222, v142
    v_exp_f32 v223, v143
    v_mfma_f32_32x32x16_bf16 v[156:171], v[36:39], v[192:195], v[156:171]
    v_exp_f32 v224, v144
    v_exp_f32 v225, v145
    s_bitcmp1_b32 s5, 2
    s_cbranch_scc0 K2_VP3
    s_setprio 1
K2_VP3:
    s_waitcnt lgkmcnt(0)
    s_mov_b64 exec, -1
    s_add_u32 m0, s94, 32768
    s_nop 0
    buffer_load_dwordx4 v[210:211], s[8:11], 0 idxen offen lds
    s_add_u32 m0, s94, 33792
    s_nop 0
    buffer_load_dwordx4 v[212:213], s[8:11], 0 idxen offen lds
    s_add_u32 m0, s94, 34816
    s_nop 0
    buffer_load_dwordx4 v[214:215], s[8:11], 0 idxen offen lds
    s_add_u32 m0, s94, 35840
    s_nop 0
    buffer_load_dwordx4 v[216:217], s[8:11], 0 idxen offen lds
    s_mov_b64 exec, s[30:31]
    s_setprio 0
    v_exp_f32 v226, v146
    v_exp_f32 v227, v147
    v_pk_add_f32 v[220:221], v[220:221], 1.0 op_sel_hi:[1,0]
    v_pk_add_f32 v[222:223], v[222:223], 1.0 op_sel_hi:[1,0]
    v_pk_add_f32 v[224:225], v[224:225], 1.0 op_sel_hi:[1,0]
    v_pk_add_f32 v[226:227], v[226:227], 1.0 op_sel_hi:[1,0]
    v_mfma_f32_32x32x16_bf16 v[156:171], v[16:19], v[172:175], v[156:171]
    v_rcp_f32 v220, v220
    v_rcp_f32 v221, v221
    v_rcp_f32 v222, v222
    v_rcp_f32 v223, v223
    v_mfma_f32_32x32x16_bf16 v[156:171], v[20:23], v[176:179], v[156:171]
    v_rcp_f32 v224, v224
    v_rcp_f32 v225, v225
    v_rcp_f32 v226, v226
    v_rcp_f32 v227, v227
    v_pk_fma_f32 v[76:77], v[140:141], v[220:221], v[76:77]
    v_pk_fma_f32 v[78:79], v[142:143], v[222:223], v[78:79]
    v_pk_fma_f32 v[80:81], v[144:145], v[224:225], v[80:81]
    v_pk_fma_f32 v[82:83], v[146:147], v[226:227], v[82:83]
    v_pk_mul_f32 v[228:229], v[76:77], v[108:109]
    v_pk_mul_f32 v[230:231], v[78:79], v[110:111]
    v_pk_fma_f32 v[228:229], v[80:81], v[112:113], v[228:229]
    v_pk_fma_f32 v[230:231], v[82:83], v[114:115], v[230:231]
    v_mfma_f32_32x32x16_bf16 v[156:171], v[24:27], v[180:183], v[156:171]
    v_exp_f32 v220, v148
    v_exp_f32 v221, v149
    v_exp_f32 v222, v150
    v_exp_f32 v223, v151
    v_mfma_f32_32x32x16_bf16 v[156:171], v[28:31], v[184:187], v[156:171]
    v_exp_f32 v224, v152
    v_exp_f32 v225, v153
    v_exp_f32 v226, v154
    buffer_load_dwordx4 v[188:191], v[218:219], s[12:15], 0 idxen offen
    buffer_load_dwordx2 v[204:205], v203, s[16:19], 0 idxen
    v_exp_f32 v227, v155
    s_waitcnt vmcnt(6)
    ds_read_b128 v[172:175], v251 offset:0
    ds_read_b128 v[176:179], v252 offset:0
    ds_read_b128 v[180:183], v253 offset:0
    ds_read_b128 v[184:187], v254 offset:0
    v_cmp_lt_u32_e64 s[36:37], s6, v235
    s_add_u32 s6, s6, 1
    v_lshlrev_b32 v232, 16, v200
    v_and_b32 v233, 0xffff0000, v200
    v_sub_f32 v234, v242, v201
    v_pk_add_f32 v[232:233], v[240:241], v[232:233] neg_lo:[0,1] neg_hi:[0,1]
    v_mul_f32 v208, v232, v232
    v_fmac_f32 v208, v233, v233
    v_fmac_f32 v208, v234, v234
    v_cvt_pk_bf16_f32 v208, v208, v208
    v_cndmask_b32_e64 v203, 0, v207, s[36:37]
    v_add_u32 v207, v207, v206
    ds_read_b32 v218, v203
    ds_read_u16 v203, v203 offset:4
    v_pk_add_f32 v[220:221], v[220:221], 1.0 op_sel_hi:[1,0]
    v_pk_add_f32 v[222:223], v[222:223], 1.0 op_sel_hi:[1,0]
    v_pk_add_f32 v[224:225], v[224:225], 1.0 op_sel_hi:[1,0]
    v_pk_add_f32 v[226:227], v[226:227], 1.0 op_sel_hi:[1,0]
    v_rcp_f32 v220, v220
    v_rcp_f32 v221, v221
    v_rcp_f32 v222, v222
    v_rcp_f32 v223, v223
    v_rcp_f32 v224, v224
    v_rcp_f32 v225, v225
    v_rcp_f32 v226, v226
    v_rcp_f32 v227, v227
    s_waitcnt lgkmcnt(0)
    s_mov_b64 exec, -1
    ds_bpermute_b32 v210, v239, v203 offset:0
    ds_bpermute_b32 v212, v239, v203 offset:32
    ds_bpermute_b32 v214, v239, v203 offset:64
    ds_bpermute_b32 v216, v239, v203 offset:96
    s_mov_b64 exec, s[30:31]
    v_pk_fma_f32 v[84:85], v[148:149], v[220:221], v[84:85]
    v_pk_fma_f32 v[86:87], v[150:151], v[222:223], v[86:87]
    v_pk_fma_f32 v[88:89], v[152:153], v[224:225], v[88:89]
    v_pk_fma_f32 v[90:91], v[154:155], v[226:227], v[90:91]
    v_pk_fma_f32 v[228:229], v[84:85], v[116:117], v[228:229]
    v_pk_fma_f32 v[230:231], v[86:87], v[118:119], v[230:231]
    v_pk_fma_f32 v[228:229], v[88:89], v[120:121], v[228:229]
    v_pk_fma_f32 v[230:231], v[90:91], v[122:123], v[230:231]
    v_mfma_f32_32x32x8_bf16 v[140:155], v[40:41], v[208:209], v[44:59]
    v_exp_f32 v220, v156
    v_exp_f32 v221, v157
    v_exp_f32 v222, v158
    v_exp_f32 v223, v159
    v_mfma_f32_32x32x16_bf16 v[140:155], v[32:35], v[196:199], v[140:155]
    v_exp_f32 v224, v160
    v_exp_f32 v225, v161
    v_exp_f32 v226, v162
    v_exp_f32 v227, v163
    v_pk_add_f32 v[220:221], v[220:221], 1.0 op_sel_hi:[1,0]
    v_pk_add_f32 v[222:223], v[222:223], 1.0 op_sel_hi:[1,0]
    v_pk_add_f32 v[224:225], v[224:225], 1.0 op_sel_hi:[1,0]
    v_pk_add_f32 v[226:227], v[226:227], 1.0 op_sel_hi:[1,0]
    v_mfma_f32_32x32x16_bf16 v[140:155], v[0:3], v[172:175], v[140:155]
    v_rcp_f32 v220, v220
    v_rcp_f32 v221, v221
    v_rcp_f32 v222, v222
    v_rcp_f32 v223, v223
    v_mfma_f32_32x32x16_bf16 v[140:155], v[4:7], v[176:179], v[140:155]
    v_rcp_f32 v224, v224
    v_rcp_f32 v225, v225
    v_rcp_f32 v226, v226
    v_rcp_f32 v227, v227
    v_pk_fma_f32 v[92:93], v[156:157], v[220:221], v[92:93]
    v_pk_fma_f32 v[94:95], v[158:159], v[222:223], v[94:95]
    v_pk_fma_f32 v[96:97], v[160:161], v[224:225], v[96:97]
    v_pk_fma_f32 v[98:99], v[162:163], v[226:227], v[98:99]
    v_pk_fma_f32 v[228:229], v[92:93], v[124:125], v[228:229]
    v_pk_fma_f32 v[230:231], v[94:95], v[126:127], v[230:231]
    v_pk_fma_f32 v[228:229], v[96:97], v[128:129], v[228:229]
    v_pk_fma_f32 v[230:231], v[98:99], v[130:131], v[230:231]
    v_mfma_f32_32x32x16_bf16 v[140:155], v[8:11], v[180:183], v[140:155]
    v_exp_f32 v220, v164
    v_exp_f32 v221, v165
    v_exp_f32 v222, v166
    v_exp_f32 v223, v167
    v_mfma_f32_32x32x16_bf16 v[140:155], v[12:15], v[184:187], v[140:155]
    v_exp_f32 v224, v168
    v_exp_f32 v225, v169
    v_exp_f32 v226, v170
    v_exp_f32 v227, v171
    v_pk_add_f32 v[220:221], v[220:221], 1.0 op_sel_hi:[1,0]
    v_pk_add_f32 v[222:223], v[222:223], 1.0 op_sel_hi:[1,0]
    v_pk_add_f32 v[224:225], v[224:225], 1.0 op_sel_hi:[1,0]
    v_pk_add_f32 v[226:227], v[226:227], 1.0 op_sel_hi:[1,0]
    v_rcp_f32 v220, v220
    v_rcp_f32 v221, v221
    v_rcp_f32 v222, v222
    v_rcp_f32 v223, v223
    v_rcp_f32 v224, v224
    v_rcp_f32 v225, v225
    v_rcp_f32 v226, v226
    v_rcp_f32 v227, v227
    v_pk_fma_f32 v[100:101], v[164:165], v[220:221], v[100:101]
    v_pk_fma_f32 v[102:103], v[166:167], v[222:223], v[102:103]
    v_pk_fma_f32 v[104:105], v[168:169], v[224:225], v[104:105]
    v_pk_fma_f32 v[106:107], v[170:171], v[226:227], v[106:107]
    v_pk_fma_f32 v[228:229], v[100:101], v[132:133], v[228:229]
    v_pk_fma_f32 v[230:231], v[102:103], v[134:135], v[230:231]
    v_pk_fma_f32 v[228:229], v[104:105], v[136:137], v[228:229]
    v_pk_fma_f32 v[230:231], v[106:107], v[138:139], v[230:231]
    v_pk_add_f32 v[228:229], v[228:229], v[230:231]
    s_cmp_eq_u64 s[32:33], 0
    v_add_f32 v247, v228, v229
    v_sub_f32 v248, v247, v243
    v_pk_fma_f32 v[244:245], v[236:237], v[248:249], v[244:245] op_sel_hi:[1,0,1]
    v_fmac_f32 v246, v238, v248
    s_mov_b64 exec, -1
    s_cbranch_scc1 K2_DONE
    v_mfma_f32_32x32x8_bf16 v[156:171], v[42:43], v[208:209], v[60:75]
    s_mov_b64 exec, s[32:33]
    v_exp_f32 v220, v140
    v_exp_f32 v221, v141
    v_exp_f32 v222, v142
    v_exp_f32 v223, v143
    v_mfma_f32_32x32x16_bf16 v[156:171], v[36:39], v[196:199], v[156:171]
    v_exp_f32 v224, v144
    v_exp_f32 v225, v145
    s_bitcmp1_b32 s5, 2
    s_cbranch_scc0 K2_VP5
    s_setprio 1
K2_VP5:
    s_waitcnt lgkmcnt(0)
    s_mov_b64 exec, -1
    s_add_u32 m0, s94, 0
    s_nop 0
    buffer_load_dwordx4 v[210:211], s[8:11], 0 idxen offen lds
    s_add_u32 m0, s94, 1024
    s_nop 0
    buffer_load_dwordx4 v[212:213], s[8:11], 0 idxen offen lds
    s_add_u32 m0, s94, 2048
    s_nop 0
    buffer_load_dwordx4 v[214:215], s[8:11], 0 idxen offen lds
    s_add_u32 m0, s94, 3072
    s_nop 0
    buffer_load_dwordx4 v[216:217], s[8:11], 0 idxen offen lds
    s_mov_b64 exec, s[32:33]
    s_setprio 0
    v_exp_f32 v226, v146
    v_exp_f32 v227, v147
    v_pk_add_f32 v[220:221], v[220:221], 1.0 op_sel_hi:[1,0]
    v_pk_add_f32 v[222:223], v[222:223], 1.0 op_sel_hi:[1,0]
    v_pk_add_f32 v[224:225], v[224:225], 1.0 op_sel_hi:[1,0]
    v_pk_add_f32 v[226:227], v[226:227], 1.0 op_sel_hi:[1,0]
    v_mfma_f32_32x32x16_bf16 v[156:171], v[16:19], v[172:175], v[156:171]
    v_rcp_f32 v220, v220
    v_rcp_f32 v221, v221
    v_rcp_f32 v222, v222
    v_rcp_f32 v223, v223
    v_mfma_f32_32x32x16_bf16 v[156:171], v[20:23], v[176:179], v[156:171]
    v_rcp_f32 v224, v224
    v_rcp_f32 v225, v225
    v_rcp_f32 v226, v226
    v_rcp_f32 v227, v227
    v_pk_fma_f32 v[76:77], v[140:141], v[220:221], v[76:77]
    v_pk_fma_f32 v[78:79], v[142:143], v[222:223], v[78:79]
    v_pk_fma_f32 v[80:81], v[144:145], v[224:225], v[80:81]
    v_pk_fma_f32 v[82:83], v[146:147], v[226:227], v[82:83]
    v_pk_mul_f32 v[228:229], v[76:77], v[108:109]
    v_pk_mul_f32 v[230:231], v[78:79], v[110:111]
    v_pk_fma_f32 v[228:229], v[80:81], v[112:113], v[228:229]
    v_pk_fma_f32 v[230:231], v[82:83], v[114:115], v[230:231]
    v_mfma_f32_32x32x16_bf16 v[156:171], v[24:27], v[180:183], v[156:171]
    v_exp_f32 v220, v148
    v_exp_f32 v221, v149
    v_exp_f32 v222, v150
    v_exp_f32 v223, v151
    v_mfma_f32_32x32x16_bf16 v[156:171], v[28:31], v[184:187], v[156:171]
    v_exp_f32 v224, v152
    v_exp_f32 v225, v153
    v_exp_f32 v226, v154
    buffer_load_dwordx4 v[192:195], v[218:219], s[12:15], 0 idxen offen
    buffer_load_dwordx2 v[200:201], v203, s[16:19], 0 idxen
    v_exp_f32 v227, v155
    s_waitcnt vmcnt(6)
    ds_read_b128 v[172:175], v251 offset:32768
    ds_read_b128 v[176:179], v252 offset:32768
    ds_read_b128 v[180:183], v253 offset:32768
    ds_read_b128 v[184:187], v254 offset:32768
    v_cmp_lt_u32_e64 s[38:39], s6, v235
    s_add_u32 s6, s6, 1
    v_lshlrev_b32 v236, 16, v204
    v_and_b32 v237, 0xffff0000, v204
    v_sub_f32 v238, v242, v205
    v_pk_add_f32 v[236:237], v[240:241], v[236:237] neg_lo:[0,1] neg_hi:[0,1]
    v_mul_f32 v208, v236, v236
    v_fmac_f32 v208, v237, v237
    v_fmac_f32 v208, v238, v238
    v_cvt_pk_bf16_f32 v208, v208, v208
    v_cndmask_b32_e64 v203, 0, v207, s[38:39]
    v_add_u32 v207, v207, v206
    ds_read_b32 v218, v203
    ds_read_u16 v203, v203 offset:4
    v_pk_add_f32 v[220:221], v[220:221], 1.0 op_sel_hi:[1,0]
    v_pk_add_f32 v[222:223], v[222:223], 1.0 op_sel_hi:[1,0]
    v_pk_add_f32 v[224:225], v[224:225], 1.0 op_sel_hi:[1,0]
    v_pk_add_f32 v[226:227], v[226:227], 1.0 op_sel_hi:[1,0]
    v_rcp_f32 v220, v220
    v_rcp_f32 v221, v221
    v_rcp_f32 v222, v222
    v_rcp_f32 v223, v223
    v_rcp_f32 v224, v224
    v_rcp_f32 v225, v225
    v_rcp_f32 v226, v226
    v_rcp_f32 v227, v227
    s_waitcnt lgkmcnt(0)
    s_mov_b64 exec, -1
    ds_bpermute_b32 v210, v239, v203 offset:0
    ds_bpermute_b32 v212, v239, v203 offset:32
    ds_bpermute_b32 v214, v239, v203 offset:64
    ds_bpermute_b32 v216, v239, v203 offset:96
    s_mov_b64 exec, s[32:33]
    v_pk_fma_f32 v[84:85], v[148:149], v[220:221], v[84:85]
    v_pk_fma_f32 v[86:87], v[150:151], v[222:223], v[86:87]
    v_pk_fma_f32 v[88:89], v[152:153], v[224:225], v[88:89]
    v_pk_fma_f32 v[90:91], v[154:155], v[226:227], v[90:91]
    v_pk_fma_f32 v[228:229], v[84:85], v[116:117], v[228:229]
    v_pk_fma_f32 v[230:231], v[86:87], v[118:119], v[230:231]
    v_pk_fma_f32 v[228:229], v[88:89], v[120:121], v[228:229]
    v_pk_fma_f32 v[230:231], v[90:91], v[122:123], v[230:231]
    v_mfma_f32_32x32x8_bf16 v[140:155], v[40:41], v[208:209], v[44:59]
    v_exp_f32 v220, v156
    v_exp_f32 v221, v157
    v_exp_f32 v222, v158
    v_exp_f32 v223, v159
    v_mfma_f32_32x32x16_bf16 v[140:155], v[32:35], v[188:191], v[140:155]
    v_exp_f32 v224, v160
    v_exp_f32 v225, v161
    v_exp_f32 v226, v162
    v_exp_f32 v227, v163
    v_pk_add_f32 v[220:221], v[220:221], 1.0 op_sel_hi:[1,0]
    v_pk_add_f32 v[222:223], v[222:223], 1.0 op_sel_hi:[1,0]
    v_pk_add_f32 v[224:225], v[224:225], 1.0 op_sel_hi:[1,0]
    v_pk_add_f32 v[226:227], v[226:227], 1.0 op_sel_hi:[1,0]
    v_mfma_f32_32x32x16_bf16 v[140:155], v[0:3], v[172:175], v[140:155]
    v_rcp_f32 v220, v220
    v_rcp_f32 v221, v221
    v_rcp_f32 v222, v222
    v_rcp_f32 v223, v223
    v_mfma_f32_32x32x16_bf16 v[140:155], v[4:7], v[176:179], v[140:155]
    v_rcp_f32 v224, v224
    v_rcp_f32 v225, v225
    v_rcp_f32 v226, v226
    v_rcp_f32 v227, v227
    v_pk_fma_f32 v[92:93], v[156:157], v[220:221], v[92:93]
    v_pk_fma_f32 v[94:95], v[158:159], v[222:223], v[94:95]
    v_pk_fma_f32 v[96:97], v[160:161], v[224:225], v[96:97]
    v_pk_fma_f32 v[98:99], v[162:163], v[226:227], v[98:99]
    v_pk_fma_f32 v[228:229], v[92:93], v[124:125], v[228:229]
    v_pk_fma_f32 v[230:231], v[94:95], v[126:127], v[230:231]
    v_pk_fma_f32 v[228:229], v[96:97], v[128:129], v[228:229]
    v_pk_fma_f32 v[230:231], v[98:99], v[130:131], v[230:231]
    v_mfma_f32_32x32x16_bf16 v[140:155], v[8:11], v[180:183], v[140:155]
    v_exp_f32 v220, v164
    v_exp_f32 v221, v165
    v_exp_f32 v222, v166
    v_exp_f32 v223, v167
    v_mfma_f32_32x32x16_bf16 v[140:155], v[12:15], v[184:187], v[140:155]
    v_exp_f32 v224, v168
    v_exp_f32 v225, v169
    v_exp_f32 v226, v170
    v_exp_f32 v227, v171
    v_pk_add_f32 v[220:221], v[220:221], 1.0 op_sel_hi:[1,0]
    v_pk_add_f32 v[222:223], v[222:223], 1.0 op_sel_hi:[1,0]
    v_pk_add_f32 v[224:225], v[224:225], 1.0 op_sel_hi:[1,0]
    v_pk_add_f32 v[226:227], v[226:227], 1.0 op_sel_hi:[1,0]
    v_rcp_f32 v220, v220
    v_rcp_f32 v221, v221
    v_rcp_f32 v222, v222
    v_rcp_f32 v223, v223
    v_rcp_f32 v224, v224
    v_rcp_f32 v225, v225
    v_rcp_f32 v226, v226
    v_rcp_f32 v227, v227
    v_pk_fma_f32 v[100:101], v[164:165], v[220:221], v[100:101]
    v_pk_fma_f32 v[102:103], v[166:167], v[222:223], v[102:103]
    v_pk_fma_f32 v[104:105], v[168:169], v[224:225], v[104:105]
    v_pk_fma_f32 v[106:107], v[170:171], v[226:227], v[106:107]
    v_pk_fma_f32 v[228:229], v[100:101], v[132:133], v[228:229]
    v_pk_fma_f32 v[230:231], v[102:103], v[134:135], v[230:231]
    v_pk_fma_f32 v[228:229], v[104:105], v[136:137], v[228:229]
    v_pk_fma_f32 v[230:231], v[106:107], v[138:139], v[230:231]
    v_pk_add_f32 v[228:229], v[228:229], v[230:231]
    s_cmp_eq_u64 s[34:35], 0
    v_add_f32 v243, v228, v229
    v_sub_f32 v248, v243, v247
    v_pk_fma_f32 v[244:245], v[232:233], v[248:249], v[244:245] op_sel_hi:[1,0,1]
    v_fmac_f32 v246, v234, v248
    s_mov_b64 exec, -1
    s_cbranch_scc1 K2_DONE
    v_mfma_f32_32x32x8_bf16 v[156:171], v[42:43], v[208:209], v[60:75]
    s_mov_b64 exec, s[34:35]
    v_exp_f32 v220, v140
    v_exp_f32 v221, v141
    v_exp_f32 v222, v142
    v_exp_f32 v223, v143
    v_mfma_f32_32x32x16_bf16 v[156:171], v[36:39], v[188:191], v[156:171]
    v_exp_f32 v224, v144
    v_exp_f32 v225, v145
    s_bitcmp1_b32 s5, 2
    s_cbranch_scc0 K2_VP7
    s_setprio 1
K2_VP7:
    s_waitcnt lgkmcnt(0)
    s_mov_b64 exec, -1
    s_add_u32 m0, s94, 32768
    s_nop 0
    buffer_load_dwordx4 v[210:211], s[8:11], 0 idxen offen lds
    s_add_u32 m0, s94, 33792
    s_nop 0
    buffer_load_dwordx4 v[212:213], s[8:11], 0 idxen offen lds
    s_add_u32 m0, s94, 34816
    s_nop 0
    buffer_load_dwordx4 v[214:215], s[8:11], 0 idxen offen lds
    s_add_u32 m0, s94, 35840
    s_nop 0
    buffer_load_dwordx4 v[216:217], s[8:11], 0 idxen offen lds
    s_mov_b64 exec, s[34:35]
    s_setprio 0
    v_exp_f32 v226, v146
    v_exp_f32 v227, v147
    v_pk_add_f32 v[220:221], v[220:221], 1.0 op_sel_hi:[1,0]
    v_pk_add_f32 v[222:223], v[222:223], 1.0 op_sel_hi:[1,0]
    v_pk_add_f32 v[224:225], v[224:225], 1.0 op_sel_hi:[1,0]
    v_pk_add_f32 v[226:227], v[226:227], 1.0 op_sel_hi:[1,0]
    v_mfma_f32_32x32x16_bf16 v[156:171], v[16:19], v[172:175], v[156:171]
    v_rcp_f32 v220, v220
    v_rcp_f32 v221, v221
    v_rcp_f32 v222, v222
    v_rcp_f32 v223, v223
    v_mfma_f32_32x32x16_bf16 v[156:171], v[20:23], v[176:179], v[156:171]
    v_rcp_f32 v224, v224
    v_rcp_f32 v225, v225
    v_rcp_f32 v226, v226
    v_rcp_f32 v227, v227
    v_pk_fma_f32 v[76:77], v[140:141], v[220:221], v[76:77]
    v_pk_fma_f32 v[78:79], v[142:143], v[222:223], v[78:79]
    v_pk_fma_f32 v[80:81], v[144:145], v[224:225], v[80:81]
    v_pk_fma_f32 v[82:83], v[146:147], v[226:227], v[82:83]
    v_pk_mul_f32 v[228:229], v[76:77], v[108:109]
    v_pk_mul_f32 v[230:231], v[78:79], v[110:111]
    v_pk_fma_f32 v[228:229], v[80:81], v[112:113], v[228:229]
    v_pk_fma_f32 v[230:231], v[82:83], v[114:115], v[230:231]
    v_mfma_f32_32x32x16_bf16 v[156:171], v[24:27], v[180:183], v[156:171]
    v_exp_f32 v220, v148
    v_exp_f32 v221, v149
    v_exp_f32 v222, v150
    v_exp_f32 v223, v151
    v_mfma_f32_32x32x16_bf16 v[156:171], v[28:31], v[184:187], v[156:171]
    v_exp_f32 v224, v152
    v_exp_f32 v225, v153
    v_exp_f32 v226, v154
    buffer_load_dwordx4 v[196:199], v[218:219], s[12:15], 0 idxen offen
    buffer_load_dwordx2 v[204:205], v203, s[16:19], 0 idxen
    v_exp_f32 v227, v155
    s_waitcnt vmcnt(6)
    ds_read_b128 v[172:175], v251 offset:0
    ds_read_b128 v[176:179], v252 offset:0
    ds_read_b128 v[180:183], v253 offset:0
    ds_read_b128 v[184:187], v254 offset:0
    v_cmp_lt_u32_e64 s[28:29], s6, v235
    s_add_u32 s6, s6, 1
    v_lshlrev_b32 v232, 16, v200
    v_and_b32 v233, 0xffff0000, v200
    v_sub_f32 v234, v242, v201
    v_pk_add_f32 v[232:233], v[240:241], v[232:233] neg_lo:[0,1] neg_hi:[0,1]
    v_mul_f32 v208, v232, v232
    v_fmac_f32 v208, v233, v233
    v_fmac_f32 v208, v234, v234
    v_cvt_pk_bf16_f32 v208, v208, v208
    v_cndmask_b32_e64 v203, 0, v207, s[28:29]
    v_add_u32 v207, v207, v206
    ds_read_b32 v218, v203
    ds_read_u16 v203, v203 offset:4
    v_pk_add_f32 v[220:221], v[220:221], 1.0 op_sel_hi:[1,0]
    v_pk_add_f32 v[222:223], v[222:223], 1.0 op_sel_hi:[1,0]
    v_pk_add_f32 v[224:225], v[224:225], 1.0 op_sel_hi:[1,0]
    v_pk_add_f32 v[226:227], v[226:227], 1.0 op_sel_hi:[1,0]
    v_rcp_f32 v220, v220
    v_rcp_f32 v221, v221
    v_rcp_f32 v222, v222
    v_rcp_f32 v223, v223
    v_rcp_f32 v224, v224
    v_rcp_f32 v225, v225
    v_rcp_f32 v226, v226
    v_rcp_f32 v227, v227
    s_waitcnt lgkmcnt(0)
    s_mov_b64 exec, -1
    ds_bpermute_b32 v210, v239, v203 offset:0
    ds_bpermute_b32 v212, v239, v203 offset:32
    ds_bpermute_b32 v214, v239, v203 offset:64
    ds_bpermute_b32 v216, v239, v203 offset:96
    s_mov_b64 exec, s[34:35]
    v_pk_fma_f32 v[84:85], v[148:149], v[220:221], v[84:85]
    v_pk_fma_f32 v[86:87], v[150:151], v[222:223], v[86:87]
    v_pk_fma_f32 v[88:89], v[152:153], v[224:225], v[88:89]
    v_pk_fma_f32 v[90:91], v[154:155], v[226:227], v[90:91]
    v_pk_fma_f32 v[228:229], v[84:85], v[116:117], v[228:229]
    v_pk_fma_f32 v[230:231], v[86:87], v[118:119], v[230:231]
    v_pk_fma_f32 v[228:229], v[88:89], v[120:121], v[228:229]
    v_pk_fma_f32 v[230:231], v[90:91], v[122:123], v[230:231]
    v_mfma_f32_32x32x8_bf16 v[140:155], v[40:41], v[208:209], v[44:59]
    v_exp_f32 v220, v156
    v_exp_f32 v221, v157
    v_exp_f32 v222, v158
    v_exp_f32 v223, v159
    v_mfma_f32_32x32x16_bf16 v[140:155], v[32:35], v[192:195], v[140:155]
    v_exp_f32 v224, v160
    v_exp_f32 v225, v161
    v_exp_f32 v226, v162
    v_exp_f32 v227, v163
    v_pk_add_f32 v[220:221], v[220:221], 1.0 op_sel_hi:[1,0]
    v_pk_add_f32 v[222:223], v[222:223], 1.0 op_sel_hi:[1,0]
    v_pk_add_f32 v[224:225], v[224:225], 1.0 op_sel_hi:[1,0]
    v_pk_add_f32 v[226:227], v[226:227], 1.0 op_sel_hi:[1,0]
    v_mfma_f32_32x32x16_bf16 v[140:155], v[0:3], v[172:175], v[140:155]
    v_rcp_f32 v220, v220
    v_rcp_f32 v221, v221
    v_rcp_f32 v222, v222
    v_rcp_f32 v223, v223
    v_mfma_f32_32x32x16_bf16 v[140:155], v[4:7], v[176:179], v[140:155]
    v_rcp_f32 v224, v224
    v_rcp_f32 v225, v225
    v_rcp_f32 v226, v226
    v_rcp_f32 v227, v227
    v_pk_fma_f32 v[92:93], v[156:157], v[220:221], v[92:93]
    v_pk_fma_f32 v[94:95], v[158:159], v[222:223], v[94:95]
    v_pk_fma_f32 v[96:97], v[160:161], v[224:225], v[96:97]
    v_pk_fma_f32 v[98:99], v[162:163], v[226:227], v[98:99]
    v_pk_fma_f32 v[228:229], v[92:93], v[124:125], v[228:229]
    v_pk_fma_f32 v[230:231], v[94:95], v[126:127], v[230:231]
    v_pk_fma_f32 v[228:229], v[96:97], v[128:129], v[228:229]
    v_pk_fma_f32 v[230:231], v[98:99], v[130:131], v[230:231]
    v_mfma_f32_32x32x16_bf16 v[140:155], v[8:11], v[180:183], v[140:155]
    v_exp_f32 v220, v164
    v_exp_f32 v221, v165
    v_exp_f32 v222, v166
    v_exp_f32 v223, v167
    v_mfma_f32_32x32x16_bf16 v[140:155], v[12:15], v[184:187], v[140:155]
    v_exp_f32 v224, v168
    v_exp_f32 v225, v169
    v_exp_f32 v226, v170
    v_exp_f32 v227, v171
    v_pk_add_f32 v[220:221], v[220:221], 1.0 op_sel_hi:[1,0]
    v_pk_add_f32 v[222:223], v[222:223], 1.0 op_sel_hi:[1,0]
    v_pk_add_f32 v[224:225], v[224:225], 1.0 op_sel_hi:[1,0]
    v_pk_add_f32 v[226:227], v[226:227], 1.0 op_sel_hi:[1,0]
    v_rcp_f32 v220, v220
    v_rcp_f32 v221, v221
    v_rcp_f32 v222, v222
    v_rcp_f32 v223, v223
    v_rcp_f32 v224, v224
    v_rcp_f32 v225, v225
    v_rcp_f32 v226, v226
    v_rcp_f32 v227, v227
    v_pk_fma_f32 v[100:101], v[164:165], v[220:221], v[100:101]
    v_pk_fma_f32 v[102:103], v[166:167], v[222:223], v[102:103]
    v_pk_fma_f32 v[104:105], v[168:169], v[224:225], v[104:105]
    v_pk_fma_f32 v[106:107], v[170:171], v[226:227], v[106:107]
    v_pk_fma_f32 v[228:229], v[100:101], v[132:133], v[228:229]
    v_pk_fma_f32 v[230:231], v[102:103], v[134:135], v[230:231]
    v_pk_fma_f32 v[228:229], v[104:105], v[136:137], v[228:229]
    v_pk_fma_f32 v[230:231], v[106:107], v[138:139], v[230:231]
    v_pk_add_f32 v[228:229], v[228:229], v[230:231]
    s_cmp_eq_u64 s[36:37], 0
    v_add_f32 v247, v228, v229
    v_sub_f32 v248, v247, v243
    v_pk_fma_f32 v[244:245], v[236:237], v[248:249], v[244:245] op_sel_hi:[1,0,1]
    v_fmac_f32 v246, v238, v248
    s_mov_b64 exec, -1
    s_cbranch_scc1 K2_DONE
    v_mfma_f32_32x32x8_bf16 v[156:171], v[42:43], v[208:209], v[60:75]
    s_mov_b64 exec, s[36:37]
    v_exp_f32 v220, v140
    v_exp_f32 v221, v141
    v_exp_f32 v222, v142
    v_exp_f32 v223, v143
    v_mfma_f32_32x32x16_bf16 v[156:171], v[36:39], v[192:195], v[156:171]
    v_exp_f32 v224, v144
    v_exp_f32 v225, v145
    s_bitcmp1_b32 s5, 2
    s_cbranch_scc0 K2_VP9
    s_setprio 1
K2_VP9:
    s_waitcnt lgkmcnt(0)
    s_mov_b64 exec, -1
    s_add_u32 m0, s94, 0
    s_nop 0
    buffer_load_dwordx4 v[210:211], s[8:11], 0 idxen offen lds
    s_add_u32 m0, s94, 1024
    s_nop 0
    buffer_load_dwordx4 v[212:213], s[8:11], 0 idxen offen lds
    s_add_u32 m0, s94, 2048
    s_nop 0
    buffer_load_dwordx4 v[214:215], s[8:11], 0 idxen offen lds
    s_add_u32 m0, s94, 3072
    s_nop 0
    buffer_load_dwordx4 v[216:217], s[8:11], 0 idxen offen lds
    s_mov_b64 exec, s[36:37]
    s_setprio 0
    v_exp_f32 v226, v146
    v_exp_f32 v227, v147
    v_pk_add_f32 v[220:221], v[220:221], 1.0 op_sel_hi:[1,0]
    v_pk_add_f32 v[222:223], v[222:223], 1.0 op_sel_hi:[1,0]
    v_pk_add_f32 v[224:225], v[224:225], 1.0 op_sel_hi:[1,0]
    v_pk_add_f32 v[226:227], v[226:227], 1.0 op_sel_hi:[1,0]
    v_mfma_f32_32x32x16_bf16 v[156:171], v[16:19], v[172:175], v[156:171]
    v_rcp_f32 v220, v220
    v_rcp_f32 v221, v221
    v_rcp_f32 v222, v222
    v_rcp_f32 v223, v223
    v_mfma_f32_32x32x16_bf16 v[156:171], v[20:23], v[176:179], v[156:171]
    v_rcp_f32 v224, v224
    v_rcp_f32 v225, v225
    v_rcp_f32 v226, v226
    v_rcp_f32 v227, v227
    v_pk_fma_f32 v[76:77], v[140:141], v[220:221], v[76:77]
    v_pk_fma_f32 v[78:79], v[142:143], v[222:223], v[78:79]
    v_pk_fma_f32 v[80:81], v[144:145], v[224:225], v[80:81]
    v_pk_fma_f32 v[82:83], v[146:147], v[226:227], v[82:83]
    v_pk_mul_f32 v[228:229], v[76:77], v[108:109]
    v_pk_mul_f32 v[230:231], v[78:79], v[110:111]
    v_pk_fma_f32 v[228:229], v[80:81], v[112:113], v[228:229]
    v_pk_fma_f32 v[230:231], v[82:83], v[114:115], v[230:231]
    v_mfma_f32_32x32x16_bf16 v[156:171], v[24:27], v[180:183], v[156:171]
    v_exp_f32 v220, v148
    v_exp_f32 v221, v149
    v_exp_f32 v222, v150
    v_exp_f32 v223, v151
    v_mfma_f32_32x32x16_bf16 v[156:171], v[28:31], v[184:187], v[156:171]
    v_exp_f32 v224, v152
    v_exp_f32 v225, v153
    v_exp_f32 v226, v154
    buffer_load_dwordx4 v[188:191], v[218:219], s[12:15], 0 idxen offen
    buffer_load_dwordx2 v[200:201], v203, s[16:19], 0 idxen
    v_exp_f32 v227, v155
    s_waitcnt vmcnt(6)
    ds_read_b128 v[172:175], v251 offset:32768
    ds_read_b128 v[176:179], v252 offset:32768
    ds_read_b128 v[180:183], v253 offset:32768
    ds_read_b128 v[184:187], v254 offset:32768
    v_cmp_lt_u32_e64 s[30:31], s6, v235
    s_add_u32 s6, s6, 1
    v_lshlrev_b32 v236, 16, v204
    v_and_b32 v237, 0xffff0000, v204
    v_sub_f32 v238, v242, v205
    v_pk_add_f32 v[236:237], v[240:241], v[236:237] neg_lo:[0,1] neg_hi:[0,1]
    v_mul_f32 v208, v236, v236
    v_fmac_f32 v208, v237, v237
    v_fmac_f32 v208, v238, v238
    v_cvt_pk_bf16_f32 v208, v208, v208
    v_cndmask_b32_e64 v203, 0, v207, s[30:31]
    v_add_u32 v207, v207, v206
    ds_read_b32 v218, v203
    ds_read_u16 v203, v203 offset:4
    v_pk_add_f32 v[220:221], v[220:221], 1.0 op_sel_hi:[1,0]
    v_pk_add_f32 v[222:223], v[222:223], 1.0 op_sel_hi:[1,0]
    v_pk_add_f32 v[224:225], v[224:225], 1.0 op_sel_hi:[1,0]
    v_pk_add_f32 v[226:227], v[226:227], 1.0 op_sel_hi:[1,0]
    v_rcp_f32 v220, v220
    v_rcp_f32 v221, v221
    v_rcp_f32 v222, v222
    v_rcp_f32 v223, v223
    v_rcp_f32 v224, v224
    v_rcp_f32 v225, v225
    v_rcp_f32 v226, v226
    v_rcp_f32 v227, v227
    s_waitcnt lgkmcnt(0)
    s_mov_b64 exec, -1
    ds_bpermute_b32 v210, v239, v203 offset:0
    ds_bpermute_b32 v212, v239, v203 offset:32
    ds_bpermute_b32 v214, v239, v203 offset:64
    ds_bpermute_b32 v216, v239, v203 offset:96
    s_mov_b64 exec, s[36:37]
    v_pk_fma_f32 v[84:85], v[148:149], v[220:221], v[84:85]
    v_pk_fma_f32 v[86:87], v[150:151], v[222:223], v[86:87]
    v_pk_fma_f32 v[88:89], v[152:153], v[224:225], v[88:89]
    v_pk_fma_f32 v[90:91], v[154:155], v[226:227], v[90:91]
    v_pk_fma_f32 v[228:229], v[84:85], v[116:117], v[228:229]
    v_pk_fma_f32 v[230:231], v[86:87], v[118:119], v[230:231]
    v_pk_fma_f32 v[228:229], v[88:89], v[120:121], v[228:229]
    v_pk_fma_f32 v[230:231], v[90:91], v[122:123], v[230:231]
    v_mfma_f32_32x32x8_bf16 v[140:155], v[40:41], v[208:209], v[44:59]
    v_exp_f32 v220, v156
    v_exp_f32 v221, v157
    v_exp_f32 v222, v158
    v_exp_f32 v223, v159
    v_mfma_f32_32x32x16_bf16 v[140:155], v[32:35], v[196:199], v[140:155]
    v_exp_f32 v224, v160
    v_exp_f32 v225, v161
    v_exp_f32 v226, v162
    v_exp_f32 v227, v163
    v_pk_add_f32 v[220:221], v[220:221], 1.0 op_sel_hi:[1,0]
    v_pk_add_f32 v[222:223], v[222:223], 1.0 op_sel_hi:[1,0]
    v_pk_add_f32 v[224:225], v[224:225], 1.0 op_sel_hi:[1,0]
    v_pk_add_f32 v[226:227], v[226:227], 1.0 op_sel_hi:[1,0]
    v_mfma_f32_32x32x16_bf16 v[140:155], v[0:3], v[172:175], v[140:155]
    v_rcp_f32 v220, v220
    v_rcp_f32 v221, v221
    v_rcp_f32 v222, v222
    v_rcp_f32 v223, v223
    v_mfma_f32_32x32x16_bf16 v[140:155], v[4:7], v[176:179], v[140:155]
    v_rcp_f32 v224, v224
    v_rcp_f32 v225, v225
    v_rcp_f32 v226, v226
    v_rcp_f32 v227, v227
    v_pk_fma_f32 v[92:93], v[156:157], v[220:221], v[92:93]
    v_pk_fma_f32 v[94:95], v[158:159], v[222:223], v[94:95]
    v_pk_fma_f32 v[96:97], v[160:161], v[224:225], v[96:97]
    v_pk_fma_f32 v[98:99], v[162:163], v[226:227], v[98:99]
    v_pk_fma_f32 v[228:229], v[92:93], v[124:125], v[228:229]
    v_pk_fma_f32 v[230:231], v[94:95], v[126:127], v[230:231]
    v_pk_fma_f32 v[228:229], v[96:97], v[128:129], v[228:229]
    v_pk_fma_f32 v[230:231], v[98:99], v[130:131], v[230:231]
    v_mfma_f32_32x32x16_bf16 v[140:155], v[8:11], v[180:183], v[140:155]
    v_exp_f32 v220, v164
    v_exp_f32 v221, v165
    v_exp_f32 v222, v166
    v_exp_f32 v223, v167
    v_mfma_f32_32x32x16_bf16 v[140:155], v[12:15], v[184:187], v[140:155]
    v_exp_f32 v224, v168
    v_exp_f32 v225, v169
    v_exp_f32 v226, v170
    v_exp_f32 v227, v171
    v_pk_add_f32 v[220:221], v[220:221], 1.0 op_sel_hi:[1,0]
    v_pk_add_f32 v[222:223], v[222:223], 1.0 op_sel_hi:[1,0]
    v_pk_add_f32 v[224:225], v[224:225], 1.0 op_sel_hi:[1,0]
    v_pk_add_f32 v[226:227], v[226:227], 1.0 op_sel_hi:[1,0]
    v_rcp_f32 v220, v220
    v_rcp_f32 v221, v221
    v_rcp_f32 v222, v222
    v_rcp_f32 v223, v223
    v_rcp_f32 v224, v224
    v_rcp_f32 v225, v225
    v_rcp_f32 v226, v226
    v_rcp_f32 v227, v227
    v_pk_fma_f32 v[100:101], v[164:165], v[220:221], v[100:101]
    v_pk_fma_f32 v[102:103], v[166:167], v[222:223], v[102:103]
    v_pk_fma_f32 v[104:105], v[168:169], v[224:225], v[104:105]
    v_pk_fma_f32 v[106:107], v[170:171], v[226:227], v[106:107]
    v_pk_fma_f32 v[228:229], v[100:101], v[132:133], v[228:229]
    v_pk_fma_f32 v[230:231], v[102:103], v[134:135], v[230:231]
    v_pk_fma_f32 v[228:229], v[104:105], v[136:137], v[228:229]
    v_pk_fma_f32 v[230:231], v[106:107], v[138:139], v[230:231]
    v_pk_add_f32 v[228:229], v[228:229], v[230:231]
    s_cmp_eq_u64 s[38:39], 0
    v_add_f32 v243, v228, v229
    v_sub_f32 v248, v243, v247
    v_pk_fma_f32 v[244:245], v[232:233], v[248:249], v[244:245] op_sel_hi:[1,0,1]
    v_fmac_f32 v246, v234, v248
    s_mov_b64 exec, -1
    s_cbranch_scc1 K2_DONE
    v_mfma_f32_32x32x8_bf16 v[156:171], v[42:43], v[208:209], v[60:75]
    s_mov_b64 exec, s[38:39]
    v_exp_f32 v220, v140
    v_exp_f32 v221, v141
    v_exp_f32 v222, v142
    v_exp_f32 v223, v143
    v_mfma_f32_32x32x16_bf16 v[156:171], v[36:39], v[196:199], v[156:171]
    v_exp_f32 v224, v144
    v_exp_f32 v225, v145
    s_bitcmp1_b32 s5, 2
    s_cbranch_scc0 K2_VP11
    s_setprio 1
K2_VP11:
    s_waitcnt lgkmcnt(0)
    s_mov_b64 exec, -1
    s_add_u32 m0, s94, 32768
    s_nop 0
    buffer_load_dwordx4 v[210:211], s[8:11], 0 idxen offen lds
    s_add_u32 m0, s94, 33792
    s_nop 0
    buffer_load_dwordx4 v[212:213], s[8:11], 0 idxen offen lds
    s_add_u32 m0, s94, 34816
    s_nop 0
    buffer_load_dwordx4 v[214:215], s[8:11], 0 idxen offen lds
    s_add_u32 m0, s94, 35840
    s_nop 0
    buffer_load_dwordx4 v[216:217], s[8:11], 0 idxen offen lds
    s_mov_b64 exec, s[38:39]
    s_setprio 0
    v_exp_f32 v226, v146
    v_exp_f32 v227, v147
    v_pk_add_f32 v[220:221], v[220:221], 1.0 op_sel_hi:[1,0]
    v_pk_add_f32 v[222:223], v[222:223], 1.0 op_sel_hi:[1,0]
    v_pk_add_f32 v[224:225], v[224:225], 1.0 op_sel_hi:[1,0]
    v_pk_add_f32 v[226:227], v[226:227], 1.0 op_sel_hi:[1,0]
    v_mfma_f32_32x32x16_bf16 v[156:171], v[16:19], v[172:175], v[156:171]
    v_rcp_f32 v220, v220
    v_rcp_f32 v221, v221
    v_rcp_f32 v222, v222
    v_rcp_f32 v223, v223
    v_mfma_f32_32x32x16_bf16 v[156:171], v[20:23], v[176:179], v[156:171]
    v_rcp_f32 v224, v224
    v_rcp_f32 v225, v225
    v_rcp_f32 v226, v226
    v_rcp_f32 v227, v227
    v_pk_fma_f32 v[76:77], v[140:141], v[220:221], v[76:77]
    v_pk_fma_f32 v[78:79], v[142:143], v[222:223], v[78:79]
    v_pk_fma_f32 v[80:81], v[144:145], v[224:225], v[80:81]
    v_pk_fma_f32 v[82:83], v[146:147], v[226:227], v[82:83]
    v_pk_mul_f32 v[228:229], v[76:77], v[108:109]
    v_pk_mul_f32 v[230:231], v[78:79], v[110:111]
    v_pk_fma_f32 v[228:229], v[80:81], v[112:113], v[228:229]
    v_pk_fma_f32 v[230:231], v[82:83], v[114:115], v[230:231]
    v_mfma_f32_32x32x16_bf16 v[156:171], v[24:27], v[180:183], v[156:171]
    v_exp_f32 v220, v148
    v_exp_f32 v221, v149
    v_exp_f32 v222, v150
    v_exp_f32 v223, v151
    v_mfma_f32_32x32x16_bf16 v[156:171], v[28:31], v[184:187], v[156:171]
    v_exp_f32 v224, v152
    v_exp_f32 v225, v153
    v_exp_f32 v226, v154
    buffer_load_dwordx4 v[192:195], v[218:219], s[12:15], 0 idxen offen
    buffer_load_dwordx2 v[204:205], v203, s[16:19], 0 idxen
    v_exp_f32 v227, v155
    s_waitcnt vmcnt(6)
    ds_read_b128 v[172:175], v251 offset:0
    ds_read_b128 v[176:179], v252 offset:0
    ds_read_b128 v[180:183], v253 offset:0
    ds_read_b128 v[184:187], v254 offset:0
    v_cmp_lt_u32_e64 s[32:33], s6, v235
    s_add_u32 s6, s6, 1
    v_lshlrev_b32 v232, 16, v200
    v_and_b32 v233, 0xffff0000, v200
    v_sub_f32 v234, v242, v201
    v_pk_add_f32 v[232:233], v[240:241], v[232:233] neg_lo:[0,1] neg_hi:[0,1]
    v_mul_f32 v208, v232, v232
    v_fmac_f32 v208, v233, v233
    v_fmac_f32 v208, v234, v234
    v_cvt_pk_bf16_f32 v208, v208, v208
    v_cndmask_b32_e64 v203, 0, v207, s[32:33]
    v_add_u32 v207, v207, v206
    ds_read_b32 v218, v203
    ds_read_u16 v203, v203 offset:4
    v_pk_add_f32 v[220:221], v[220:221], 1.0 op_sel_hi:[1,0]
    v_pk_add_f32 v[222:223], v[222:223], 1.0 op_sel_hi:[1,0]
    v_pk_add_f32 v[224:225], v[224:225], 1.0 op_sel_hi:[1,0]
    v_pk_add_f32 v[226:227], v[226:227], 1.0 op_sel_hi:[1,0]
    v_rcp_f32 v220, v220
    v_rcp_f32 v221, v221
    v_rcp_f32 v222, v222
    v_rcp_f32 v223, v223
    v_rcp_f32 v224, v224
    v_rcp_f32 v225, v225
    v_rcp_f32 v226, v226
    v_rcp_f32 v227, v227
    s_waitcnt lgkmcnt(0)
    s_mov_b64 exec, -1
    ds_bpermute_b32 v210, v239, v203 offset:0
    ds_bpermute_b32 v212, v239, v203 offset:32
    ds_bpermute_b32 v214, v239, v203 offset:64
    ds_bpermute_b32 v216, v239, v203 offset:96
    s_mov_b64 exec, s[38:39]
    v_pk_fma_f32 v[84:85], v[148:149], v[220:221], v[84:85]
    v_pk_fma_f32 v[86:87], v[150:151], v[222:223], v[86:87]
    v_pk_fma_f32 v[88:89], v[152:153], v[224:225], v[88:89]
    v_pk_fma_f32 v[90:91], v[154:155], v[226:227], v[90:91]
    v_pk_fma_f32 v[228:229], v[84:85], v[116:117], v[228:229]
    v_pk_fma_f32 v[230:231], v[86:87], v[118:119], v[230:231]
    v_pk_fma_f32 v[228:229], v[88:89], v[120:121], v[228:229]
    v_pk_fma_f32 v[230:231], v[90:91], v[122:123], v[230:231]
    v_mfma_f32_32x32x8_bf16 v[140:155], v[40:41], v[208:209], v[44:59]
    v_exp_f32 v220, v156
    v_exp_f32 v221, v157
    v_exp_f32 v222, v158
    v_exp_f32 v223, v159
    v_mfma_f32_32x32x16_bf16 v[140:155], v[32:35], v[188:191], v[140:155]
    v_exp_f32 v224, v160
    v_exp_f32 v225, v161
    v_exp_f32 v226, v162
    v_exp_f32 v227, v163
    v_pk_add_f32 v[220:221], v[220:221], 1.0 op_sel_hi:[1,0]
    v_pk_add_f32 v[222:223], v[222:223], 1.0 op_sel_hi:[1,0]
    v_pk_add_f32 v[224:225], v[224:225], 1.0 op_sel_hi:[1,0]
    v_pk_add_f32 v[226:227], v[226:227], 1.0 op_sel_hi:[1,0]
    v_mfma_f32_32x32x16_bf16 v[140:155], v[0:3], v[172:175], v[140:155]
    v_rcp_f32 v220, v220
    v_rcp_f32 v221, v221
    v_rcp_f32 v222, v222
    v_rcp_f32 v223, v223
    v_mfma_f32_32x32x16_bf16 v[140:155], v[4:7], v[176:179], v[140:155]
    v_rcp_f32 v224, v224
    v_rcp_f32 v225, v225
    v_rcp_f32 v226, v226
    v_rcp_f32 v227, v227
    v_pk_fma_f32 v[92:93], v[156:157], v[220:221], v[92:93]
    v_pk_fma_f32 v[94:95], v[158:159], v[222:223], v[94:95]
    v_pk_fma_f32 v[96:97], v[160:161], v[224:225], v[96:97]
    v_pk_fma_f32 v[98:99], v[162:163], v[226:227], v[98:99]
    v_pk_fma_f32 v[228:229], v[92:93], v[124:125], v[228:229]
    v_pk_fma_f32 v[230:231], v[94:95], v[126:127], v[230:231]
    v_pk_fma_f32 v[228:229], v[96:97], v[128:129], v[228:229]
    v_pk_fma_f32 v[230:231], v[98:99], v[130:131], v[230:231]
    v_mfma_f32_32x32x16_bf16 v[140:155], v[8:11], v[180:183], v[140:155]
    v_exp_f32 v220, v164
    v_exp_f32 v221, v165
    v_exp_f32 v222, v166
    v_exp_f32 v223, v167
    v_mfma_f32_32x32x16_bf16 v[140:155], v[12:15], v[184:187], v[140:155]
    v_exp_f32 v224, v168
    v_exp_f32 v225, v169
    v_exp_f32 v226, v170
    v_exp_f32 v227, v171
    v_pk_add_f32 v[220:221], v[220:221], 1.0 op_sel_hi:[1,0]
    v_pk_add_f32 v[222:223], v[222:223], 1.0 op_sel_hi:[1,0]
    v_pk_add_f32 v[224:225], v[224:225], 1.0 op_sel_hi:[1,0]
    v_pk_add_f32 v[226:227], v[226:227], 1.0 op_sel_hi:[1,0]
    v_rcp_f32 v220, v220
    v_rcp_f32 v221, v221
    v_rcp_f32 v222, v222
    v_rcp_f32 v223, v223
    v_rcp_f32 v224, v224
    v_rcp_f32 v225, v225
    v_rcp_f32 v226, v226
    v_rcp_f32 v227, v227
    v_pk_fma_f32 v[100:101], v[164:165], v[220:221], v[100:101]
    v_pk_fma_f32 v[102:103], v[166:167], v[222:223], v[102:103]
    v_pk_fma_f32 v[104:105], v[168:169], v[224:225], v[104:105]
    v_pk_fma_f32 v[106:107], v[170:171], v[226:227], v[106:107]
    v_pk_fma_f32 v[228:229], v[100:101], v[132:133], v[228:229]
    v_pk_fma_f32 v[230:231], v[102:103], v[134:135], v[230:231]
    v_pk_fma_f32 v[228:229], v[104:105], v[136:137], v[228:229]
    v_pk_fma_f32 v[230:231], v[106:107], v[138:139], v[230:231]
    v_pk_add_f32 v[228:229], v[228:229], v[230:231]
    s_cmp_eq_u64 s[28:29], 0
    v_add_f32 v247, v228, v229
    v_sub_f32 v248, v247, v243
    v_pk_fma_f32 v[244:245], v[236:237], v[248:249], v[244:245] op_sel_hi:[1,0,1]
    v_fmac_f32 v246, v238, v248
    s_mov_b64 exec, -1
    s_cbranch_scc0 K2_LOOP
K2_DONE:
    v_and_b32 v203, 63, v250
    s_or_b32 s95, s7, s93
    s_cselect_b32 s97, 3, s97
    s_cmp_gt_u32 s97, 2
    v_lshlrev_b32 v203, 4, v203
    s_cbranch_scc1 K2_SLOW
    v_bfe_u32 v220, v249, 1, 3
    v_lshlrev_b32 v220, 4, v220
    v_lshlrev_b32 v221, 2, v219
    v_xor_b32 v220, v220, v221
    v_lshl_add_u32 v220, v249, 7, v220
    v_add_u32 v220, 100352, v220
    v_xor_b32 v221, 16, v220
    v_xor_b32 v222, 32, v220
    v_xor_b32 v223, 48, v220
    ds_read_b128 v[172:175], v220
    ds_read_b128 v[176:179], v221
    ds_read_b128 v[180:183], v222
    ds_read_b128 v[184:187], v223
    v_add_u32 v220, 125952, v203
    v_cmp_eq_u32_e64 s[46:47], 16, v206
    v_cmp_eq_u32_e64 s[44:45], 8, v206
    v_add_u32 v218, s4, v249
    ds_read_b128 v[0:3], v220 offset:32768
    ds_read_b128 v[4:7], v220 offset:33792
    ds_read_b128 v[8:11], v220 offset:34816
    ds_read_b128 v[12:15], v220 offset:35840
    ds_read_b128 v[16:19], v220 offset:0
    ds_read_b128 v[20:23], v220 offset:1024
    ds_read_b128 v[24:27], v220 offset:2048
    ds_read_b128 v[28:31], v220 offset:3072
    ds_read_b128 v[44:47], v220 offset:4096
    ds_read_b128 v[48:51], v220 offset:5120
    ds_read_b128 v[52:55], v220 offset:6144
    ds_read_b128 v[56:59], v220 offset:7168
    ds_read_b128 v[60:63], v220 offset:8192
    ds_read_b128 v[64:67], v220 offset:9216
    ds_read_b128 v[68:71], v220 offset:10240
    ds_read_b128 v[72:75], v220 offset:11264
    s_mov_b64 exec, s[46:47]
    s_and_b32 s46, s46, 0x55555555
    s_or_b32 s44, s44, s46
    s_mov_b32 s98, s94
    v_add_f32_dpp v244, v244, v244 quad_perm:[1,0,3,2] row_mask:0xf bank_mask:0xf
    v_add_f32_dpp v245, v245, v245 quad_perm:[1,0,3,2] row_mask:0xf bank_mask:0xf
    v_add_f32_dpp v246, v246, v246 quad_perm:[1,0,3,2] row_mask:0xf bank_mask:0xf
    v_add_f32_dpp v76, v76, v76 quad_perm:[1,0,3,2] row_mask:0xf bank_mask:0xf
    v_add_f32_dpp v77, v77, v77 quad_perm:[1,0,3,2] row_mask:0xf bank_mask:0xf
    v_add_f32_dpp v78, v78, v78 quad_perm:[1,0,3,2] row_mask:0xf bank_mask:0xf
    v_add_f32_dpp v79, v79, v79 quad_perm:[1,0,3,2] row_mask:0xf bank_mask:0xf
    v_add_f32_dpp v80, v80, v80 quad_perm:[1,0,3,2] row_mask:0xf bank_mask:0xf
    v_add_f32_dpp v81, v81, v81 quad_perm:[1,0,3,2] row_mask:0xf bank_mask:0xf
    v_add_f32_dpp v82, v82, v82 quad_perm:[1,0,3,2] row_mask:0xf bank_mask:0xf
    v_add_f32_dpp v83, v83, v83 quad_perm:[1,0,3,2] row_mask:0xf bank_mask:0xf
    v_add_f32_dpp v84, v84, v84 quad_perm:[1,0,3,2] row_mask:0xf bank_mask:0xf
    v_add_f32_dpp v85, v85, v85 quad_perm:[1,0,3,2] row_mask:0xf bank_mask:0xf
    v_add_f32_dpp v86, v86, v86 quad_perm:[1,0,3,2] row_mask:0xf bank_mask:0xf
    v_add_f32_dpp v87, v87, v87 quad_perm:[1,0,3,2] row_mask:0xf bank_mask:0xf
    v_add_f32_dpp v88, v88, v88 quad_perm:[1,0,3,2] row_mask:0xf bank_mask:0xf
    v_add_f32_dpp v89, v89, v89 quad_perm:[1,0,3,2] row_mask:0xf bank_mask:0xf
    v_add_f32_dpp v90, v90, v90 quad_perm:[1,0,3,2] row_mask:0xf bank_mask:0xf
    v_add_f32_dpp v91, v91, v91 quad_perm:[1,0,3,2] row_mask:0xf bank_mask:0xf
    v_add_f32_dpp v92, v92, v92 quad_perm:[1,0,3,2] row_mask:0xf bank_mask:0xf
    v_add_f32_dpp v93, v93, v93 quad_perm:[1,0,3,2] row_mask:0xf bank_mask:0xf
    v_add_f32_dpp v94, v94, v94 quad_perm:[1,0,3,2] row_mask:0xf bank_mask:0xf
    v_add_f32_dpp v95, v95, v95 quad_perm:[1,0,3,2] row_mask:0xf bank_mask:0xf
    v_add_f32_dpp v96, v96, v96 quad_perm:[1,0,3,2] row_mask:0xf bank_mask:0xf
    v_add_f32_dpp v97, v97, v97 quad_perm:[1,0,3,2] row_mask:0xf bank_mask:0xf
    v_add_f32_dpp v98, v98, v98 quad_perm:[1,0,3,2] row_mask:0xf bank_mask:0xf
    v_add_f32_dpp v99, v99, v99 quad_perm:[1,0,3,2] row_mask:0xf bank_mask:0xf
    v_add_f32_dpp v100, v100, v100 quad_perm:[1,0,3,2] row_mask:0xf bank_mask:0xf
    v_add_f32_dpp v101, v101, v101 quad_perm:[1,0,3,2] row_mask:0xf bank_mask:0xf
    v_add_f32_dpp v102, v102, v102 quad_perm:[1,0,3,2] row_mask:0xf bank_mask:0xf
    v_add_f32_dpp v103, v103, v103 quad_perm:[1,0,3,2] row_mask:0xf bank_mask:0xf
    v_add_f32_dpp v104, v104, v104 quad_perm:[1,0,3,2] row_mask:0xf bank_mask:0xf
    v_add_f32_dpp v105, v105, v105 quad_perm:[1,0,3,2] row_mask:0xf bank_mask:0xf
    v_add_f32_dpp v106, v106, v106 quad_perm:[1,0,3,2] row_mask:0xf bank_mask:0xf
    v_add_f32_dpp v107, v107, v107 quad_perm:[1,0,3,2] row_mask:0xf bank_mask:0xf
    s_mov_b64 exec, -1
    v_mov_b32 v224, v244
    v_mov_b32 v225, v245
    v_mov_b32 v226, v246
    s_nop 1
    v_permlane32_swap_b32 v224, v244
    v_permlane32_swap_b32 v225, v245
    v_permlane32_swap_b32 v226, v246
    s_nop 1
    v_add_f32 v244, v244, v224
    v_add_f32 v245, v245, v225
    v_add_f32 v246, v246, v226
    s_branch K2_TAIL
K2_EMPTY:
    s_waitcnt vmcnt(0) lgkmcnt(0)
    v_mov_b32 v244, 0
    v_mov_b32 v245, 0
    v_mov_b32 v246, 0
    v_mov_b32 v76, 0
    v_mov_b32 v77, 0
    v_mov_b32 v78, 0
    v_mov_b32 v79, 0
    v_mov_b32 v80, 0
    v_mov_b32 v81, 0
    v_mov_b32 v82, 0
    v_mov_b32 v83, 0
    v_mov_b32 v84, 0
    v_mov_b32 v85, 0
    v_mov_b32 v86, 0
    v_mov_b32 v87, 0
    v_mov_b32 v88, 0
    v_mov_b32 v89, 0
    v_mov_b32 v90, 0
    v_mov_b32 v91, 0
    v_mov_b32 v92, 0
    v_mov_b32 v93, 0
    v_mov_b32 v94, 0
    v_mov_b32 v95, 0
    v_mov_b32 v96, 0
    v_mov_b32 v97, 0
    v_mov_b32 v98, 0
    v_mov_b32 v99, 0
    v_mov_b32 v100, 0
    v_mov_b32 v101, 0
    v_mov_b32 v102, 0
    v_mov_b32 v103, 0
    v_mov_b32 v104, 0
    v_mov_b32 v105, 0
    v_mov_b32 v106, 0
    v_mov_b32 v107, 0
    v_mov_b32 v242, v241
    v_and_b32 v241, 0xffff0000, v240
    v_lshlrev_b32 v240, 16, v240
    s_branch K2_DONE
K2_SLOW:
    v_and_b32 v223, 31, v250
    v_lshlrev_b32 v220, 2, v219
    v_xor_b32 v220, v220, v251
    v_lshl_add_u32 v220, v219, 11, v220
    s_lshl_b32 s95, s100, 10
    s_add_u32 s95, s95, 129024
    v_lshl_add_u32 v221, v223, 5, v219
    v_add_u32 v221, s95, v221
    s_lshl_b32 s95, s5, 5
    v_add_u32 v223, s95, v223
    v_add_u32 v218, s4, v223
    v_min_u32 v222, 49999, v218
    s_waitcnt vmcnt(0)
    buffer_load_dwordx2 v[240:241], v222, s[16:19], 0 idxen
    v_xor_b32 v222, 0, v220
    ds_write_b128 v222, v[76:79]
    v_xor_b32 v222, 16, v220
    ds_write_b128 v222, v[80:83]
    v_xor_b32 v222, 32, v220
    ds_write_b128 v222, v[84:87]
    v_xor_b32 v222, 48, v220
    ds_write_b128 v222, v[88:91]
    v_xor_b32 v222, 64, v220
    ds_write_b128 v222, v[92:95]
    v_xor_b32 v222, 80, v220
    ds_write_b128 v222, v[96:99]
    v_xor_b32 v222, 96, v220
    ds_write_b128 v222, v[100:103]
    v_xor_b32 v222, 112, v220
    ds_write_b128 v222, v[104:107]
    ds_write_b128 v221, v[244:247]
    v_lshlrev_b32 v220, 2, v223
    ds_read_b32 v235, v220 offset:32768
    s_sub_u32 s99, s101, s94
    v_add_u32 v251, s99, v251
    v_add_u32 v252, s99, v252
    v_add_u32 v253, s99, v253
    v_add_u32 v254, s99, v254
    ds_read_b128 v[172:175], v251 offset:0
    ds_read_b128 v[176:179], v252 offset:0
    ds_read_b128 v[180:183], v253 offset:0
    ds_read_b128 v[184:187], v254 offset:0
    v_mov_b32 v76, 0
    v_mov_b32 v77, 0
    v_mov_b32 v78, 0
    v_mov_b32 v79, 0
    v_mov_b32 v80, 0
    v_mov_b32 v81, 0
    v_mov_b32 v82, 0
    v_mov_b32 v83, 0
    v_mov_b32 v84, 0
    v_mov_b32 v85, 0
    v_mov_b32 v86, 0
    v_mov_b32 v87, 0
    v_mov_b32 v88, 0
    v_mov_b32 v89, 0
    v_mov_b32 v90, 0
    v_mov_b32 v91, 0
    v_mov_b32 v92, 0
    v_mov_b32 v93, 0
    v_mov_b32 v94, 0
    v_mov_b32 v95, 0
    v_mov_b32 v96, 0
    v_mov_b32 v97, 0
    v_mov_b32 v98, 0
    v_mov_b32 v99, 0
    v_mov_b32 v100, 0
    v_mov_b32 v101, 0
    v_mov_b32 v102, 0
    v_mov_b32 v103, 0
    v_mov_b32 v104, 0
    v_mov_b32 v105, 0
    v_mov_b32 v106, 0
    v_mov_b32 v107, 0
    v_mov_b32 v244, 0
    v_mov_b32 v245, 0
    v_mov_b32 v246, 0
    s_lshl_b32 s99, s3, 8
    v_add_u32 v249, s99, v223
    v_mul_u32_u24 v249, 272, v249
    v_lshl_add_u32 v243, v219, 3, v249
    s_mov_b32 s99, 7602176
    s_cmp_eq_u32 s7, 0
    s_cbranch_scc1 K2_NOLD
    buffer_load_dwordx4 v[76:79], v243, s[20:23], s99 offen offset:0 sc0 sc1
    buffer_load_dwordx4 v[80:83], v243, s[20:23], s99 offen offset:16 sc0 sc1
    buffer_load_dwordx4 v[84:87], v243, s[20:23], s99 offen offset:32 sc0 sc1
    buffer_load_dwordx4 v[88:91], v243, s[20:23], s99 offen offset:48 sc0 sc1
    buffer_load_dwordx4 v[92:95], v243, s[20:23], s99 offen offset:64 sc0 sc1
    buffer_load_dwordx4 v[96:99], v243, s[20:23], s99 offen offset:80 sc0 sc1
    buffer_load_dwordx4 v[100:103], v243, s[20:23], s99 offen offset:96 sc0 sc1
    buffer_load_dwordx4 v[104:107], v243, s[20:23], s99 offen offset:112 sc0 sc1
    buffer_load_dwordx3 v[244:246], v249, s[20:23], s99 offen offset:256 sc0 sc1
    s_waitcnt vmcnt(0)
K2_NOLD:
    s_waitcnt lgkmcnt(0)
    v_and_b32 v207, 0xffff, v235
    v_lshrrev_b32 v235, 16, v235
    v_lshlrev_b32 v247, 11, v219
    v_add_u32 v247, 34816, v247
    v_add_u32 v220, 138240, v203
    v_cmp_lt_u32 vcc, 0, v235
    s_barrier
    s_cbranch_vccz K2_GDONE
K2_GLOOP:
    s_mov_b64 exec, vcc
    v_bfe_u32 v221, v207, 3, 3
    v_lshlrev_b32 v221, 4, v221
    v_lshl_add_u32 v221, v207, 5, v221
    v_add_u32 v221, v247, v221
    v_xor_b32 v222, 0, v221
    ds_read_b128 v[140:143], v222
    v_xor_b32 v222, 16, v221
    ds_read_b128 v[144:147], v222
    v_xor_b32 v222, 32, v221
    ds_read_b128 v[148:151], v222
    v_xor_b32 v222, 48, v221
    ds_read_b128 v[152:155], v222
    v_xor_b32 v222, 64, v221
    ds_read_b128 v[156:159], v222
    v_xor_b32 v222, 80, v221
    ds_read_b128 v[160:163], v222
    v_xor_b32 v222, 96, v221
    ds_read_b128 v[164:167], v222
    v_xor_b32 v222, 112, v221
    ds_read_b128 v[168:171], v222
    v_lshlrev_b32 v222, 3, v207
    v_add_u32 v222, 129024, v222
    ds_read_b128 v[188:191], v222
    ds_read_b128 v[192:195], v222 offset:16
    v_add_u32 v207, 4, v207
    v_subrev_u32 v235, 1, v235
    v_cmp_lt_u32 vcc, 0, v235
    s_waitcnt lgkmcnt(9)
    v_pk_add_f32 v[76:77], v[76:77], v[140:141]
    v_pk_add_f32 v[78:79], v[78:79], v[142:143]
    s_waitcnt lgkmcnt(8)
    v_pk_add_f32 v[80:81], v[80:81], v[144:145]
    v_pk_add_f32 v[82:83], v[82:83], v[146:147]
    s_waitcnt lgkmcnt(7)
    v_pk_add_f32 v[84:85], v[84:85], v[148:149]
    v_pk_add_f32 v[86:87], v[86:87], v[150:151]
    s_waitcnt lgkmcnt(6)
    v_pk_add_f32 v[88:89], v[88:89], v[152:153]
    v_pk_add_f32 v[90:91], v[90:91], v[154:155]
    s_waitcnt lgkmcnt(5)
    v_pk_add_f32 v[92:93], v[92:93], v[156:157]
    v_pk_add_f32 v[94:95], v[94:95], v[158:159]
    s_waitcnt lgkmcnt(4)
    v_pk_add_f32 v[96:97], v[96:97], v[160:161]
    v_pk_add_f32 v[98:99], v[98:99], v[162:163]
    s_waitcnt lgkmcnt(3)
    v_pk_add_f32 v[100:101], v[100:101], v[164:165]
    v_pk_add_f32 v[102:103], v[102:103], v[166:167]
    s_waitcnt lgkmcnt(2)
    v_pk_add_f32 v[104:105], v[104:105], v[168:169]
    v_pk_add_f32 v[106:107], v[106:107], v[170:171]
    s_waitcnt lgkmcnt(0)
    v_pk_add_f32 v[244:245], v[244:245], v[188:189]
    v_add_f32 v246, v246, v190
    v_pk_add_f32 v[244:245], v[244:245], v[192:193]
    v_add_f32 v246, v246, v194
    s_cbranch_vccnz K2_GLOOP
    s_mov_b64 exec, -1
K2_GDONE:
    s_cmp_eq_u32 s93, 0
    s_cbranch_scc1 K2_EPI
    buffer_store_dwordx4 v[76:79], v243, s[20:23], s99 offen offset:0
    buffer_store_dwordx4 v[80:83], v243, s[20:23], s99 offen offset:16
    buffer_store_dwordx4 v[84:87], v243, s[20:23], s99 offen offset:32
    buffer_store_dwordx4 v[88:91], v243, s[20:23], s99 offen offset:48
    buffer_store_dwordx4 v[92:95], v243, s[20:23], s99 offen offset:64
    buffer_store_dwordx4 v[96:99], v243, s[20:23], s99 offen offset:80
    buffer_store_dwordx4 v[100:103], v243, s[20:23], s99 offen offset:96
    buffer_store_dwordx4 v[104:107], v243, s[20:23], s99 offen offset:112
    buffer_store_dwordx3 v[244:246], v249, s[20:23], s99 offen offset:256
    s_add_u32 s7, s7, s92
    s_waitcnt vmcnt(0)
    s_barrier
    s_branch K2_TOP
K2_EPI:
    s_cmp_ge_u32 s5, 6
    s_cbranch_scc1 K2_NWH2
    s_mul_i32 s95, s5, 2048
    s_add_u32 m0, s95, 138240
    s_add_u32 s95, s95, 7561216
    buffer_load_dwordx4 v203, s[20:23], s95 offen offset:0 lds
    buffer_load_dwordx4 v203, s[20:23], s95 offen offset:1024 lds
K2_NWH2:
    s_lshl_b32 s95, s5, 5
    s_cmp_ge_u32 s95, s96
    s_waitcnt vmcnt(0)
    s_barrier
    s_cbranch_scc1 K2_END0
    ds_read_b128 v[0:3], v220 offset:20480
    ds_read_b128 v[4:7], v220 offset:21504
    ds_read_b128 v[8:11], v220 offset:22528
    ds_read_b128 v[12:15], v220 offset:23552
    ds_read_b128 v[16:19], v220 offset:0
    ds_read_b128 v[20:23], v220 offset:1024
    ds_read_b128 v[24:27], v220 offset:2048
    ds_read_b128 v[28:31], v220 offset:3072
    ds_read_b128 v[44:47], v220 offset:4096
    ds_read_b128 v[48:51], v220 offset:5120
    ds_read_b128 v[52:55], v220 offset:6144
    ds_read_b128 v[56:59], v220 offset:7168
    ds_read_b128 v[60:63], v220 offset:8192
    ds_read_b128 v[64:67], v220 offset:9216
    ds_read_b128 v[68:71], v220 offset:10240
    ds_read_b128 v[72:75], v220 offset:11264
    v_cmp_gt_u32_e64 s[44:45], s96, v223
    s_mov_b32 s98, s101
    s_waitcnt vmcnt(0)
    v_mov_b32 v242, v241
    v_and_b32 v241, 0xffff0000, v240
    v_lshlrev_b32 v240, 16, v240
K2_TAIL:
    v_add_u32 v235, s98, v203
    v_lshlrev_b32 v203, 7, v218
    v_cndmask_b32_e64 v203, 2.0, v203, s[44:45]
    s_waitcnt lgkmcnt(8)
    v_mfma_f32_32x32x16_bf16 v[140:155], v[0:3], v[172:175], 0
    v_cvt_pk_bf16_f32 v108, v76, v77
    v_cvt_pk_bf16_f32 v109, v78, v79
    v_mfma_f32_32x32x16_bf16 v[156:171], v[16:19], v[172:175], 0
    v_cvt_pk_bf16_f32 v110, v80, v81
    v_cvt_pk_bf16_f32 v111, v82, v83
    v_mfma_f32_32x32x16_bf16 v[140:155], v[4:7], v[176:179], v[140:155]
    v_cvt_pk_bf16_f32 v112, v84, v85
    v_cvt_pk_bf16_f32 v113, v86, v87
    v_mfma_f32_32x32x16_bf16 v[156:171], v[20:23], v[176:179], v[156:171]
    v_cvt_pk_bf16_f32 v114, v88, v89
    v_cvt_pk_bf16_f32 v115, v90, v91
    v_mfma_f32_32x32x16_bf16 v[140:155], v[8:11], v[180:183], v[140:155]
    v_cvt_pk_bf16_f32 v116, v92, v93
    v_cvt_pk_bf16_f32 v117, v94, v95
    v_mfma_f32_32x32x16_bf16 v[156:171], v[24:27], v[180:183], v[156:171]
    v_cvt_pk_bf16_f32 v118, v96, v97
    v_cvt_pk_bf16_f32 v119, v98, v99
    v_mfma_f32_32x32x16_bf16 v[140:155], v[12:15], v[184:187], v[140:155]
    v_cvt_pk_bf16_f32 v120, v100, v101
    v_cvt_pk_bf16_f32 v121, v102, v103
    v_mfma_f32_32x32x16_bf16 v[156:171], v[28:31], v[184:187], v[156:171]
    v_cvt_pk_bf16_f32 v122, v104, v105
    v_cvt_pk_bf16_f32 v123, v106, v107
    s_waitcnt lgkmcnt(0)
    ds_bpermute_b32 v210, v239, v203 offset:0
    ds_bpermute_b32 v212, v239, v203 offset:32
    ds_bpermute_b32 v214, v239, v203 offset:64
    ds_bpermute_b32 v216, v239, v203 offset:96
    v_mfma_f32_32x32x16_bf16 v[140:155], v[44:47], v[108:111], v[140:155]
    v_lshlrev_b32 v76, 16, v172
    v_and_b32 v77, 0xffff0000, v172
    v_lshlrev_b32 v78, 16, v173
    v_and_b32 v79, 0xffff0000, v173
    v_lshlrev_b32 v80, 16, v174
    v_and_b32 v81, 0xffff0000, v174
    v_lshlrev_b32 v82, 16, v175
    v_and_b32 v83, 0xffff0000, v175
    v_mfma_f32_32x32x16_bf16 v[140:155], v[48:51], v[112:115], v[140:155]
    v_lshlrev_b32 v84, 16, v176
    v_and_b32 v85, 0xffff0000, v176
    v_lshlrev_b32 v86, 16, v177
    v_and_b32 v87, 0xffff0000, v177
    v_lshlrev_b32 v88, 16, v178
    v_and_b32 v89, 0xffff0000, v178
    v_lshlrev_b32 v90, 16, v179
    v_and_b32 v91, 0xffff0000, v179
    v_mfma_f32_32x32x16_bf16 v[140:155], v[52:55], v[116:119], v[140:155]
    v_lshlrev_b32 v92, 16, v180
    v_and_b32 v93, 0xffff0000, v180
    v_lshlrev_b32 v94, 16, v181
    v_and_b32 v95, 0xffff0000, v181
    v_lshlrev_b32 v96, 16, v182
    v_and_b32 v97, 0xffff0000, v182
    v_lshlrev_b32 v98, 16, v183
    v_and_b32 v99, 0xffff0000, v183
    v_mfma_f32_32x32x16_bf16 v[140:155], v[56:59], v[120:123], v[140:155]
    v_lshlrev_b32 v100, 16, v184
    v_and_b32 v101, 0xffff0000, v184
    v_lshlrev_b32 v102, 16, v185
    v_and_b32 v103, 0xffff0000, v185
    v_lshlrev_b32 v104, 16, v186
    v_and_b32 v105, 0xffff0000, v186
    v_lshlrev_b32 v106, 16, v187
    v_and_b32 v107, 0xffff0000, v187
    v_mfma_f32_32x32x16_bf16 v[156:171], v[60:63], v[108:111], v[156:171]
    v_mov_b32 v243, 0
    v_pk_add_f32 v[244:245], v[244:245], v[240:241]
    v_add_f32 v246, v246, v242
    v_cvt_pk_bf16_f32 v244, v244, v245
    v_cvt_pk_bf16_f32 v246, v246, v246
    s_mov_b32 exec_lo, s44
    s_mov_b32 exec_hi, 0
    s_cmp_eq_u32 s98, s94
    s_cbranch_scc1 K2_PF
    v_mul_u32_u24 v220, 6, v218
    s_mov_b32 s99, 6400000
    buffer_store_short v244, v220, s[24:27], s99 offen
    buffer_store_short_d16_hi v244, v220, s[24:27], s99 offen offset:2
    buffer_store_short v246, v220, s[24:27], s99 offen offset:4
    s_branch K2_PD
K2_PF:
    s_mov_b32 s99, 32768
    v_mad_u32_u24 v220, v249, 6, s99
    ds_write_b16 v220, v244
    ds_write_b16_d16_hi v220, v244 offset:2
    ds_write_b16 v220, v246 offset:4
    s_mov_b64 exec, 1
    v_mov_b32 v220, 108
    v_mov_b32 v221, 1
    ds_add_rtn_u32 v243, v220, v221
K2_PD:
    s_mov_b64 exec, -1
    s_mov_b32 s40, 0xbf317218
    s_mov_b32 s41, 0xbf317218
    v_mfma_f32_32x32x16_bf16 v[156:171], v[64:67], v[112:115], v[156:171]
    v_exp_f32 v220, v140
    v_exp_f32 v221, v141
    v_exp_f32 v222, v142
    v_exp_f32 v223, v143
    v_mfma_f32_32x32x16_bf16 v[156:171], v[68:71], v[116:119], v[156:171]
    v_exp_f32 v224, v144
    v_exp_f32 v225, v145
    v_exp_f32 v226, v146
    v_exp_f32 v227, v147
    v_pk_add_f32 v[220:221], v[220:221], 1.0 op_sel_hi:[1,0]
    v_pk_add_f32 v[222:223], v[222:223], 1.0 op_sel_hi:[1,0]
    v_mfma_f32_32x32x16_bf16 v[156:171], v[72:75], v[120:123], v[156:171]
    v_pk_add_f32 v[224:225], v[224:225], 1.0 op_sel_hi:[1,0]
    v_pk_add_f32 v[226:227], v[226:227], 1.0 op_sel_hi:[1,0]
    v_rcp_f32 v220, v220
    v_rcp_f32 v221, v221
    v_rcp_f32 v222, v222
    v_rcp_f32 v223, v223
    v_rcp_f32 v224, v224
    v_rcp_f32 v225, v225
    v_rcp_f32 v226, v226
    v_rcp_f32 v227, v227
    s_waitcnt lgkmcnt(0)
    v_add_u32 v210, v210, v211
    v_add_u32 v212, v212, v213
    v_add_u32 v214, v214, v215
    v_add_u32 v216, v216, v217
    v_pk_mul_f32 v[220:221], v[220:221], v[140:141]
    v_pk_mul_f32 v[222:223], v[222:223], v[142:143]
    v_pk_mul_f32 v[224:225], v[224:225], v[144:145]
    v_pk_mul_f32 v[226:227], v[226:227], v[146:147]
    v_pk_fma_f32 v[220:221], v[220:221], s[40:41], v[76:77]
    v_pk_fma_f32 v[222:223], v[222:223], s[40:41], v[78:79]
    v_pk_fma_f32 v[224:225], v[224:225], s[40:41], v[80:81]
    v_pk_fma_f32 v[226:227], v[226:227], s[40:41], v[82:83]
    v_cvt_pk_bf16_f32 v172, v220, v221
    v_cvt_pk_bf16_f32 v173, v222, v223
    v_cvt_pk_bf16_f32 v174, v224, v225
    v_cvt_pk_bf16_f32 v175, v226, v227
    s_waitcnt vmcnt(0)
    ds_write_b128 v251, v[172:175]
    v_exp_f32 v220, v148
    v_exp_f32 v221, v149
    v_exp_f32 v222, v150
    v_exp_f32 v223, v151
    v_exp_f32 v224, v152
    v_exp_f32 v225, v153
    v_exp_f32 v226, v154
    v_exp_f32 v227, v155
    v_pk_add_f32 v[220:221], v[220:221], 1.0 op_sel_hi:[1,0]
    v_pk_add_f32 v[222:223], v[222:223], 1.0 op_sel_hi:[1,0]
    v_pk_add_f32 v[224:225], v[224:225], 1.0 op_sel_hi:[1,0]
    v_pk_add_f32 v[226:227], v[226:227], 1.0 op_sel_hi:[1,0]
    v_rcp_f32 v220, v220
    v_rcp_f32 v221, v221
    v_rcp_f32 v222, v222
    v_rcp_f32 v223, v223
    v_rcp_f32 v224, v224
    v_rcp_f32 v225, v225
    v_rcp_f32 v226, v226
    v_rcp_f32 v227, v227
    v_pk_mul_f32 v[220:221], v[220:221], v[148:149]
    v_pk_mul_f32 v[222:223], v[222:223], v[150:151]
    v_pk_mul_f32 v[224:225], v[224:225], v[152:153]
    v_pk_mul_f32 v[226:227], v[226:227], v[154:155]
    v_pk_fma_f32 v[220:221], v[220:221], s[40:41], v[84:85]
    v_pk_fma_f32 v[222:223], v[222:223], s[40:41], v[86:87]
    v_pk_fma_f32 v[224:225], v[224:225], s[40:41], v[88:89]
    v_pk_fma_f32 v[226:227], v[226:227], s[40:41], v[90:91]
    v_cvt_pk_bf16_f32 v176, v220, v221
    v_cvt_pk_bf16_f32 v177, v222, v223
    v_cvt_pk_bf16_f32 v178, v224, v225
    v_cvt_pk_bf16_f32 v179, v226, v227
    ds_write_b128 v252, v[176:179]
    v_exp_f32 v220, v156
    v_exp_f32 v221, v157
    v_exp_f32 v222, v158
    v_exp_f32 v223, v159
    v_exp_f32 v224, v160
    v_exp_f32 v225, v161
    v_exp_f32 v226, v162
    v_exp_f32 v227, v163
    v_pk_add_f32 v[220:221], v[220:221], 1.0 op_sel_hi:[1,0]
    v_pk_add_f32 v[222:223], v[222:223], 1.0 op_sel_hi:[1,0]
    v_pk_add_f32 v[224:225], v[224:225], 1.0 op_sel_hi:[1,0]
    v_pk_add_f32 v[226:227], v[226:227], 1.0 op_sel_hi:[1,0]
    v_rcp_f32 v220, v220
    v_rcp_f32 v221, v221
    v_rcp_f32 v222, v222
    v_rcp_f32 v223, v223
    v_rcp_f32 v224, v224
    v_rcp_f32 v225, v225
    v_rcp_f32 v226, v226
    v_rcp_f32 v227, v227
    v_pk_mul_f32 v[220:221], v[220:221], v[156:157]
    v_pk_mul_f32 v[222:223], v[222:223], v[158:159]
    v_pk_mul_f32 v[224:225], v[224:225], v[160:161]
    v_pk_mul_f32 v[226:227], v[226:227], v[162:163]
    v_pk_fma_f32 v[220:221], v[220:221], s[40:41], v[92:93]
    v_pk_fma_f32 v[222:223], v[222:223], s[40:41], v[94:95]
    v_pk_fma_f32 v[224:225], v[224:225], s[40:41], v[96:97]
    v_pk_fma_f32 v[226:227], v[226:227], s[40:41], v[98:99]
    v_cvt_pk_bf16_f32 v180, v220, v221
    v_cvt_pk_bf16_f32 v181, v222, v223
    v_cvt_pk_bf16_f32 v182, v224, v225
    v_cvt_pk_bf16_f32 v183, v226, v227
    ds_write_b128 v253, v[180:183]
    v_exp_f32 v220, v164
    v_exp_f32 v221, v165
    v_exp_f32 v222, v166
    v_exp_f32 v223, v167
    v_exp_f32 v224, v168
    v_exp_f32 v225, v169
    v_exp_f32 v226, v170
    v_exp_f32 v227, v171
    v_pk_add_f32 v[220:221], v[220:221], 1.0 op_sel_hi:[1,0]
    v_pk_add_f32 v[222:223], v[222:223], 1.0 op_sel_hi:[1,0]
    v_pk_add_f32 v[224:225], v[224:225], 1.0 op_sel_hi:[1,0]
    v_pk_add_f32 v[226:227], v[226:227], 1.0 op_sel_hi:[1,0]
    v_rcp_f32 v220, v220
    v_rcp_f32 v221, v221
    v_rcp_f32 v222, v222
    v_rcp_f32 v223, v223
    v_rcp_f32 v224, v224
    v_rcp_f32 v225, v225
    v_rcp_f32 v226, v226
    v_rcp_f32 v227, v227
    v_pk_mul_f32 v[220:221], v[220:221], v[164:165]
    v_pk_mul_f32 v[222:223], v[222:223], v[166:167]
    v_pk_mul_f32 v[224:225], v[224:225], v[168:169]
    v_pk_mul_f32 v[226:227], v[226:227], v[170:171]
    v_pk_fma_f32 v[220:221], v[220:221], s[40:41], v[100:101]
    v_pk_fma_f32 v[222:223], v[222:223], s[40:41], v[102:103]
    v_pk_fma_f32 v[224:225], v[224:225], s[40:41], v[104:105]
    v_pk_fma_f32 v[226:227], v[226:227], s[40:41], v[106:107]
    v_cvt_pk_bf16_f32 v184, v220, v221
    v_cvt_pk_bf16_f32 v185, v222, v223
    v_cvt_pk_bf16_f32 v186, v224, v225
    v_cvt_pk_bf16_f32 v187, v226, v227
    ds_write_b128 v254, v[184:187]
    ds_read_b128 v[140:143], v235 offset:0
    ds_read_b128 v[144:147], v235 offset:1024
    ds_read_b128 v[148:151], v235 offset:2048
    ds_read_b128 v[152:155], v235 offset:3072
    s_waitcnt lgkmcnt(3)
    buffer_store_dwordx4 v[140:143], v210, s[24:27], 0 offen sc1
    s_waitcnt lgkmcnt(2)
    buffer_store_dwordx4 v[144:147], v212, s[24:27], 0 offen sc1
    s_waitcnt lgkmcnt(1)
    buffer_store_dwordx4 v[148:151], v214, s[24:27], 0 offen sc1
    s_waitcnt lgkmcnt(0)
    buffer_store_dwordx4 v[152:155], v216, s[24:27], 0 offen sc1
    v_readfirstlane_b32 s95, v243
    v_and_b32 v220, 63, v250
    v_lshlrev_b32 v220, 3, v220
    s_cmp_lg_u32 s95, 7
    s_cbranch_scc1 K2_PE
    ds_read_b64 v[188:189], v220 offset:32768
    ds_read_b64 v[190:191], v220 offset:33280
    ds_read_b64 v[192:193], v220 offset:33792
    s_mul_i32 s99, s4, 6
    s_add_u32 s99, s99, 6400000
    s_mul_i32 s95, s96, 6
    v_cmp_gt_i32 vcc, s95, v220
    s_sub_i32 s95, s95, 512
    s_waitcnt lgkmcnt(2)
    s_mov_b64 exec, vcc
    buffer_store_dwordx2 v[188:189], v220, s[24:27], s99 offen offset:0 sc1
    v_cmp_gt_i32 vcc, s95, v220
    s_sub_i32 s95, s95, 512
    s_waitcnt lgkmcnt(1)
    s_mov_b64 exec, vcc
    buffer_store_dwordx2 v[190:191], v220, s[24:27], s99 offen offset:512 sc1
    v_cmp_gt_i32 vcc, s95, v220
    s_sub_i32 s95, s95, 512
    s_waitcnt lgkmcnt(0)
    s_mov_b64 exec, vcc
    buffer_store_dwordx2 v[192:193], v220, s[24:27], s99 offen offset:1024 sc1
    s_mov_b64 exec, -1
K2_PE:
    s_endpgm
K2_END0:
    s_waitcnt vmcnt(0)
K2_END:
    s_endpgm
.section .rodata,"a"
.p2align 6
.amdhsa_kernel egnn_sort_kernel
  .amdhsa_next_free_vgpr 120
  .amdhsa_next_free_sgpr 48
  .amdhsa_accum_offset 120
  .amdhsa_group_segment_fixed_size 0
  .amdhsa_kernarg_size 88
  .amdhsa_user_sgpr_count 2
  .amdhsa_user_sgpr_kernarg_segment_ptr 1
  .amdhsa_system_sgpr_workgroup_id_x 1
.end_amdhsa_kernel
.p2align 6
.amdhsa_kernel egnn_main_kernel
  .amdhsa_next_free_vgpr 256
  .amdhsa_next_free_sgpr 102
  .amdhsa_accum_offset 256
  .amdhsa_group_segment_fixed_size 0
  .amdhsa_kernarg_size 88
  .amdhsa_user_sgpr_count 2
  .amdhsa_user_sgpr_kernarg_segment_ptr 1
  .amdhsa_system_sgpr_workgroup_id_x 1
.end_amdhsa_kernel
```

```asm
; @launch kernel=egnn_fused_kernel grid=(256,1,1) block=(512,1,1) lds=162816
.amdgcn_target "amdgcn-amd-amdhsa--gfx950"
.text
.globl egnn_fused_kernel
.p2align 8
.type egnn_fused_kernel,@function
egnn_fused_kernel:
    s_cmp_ge_u32 s2, 256
    s_cbranch_scc1 K2_END
    s_mov_b32 s60, s2
    s_load_dwordx2 s[38:39], s[0:1], 80
    v_lshrrev_b32 v1, 6, v0
    s_nop 0
    v_readfirstlane_b32 s3, v1
    s_cmp_ge_u32 s3, 7
    s_cbranch_scc1 KF_W7
    s_cmp_ge_u32 s2, 250
    s_cbranch_scc1 KF_B4
    s_load_dwordx4 s[4:7], s[0:1], 24
    s_load_dwordx4 s[8:11], s[0:1], 8
    s_and_b32 s28, s2, 7
    s_min_u32 s29, s28, 2
    s_mul_i32 s28, s28, 31
    s_lshr_b32 s2, s2, 3
    s_add_u32 s2, s2, s28
    s_add_u32 s2, s2, s29
    v_lshlrev_b32 v1, 2, v0
    v_lshlrev_b32 v15, 3, v0
    v_mov_b32 v2, 0
    v_mov_b32 v3, 0
    v_cmp_gt_u32 vcc, 144, v0
    s_mov_b64 exec, vcc
    ds_write_b64 v15, v[2:3] offset:0
    s_mov_b64 exec, -1
    v_mov_b32 v3, 1
    s_mul_i32 s28, s2, 12800
    s_mul_i32 s29, s2, 200
    s_mul_i32 s30, s2, 3200
    s_mov_b32 s31, 85599
    s_movk_i32 s32, -196
    v_add_u32 v12, s29, v0
    v_mul_u32_u24 v13, 6, v12
    v_lshlrev_b32 v14, 4, v0
    v_mov_b32 v15, 400
    v_cmp_gt_u32 s[34:35], v15, v0
    v_mov_b32 v15, 200
    v_cmp_gt_u32 s[36:37], v15, v0
    s_waitcnt lgkmcnt(0)
    s_mov_b32 s12, s4
    s_and_b32 s13, s5, 0xffff
    s_mov_b32 s14, 3200000
    s_mov_b32 s15, 0x20000
    s_mov_b32 s16, s6
    s_and_b32 s17, s7, 0xffff
    s_mov_b32 s18, 3200000
    s_mov_b32 s19, 0x20000
    s_mov_b32 s20, s8
    s_and_b32 s21, s9, 0xffff
    s_mov_b32 s22, 300000
    s_mov_b32 s23, 0x20000
    s_mov_b32 s24, s38
    s_and_b32 s25, s39, 0xffff
    s_mov_b32 s26, 25600000
    s_mov_b32 s27, 0x20000
    s_cmp_ge_u32 s3, 4
    s_cbranch_scc1 K1_NOPOS
    s_mov_b64 exec, s[36:37]
    buffer_load_ushort v16, v13, s[20:23], 0 offen
    buffer_load_ushort v17, v13, s[20:23], 0 offen offset:2
    buffer_load_ushort v18, v13, s[20:23], 0 offen offset:4
K1_NOPOS:
    s_mov_b64 exec, s[34:35]
    s_mov_b32 s42, s28
    buffer_load_dwordx4 v[60:63], v14, s[16:19], s42 offen nt
    s_add_u32 s42, s42, 6400
    buffer_load_dwordx4 v[64:67], v14, s[16:19], s42 offen nt
    v_add_u32 v76, s30, v1
    v_add_u32 v78, 1, v76
    v_add_u32 v80, 2, v76
    v_add_u32 v82, 3, v76
    v_add_u32 v84, 1600, v76
    v_add_u32 v86, 1601, v76
    v_add_u32 v88, 1602, v76
    v_add_u32 v90, 1603, v76
    s_barrier
    s_waitcnt vmcnt(0)
    s_mov_b32 s42, s28
    buffer_load_dwordx4 v[68:71], v14, s[12:15], s42 offen nt
    s_add_u32 s42, s42, 6400
    buffer_load_dwordx4 v[72:75], v14, s[12:15], s42 offen nt
    v_mul_u32_u24 v92, s31, v60
    v_lshrrev_b32 v92, 24, v92
    v_mad_i32_i24 v60, v92, s32, v60
    v_lshlrev_b32 v92, 2, v92
    ds_add_rtn_u32 v100, v92, v3 offset:0
    v_lshrrev_b32 v108, 7, v92
    v_mul_u32_u24 v93, s31, v61
    v_lshrrev_b32 v93, 24, v93
    v_mad_i32_i24 v61, v93, s32, v61
    v_lshlrev_b32 v93, 2, v93
    ds_add_rtn_u32 v101, v93, v3 offset:0
    v_lshrrev_b32 v109, 7, v93
    v_mul_u32_u24 v94, s31, v62
    v_lshrrev_b32 v94, 24, v94
    v_mad_i32_i24 v62, v94, s32, v62
    v_lshlrev_b32 v94, 2, v94
    ds_add_rtn_u32 v102, v94, v3 offset:0
    v_lshrrev_b32 v110, 7, v94
    v_mul_u32_u24 v95, s31, v63
    v_lshrrev_b32 v95, 24, v95
    v_mad_i32_i24 v63, v95, s32, v63
    v_lshlrev_b32 v95, 2, v95
    ds_add_rtn_u32 v103, v95, v3 offset:0
    v_lshrrev_b32 v111, 7, v95
    v_mul_u32_u24 v96, s31, v64
    v_lshrrev_b32 v96, 24, v96
    v_mad_i32_i24 v64, v96, s32, v64
    v_lshlrev_b32 v96, 2, v96
    ds_add_rtn_u32 v104, v96, v3 offset:0
    v_lshrrev_b32 v112, 7, v96
    v_mul_u32_u24 v97, s31, v65
    v_lshrrev_b32 v97, 24, v97
    v_mad_i32_i24 v65, v97, s32, v65
    v_lshlrev_b32 v97, 2, v97
    ds_add_rtn_u32 v105, v97, v3 offset:0
    v_lshrrev_b32 v113, 7, v97
    v_mul_u32_u24 v98, s31, v66
    v_lshrrev_b32 v98, 24, v98
    v_mad_i32_i24 v66, v98, s32, v66
    v_lshlrev_b32 v98, 2, v98
    ds_add_rtn_u32 v106, v98, v3 offset:0
    v_lshrrev_b32 v114, 7, v98
    v_mul_u32_u24 v99, s31, v67
    v_lshrrev_b32 v99, 24, v99
    v_mad_i32_i24 v67, v99, s32, v67
    v_lshlrev_b32 v99, 2, v99
    ds_add_rtn_u32 v107, v99, v3 offset:0
    v_lshrrev_b32 v115, 7, v99
    s_cmp_ge_u32 s3, 4
    s_cbranch_scc1 K1_P3
    s_mov_b64 exec, s[36:37]
    v_lshl_or_b32 v16, v17, 16, v16
    v_lshlrev_b32 v17, 16, v18
    v_lshlrev_b32 v12, 3, v12
    s_mov_b32 s33, 6684672
    buffer_store_dwordx2 v[16:17], v12, s[24:27], s33 offen sc1
K1_P3:
    s_mov_b64 exec, -1
    v_and_b32 v2, 63, v0
    v_lshlrev_b32 v2, 4, v2
    s_waitcnt lgkmcnt(0)
    s_barrier
    ds_read_b128 v[36:39], v2 offset:0
    s_waitcnt lgkmcnt(0)
    v_add_u32 v42, v36, v37
    v_add_u32 v43, v42, v38
    v_add_u32 v44, v43, v39
    v_mov_b32 v45, v44
    s_nop 1
    v_add_u32_dpp v45, v45, v45 row_shr:1 row_mask:0xf bank_mask:0xf
    s_nop 1
    v_add_u32_dpp v45, v45, v45 row_shr:2 row_mask:0xf bank_mask:0xf
    s_nop 1
    v_add_u32_dpp v45, v45, v45 row_shr:4 row_mask:0xf bank_mask:0xf
    s_nop 1
    v_add_u32_dpp v45, v45, v45 row_shr:8 row_mask:0xf bank_mask:0xf
    s_nop 1
    v_add_u32_dpp v45, v45, v45 row_bcast:15 row_mask:0xa bank_mask:0xf
    s_nop 1
    v_add_u32_dpp v45, v45, v45 row_bcast:31 row_mask:0xc bank_mask:0xf
    v_sub_u32 v40, v45, v44
    v_add_u32 v41, v40, v36
    v_add_u32 v42, v40, v42
    v_add_u32 v43, v40, v43
    v_lshlrev_b32 v48, 3, v40
    v_lshlrev_b32 v49, 3, v41
    v_lshlrev_b32 v50, 3, v42
    v_lshlrev_b32 v51, 3, v43
    ds_write_b128 v2, v[48:51] offset:1280
    s_mov_b64 exec, s[34:35]
    ds_read_b32 v92, v92 offset:1280
    ds_read_b32 v93, v93 offset:1280
    ds_read_b32 v94, v94 offset:1280
    ds_read_b32 v95, v95 offset:1280
    ds_read_b32 v96, v96 offset:1280
    ds_read_b32 v97, v97 offset:1280
    ds_read_b32 v98, v98 offset:1280
    ds_read_b32 v99, v99 offset:1280
    s_cmp_ge_u32 s3, 4
    s_cbranch_scc1 K1_SW0
    s_waitcnt vmcnt(1)
    s_branch K1_SW1
K1_SW0:
    s_waitcnt vmcnt(0)
K1_SW1:
    v_mul_u32_u24 v77, 2675, v68
    v_lshrrev_b32 v77, 24, v77
    v_sub_u32 v77, v77, v108
    v_and_b32 v77, 7, v77
    v_lshl_or_b32 v60, v60, 3, v77
    v_lshl_or_b32 v77, v60, 18, v68
    v_mul_u32_u24 v79, 2675, v69
    v_lshrrev_b32 v79, 24, v79
    v_sub_u32 v79, v79, v109
    v_and_b32 v79, 7, v79
    v_lshl_or_b32 v61, v61, 3, v79
    v_lshl_or_b32 v79, v61, 18, v69
    v_mul_u32_u24 v81, 2675, v70
    v_lshrrev_b32 v81, 24, v81
    v_sub_u32 v81, v81, v110
    v_and_b32 v81, 7, v81
    v_lshl_or_b32 v62, v62, 3, v81
    v_lshl_or_b32 v81, v62, 18, v70
    v_mul_u32_u24 v83, 2675, v71
    v_lshrrev_b32 v83, 24, v83
    v_sub_u32 v83, v83, v111
    v_and_b32 v83, 7, v83
    v_lshl_or_b32 v63, v63, 3, v83
    v_lshl_or_b32 v83, v63, 18, v71
    v_mul_u32_u24 v85, 2675, v72
    v_lshrrev_b32 v85, 24, v85
    v_sub_u32 v85, v85, v112
    v_and_b32 v85, 7, v85
    v_lshl_or_b32 v64, v64, 3, v85
    v_lshl_or_b32 v85, v64, 18, v72
    v_mul_u32_u24 v87, 2675, v73
    v_lshrrev_b32 v87, 24, v87
    v_sub_u32 v87, v87, v113
    v_and_b32 v87, 7, v87
    v_lshl_or_b32 v65, v65, 3, v87
    v_lshl_or_b32 v87, v65, 18, v73
    v_mul_u32_u24 v89, 2675, v74
    v_lshrrev_b32 v89, 24, v89
    v_sub_u32 v89, v89, v114
    v_and_b32 v89, 7, v89
    v_lshl_or_b32 v66, v66, 3, v89
    v_lshl_or_b32 v89, v66, 18, v74
    v_mul_u32_u24 v91, 2675, v75
    v_lshrrev_b32 v91, 24, v91
    v_sub_u32 v91, v91, v115
    v_and_b32 v91, 7, v91
    v_lshl_or_b32 v67, v67, 3, v91
    v_lshl_or_b32 v91, v67, 18, v75
    s_waitcnt lgkmcnt(7)
    v_lshl_add_u32 v92, v100, 3, v92
    ds_write_b64 v92, v[76:77] offset:2304
    s_waitcnt lgkmcnt(7)
    v_lshl_add_u32 v93, v101, 3, v93
    ds_write_b64 v93, v[78:79] offset:2304
    s_waitcnt lgkmcnt(7)
    v_lshl_add_u32 v94, v102, 3, v94
    ds_write_b64 v94, v[80:81] offset:2304
    s_waitcnt lgkmcnt(7)
    v_lshl_add_u32 v95, v103, 3, v95
    ds_write_b64 v95, v[82:83] offset:2304
    s_waitcnt lgkmcnt(7)
    v_lshl_add_u32 v96, v104, 3, v96
    ds_write_b64 v96, v[84:85] offset:2304
    s_waitcnt lgkmcnt(7)
    v_lshl_add_u32 v97, v105, 3, v97
    ds_write_b64 v97, v[86:87] offset:2304
    s_waitcnt lgkmcnt(7)
    v_lshl_add_u32 v98, v106, 3, v98
    ds_write_b64 v98, v[88:89] offset:2304
    s_waitcnt lgkmcnt(7)
    v_lshl_add_u32 v99, v107, 3, v99
    ds_write_b64 v99, v[90:91] offset:2304
    s_mul_i32 s33, s2, 25600
    s_waitcnt lgkmcnt(0)
    s_barrier
    ds_read_b128 v[60:63], v14 offset:2304
    ds_read_b128 v[64:67], v14 offset:8704
    ds_read_b128 v[68:71], v14 offset:15104
    ds_read_b128 v[72:75], v14 offset:21504
    s_waitcnt lgkmcnt(3)
    buffer_store_dwordx4 v[60:63], v14, s[24:27], s33 offen sc1
    s_add_u32 s33, s33, 6400
    s_waitcnt lgkmcnt(2)
    buffer_store_dwordx4 v[64:67], v14, s[24:27], s33 offen sc1
    s_add_u32 s33, s33, 6400
    s_waitcnt lgkmcnt(1)
    buffer_store_dwordx4 v[68:71], v14, s[24:27], s33 offen sc1
    s_add_u32 s33, s33, 6400
    s_waitcnt lgkmcnt(0)
    buffer_store_dwordx4 v[72:75], v14, s[24:27], s33 offen sc1
    s_mov_b64 exec, -1
    s_waitcnt vmcnt(0)
    s_barrier
    v_mov_b32 v2, 0
    ds_read_b64 v[196:197], v2 offset:1152
    s_cmp_lg_u32 s3, 6
    s_waitcnt lgkmcnt(0)
    s_cbranch_scc1 K2_ENTRY
    v_and_b32 v2, 63, v0
    v_lshlrev_b32 v2, 4, v2
    v_add_u32 v44, v43, v39
    v_lshl_or_b32 v40, v41, 16, v40
    v_lshl_or_b32 v41, v43, 16, v42
    v_lshl_or_b32 v42, v197, 16, v44
    v_mov_b32 v43, v196
    s_lshl_b32 s33, s2, 10
    s_add_u32 s33, s33, 6422528
    buffer_store_dwordx4 v[40:43], v2, s[24:27], s33 offen sc1
    s_branch K2_ENTRY
KF_B4:
    s_barrier
    v_mov_b32 v2, 0
    ds_read_b64 v[196:197], v2 offset:1152
    s_waitcnt lgkmcnt(0)
    s_branch K2_ENTRY
KF_W7:
    s_load_dwordx2 s[56:57], s[0:1], 72
    s_waitcnt lgkmcnt(0)
    s_mov_b32 s48, s56
    s_and_b32 s49, s57, 0xffff
    s_mov_b32 s50, 256
    s_mov_b32 s51, 0x20000
    v_mov_b32 v22, 0
    s_cmp_lg_u32 s2, 0
    s_cbranch_scc1 KF_NN
    s_memrealtime s[52:53]
    s_waitcnt lgkmcnt(0)
    s_or_b32 s52, s52, 1
    s_and_b32 s53, s53, 0xffff
    v_mov_b32 v20, s52
    v_mov_b32 v21, s53
    s_mov_b64 exec, 1
    buffer_store_dwordx2 v[20:21], v22, s[48:51], 0 offen sc1
    s_mov_b64 exec, -1
KF_NN:
    s_cmp_ge_u32 s2, 250
    s_cbranch_scc1 KF_NP
    s_barrier
    s_branch K1_FRAG
KF_FJ:
    s_barrier
    s_barrier
KF_NP:
    s_mov_b32 s54, 0x40000
    s_mov_b64 exec, 1
KF_NL:
    buffer_load_dwordx2 v[20:21], v22, s[48:51], 0 offen sc1
    s_waitcnt vmcnt(0)
    v_readfirstlane_b32 s52, v20
    s_cmp_lg_u32 s52, 0
    s_cbranch_scc1 KF_NX
    s_sub_u32 s54, s54, 1
    s_cbranch_scc0 KF_NL
KF_NX:
    ds_write_b64 v22, v[20:21] offset:1152
    s_mov_b64 exec, -1
    s_waitcnt vmcnt(0) lgkmcnt(0)
    s_branch KF_B4
K1_FRAG:
    s_cmp_ge_u32 s2, 144
    s_cbranch_scc1 K1_END
    s_load_dwordx4 s[4:7], s[0:1], 40
    s_load_dwordx2 s[8:9], s[0:1], 56
    s_lshr_b32 s28, s2, 2
    s_and_b32 s3, s2, 3
    s_lshl_b32 s3, s3, 6
    v_and_b32 v1, 63, v0
    v_add_u32 v1, s3, v1
    v_lshlrev_b32 v10, 2, v1
    s_lshl_b32 s33, s28, 10
    s_add_u32 s33, s33, 7536640
    s_mov_b32 s34, 0xbfb8aa3b
    s_waitcnt lgkmcnt(0)
    s_mov_b32 s12, s4
    s_and_b32 s13, s5, 0xffff
    s_mov_b32 s14, 18560
    s_mov_b32 s15, 0x20000
    s_mov_b32 s16, s6
    s_and_b32 s17, s7, 0xffff
    s_mov_b32 s18, 128
    s_mov_b32 s19, 0x20000
    s_mov_b32 s20, s8
    s_and_b32 s21, s9, 0xffff
    s_mov_b32 s22, 16384
    s_mov_b32 s23, 0x20000
    s_mov_b32 s24, s38
    s_and_b32 s25, s39, 0xffff
    s_mov_b32 s26, 25427968
    s_mov_b32 s27, 0x20000
    s_cmp_eq_u32 s28, 19
    s_cbranch_scc1 K1_WX
    s_cmp_eq_u32 s28, 18
    s_cbranch_scc1 K1_W3
    v_lshrrev_b32 v2, 2, v1
    v_and_b32 v3, 4, v2
    v_lshlrev_b32 v3, 3, v3
    v_bfe_u32 v4, v2, 3, 2
    v_lshl_add_u32 v3, v4, 2, v3
    v_and_b32 v4, 3, v2
    v_add_u32 v3, v3, v4
    v_lshrrev_b32 v5, 7, v1
    v_and_b32 v6, 3, v1
    s_mov_b32 s35, 32
    s_cmp_ge_u32 s28, 18
    s_cbranch_scc1 K1_FH
    s_cmp_ge_u32 s28, 16
    s_cbranch_scc1 K1_F4
    s_mov_b32 s36, s28
    s_branch K1_FC
K1_FH:
    s_sub_u32 s36, s28, 20
    s_mov_b32 s12, s20
    s_mov_b32 s13, s21
    s_mov_b32 s14, s22
    s_cmp_ge_u32 s36, 8
    s_cselect_b32 s34, 1.0, s34
K1_FC:
    s_lshr_b32 s37, s36, 3
    s_lshl_b32 s37, s37, 6
    s_and_b32 s38, s36, 3
    s_lshl_b32 s38, s38, 3
    s_add_u32 s37, s37, s38
    s_bfe_u32 s38, s36, 0x10002
    s_branch K1_FD
K1_F4:
    s_mov_b32 s35, 8
    s_movk_i32 s37, 129
    s_sub_u32 s38, s28, 16
K1_FD:
    s_lshl_b32 s38, s38, 4
    v_mul_u32_u24 v5, s35, v5
    v_lshl_add_u32 v5, v6, 1, v5
    v_add_u32 v5, s37, v5
    v_add_u32 v3, s38, v3
    v_lshlrev_b32 v3, 1, v3
    v_lshl_add_u32 v3, v5, 7, v3
    buffer_load_ushort v7, v3, s[12:15], 0 offen
    buffer_load_ushort v8, v3, s[12:15], 0 offen offset:128
    s_waitcnt vmcnt(0)
    v_lshlrev_b32 v7, 16, v7
    v_lshlrev_b32 v8, 16, v8
    v_mul_f32 v7, s34, v7
    v_mul_f32 v8, s34, v8
    v_cvt_pk_bf16_f32 v7, v7, v8
    buffer_store_dword v7, v10, s[24:27], s33 offen sc1
    s_branch KF_FJ
K1_W3:
    v_and_b32 v2, 31, v1
    v_and_b32 v3, 4, v2
    v_lshlrev_b32 v3, 3, v3
    v_bfe_u32 v4, v2, 3, 2
    v_lshl_add_u32 v3, v4, 2, v3
    v_and_b32 v4, 3, v2
    v_add_u32 v3, v3, v4
    v_bfe_u32 v5, v1, 6, 1
    v_lshl_add_u32 v3, v5, 4, v3
    v_lshlrev_b32 v3, 1, v3
    s_movk_i32 s35, 16384
    buffer_load_ushort v7, v3, s[12:15], s35 offen
    v_and_b32 v6, 32, v1
    v_cmp_eq_u32 vcc, 0, v6
    s_waitcnt vmcnt(0)
    v_lshlrev_b32 v7, 16, v7
    v_mul_f32 v7, s34, v7
    v_cvt_pk_bf16_f32 v8, v7, v7
    v_lshlrev_b32 v8, 16, v8
    v_sub_f32 v9, v7, v8
    v_cvt_pk_bf16_f32 v7, v8, v9
    v_cndmask_b32 v7, 0, v7, vcc
    buffer_store_dword v7, v10, s[24:27], s33 offen sc1
    s_branch KF_FJ
K1_WX:
    v_lshlrev_b32 v3, 1, v1
    buffer_load_ushort v7, v3, s[16:19], 0 offen
    s_waitcnt vmcnt(0)
    v_lshlrev_b32 v7, 16, v7
    v_mul_f32 v7, 0xbf317218, v7
    buffer_store_dword v7, v10, s[24:27], s33 offen sc1
K1_END:
    s_branch KF_FJ
K2_ENTRY:
    s_mov_b32 s2, s60
    s_load_dwordx2 s[28:29], s[0:1], 0
    s_load_dwordx2 s[30:31], s[0:1], 16
    s_load_dwordx2 s[32:33], s[0:1], 64
    s_load_dwordx2 s[34:35], s[0:1], 80
    v_mov_b32 v250, v0
    v_lshrrev_b32 v220, 6, v0
    s_and_b32 s3, s2, 7
    s_lshl_b32 s3, s3, 5
    v_readfirstlane_b32 s5, v220
    s_lshr_b32 s95, s2, 3
    s_add_u32 s3, s3, s95
    s_mul_i32 s4, s3, 196
    s_sub_u32 s96, 50000, s4
    s_min_u32 s96, s96, 196
    s_mov_b32 s7, 0
    s_mov_b32 s92, 48
    s_sub_u32 s100, 11, s5
    s_cmp_lt_u32 s5, 4
    s_cselect_b32 s100, s5, s100
    s_lshl_b32 s94, s100, 12
    s_add_u32 s94, s94, 34816
    s_waitcnt lgkmcnt(0)
    s_add_u32 s88, s34, 6422528
    s_addc_u32 s89, s35, 0
    s_and_b32 s89, s89, 0xffff
    s_mov_b32 s90, 262144
    s_mov_b32 s91, 0x20000
    s_mov_b32 s8, s28
    s_and_b32 s9, s29, 0xffff
    s_or_b32 s9, s9, 8388608
    s_mov_b32 s10, 50000
    s_mov_b32 s11, 0x20000
    s_mov_b32 s12, s30
    s_and_b32 s13, s31, 0xffff
    s_or_b32 s13, s13, 2097152
    s_mov_b32 s14, 800000
    s_mov_b32 s15, 0x20000
    s_add_u32 s16, s34, 6684672
    s_addc_u32 s17, s35, 0
    s_and_b32 s17, s17, 0xffff
    s_or_b32 s17, s17, 524288
    s_mov_b32 s18, 50000
    s_mov_b32 s19, 0x20000
    s_mov_b32 s20, s34
    s_and_b32 s21, s35, 0xffff
    s_mov_b32 s22, 25427968
    s_mov_b32 s23, 0x20000
    s_mov_b32 s24, s32
    s_and_b32 s25, s33, 0xffff
    s_mov_b32 s26, 6700000
    s_mov_b32 s27, 0x20000
K2_TOP:
    v_bfe_u32 v220, v250, 4, 2
    s_mul_i32 s95, s5, 36
    s_sub_u32 s95, s95, 36
    v_mad_u32_u24 v220, v220, 9, s95
    v_lshlrev_b32 v221, 4, v220
    s_and_b32 s95, s3, 3
    s_mul_i32 s95, s95, 1020
    s_lshl_b32 s99, s3, 10
    s_sub_u32 s95, s99, s95
    v_and_b32 v102, 63, v250
    s_mul_i32 s99, s5, 36
    s_sub_u32 s99, s99, 36
    v_cmp_gt_u32_e64 s[44:45], 36, v102
    v_add_u32 v102, s99, v102
    v_mov_b32 v103, 250
    v_cmp_gt_u32_e64 s[46:47], v103, v102
    s_lshr_b32 s99, s3, 2
    s_lshl_b32 s99, s99, 4
    v_lshl_add_u32 v102, v102, 10, s99
    s_and_b64 s[44:45], s[44:45], s[46:47]
    v_cndmask_b32_e64 v102, 2.0, v102, s[44:45]
    s_cmp_eq_u32 s5, 0
    s_cbranch_scc1 K2_NOOF
    buffer_load_dwordx4 v[98:101], v102, s[88:91], 0 offen sc1
K2_NOOF:
    v_and_b32 v222, 63, v250
    v_lshlrev_b32 v203, 4, v222
    v_lshrrev_b32 v239, 3, v222
    v_lshrrev_b32 v223, 4, v222
    v_xor_b32 v223, v223, v222
    v_and_b32 v223, 7, v223
    v_lshlrev_b32 v211, 4, v223
    v_xor_b32 v213, 64, v211
    v_mov_b32 v215, v211
    v_mov_b32 v217, v213
    s_lshl_b32 s95, s5, 5
    s_add_u32 s95, s95, s4
    v_add_u32 v210, s95, v239
    v_add_u32 v212, 8, v210
    v_add_u32 v214, 16, v210
    v_add_u32 v216, 24, v210
    s_add_u32 s99, s4, s96
    v_cmp_gt_u32 vcc, s99, v210
    s_nop 1
    v_cndmask_b32 v210, -1, v210, vcc
    v_cmp_gt_u32 vcc, s99, v212
    s_nop 1
    v_cndmask_b32 v212, -1, v212, vcc
    v_cmp_gt_u32 vcc, s99, v214
    s_nop 1
    v_cndmask_b32 v214, -1, v214, vcc
    v_cmp_gt_u32 vcc, s99, v216
    s_nop 1
    v_cndmask_b32 v216, -1, v216, vcc
    s_lshl_b32 s101, s5, 12
    s_add_u32 s101, s101, 100352
    s_barrier
    v_mov_b32 v228, 0
    v_mov_b32 v229, 0
    v_mov_b32 v230, 0
    v_mov_b32 v231, 0
    s_lshl_b32 s95, s5, 10
    s_cmp_ge_u32 s5, 4
    s_cselect_b32 s99, 30720, 0
    s_add_u32 s95, s95, s99
    v_add_u32 v223, s95, v203
    ds_write_b128 v223, v[228:231]
    ds_write_b128 v223, v[228:231] offset:4096
    v_and_b32 v223, 2047, v223
    ds_write_b128 v223, v[228:231] offset:43008
    v_lshlrev_b32 v239, 2, v239
    v_mov_b32 v41, 0
    v_mov_b32 v43, 0
    v_mov_b32 v209, 0
    v_lshrrev_b32 v219, 5, v222
    v_lshlrev_b32 v219, 4, v219
    v_and_b32 v223, 31, v222
    v_bfe_u32 v251, v222, 1, 3
    v_lshlrev_b32 v251, 4, v251
    v_lshlrev_b32 v252, 2, v219
    v_xor_b32 v251, v251, v252
    v_lshl_add_u32 v251, v223, 7, v251
    v_add_u32 v251, s94, v251
    v_xor_b32 v252, 16, v251
    v_xor_b32 v253, 32, v251
    v_xor_b32 v254, 48, v251
    v_and_b32 v222, 15, v250
    v_cmp_gt_u32 vcc, 243, v220
    v_mul_u32_u24 v220, 3200, v220
    v_add3_u32 v220, v220, v222, s7
    v_add_u32 v221, 16, v222
    v_add_u32 v223, 32, v222
    v_cmp_gt_u32_e64 s[32:33], s92, v221
    v_cmp_gt_u32_e64 s[34:35], s92, v222
    s_nop 0
    v_cndmask_b32_e64 v221, 2.0, v221, s[32:33]
    v_cndmask_b32_e64 v223, 2.0, v223, s[32:33]
    v_cndmask_b32_e64 v222, 2.0, v222, s[34:35]
    s_cmp_eq_u32 s5, 0
    s_cbranch_scc1 KF_PD
    s_cmp_eq_u32 s92, 48
    s_cselect_b32 s50, 1, 0
    s_cmp_eq_u32 s7, 0
    s_cselect_b32 s50, s50, 0
    s_cmp_eq_u32 s50, 1
    s_cselect_b64 s[52:53], s[44:45], 0
    s_mov_b32 s50, 0x40000
KF_PL:
    s_waitcnt vmcnt(0)
    v_lshrrev_b32 v104, 16, v100
    v_cmp_eq_u32_e64 s[46:47], v101, v196
    v_cmp_eq_u32_e64 s[48:49], v104, v197
    s_and_b64 s[46:47], s[46:47], s[48:49]
    s_andn2_b64 s[46:47], s[52:53], s[46:47]
    s_cbranch_scc0 KF_OK
    s_sub_u32 s50, s50, 1
    s_cbranch_scc1 KF_OK
    buffer_load_dwordx4 v[98:101], v102, s[88:91], 0 offen sc1
    s_branch KF_PL
KF_OK:
    s_and_b32 s50, s3, 3
    s_cmp_lt_u32 s50, 2
    s_cselect_b64 s[46:47], -1, 0
    s_and_b32 s50, s50, 1
    s_lshl_b32 s50, s50, 4
    v_cndmask_b32_e64 v104, v99, v98, s[46:47]
    v_cndmask_b32_e64 v105, v100, v99, s[46:47]
    v_alignbit_b32 v104, v105, v104, s50
    v_lshlrev_b32 v105, 16, v104
    v_sub_u32 v104, v104, v105
    v_cndmask_b32_e64 v104, 0, v104, s[44:45]
    v_bfe_u32 v105, v250, 4, 2
    v_mul_u32_u24 v105, 36, v105
    ds_bpermute_b32 v172, v105, v104 offset:0
    ds_bpermute_b32 v173, v105, v104 offset:4
    ds_bpermute_b32 v174, v105, v104 offset:8
    ds_bpermute_b32 v175, v105, v104 offset:12
    ds_bpermute_b32 v176, v105, v104 offset:16
    ds_bpermute_b32 v177, v105, v104 offset:20
    ds_bpermute_b32 v178, v105, v104 offset:24
    ds_bpermute_b32 v179, v105, v104 offset:28
    ds_bpermute_b32 v180, v105, v104 offset:32
    s_waitcnt lgkmcnt(0)
KF_PD:
    s_cmp_eq_u32 s5, 0
    s_cbranch_scc0 K2_MK
    s_branch K2_NOREC
K2_MK:
    v_cndmask_b32 v179, 0, v179, vcc
    v_cndmask_b32 v180, 0, v180, vcc
    v_and_b32 v98, 0xffff, v172
    v_lshrrev_b32 v172, 16, v172
    v_subrev_u32 v172, s7, v172
    v_cmp_gt_i32_e64 s[32:33], v172, v222
    v_add_lshl_u32 v98, v98, v220, 3
    s_mov_b32 s95, 0
    v_cndmask_b32_e64 v98, 2.0, v98, s[32:33]
    buffer_load_dwordx2 v[44:45], v98, s[20:23], s95 offen sc1
    v_and_b32 v99, 0xffff, v173
    v_lshrrev_b32 v173, 16, v173
    v_subrev_u32 v173, s7, v173
    v_cmp_gt_i32_e64 s[34:35], v173, v222
    v_add_lshl_u32 v99, v99, v220, 3
    s_mov_b32 s95, 25600
    v_cndmask_b32_e64 v99, 2.0, v99, s[34:35]
    buffer_load_dwordx2 v[46:47], v99, s[20:23], s95 offen sc1
    v_and_b32 v100, 0xffff, v174
    v_lshrrev_b32 v174, 16, v174
    v_subrev_u32 v174, s7, v174
    v_cmp_gt_i32_e64 s[36:37], v174, v222
    v_add_lshl_u32 v100, v100, v220, 3
    s_mov_b32 s95, 51200
    v_cndmask_b32_e64 v100, 2.0, v100, s[36:37]
    buffer_load_dwordx2 v[48:49], v100, s[20:23], s95 offen sc1
    v_and_b32 v101, 0xffff, v175
    v_lshrrev_b32 v175, 16, v175
    v_subrev_u32 v175, s7, v175
    v_cmp_gt_i32_e64 s[38:39], v175, v222
    v_add_lshl_u32 v101, v101, v220, 3
    s_mov_b32 s95, 76800
    v_cndmask_b32_e64 v101, 2.0, v101, s[38:39]
    buffer_load_dwordx2 v[50:51], v101, s[20:23], s95 offen sc1
    v_and_b32 v102, 0xffff, v176
    v_lshrrev_b32 v176, 16, v176
    v_subrev_u32 v176, s7, v176
    v_cmp_gt_i32_e64 s[40:41], v176, v222
    v_add_lshl_u32 v102, v102, v220, 3
    s_mov_b32 s95, 102400
    v_cndmask_b32_e64 v102, 2.0, v102, s[40:41]
    buffer_load_dwordx2 v[52:53], v102, s[20:23], s95 offen sc1
    v_and_b32 v103, 0xffff, v177
    v_lshrrev_b32 v177, 16, v177
    v_subrev_u32 v177, s7, v177
    v_cmp_gt_i32_e64 s[42:43], v177, v222
    v_add_lshl_u32 v103, v103, v220, 3
    s_mov_b32 s95, 128000
    v_cndmask_b32_e64 v103, 2.0, v103, s[42:43]
    buffer_load_dwordx2 v[54:55], v103, s[20:23], s95 offen sc1
    v_and_b32 v104, 0xffff, v178
    v_lshrrev_b32 v178, 16, v178
    v_subrev_u32 v178, s7, v178
    v_cmp_gt_i32_e64 s[44:45], v178, v222
    v_add_lshl_u32 v104, v104, v220, 3
    s_mov_b32 s95, 153600
    v_cndmask_b32_e64 v104, 2.0, v104, s[44:45]
    buffer_load_dwordx2 v[56:57], v104, s[20:23], s95 offen sc1
    v_and_b32 v105, 0xffff, v179
    v_lshrrev_b32 v179, 16, v179
    v_subrev_u32 v179, s7, v179
    v_cmp_gt_i32_e64 s[46:47], v179, v222
    v_add_lshl_u32 v105, v105, v220, 3
    s_mov_b32 s95, 179200
    v_cndmask_b32_e64 v105, 2.0, v105, s[46:47]
    buffer_load_dwordx2 v[58:59], v105, s[20:23], s95 offen sc1
    v_and_b32 v106, 0xffff, v180
    v_lshrrev_b32 v180, 16, v180
    v_subrev_u32 v180, s7, v180
    v_cmp_gt_i32_e64 s[48:49], v180, v222
    v_add_lshl_u32 v106, v106, v220, 3
    s_mov_b32 s95, 204800
    v_cndmask_b32_e64 v106, 2.0, v106, s[48:49]
    buffer_load_dwordx2 v[60:61], v106, s[20:23], s95 offen sc1
    v_cmp_gt_i32_e64 s[50:51], v172, v221
    v_cmp_gt_i32_e64 s[68:69], v172, v223
    v_cmp_gt_i32_e64 s[52:53], v173, v221
    v_cmp_gt_i32_e64 s[70:71], v173, v223
    v_cmp_gt_i32_e64 s[54:55], v174, v221
    v_cmp_gt_i32_e64 s[72:73], v174, v223
    v_cmp_gt_i32_e64 s[56:57], v175, v221
    v_cmp_gt_i32_e64 s[74:75], v175, v223
    v_cmp_gt_i32_e64 s[58:59], v176, v221
    v_cmp_gt_i32_e64 s[76:77], v176, v223
    v_cmp_gt_i32_e64 s[60:61], v177, v221
    v_cmp_gt_i32_e64 s[78:79], v177, v223
    v_cmp_gt_i32_e64 s[62:63], v178, v221
    v_cmp_gt_i32_e64 s[80:81], v178, v223
    v_cmp_gt_i32_e64 s[64:65], v179, v221
    v_cmp_gt_i32_e64 s[82:83], v179, v223
    v_cmp_gt_i32_e64 s[66:67], v180, v221
    v_cmp_gt_i32_e64 s[84:85], v180, v223
    s_mov_b32 s95, 0
    s_mov_b64 exec, s[50:51]
    s_cbranch_execz K2_G1
    buffer_load_dwordx2 v[62:63], v98, s[20:23], s95 offen offset:128 sc1
K2_G1:
    s_mov_b32 s95, 25600
    s_mov_b64 exec, s[52:53]
    s_cbranch_execz K2_G2
    buffer_load_dwordx2 v[64:65], v99, s[20:23], s95 offen offset:128 sc1
K2_G2:
    s_mov_b32 s95, 51200
    s_mov_b64 exec, s[54:55]
    s_cbranch_execz K2_G3
    buffer_load_dwordx2 v[66:67], v100, s[20:23], s95 offen offset:128 sc1
K2_G3:
    s_mov_b32 s95, 76800
    s_mov_b64 exec, s[56:57]
    s_cbranch_execz K2_G4
    buffer_load_dwordx2 v[68:69], v101, s[20:23], s95 offen offset:128 sc1
K2_G4:
    s_mov_b32 s95, 102400
    s_mov_b64 exec, s[58:59]
    s_cbranch_execz K2_G5
    buffer_load_dwordx2 v[70:71], v102, s[20:23], s95 offen offset:128 sc1
K2_G5:
    s_mov_b32 s95, 128000
    s_mov_b64 exec, s[60:61]
    s_cbranch_execz K2_G6
    buffer_load_dwordx2 v[72:73], v103, s[20:23], s95 offen offset:128 sc1
K2_G6:
    s_mov_b32 s95, 153600
    s_mov_b64 exec, s[62:63]
    s_cbranch_execz K2_G7
    buffer_load_dwordx2 v[74:75], v104, s[20:23], s95 offen offset:128 sc1
K2_G7:
    s_mov_b32 s95, 179200
    s_mov_b64 exec, s[64:65]
    s_cbranch_execz K2_G8
    buffer_load_dwordx2 v[76:77], v105, s[20:23], s95 offen offset:128 sc1
K2_G8:
    s_mov_b32 s95, 204800
    s_mov_b64 exec, s[66:67]
    s_cbranch_execz K2_G9
    buffer_load_dwordx2 v[78:79], v106, s[20:23], s95 offen offset:128 sc1
K2_G9:
    s_or_b64 vcc, s[68:69], s[70:71]
    s_or_b64 vcc, vcc, s[72:73]
    s_or_b64 vcc, vcc, s[74:75]
    s_or_b64 vcc, vcc, s[76:77]
    s_or_b64 vcc, vcc, s[78:79]
    s_or_b64 vcc, vcc, s[80:81]
    s_or_b64 vcc, vcc, s[82:83]
    s_or_b64 vcc, vcc, s[84:85]
    s_cselect_b32 s97, 1, 0
    s_cbranch_scc0 K2_NP2A
    s_mov_b32 s95, 0
    s_mov_b64 exec, s[68:69]
    s_cbranch_execz K2_G10
    buffer_load_dwordx2 v[80:81], v98, s[20:23], s95 offen offset:256 sc1
K2_G10:
    s_mov_b32 s95, 25600
    s_mov_b64 exec, s[70:71]
    s_cbranch_execz K2_G11
    buffer_load_dwordx2 v[82:83], v99, s[20:23], s95 offen offset:256 sc1
K2_G11:
    s_mov_b32 s95, 51200
    s_mov_b64 exec, s[72:73]
    s_cbranch_execz K2_G12
    buffer_load_dwordx2 v[84:85], v100, s[20:23], s95 offen offset:256 sc1
K2_G12:
    s_mov_b32 s95, 76800
    s_mov_b64 exec, s[74:75]
    s_cbranch_execz K2_G13
    buffer_load_dwordx2 v[86:87], v101, s[20:23], s95 offen offset:256 sc1
K2_G13:
    s_mov_b32 s95, 102400
    s_mov_b64 exec, s[76:77]
    s_cbranch_execz K2_G14
    buffer_load_dwordx2 v[88:89], v102, s[20:23], s95 offen offset:256 sc1
K2_G14:
    s_mov_b32 s95, 128000
    s_mov_b64 exec, s[78:79]
    s_cbranch_execz K2_G15
    buffer_load_dwordx2 v[90:91], v103, s[20:23], s95 offen offset:256 sc1
K2_G15:
    s_mov_b32 s95, 153600
    s_mov_b64 exec, s[80:81]
    s_cbranch_execz K2_G16
    buffer_load_dwordx2 v[92:93], v104, s[20:23], s95 offen offset:256 sc1
K2_G16:
    s_mov_b32 s95, 179200
    s_mov_b64 exec, s[82:83]
    s_cbranch_execz K2_G17
    buffer_load_dwordx2 v[94:95], v105, s[20:23], s95 offen offset:256 sc1
K2_G17:
    s_mov_b32 s95, 204800
    s_mov_b64 exec, s[84:85]
    s_cbranch_execz K2_G18
    buffer_load_dwordx2 v[96:97], v106, s[20:23], s95 offen offset:256 sc1
K2_G18:
K2_NP2A:
    s_mov_b64 exec, -1
    v_max3_i32 v221, v172, v173, v174
    v_max3_i32 v221, v221, v175, v176
    v_max3_i32 v221, v221, v177, v178
    v_max3_i32 v221, v221, v179, v180
    v_mov_b32 v223, 1
    v_cmp_lt_i32_e64 s[86:87], s92, v221
K2_NOREC:
    s_waitcnt lgkmcnt(0)
    s_barrier
    s_add_u32 s95, s101, 0
    s_cmp_lt_u32 s95, 125952
    s_cselect_b32 m0, s95, 47104
    s_nop 0
    buffer_load_dwordx4 v[210:211], s[8:11], 0 idxen offen lds
    s_add_u32 s95, s101, 1024
    s_cmp_lt_u32 s95, 125952
    s_cselect_b32 m0, s95, 47104
    s_nop 0
    buffer_load_dwordx4 v[212:213], s[8:11], 0 idxen offen lds
    s_add_u32 s95, s101, 2048
    s_cmp_lt_u32 s95, 125952
    s_cselect_b32 m0, s95, 47104
    s_nop 0
    buffer_load_dwordx4 v[214:215], s[8:11], 0 idxen offen lds
    s_add_u32 s95, s101, 3072
    s_cmp_lt_u32 s95, 125952
    s_cselect_b32 m0, s95, 47104
    s_nop 0
    buffer_load_dwordx4 v[216:217], s[8:11], 0 idxen offen lds
    s_mul_i32 s95, s5, 3072
    s_add_u32 m0, s95, 138240
    s_add_u32 s95, s95, 7536640
    buffer_load_dwordx4 v203, s[20:23], s95 offen offset:0 sc1 lds
    buffer_load_dwordx4 v203, s[20:23], s95 offen offset:1024 sc1 lds
    buffer_load_dwordx4 v203, s[20:23], s95 offen offset:2048 sc1 lds
    s_cmp_lg_u32 s5, 0
    s_cbranch_scc1 K2_NOPW
    s_lshr_b32 s95, s2, 3
    s_mul_i32 s99, s95, 0
    v_add_u32 v224, s99, v203
    s_mul_i32 s99, s95, 0
    v_add_u32 v225, s99, v250
    v_add_u32 v224, 0, v250
    v_cmp_gt_u32 vcc, s96, v224
    s_nop 1
    v_cndmask_b32_e64 v104, -0.5, 0.5, vcc
    v_add_u32 v224, 64, v250
    v_cmp_gt_u32 vcc, s96, v224
    s_nop 1
    v_cndmask_b32_e64 v105, -0.5, 0.5, vcc
    v_add_u32 v224, 128, v250
    v_cmp_gt_u32 vcc, s96, v224
    s_nop 1
    v_cndmask_b32_e64 v106, -0.5, 0.5, vcc
    v_add_u32 v224, 192, v250
    v_cmp_gt_u32 vcc, s96, v224
    s_nop 1
    v_cndmask_b32_e64 v107, -0.5, 0.5, vcc
    s_branch K2_B1
K2_NOPW:
    s_mov_b64 exec, s[86:87]
    ds_write_b32 v228, v223 offset:96
    s_mov_b64 exec, -1
    s_waitcnt vmcnt(15)
    s_mov_b64 exec, s[32:33]
    v_lshrrev_b32 v172, 16, v45
    ds_add_rtn_u32 v172, v172, v223 offset:34816
    s_waitcnt vmcnt(14)
    s_mov_b64 exec, s[34:35]
    v_lshrrev_b32 v173, 16, v47
    ds_add_rtn_u32 v173, v173, v223 offset:34816
    s_waitcnt vmcnt(13)
    s_mov_b64 exec, s[36:37]
    v_lshrrev_b32 v174, 16, v49
    ds_add_rtn_u32 v174, v174, v223 offset:34816
    s_waitcnt vmcnt(12)
    s_mov_b64 exec, s[38:39]
    v_lshrrev_b32 v175, 16, v51
    ds_add_rtn_u32 v175, v175, v223 offset:34816
    s_waitcnt vmcnt(11)
    s_mov_b64 exec, s[40:41]
    v_lshrrev_b32 v176, 16, v53
    ds_add_rtn_u32 v176, v176, v223 offset:34816
    s_waitcnt vmcnt(10)
    s_mov_b64 exec, s[42:43]
    v_lshrrev_b32 v177, 16, v55
    ds_add_rtn_u32 v177, v177, v223 offset:34816
    s_waitcnt vmcnt(9)
    s_mov_b64 exec, s[44:45]
    v_lshrrev_b32 v178, 16, v57
    ds_add_rtn_u32 v178, v178, v223 offset:34816
    s_waitcnt vmcnt(8)
    s_mov_b64 exec, s[46:47]
    v_lshrrev_b32 v179, 16, v59
    ds_add_rtn_u32 v179, v179, v223 offset:34816
    s_waitcnt vmcnt(7)
    s_mov_b64 exec, s[48:49]
    v_lshrrev_b32 v180, 16, v61
    ds_add_rtn_u32 v180, v180, v223 offset:34816
    s_mov_b64 exec, s[50:51]
    s_cbranch_execz K2_G19
    v_lshrrev_b32 v181, 16, v63
    ds_add_rtn_u32 v181, v181, v223 offset:34816
K2_G19:
    s_mov_b64 exec, s[52:53]
    s_cbranch_execz K2_G20
    v_lshrrev_b32 v182, 16, v65
    ds_add_rtn_u32 v182, v182, v223 offset:34816
K2_G20:
    s_mov_b64 exec, s[54:55]
    s_cbranch_execz K2_G21
    v_lshrrev_b32 v183, 16, v67
    ds_add_rtn_u32 v183, v183, v223 offset:34816
K2_G21:
    s_mov_b64 exec, s[56:57]
    s_cbranch_execz K2_G22
    v_lshrrev_b32 v184, 16, v69
    ds_add_rtn_u32 v184, v184, v223 offset:34816
K2_G22:
    s_mov_b64 exec, s[58:59]
    s_cbranch_execz K2_G23
    v_lshrrev_b32 v185, 16, v71
    ds_add_rtn_u32 v185, v185, v223 offset:34816
K2_G23:
    s_mov_b64 exec, s[60:61]
    s_cbranch_execz K2_G24
    v_lshrrev_b32 v186, 16, v73
    ds_add_rtn_u32 v186, v186, v223 offset:34816
K2_G24:
    s_mov_b64 exec, s[62:63]
    s_cbranch_execz K2_G25
    v_lshrrev_b32 v187, 16, v75
    ds_add_rtn_u32 v187, v187, v223 offset:34816
K2_G25:
    s_mov_b64 exec, s[64:65]
    s_cbranch_execz K2_G26
    v_lshrrev_b32 v188, 16, v77
    ds_add_rtn_u32 v188, v188, v223 offset:34816
K2_G26:
    s_mov_b64 exec, s[66:67]
    s_cbranch_execz K2_G27
    v_lshrrev_b32 v189, 16, v79
    ds_add_rtn_u32 v189, v189, v223 offset:34816
K2_G27:
    s_cmp_eq_u32 s97, 0
    s_cbranch_scc1 K2_NP2B
    s_mov_b64 exec, s[68:69]
    s_cbranch_execz K2_G28
    v_lshrrev_b32 v190, 16, v81
    ds_add_rtn_u32 v190, v190, v223 offset:34816
K2_G28:
    s_mov_b64 exec, s[70:71]
    s_cbranch_execz K2_G29
    v_lshrrev_b32 v191, 16, v83
    ds_add_rtn_u32 v191, v191, v223 offset:34816
K2_G29:
    s_mov_b64 exec, s[72:73]
    s_cbranch_execz K2_G30
    v_lshrrev_b32 v192, 16, v85
    ds_add_rtn_u32 v192, v192, v223 offset:34816
K2_G30:
    s_mov_b64 exec, s[74:75]
    s_cbranch_execz K2_G31
    v_lshrrev_b32 v193, 16, v87
    ds_add_rtn_u32 v193, v193, v223 offset:34816
K2_G31:
    s_mov_b64 exec, s[76:77]
    s_cbranch_execz K2_G32
    v_lshrrev_b32 v194, 16, v89
    ds_add_rtn_u32 v194, v194, v223 offset:34816
K2_G32:
    s_mov_b64 exec, s[78:79]
    s_cbranch_execz K2_G33
    v_lshrrev_b32 v195, 16, v91
    ds_add_rtn_u32 v195, v195, v223 offset:34816
K2_G33:
    s_mov_b64 exec, s[80:81]
    s_cbranch_execz K2_G34
    v_lshrrev_b32 v196, 16, v93
    ds_add_rtn_u32 v196, v196, v223 offset:34816
K2_G34:
    s_mov_b64 exec, s[82:83]
    s_cbranch_execz K2_G35
    v_lshrrev_b32 v197, 16, v95
    ds_add_rtn_u32 v197, v197, v223 offset:34816
K2_G35:
    s_mov_b64 exec, s[84:85]
    s_cbranch_execz K2_G36
    v_lshrrev_b32 v198, 16, v97
    ds_add_rtn_u32 v198, v198, v223 offset:34816
K2_G36:
K2_NP2B:
    s_mov_b64 exec, -1
K2_B1:
    s_cmp_lg_u32 s5, 0
    s_waitcnt lgkmcnt(0)
    s_barrier
    s_cbranch_scc1 K2_W2
    v_lshlrev_b32 v222, 1, v203
    ds_read_b128 v[0:3], v222 offset:34816
    ds_read_b128 v[4:7], v222 offset:34832
    ds_read_b128 v[8:11], v222 offset:36864
    ds_read_b128 v[12:15], v222 offset:36880
    ds_read_b128 v[16:19], v222 offset:38912
    ds_read_b128 v[20:23], v222 offset:38928
    ds_read_b128 v[24:27], v222 offset:40960
    ds_read_b128 v[28:31], v222 offset:40976
    s_waitcnt lgkmcnt(6)
    v_add3_u32 v76, v0, v1, v2
    v_add3_u32 v80, v3, v4, v5
    v_add3_u32 v76, v76, v6, v7
    v_add_u32 v76, v76, v80
    s_waitcnt lgkmcnt(4)
    v_add3_u32 v77, v8, v9, v10
    v_add3_u32 v81, v11, v12, v13
    v_add3_u32 v77, v77, v14, v15
    v_add_u32 v77, v77, v81
    s_waitcnt lgkmcnt(2)
    v_add3_u32 v78, v16, v17, v18
    v_add3_u32 v82, v19, v20, v21
    v_add3_u32 v78, v78, v22, v23
    v_add_u32 v78, v78, v82
    s_waitcnt lgkmcnt(0)
    v_add3_u32 v79, v24, v25, v26
    v_add3_u32 v83, v27, v28, v29
    v_add3_u32 v79, v79, v30, v31
    v_add_u32 v79, v79, v83
    v_add_u32 v82, v76, v77
    v_add_u32 v83, v82, v78
    v_add_u32 v220, v83, v79
    v_mov_b32 v221, v220
    s_nop 1
    v_add_u32_dpp v221, v221, v221 row_shr:1 row_mask:0xf bank_mask:0xf
    s_nop 1
    v_add_u32_dpp v221, v221, v221 row_shr:2 row_mask:0xf bank_mask:0xf
    s_nop 1
    v_add_u32_dpp v221, v221, v221 row_shr:4 row_mask:0xf bank_mask:0xf
    s_nop 1
    v_add_u32_dpp v221, v221, v221 row_shr:8 row_mask:0xf bank_mask:0xf
    s_nop 1
    v_add_u32_dpp v221, v221, v221 row_bcast:15 row_mask:0xa bank_mask:0xf
    s_nop 1
    v_add_u32_dpp v221, v221, v221 row_bcast:31 row_mask:0xc bank_mask:0xf
    v_sub_u32 v80, v221, v220
    v_add_u32 v81, v80, v76
    v_add_u32 v82, v80, v82
    v_add_u32 v83, v80, v83
    s_movk_i32 s95, 2560
    v_lshl_add_u32 v140, v80, 3, s95
    v_lshl_add_u32 v141, v0, 3, v140
    v_lshl_add_u32 v142, v1, 3, v141
    v_lshl_add_u32 v143, v2, 3, v142
    ds_write_b128 v222, v[140:143] offset:34816
    v_lshl_add_u32 v144, v3, 3, v143
    v_lshl_add_u32 v145, v4, 3, v144
    v_lshl_add_u32 v146, v5, 3, v145
    v_lshl_add_u32 v147, v6, 3, v146
    ds_write_b128 v222, v[144:147] offset:34832
    v_lshl_add_u32 v148, v81, 3, s95
    v_lshl_add_u32 v149, v8, 3, v148
    v_lshl_add_u32 v150, v9, 3, v149
    v_lshl_add_u32 v151, v10, 3, v150
    ds_write_b128 v222, v[148:151] offset:36864
    v_lshl_add_u32 v152, v11, 3, v151
    v_lshl_add_u32 v153, v12, 3, v152
    v_lshl_add_u32 v154, v13, 3, v153
    v_lshl_add_u32 v155, v14, 3, v154
    ds_write_b128 v222, v[152:155] offset:36880
    v_lshl_add_u32 v156, v82, 3, s95
    v_lshl_add_u32 v157, v16, 3, v156
    v_lshl_add_u32 v158, v17, 3, v157
    v_lshl_add_u32 v159, v18, 3, v158
    ds_write_b128 v222, v[156:159] offset:38912
    v_lshl_add_u32 v160, v19, 3, v159
    v_lshl_add_u32 v161, v20, 3, v160
    v_lshl_add_u32 v162, v21, 3, v161
    v_lshl_add_u32 v163, v22, 3, v162
    ds_write_b128 v222, v[160:163] offset:38928
    v_lshl_add_u32 v164, v83, 3, s95
    v_lshl_add_u32 v165, v24, 3, v164
    v_lshl_add_u32 v166, v25, 3, v165
    v_lshl_add_u32 v167, v26, 3, v166
    ds_write_b128 v222, v[164:167] offset:40960
    v_lshl_add_u32 v168, v27, 3, v167
    v_lshl_add_u32 v169, v28, 3, v168
    v_lshl_add_u32 v170, v29, 3, v169
    v_lshl_add_u32 v171, v30, 3, v170
    ds_write_b128 v222, v[168:171] offset:40976
    s_mov_b32 exec_lo, 0
    s_brev_b32 exec_hi, 1
    ds_write_b32 v228, v221 offset:100
    s_mov_b64 exec, -1
K2_W2:
    s_cmp_ge_u32 s5, 6
    s_cbranch_scc1 K2_NWH
    s_mul_i32 s95, s5, 2048
    s_add_u32 m0, s95, 125952
    s_add_u32 s95, s95, 7561216
    buffer_load_dwordx4 v203, s[20:23], s95 offen offset:0 sc1 lds
    buffer_load_dwordx4 v203, s[20:23], s95 offen offset:1024 sc1 lds
K2_NWH:
    s_cmp_eq_u32 s5, 0
    s_cbranch_scc1 K2_NFT
    s_mov_b32 s95, 1835008
    s_mov_b64 exec, s[32:33]
    v_and_or_b32 v140, v45, s95, v172
    v_lshrrev_b32 v141, 18, v45
    v_cmpx_gt_u32 vcc, 1, v140
    ds_write_b64 v141, v[44:45] offset:43008
    s_mov_b64 exec, s[34:35]
    v_and_or_b32 v142, v47, s95, v173
    v_lshrrev_b32 v143, 18, v47
    v_cmpx_gt_u32 vcc, 1, v142
    ds_write_b64 v143, v[46:47] offset:43008
    s_mov_b64 exec, s[36:37]
    v_and_or_b32 v144, v49, s95, v174
    v_lshrrev_b32 v145, 18, v49
    v_cmpx_gt_u32 vcc, 1, v144
    ds_write_b64 v145, v[48:49] offset:43008
    s_mov_b64 exec, s[38:39]
    v_and_or_b32 v146, v51, s95, v175
    v_lshrrev_b32 v147, 18, v51
    v_cmpx_gt_u32 vcc, 1, v146
    ds_write_b64 v147, v[50:51] offset:43008
    s_mov_b64 exec, s[40:41]
    v_and_or_b32 v148, v53, s95, v176
    v_lshrrev_b32 v149, 18, v53
    v_cmpx_gt_u32 vcc, 1, v148
    ds_write_b64 v149, v[52:53] offset:43008
    s_mov_b64 exec, s[42:43]
    v_and_or_b32 v150, v55, s95, v177
    v_lshrrev_b32 v151, 18, v55
    v_cmpx_gt_u32 vcc, 1, v150
    ds_write_b64 v151, v[54:55] offset:43008
    s_mov_b64 exec, s[44:45]
    v_and_or_b32 v152, v57, s95, v178
    v_lshrrev_b32 v153, 18, v57
    v_cmpx_gt_u32 vcc, 1, v152
    ds_write_b64 v153, v[56:57] offset:43008
    s_mov_b64 exec, s[46:47]
    v_and_or_b32 v154, v59, s95, v179
    v_lshrrev_b32 v155, 18, v59
    v_cmpx_gt_u32 vcc, 1, v154
    ds_write_b64 v155, v[58:59] offset:43008
    s_mov_b64 exec, s[48:49]
    v_and_or_b32 v156, v61, s95, v180
    v_lshrrev_b32 v157, 18, v61
    v_cmpx_gt_u32 vcc, 1, v156
    ds_write_b64 v157, v[60:61] offset:43008
    s_mov_b64 exec, -1
    s_mul_i32 s95, s5, 224
    v_lshrrev_b32 v140, 1, v203
    v_add_u32 v140, s95, v140
K2_NFT:
    s_cmp_eq_u32 s5, 0
    s_waitcnt lgkmcnt(0)
    s_barrier
    ds_read_b64 v[232:233], v228 offset:96
    s_cbranch_scc1 K2_NOS1
    ds_read_b64 v[140:141], v140 offset:42784
    s_mov_b64 exec, s[32:33]
    v_lshrrev_b32 v98, 16, v45
    ds_read_b32 v98, v98 offset:34816
    s_mov_b64 exec, s[34:35]
    v_lshrrev_b32 v99, 16, v47
    ds_read_b32 v99, v99 offset:34816
    s_mov_b64 exec, s[36:37]
    v_lshrrev_b32 v100, 16, v49
    ds_read_b32 v100, v100 offset:34816
    s_mov_b64 exec, s[38:39]
    v_lshrrev_b32 v101, 16, v51
    ds_read_b32 v101, v101 offset:34816
    s_mov_b64 exec, s[40:41]
    v_lshrrev_b32 v102, 16, v53
    ds_read_b32 v102, v102 offset:34816
    s_mov_b64 exec, s[42:43]
    v_lshrrev_b32 v103, 16, v55
    ds_read_b32 v103, v103 offset:34816
    s_mov_b64 exec, s[44:45]
    v_lshrrev_b32 v104, 16, v57
    ds_read_b32 v104, v104 offset:34816
    s_mov_b64 exec, s[46:47]
    v_lshrrev_b32 v105, 16, v59
    ds_read_b32 v105, v105 offset:34816
    s_mov_b64 exec, s[48:49]
    v_lshrrev_b32 v106, 16, v61
    ds_read_b32 v106, v106 offset:34816
    s_mov_b64 exec, -1
    s_waitcnt lgkmcnt(9)
    v_and_b32 v141, 0xffff, v141
    s_mov_b64 exec, 0xfffffff
    buffer_load_dword v202, v140, s[12:15], 0 idxen
    buffer_load_dword v202, v141, s[8:11], 0 idxen
    buffer_load_dword v202, v141, s[16:19], 0 idxen
    s_mov_b64 exec, s[50:51]
    s_cbranch_execz K2_G37
    v_lshrrev_b32 v220, 16, v63
    ds_read_b32 v220, v220 offset:34816
K2_G37:
    s_mov_b64 exec, s[52:53]
    s_cbranch_execz K2_G38
    v_lshrrev_b32 v221, 16, v65
    ds_read_b32 v221, v221 offset:34816
K2_G38:
    s_mov_b64 exec, s[54:55]
    s_cbranch_execz K2_G39
    v_lshrrev_b32 v222, 16, v67
    ds_read_b32 v222, v222 offset:34816
K2_G39:
    s_mov_b64 exec, s[56:57]
    s_cbranch_execz K2_G40
    v_lshrrev_b32 v223, 16, v69
    ds_read_b32 v223, v223 offset:34816
K2_G40:
    s_mov_b64 exec, s[58:59]
    s_cbranch_execz K2_G41
    v_lshrrev_b32 v224, 16, v71
    ds_read_b32 v224, v224 offset:34816
K2_G41:
    s_mov_b64 exec, s[60:61]
    s_cbranch_execz K2_G42
    v_lshrrev_b32 v225, 16, v73
    ds_read_b32 v225, v225 offset:34816
K2_G42:
    s_mov_b64 exec, s[62:63]
    s_cbranch_execz K2_G43
    v_lshrrev_b32 v226, 16, v75
    ds_read_b32 v226, v226 offset:34816
K2_G43:
    s_mov_b64 exec, s[64:65]
    s_cbranch_execz K2_G44
    v_lshrrev_b32 v227, 16, v77
    ds_read_b32 v227, v227 offset:34816
K2_G44:
    s_mov_b64 exec, s[66:67]
    s_cbranch_execz K2_G45
    v_lshrrev_b32 v228, 16, v79
    ds_read_b32 v228, v228 offset:34816
K2_G45:
    s_mov_b64 exec, -1
K2_NOS1:
    s_waitcnt lgkmcnt(0)
    v_readfirstlane_b32 s98, v233
    v_readfirstlane_b32 s93, v232
    s_cmp_le_u32 s98, 3776
    s_cbranch_scc1 K2_FITS
    s_cmp_eq_u32 s92, 15
    s_cbranch_scc1 K2_END0
    s_mov_b32 s92, 15
    s_waitcnt vmcnt(0)
    s_barrier
    s_branch K2_TOP
K2_FITS:
    s_cmp_eq_u32 s5, 0
    s_cbranch_scc1 K2_PLAN
    s_mov_b64 exec, s[32:33]
    v_lshl_add_u32 v98, v172, 3, v98
    ds_write_b64 v98, v[44:45]
    s_mov_b64 exec, s[34:35]
    v_lshl_add_u32 v99, v173, 3, v99
    ds_write_b64 v99, v[46:47]
    s_mov_b64 exec, s[36:37]
    v_lshl_add_u32 v100, v174, 3, v100
    ds_write_b64 v100, v[48:49]
    s_mov_b64 exec, s[38:39]
    v_lshl_add_u32 v101, v175, 3, v101
    ds_write_b64 v101, v[50:51]
    s_mov_b64 exec, s[40:41]
    v_lshl_add_u32 v102, v176, 3, v102
    ds_write_b64 v102, v[52:53]
    s_mov_b64 exec, s[42:43]
    v_lshl_add_u32 v103, v177, 3, v103
    ds_write_b64 v103, v[54:55]
    s_mov_b64 exec, s[44:45]
    v_lshl_add_u32 v104, v178, 3, v104
    ds_write_b64 v104, v[56:57]
    s_mov_b64 exec, s[46:47]
    v_lshl_add_u32 v105, v179, 3, v105
    ds_write_b64 v105, v[58:59]
    s_mov_b64 exec, s[48:49]
    v_lshl_add_u32 v106, v180, 3, v106
    ds_write_b64 v106, v[60:61]
    s_mov_b64 exec, s[50:51]
    s_cbranch_execz K2_G46
    v_lshl_add_u32 v220, v181, 3, v220
    ds_write_b64 v220, v[62:63]
K2_G46:
    s_mov_b64 exec, s[52:53]
    s_cbranch_execz K2_G47
    v_lshl_add_u32 v221, v182, 3, v221
    ds_write_b64 v221, v[64:65]
K2_G47:
    s_mov_b64 exec, s[54:55]
    s_cbranch_execz K2_G48
    v_lshl_add_u32 v222, v183, 3, v222
    ds_write_b64 v222, v[66:67]
K2_G48:
    s_mov_b64 exec, s[56:57]
    s_cbranch_execz K2_G49
    v_lshl_add_u32 v223, v184, 3, v223
    ds_write_b64 v223, v[68:69]
K2_G49:
    s_mov_b64 exec, s[58:59]
    s_cbranch_execz K2_G50
    v_lshl_add_u32 v224, v185, 3, v224
    ds_write_b64 v224, v[70:71]
K2_G50:
    s_mov_b64 exec, s[60:61]
    s_cbranch_execz K2_G51
    v_lshl_add_u32 v225, v186, 3, v225
    ds_write_b64 v225, v[72:73]
K2_G51:
    s_mov_b64 exec, s[62:63]
    s_cbranch_execz K2_G52
    v_lshl_add_u32 v226, v187, 3, v226
    ds_write_b64 v226, v[74:75]
K2_G52:
    s_mov_b64 exec, s[64:65]
    s_cbranch_execz K2_G53
    v_lshl_add_u32 v227, v188, 3, v227
    ds_write_b64 v227, v[76:77]
K2_G53:
    s_mov_b64 exec, s[66:67]
    s_cbranch_execz K2_G54
    v_lshl_add_u32 v228, v189, 3, v228
    ds_write_b64 v228, v[78:79]
K2_G54:
    s_cmp_eq_u32 s97, 0
    s_cbranch_scc1 K2_B3
    s_mov_b64 exec, s[68:69]
    s_cbranch_execz K2_G55
    v_lshrrev_b32 v98, 16, v81
    ds_read_b32 v98, v98 offset:34816
K2_G55:
    s_mov_b64 exec, s[70:71]
    s_cbranch_execz K2_G56
    v_lshrrev_b32 v99, 16, v83
    ds_read_b32 v99, v99 offset:34816
K2_G56:
    s_mov_b64 exec, s[72:73]
    s_cbranch_execz K2_G57
    v_lshrrev_b32 v100, 16, v85
    ds_read_b32 v100, v100 offset:34816
K2_G57:
    s_mov_b64 exec, s[74:75]
    s_cbranch_execz K2_G58
    v_lshrrev_b32 v101, 16, v87
    ds_read_b32 v101, v101 offset:34816
K2_G58:
    s_mov_b64 exec, s[76:77]
    s_cbranch_execz K2_G59
    v_lshrrev_b32 v102, 16, v89
    ds_read_b32 v102, v102 offset:34816
K2_G59:
    s_mov_b64 exec, s[78:79]
    s_cbranch_execz K2_G60
    v_lshrrev_b32 v103, 16, v91
    ds_read_b32 v103, v103 offset:34816
K2_G60:
    s_mov_b64 exec, s[80:81]
    s_cbranch_execz K2_G61
    v_lshrrev_b32 v104, 16, v93
    ds_read_b32 v104, v104 offset:34816
K2_G61:
    s_mov_b64 exec, s[82:83]
    s_cbranch_execz K2_G62
    v_lshrrev_b32 v105, 16, v95
    ds_read_b32 v105, v105 offset:34816
K2_G62:
    s_mov_b64 exec, s[84:85]
    s_cbranch_execz K2_G63
    v_lshrrev_b32 v106, 16, v97
    ds_read_b32 v106, v106 offset:34816
K2_G63:
    s_waitcnt lgkmcnt(0)
    s_mov_b64 exec, s[68:69]
    s_cbranch_execz K2_G64
    v_lshl_add_u32 v98, v190, 3, v98
    ds_write_b64 v98, v[80:81]
K2_G64:
    s_mov_b64 exec, s[70:71]
    s_cbranch_execz K2_G65
    v_lshl_add_u32 v99, v191, 3, v99
    ds_write_b64 v99, v[82:83]
K2_G65:
    s_mov_b64 exec, s[72:73]
    s_cbranch_execz K2_G66
    v_lshl_add_u32 v100, v192, 3, v100
    ds_write_b64 v100, v[84:85]
K2_G66:
    s_mov_b64 exec, s[74:75]
    s_cbranch_execz K2_G67
    v_lshl_add_u32 v101, v193, 3, v101
    ds_write_b64 v101, v[86:87]
K2_G67:
    s_mov_b64 exec, s[76:77]
    s_cbranch_execz K2_G68
    v_lshl_add_u32 v102, v194, 3, v102
    ds_write_b64 v102, v[88:89]
K2_G68:
    s_mov_b64 exec, s[78:79]
    s_cbranch_execz K2_G69
    v_lshl_add_u32 v103, v195, 3, v103
    ds_write_b64 v103, v[90:91]
K2_G69:
    s_mov_b64 exec, s[80:81]
    s_cbranch_execz K2_G70
    v_lshl_add_u32 v104, v196, 3, v104
    ds_write_b64 v104, v[92:93]
K2_G70:
    s_mov_b64 exec, s[82:83]
    s_cbranch_execz K2_G71
    v_lshl_add_u32 v105, v197, 3, v105
    ds_write_b64 v105, v[94:95]
K2_G71:
    s_mov_b64 exec, s[84:85]
    s_cbranch_execz K2_G72
    v_lshl_add_u32 v106, v198, 3, v106
    ds_write_b64 v106, v[96:97]
K2_G72:
    s_branch K2_B3
K2_PLAN:
    s_mul_i32 s99, s98, 3
    s_lshr_b32 s99, s99, 9
    s_max_u32 s99, s99, 1
    v_cvt_f32_u32 v84, v76
    v_add_f32 v84, -0.5, v84
    v_max_f32 v104, v104, v84
    v_cvt_f32_u32 v85, v77
    v_add_f32 v85, -0.5, v85
    v_max_f32 v105, v105, v85
    v_cvt_f32_u32 v86, v78
    v_add_f32 v86, -0.5, v86
    v_max_f32 v106, v106, v86
    v_cvt_f32_u32 v87, v79
    v_add_f32 v87, -0.5, v87
    v_max_f32 v107, v107, v87
K2_DLOOP:
    v_cvt_f32_u32 v220, s99
    v_rcp_f32 v221, v220
    v_add_f32 v88, v104, v220
    v_add_f32 v89, v105, v220
    v_add_f32 v90, v106, v220
    v_add_f32 v91, v107, v220
    v_mul_f32 v88, v88, v221
    v_cvt_u32_f32 v88, v88
    v_mul_f32 v89, v89, v221
    v_cvt_u32_f32 v89, v89
    v_mul_f32 v90, v90, v221
    v_cvt_u32_f32 v90, v90
    v_mul_f32 v91, v91, v221
    v_cvt_u32_f32 v91, v91
    v_add_u32 v222, v88, v89
    v_add3_u32 v222, v222, v90, v91
    s_nop 1
    v_add_u32_dpp v222, v222, v222 row_shr:1 row_mask:0xf bank_mask:0xf
    s_nop 1
    v_add_u32_dpp v222, v222, v222 row_shr:2 row_mask:0xf bank_mask:0xf
    s_nop 1
    v_add_u32_dpp v222, v222, v222 row_shr:4 row_mask:0xf bank_mask:0xf
    s_nop 1
    v_add_u32_dpp v222, v222, v222 row_shr:8 row_mask:0xf bank_mask:0xf
    s_nop 1
    v_add_u32_dpp v222, v222, v222 row_bcast:15 row_mask:0xa bank_mask:0xf
    s_nop 1
    v_add_u32_dpp v222, v222, v222 row_bcast:31 row_mask:0xc bank_mask:0xf
    s_nop 0
    v_readlane_b32 s95, v222, 63
    s_add_u32 s99, s99, 1
    s_cmp_gt_u32 s95, 255
    s_cbranch_scc1 K2_DLOOP
    v_cvt_f32_u32 v92, v88
    v_rcp_f32 v96, v92
    v_add_f32 v92, v92, v84
    v_cmp_eq_u32_e64 s[48:49], 1, v88
    v_lshlrev_b32 v44, 16, v88
    v_cvt_f32_u32 v93, v89
    v_rcp_f32 v97, v93
    v_add_f32 v93, v93, v85
    v_cmp_eq_u32_e64 s[50:51], 1, v89
    v_lshlrev_b32 v45, 16, v89
    v_cvt_f32_u32 v94, v90
    v_rcp_f32 v98, v94
    v_add_f32 v94, v94, v86
    v_cmp_eq_u32_e64 s[52:53], 1, v90
    v_lshlrev_b32 v46, 16, v90
    v_cvt_f32_u32 v95, v91
    v_rcp_f32 v99, v95
    v_add_f32 v95, v95, v87
    v_cmp_eq_u32_e64 s[54:55], 1, v91
    v_lshlrev_b32 v47, 16, v91
    v_cndmask_b32_e64 v44, v44, 1, s[48:49]
    v_cndmask_b32_e64 v45, v45, 1, s[50:51]
    v_cndmask_b32_e64 v46, v46, 1, s[52:53]
    v_cndmask_b32_e64 v47, v47, 1, s[54:55]
    v_mul_f32 v92, v92, v96
    v_cvt_u32_f32 v92, v92
    v_sub_u32 v96, 63, v92
    v_lshlrev_b32 v96, 2, v96
    ds_add_rtn_u32 v100, v96, v44 offset:128
    v_mul_f32 v93, v93, v97
    v_cvt_u32_f32 v93, v93
    v_sub_u32 v97, 63, v93
    v_lshlrev_b32 v97, 2, v97
    ds_add_rtn_u32 v101, v97, v45 offset:128
    v_mul_f32 v94, v94, v98
    v_cvt_u32_f32 v94, v94
    v_sub_u32 v98, 63, v94
    v_lshlrev_b32 v98, 2, v98
    ds_add_rtn_u32 v102, v98, v46 offset:128
    v_mul_f32 v95, v95, v99
    v_cvt_u32_f32 v95, v95
    v_sub_u32 v99, 63, v95
    v_lshlrev_b32 v99, 2, v99
    ds_add_rtn_u32 v103, v99, v47 offset:128
    v_lshrrev_b32 v220, 2, v203
    ds_read_b32 v221, v220 offset:128
    v_add_u32 v222, 0, v250
    v_lshl_or_b32 v172, v222, 24, v140
    v_lshl_or_b32 v172, v92, 18, v172
    v_lshlrev_b32 v173, 3, v88
    v_sub_u32 v222, 1, v92
    v_mad_i32_i24 v76, v222, v88, v76
    v_add_u32 v222, 64, v250
    v_lshl_or_b32 v174, v222, 24, v148
    v_lshl_or_b32 v174, v93, 18, v174
    v_lshlrev_b32 v175, 3, v89
    v_sub_u32 v222, 1, v93
    v_mad_i32_i24 v77, v222, v89, v77
    v_add_u32 v222, 128, v250
    v_lshl_or_b32 v176, v222, 24, v156
    v_lshl_or_b32 v176, v94, 18, v176
    v_lshlrev_b32 v177, 3, v90
    v_sub_u32 v222, 1, v94
    v_mad_i32_i24 v78, v222, v90, v78
    v_add_u32 v222, 192, v250
    v_lshl_or_b32 v178, v222, 24, v164
    v_lshl_or_b32 v178, v95, 18, v178
    v_lshlrev_b32 v179, 3, v91
    v_sub_u32 v222, 1, v95
    v_mad_i32_i24 v79, v222, v91, v79
    v_max3_u32 v224, v88, v89, v90
    v_max_u32 v224, v224, v91
    v_mov_b32 v225, -262136
    s_mov_b32 s99, 0
    s_waitcnt lgkmcnt(0)
    v_mov_b32 v222, v221
    v_and_b32 v57, 0xffff, v221
    v_cmp_ne_u32 vcc, 0, v57
    v_and_b32 v52, 0xffff, v100
    v_lshrrev_b32 v100, 16, v100
    v_add_u32_dpp v222, v222, v222 row_shr:1 row_mask:0xf bank_mask:0xf
    v_min_u32 v48, 1, v52
    v_cndmask_b32_e64 v100, v100, v52, s[48:49]
    v_add_u32_dpp v222, v222, v222 row_shr:2 row_mask:0xf bank_mask:0xf
    v_mad_i32_i24 v48, v48, -10, 20
    v_cndmask_b32_e64 v48, 0, v48, s[48:49]
    v_add_u32_dpp v222, v222, v222 row_shr:4 row_mask:0xf bank_mask:0xf
    v_and_b32 v53, 0xffff, v101
    v_lshrrev_b32 v101, 16, v101
    v_add_u32_dpp v222, v222, v222 row_shr:8 row_mask:0xf bank_mask:0xf
    v_min_u32 v49, 1, v53
    v_cndmask_b32_e64 v101, v101, v53, s[50:51]
    v_add_u32_dpp v222, v222, v222 row_bcast:15 row_mask:0xa bank_mask:0xf
    v_mad_i32_i24 v49, v49, -10, 20
    v_cndmask_b32_e64 v49, 0, v49, s[50:51]
    v_add_u32_dpp v222, v222, v222 row_bcast:31 row_mask:0xc bank_mask:0xf
    v_lshrrev_b32 v58, 16, v222
    v_cndmask_b32 v56, 0, v58, vcc
    v_sub_u32 v222, v222, v221
    v_and_b32 v54, 0xffff, v102
    v_lshrrev_b32 v102, 16, v102
    v_max_u32_dpp v56, v56, v56 row_shr:1 row_mask:0xf bank_mask:0xf
    v_min_u32 v50, 1, v54
    v_cndmask_b32_e64 v102, v102, v54, s[52:53]
    v_max_u32_dpp v56, v56, v56 row_shr:2 row_mask:0xf bank_mask:0xf
    v_mad_i32_i24 v50, v50, -10, 20
    v_cndmask_b32_e64 v50, 0, v50, s[52:53]
    v_max_u32_dpp v56, v56, v56 row_shr:4 row_mask:0xf bank_mask:0xf
    v_and_b32 v55, 0xffff, v103
    v_lshrrev_b32 v103, 16, v103
    v_max_u32_dpp v56, v56, v56 row_shr:8 row_mask:0xf bank_mask:0xf
    v_min_u32 v51, 1, v55
    v_cndmask_b32_e64 v103, v103, v55, s[54:55]
    v_max_u32_dpp v56, v56, v56 row_bcast:15 row_mask:0xa bank_mask:0xf
    v_mad_i32_i24 v51, v51, -10, 20
    v_cndmask_b32_e64 v51, 0, v51, s[54:55]
    v_max_u32_dpp v56, v56, v56 row_bcast:31 row_mask:0xc bank_mask:0xf
    v_and_b32 v57, 0xffff, v222
    v_and_b32 v221, 1, v222
    v_mov_b32_dpp v56, v56 wave_shr:1 row_mask:0xf bank_mask:0xf
    v_cmp_eq_u32 vcc, 1, v221
    v_lshrrev_b32 v222, 16, v222
    v_add3_u32 v222, v222, v57, v221
    v_cndmask_b32 v56, v58, v56, vcc
    v_add_u32 v58, v58, v57
    v_add_u32 v56, v56, v57
    v_lshl_or_b32 v222, v58, 10, v222
    v_lshl_or_b32 v222, v56, 20, v222
    ds_bpermute_b32 v96, v96, v222
    ds_bpermute_b32 v97, v97, v222
    ds_bpermute_b32 v98, v98, v222
    ds_bpermute_b32 v99, v99, v222
    s_waitcnt lgkmcnt(3)
    v_bfe_u32 v96, v96, v48, 10
    v_add_lshl_u32 v96, v96, v100, 2
    v_lshl_or_b32 v222, v88, 16, v96
    v_lshlrev_b32 v96, 1, v96
    ds_write_b32 v220, v222 offset:32768
    s_waitcnt lgkmcnt(3)
    v_bfe_u32 v97, v97, v49, 10
    v_add_lshl_u32 v97, v97, v101, 2
    v_lshl_or_b32 v222, v89, 16, v97
    v_lshlrev_b32 v97, 1, v97
    ds_write_b32 v220, v222 offset:33024
    s_waitcnt lgkmcnt(3)
    v_bfe_u32 v98, v98, v50, 10
    v_add_lshl_u32 v98, v98, v102, 2
    v_lshl_or_b32 v222, v90, 16, v98
    v_lshlrev_b32 v98, 1, v98
    ds_write_b32 v220, v222 offset:33280
    s_waitcnt lgkmcnt(3)
    v_bfe_u32 v99, v99, v51, 10
    v_add_lshl_u32 v99, v99, v103, 2
    v_lshl_or_b32 v222, v91, 16, v99
    v_lshlrev_b32 v99, 1, v99
    ds_write_b32 v220, v222 offset:33536
K2_PLOOP:
    v_cmp_lt_u32_e64 s[32:33], s99, v88
    v_cmp_lt_u32_e64 s[34:35], s99, v89
    v_cmp_lt_u32_e64 s[36:37], s99, v90
    v_cmp_lt_u32_e64 s[38:39], s99, v91
    s_add_u32 s99, s99, 1
    v_cmp_eq_u32_e64 s[40:41], s99, v76
    v_cmp_eq_u32_e64 s[42:43], s99, v77
    v_cmp_eq_u32_e64 s[44:45], s99, v78
    v_cmp_eq_u32_e64 s[46:47], s99, v79
    s_mov_b64 exec, s[32:33]
    ds_write_b64 v96, v[172:173] offset:512
    s_mov_b64 exec, s[34:35]
    ds_write_b64 v97, v[174:175] offset:512
    s_mov_b64 exec, s[36:37]
    ds_write_b64 v98, v[176:177] offset:512
    s_mov_b64 exec, s[38:39]
    ds_write_b64 v99, v[178:179] offset:512
    s_mov_b64 exec, -1
    v_cmp_lt_u32 vcc, s99, v224
    v_cndmask_b32_e64 v222, 8, v225, s[40:41]
    v_add_u32 v172, v172, v222
    v_add_u32 v96, 8, v96
    v_cndmask_b32_e64 v222, 8, v225, s[42:43]
    v_add_u32 v174, v174, v222
    v_add_u32 v97, 8, v97
    v_cndmask_b32_e64 v222, 8, v225, s[44:45]
    v_add_u32 v176, v176, v222
    v_add_u32 v98, 8, v98
    v_cndmask_b32_e64 v222, 8, v225, s[46:47]
    v_add_u32 v178, v178, v222
    v_add_u32 v99, 8, v99
    s_cbranch_vccnz K2_PLOOP
    v_mov_b32 v222, s99
    ds_write_b32 v228, v222 offset:104
    s_waitcnt vmcnt(0)
K2_B3:
    s_mov_b64 exec, -1
    s_lshl_b32 s95, s100, 8
    v_and_b32 v220, 31, v250
    v_lshl_add_u32 v220, v220, 3, s95
    s_mov_b32 s6, 0
    s_waitcnt vmcnt(3) lgkmcnt(0)
    s_barrier
    ds_read_b64 v[220:221], v220 offset:512
    ds_read_b32 v222, v229 offset:104
    s_waitcnt lgkmcnt(0)
    v_bfe_u32 v235, v220, 18, 6
    v_and_b32 v207, 0x3ffff, v220
    v_lshrrev_b32 v249, 24, v220
    v_mov_b32 v206, v221
    v_readfirstlane_b32 s97, v222
    v_cmp_lt_u32_e64 s[28:29], s6, v235
    s_add_u32 s6, s6, 1
    v_add_u32 v221, s4, v249
    buffer_load_dwordx2 v[240:241], v221, s[16:19], 0 idxen sc1
    v_cndmask_b32_e64 v203, 0, v207, s[28:29]
    v_add_u32 v207, v207, v206
    ds_read_b32 v218, v203
    ds_read_u16 v203, v203 offset:4
    v_bfe_u32 v220, v249, 1, 3
    v_lshlrev_b32 v220, 4, v220
    v_lshlrev_b32 v221, 2, v219
    v_xor_b32 v220, v220, v221
    v_lshl_add_u32 v220, v249, 7, v220
    v_add_u32 v220, 100352, v220
    v_xor_b32 v221, 16, v220
    v_xor_b32 v222, 32, v220
    v_xor_b32 v223, 48, v220
    s_waitcnt lgkmcnt(0)
    ds_bpermute_b32 v210, v239, v203 offset:0
    ds_bpermute_b32 v212, v239, v203 offset:32
    ds_bpermute_b32 v214, v239, v203 offset:64
    ds_bpermute_b32 v216, v239, v203 offset:96
    ds_read_b128 v[172:175], v220
    ds_read_b128 v[176:179], v221
    ds_read_b128 v[180:183], v222
    ds_read_b128 v[184:187], v223
    buffer_load_dwordx4 v[188:191], v[218:219], s[12:15], 0 idxen offen
    buffer_load_dwordx2 v[200:201], v203, s[16:19], 0 idxen sc1
    v_cmp_lt_u32_e64 s[30:31], s6, v235
    s_add_u32 s6, s6, 1
    s_cmp_eq_u64 s[28:29], 0
    s_cbranch_scc1 K2_EMPTY
    s_waitcnt lgkmcnt(4)
    s_add_u32 m0, s94, 0
    s_nop 0
    buffer_load_dwordx4 v[210:211], s[8:11], 0 idxen offen lds
    s_add_u32 m0, s94, 1024
    s_nop 0
    buffer_load_dwordx4 v[212:213], s[8:11], 0 idxen offen lds
    s_add_u32 m0, s94, 2048
    s_nop 0
    buffer_load_dwordx4 v[214:215], s[8:11], 0 idxen offen lds
    s_add_u32 m0, s94, 3072
    s_nop 0
    buffer_load_dwordx4 v[216:217], s[8:11], 0 idxen offen lds
    v_cndmask_b32_e64 v203, 0, v207, s[30:31]
    v_add_u32 v207, v207, v206
    ds_read_b32 v218, v203
    ds_read_u16 v203, v203 offset:4
    s_waitcnt lgkmcnt(0)
    ds_bpermute_b32 v210, v239, v203 offset:0
    ds_bpermute_b32 v212, v239, v203 offset:32
    ds_bpermute_b32 v214, v239, v203 offset:64
    ds_bpermute_b32 v216, v239, v203 offset:96
    buffer_load_dwordx4 v[192:195], v[218:219], s[12:15], 0 idxen offen
    buffer_load_dwordx2 v[204:205], v203, s[16:19], 0 idxen sc1
    v_cmp_lt_u32_e64 s[32:33], s6, v235
    s_add_u32 s6, s6, 1
    s_waitcnt lgkmcnt(0)
    s_add_u32 m0, s94, 32768
    s_nop 0
    buffer_load_dwordx4 v[210:211], s[8:11], 0 idxen offen lds
    s_add_u32 m0, s94, 33792
    s_nop 0
    buffer_load_dwordx4 v[212:213], s[8:11], 0 idxen offen lds
    s_add_u32 m0, s94, 34816
    s_nop 0
    buffer_load_dwordx4 v[214:215], s[8:11], 0 idxen offen lds
    s_add_u32 m0, s94, 35840
    s_nop 0
    buffer_load_dwordx4 v[216:217], s[8:11], 0 idxen offen lds
    v_cndmask_b32_e64 v203, 0, v207, s[32:33]
    v_add_u32 v207, v207, v206
    ds_read_b32 v218, v203
    ds_read_u16 v203, v203 offset:4
    s_waitcnt lgkmcnt(0)
    ds_bpermute_b32 v210, v239, v203 offset:0
    ds_bpermute_b32 v212, v239, v203 offset:32
    ds_bpermute_b32 v214, v239, v203 offset:64
    ds_bpermute_b32 v216, v239, v203 offset:96
    v_and_b32 v221, 63, v250
    v_lshlrev_b32 v220, 4, v221
    v_lshlrev_b32 v221, 2, v221
    v_add_u32 v220, 138240, v220
    v_lshlrev_b32 v222, 3, v219
    v_add_u32 v221, 156672, v221
    v_add_u32 v222, 157696, v222
    ds_read_b128 v[140:143], v220 offset:0
    ds_read_b128 v[144:147], v220 offset:1024
    ds_read_b128 v[148:151], v220 offset:2048
    ds_read_b128 v[152:155], v220 offset:3072
    ds_read_b128 v[156:159], v220 offset:4096
    ds_read_b128 v[160:163], v220 offset:5120
    ds_read_b128 v[164:167], v220 offset:6144
    ds_read_b128 v[168:171], v220 offset:7168
    ds_read_b128 v[0:3], v220 offset:8192
    ds_read_b128 v[4:7], v220 offset:9216
    ds_read_b128 v[8:11], v220 offset:10240
    ds_read_b128 v[12:15], v220 offset:11264
    ds_read_b128 v[16:19], v220 offset:12288
    ds_read_b128 v[20:23], v220 offset:13312
    ds_read_b128 v[24:27], v220 offset:14336
    ds_read_b128 v[28:31], v220 offset:15360
    ds_read_b128 v[32:35], v220 offset:16384
    ds_read_b128 v[36:39], v220 offset:17408
    ds_read_b32 v40, v221
    ds_read_b32 v42, v221 offset:256
    ds_read_b128 v[108:111], v222 offset:0
    ds_read_b128 v[112:115], v222 offset:16
    ds_read_b128 v[116:119], v222 offset:32
    ds_read_b128 v[120:123], v222 offset:48
    ds_read_b128 v[124:127], v222 offset:64
    ds_read_b128 v[128:131], v222 offset:80
    ds_read_b128 v[132:135], v222 offset:96
    ds_read_b128 v[136:139], v222 offset:112
    v_mov_b32 v76, 0
    v_mov_b32 v77, 0
    v_mov_b32 v78, 0
    v_mov_b32 v79, 0
    v_mov_b32 v80, 0
    v_mov_b32 v81, 0
    v_mov_b32 v82, 0
    v_mov_b32 v83, 0
    v_mov_b32 v84, 0
    v_mov_b32 v85, 0
    v_mov_b32 v86, 0
    v_mov_b32 v87, 0
    v_mov_b32 v88, 0
    v_mov_b32 v89, 0
    v_mov_b32 v90, 0
    v_mov_b32 v91, 0
    v_mov_b32 v92, 0
    v_mov_b32 v93, 0
    v_mov_b32 v94, 0
    v_mov_b32 v95, 0
    v_mov_b32 v96, 0
    v_mov_b32 v97, 0
    v_mov_b32 v98, 0
    v_mov_b32 v99, 0
    v_mov_b32 v100, 0
    v_mov_b32 v101, 0
    v_mov_b32 v102, 0
    v_mov_b32 v103, 0
    v_mov_b32 v104, 0
    v_mov_b32 v105, 0
    v_mov_b32 v106, 0
    v_mov_b32 v107, 0
    v_mov_b32 v244, 0
    v_mov_b32 v245, 0
    v_mov_b32 v246, 0
    v_mov_b32 v247, 0
    s_waitcnt lgkmcnt(0)
    v_mfma_f32_32x32x16_bf16 v[44:59], v[140:143], v[172:175], 0
    v_mfma_f32_32x32x16_bf16 v[60:75], v[156:159], v[172:175], 0
    v_mfma_f32_32x32x16_bf16 v[44:59], v[144:147], v[176:179], v[44:59]
    v_mfma_f32_32x32x16_bf16 v[60:75], v[160:163], v[176:179], v[60:75]
    v_mfma_f32_32x32x16_bf16 v[44:59], v[148:151], v[180:183], v[44:59]
    v_mfma_f32_32x32x16_bf16 v[60:75], v[164:167], v[180:183], v[60:75]
    v_mfma_f32_32x32x16_bf16 v[44:59], v[152:155], v[184:187], v[44:59]
    v_mfma_f32_32x32x16_bf16 v[60:75], v[168:171], v[184:187], v[60:75]
    s_waitcnt vmcnt(6)
    ds_read_b128 v[172:175], v251 offset:0
    ds_read_b128 v[176:179], v252 offset:0
    ds_read_b128 v[180:183], v253 offset:0
    ds_read_b128 v[184:187], v254 offset:0
    v_mov_b32 v242, v241
    v_and_b32 v241, 0xffff0000, v240
    v_lshlrev_b32 v240, 16, v240
    v_lshlrev_b32 v232, 16, v200
    v_and_b32 v233, 0xffff0000, v200
    v_sub_f32 v234, v242, v201
    v_pk_add_f32 v[232:233], v[240:241], v[232:233] neg_lo:[0,1] neg_hi:[0,1]
    v_mul_f32 v208, v232, v232
    v_fmac_f32 v208, v233, v233
    v_fmac_f32 v208, v234, v234
    v_cvt_pk_bf16_f32 v208, v208, v208
    s_waitcnt lgkmcnt(0)
    s_nop 0
    v_mfma_f32_32x32x8_bf16 v[140:155], v[40:41], v[208:209], v[44:59]
    v_mfma_f32_32x32x16_bf16 v[140:155], v[32:35], v[188:191], v[140:155]
    v_mfma_f32_32x32x16_bf16 v[140:155], v[0:3], v[172:175], v[140:155]
    v_mfma_f32_32x32x16_bf16 v[140:155], v[4:7], v[176:179], v[140:155]
    v_mfma_f32_32x32x16_bf16 v[140:155], v[8:11], v[180:183], v[140:155]
    v_mfma_f32_32x32x16_bf16 v[140:155], v[12:15], v[184:187], v[140:155]
    s_nop 7
K2_LOOP:
    v_mfma_f32_32x32x8_bf16 v[156:171], v[42:43], v[208:209], v[60:75]
    s_mov_b64 exec, s[28:29]
    s_nop 1
    v_exp_f32 v220, v140
    v_exp_f32 v221, v141
    v_exp_f32 v222, v142
    v_exp_f32 v223, v143
    v_mfma_f32_32x32x16_bf16 v[156:171], v[36:39], v[188:191], v[156:171]
    v_exp_f32 v224, v144
    v_exp_f32 v225, v145
    s_bitcmp1_b32 s5, 2
    s_cbranch_scc0 K2_VP1
    s_setprio 1
K2_VP1:
    s_waitcnt lgkmcnt(0)
    s_mov_b64 exec, -1
    s_add_u32 m0, s94, 0
    s_nop 0
    buffer_load_dwordx4 v[210:211], s[8:11], 0 idxen offen lds
    s_add_u32 m0, s94, 1024
    s_nop 0
    buffer_load_dwordx4 v[212:213], s[8:11], 0 idxen offen lds
    s_add_u32 m0, s94, 2048
    s_nop 0
    buffer_load_dwordx4 v[214:215], s[8:11], 0 idxen offen lds
    s_add_u32 m0, s94, 3072
    s_nop 0
    buffer_load_dwordx4 v[216:217], s[8:11], 0 idxen offen lds
    s_mov_b64 exec, s[28:29]
    s_setprio 0
    v_exp_f32 v226, v146
    v_exp_f32 v227, v147
    v_pk_add_f32 v[220:221], v[220:221], 1.0 op_sel_hi:[1,0]
    v_pk_add_f32 v[222:223], v[222:223], 1.0 op_sel_hi:[1,0]
    v_pk_add_f32 v[224:225], v[224:225], 1.0 op_sel_hi:[1,0]
    v_pk_add_f32 v[226:227], v[226:227], 1.0 op_sel_hi:[1,0]
    v_mfma_f32_32x32x16_bf16 v[156:171], v[16:19], v[172:175], v[156:171]
    v_rcp_f32 v220, v220
    v_rcp_f32 v221, v221
    v_rcp_f32 v222, v222
    v_rcp_f32 v223, v223
    v_mfma_f32_32x32x16_bf16 v[156:171], v[20:23], v[176:179], v[156:171]
    v_rcp_f32 v224, v224
    v_rcp_f32 v225, v225
    v_rcp_f32 v226, v226
    v_rcp_f32 v227, v227
    v_pk_fma_f32 v[76:77], v[140:141], v[220:221], v[76:77]
    v_pk_fma_f32 v[78:79], v[142:143], v[222:223], v[78:79]
    v_pk_fma_f32 v[80:81], v[144:145], v[224:225], v[80:81]
    v_pk_fma_f32 v[82:83], v[146:147], v[226:227], v[82:83]
    v_pk_mul_f32 v[228:229], v[76:77], v[108:109]
    v_pk_mul_f32 v[230:231], v[78:79], v[110:111]
    v_pk_fma_f32 v[228:229], v[80:81], v[112:113], v[228:229]
    v_pk_fma_f32 v[230:231], v[82:83], v[114:115], v[230:231]
    v_mfma_f32_32x32x16_bf16 v[156:171], v[24:27], v[180:183], v[156:171]
    v_exp_f32 v220, v148
    v_exp_f32 v221, v149
    v_exp_f32 v222, v150
    v_exp_f32 v223, v151
    v_mfma_f32_32x32x16_bf16 v[156:171], v[28:31], v[184:187], v[156:171]
    v_exp_f32 v224, v152
    v_exp_f32 v225, v153
    v_exp_f32 v226, v154
    buffer_load_dwordx4 v[188:191], v[218:219], s[12:15], 0 idxen offen
    buffer_load_dwordx2 v[200:201], v203, s[16:19], 0 idxen sc1
    v_exp_f32 v227, v155
    s_waitcnt vmcnt(6)
    ds_read_b128 v[172:175], v251 offset:32768
    ds_read_b128 v[176:179], v252 offset:32768
    ds_read_b128 v[180:183], v253 offset:32768
    ds_read_b128 v[184:187], v254 offset:32768
    v_cmp_lt_u32_e64 s[34:35], s6, v235
    s_add_u32 s6, s6, 1
    v_lshlrev_b32 v236, 16, v204
    v_and_b32 v237, 0xffff0000, v204
    v_sub_f32 v238, v242, v205
    v_pk_add_f32 v[236:237], v[240:241], v[236:237] neg_lo:[0,1] neg_hi:[0,1]
    v_mul_f32 v208, v236, v236
    v_fmac_f32 v208, v237, v237
    v_fmac_f32 v208, v238, v238
    v_cvt_pk_bf16_f32 v208, v208, v208
    v_cndmask_b32_e64 v203, 0, v207, s[34:35]
    v_add_u32 v207, v207, v206
    ds_read_b32 v218, v203
    ds_read_u16 v203, v203 offset:4
    v_pk_add_f32 v[220:221], v[220:221], 1.0 op_sel_hi:[1,0]
    v_pk_add_f32 v[222:223], v[222:223], 1.0 op_sel_hi:[1,0]
    v_pk_add_f32 v[224:225], v[224:225], 1.0 op_sel_hi:[1,0]
    v_pk_add_f32 v[226:227], v[226:227], 1.0 op_sel_hi:[1,0]
    v_rcp_f32 v220, v220
    v_rcp_f32 v221, v221
    v_rcp_f32 v222, v222
    v_rcp_f32 v223, v223
    v_rcp_f32 v224, v224
    v_rcp_f32 v225, v225
    v_rcp_f32 v226, v226
    v_rcp_f32 v227, v227
    s_waitcnt lgkmcnt(0)
    s_mov_b64 exec, -1
    ds_bpermute_b32 v210, v239, v203 offset:0
    ds_bpermute_b32 v212, v239, v203 offset:32
    ds_bpermute_b32 v214, v239, v203 offset:64
    ds_bpermute_b32 v216, v239, v203 offset:96
    s_mov_b64 exec, s[28:29]
    v_pk_fma_f32 v[84:85], v[148:149], v[220:221], v[84:85]
    v_pk_fma_f32 v[86:87], v[150:151], v[222:223], v[86:87]
    v_pk_fma_f32 v[88:89], v[152:153], v[224:225], v[88:89]
    v_pk_fma_f32 v[90:91], v[154:155], v[226:227], v[90:91]
    v_pk_fma_f32 v[228:229], v[84:85], v[116:117], v[228:229]
    v_pk_fma_f32 v[230:231], v[86:87], v[118:119], v[230:231]
    v_pk_fma_f32 v[228:229], v[88:89], v[120:121], v[228:229]
    v_pk_fma_f32 v[230:231], v[90:91], v[122:123], v[230:231]
    v_mfma_f32_32x32x8_bf16 v[140:155], v[40:41], v[208:209], v[44:59]
    v_exp_f32 v220, v156
    v_exp_f32 v221, v157
    v_exp_f32 v222, v158
    v_exp_f32 v223, v159
    v_mfma_f32_32x32x16_bf16 v[140:155], v[32:35], v[192:195], v[140:155]
    v_exp_f32 v224, v160
    v_exp_f32 v225, v161
    v_exp_f32 v226, v162
    v_exp_f32 v227, v163
    v_pk_add_f32 v[220:221], v[220:221], 1.0 op_sel_hi:[1,0]
    v_pk_add_f32 v[222:223], v[222:223], 1.0 op_sel_hi:[1,0]
    v_pk_add_f32 v[224:225], v[224:225], 1.0 op_sel_hi:[1,0]
    v_pk_add_f32 v[226:227], v[226:227], 1.0 op_sel_hi:[1,0]
    v_mfma_f32_32x32x16_bf16 v[140:155], v[0:3], v[172:175], v[140:155]
    v_rcp_f32 v220, v220
    v_rcp_f32 v221, v221
    v_rcp_f32 v222, v222
    v_rcp_f32 v223, v223
    v_mfma_f32_32x32x16_bf16 v[140:155], v[4:7], v[176:179], v[140:155]
    v_rcp_f32 v224, v224
    v_rcp_f32 v225, v225
    v_rcp_f32 v226, v226
    v_rcp_f32 v227, v227
    v_pk_fma_f32 v[92:93], v[156:157], v[220:221], v[92:93]
    v_pk_fma_f32 v[94:95], v[158:159], v[222:223], v[94:95]
    v_pk_fma_f32 v[96:97], v[160:161], v[224:225], v[96:97]
    v_pk_fma_f32 v[98:99], v[162:163], v[226:227], v[98:99]
    v_pk_fma_f32 v[228:229], v[92:93], v[124:125], v[228:229]
    v_pk_fma_f32 v[230:231], v[94:95], v[126:127], v[230:231]
    v_pk_fma_f32 v[228:229], v[96:97], v[128:129], v[228:229]
    v_pk_fma_f32 v[230:231], v[98:99], v[130:131], v[230:231]
    v_mfma_f32_32x32x16_bf16 v[140:155], v[8:11], v[180:183], v[140:155]
    v_exp_f32 v220, v164
    v_exp_f32 v221, v165
    v_exp_f32 v222, v166
    v_exp_f32 v223, v167
    v_mfma_f32_32x32x16_bf16 v[140:155], v[12:15], v[184:187], v[140:155]
    v_exp_f32 v224, v168
    v_exp_f32 v225, v169
    v_exp_f32 v226, v170
    v_exp_f32 v227, v171
    v_pk_add_f32 v[220:221], v[220:221], 1.0 op_sel_hi:[1,0]
    v_pk_add_f32 v[222:223], v[222:223], 1.0 op_sel_hi:[1,0]
    v_pk_add_f32 v[224:225], v[224:225], 1.0 op_sel_hi:[1,0]
    v_pk_add_f32 v[226:227], v[226:227], 1.0 op_sel_hi:[1,0]
    v_rcp_f32 v220, v220
    v_rcp_f32 v221, v221
    v_rcp_f32 v222, v222
    v_rcp_f32 v223, v223
    v_rcp_f32 v224, v224
    v_rcp_f32 v225, v225
    v_rcp_f32 v226, v226
    v_rcp_f32 v227, v227
    v_pk_fma_f32 v[100:101], v[164:165], v[220:221], v[100:101]
    v_pk_fma_f32 v[102:103], v[166:167], v[222:223], v[102:103]
    v_pk_fma_f32 v[104:105], v[168:169], v[224:225], v[104:105]
    v_pk_fma_f32 v[106:107], v[170:171], v[226:227], v[106:107]
    v_pk_fma_f32 v[228:229], v[100:101], v[132:133], v[228:229]
    v_pk_fma_f32 v[230:231], v[102:103], v[134:135], v[230:231]
    v_pk_fma_f32 v[228:229], v[104:105], v[136:137], v[228:229]
    v_pk_fma_f32 v[230:231], v[106:107], v[138:139], v[230:231]
    v_pk_add_f32 v[228:229], v[228:229], v[230:231]
    s_cmp_eq_u64 s[30:31], 0
    v_add_f32 v243, v228, v229
    v_sub_f32 v248, v243, v247
    v_pk_fma_f32 v[244:245], v[232:233], v[248:249], v[244:245] op_sel_hi:[1,0,1]
    v_fmac_f32 v246, v234, v248
    s_mov_b64 exec, -1
    s_cbranch_scc1 K2_DONE
    v_mfma_f32_32x32x8_bf16 v[156:171], v[42:43], v[208:209], v[60:75]
    s_mov_b64 exec, s[30:31]
    v_exp_f32 v220, v140
    v_exp_f32 v221, v141
    v_exp_f32 v222, v142
    v_exp_f32 v223, v143
    v_mfma_f32_32x32x16_bf16 v[156:171], v[36:39], v[192:195], v[156:171]
    v_exp_f32 v224, v144
    v_exp_f32 v225, v145
    s_bitcmp1_b32 s5, 2
    s_cbranch_scc0 K2_VP3
    s_setprio 1
K2_VP3:
    s_waitcnt lgkmcnt(0)
    s_mov_b64 exec, -1
    s_add_u32 m0, s94, 32768
    s_nop 0
    buffer_load_dwordx4 v[210:211], s[8:11], 0 idxen offen lds
    s_add_u32 m0, s94, 33792
    s_nop 0
    buffer_load_dwordx4 v[212:213], s[8:11], 0 idxen offen lds
    s_add_u32 m0, s94, 34816
    s_nop 0
    buffer_load_dwordx4 v[214:215], s[8:11], 0 idxen offen lds
    s_add_u32 m0, s94, 35840
    s_nop 0
    buffer_load_dwordx4 v[216:217], s[8:11], 0 idxen offen lds
    s_mov_b64 exec, s[30:31]
    s_setprio 0
    v_exp_f32 v226, v146
    v_exp_f32 v227, v147
    v_pk_add_f32 v[220:221], v[220:221], 1.0 op_sel_hi:[1,0]
    v_pk_add_f32 v[222:223], v[222:223], 1.0 op_sel_hi:[1,0]
    v_pk_add_f32 v[224:225], v[224:225], 1.0 op_sel_hi:[1,0]
    v_pk_add_f32 v[226:227], v[226:227], 1.0 op_sel_hi:[1,0]
    v_mfma_f32_32x32x16_bf16 v[156:171], v[16:19], v[172:175], v[156:171]
    v_rcp_f32 v220, v220
    v_rcp_f32 v221, v221
    v_rcp_f32 v222, v222
    v_rcp_f32 v223, v223
    v_mfma_f32_32x32x16_bf16 v[156:171], v[20:23], v[176:179], v[156:171]
    v_rcp_f32 v224, v224
    v_rcp_f32 v225, v225
    v_rcp_f32 v226, v226
    v_rcp_f32 v227, v227
    v_pk_fma_f32 v[76:77], v[140:141], v[220:221], v[76:77]
    v_pk_fma_f32 v[78:79], v[142:143], v[222:223], v[78:79]
    v_pk_fma_f32 v[80:81], v[144:145], v[224:225], v[80:81]
    v_pk_fma_f32 v[82:83], v[146:147], v[226:227], v[82:83]
    v_pk_mul_f32 v[228:229], v[76:77], v[108:109]
    v_pk_mul_f32 v[230:231], v[78:79], v[110:111]
    v_pk_fma_f32 v[228:229], v[80:81], v[112:113], v[228:229]
    v_pk_fma_f32 v[230:231], v[82:83], v[114:115], v[230:231]
    v_mfma_f32_32x32x16_bf16 v[156:171], v[24:27], v[180:183], v[156:171]
    v_exp_f32 v220, v148
    v_exp_f32 v221, v149
    v_exp_f32 v222, v150
    v_exp_f32 v223, v151
    v_mfma_f32_32x32x16_bf16 v[156:171], v[28:31], v[184:187], v[156:171]
    v_exp_f32 v224, v152
    v_exp_f32 v225, v153
    v_exp_f32 v226, v154
    buffer_load_dwordx4 v[192:195], v[218:219], s[12:15], 0 idxen offen
    buffer_load_dwordx2 v[204:205], v203, s[16:19], 0 idxen sc1
    v_exp_f32 v227, v155
    s_waitcnt vmcnt(6)
    ds_read_b128 v[172:175], v251 offset:0
    ds_read_b128 v[176:179], v252 offset:0
    ds_read_b128 v[180:183], v253 offset:0
    ds_read_b128 v[184:187], v254 offset:0
    v_cmp_lt_u32_e64 s[36:37], s6, v235
    s_add_u32 s6, s6, 1
    v_lshlrev_b32 v232, 16, v200
    v_and_b32 v233, 0xffff0000, v200
    v_sub_f32 v234, v242, v201
    v_pk_add_f32 v[232:233], v[240:241], v[232:233] neg_lo:[0,1] neg_hi:[0,1]
    v_mul_f32 v208, v232, v232
    v_fmac_f32 v208, v233, v233
    v_fmac_f32 v208, v234, v234
    v_cvt_pk_bf16_f32 v208, v208, v208
    v_cndmask_b32_e64 v203, 0, v207, s[36:37]
    v_add_u32 v207, v207, v206
    ds_read_b32 v218, v203
    ds_read_u16 v203, v203 offset:4
    v_pk_add_f32 v[220:221], v[220:221], 1.0 op_sel_hi:[1,0]
    v_pk_add_f32 v[222:223], v[222:223], 1.0 op_sel_hi:[1,0]
    v_pk_add_f32 v[224:225], v[224:225], 1.0 op_sel_hi:[1,0]
    v_pk_add_f32 v[226:227], v[226:227], 1.0 op_sel_hi:[1,0]
    v_rcp_f32 v220, v220
    v_rcp_f32 v221, v221
    v_rcp_f32 v222, v222
    v_rcp_f32 v223, v223
    v_rcp_f32 v224, v224
    v_rcp_f32 v225, v225
    v_rcp_f32 v226, v226
    v_rcp_f32 v227, v227
    s_waitcnt lgkmcnt(0)
    s_mov_b64 exec, -1
    ds_bpermute_b32 v210, v239, v203 offset:0
    ds_bpermute_b32 v212, v239, v203 offset:32
    ds_bpermute_b32 v214, v239, v203 offset:64
    ds_bpermute_b32 v216, v239, v203 offset:96
    s_mov_b64 exec, s[30:31]
    v_pk_fma_f32 v[84:85], v[148:149], v[220:221], v[84:85]
    v_pk_fma_f32 v[86:87], v[150:151], v[222:223], v[86:87]
    v_pk_fma_f32 v[88:89], v[152:153], v[224:225], v[88:89]
    v_pk_fma_f32 v[90:91], v[154:155], v[226:227], v[90:91]
    v_pk_fma_f32 v[228:229], v[84:85], v[116:117], v[228:229]
    v_pk_fma_f32 v[230:231], v[86:87], v[118:119], v[230:231]
    v_pk_fma_f32 v[228:229], v[88:89], v[120:121], v[228:229]
    v_pk_fma_f32 v[230:231], v[90:91], v[122:123], v[230:231]
    v_mfma_f32_32x32x8_bf16 v[140:155], v[40:41], v[208:209], v[44:59]
    v_exp_f32 v220, v156
    v_exp_f32 v221, v157
    v_exp_f32 v222, v158
    v_exp_f32 v223, v159
    v_mfma_f32_32x32x16_bf16 v[140:155], v[32:35], v[188:191], v[140:155]
    v_exp_f32 v224, v160
    v_exp_f32 v225, v161
    v_exp_f32 v226, v162
    v_exp_f32 v227, v163
    v_pk_add_f32 v[220:221], v[220:221], 1.0 op_sel_hi:[1,0]
    v_pk_add_f32 v[222:223], v[222:223], 1.0 op_sel_hi:[1,0]
    v_pk_add_f32 v[224:225], v[224:225], 1.0 op_sel_hi:[1,0]
    v_pk_add_f32 v[226:227], v[226:227], 1.0 op_sel_hi:[1,0]
    v_mfma_f32_32x32x16_bf16 v[140:155], v[0:3], v[172:175], v[140:155]
    v_rcp_f32 v220, v220
    v_rcp_f32 v221, v221
    v_rcp_f32 v222, v222
    v_rcp_f32 v223, v223
    v_mfma_f32_32x32x16_bf16 v[140:155], v[4:7], v[176:179], v[140:155]
    v_rcp_f32 v224, v224
    v_rcp_f32 v225, v225
    v_rcp_f32 v226, v226
    v_rcp_f32 v227, v227
    v_pk_fma_f32 v[92:93], v[156:157], v[220:221], v[92:93]
    v_pk_fma_f32 v[94:95], v[158:159], v[222:223], v[94:95]
    v_pk_fma_f32 v[96:97], v[160:161], v[224:225], v[96:97]
    v_pk_fma_f32 v[98:99], v[162:163], v[226:227], v[98:99]
    v_pk_fma_f32 v[228:229], v[92:93], v[124:125], v[228:229]
    v_pk_fma_f32 v[230:231], v[94:95], v[126:127], v[230:231]
    v_pk_fma_f32 v[228:229], v[96:97], v[128:129], v[228:229]
    v_pk_fma_f32 v[230:231], v[98:99], v[130:131], v[230:231]
    v_mfma_f32_32x32x16_bf16 v[140:155], v[8:11], v[180:183], v[140:155]
    v_exp_f32 v220, v164
    v_exp_f32 v221, v165
    v_exp_f32 v222, v166
    v_exp_f32 v223, v167
    v_mfma_f32_32x32x16_bf16 v[140:155], v[12:15], v[184:187], v[140:155]
    v_exp_f32 v224, v168
    v_exp_f32 v225, v169
    v_exp_f32 v226, v170
    v_exp_f32 v227, v171
    v_pk_add_f32 v[220:221], v[220:221], 1.0 op_sel_hi:[1,0]
    v_pk_add_f32 v[222:223], v[222:223], 1.0 op_sel_hi:[1,0]
    v_pk_add_f32 v[224:225], v[224:225], 1.0 op_sel_hi:[1,0]
    v_pk_add_f32 v[226:227], v[226:227], 1.0 op_sel_hi:[1,0]
    v_rcp_f32 v220, v220
    v_rcp_f32 v221, v221
    v_rcp_f32 v222, v222
    v_rcp_f32 v223, v223
    v_rcp_f32 v224, v224
    v_rcp_f32 v225, v225
    v_rcp_f32 v226, v226
    v_rcp_f32 v227, v227
    v_pk_fma_f32 v[100:101], v[164:165], v[220:221], v[100:101]
    v_pk_fma_f32 v[102:103], v[166:167], v[222:223], v[102:103]
    v_pk_fma_f32 v[104:105], v[168:169], v[224:225], v[104:105]
    v_pk_fma_f32 v[106:107], v[170:171], v[226:227], v[106:107]
    v_pk_fma_f32 v[228:229], v[100:101], v[132:133], v[228:229]
    v_pk_fma_f32 v[230:231], v[102:103], v[134:135], v[230:231]
    v_pk_fma_f32 v[228:229], v[104:105], v[136:137], v[228:229]
    v_pk_fma_f32 v[230:231], v[106:107], v[138:139], v[230:231]
    v_pk_add_f32 v[228:229], v[228:229], v[230:231]
    s_cmp_eq_u64 s[32:33], 0
    v_add_f32 v247, v228, v229
    v_sub_f32 v248, v247, v243
    v_pk_fma_f32 v[244:245], v[236:237], v[248:249], v[244:245] op_sel_hi:[1,0,1]
    v_fmac_f32 v246, v238, v248
    s_mov_b64 exec, -1
    s_cbranch_scc1 K2_DONE
    v_mfma_f32_32x32x8_bf16 v[156:171], v[42:43], v[208:209], v[60:75]
    s_mov_b64 exec, s[32:33]
    v_exp_f32 v220, v140
    v_exp_f32 v221, v141
    v_exp_f32 v222, v142
    v_exp_f32 v223, v143
    v_mfma_f32_32x32x16_bf16 v[156:171], v[36:39], v[188:191], v[156:171]
    v_exp_f32 v224, v144
    v_exp_f32 v225, v145
    s_bitcmp1_b32 s5, 2
    s_cbranch_scc0 K2_VP5
    s_setprio 1
K2_VP5:
    s_waitcnt lgkmcnt(0)
    s_mov_b64 exec, -1
    s_add_u32 m0, s94, 0
    s_nop 0
    buffer_load_dwordx4 v[210:211], s[8:11], 0 idxen offen lds
    s_add_u32 m0, s94, 1024
    s_nop 0
    buffer_load_dwordx4 v[212:213], s[8:11], 0 idxen offen lds
    s_add_u32 m0, s94, 2048
    s_nop 0
    buffer_load_dwordx4 v[214:215], s[8:11], 0 idxen offen lds
    s_add_u32 m0, s94, 3072
    s_nop 0
    buffer_load_dwordx4 v[216:217], s[8:11], 0 idxen offen lds
    s_mov_b64 exec, s[32:33]
    s_setprio 0
    v_exp_f32 v226, v146
    v_exp_f32 v227, v147
    v_pk_add_f32 v[220:221], v[220:221], 1.0 op_sel_hi:[1,0]
    v_pk_add_f32 v[222:223], v[222:223], 1.0 op_sel_hi:[1,0]
    v_pk_add_f32 v[224:225], v[224:225], 1.0 op_sel_hi:[1,0]
    v_pk_add_f32 v[226:227], v[226:227], 1.0 op_sel_hi:[1,0]
    v_mfma_f32_32x32x16_bf16 v[156:171], v[16:19], v[172:175], v[156:171]
    v_rcp_f32 v220, v220
    v_rcp_f32 v221, v221
    v_rcp_f32 v222, v222
    v_rcp_f32 v223, v223
    v_mfma_f32_32x32x16_bf16 v[156:171], v[20:23], v[176:179], v[156:171]
    v_rcp_f32 v224, v224
    v_rcp_f32 v225, v225
    v_rcp_f32 v226, v226
    v_rcp_f32 v227, v227
    v_pk_fma_f32 v[76:77], v[140:141], v[220:221], v[76:77]
    v_pk_fma_f32 v[78:79], v[142:143], v[222:223], v[78:79]
    v_pk_fma_f32 v[80:81], v[144:145], v[224:225], v[80:81]
    v_pk_fma_f32 v[82:83], v[146:147], v[226:227], v[82:83]
    v_pk_mul_f32 v[228:229], v[76:77], v[108:109]
    v_pk_mul_f32 v[230:231], v[78:79], v[110:111]
    v_pk_fma_f32 v[228:229], v[80:81], v[112:113], v[228:229]
    v_pk_fma_f32 v[230:231], v[82:83], v[114:115], v[230:231]
    v_mfma_f32_32x32x16_bf16 v[156:171], v[24:27], v[180:183], v[156:171]
    v_exp_f32 v220, v148
    v_exp_f32 v221, v149
    v_exp_f32 v222, v150
    v_exp_f32 v223, v151
    v_mfma_f32_32x32x16_bf16 v[156:171], v[28:31], v[184:187], v[156:171]
    v_exp_f32 v224, v152
    v_exp_f32 v225, v153
    v_exp_f32 v226, v154
    buffer_load_dwordx4 v[188:191], v[218:219], s[12:15], 0 idxen offen
    buffer_load_dwordx2 v[200:201], v203, s[16:19], 0 idxen sc1
    v_exp_f32 v227, v155
    s_waitcnt vmcnt(6)
    ds_read_b128 v[172:175], v251 offset:32768
    ds_read_b128 v[176:179], v252 offset:32768
    ds_read_b128 v[180:183], v253 offset:32768
    ds_read_b128 v[184:187], v254 offset:32768
    v_cmp_lt_u32_e64 s[38:39], s6, v235
    s_add_u32 s6, s6, 1
    v_lshlrev_b32 v236, 16, v204
    v_and_b32 v237, 0xffff0000, v204
    v_sub_f32 v238, v242, v205
    v_pk_add_f32 v[236:237], v[240:241], v[236:237] neg_lo:[0,1] neg_hi:[0,1]
    v_mul_f32 v208, v236, v236
    v_fmac_f32 v208, v237, v237
    v_fmac_f32 v208, v238, v238
    v_cvt_pk_bf16_f32 v208, v208, v208
    v_cndmask_b32_e64 v203, 0, v207, s[38:39]
    v_add_u32 v207, v207, v206
    ds_read_b32 v218, v203
    ds_read_u16 v203, v203 offset:4
    v_pk_add_f32 v[220:221], v[220:221], 1.0 op_sel_hi:[1,0]
    v_pk_add_f32 v[222:223], v[222:223], 1.0 op_sel_hi:[1,0]
    v_pk_add_f32 v[224:225], v[224:225], 1.0 op_sel_hi:[1,0]
    v_pk_add_f32 v[226:227], v[226:227], 1.0 op_sel_hi:[1,0]
    v_rcp_f32 v220, v220
    v_rcp_f32 v221, v221
    v_rcp_f32 v222, v222
    v_rcp_f32 v223, v223
    v_rcp_f32 v224, v224
    v_rcp_f32 v225, v225
    v_rcp_f32 v226, v226
    v_rcp_f32 v227, v227
    s_waitcnt lgkmcnt(0)
    s_mov_b64 exec, -1
    ds_bpermute_b32 v210, v239, v203 offset:0
    ds_bpermute_b32 v212, v239, v203 offset:32
    ds_bpermute_b32 v214, v239, v203 offset:64
    ds_bpermute_b32 v216, v239, v203 offset:96
    s_mov_b64 exec, s[32:33]
    v_pk_fma_f32 v[84:85], v[148:149], v[220:221], v[84:85]
    v_pk_fma_f32 v[86:87], v[150:151], v[222:223], v[86:87]
    v_pk_fma_f32 v[88:89], v[152:153], v[224:225], v[88:89]
    v_pk_fma_f32 v[90:91], v[154:155], v[226:227], v[90:91]
    v_pk_fma_f32 v[228:229], v[84:85], v[116:117], v[228:229]
    v_pk_fma_f32 v[230:231], v[86:87], v[118:119], v[230:231]
    v_pk_fma_f32 v[228:229], v[88:89], v[120:121], v[228:229]
    v_pk_fma_f32 v[230:231], v[90:91], v[122:123], v[230:231]
    v_mfma_f32_32x32x8_bf16 v[140:155], v[40:41], v[208:209], v[44:59]
    v_exp_f32 v220, v156
    v_exp_f32 v221, v157
    v_exp_f32 v222, v158
    v_exp_f32 v223, v159
    v_mfma_f32_32x32x16_bf16 v[140:155], v[32:35], v[192:195], v[140:155]
    v_exp_f32 v224, v160
    v_exp_f32 v225, v161
    v_exp_f32 v226, v162
    v_exp_f32 v227, v163
    v_pk_add_f32 v[220:221], v[220:221], 1.0 op_sel_hi:[1,0]
    v_pk_add_f32 v[222:223], v[222:223], 1.0 op_sel_hi:[1,0]
    v_pk_add_f32 v[224:225], v[224:225], 1.0 op_sel_hi:[1,0]
    v_pk_add_f32 v[226:227], v[226:227], 1.0 op_sel_hi:[1,0]
    v_mfma_f32_32x32x16_bf16 v[140:155], v[0:3], v[172:175], v[140:155]
    v_rcp_f32 v220, v220
    v_rcp_f32 v221, v221
    v_rcp_f32 v222, v222
    v_rcp_f32 v223, v223
    v_mfma_f32_32x32x16_bf16 v[140:155], v[4:7], v[176:179], v[140:155]
    v_rcp_f32 v224, v224
    v_rcp_f32 v225, v225
    v_rcp_f32 v226, v226
    v_rcp_f32 v227, v227
    v_pk_fma_f32 v[92:93], v[156:157], v[220:221], v[92:93]
    v_pk_fma_f32 v[94:95], v[158:159], v[222:223], v[94:95]
    v_pk_fma_f32 v[96:97], v[160:161], v[224:225], v[96:97]
    v_pk_fma_f32 v[98:99], v[162:163], v[226:227], v[98:99]
    v_pk_fma_f32 v[228:229], v[92:93], v[124:125], v[228:229]
    v_pk_fma_f32 v[230:231], v[94:95], v[126:127], v[230:231]
    v_pk_fma_f32 v[228:229], v[96:97], v[128:129], v[228:229]
    v_pk_fma_f32 v[230:231], v[98:99], v[130:131], v[230:231]
    v_mfma_f32_32x32x16_bf16 v[140:155], v[8:11], v[180:183], v[140:155]
    v_exp_f32 v220, v164
    v_exp_f32 v221, v165
    v_exp_f32 v222, v166
    v_exp_f32 v223, v167
    v_mfma_f32_32x32x16_bf16 v[140:155], v[12:15], v[184:187], v[140:155]
    v_exp_f32 v224, v168
    v_exp_f32 v225, v169
    v_exp_f32 v226, v170
    v_exp_f32 v227, v171
    v_pk_add_f32 v[220:221], v[220:221], 1.0 op_sel_hi:[1,0]
    v_pk_add_f32 v[222:223], v[222:223], 1.0 op_sel_hi:[1,0]
    v_pk_add_f32 v[224:225], v[224:225], 1.0 op_sel_hi:[1,0]
    v_pk_add_f32 v[226:227], v[226:227], 1.0 op_sel_hi:[1,0]
    v_rcp_f32 v220, v220
    v_rcp_f32 v221, v221
    v_rcp_f32 v222, v222
    v_rcp_f32 v223, v223
    v_rcp_f32 v224, v224
    v_rcp_f32 v225, v225
    v_rcp_f32 v226, v226
    v_rcp_f32 v227, v227
    v_pk_fma_f32 v[100:101], v[164:165], v[220:221], v[100:101]
    v_pk_fma_f32 v[102:103], v[166:167], v[222:223], v[102:103]
    v_pk_fma_f32 v[104:105], v[168:169], v[224:225], v[104:105]
    v_pk_fma_f32 v[106:107], v[170:171], v[226:227], v[106:107]
    v_pk_fma_f32 v[228:229], v[100:101], v[132:133], v[228:229]
    v_pk_fma_f32 v[230:231], v[102:103], v[134:135], v[230:231]
    v_pk_fma_f32 v[228:229], v[104:105], v[136:137], v[228:229]
    v_pk_fma_f32 v[230:231], v[106:107], v[138:139], v[230:231]
    v_pk_add_f32 v[228:229], v[228:229], v[230:231]
    s_cmp_eq_u64 s[34:35], 0
    v_add_f32 v243, v228, v229
    v_sub_f32 v248, v243, v247
    v_pk_fma_f32 v[244:245], v[232:233], v[248:249], v[244:245] op_sel_hi:[1,0,1]
    v_fmac_f32 v246, v234, v248
    s_mov_b64 exec, -1
    s_cbranch_scc1 K2_DONE
    v_mfma_f32_32x32x8_bf16 v[156:171], v[42:43], v[208:209], v[60:75]
    s_mov_b64 exec, s[34:35]
    v_exp_f32 v220, v140
    v_exp_f32 v221, v141
    v_exp_f32 v222, v142
    v_exp_f32 v223, v143
    v_mfma_f32_32x32x16_bf16 v[156:171], v[36:39], v[192:195], v[156:171]
    v_exp_f32 v224, v144
    v_exp_f32 v225, v145
    s_bitcmp1_b32 s5, 2
    s_cbranch_scc0 K2_VP7
    s_setprio 1
K2_VP7:
    s_waitcnt lgkmcnt(0)
    s_mov_b64 exec, -1
    s_add_u32 m0, s94, 32768
    s_nop 0
    buffer_load_dwordx4 v[210:211], s[8:11], 0 idxen offen lds
    s_add_u32 m0, s94, 33792
    s_nop 0
    buffer_load_dwordx4 v[212:213], s[8:11], 0 idxen offen lds
    s_add_u32 m0, s94, 34816
    s_nop 0
    buffer_load_dwordx4 v[214:215], s[8:11], 0 idxen offen lds
    s_add_u32 m0, s94, 35840
    s_nop 0
    buffer_load_dwordx4 v[216:217], s[8:11], 0 idxen offen lds
    s_mov_b64 exec, s[34:35]
    s_setprio 0
    v_exp_f32 v226, v146
    v_exp_f32 v227, v147
    v_pk_add_f32 v[220:221], v[220:221], 1.0 op_sel_hi:[1,0]
    v_pk_add_f32 v[222:223], v[222:223], 1.0 op_sel_hi:[1,0]
    v_pk_add_f32 v[224:225], v[224:225], 1.0 op_sel_hi:[1,0]
    v_pk_add_f32 v[226:227], v[226:227], 1.0 op_sel_hi:[1,0]
    v_mfma_f32_32x32x16_bf16 v[156:171], v[16:19], v[172:175], v[156:171]
    v_rcp_f32 v220, v220
    v_rcp_f32 v221, v221
    v_rcp_f32 v222, v222
    v_rcp_f32 v223, v223
    v_mfma_f32_32x32x16_bf16 v[156:171], v[20:23], v[176:179], v[156:171]
    v_rcp_f32 v224, v224
    v_rcp_f32 v225, v225
    v_rcp_f32 v226, v226
    v_rcp_f32 v227, v227
    v_pk_fma_f32 v[76:77], v[140:141], v[220:221], v[76:77]
    v_pk_fma_f32 v[78:79], v[142:143], v[222:223], v[78:79]
    v_pk_fma_f32 v[80:81], v[144:145], v[224:225], v[80:81]
    v_pk_fma_f32 v[82:83], v[146:147], v[226:227], v[82:83]
    v_pk_mul_f32 v[228:229], v[76:77], v[108:109]
    v_pk_mul_f32 v[230:231], v[78:79], v[110:111]
    v_pk_fma_f32 v[228:229], v[80:81], v[112:113], v[228:229]
    v_pk_fma_f32 v[230:231], v[82:83], v[114:115], v[230:231]
    v_mfma_f32_32x32x16_bf16 v[156:171], v[24:27], v[180:183], v[156:171]
    v_exp_f32 v220, v148
    v_exp_f32 v221, v149
    v_exp_f32 v222, v150
    v_exp_f32 v223, v151
    v_mfma_f32_32x32x16_bf16 v[156:171], v[28:31], v[184:187], v[156:171]
    v_exp_f32 v224, v152
    v_exp_f32 v225, v153
    v_exp_f32 v226, v154
    buffer_load_dwordx4 v[192:195], v[218:219], s[12:15], 0 idxen offen
    buffer_load_dwordx2 v[204:205], v203, s[16:19], 0 idxen sc1
    v_exp_f32 v227, v155
    s_waitcnt vmcnt(6)
    ds_read_b128 v[172:175], v251 offset:0
    ds_read_b128 v[176:179], v252 offset:0
    ds_read_b128 v[180:183], v253 offset:0
    ds_read_b128 v[184:187], v254 offset:0
    v_cmp_lt_u32_e64 s[28:29], s6, v235
    s_add_u32 s6, s6, 1
    v_lshlrev_b32 v232, 16, v200
    v_and_b32 v233, 0xffff0000, v200
    v_sub_f32 v234, v242, v201
    v_pk_add_f32 v[232:233], v[240:241], v[232:233] neg_lo:[0,1] neg_hi:[0,1]
    v_mul_f32 v208, v232, v232
    v_fmac_f32 v208, v233, v233
    v_fmac_f32 v208, v234, v234
    v_cvt_pk_bf16_f32 v208, v208, v208
    v_cndmask_b32_e64 v203, 0, v207, s[28:29]
    v_add_u32 v207, v207, v206
    ds_read_b32 v218, v203
    ds_read_u16 v203, v203 offset:4
    v_pk_add_f32 v[220:221], v[220:221], 1.0 op_sel_hi:[1,0]
    v_pk_add_f32 v[222:223], v[222:223], 1.0 op_sel_hi:[1,0]
    v_pk_add_f32 v[224:225], v[224:225], 1.0 op_sel_hi:[1,0]
    v_pk_add_f32 v[226:227], v[226:227], 1.0 op_sel_hi:[1,0]
    v_rcp_f32 v220, v220
    v_rcp_f32 v221, v221
    v_rcp_f32 v222, v222
    v_rcp_f32 v223, v223
    v_rcp_f32 v224, v224
    v_rcp_f32 v225, v225
    v_rcp_f32 v226, v226
    v_rcp_f32 v227, v227
    s_waitcnt lgkmcnt(0)
    s_mov_b64 exec, -1
    ds_bpermute_b32 v210, v239, v203 offset:0
    ds_bpermute_b32 v212, v239, v203 offset:32
    ds_bpermute_b32 v214, v239, v203 offset:64
    ds_bpermute_b32 v216, v239, v203 offset:96
    s_mov_b64 exec, s[34:35]
    v_pk_fma_f32 v[84:85], v[148:149], v[220:221], v[84:85]
    v_pk_fma_f32 v[86:87], v[150:151], v[222:223], v[86:87]
    v_pk_fma_f32 v[88:89], v[152:153], v[224:225], v[88:89]
    v_pk_fma_f32 v[90:91], v[154:155], v[226:227], v[90:91]
    v_pk_fma_f32 v[228:229], v[84:85], v[116:117], v[228:229]
    v_pk_fma_f32 v[230:231], v[86:87], v[118:119], v[230:231]
    v_pk_fma_f32 v[228:229], v[88:89], v[120:121], v[228:229]
    v_pk_fma_f32 v[230:231], v[90:91], v[122:123], v[230:231]
    v_mfma_f32_32x32x8_bf16 v[140:155], v[40:41], v[208:209], v[44:59]
    v_exp_f32 v220, v156
    v_exp_f32 v221, v157
    v_exp_f32 v222, v158
    v_exp_f32 v223, v159
    v_mfma_f32_32x32x16_bf16 v[140:155], v[32:35], v[188:191], v[140:155]
    v_exp_f32 v224, v160
    v_exp_f32 v225, v161
    v_exp_f32 v226, v162
    v_exp_f32 v227, v163
    v_pk_add_f32 v[220:221], v[220:221], 1.0 op_sel_hi:[1,0]
    v_pk_add_f32 v[222:223], v[222:223], 1.0 op_sel_hi:[1,0]
    v_pk_add_f32 v[224:225], v[224:225], 1.0 op_sel_hi:[1,0]
    v_pk_add_f32 v[226:227], v[226:227], 1.0 op_sel_hi:[1,0]
    v_mfma_f32_32x32x16_bf16 v[140:155], v[0:3], v[172:175], v[140:155]
    v_rcp_f32 v220, v220
    v_rcp_f32 v221, v221
    v_rcp_f32 v222, v222
    v_rcp_f32 v223, v223
    v_mfma_f32_32x32x16_bf16 v[140:155], v[4:7], v[176:179], v[140:155]
    v_rcp_f32 v224, v224
    v_rcp_f32 v225, v225
    v_rcp_f32 v226, v226
    v_rcp_f32 v227, v227
    v_pk_fma_f32 v[92:93], v[156:157], v[220:221], v[92:93]
    v_pk_fma_f32 v[94:95], v[158:159], v[222:223], v[94:95]
    v_pk_fma_f32 v[96:97], v[160:161], v[224:225], v[96:97]
    v_pk_fma_f32 v[98:99], v[162:163], v[226:227], v[98:99]
    v_pk_fma_f32 v[228:229], v[92:93], v[124:125], v[228:229]
    v_pk_fma_f32 v[230:231], v[94:95], v[126:127], v[230:231]
    v_pk_fma_f32 v[228:229], v[96:97], v[128:129], v[228:229]
    v_pk_fma_f32 v[230:231], v[98:99], v[130:131], v[230:231]
    v_mfma_f32_32x32x16_bf16 v[140:155], v[8:11], v[180:183], v[140:155]
    v_exp_f32 v220, v164
    v_exp_f32 v221, v165
    v_exp_f32 v222, v166
    v_exp_f32 v223, v167
    v_mfma_f32_32x32x16_bf16 v[140:155], v[12:15], v[184:187], v[140:155]
    v_exp_f32 v224, v168
    v_exp_f32 v225, v169
    v_exp_f32 v226, v170
    v_exp_f32 v227, v171
    v_pk_add_f32 v[220:221], v[220:221], 1.0 op_sel_hi:[1,0]
    v_pk_add_f32 v[222:223], v[222:223], 1.0 op_sel_hi:[1,0]
    v_pk_add_f32 v[224:225], v[224:225], 1.0 op_sel_hi:[1,0]
    v_pk_add_f32 v[226:227], v[226:227], 1.0 op_sel_hi:[1,0]
    v_rcp_f32 v220, v220
    v_rcp_f32 v221, v221
    v_rcp_f32 v222, v222
    v_rcp_f32 v223, v223
    v_rcp_f32 v224, v224
    v_rcp_f32 v225, v225
    v_rcp_f32 v226, v226
    v_rcp_f32 v227, v227
    v_pk_fma_f32 v[100:101], v[164:165], v[220:221], v[100:101]
    v_pk_fma_f32 v[102:103], v[166:167], v[222:223], v[102:103]
    v_pk_fma_f32 v[104:105], v[168:169], v[224:225], v[104:105]
    v_pk_fma_f32 v[106:107], v[170:171], v[226:227], v[106:107]
    v_pk_fma_f32 v[228:229], v[100:101], v[132:133], v[228:229]
    v_pk_fma_f32 v[230:231], v[102:103], v[134:135], v[230:231]
    v_pk_fma_f32 v[228:229], v[104:105], v[136:137], v[228:229]
    v_pk_fma_f32 v[230:231], v[106:107], v[138:139], v[230:231]
    v_pk_add_f32 v[228:229], v[228:229], v[230:231]
    s_cmp_eq_u64 s[36:37], 0
    v_add_f32 v247, v228, v229
    v_sub_f32 v248, v247, v243
    v_pk_fma_f32 v[244:245], v[236:237], v[248:249], v[244:245] op_sel_hi:[1,0,1]
    v_fmac_f32 v246, v238, v248
    s_mov_b64 exec, -1
    s_cbranch_scc1 K2_DONE
    v_mfma_f32_32x32x8_bf16 v[156:171], v[42:43], v[208:209], v[60:75]
    s_mov_b64 exec, s[36:37]
    v_exp_f32 v220, v140
    v_exp_f32 v221, v141
    v_exp_f32 v222, v142
    v_exp_f32 v223, v143
    v_mfma_f32_32x32x16_bf16 v[156:171], v[36:39], v[188:191], v[156:171]
    v_exp_f32 v224, v144
    v_exp_f32 v225, v145
    s_bitcmp1_b32 s5, 2
    s_cbranch_scc0 K2_VP9
    s_setprio 1
K2_VP9:
    s_waitcnt lgkmcnt(0)
    s_mov_b64 exec, -1
    s_add_u32 m0, s94, 0
    s_nop 0
    buffer_load_dwordx4 v[210:211], s[8:11], 0 idxen offen lds
    s_add_u32 m0, s94, 1024
    s_nop 0
    buffer_load_dwordx4 v[212:213], s[8:11], 0 idxen offen lds
    s_add_u32 m0, s94, 2048
    s_nop 0
    buffer_load_dwordx4 v[214:215], s[8:11], 0 idxen offen lds
    s_add_u32 m0, s94, 3072
    s_nop 0
    buffer_load_dwordx4 v[216:217], s[8:11], 0 idxen offen lds
    s_mov_b64 exec, s[36:37]
    s_setprio 0
    v_exp_f32 v226, v146
    v_exp_f32 v227, v147
    v_pk_add_f32 v[220:221], v[220:221], 1.0 op_sel_hi:[1,0]
    v_pk_add_f32 v[222:223], v[222:223], 1.0 op_sel_hi:[1,0]
    v_pk_add_f32 v[224:225], v[224:225], 1.0 op_sel_hi:[1,0]
    v_pk_add_f32 v[226:227], v[226:227], 1.0 op_sel_hi:[1,0]
    v_mfma_f32_32x32x16_bf16 v[156:171], v[16:19], v[172:175], v[156:171]
    v_rcp_f32 v220, v220
    v_rcp_f32 v221, v221
    v_rcp_f32 v222, v222
    v_rcp_f32 v223, v223
    v_mfma_f32_32x32x16_bf16 v[156:171], v[20:23], v[176:179], v[156:171]
    v_rcp_f32 v224, v224
    v_rcp_f32 v225, v225
    v_rcp_f32 v226, v226
    v_rcp_f32 v227, v227
    v_pk_fma_f32 v[76:77], v[140:141], v[220:221], v[76:77]
    v_pk_fma_f32 v[78:79], v[142:143], v[222:223], v[78:79]
    v_pk_fma_f32 v[80:81], v[144:145], v[224:225], v[80:81]
    v_pk_fma_f32 v[82:83], v[146:147], v[226:227], v[82:83]
    v_pk_mul_f32 v[228:229], v[76:77], v[108:109]
    v_pk_mul_f32 v[230:231], v[78:79], v[110:111]
    v_pk_fma_f32 v[228:229], v[80:81], v[112:113], v[228:229]
    v_pk_fma_f32 v[230:231], v[82:83], v[114:115], v[230:231]
    v_mfma_f32_32x32x16_bf16 v[156:171], v[24:27], v[180:183], v[156:171]
    v_exp_f32 v220, v148
    v_exp_f32 v221, v149
    v_exp_f32 v222, v150
    v_exp_f32 v223, v151
    v_mfma_f32_32x32x16_bf16 v[156:171], v[28:31], v[184:187], v[156:171]
    v_exp_f32 v224, v152
    v_exp_f32 v225, v153
    v_exp_f32 v226, v154
    buffer_load_dwordx4 v[188:191], v[218:219], s[12:15], 0 idxen offen
    buffer_load_dwordx2 v[200:201], v203, s[16:19], 0 idxen sc1
    v_exp_f32 v227, v155
    s_waitcnt vmcnt(6)
    ds_read_b128 v[172:175], v251 offset:32768
    ds_read_b128 v[176:179], v252 offset:32768
    ds_read_b128 v[180:183], v253 offset:32768
    ds_read_b128 v[184:187], v254 offset:32768
    v_cmp_lt_u32_e64 s[30:31], s6, v235
    s_add_u32 s6, s6, 1
    v_lshlrev_b32 v236, 16, v204
    v_and_b32 v237, 0xffff0000, v204
    v_sub_f32 v238, v242, v205
    v_pk_add_f32 v[236:237], v[240:241], v[236:237] neg_lo:[0,1] neg_hi:[0,1]
    v_mul_f32 v208, v236, v236
    v_fmac_f32 v208, v237, v237
    v_fmac_f32 v208, v238, v238
    v_cvt_pk_bf16_f32 v208, v208, v208
    v_cndmask_b32_e64 v203, 0, v207, s[30:31]
    v_add_u32 v207, v207, v206
    ds_read_b32 v218, v203
    ds_read_u16 v203, v203 offset:4
    v_pk_add_f32 v[220:221], v[220:221], 1.0 op_sel_hi:[1,0]
    v_pk_add_f32 v[222:223], v[222:223], 1.0 op_sel_hi:[1,0]
    v_pk_add_f32 v[224:225], v[224:225], 1.0 op_sel_hi:[1,0]
    v_pk_add_f32 v[226:227], v[226:227], 1.0 op_sel_hi:[1,0]
    v_rcp_f32 v220, v220
    v_rcp_f32 v221, v221
    v_rcp_f32 v222, v222
    v_rcp_f32 v223, v223
    v_rcp_f32 v224, v224
    v_rcp_f32 v225, v225
    v_rcp_f32 v226, v226
    v_rcp_f32 v227, v227
    s_waitcnt lgkmcnt(0)
    s_mov_b64 exec, -1
    ds_bpermute_b32 v210, v239, v203 offset:0
    ds_bpermute_b32 v212, v239, v203 offset:32
    ds_bpermute_b32 v214, v239, v203 offset:64
    ds_bpermute_b32 v216, v239, v203 offset:96
    s_mov_b64 exec, s[36:37]
    v_pk_fma_f32 v[84:85], v[148:149], v[220:221], v[84:85]
    v_pk_fma_f32 v[86:87], v[150:151], v[222:223], v[86:87]
    v_pk_fma_f32 v[88:89], v[152:153], v[224:225], v[88:89]
    v_pk_fma_f32 v[90:91], v[154:155], v[226:227], v[90:91]
    v_pk_fma_f32 v[228:229], v[84:85], v[116:117], v[228:229]
    v_pk_fma_f32 v[230:231], v[86:87], v[118:119], v[230:231]
    v_pk_fma_f32 v[228:229], v[88:89], v[120:121], v[228:229]
    v_pk_fma_f32 v[230:231], v[90:91], v[122:123], v[230:231]
    v_mfma_f32_32x32x8_bf16 v[140:155], v[40:41], v[208:209], v[44:59]
    v_exp_f32 v220, v156
    v_exp_f32 v221, v157
    v_exp_f32 v222, v158
    v_exp_f32 v223, v159
    v_mfma_f32_32x32x16_bf16 v[140:155], v[32:35], v[192:195], v[140:155]
    v_exp_f32 v224, v160
    v_exp_f32 v225, v161
    v_exp_f32 v226, v162
    v_exp_f32 v227, v163
    v_pk_add_f32 v[220:221], v[220:221], 1.0 op_sel_hi:[1,0]
    v_pk_add_f32 v[222:223], v[222:223], 1.0 op_sel_hi:[1,0]
    v_pk_add_f32 v[224:225], v[224:225], 1.0 op_sel_hi:[1,0]
    v_pk_add_f32 v[226:227], v[226:227], 1.0 op_sel_hi:[1,0]
    v_mfma_f32_32x32x16_bf16 v[140:155], v[0:3], v[172:175], v[140:155]
    v_rcp_f32 v220, v220
    v_rcp_f32 v221, v221
    v_rcp_f32 v222, v222
    v_rcp_f32 v223, v223
    v_mfma_f32_32x32x16_bf16 v[140:155], v[4:7], v[176:179], v[140:155]
    v_rcp_f32 v224, v224
    v_rcp_f32 v225, v225
    v_rcp_f32 v226, v226
    v_rcp_f32 v227, v227
    v_pk_fma_f32 v[92:93], v[156:157], v[220:221], v[92:93]
    v_pk_fma_f32 v[94:95], v[158:159], v[222:223], v[94:95]
    v_pk_fma_f32 v[96:97], v[160:161], v[224:225], v[96:97]
    v_pk_fma_f32 v[98:99], v[162:163], v[226:227], v[98:99]
    v_pk_fma_f32 v[228:229], v[92:93], v[124:125], v[228:229]
    v_pk_fma_f32 v[230:231], v[94:95], v[126:127], v[230:231]
    v_pk_fma_f32 v[228:229], v[96:97], v[128:129], v[228:229]
    v_pk_fma_f32 v[230:231], v[98:99], v[130:131], v[230:231]
    v_mfma_f32_32x32x16_bf16 v[140:155], v[8:11], v[180:183], v[140:155]
    v_exp_f32 v220, v164
    v_exp_f32 v221, v165
    v_exp_f32 v222, v166
    v_exp_f32 v223, v167
    v_mfma_f32_32x32x16_bf16 v[140:155], v[12:15], v[184:187], v[140:155]
    v_exp_f32 v224, v168
    v_exp_f32 v225, v169
    v_exp_f32 v226, v170
    v_exp_f32 v227, v171
    v_pk_add_f32 v[220:221], v[220:221], 1.0 op_sel_hi:[1,0]
    v_pk_add_f32 v[222:223], v[222:223], 1.0 op_sel_hi:[1,0]
    v_pk_add_f32 v[224:225], v[224:225], 1.0 op_sel_hi:[1,0]
    v_pk_add_f32 v[226:227], v[226:227], 1.0 op_sel_hi:[1,0]
    v_rcp_f32 v220, v220
    v_rcp_f32 v221, v221
    v_rcp_f32 v222, v222
    v_rcp_f32 v223, v223
    v_rcp_f32 v224, v224
    v_rcp_f32 v225, v225
    v_rcp_f32 v226, v226
    v_rcp_f32 v227, v227
    v_pk_fma_f32 v[100:101], v[164:165], v[220:221], v[100:101]
    v_pk_fma_f32 v[102:103], v[166:167], v[222:223], v[102:103]
    v_pk_fma_f32 v[104:105], v[168:169], v[224:225], v[104:105]
    v_pk_fma_f32 v[106:107], v[170:171], v[226:227], v[106:107]
    v_pk_fma_f32 v[228:229], v[100:101], v[132:133], v[228:229]
    v_pk_fma_f32 v[230:231], v[102:103], v[134:135], v[230:231]
    v_pk_fma_f32 v[228:229], v[104:105], v[136:137], v[228:229]
    v_pk_fma_f32 v[230:231], v[106:107], v[138:139], v[230:231]
    v_pk_add_f32 v[228:229], v[228:229], v[230:231]
    s_cmp_eq_u64 s[38:39], 0
    v_add_f32 v243, v228, v229
    v_sub_f32 v248, v243, v247
    v_pk_fma_f32 v[244:245], v[232:233], v[248:249], v[244:245] op_sel_hi:[1,0,1]
    v_fmac_f32 v246, v234, v248
    s_mov_b64 exec, -1
    s_cbranch_scc1 K2_DONE
    v_mfma_f32_32x32x8_bf16 v[156:171], v[42:43], v[208:209], v[60:75]
    s_mov_b64 exec, s[38:39]
    v_exp_f32 v220, v140
    v_exp_f32 v221, v141
    v_exp_f32 v222, v142
    v_exp_f32 v223, v143
    v_mfma_f32_32x32x16_bf16 v[156:171], v[36:39], v[192:195], v[156:171]
    v_exp_f32 v224, v144
    v_exp_f32 v225, v145
    s_bitcmp1_b32 s5, 2
    s_cbranch_scc0 K2_VP11
    s_setprio 1
K2_VP11:
    s_waitcnt lgkmcnt(0)
    s_mov_b64 exec, -1
    s_add_u32 m0, s94, 32768
    s_nop 0
    buffer_load_dwordx4 v[210:211], s[8:11], 0 idxen offen lds
    s_add_u32 m0, s94, 33792
    s_nop 0
    buffer_load_dwordx4 v[212:213], s[8:11], 0 idxen offen lds
    s_add_u32 m0, s94, 34816
    s_nop 0
    buffer_load_dwordx4 v[214:215], s[8:11], 0 idxen offen lds
    s_add_u32 m0, s94, 35840
    s_nop 0
    buffer_load_dwordx4 v[216:217], s[8:11], 0 idxen offen lds
    s_mov_b64 exec, s[38:39]
    s_setprio 0
    v_exp_f32 v226, v146
    v_exp_f32 v227, v147
    v_pk_add_f32 v[220:221], v[220:221], 1.0 op_sel_hi:[1,0]
    v_pk_add_f32 v[222:223], v[222:223], 1.0 op_sel_hi:[1,0]
    v_pk_add_f32 v[224:225], v[224:225], 1.0 op_sel_hi:[1,0]
    v_pk_add_f32 v[226:227], v[226:227], 1.0 op_sel_hi:[1,0]
    v_mfma_f32_32x32x16_bf16 v[156:171], v[16:19], v[172:175], v[156:171]
    v_rcp_f32 v220, v220
    v_rcp_f32 v221, v221
    v_rcp_f32 v222, v222
    v_rcp_f32 v223, v223
    v_mfma_f32_32x32x16_bf16 v[156:171], v[20:23], v[176:179], v[156:171]
    v_rcp_f32 v224, v224
    v_rcp_f32 v225, v225
    v_rcp_f32 v226, v226
    v_rcp_f32 v227, v227
    v_pk_fma_f32 v[76:77], v[140:141], v[220:221], v[76:77]
    v_pk_fma_f32 v[78:79], v[142:143], v[222:223], v[78:79]
    v_pk_fma_f32 v[80:81], v[144:145], v[224:225], v[80:81]
    v_pk_fma_f32 v[82:83], v[146:147], v[226:227], v[82:83]
    v_pk_mul_f32 v[228:229], v[76:77], v[108:109]
    v_pk_mul_f32 v[230:231], v[78:79], v[110:111]
    v_pk_fma_f32 v[228:229], v[80:81], v[112:113], v[228:229]
    v_pk_fma_f32 v[230:231], v[82:83], v[114:115], v[230:231]
    v_mfma_f32_32x32x16_bf16 v[156:171], v[24:27], v[180:183], v[156:171]
    v_exp_f32 v220, v148
    v_exp_f32 v221, v149
    v_exp_f32 v222, v150
    v_exp_f32 v223, v151
    v_mfma_f32_32x32x16_bf16 v[156:171], v[28:31], v[184:187], v[156:171]
    v_exp_f32 v224, v152
    v_exp_f32 v225, v153
    v_exp_f32 v226, v154
    buffer_load_dwordx4 v[192:195], v[218:219], s[12:15], 0 idxen offen
    buffer_load_dwordx2 v[204:205], v203, s[16:19], 0 idxen sc1
    v_exp_f32 v227, v155
    s_waitcnt vmcnt(6)
    ds_read_b128 v[172:175], v251 offset:0
    ds_read_b128 v[176:179], v252 offset:0
    ds_read_b128 v[180:183], v253 offset:0
    ds_read_b128 v[184:187], v254 offset:0
    v_cmp_lt_u32_e64 s[32:33], s6, v235
    s_add_u32 s6, s6, 1
    v_lshlrev_b32 v232, 16, v200
    v_and_b32 v233, 0xffff0000, v200
    v_sub_f32 v234, v242, v201
    v_pk_add_f32 v[232:233], v[240:241], v[232:233] neg_lo:[0,1] neg_hi:[0,1]
    v_mul_f32 v208, v232, v232
    v_fmac_f32 v208, v233, v233
    v_fmac_f32 v208, v234, v234
    v_cvt_pk_bf16_f32 v208, v208, v208
    v_cndmask_b32_e64 v203, 0, v207, s[32:33]
    v_add_u32 v207, v207, v206
    ds_read_b32 v218, v203
    ds_read_u16 v203, v203 offset:4
    v_pk_add_f32 v[220:221], v[220:221], 1.0 op_sel_hi:[1,0]
    v_pk_add_f32 v[222:223], v[222:223], 1.0 op_sel_hi:[1,0]
    v_pk_add_f32 v[224:225], v[224:225], 1.0 op_sel_hi:[1,0]
    v_pk_add_f32 v[226:227], v[226:227], 1.0 op_sel_hi:[1,0]
    v_rcp_f32 v220, v220
    v_rcp_f32 v221, v221
    v_rcp_f32 v222, v222
    v_rcp_f32 v223, v223
    v_rcp_f32 v224, v224
    v_rcp_f32 v225, v225
    v_rcp_f32 v226, v226
    v_rcp_f32 v227, v227
    s_waitcnt lgkmcnt(0)
    s_mov_b64 exec, -1
    ds_bpermute_b32 v210, v239, v203 offset:0
    ds_bpermute_b32 v212, v239, v203 offset:32
    ds_bpermute_b32 v214, v239, v203 offset:64
    ds_bpermute_b32 v216, v239, v203 offset:96
    s_mov_b64 exec, s[38:39]
    v_pk_fma_f32 v[84:85], v[148:149], v[220:221], v[84:85]
    v_pk_fma_f32 v[86:87], v[150:151], v[222:223], v[86:87]
    v_pk_fma_f32 v[88:89], v[152:153], v[224:225], v[88:89]
    v_pk_fma_f32 v[90:91], v[154:155], v[226:227], v[90:91]
    v_pk_fma_f32 v[228:229], v[84:85], v[116:117], v[228:229]
    v_pk_fma_f32 v[230:231], v[86:87], v[118:119], v[230:231]
    v_pk_fma_f32 v[228:229], v[88:89], v[120:121], v[228:229]
    v_pk_fma_f32 v[230:231], v[90:91], v[122:123], v[230:231]
    v_mfma_f32_32x32x8_bf16 v[140:155], v[40:41], v[208:209], v[44:59]
    v_exp_f32 v220, v156
    v_exp_f32 v221, v157
    v_exp_f32 v222, v158
    v_exp_f32 v223, v159
    v_mfma_f32_32x32x16_bf16 v[140:155], v[32:35], v[188:191], v[140:155]
    v_exp_f32 v224, v160
    v_exp_f32 v225, v161
    v_exp_f32 v226, v162
    v_exp_f32 v227, v163
    v_pk_add_f32 v[220:221], v[220:221], 1.0 op_sel_hi:[1,0]
    v_pk_add_f32 v[222:223], v[222:223], 1.0 op_sel_hi:[1,0]
    v_pk_add_f32 v[224:225], v[224:225], 1.0 op_sel_hi:[1,0]
    v_pk_add_f32 v[226:227], v[226:227], 1.0 op_sel_hi:[1,0]
    v_mfma_f32_32x32x16_bf16 v[140:155], v[0:3], v[172:175], v[140:155]
    v_rcp_f32 v220, v220
    v_rcp_f32 v221, v221
    v_rcp_f32 v222, v222
    v_rcp_f32 v223, v223
    v_mfma_f32_32x32x16_bf16 v[140:155], v[4:7], v[176:179], v[140:155]
    v_rcp_f32 v224, v224
    v_rcp_f32 v225, v225
    v_rcp_f32 v226, v226
    v_rcp_f32 v227, v227
    v_pk_fma_f32 v[92:93], v[156:157], v[220:221], v[92:93]
    v_pk_fma_f32 v[94:95], v[158:159], v[222:223], v[94:95]
    v_pk_fma_f32 v[96:97], v[160:161], v[224:225], v[96:97]
    v_pk_fma_f32 v[98:99], v[162:163], v[226:227], v[98:99]
    v_pk_fma_f32 v[228:229], v[92:93], v[124:125], v[228:229]
    v_pk_fma_f32 v[230:231], v[94:95], v[126:127], v[230:231]
    v_pk_fma_f32 v[228:229], v[96:97], v[128:129], v[228:229]
    v_pk_fma_f32 v[230:231], v[98:99], v[130:131], v[230:231]
    v_mfma_f32_32x32x16_bf16 v[140:155], v[8:11], v[180:183], v[140:155]
    v_exp_f32 v220, v164
    v_exp_f32 v221, v165
    v_exp_f32 v222, v166
    v_exp_f32 v223, v167
    v_mfma_f32_32x32x16_bf16 v[140:155], v[12:15], v[184:187], v[140:155]
    v_exp_f32 v224, v168
    v_exp_f32 v225, v169
    v_exp_f32 v226, v170
    v_exp_f32 v227, v171
    v_pk_add_f32 v[220:221], v[220:221], 1.0 op_sel_hi:[1,0]
    v_pk_add_f32 v[222:223], v[222:223], 1.0 op_sel_hi:[1,0]
    v_pk_add_f32 v[224:225], v[224:225], 1.0 op_sel_hi:[1,0]
    v_pk_add_f32 v[226:227], v[226:227], 1.0 op_sel_hi:[1,0]
    v_rcp_f32 v220, v220
    v_rcp_f32 v221, v221
    v_rcp_f32 v222, v222
    v_rcp_f32 v223, v223
    v_rcp_f32 v224, v224
    v_rcp_f32 v225, v225
    v_rcp_f32 v226, v226
    v_rcp_f32 v227, v227
    v_pk_fma_f32 v[100:101], v[164:165], v[220:221], v[100:101]
    v_pk_fma_f32 v[102:103], v[166:167], v[222:223], v[102:103]
    v_pk_fma_f32 v[104:105], v[168:169], v[224:225], v[104:105]
    v_pk_fma_f32 v[106:107], v[170:171], v[226:227], v[106:107]
    v_pk_fma_f32 v[228:229], v[100:101], v[132:133], v[228:229]
    v_pk_fma_f32 v[230:231], v[102:103], v[134:135], v[230:231]
    v_pk_fma_f32 v[228:229], v[104:105], v[136:137], v[228:229]
    v_pk_fma_f32 v[230:231], v[106:107], v[138:139], v[230:231]
    v_pk_add_f32 v[228:229], v[228:229], v[230:231]
    s_cmp_eq_u64 s[28:29], 0
    v_add_f32 v247, v228, v229
    v_sub_f32 v248, v247, v243
    v_pk_fma_f32 v[244:245], v[236:237], v[248:249], v[244:245] op_sel_hi:[1,0,1]
    v_fmac_f32 v246, v238, v248
    s_mov_b64 exec, -1
    s_cbranch_scc0 K2_LOOP
K2_DONE:
    v_and_b32 v203, 63, v250
    s_or_b32 s95, s7, s93
    s_cselect_b32 s97, 3, s97
    s_cmp_gt_u32 s97, 2
    v_lshlrev_b32 v203, 4, v203
    s_cbranch_scc1 K2_SLOW
    v_bfe_u32 v220, v249, 1, 3
    v_lshlrev_b32 v220, 4, v220
    v_lshlrev_b32 v221, 2, v219
    v_xor_b32 v220, v220, v221
    v_lshl_add_u32 v220, v249, 7, v220
    v_add_u32 v220, 100352, v220
    v_xor_b32 v221, 16, v220
    v_xor_b32 v222, 32, v220
    v_xor_b32 v223, 48, v220
    ds_read_b128 v[172:175], v220
    ds_read_b128 v[176:179], v221
    ds_read_b128 v[180:183], v222
    ds_read_b128 v[184:187], v223
    v_add_u32 v220, 125952, v203
    v_cmp_eq_u32_e64 s[46:47], 16, v206
    v_cmp_eq_u32_e64 s[44:45], 8, v206
    v_add_u32 v218, s4, v249
    ds_read_b128 v[0:3], v220 offset:32768
    ds_read_b128 v[4:7], v220 offset:33792
    ds_read_b128 v[8:11], v220 offset:34816
    ds_read_b128 v[12:15], v220 offset:35840
    ds_read_b128 v[16:19], v220 offset:0
    ds_read_b128 v[20:23], v220 offset:1024
    ds_read_b128 v[24:27], v220 offset:2048
    ds_read_b128 v[28:31], v220 offset:3072
    ds_read_b128 v[44:47], v220 offset:4096
    ds_read_b128 v[48:51], v220 offset:5120
    ds_read_b128 v[52:55], v220 offset:6144
    ds_read_b128 v[56:59], v220 offset:7168
    ds_read_b128 v[60:63], v220 offset:8192
    ds_read_b128 v[64:67], v220 offset:9216
    ds_read_b128 v[68:71], v220 offset:10240
    ds_read_b128 v[72:75], v220 offset:11264
    s_mov_b64 exec, s[46:47]
    s_and_b32 s46, s46, 0x55555555
    s_or_b32 s44, s44, s46
    s_mov_b32 s98, s94
    v_add_f32_dpp v244, v244, v244 quad_perm:[1,0,3,2] row_mask:0xf bank_mask:0xf
    v_add_f32_dpp v245, v245, v245 quad_perm:[1,0,3,2] row_mask:0xf bank_mask:0xf
    v_add_f32_dpp v246, v246, v246 quad_perm:[1,0,3,2] row_mask:0xf bank_mask:0xf
    v_add_f32_dpp v76, v76, v76 quad_perm:[1,0,3,2] row_mask:0xf bank_mask:0xf
    v_add_f32_dpp v77, v77, v77 quad_perm:[1,0,3,2] row_mask:0xf bank_mask:0xf
    v_add_f32_dpp v78, v78, v78 quad_perm:[1,0,3,2] row_mask:0xf bank_mask:0xf
    v_add_f32_dpp v79, v79, v79 quad_perm:[1,0,3,2] row_mask:0xf bank_mask:0xf
    v_add_f32_dpp v80, v80, v80 quad_perm:[1,0,3,2] row_mask:0xf bank_mask:0xf
    v_add_f32_dpp v81, v81, v81 quad_perm:[1,0,3,2] row_mask:0xf bank_mask:0xf
    v_add_f32_dpp v82, v82, v82 quad_perm:[1,0,3,2] row_mask:0xf bank_mask:0xf
    v_add_f32_dpp v83, v83, v83 quad_perm:[1,0,3,2] row_mask:0xf bank_mask:0xf
    v_add_f32_dpp v84, v84, v84 quad_perm:[1,0,3,2] row_mask:0xf bank_mask:0xf
    v_add_f32_dpp v85, v85, v85 quad_perm:[1,0,3,2] row_mask:0xf bank_mask:0xf
    v_add_f32_dpp v86, v86, v86 quad_perm:[1,0,3,2] row_mask:0xf bank_mask:0xf
    v_add_f32_dpp v87, v87, v87 quad_perm:[1,0,3,2] row_mask:0xf bank_mask:0xf
    v_add_f32_dpp v88, v88, v88 quad_perm:[1,0,3,2] row_mask:0xf bank_mask:0xf
    v_add_f32_dpp v89, v89, v89 quad_perm:[1,0,3,2] row_mask:0xf bank_mask:0xf
    v_add_f32_dpp v90, v90, v90 quad_perm:[1,0,3,2] row_mask:0xf bank_mask:0xf
    v_add_f32_dpp v91, v91, v91 quad_perm:[1,0,3,2] row_mask:0xf bank_mask:0xf
    v_add_f32_dpp v92, v92, v92 quad_perm:[1,0,3,2] row_mask:0xf bank_mask:0xf
    v_add_f32_dpp v93, v93, v93 quad_perm:[1,0,3,2] row_mask:0xf bank_mask:0xf
    v_add_f32_dpp v94, v94, v94 quad_perm:[1,0,3,2] row_mask:0xf bank_mask:0xf
    v_add_f32_dpp v95, v95, v95 quad_perm:[1,0,3,2] row_mask:0xf bank_mask:0xf
    v_add_f32_dpp v96, v96, v96 quad_perm:[1,0,3,2] row_mask:0xf bank_mask:0xf
    v_add_f32_dpp v97, v97, v97 quad_perm:[1,0,3,2] row_mask:0xf bank_mask:0xf
    v_add_f32_dpp v98, v98, v98 quad_perm:[1,0,3,2] row_mask:0xf bank_mask:0xf
    v_add_f32_dpp v99, v99, v99 quad_perm:[1,0,3,2] row_mask:0xf bank_mask:0xf
    v_add_f32_dpp v100, v100, v100 quad_perm:[1,0,3,2] row_mask:0xf bank_mask:0xf
    v_add_f32_dpp v101, v101, v101 quad_perm:[1,0,3,2] row_mask:0xf bank_mask:0xf
    v_add_f32_dpp v102, v102, v102 quad_perm:[1,0,3,2] row_mask:0xf bank_mask:0xf
    v_add_f32_dpp v103, v103, v103 quad_perm:[1,0,3,2] row_mask:0xf bank_mask:0xf
    v_add_f32_dpp v104, v104, v104 quad_perm:[1,0,3,2] row_mask:0xf bank_mask:0xf
    v_add_f32_dpp v105, v105, v105 quad_perm:[1,0,3,2] row_mask:0xf bank_mask:0xf
    v_add_f32_dpp v106, v106, v106 quad_perm:[1,0,3,2] row_mask:0xf bank_mask:0xf
    v_add_f32_dpp v107, v107, v107 quad_perm:[1,0,3,2] row_mask:0xf bank_mask:0xf
    s_mov_b64 exec, -1
    v_mov_b32 v224, v244
    v_mov_b32 v225, v245
    v_mov_b32 v226, v246
    s_nop 1
    v_permlane32_swap_b32 v224, v244
    v_permlane32_swap_b32 v225, v245
    v_permlane32_swap_b32 v226, v246
    s_nop 1
    v_add_f32 v244, v244, v224
    v_add_f32 v245, v245, v225
    v_add_f32 v246, v246, v226
    s_branch K2_TAIL
K2_EMPTY:
    s_waitcnt vmcnt(0) lgkmcnt(0)
    v_mov_b32 v244, 0
    v_mov_b32 v245, 0
    v_mov_b32 v246, 0
    v_mov_b32 v76, 0
    v_mov_b32 v77, 0
    v_mov_b32 v78, 0
    v_mov_b32 v79, 0
    v_mov_b32 v80, 0
    v_mov_b32 v81, 0
    v_mov_b32 v82, 0
    v_mov_b32 v83, 0
    v_mov_b32 v84, 0
    v_mov_b32 v85, 0
    v_mov_b32 v86, 0
    v_mov_b32 v87, 0
    v_mov_b32 v88, 0
    v_mov_b32 v89, 0
    v_mov_b32 v90, 0
    v_mov_b32 v91, 0
    v_mov_b32 v92, 0
    v_mov_b32 v93, 0
    v_mov_b32 v94, 0
    v_mov_b32 v95, 0
    v_mov_b32 v96, 0
    v_mov_b32 v97, 0
    v_mov_b32 v98, 0
    v_mov_b32 v99, 0
    v_mov_b32 v100, 0
    v_mov_b32 v101, 0
    v_mov_b32 v102, 0
    v_mov_b32 v103, 0
    v_mov_b32 v104, 0
    v_mov_b32 v105, 0
    v_mov_b32 v106, 0
    v_mov_b32 v107, 0
    v_mov_b32 v242, v241
    v_and_b32 v241, 0xffff0000, v240
    v_lshlrev_b32 v240, 16, v240
    s_branch K2_DONE
K2_SLOW:
    v_and_b32 v223, 31, v250
    v_lshlrev_b32 v220, 2, v219
    v_xor_b32 v220, v220, v251
    v_lshl_add_u32 v220, v219, 11, v220
    s_lshl_b32 s95, s100, 10
    s_add_u32 s95, s95, 129024
    v_lshl_add_u32 v221, v223, 5, v219
    v_add_u32 v221, s95, v221
    s_lshl_b32 s95, s5, 5
    v_add_u32 v223, s95, v223
    v_add_u32 v218, s4, v223
    v_min_u32 v222, 49999, v218
    s_waitcnt vmcnt(0)
    buffer_load_dwordx2 v[240:241], v222, s[16:19], 0 idxen sc1
    v_xor_b32 v222, 0, v220
    ds_write_b128 v222, v[76:79]
    v_xor_b32 v222, 16, v220
    ds_write_b128 v222, v[80:83]
    v_xor_b32 v222, 32, v220
    ds_write_b128 v222, v[84:87]
    v_xor_b32 v222, 48, v220
    ds_write_b128 v222, v[88:91]
    v_xor_b32 v222, 64, v220
    ds_write_b128 v222, v[92:95]
    v_xor_b32 v222, 80, v220
    ds_write_b128 v222, v[96:99]
    v_xor_b32 v222, 96, v220
    ds_write_b128 v222, v[100:103]
    v_xor_b32 v222, 112, v220
    ds_write_b128 v222, v[104:107]
    ds_write_b128 v221, v[244:247]
    v_lshlrev_b32 v220, 2, v223
    ds_read_b32 v235, v220 offset:32768
    s_sub_u32 s99, s101, s94
    v_add_u32 v251, s99, v251
    v_add_u32 v252, s99, v252
    v_add_u32 v253, s99, v253
    v_add_u32 v254, s99, v254
    ds_read_b128 v[172:175], v251 offset:0
    ds_read_b128 v[176:179], v252 offset:0
    ds_read_b128 v[180:183], v253 offset:0
    ds_read_b128 v[184:187], v254 offset:0
    v_mov_b32 v76, 0
    v_mov_b32 v77, 0
    v_mov_b32 v78, 0
    v_mov_b32 v79, 0
    v_mov_b32 v80, 0
    v_mov_b32 v81, 0
    v_mov_b32 v82, 0
    v_mov_b32 v83, 0
    v_mov_b32 v84, 0
    v_mov_b32 v85, 0
    v_mov_b32 v86, 0
    v_mov_b32 v87, 0
    v_mov_b32 v88, 0
    v_mov_b32 v89, 0
    v_mov_b32 v90, 0
    v_mov_b32 v91, 0
    v_mov_b32 v92, 0
    v_mov_b32 v93, 0
    v_mov_b32 v94, 0
    v_mov_b32 v95, 0
    v_mov_b32 v96, 0
    v_mov_b32 v97, 0
    v_mov_b32 v98, 0
    v_mov_b32 v99, 0
    v_mov_b32 v100, 0
    v_mov_b32 v101, 0
    v_mov_b32 v102, 0
    v_mov_b32 v103, 0
    v_mov_b32 v104, 0
    v_mov_b32 v105, 0
    v_mov_b32 v106, 0
    v_mov_b32 v107, 0
    v_mov_b32 v244, 0
    v_mov_b32 v245, 0
    v_mov_b32 v246, 0
    s_lshl_b32 s99, s3, 8
    v_add_u32 v249, s99, v223
    v_mul_u32_u24 v249, 272, v249
    v_lshl_add_u32 v243, v219, 3, v249
    s_mov_b32 s99, 7602176
    s_cmp_eq_u32 s7, 0
    s_cbranch_scc1 K2_NOLD
    buffer_load_dwordx4 v[76:79], v243, s[20:23], s99 offen offset:0 sc0 sc1
    buffer_load_dwordx4 v[80:83], v243, s[20:23], s99 offen offset:16 sc0 sc1
    buffer_load_dwordx4 v[84:87], v243, s[20:23], s99 offen offset:32 sc0 sc1
    buffer_load_dwordx4 v[88:91], v243, s[20:23], s99 offen offset:48 sc0 sc1
    buffer_load_dwordx4 v[92:95], v243, s[20:23], s99 offen offset:64 sc0 sc1
    buffer_load_dwordx4 v[96:99], v243, s[20:23], s99 offen offset:80 sc0 sc1
    buffer_load_dwordx4 v[100:103], v243, s[20:23], s99 offen offset:96 sc0 sc1
    buffer_load_dwordx4 v[104:107], v243, s[20:23], s99 offen offset:112 sc0 sc1
    buffer_load_dwordx3 v[244:246], v249, s[20:23], s99 offen offset:256 sc0 sc1
    s_waitcnt vmcnt(0)
K2_NOLD:
    s_waitcnt lgkmcnt(0)
    v_and_b32 v207, 0xffff, v235
    v_lshrrev_b32 v235, 16, v235
    v_lshlrev_b32 v247, 11, v219
    v_add_u32 v247, 34816, v247
    v_add_u32 v220, 138240, v203
    v_cmp_lt_u32 vcc, 0, v235
    s_barrier
    s_cbranch_vccz K2_GDONE
K2_GLOOP:
    s_mov_b64 exec, vcc
    v_bfe_u32 v221, v207, 3, 3
    v_lshlrev_b32 v221, 4, v221
    v_lshl_add_u32 v221, v207, 5, v221
    v_add_u32 v221, v247, v221
    v_xor_b32 v222, 0, v221
    ds_read_b128 v[140:143], v222
    v_xor_b32 v222, 16, v221
    ds_read_b128 v[144:147], v222
    v_xor_b32 v222, 32, v221
    ds_read_b128 v[148:151], v222
    v_xor_b32 v222, 48, v221
    ds_read_b128 v[152:155], v222
    v_xor_b32 v222, 64, v221
    ds_read_b128 v[156:159], v222
    v_xor_b32 v222, 80, v221
    ds_read_b128 v[160:163], v222
    v_xor_b32 v222, 96, v221
    ds_read_b128 v[164:167], v222
    v_xor_b32 v222, 112, v221
    ds_read_b128 v[168:171], v222
    v_lshlrev_b32 v222, 3, v207
    v_add_u32 v222, 129024, v222
    ds_read_b128 v[188:191], v222
    ds_read_b128 v[192:195], v222 offset:16
    v_add_u32 v207, 4, v207
    v_subrev_u32 v235, 1, v235
    v_cmp_lt_u32 vcc, 0, v235
    s_waitcnt lgkmcnt(9)
    v_pk_add_f32 v[76:77], v[76:77], v[140:141]
    v_pk_add_f32 v[78:79], v[78:79], v[142:143]
    s_waitcnt lgkmcnt(8)
    v_pk_add_f32 v[80:81], v[80:81], v[144:145]
    v_pk_add_f32 v[82:83], v[82:83], v[146:147]
    s_waitcnt lgkmcnt(7)
    v_pk_add_f32 v[84:85], v[84:85], v[148:149]
    v_pk_add_f32 v[86:87], v[86:87], v[150:151]
    s_waitcnt lgkmcnt(6)
    v_pk_add_f32 v[88:89], v[88:89], v[152:153]
    v_pk_add_f32 v[90:91], v[90:91], v[154:155]
    s_waitcnt lgkmcnt(5)
    v_pk_add_f32 v[92:93], v[92:93], v[156:157]
    v_pk_add_f32 v[94:95], v[94:95], v[158:159]
    s_waitcnt lgkmcnt(4)
    v_pk_add_f32 v[96:97], v[96:97], v[160:161]
    v_pk_add_f32 v[98:99], v[98:99], v[162:163]
    s_waitcnt lgkmcnt(3)
    v_pk_add_f32 v[100:101], v[100:101], v[164:165]
    v_pk_add_f32 v[102:103], v[102:103], v[166:167]
    s_waitcnt lgkmcnt(2)
    v_pk_add_f32 v[104:105], v[104:105], v[168:169]
    v_pk_add_f32 v[106:107], v[106:107], v[170:171]
    s_waitcnt lgkmcnt(0)
    v_pk_add_f32 v[244:245], v[244:245], v[188:189]
    v_add_f32 v246, v246, v190
    v_pk_add_f32 v[244:245], v[244:245], v[192:193]
    v_add_f32 v246, v246, v194
    s_cbranch_vccnz K2_GLOOP
    s_mov_b64 exec, -1
K2_GDONE:
    s_cmp_eq_u32 s93, 0
    s_cbranch_scc1 K2_EPI
    buffer_store_dwordx4 v[76:79], v243, s[20:23], s99 offen offset:0
    buffer_store_dwordx4 v[80:83], v243, s[20:23], s99 offen offset:16
    buffer_store_dwordx4 v[84:87], v243, s[20:23], s99 offen offset:32
    buffer_store_dwordx4 v[88:91], v243, s[20:23], s99 offen offset:48
    buffer_store_dwordx4 v[92:95], v243, s[20:23], s99 offen offset:64
    buffer_store_dwordx4 v[96:99], v243, s[20:23], s99 offen offset:80
    buffer_store_dwordx4 v[100:103], v243, s[20:23], s99 offen offset:96
    buffer_store_dwordx4 v[104:107], v243, s[20:23], s99 offen offset:112
    buffer_store_dwordx3 v[244:246], v249, s[20:23], s99 offen offset:256
    s_add_u32 s7, s7, s92
    s_waitcnt vmcnt(0)
    s_barrier
    s_branch K2_TOP
K2_EPI:
    s_cmp_ge_u32 s5, 6
    s_cbranch_scc1 K2_NWH2
    s_mul_i32 s95, s5, 2048
    s_add_u32 m0, s95, 138240
    s_add_u32 s95, s95, 7561216
    buffer_load_dwordx4 v203, s[20:23], s95 offen offset:0 sc1 lds
    buffer_load_dwordx4 v203, s[20:23], s95 offen offset:1024 sc1 lds
K2_NWH2:
    s_lshl_b32 s95, s5, 5
    s_cmp_ge_u32 s95, s96
    s_waitcnt vmcnt(0)
    s_barrier
    s_cbranch_scc1 K2_END0
    ds_read_b128 v[0:3], v220 offset:20480
    ds_read_b128 v[4:7], v220 offset:21504
    ds_read_b128 v[8:11], v220 offset:22528
    ds_read_b128 v[12:15], v220 offset:23552
    ds_read_b128 v[16:19], v220 offset:0
    ds_read_b128 v[20:23], v220 offset:1024
    ds_read_b128 v[24:27], v220 offset:2048
    ds_read_b128 v[28:31], v220 offset:3072
    ds_read_b128 v[44:47], v220 offset:4096
    ds_read_b128 v[48:51], v220 offset:5120
    ds_read_b128 v[52:55], v220 offset:6144
    ds_read_b128 v[56:59], v220 offset:7168
    ds_read_b128 v[60:63], v220 offset:8192
    ds_read_b128 v[64:67], v220 offset:9216
    ds_read_b128 v[68:71], v220 offset:10240
    ds_read_b128 v[72:75], v220 offset:11264
    v_cmp_gt_u32_e64 s[44:45], s96, v223
    s_mov_b32 s98, s101
    s_waitcnt vmcnt(0)
    v_mov_b32 v242, v241
    v_and_b32 v241, 0xffff0000, v240
    v_lshlrev_b32 v240, 16, v240
K2_TAIL:
    v_add_u32 v235, s98, v203
    v_lshlrev_b32 v203, 7, v218
    v_cndmask_b32_e64 v203, 2.0, v203, s[44:45]
    s_waitcnt lgkmcnt(8)
    v_mfma_f32_32x32x16_bf16 v[140:155], v[0:3], v[172:175], 0
    v_cvt_pk_bf16_f32 v108, v76, v77
    v_cvt_pk_bf16_f32 v109, v78, v79
    v_mfma_f32_32x32x16_bf16 v[156:171], v[16:19], v[172:175], 0
    v_cvt_pk_bf16_f32 v110, v80, v81
    v_cvt_pk_bf16_f32 v111, v82, v83
    v_mfma_f32_32x32x16_bf16 v[140:155], v[4:7], v[176:179], v[140:155]
    v_cvt_pk_bf16_f32 v112, v84, v85
    v_cvt_pk_bf16_f32 v113, v86, v87
    v_mfma_f32_32x32x16_bf16 v[156:171], v[20:23], v[176:179], v[156:171]
    v_cvt_pk_bf16_f32 v114, v88, v89
    v_cvt_pk_bf16_f32 v115, v90, v91
    v_mfma_f32_32x32x16_bf16 v[140:155], v[8:11], v[180:183], v[140:155]
    v_cvt_pk_bf16_f32 v116, v92, v93
    v_cvt_pk_bf16_f32 v117, v94, v95
    v_mfma_f32_32x32x16_bf16 v[156:171], v[24:27], v[180:183], v[156:171]
    v_cvt_pk_bf16_f32 v118, v96, v97
    v_cvt_pk_bf16_f32 v119, v98, v99
    v_mfma_f32_32x32x16_bf16 v[140:155], v[12:15], v[184:187], v[140:155]
    v_cvt_pk_bf16_f32 v120, v100, v101
    v_cvt_pk_bf16_f32 v121, v102, v103
    v_mfma_f32_32x32x16_bf16 v[156:171], v[28:31], v[184:187], v[156:171]
    v_cvt_pk_bf16_f32 v122, v104, v105
    v_cvt_pk_bf16_f32 v123, v106, v107
    s_waitcnt lgkmcnt(0)
    ds_bpermute_b32 v210, v239, v203 offset:0
    ds_bpermute_b32 v212, v239, v203 offset:32
    ds_bpermute_b32 v214, v239, v203 offset:64
    ds_bpermute_b32 v216, v239, v203 offset:96
    v_mfma_f32_32x32x16_bf16 v[140:155], v[44:47], v[108:111], v[140:155]
    v_lshlrev_b32 v76, 16, v172
    v_and_b32 v77, 0xffff0000, v172
    v_lshlrev_b32 v78, 16, v173
    v_and_b32 v79, 0xffff0000, v173
    v_lshlrev_b32 v80, 16, v174
    v_and_b32 v81, 0xffff0000, v174
    v_lshlrev_b32 v82, 16, v175
    v_and_b32 v83, 0xffff0000, v175
    v_mfma_f32_32x32x16_bf16 v[140:155], v[48:51], v[112:115], v[140:155]
    v_lshlrev_b32 v84, 16, v176
    v_and_b32 v85, 0xffff0000, v176
    v_lshlrev_b32 v86, 16, v177
    v_and_b32 v87, 0xffff0000, v177
    v_lshlrev_b32 v88, 16, v178
    v_and_b32 v89, 0xffff0000, v178
    v_lshlrev_b32 v90, 16, v179
    v_and_b32 v91, 0xffff0000, v179
    v_mfma_f32_32x32x16_bf16 v[140:155], v[52:55], v[116:119], v[140:155]
    v_lshlrev_b32 v92, 16, v180
    v_and_b32 v93, 0xffff0000, v180
    v_lshlrev_b32 v94, 16, v181
    v_and_b32 v95, 0xffff0000, v181
    v_lshlrev_b32 v96, 16, v182
    v_and_b32 v97, 0xffff0000, v182
    v_lshlrev_b32 v98, 16, v183
    v_and_b32 v99, 0xffff0000, v183
    v_mfma_f32_32x32x16_bf16 v[140:155], v[56:59], v[120:123], v[140:155]
    v_lshlrev_b32 v100, 16, v184
    v_and_b32 v101, 0xffff0000, v184
    v_lshlrev_b32 v102, 16, v185
    v_and_b32 v103, 0xffff0000, v185
    v_lshlrev_b32 v104, 16, v186
    v_and_b32 v105, 0xffff0000, v186
    v_lshlrev_b32 v106, 16, v187
    v_and_b32 v107, 0xffff0000, v187
    v_mfma_f32_32x32x16_bf16 v[156:171], v[60:63], v[108:111], v[156:171]
    v_mov_b32 v243, 0
    v_pk_add_f32 v[244:245], v[244:245], v[240:241]
    v_add_f32 v246, v246, v242
    v_cvt_pk_bf16_f32 v244, v244, v245
    v_cvt_pk_bf16_f32 v246, v246, v246
    s_mov_b32 exec_lo, s44
    s_mov_b32 exec_hi, 0
    s_cmp_eq_u32 s98, s94
    s_cbranch_scc1 K2_PF
    v_mul_u32_u24 v220, 6, v218
    s_mov_b32 s99, 6400000
    buffer_store_short v244, v220, s[24:27], s99 offen
    buffer_store_short_d16_hi v244, v220, s[24:27], s99 offen offset:2
    buffer_store_short v246, v220, s[24:27], s99 offen offset:4
    s_branch K2_PD
K2_PF:
    s_mov_b32 s99, 32768
    v_mad_u32_u24 v220, v249, 6, s99
    ds_write_b16 v220, v244
    ds_write_b16_d16_hi v220, v244 offset:2
    ds_write_b16 v220, v246 offset:4
    s_mov_b64 exec, 1
    v_mov_b32 v220, 108
    v_mov_b32 v221, 1
    ds_add_rtn_u32 v243, v220, v221
K2_PD:
    s_mov_b64 exec, -1
    s_mov_b32 s40, 0xbf317218
    s_mov_b32 s41, 0xbf317218
    v_mfma_f32_32x32x16_bf16 v[156:171], v[64:67], v[112:115], v[156:171]
    v_exp_f32 v220, v140
    v_exp_f32 v221, v141
    v_exp_f32 v222, v142
    v_exp_f32 v223, v143
    v_mfma_f32_32x32x16_bf16 v[156:171], v[68:71], v[116:119], v[156:171]
    v_exp_f32 v224, v144
    v_exp_f32 v225, v145
    v_exp_f32 v226, v146
    v_exp_f32 v227, v147
    v_pk_add_f32 v[220:221], v[220:221], 1.0 op_sel_hi:[1,0]
    v_pk_add_f32 v[222:223], v[222:223], 1.0 op_sel_hi:[1,0]
    v_mfma_f32_32x32x16_bf16 v[156:171], v[72:75], v[120:123], v[156:171]
    v_pk_add_f32 v[224:225], v[224:225], 1.0 op_sel_hi:[1,0]
    v_pk_add_f32 v[226:227], v[226:227], 1.0 op_sel_hi:[1,0]
    v_rcp_f32 v220, v220
    v_rcp_f32 v221, v221
    v_rcp_f32 v222, v222
    v_rcp_f32 v223, v223
    v_rcp_f32 v224, v224
    v_rcp_f32 v225, v225
    v_rcp_f32 v226, v226
    v_rcp_f32 v227, v227
    s_waitcnt lgkmcnt(0)
    v_add_u32 v210, v210, v211
    v_add_u32 v212, v212, v213
    v_add_u32 v214, v214, v215
    v_add_u32 v216, v216, v217
    v_pk_mul_f32 v[220:221], v[220:221], v[140:141]
    v_pk_mul_f32 v[222:223], v[222:223], v[142:143]
    v_pk_mul_f32 v[224:225], v[224:225], v[144:145]
    v_pk_mul_f32 v[226:227], v[226:227], v[146:147]
    v_pk_fma_f32 v[220:221], v[220:221], s[40:41], v[76:77]
    v_pk_fma_f32 v[222:223], v[222:223], s[40:41], v[78:79]
    v_pk_fma_f32 v[224:225], v[224:225], s[40:41], v[80:81]
    v_pk_fma_f32 v[226:227], v[226:227], s[40:41], v[82:83]
    v_cvt_pk_bf16_f32 v172, v220, v221
    v_cvt_pk_bf16_f32 v173, v222, v223
    v_cvt_pk_bf16_f32 v174, v224, v225
    v_cvt_pk_bf16_f32 v175, v226, v227
    s_waitcnt vmcnt(0)
    ds_write_b128 v251, v[172:175]
    v_exp_f32 v220, v148
    v_exp_f32 v221, v149
    v_exp_f32 v222, v150
    v_exp_f32 v223, v151
    v_exp_f32 v224, v152
    v_exp_f32 v225, v153
    v_exp_f32 v226, v154
    v_exp_f32 v227, v155
    v_pk_add_f32 v[220:221], v[220:221], 1.0 op_sel_hi:[1,0]
    v_pk_add_f32 v[222:223], v[222:223], 1.0 op_sel_hi:[1,0]
    v_pk_add_f32 v[224:225], v[224:225], 1.0 op_sel_hi:[1,0]
    v_pk_add_f32 v[226:227], v[226:227], 1.0 op_sel_hi:[1,0]
    v_rcp_f32 v220, v220
    v_rcp_f32 v221, v221
    v_rcp_f32 v222, v222
    v_rcp_f32 v223, v223
    v_rcp_f32 v224, v224
    v_rcp_f32 v225, v225
    v_rcp_f32 v226, v226
    v_rcp_f32 v227, v227
    v_pk_mul_f32 v[220:221], v[220:221], v[148:149]
    v_pk_mul_f32 v[222:223], v[222:223], v[150:151]
    v_pk_mul_f32 v[224:225], v[224:225], v[152:153]
    v_pk_mul_f32 v[226:227], v[226:227], v[154:155]
    v_pk_fma_f32 v[220:221], v[220:221], s[40:41], v[84:85]
    v_pk_fma_f32 v[222:223], v[222:223], s[40:41], v[86:87]
    v_pk_fma_f32 v[224:225], v[224:225], s[40:41], v[88:89]
    v_pk_fma_f32 v[226:227], v[226:227], s[40:41], v[90:91]
    v_cvt_pk_bf16_f32 v176, v220, v221
    v_cvt_pk_bf16_f32 v177, v222, v223
    v_cvt_pk_bf16_f32 v178, v224, v225
    v_cvt_pk_bf16_f32 v179, v226, v227
    ds_write_b128 v252, v[176:179]
    v_exp_f32 v220, v156
    v_exp_f32 v221, v157
    v_exp_f32 v222, v158
    v_exp_f32 v223, v159
    v_exp_f32 v224, v160
    v_exp_f32 v225, v161
    v_exp_f32 v226, v162
    v_exp_f32 v227, v163
    v_pk_add_f32 v[220:221], v[220:221], 1.0 op_sel_hi:[1,0]
    v_pk_add_f32 v[222:223], v[222:223], 1.0 op_sel_hi:[1,0]
    v_pk_add_f32 v[224:225], v[224:225], 1.0 op_sel_hi:[1,0]
    v_pk_add_f32 v[226:227], v[226:227], 1.0 op_sel_hi:[1,0]
    v_rcp_f32 v220, v220
    v_rcp_f32 v221, v221
    v_rcp_f32 v222, v222
    v_rcp_f32 v223, v223
    v_rcp_f32 v224, v224
    v_rcp_f32 v225, v225
    v_rcp_f32 v226, v226
    v_rcp_f32 v227, v227
    v_pk_mul_f32 v[220:221], v[220:221], v[156:157]
    v_pk_mul_f32 v[222:223], v[222:223], v[158:159]
    v_pk_mul_f32 v[224:225], v[224:225], v[160:161]
    v_pk_mul_f32 v[226:227], v[226:227], v[162:163]
    v_pk_fma_f32 v[220:221], v[220:221], s[40:41], v[92:93]
    v_pk_fma_f32 v[222:223], v[222:223], s[40:41], v[94:95]
    v_pk_fma_f32 v[224:225], v[224:225], s[40:41], v[96:97]
    v_pk_fma_f32 v[226:227], v[226:227], s[40:41], v[98:99]
    v_cvt_pk_bf16_f32 v180, v220, v221
    v_cvt_pk_bf16_f32 v181, v222, v223
    v_cvt_pk_bf16_f32 v182, v224, v225
    v_cvt_pk_bf16_f32 v183, v226, v227
    ds_write_b128 v253, v[180:183]
    v_exp_f32 v220, v164
    v_exp_f32 v221, v165
    v_exp_f32 v222, v166
    v_exp_f32 v223, v167
    v_exp_f32 v224, v168
    v_exp_f32 v225, v169
    v_exp_f32 v226, v170
    v_exp_f32 v227, v171
    v_pk_add_f32 v[220:221], v[220:221], 1.0 op_sel_hi:[1,0]
    v_pk_add_f32 v[222:223], v[222:223], 1.0 op_sel_hi:[1,0]
    v_pk_add_f32 v[224:225], v[224:225], 1.0 op_sel_hi:[1,0]
    v_pk_add_f32 v[226:227], v[226:227], 1.0 op_sel_hi:[1,0]
    v_rcp_f32 v220, v220
    v_rcp_f32 v221, v221
    v_rcp_f32 v222, v222
    v_rcp_f32 v223, v223
    v_rcp_f32 v224, v224
    v_rcp_f32 v225, v225
    v_rcp_f32 v226, v226
    v_rcp_f32 v227, v227
    v_pk_mul_f32 v[220:221], v[220:221], v[164:165]
    v_pk_mul_f32 v[222:223], v[222:223], v[166:167]
    v_pk_mul_f32 v[224:225], v[224:225], v[168:169]
    v_pk_mul_f32 v[226:227], v[226:227], v[170:171]
    v_pk_fma_f32 v[220:221], v[220:221], s[40:41], v[100:101]
    v_pk_fma_f32 v[222:223], v[222:223], s[40:41], v[102:103]
    v_pk_fma_f32 v[224:225], v[224:225], s[40:41], v[104:105]
    v_pk_fma_f32 v[226:227], v[226:227], s[40:41], v[106:107]
    v_cvt_pk_bf16_f32 v184, v220, v221
    v_cvt_pk_bf16_f32 v185, v222, v223
    v_cvt_pk_bf16_f32 v186, v224, v225
    v_cvt_pk_bf16_f32 v187, v226, v227
    ds_write_b128 v254, v[184:187]
    ds_read_b128 v[140:143], v235 offset:0
    ds_read_b128 v[144:147], v235 offset:1024
    ds_read_b128 v[148:151], v235 offset:2048
    ds_read_b128 v[152:155], v235 offset:3072
    s_waitcnt lgkmcnt(3)
    buffer_store_dwordx4 v[140:143], v210, s[24:27], 0 offen sc1
    s_waitcnt lgkmcnt(2)
    buffer_store_dwordx4 v[144:147], v212, s[24:27], 0 offen sc1
    s_waitcnt lgkmcnt(1)
    buffer_store_dwordx4 v[148:151], v214, s[24:27], 0 offen sc1
    s_waitcnt lgkmcnt(0)
    buffer_store_dwordx4 v[152:155], v216, s[24:27], 0 offen sc1
    v_readfirstlane_b32 s95, v243
    v_and_b32 v220, 63, v250
    v_lshlrev_b32 v220, 3, v220
    s_cmp_lg_u32 s95, 7
    s_cbranch_scc1 K2_PE
    ds_read_b64 v[188:189], v220 offset:32768
    ds_read_b64 v[190:191], v220 offset:33280
    ds_read_b64 v[192:193], v220 offset:33792
    s_mul_i32 s99, s4, 6
    s_add_u32 s99, s99, 6400000
    s_mul_i32 s95, s96, 6
    v_cmp_gt_i32 vcc, s95, v220
    s_sub_i32 s95, s95, 512
    s_waitcnt lgkmcnt(2)
    s_mov_b64 exec, vcc
    buffer_store_dwordx2 v[188:189], v220, s[24:27], s99 offen offset:0 sc1
    v_cmp_gt_i32 vcc, s95, v220
    s_sub_i32 s95, s95, 512
    s_waitcnt lgkmcnt(1)
    s_mov_b64 exec, vcc
    buffer_store_dwordx2 v[190:191], v220, s[24:27], s99 offen offset:512 sc1
    v_cmp_gt_i32 vcc, s95, v220
    s_sub_i32 s95, s95, 512
    s_waitcnt lgkmcnt(0)
    s_mov_b64 exec, vcc
    buffer_store_dwordx2 v[192:193], v220, s[24:27], s99 offen offset:1024 sc1
    s_mov_b64 exec, -1
K2_PE:
    s_endpgm
K2_END0:
    s_waitcnt vmcnt(0)
K2_END:
    s_endpgm
.section .rodata,"a"
.p2align 6
.amdhsa_kernel egnn_fused_kernel
  .amdhsa_next_free_vgpr 256
  .amdhsa_next_free_sgpr 102
  .amdhsa_accum_offset 256
  .amdhsa_group_segment_fixed_size 0
  .amdhsa_kernarg_size 88
  .amdhsa_user_sgpr_count 2
  .amdhsa_user_sgpr_kernarg_segment_ptr 1
  .amdhsa_system_sgpr_workgroup_id_x 1
.end_amdhsa_kernel
```

```asm
; @launch kernel=egnn_fused_kernel grid=(256,1,1) block=(512,1,1) lds=162816
.amdgcn_target "amdgcn-amd-amdhsa--gfx950"
.text
.globl egnn_fused_kernel
.p2align 8
.type egnn_fused_kernel,@function
egnn_fused_kernel:
    s_cmp_ge_u32 s2, 256
    s_cbranch_scc1 K2_END
    s_mov_b32 s60, s2
    s_load_dwordx2 s[38:39], s[0:1], 80
    v_lshrrev_b32 v1, 6, v0
    s_nop 0
    v_readfirstlane_b32 s3, v1
    s_cmp_ge_u32 s3, 7
    s_cbranch_scc1 KF_W7
    s_cmp_ge_u32 s2, 250
    s_cbranch_scc1 KF_B4
    s_load_dwordx4 s[4:7], s[0:1], 24
    s_load_dwordx4 s[8:11], s[0:1], 8
    s_and_b32 s28, s2, 7
    s_min_u32 s29, s28, 2
    s_mul_i32 s28, s28, 31
    s_lshr_b32 s2, s2, 3
    s_add_u32 s2, s2, s28
    s_add_u32 s2, s2, s29
    v_lshlrev_b32 v1, 2, v0
    v_lshlrev_b32 v15, 3, v0
    v_mov_b32 v2, 0
    v_mov_b32 v3, 0
    v_cmp_gt_u32 vcc, 144, v0
    s_mov_b64 exec, vcc
    ds_write_b64 v15, v[2:3] offset:0
    s_mov_b64 exec, -1
    v_mov_b32 v3, 1
    s_mul_i32 s28, s2, 12800
    s_mul_i32 s29, s2, 200
    s_mul_i32 s30, s2, 3200
    s_mov_b32 s31, 85599
    s_movk_i32 s32, -196
    v_add_u32 v12, s29, v0
    v_mul_u32_u24 v13, 6, v12
    v_lshlrev_b32 v14, 4, v0
    v_mov_b32 v15, 400
    v_cmp_gt_u32 s[34:35], v15, v0
    v_mov_b32 v15, 200
    v_cmp_gt_u32 s[36:37], v15, v0
    s_waitcnt lgkmcnt(0)
    s_mov_b32 s12, s4
    s_and_b32 s13, s5, 0xffff
    s_mov_b32 s14, 3200000
    s_mov_b32 s15, 0x20000
    s_mov_b32 s16, s6
    s_and_b32 s17, s7, 0xffff
    s_mov_b32 s18, 3200000
    s_mov_b32 s19, 0x20000
    s_mov_b32 s20, s8
    s_and_b32 s21, s9, 0xffff
    s_mov_b32 s22, 300000
    s_mov_b32 s23, 0x20000
    s_mov_b32 s24, s38
    s_and_b32 s25, s39, 0xffff
    s_mov_b32 s26, 25600000
    s_mov_b32 s27, 0x20000
    s_cmp_ge_u32 s3, 4
    s_cbranch_scc1 K1_NOPOS
    s_mov_b64 exec, s[36:37]
    buffer_load_ushort v16, v13, s[20:23], 0 offen
    buffer_load_ushort v17, v13, s[20:23], 0 offen offset:2
    buffer_load_ushort v18, v13, s[20:23], 0 offen offset:4
K1_NOPOS:
    s_mov_b64 exec, s[34:35]
    s_mov_b32 s42, s28
    buffer_load_dwordx4 v[60:63], v14, s[16:19], s42 offen nt
    s_add_u32 s42, s42, 6400
    buffer_load_dwordx4 v[64:67], v14, s[16:19], s42 offen nt
    v_add_u32 v76, s30, v1
    v_add_u32 v78, 1, v76
    v_add_u32 v80, 2, v76
    v_add_u32 v82, 3, v76
    v_add_u32 v84, 1600, v76
    v_add_u32 v86, 1601, v76
    v_add_u32 v88, 1602, v76
    v_add_u32 v90, 1603, v76
    s_barrier
    s_waitcnt vmcnt(0)
    s_mov_b32 s42, s28
    buffer_load_dwordx4 v[68:71], v14, s[12:15], s42 offen nt
    s_add_u32 s42, s42, 6400
    buffer_load_dwordx4 v[72:75], v14, s[12:15], s42 offen nt
    v_mul_u32_u24 v92, s31, v60
    v_lshrrev_b32 v92, 24, v92
    v_mad_i32_i24 v60, v92, s32, v60
    v_lshlrev_b32 v92, 2, v92
    ds_add_rtn_u32 v100, v92, v3 offset:0
    v_lshrrev_b32 v108, 7, v92
    v_mul_u32_u24 v93, s31, v61
    v_lshrrev_b32 v93, 24, v93
    v_mad_i32_i24 v61, v93, s32, v61
    v_lshlrev_b32 v93, 2, v93
    ds_add_rtn_u32 v101, v93, v3 offset:0
    v_lshrrev_b32 v109, 7, v93
    v_mul_u32_u24 v94, s31, v62
    v_lshrrev_b32 v94, 24, v94
    v_mad_i32_i24 v62, v94, s32, v62
    v_lshlrev_b32 v94, 2, v94
    ds_add_rtn_u32 v102, v94, v3 offset:0
    v_lshrrev_b32 v110, 7, v94
    v_mul_u32_u24 v95, s31, v63
    v_lshrrev_b32 v95, 24, v95
    v_mad_i32_i24 v63, v95, s32, v63
    v_lshlrev_b32 v95, 2, v95
    ds_add_rtn_u32 v103, v95, v3 offset:0
    v_lshrrev_b32 v111, 7, v95
    v_mul_u32_u24 v96, s31, v64
    v_lshrrev_b32 v96, 24, v96
    v_mad_i32_i24 v64, v96, s32, v64
    v_lshlrev_b32 v96, 2, v96
    ds_add_rtn_u32 v104, v96, v3 offset:0
    v_lshrrev_b32 v112, 7, v96
    v_mul_u32_u24 v97, s31, v65
    v_lshrrev_b32 v97, 24, v97
    v_mad_i32_i24 v65, v97, s32, v65
    v_lshlrev_b32 v97, 2, v97
    ds_add_rtn_u32 v105, v97, v3 offset:0
    v_lshrrev_b32 v113, 7, v97
    v_mul_u32_u24 v98, s31, v66
    v_lshrrev_b32 v98, 24, v98
    v_mad_i32_i24 v66, v98, s32, v66
    v_lshlrev_b32 v98, 2, v98
    ds_add_rtn_u32 v106, v98, v3 offset:0
    v_lshrrev_b32 v114, 7, v98
    v_mul_u32_u24 v99, s31, v67
    v_lshrrev_b32 v99, 24, v99
    v_mad_i32_i24 v67, v99, s32, v67
    v_lshlrev_b32 v99, 2, v99
    ds_add_rtn_u32 v107, v99, v3 offset:0
    v_lshrrev_b32 v115, 7, v99
    s_cmp_ge_u32 s3, 4
    s_cbranch_scc1 K1_P3
    s_mov_b64 exec, s[36:37]
    v_lshl_or_b32 v16, v17, 16, v16
    v_lshlrev_b32 v17, 16, v18
    v_lshlrev_b32 v12, 3, v12
    s_mov_b32 s33, 6684672
    buffer_store_dwordx2 v[16:17], v12, s[24:27], s33 offen sc1
K1_P3:
    s_mov_b64 exec, -1
    v_and_b32 v2, 63, v0
    v_lshlrev_b32 v2, 4, v2
    s_waitcnt lgkmcnt(0)
    s_barrier
    ds_read_b128 v[36:39], v2 offset:0
    s_waitcnt lgkmcnt(0)
    v_add_u32 v42, v36, v37
    v_add_u32 v43, v42, v38
    v_add_u32 v44, v43, v39
    v_mov_b32 v45, v44
    s_nop 1
    v_add_u32_dpp v45, v45, v45 row_shr:1 row_mask:0xf bank_mask:0xf
    s_nop 1
    v_add_u32_dpp v45, v45, v45 row_shr:2 row_mask:0xf bank_mask:0xf
    s_nop 1
    v_add_u32_dpp v45, v45, v45 row_shr:4 row_mask:0xf bank_mask:0xf
    s_nop 1
    v_add_u32_dpp v45, v45, v45 row_shr:8 row_mask:0xf bank_mask:0xf
    s_nop 1
    v_add_u32_dpp v45, v45, v45 row_bcast:15 row_mask:0xa bank_mask:0xf
    s_nop 1
    v_add_u32_dpp v45, v45, v45 row_bcast:31 row_mask:0xc bank_mask:0xf
    v_sub_u32 v40, v45, v44
    v_add_u32 v41, v40, v36
    v_add_u32 v42, v40, v42
    v_add_u32 v43, v40, v43
    v_lshlrev_b32 v48, 3, v40
    v_lshlrev_b32 v49, 3, v41
    v_lshlrev_b32 v50, 3, v42
    v_lshlrev_b32 v51, 3, v43
    ds_write_b128 v2, v[48:51] offset:1280
    s_mov_b64 exec, s[34:35]
    ds_read_b32 v92, v92 offset:1280
    ds_read_b32 v93, v93 offset:1280
    ds_read_b32 v94, v94 offset:1280
    ds_read_b32 v95, v95 offset:1280
    ds_read_b32 v96, v96 offset:1280
    ds_read_b32 v97, v97 offset:1280
    ds_read_b32 v98, v98 offset:1280
    ds_read_b32 v99, v99 offset:1280
    s_cmp_ge_u32 s3, 4
    s_cbranch_scc1 K1_SW0
    s_waitcnt vmcnt(1)
    s_branch K1_SW1
K1_SW0:
    s_waitcnt vmcnt(0)
K1_SW1:
    v_mul_u32_u24 v77, 2675, v68
    v_lshrrev_b32 v77, 24, v77
    v_sub_u32 v77, v77, v108
    v_and_b32 v77, 7, v77
    v_lshl_or_b32 v60, v60, 3, v77
    v_lshl_or_b32 v77, v60, 18, v68
    v_mul_u32_u24 v79, 2675, v69
    v_lshrrev_b32 v79, 24, v79
    v_sub_u32 v79, v79, v109
    v_and_b32 v79, 7, v79
    v_lshl_or_b32 v61, v61, 3, v79
    v_lshl_or_b32 v79, v61, 18, v69
    v_mul_u32_u24 v81, 2675, v70
    v_lshrrev_b32 v81, 24, v81
    v_sub_u32 v81, v81, v110
    v_and_b32 v81, 7, v81
    v_lshl_or_b32 v62, v62, 3, v81
    v_lshl_or_b32 v81, v62, 18, v70
    v_mul_u32_u24 v83, 2675, v71
    v_lshrrev_b32 v83, 24, v83
    v_sub_u32 v83, v83, v111
    v_and_b32 v83, 7, v83
    v_lshl_or_b32 v63, v63, 3, v83
    v_lshl_or_b32 v83, v63, 18, v71
    v_mul_u32_u24 v85, 2675, v72
    v_lshrrev_b32 v85, 24, v85
    v_sub_u32 v85, v85, v112
    v_and_b32 v85, 7, v85
    v_lshl_or_b32 v64, v64, 3, v85
    v_lshl_or_b32 v85, v64, 18, v72
    v_mul_u32_u24 v87, 2675, v73
    v_lshrrev_b32 v87, 24, v87
    v_sub_u32 v87, v87, v113
    v_and_b32 v87, 7, v87
    v_lshl_or_b32 v65, v65, 3, v87
    v_lshl_or_b32 v87, v65, 18, v73
    v_mul_u32_u24 v89, 2675, v74
    v_lshrrev_b32 v89, 24, v89
    v_sub_u32 v89, v89, v114
    v_and_b32 v89, 7, v89
    v_lshl_or_b32 v66, v66, 3, v89
    v_lshl_or_b32 v89, v66, 18, v74
    v_mul_u32_u24 v91, 2675, v75
    v_lshrrev_b32 v91, 24, v91
    v_sub_u32 v91, v91, v115
    v_and_b32 v91, 7, v91
    v_lshl_or_b32 v67, v67, 3, v91
    v_lshl_or_b32 v91, v67, 18, v75
    s_waitcnt lgkmcnt(7)
    v_lshl_add_u32 v92, v100, 3, v92
    ds_write_b64 v92, v[76:77] offset:2304
    s_waitcnt lgkmcnt(7)
    v_lshl_add_u32 v93, v101, 3, v93
    ds_write_b64 v93, v[78:79] offset:2304
    s_waitcnt lgkmcnt(7)
    v_lshl_add_u32 v94, v102, 3, v94
    ds_write_b64 v94, v[80:81] offset:2304
    s_waitcnt lgkmcnt(7)
    v_lshl_add_u32 v95, v103, 3, v95
    ds_write_b64 v95, v[82:83] offset:2304
    s_waitcnt lgkmcnt(7)
    v_lshl_add_u32 v96, v104, 3, v96
    ds_write_b64 v96, v[84:85] offset:2304
    s_waitcnt lgkmcnt(7)
    v_lshl_add_u32 v97, v105, 3, v97
    ds_write_b64 v97, v[86:87] offset:2304
    s_waitcnt lgkmcnt(7)
    v_lshl_add_u32 v98, v106, 3, v98
    ds_write_b64 v98, v[88:89] offset:2304
    s_waitcnt lgkmcnt(7)
    v_lshl_add_u32 v99, v107, 3, v99
    ds_write_b64 v99, v[90:91] offset:2304
    s_mul_i32 s33, s2, 25600
    s_waitcnt lgkmcnt(0)
    s_barrier
    ds_read_b128 v[60:63], v14 offset:2304
    ds_read_b128 v[64:67], v14 offset:8704
    ds_read_b128 v[68:71], v14 offset:15104
    ds_read_b128 v[72:75], v14 offset:21504
    s_waitcnt lgkmcnt(3)
    buffer_store_dwordx4 v[60:63], v14, s[24:27], s33 offen sc1
    s_add_u32 s33, s33, 6400
    s_waitcnt lgkmcnt(2)
    buffer_store_dwordx4 v[64:67], v14, s[24:27], s33 offen sc1
    s_add_u32 s33, s33, 6400
    s_waitcnt lgkmcnt(1)
    buffer_store_dwordx4 v[68:71], v14, s[24:27], s33 offen sc1
    s_add_u32 s33, s33, 6400
    s_waitcnt lgkmcnt(0)
    buffer_store_dwordx4 v[72:75], v14, s[24:27], s33 offen sc1
    s_mov_b64 exec, -1
    s_waitcnt vmcnt(0)
    s_barrier
    v_mov_b32 v2, 0
    ds_read_b64 v[196:197], v2 offset:1152
    s_cmp_lg_u32 s3, 6
    s_waitcnt lgkmcnt(0)
    s_cbranch_scc1 K2_ENTRY
    v_and_b32 v2, 63, v0
    v_lshlrev_b32 v2, 4, v2
    v_add_u32 v44, v43, v39
    v_lshl_or_b32 v40, v41, 16, v40
    v_lshl_or_b32 v41, v43, 16, v42
    v_lshl_or_b32 v42, v197, 16, v44
    v_mov_b32 v43, v196
    s_lshl_b32 s33, s2, 10
    s_add_u32 s33, s33, 6422528
    buffer_store_dwordx4 v[40:43], v2, s[24:27], s33 offen sc1
    s_branch K2_ENTRY
KF_B4:
    s_barrier
    v_mov_b32 v2, 0
    ds_read_b64 v[196:197], v2 offset:1152
    s_waitcnt lgkmcnt(0)
    s_branch K2_ENTRY
KF_W7:
    s_load_dwordx2 s[56:57], s[0:1], 72
    s_waitcnt lgkmcnt(0)
    s_mov_b32 s48, s56
    s_and_b32 s49, s57, 0xffff
    s_mov_b32 s50, 256
    s_mov_b32 s51, 0x20000
    v_mov_b32 v22, 0
    s_cmp_lg_u32 s2, 0
    s_cbranch_scc1 KF_NN
    s_memrealtime s[52:53]
    s_waitcnt lgkmcnt(0)
    s_or_b32 s52, s52, 1
    s_and_b32 s53, s53, 0xffff
    v_mov_b32 v20, s52
    v_mov_b32 v21, s53
    s_mov_b64 exec, 1
    buffer_store_dwordx2 v[20:21], v22, s[48:51], 0 offen sc1
    s_mov_b64 exec, -1
KF_NN:
    s_cmp_ge_u32 s2, 250
    s_cbranch_scc1 KF_NP
    s_barrier
    s_branch K1_FRAG
KF_FJ:
    s_barrier
    s_barrier
KF_NP:
    s_mov_b32 s54, 0x40000
    s_mov_b64 exec, 1
KF_NL:
    buffer_load_dwordx2 v[20:21], v22, s[48:51], 0 offen sc1
    s_waitcnt vmcnt(0)
    v_readfirstlane_b32 s52, v20
    s_cmp_lg_u32 s52, 0
    s_cbranch_scc1 KF_NX
    s_sub_u32 s54, s54, 1
    s_cbranch_scc0 KF_NL
KF_NX:
    ds_write_b64 v22, v[20:21] offset:1152
    s_mov_b64 exec, -1
    s_waitcnt vmcnt(0) lgkmcnt(0)
    s_branch KF_B4
K1_FRAG:
    s_cmp_ge_u32 s2, 144
    s_cbranch_scc1 K1_END
    s_load_dwordx4 s[4:7], s[0:1], 40
    s_load_dwordx2 s[8:9], s[0:1], 56
    s_lshr_b32 s28, s2, 2
    s_and_b32 s3, s2, 3
    s_lshl_b32 s3, s3, 6
    v_and_b32 v1, 63, v0
    v_add_u32 v1, s3, v1
    v_lshlrev_b32 v10, 2, v1
    s_lshl_b32 s33, s28, 10
    s_add_u32 s33, s33, 7536640
    s_mov_b32 s34, 0xbfb8aa3b
    s_waitcnt lgkmcnt(0)
    s_mov_b32 s12, s4
    s_and_b32 s13, s5, 0xffff
    s_mov_b32 s14, 18560
    s_mov_b32 s15, 0x20000
    s_mov_b32 s16, s6
    s_and_b32 s17, s7, 0xffff
    s_mov_b32 s18, 128
    s_mov_b32 s19, 0x20000
    s_mov_b32 s20, s8
    s_and_b32 s21, s9, 0xffff
    s_mov_b32 s22, 16384
    s_mov_b32 s23, 0x20000
    s_mov_b32 s24, s38
    s_and_b32 s25, s39, 0xffff
    s_mov_b32 s26, 25427968
    s_mov_b32 s27, 0x20000
    s_cmp_eq_u32 s28, 19
    s_cbranch_scc1 K1_WX
    s_cmp_eq_u32 s28, 18
    s_cbranch_scc1 K1_W3
    v_lshrrev_b32 v2, 2, v1
    v_and_b32 v3, 4, v2
    v_lshlrev_b32 v3, 3, v3
    v_bfe_u32 v4, v2, 3, 2
    v_lshl_add_u32 v3, v4, 2, v3
    v_and_b32 v4, 3, v2
    v_add_u32 v3, v3, v4
    v_lshrrev_b32 v5, 7, v1
    v_and_b32 v6, 3, v1
    s_mov_b32 s35, 32
    s_cmp_ge_u32 s28, 18
    s_cbranch_scc1 K1_FH
    s_cmp_ge_u32 s28, 16
    s_cbranch_scc1 K1_F4
    s_mov_b32 s36, s28
    s_branch K1_FC
K1_FH:
    s_sub_u32 s36, s28, 20
    s_mov_b32 s12, s20
    s_mov_b32 s13, s21
    s_mov_b32 s14, s22
    s_cmp_ge_u32 s36, 8
    s_cselect_b32 s34, 1.0, s34
K1_FC:
    s_lshr_b32 s37, s36, 3
    s_lshl_b32 s37, s37, 6
    s_and_b32 s38, s36, 3
    s_lshl_b32 s38, s38, 3
    s_add_u32 s37, s37, s38
    s_bfe_u32 s38, s36, 0x10002
    s_branch K1_FD
K1_F4:
    s_mov_b32 s35, 8
    s_movk_i32 s37, 129
    s_sub_u32 s38, s28, 16
K1_FD:
    s_lshl_b32 s38, s38, 4
    v_mul_u32_u24 v5, s35, v5
    v_lshl_add_u32 v5, v6, 1, v5
    v_add_u32 v5, s37, v5
    v_add_u32 v3, s38, v3
    v_lshlrev_b32 v3, 1, v3
    v_lshl_add_u32 v3, v5, 7, v3
    buffer_load_ushort v7, v3, s[12:15], 0 offen
    buffer_load_ushort v8, v3, s[12:15], 0 offen offset:128
    s_waitcnt vmcnt(0)
    v_lshlrev_b32 v7, 16, v7
    v_lshlrev_b32 v8, 16, v8
    v_mul_f32 v7, s34, v7
    v_mul_f32 v8, s34, v8
    v_cvt_pk_bf16_f32 v7, v7, v8
    buffer_store_dword v7, v10, s[24:27], s33 offen sc1
    s_branch KF_FJ
K1_W3:
    v_and_b32 v2, 31, v1
    v_and_b32 v3, 4, v2
    v_lshlrev_b32 v3, 3, v3
    v_bfe_u32 v4, v2, 3, 2
    v_lshl_add_u32 v3, v4, 2, v3
    v_and_b32 v4, 3, v2
    v_add_u32 v3, v3, v4
    v_bfe_u32 v5, v1, 6, 1
    v_lshl_add_u32 v3, v5, 4, v3
    v_lshlrev_b32 v3, 1, v3
    s_movk_i32 s35, 16384
    buffer_load_ushort v7, v3, s[12:15], s35 offen
    v_and_b32 v6, 32, v1
    v_cmp_eq_u32 vcc, 0, v6
    s_waitcnt vmcnt(0)
    v_lshlrev_b32 v7, 16, v7
    v_mul_f32 v7, s34, v7
    v_cvt_pk_bf16_f32 v8, v7, v7
    v_lshlrev_b32 v8, 16, v8
    v_sub_f32 v9, v7, v8
    v_cvt_pk_bf16_f32 v7, v8, v9
    v_cndmask_b32 v7, 0, v7, vcc
    buffer_store_dword v7, v10, s[24:27], s33 offen sc1
    s_branch KF_FJ
K1_WX:
    v_lshlrev_b32 v3, 1, v1
    buffer_load_ushort v7, v3, s[16:19], 0 offen
    s_waitcnt vmcnt(0)
    v_lshlrev_b32 v7, 16, v7
    v_mul_f32 v7, 0xbf317218, v7
    buffer_store_dword v7, v10, s[24:27], s33 offen sc1
K1_END:
    s_branch KF_FJ
K2_ENTRY:
    s_mov_b32 s2, s60
    s_load_dwordx2 s[28:29], s[0:1], 0
    s_load_dwordx2 s[30:31], s[0:1], 16
    s_load_dwordx2 s[32:33], s[0:1], 64
    s_load_dwordx2 s[34:35], s[0:1], 80
    v_mov_b32 v250, v0
    v_lshrrev_b32 v220, 6, v0
    s_and_b32 s3, s2, 7
    s_lshl_b32 s3, s3, 5
    v_readfirstlane_b32 s5, v220
    s_lshr_b32 s95, s2, 3
    s_add_u32 s3, s3, s95
    s_mul_i32 s4, s3, 196
    s_sub_u32 s96, 50000, s4
    s_min_u32 s96, s96, 196
    s_mov_b32 s7, 0
    s_mov_b32 s92, 48
    s_sub_u32 s100, 11, s5
    s_cmp_lt_u32 s5, 4
    s_cselect_b32 s100, s5, s100
    s_lshl_b32 s94, s100, 12
    s_add_u32 s94, s94, 34816
    s_waitcnt lgkmcnt(0)
    s_add_u32 s88, s34, 6422528
    s_addc_u32 s89, s35, 0
    s_and_b32 s89, s89, 0xffff
    s_mov_b32 s90, 262144
    s_mov_b32 s91, 0x20000
    s_mov_b32 s8, s28
    s_and_b32 s9, s29, 0xffff
    s_or_b32 s9, s9, 8388608
    s_mov_b32 s10, 50000
    s_mov_b32 s11, 0x20000
    s_mov_b32 s12, s30
    s_and_b32 s13, s31, 0xffff
    s_or_b32 s13, s13, 2097152
    s_mov_b32 s14, 800000
    s_mov_b32 s15, 0x20000
    s_add_u32 s16, s34, 6684672
    s_addc_u32 s17, s35, 0
    s_and_b32 s17, s17, 0xffff
    s_or_b32 s17, s17, 524288
    s_mov_b32 s18, 50000
    s_mov_b32 s19, 0x20000
    s_mov_b32 s20, s34
    s_and_b32 s21, s35, 0xffff
    s_mov_b32 s22, 25427968
    s_mov_b32 s23, 0x20000
    s_mov_b32 s24, s32
    s_and_b32 s25, s33, 0xffff
    s_mov_b32 s26, 6700000
    s_mov_b32 s27, 0x20000
K2_TOP:
    v_bfe_u32 v220, v250, 4, 2
    s_mul_i32 s95, s5, 36
    s_sub_u32 s95, s95, 36
    v_mad_u32_u24 v220, v220, 9, s95
    v_lshlrev_b32 v221, 4, v220
    s_and_b32 s95, s3, 3
    s_mul_i32 s95, s95, 1020
    s_lshl_b32 s99, s3, 10
    s_sub_u32 s95, s99, s95
    v_and_b32 v102, 63, v250
    s_mul_i32 s99, s5, 36
    s_sub_u32 s99, s99, 36
    v_cmp_gt_u32_e64 s[44:45], 36, v102
    v_add_u32 v102, s99, v102
    v_mov_b32 v103, 250
    v_cmp_gt_u32_e64 s[46:47], v103, v102
    s_lshr_b32 s99, s3, 2
    s_lshl_b32 s99, s99, 4
    v_lshl_add_u32 v102, v102, 10, s99
    s_and_b64 s[44:45], s[44:45], s[46:47]
    v_cndmask_b32_e64 v102, 2.0, v102, s[44:45]
    s_cmp_eq_u32 s5, 0
    s_cbranch_scc1 K2_NOOF
    buffer_load_dwordx4 v[98:101], v102, s[88:91], 0 offen sc1
K2_NOOF:
    v_and_b32 v222, 63, v250
    v_lshlrev_b32 v203, 4, v222
    v_lshrrev_b32 v239, 3, v222
    v_lshrrev_b32 v223, 4, v222
    v_xor_b32 v223, v223, v222
    v_and_b32 v223, 7, v223
    v_lshlrev_b32 v211, 4, v223
    v_xor_b32 v213, 64, v211
    v_mov_b32 v215, v211
    v_mov_b32 v217, v213
    s_lshl_b32 s95, s5, 5
    s_add_u32 s95, s95, s4
    v_add_u32 v210, s95, v239
    v_add_u32 v212, 8, v210
    v_add_u32 v214, 16, v210
    v_add_u32 v216, 24, v210
    s_add_u32 s99, s4, s96
    v_cmp_gt_u32 vcc, s99, v210
    s_nop 1
    v_cndmask_b32 v210, -1, v210, vcc
    v_cmp_gt_u32 vcc, s99, v212
    s_nop 1
    v_cndmask_b32 v212, -1, v212, vcc
    v_cmp_gt_u32 vcc, s99, v214
    s_nop 1
    v_cndmask_b32 v214, -1, v214, vcc
    v_cmp_gt_u32 vcc, s99, v216
    s_nop 1
    v_cndmask_b32 v216, -1, v216, vcc
    s_lshl_b32 s101, s5, 12
    s_add_u32 s101, s101, 100352
    s_barrier
    v_mov_b32 v228, 0
    v_mov_b32 v229, 0
    v_mov_b32 v230, 0
    v_mov_b32 v231, 0
    s_lshl_b32 s95, s5, 10
    s_cmp_ge_u32 s5, 4
    s_cselect_b32 s99, 30720, 0
    s_add_u32 s95, s95, s99
    v_add_u32 v223, s95, v203
    ds_write_b128 v223, v[228:231]
    ds_write_b128 v223, v[228:231] offset:4096
    v_and_b32 v223, 2047, v223
    ds_write_b128 v223, v[228:231] offset:43008
    v_lshlrev_b32 v239, 2, v239
    v_mov_b32 v41, 0
    v_mov_b32 v43, 0
    v_mov_b32 v209, 0
    v_lshrrev_b32 v219, 5, v222
    v_lshlrev_b32 v219, 4, v219
    v_and_b32 v223, 31, v222
    v_bfe_u32 v251, v222, 1, 3
    v_lshlrev_b32 v251, 4, v251
    v_lshlrev_b32 v252, 2, v219
    v_xor_b32 v251, v251, v252
    v_lshl_add_u32 v251, v223, 7, v251
    v_add_u32 v251, s94, v251
    v_xor_b32 v252, 16, v251
    v_xor_b32 v253, 32, v251
    v_xor_b32 v254, 48, v251
    v_and_b32 v222, 15, v250
    v_cmp_gt_u32 vcc, 243, v220
    v_mul_u32_u24 v220, 3200, v220
    v_add3_u32 v220, v220, v222, s7
    v_add_u32 v221, 16, v222
    v_add_u32 v223, 32, v222
    v_cmp_gt_u32_e64 s[32:33], s92, v221
    v_cmp_gt_u32_e64 s[34:35], s92, v222
    s_nop 0
    v_cndmask_b32_e64 v221, 2.0, v221, s[32:33]
    v_cndmask_b32_e64 v223, 2.0, v223, s[32:33]
    v_cndmask_b32_e64 v222, 2.0, v222, s[34:35]
    s_cmp_eq_u32 s5, 0
    s_cbranch_scc1 KF_PD
    s_cmp_eq_u32 s92, 48
    s_cselect_b32 s50, 1, 0
    s_cmp_eq_u32 s7, 0
    s_cselect_b32 s50, s50, 0
    s_cmp_eq_u32 s50, 1
    s_cselect_b64 s[52:53], s[44:45], 0
    s_mov_b32 s50, 0x40000
KF_PL:
    s_waitcnt vmcnt(0)
    v_lshrrev_b32 v104, 16, v100
    v_cmp_eq_u32_e64 s[46:47], v101, v196
    v_cmp_eq_u32_e64 s[48:49], v104, v197
    s_and_b64 s[46:47], s[46:47], s[48:49]
    s_andn2_b64 s[46:47], s[52:53], s[46:47]
    s_cbranch_scc0 KF_OK
    s_sub_u32 s50, s50, 1
    s_cbranch_scc1 KF_OK
    buffer_load_dwordx4 v[98:101], v102, s[88:91], 0 offen sc1
    s_branch KF_PL
KF_OK:
    s_and_b32 s50, s3, 3
    s_cmp_lt_u32 s50, 2
    s_cselect_b64 s[46:47], -1, 0
    s_and_b32 s50, s50, 1
    s_lshl_b32 s50, s50, 4
    v_cndmask_b32_e64 v104, v99, v98, s[46:47]
    v_cndmask_b32_e64 v105, v100, v99, s[46:47]
    v_alignbit_b32 v104, v105, v104, s50
    v_lshlrev_b32 v105, 16, v104
    v_sub_u32 v104, v104, v105
    v_cndmask_b32_e64 v104, 0, v104, s[44:45]
    v_bfe_u32 v105, v250, 4, 2
    v_mul_u32_u24 v105, 36, v105
    ds_bpermute_b32 v172, v105, v104 offset:0
    ds_bpermute_b32 v173, v105, v104 offset:4
    ds_bpermute_b32 v174, v105, v104 offset:8
    ds_bpermute_b32 v175, v105, v104 offset:12
    ds_bpermute_b32 v176, v105, v104 offset:16
    ds_bpermute_b32 v177, v105, v104 offset:20
    ds_bpermute_b32 v178, v105, v104 offset:24
    ds_bpermute_b32 v179, v105, v104 offset:28
    ds_bpermute_b32 v180, v105, v104 offset:32
    s_waitcnt lgkmcnt(0)
KF_PD:
    s_cmp_eq_u32 s5, 0
    s_cbranch_scc0 K2_MK
    s_branch K2_NOREC
K2_MK:
    v_cndmask_b32 v179, 0, v179, vcc
    v_cndmask_b32 v180, 0, v180, vcc
    v_and_b32 v98, 0xffff, v172
    v_lshrrev_b32 v172, 16, v172
    v_subrev_u32 v172, s7, v172
    v_cmp_gt_i32_e64 s[32:33], v172, v222
    v_add_lshl_u32 v98, v98, v220, 3
    s_mov_b32 s95, 0
    v_cndmask_b32_e64 v98, 2.0, v98, s[32:33]
    buffer_load_dwordx2 v[44:45], v98, s[20:23], s95 offen sc1
    v_and_b32 v99, 0xffff, v173
    v_lshrrev_b32 v173, 16, v173
    v_subrev_u32 v173, s7, v173
    v_cmp_gt_i32_e64 s[34:35], v173, v222
    v_add_lshl_u32 v99, v99, v220, 3
    s_mov_b32 s95, 25600
    v_cndmask_b32_e64 v99, 2.0, v99, s[34:35]
    buffer_load_dwordx2 v[46:47], v99, s[20:23], s95 offen sc1
    v_and_b32 v100, 0xffff, v174
    v_lshrrev_b32 v174, 16, v174
    v_subrev_u32 v174, s7, v174
    v_cmp_gt_i32_e64 s[36:37], v174, v222
    v_add_lshl_u32 v100, v100, v220, 3
    s_mov_b32 s95, 51200
    v_cndmask_b32_e64 v100, 2.0, v100, s[36:37]
    buffer_load_dwordx2 v[48:49], v100, s[20:23], s95 offen sc1
    v_and_b32 v101, 0xffff, v175
    v_lshrrev_b32 v175, 16, v175
    v_subrev_u32 v175, s7, v175
    v_cmp_gt_i32_e64 s[38:39], v175, v222
    v_add_lshl_u32 v101, v101, v220, 3
    s_mov_b32 s95, 76800
    v_cndmask_b32_e64 v101, 2.0, v101, s[38:39]
    buffer_load_dwordx2 v[50:51], v101, s[20:23], s95 offen sc1
    v_and_b32 v102, 0xffff, v176
    v_lshrrev_b32 v176, 16, v176
    v_subrev_u32 v176, s7, v176
    v_cmp_gt_i32_e64 s[40:41], v176, v222
    v_add_lshl_u32 v102, v102, v220, 3
    s_mov_b32 s95, 102400
    v_cndmask_b32_e64 v102, 2.0, v102, s[40:41]
    buffer_load_dwordx2 v[52:53], v102, s[20:23], s95 offen sc1
    v_and_b32 v103, 0xffff, v177
    v_lshrrev_b32 v177, 16, v177
    v_subrev_u32 v177, s7, v177
    v_cmp_gt_i32_e64 s[42:43], v177, v222
    v_add_lshl_u32 v103, v103, v220, 3
    s_mov_b32 s95, 128000
    v_cndmask_b32_e64 v103, 2.0, v103, s[42:43]
    buffer_load_dwordx2 v[54:55], v103, s[20:23], s95 offen sc1
    v_and_b32 v104, 0xffff, v178
    v_lshrrev_b32 v178, 16, v178
    v_subrev_u32 v178, s7, v178
    v_cmp_gt_i32_e64 s[44:45], v178, v222
    v_add_lshl_u32 v104, v104, v220, 3
    s_mov_b32 s95, 153600
    v_cndmask_b32_e64 v104, 2.0, v104, s[44:45]
    buffer_load_dwordx2 v[56:57], v104, s[20:23], s95 offen sc1
    v_and_b32 v105, 0xffff, v179
    v_lshrrev_b32 v179, 16, v179
    v_subrev_u32 v179, s7, v179
    v_cmp_gt_i32_e64 s[46:47], v179, v222
    v_add_lshl_u32 v105, v105, v220, 3
    s_mov_b32 s95, 179200
    v_cndmask_b32_e64 v105, 2.0, v105, s[46:47]
    buffer_load_dwordx2 v[58:59], v105, s[20:23], s95 offen sc1
    v_and_b32 v106, 0xffff, v180
    v_lshrrev_b32 v180, 16, v180
    v_subrev_u32 v180, s7, v180
    v_cmp_gt_i32_e64 s[48:49], v180, v222
    v_add_lshl_u32 v106, v106, v220, 3
    s_mov_b32 s95, 204800
    v_cndmask_b32_e64 v106, 2.0, v106, s[48:49]
    buffer_load_dwordx2 v[60:61], v106, s[20:23], s95 offen sc1
    v_cmp_gt_i32_e64 s[50:51], v172, v221
    v_cmp_gt_i32_e64 s[68:69], v172, v223
    v_cmp_gt_i32_e64 s[52:53], v173, v221
    v_cmp_gt_i32_e64 s[70:71], v173, v223
    v_cmp_gt_i32_e64 s[54:55], v174, v221
    v_cmp_gt_i32_e64 s[72:73], v174, v223
    v_cmp_gt_i32_e64 s[56:57], v175, v221
    v_cmp_gt_i32_e64 s[74:75], v175, v223
    v_cmp_gt_i32_e64 s[58:59], v176, v221
    v_cmp_gt_i32_e64 s[76:77], v176, v223
    v_cmp_gt_i32_e64 s[60:61], v177, v221
    v_cmp_gt_i32_e64 s[78:79], v177, v223
    v_cmp_gt_i32_e64 s[62:63], v178, v221
    v_cmp_gt_i32_e64 s[80:81], v178, v223
    v_cmp_gt_i32_e64 s[64:65], v179, v221
    v_cmp_gt_i32_e64 s[82:83], v179, v223
    v_cmp_gt_i32_e64 s[66:67], v180, v221
    v_cmp_gt_i32_e64 s[84:85], v180, v223
    s_mov_b32 s95, 0
    s_mov_b64 exec, s[50:51]
    s_cbranch_execz K2_G1
    buffer_load_dwordx2 v[62:63], v98, s[20:23], s95 offen offset:128 sc1
K2_G1:
    s_mov_b32 s95, 25600
    s_mov_b64 exec, s[52:53]
    s_cbranch_execz K2_G2
    buffer_load_dwordx2 v[64:65], v99, s[20:23], s95 offen offset:128 sc1
K2_G2:
    s_mov_b32 s95, 51200
    s_mov_b64 exec, s[54:55]
    s_cbranch_execz K2_G3
    buffer_load_dwordx2 v[66:67], v100, s[20:23], s95 offen offset:128 sc1
K2_G3:
    s_mov_b32 s95, 76800
    s_mov_b64 exec, s[56:57]
    s_cbranch_execz K2_G4
    buffer_load_dwordx2 v[68:69], v101, s[20:23], s95 offen offset:128 sc1
K2_G4:
    s_mov_b32 s95, 102400
    s_mov_b64 exec, s[58:59]
    s_cbranch_execz K2_G5
    buffer_load_dwordx2 v[70:71], v102, s[20:23], s95 offen offset:128 sc1
K2_G5:
    s_mov_b32 s95, 128000
    s_mov_b64 exec, s[60:61]
    s_cbranch_execz K2_G6
    buffer_load_dwordx2 v[72:73], v103, s[20:23], s95 offen offset:128 sc1
K2_G6:
    s_mov_b32 s95, 153600
    s_mov_b64 exec, s[62:63]
    s_cbranch_execz K2_G7
    buffer_load_dwordx2 v[74:75], v104, s[20:23], s95 offen offset:128 sc1
K2_G7:
    s_mov_b32 s95, 179200
    s_mov_b64 exec, s[64:65]
    s_cbranch_execz K2_G8
    buffer_load_dwordx2 v[76:77], v105, s[20:23], s95 offen offset:128 sc1
K2_G8:
    s_mov_b32 s95, 204800
    s_mov_b64 exec, s[66:67]
    s_cbranch_execz K2_G9
    buffer_load_dwordx2 v[78:79], v106, s[20:23], s95 offen offset:128 sc1
K2_G9:
    s_or_b64 vcc, s[68:69], s[70:71]
    s_or_b64 vcc, vcc, s[72:73]
    s_or_b64 vcc, vcc, s[74:75]
    s_or_b64 vcc, vcc, s[76:77]
    s_or_b64 vcc, vcc, s[78:79]
    s_or_b64 vcc, vcc, s[80:81]
    s_or_b64 vcc, vcc, s[82:83]
    s_or_b64 vcc, vcc, s[84:85]
    s_cselect_b32 s97, 1, 0
    s_cbranch_scc0 K2_NP2A
    s_mov_b32 s95, 0
    s_mov_b64 exec, s[68:69]
    s_cbranch_execz K2_G10
    buffer_load_dwordx2 v[80:81], v98, s[20:23], s95 offen offset:256 sc1
K2_G10:
    s_mov_b32 s95, 25600
    s_mov_b64 exec, s[70:71]
    s_cbranch_execz K2_G11
    buffer_load_dwordx2 v[82:83], v99, s[20:23], s95 offen offset:256 sc1
K2_G11:
    s_mov_b32 s95, 51200
    s_mov_b64 exec, s[72:73]
    s_cbranch_execz K2_G12
    buffer_load_dwordx2 v[84:85], v100, s[20:23], s95 offen offset:256 sc1
K2_G12:
    s_mov_b32 s95, 76800
    s_mov_b64 exec, s[74:75]
    s_cbranch_execz K2_G13
    buffer_load_dwordx2 v[86:87], v101, s[20:23], s95 offen offset:256 sc1
K2_G13:
    s_mov_b32 s95, 102400
    s_mov_b64 exec, s[76:77]
    s_cbranch_execz K2_G14
    buffer_load_dwordx2 v[88:89], v102, s[20:23], s95 offen offset:256 sc1
K2_G14:
    s_mov_b32 s95, 128000
    s_mov_b64 exec, s[78:79]
    s_cbranch_execz K2_G15
    buffer_load_dwordx2 v[90:91], v103, s[20:23], s95 offen offset:256 sc1
K2_G15:
    s_mov_b32 s95, 153600
    s_mov_b64 exec, s[80:81]
    s_cbranch_execz K2_G16
    buffer_load_dwordx2 v[92:93], v104, s[20:23], s95 offen offset:256 sc1
K2_G16:
    s_mov_b32 s95, 179200
    s_mov_b64 exec, s[82:83]
    s_cbranch_execz K2_G17
    buffer_load_dwordx2 v[94:95], v105, s[20:23], s95 offen offset:256 sc1
K2_G17:
    s_mov_b32 s95, 204800
    s_mov_b64 exec, s[84:85]
    s_cbranch_execz K2_G18
    buffer_load_dwordx2 v[96:97], v106, s[20:23], s95 offen offset:256 sc1
K2_G18:
K2_NP2A:
    s_mov_b64 exec, -1
    v_max3_i32 v221, v172, v173, v174
    v_max3_i32 v221, v221, v175, v176
    v_max3_i32 v221, v221, v177, v178
    v_max3_i32 v221, v221, v179, v180
    v_mov_b32 v223, 1
    v_cmp_lt_i32_e64 s[86:87], s92, v221
K2_NOREC:
    s_waitcnt lgkmcnt(0)
    s_barrier
    s_add_u32 s95, s101, 0
    s_cmp_lt_u32 s95, 125952
    s_cselect_b32 m0, s95, 47104
    s_nop 0
    buffer_load_dwordx4 v[210:211], s[8:11], 0 idxen offen lds
    s_add_u32 s95, s101, 1024
    s_cmp_lt_u32 s95, 125952
    s_cselect_b32 m0, s95, 47104
    s_nop 0
    buffer_load_dwordx4 v[212:213], s[8:11], 0 idxen offen lds
    s_add_u32 s95, s101, 2048
    s_cmp_lt_u32 s95, 125952
    s_cselect_b32 m0, s95, 47104
    s_nop 0
    buffer_load_dwordx4 v[214:215], s[8:11], 0 idxen offen lds
    s_add_u32 s95, s101, 3072
    s_cmp_lt_u32 s95, 125952
    s_cselect_b32 m0, s95, 47104
    s_nop 0
    buffer_load_dwordx4 v[216:217], s[8:11], 0 idxen offen lds
    s_cmp_lg_u32 s5, 0
    s_cbranch_scc1 K2_NOPW
    s_lshr_b32 s95, s2, 3
    s_mul_i32 s99, s95, 0
    v_add_u32 v224, s99, v203
    s_mul_i32 s99, s95, 0
    v_add_u32 v225, s99, v250
    v_add_u32 v224, 0, v250
    v_cmp_gt_u32 vcc, s96, v224
    s_nop 1
    v_cndmask_b32_e64 v104, -0.5, 0.5, vcc
    v_add_u32 v224, 64, v250
    v_cmp_gt_u32 vcc, s96, v224
    s_nop 1
    v_cndmask_b32_e64 v105, -0.5, 0.5, vcc
    v_add_u32 v224, 128, v250
    v_cmp_gt_u32 vcc, s96, v224
    s_nop 1
    v_cndmask_b32_e64 v106, -0.5, 0.5, vcc
    v_add_u32 v224, 192, v250
    v_cmp_gt_u32 vcc, s96, v224
    s_nop 1
    v_cndmask_b32_e64 v107, -0.5, 0.5, vcc
    s_branch K2_B1
K2_NOPW:
    s_mov_b64 exec, s[86:87]
    ds_write_b32 v228, v223 offset:96
    s_mov_b64 exec, -1
    s_waitcnt vmcnt(12)
    s_mov_b64 exec, s[32:33]
    v_lshrrev_b32 v172, 16, v45
    ds_add_rtn_u32 v172, v172, v223 offset:34816
    s_waitcnt vmcnt(11)
    s_mov_b64 exec, s[34:35]
    v_lshrrev_b32 v173, 16, v47
    ds_add_rtn_u32 v173, v173, v223 offset:34816
    s_waitcnt vmcnt(10)
    s_mov_b64 exec, s[36:37]
    v_lshrrev_b32 v174, 16, v49
    ds_add_rtn_u32 v174, v174, v223 offset:34816
    s_waitcnt vmcnt(9)
    s_mov_b64 exec, s[38:39]
    v_lshrrev_b32 v175, 16, v51
    ds_add_rtn_u32 v175, v175, v223 offset:34816
    s_waitcnt vmcnt(8)
    s_mov_b64 exec, s[40:41]
    v_lshrrev_b32 v176, 16, v53
    ds_add_rtn_u32 v176, v176, v223 offset:34816
    s_waitcnt vmcnt(7)
    s_mov_b64 exec, s[42:43]
    v_lshrrev_b32 v177, 16, v55
    ds_add_rtn_u32 v177, v177, v223 offset:34816
    s_waitcnt vmcnt(6)
    s_mov_b64 exec, s[44:45]
    v_lshrrev_b32 v178, 16, v57
    ds_add_rtn_u32 v178, v178, v223 offset:34816
    s_waitcnt vmcnt(5)
    s_mov_b64 exec, s[46:47]
    v_lshrrev_b32 v179, 16, v59
    ds_add_rtn_u32 v179, v179, v223 offset:34816
    s_waitcnt vmcnt(4)
    s_mov_b64 exec, s[48:49]
    v_lshrrev_b32 v180, 16, v61
    ds_add_rtn_u32 v180, v180, v223 offset:34816
    s_mov_b64 exec, s[50:51]
    s_cbranch_execz K2_G19
    v_lshrrev_b32 v181, 16, v63
    ds_add_rtn_u32 v181, v181, v223 offset:34816
K2_G19:
    s_mov_b64 exec, s[52:53]
    s_cbranch_execz K2_G20
    v_lshrrev_b32 v182, 16, v65
    ds_add_rtn_u32 v182, v182, v223 offset:34816
K2_G20:
    s_mov_b64 exec, s[54:55]
    s_cbranch_execz K2_G21
    v_lshrrev_b32 v183, 16, v67
    ds_add_rtn_u32 v183, v183, v223 offset:34816
K2_G21:
    s_mov_b64 exec, s[56:57]
    s_cbranch_execz K2_G22
    v_lshrrev_b32 v184, 16, v69
    ds_add_rtn_u32 v184, v184, v223 offset:34816
K2_G22:
    s_mov_b64 exec, s[58:59]
    s_cbranch_execz K2_G23
    v_lshrrev_b32 v185, 16, v71
    ds_add_rtn_u32 v185, v185, v223 offset:34816
K2_G23:
    s_mov_b64 exec, s[60:61]
    s_cbranch_execz K2_G24
    v_lshrrev_b32 v186, 16, v73
    ds_add_rtn_u32 v186, v186, v223 offset:34816
K2_G24:
    s_mov_b64 exec, s[62:63]
    s_cbranch_execz K2_G25
    v_lshrrev_b32 v187, 16, v75
    ds_add_rtn_u32 v187, v187, v223 offset:34816
K2_G25:
    s_mov_b64 exec, s[64:65]
    s_cbranch_execz K2_G26
    v_lshrrev_b32 v188, 16, v77
    ds_add_rtn_u32 v188, v188, v223 offset:34816
K2_G26:
    s_mov_b64 exec, s[66:67]
    s_cbranch_execz K2_G27
    v_lshrrev_b32 v189, 16, v79
    ds_add_rtn_u32 v189, v189, v223 offset:34816
K2_G27:
    s_cmp_eq_u32 s97, 0
    s_cbranch_scc1 K2_NP2B
    s_mov_b64 exec, s[68:69]
    s_cbranch_execz K2_G28
    v_lshrrev_b32 v190, 16, v81
    ds_add_rtn_u32 v190, v190, v223 offset:34816
K2_G28:
    s_mov_b64 exec, s[70:71]
    s_cbranch_execz K2_G29
    v_lshrrev_b32 v191, 16, v83
    ds_add_rtn_u32 v191, v191, v223 offset:34816
K2_G29:
    s_mov_b64 exec, s[72:73]
    s_cbranch_execz K2_G30
    v_lshrrev_b32 v192, 16, v85
    ds_add_rtn_u32 v192, v192, v223 offset:34816
K2_G30:
    s_mov_b64 exec, s[74:75]
    s_cbranch_execz K2_G31
    v_lshrrev_b32 v193, 16, v87
    ds_add_rtn_u32 v193, v193, v223 offset:34816
K2_G31:
    s_mov_b64 exec, s[76:77]
    s_cbranch_execz K2_G32
    v_lshrrev_b32 v194, 16, v89
    ds_add_rtn_u32 v194, v194, v223 offset:34816
K2_G32:
    s_mov_b64 exec, s[78:79]
    s_cbranch_execz K2_G33
    v_lshrrev_b32 v195, 16, v91
    ds_add_rtn_u32 v195, v195, v223 offset:34816
K2_G33:
    s_mov_b64 exec, s[80:81]
    s_cbranch_execz K2_G34
    v_lshrrev_b32 v196, 16, v93
    ds_add_rtn_u32 v196, v196, v223 offset:34816
K2_G34:
    s_mov_b64 exec, s[82:83]
    s_cbranch_execz K2_G35
    v_lshrrev_b32 v197, 16, v95
    ds_add_rtn_u32 v197, v197, v223 offset:34816
K2_G35:
    s_mov_b64 exec, s[84:85]
    s_cbranch_execz K2_G36
    v_lshrrev_b32 v198, 16, v97
    ds_add_rtn_u32 v198, v198, v223 offset:34816
K2_G36:
K2_NP2B:
    s_mov_b64 exec, -1
K2_B1:
    s_cmp_lg_u32 s5, 0
    s_waitcnt lgkmcnt(0)
    s_barrier
    s_cbranch_scc1 K2_W2
    v_lshlrev_b32 v222, 1, v203
    ds_read_b128 v[0:3], v222 offset:34816
    ds_read_b128 v[4:7], v222 offset:34832
    ds_read_b128 v[8:11], v222 offset:36864
    ds_read_b128 v[12:15], v222 offset:36880
    ds_read_b128 v[16:19], v222 offset:38912
    ds_read_b128 v[20:23], v222 offset:38928
    ds_read_b128 v[24:27], v222 offset:40960
    ds_read_b128 v[28:31], v222 offset:40976
    s_waitcnt lgkmcnt(6)
    v_add3_u32 v76, v0, v1, v2
    v_add3_u32 v80, v3, v4, v5
    v_add3_u32 v76, v76, v6, v7
    v_add_u32 v76, v76, v80
    s_waitcnt lgkmcnt(4)
    v_add3_u32 v77, v8, v9, v10
    v_add3_u32 v81, v11, v12, v13
    v_add3_u32 v77, v77, v14, v15
    v_add_u32 v77, v77, v81
    s_waitcnt lgkmcnt(2)
    v_add3_u32 v78, v16, v17, v18
    v_add3_u32 v82, v19, v20, v21
    v_add3_u32 v78, v78, v22, v23
    v_add_u32 v78, v78, v82
    s_waitcnt lgkmcnt(0)
    v_add3_u32 v79, v24, v25, v26
    v_add3_u32 v83, v27, v28, v29
    v_add3_u32 v79, v79, v30, v31
    v_add_u32 v79, v79, v83
    v_add_u32 v82, v76, v77
    v_add_u32 v83, v82, v78
    v_add_u32 v220, v83, v79
    v_mov_b32 v221, v220
    s_nop 1
    v_add_u32_dpp v221, v221, v221 row_shr:1 row_mask:0xf bank_mask:0xf
    s_nop 1
    v_add_u32_dpp v221, v221, v221 row_shr:2 row_mask:0xf bank_mask:0xf
    s_nop 1
    v_add_u32_dpp v221, v221, v221 row_shr:4 row_mask:0xf bank_mask:0xf
    s_nop 1
    v_add_u32_dpp v221, v221, v221 row_shr:8 row_mask:0xf bank_mask:0xf
    s_nop 1
    v_add_u32_dpp v221, v221, v221 row_bcast:15 row_mask:0xa bank_mask:0xf
    s_nop 1
    v_add_u32_dpp v221, v221, v221 row_bcast:31 row_mask:0xc bank_mask:0xf
    v_sub_u32 v80, v221, v220
    v_add_u32 v81, v80, v76
    v_add_u32 v82, v80, v82
    v_add_u32 v83, v80, v83
    s_movk_i32 s95, 2560
    v_lshl_add_u32 v140, v80, 3, s95
    v_lshl_add_u32 v141, v0, 3, v140
    v_lshl_add_u32 v142, v1, 3, v141
    v_lshl_add_u32 v143, v2, 3, v142
    ds_write_b128 v222, v[140:143] offset:34816
    v_lshl_add_u32 v144, v3, 3, v143
    v_lshl_add_u32 v145, v4, 3, v144
    v_lshl_add_u32 v146, v5, 3, v145
    v_lshl_add_u32 v147, v6, 3, v146
    ds_write_b128 v222, v[144:147] offset:34832
    v_lshl_add_u32 v148, v81, 3, s95
    v_lshl_add_u32 v149, v8, 3, v148
    v_lshl_add_u32 v150, v9, 3, v149
    v_lshl_add_u32 v151, v10, 3, v150
    ds_write_b128 v222, v[148:151] offset:36864
    v_lshl_add_u32 v152, v11, 3, v151
    v_lshl_add_u32 v153, v12, 3, v152
    v_lshl_add_u32 v154, v13, 3, v153
    v_lshl_add_u32 v155, v14, 3, v154
    ds_write_b128 v222, v[152:155] offset:36880
    v_lshl_add_u32 v156, v82, 3, s95
    v_lshl_add_u32 v157, v16, 3, v156
    v_lshl_add_u32 v158, v17, 3, v157
    v_lshl_add_u32 v159, v18, 3, v158
    ds_write_b128 v222, v[156:159] offset:38912
    v_lshl_add_u32 v160, v19, 3, v159
    v_lshl_add_u32 v161, v20, 3, v160
    v_lshl_add_u32 v162, v21, 3, v161
    v_lshl_add_u32 v163, v22, 3, v162
    ds_write_b128 v222, v[160:163] offset:38928
    v_lshl_add_u32 v164, v83, 3, s95
    v_lshl_add_u32 v165, v24, 3, v164
    v_lshl_add_u32 v166, v25, 3, v165
    v_lshl_add_u32 v167, v26, 3, v166
    ds_write_b128 v222, v[164:167] offset:40960
    v_lshl_add_u32 v168, v27, 3, v167
    v_lshl_add_u32 v169, v28, 3, v168
    v_lshl_add_u32 v170, v29, 3, v169
    v_lshl_add_u32 v171, v30, 3, v170
    ds_write_b128 v222, v[168:171] offset:40976
    s_mov_b32 exec_lo, 0
    s_brev_b32 exec_hi, 1
    ds_write_b32 v228, v221 offset:100
    s_mov_b64 exec, -1
K2_W2:
    s_mul_i32 s95, s5, 3072
    s_add_u32 m0, s95, 138240
    s_add_u32 s95, s95, 7536640
    buffer_load_dwordx4 v203, s[20:23], s95 offen offset:0 sc1 lds
    buffer_load_dwordx4 v203, s[20:23], s95 offen offset:1024 sc1 lds
    buffer_load_dwordx4 v203, s[20:23], s95 offen offset:2048 sc1 lds
    s_cmp_ge_u32 s5, 6
    s_cbranch_scc1 K2_NWH
    s_mul_i32 s95, s5, 2048
    s_add_u32 m0, s95, 125952
    s_add_u32 s95, s95, 7561216
    buffer_load_dwordx4 v203, s[20:23], s95 offen offset:0 sc1 lds
    buffer_load_dwordx4 v203, s[20:23], s95 offen offset:1024 sc1 lds
K2_NWH:
    s_cmp_eq_u32 s5, 0
    s_cbranch_scc1 K2_NFT
    s_mov_b32 s95, 1835008
    s_mov_b64 exec, s[32:33]
    v_and_or_b32 v140, v45, s95, v172
    v_lshrrev_b32 v141, 18, v45
    v_cmpx_gt_u32 vcc, 1, v140
    ds_write_b64 v141, v[44:45] offset:43008
    s_mov_b64 exec, s[34:35]
    v_and_or_b32 v142, v47, s95, v173
    v_lshrrev_b32 v143, 18, v47
    v_cmpx_gt_u32 vcc, 1, v142
    ds_write_b64 v143, v[46:47] offset:43008
    s_mov_b64 exec, s[36:37]
    v_and_or_b32 v144, v49, s95, v174
    v_lshrrev_b32 v145, 18, v49
    v_cmpx_gt_u32 vcc, 1, v144
    ds_write_b64 v145, v[48:49] offset:43008
    s_mov_b64 exec, s[38:39]
    v_and_or_b32 v146, v51, s95, v175
    v_lshrrev_b32 v147, 18, v51
    v_cmpx_gt_u32 vcc, 1, v146
    ds_write_b64 v147, v[50:51] offset:43008
    s_mov_b64 exec, s[40:41]
    v_and_or_b32 v148, v53, s95, v176
    v_lshrrev_b32 v149, 18, v53
    v_cmpx_gt_u32 vcc, 1, v148
    ds_write_b64 v149, v[52:53] offset:43008
    s_mov_b64 exec, s[42:43]
    v_and_or_b32 v150, v55, s95, v177
    v_lshrrev_b32 v151, 18, v55
    v_cmpx_gt_u32 vcc, 1, v150
    ds_write_b64 v151, v[54:55] offset:43008
    s_mov_b64 exec, s[44:45]
    v_and_or_b32 v152, v57, s95, v178
    v_lshrrev_b32 v153, 18, v57
    v_cmpx_gt_u32 vcc, 1, v152
    ds_write_b64 v153, v[56:57] offset:43008
    s_mov_b64 exec, s[46:47]
    v_and_or_b32 v154, v59, s95, v179
    v_lshrrev_b32 v155, 18, v59
    v_cmpx_gt_u32 vcc, 1, v154
    ds_write_b64 v155, v[58:59] offset:43008
    s_mov_b64 exec, s[48:49]
    v_and_or_b32 v156, v61, s95, v180
    v_lshrrev_b32 v157, 18, v61
    v_cmpx_gt_u32 vcc, 1, v156
    ds_write_b64 v157, v[60:61] offset:43008
    s_mov_b64 exec, -1
    s_mul_i32 s95, s5, 224
    v_lshrrev_b32 v140, 1, v203
    v_add_u32 v140, s95, v140
K2_NFT:
    s_cmp_eq_u32 s5, 0
    s_waitcnt lgkmcnt(0)
    s_barrier
    ds_read_b64 v[232:233], v228 offset:96
    s_cbranch_scc1 K2_NOS1
    ds_read_b64 v[140:141], v140 offset:42784
    s_mov_b64 exec, s[32:33]
    v_lshrrev_b32 v98, 16, v45
    ds_read_b32 v98, v98 offset:34816
    s_mov_b64 exec, s[34:35]
    v_lshrrev_b32 v99, 16, v47
    ds_read_b32 v99, v99 offset:34816
    s_mov_b64 exec, s[36:37]
    v_lshrrev_b32 v100, 16, v49
    ds_read_b32 v100, v100 offset:34816
    s_mov_b64 exec, s[38:39]
    v_lshrrev_b32 v101, 16, v51
    ds_read_b32 v101, v101 offset:34816
    s_mov_b64 exec, s[40:41]
    v_lshrrev_b32 v102, 16, v53
    ds_read_b32 v102, v102 offset:34816
    s_mov_b64 exec, s[42:43]
    v_lshrrev_b32 v103, 16, v55
    ds_read_b32 v103, v103 offset:34816
    s_mov_b64 exec, s[44:45]
    v_lshrrev_b32 v104, 16, v57
    ds_read_b32 v104, v104 offset:34816
    s_mov_b64 exec, s[46:47]
    v_lshrrev_b32 v105, 16, v59
    ds_read_b32 v105, v105 offset:34816
    s_mov_b64 exec, s[48:49]
    v_lshrrev_b32 v106, 16, v61
    ds_read_b32 v106, v106 offset:34816
    s_mov_b64 exec, -1
    s_waitcnt lgkmcnt(9)
    v_and_b32 v141, 0xffff, v141
    s_mov_b64 exec, 0xfffffff
    buffer_load_dword v202, v140, s[12:15], 0 idxen
    buffer_load_dword v202, v141, s[8:11], 0 idxen
    buffer_load_dword v202, v141, s[16:19], 0 idxen
    s_mov_b64 exec, s[50:51]
    s_cbranch_execz K2_G37
    v_lshrrev_b32 v220, 16, v63
    ds_read_b32 v220, v220 offset:34816
K2_G37:
    s_mov_b64 exec, s[52:53]
    s_cbranch_execz K2_G38
    v_lshrrev_b32 v221, 16, v65
    ds_read_b32 v221, v221 offset:34816
K2_G38:
    s_mov_b64 exec, s[54:55]
    s_cbranch_execz K2_G39
    v_lshrrev_b32 v222, 16, v67
    ds_read_b32 v222, v222 offset:34816
K2_G39:
    s_mov_b64 exec, s[56:57]
    s_cbranch_execz K2_G40
    v_lshrrev_b32 v223, 16, v69
    ds_read_b32 v223, v223 offset:34816
K2_G40:
    s_mov_b64 exec, s[58:59]
    s_cbranch_execz K2_G41
    v_lshrrev_b32 v224, 16, v71
    ds_read_b32 v224, v224 offset:34816
K2_G41:
    s_mov_b64 exec, s[60:61]
    s_cbranch_execz K2_G42
    v_lshrrev_b32 v225, 16, v73
    ds_read_b32 v225, v225 offset:34816
K2_G42:
    s_mov_b64 exec, s[62:63]
    s_cbranch_execz K2_G43
    v_lshrrev_b32 v226, 16, v75
    ds_read_b32 v226, v226 offset:34816
K2_G43:
    s_mov_b64 exec, s[64:65]
    s_cbranch_execz K2_G44
    v_lshrrev_b32 v227, 16, v77
    ds_read_b32 v227, v227 offset:34816
K2_G44:
    s_mov_b64 exec, s[66:67]
    s_cbranch_execz K2_G45
    v_lshrrev_b32 v228, 16, v79
    ds_read_b32 v228, v228 offset:34816
K2_G45:
    s_mov_b64 exec, -1
K2_NOS1:
    s_waitcnt lgkmcnt(0)
    v_readfirstlane_b32 s98, v233
    v_readfirstlane_b32 s93, v232
    s_cmp_le_u32 s98, 3776
    s_cbranch_scc1 K2_FITS
    s_cmp_eq_u32 s92, 15
    s_cbranch_scc1 K2_END0
    s_mov_b32 s92, 15
    s_waitcnt vmcnt(0)
    s_barrier
    s_branch K2_TOP
K2_FITS:
    s_cmp_eq_u32 s5, 0
    s_cbranch_scc1 K2_PLAN
    s_mov_b64 exec, s[32:33]
    v_lshl_add_u32 v98, v172, 3, v98
    ds_write_b64 v98, v[44:45]
    s_mov_b64 exec, s[34:35]
    v_lshl_add_u32 v99, v173, 3, v99
    ds_write_b64 v99, v[46:47]
    s_mov_b64 exec, s[36:37]
    v_lshl_add_u32 v100, v174, 3, v100
    ds_write_b64 v100, v[48:49]
    s_mov_b64 exec, s[38:39]
    v_lshl_add_u32 v101, v175, 3, v101
    ds_write_b64 v101, v[50:51]
    s_mov_b64 exec, s[40:41]
    v_lshl_add_u32 v102, v176, 3, v102
    ds_write_b64 v102, v[52:53]
    s_mov_b64 exec, s[42:43]
    v_lshl_add_u32 v103, v177, 3, v103
    ds_write_b64 v103, v[54:55]
    s_mov_b64 exec, s[44:45]
    v_lshl_add_u32 v104, v178, 3, v104
    ds_write_b64 v104, v[56:57]
    s_mov_b64 exec, s[46:47]
    v_lshl_add_u32 v105, v179, 3, v105
    ds_write_b64 v105, v[58:59]
    s_mov_b64 exec, s[48:49]
    v_lshl_add_u32 v106, v180, 3, v106
    ds_write_b64 v106, v[60:61]
    s_mov_b64 exec, s[50:51]
    s_cbranch_execz K2_G46
    v_lshl_add_u32 v220, v181, 3, v220
    ds_write_b64 v220, v[62:63]
K2_G46:
    s_mov_b64 exec, s[52:53]
    s_cbranch_execz K2_G47
    v_lshl_add_u32 v221, v182, 3, v221
    ds_write_b64 v221, v[64:65]
K2_G47:
    s_mov_b64 exec, s[54:55]
    s_cbranch_execz K2_G48
    v_lshl_add_u32 v222, v183, 3, v222
    ds_write_b64 v222, v[66:67]
K2_G48:
    s_mov_b64 exec, s[56:57]
    s_cbranch_execz K2_G49
    v_lshl_add_u32 v223, v184, 3, v223
    ds_write_b64 v223, v[68:69]
K2_G49:
    s_mov_b64 exec, s[58:59]
    s_cbranch_execz K2_G50
    v_lshl_add_u32 v224, v185, 3, v224
    ds_write_b64 v224, v[70:71]
K2_G50:
    s_mov_b64 exec, s[60:61]
    s_cbranch_execz K2_G51
    v_lshl_add_u32 v225, v186, 3, v225
    ds_write_b64 v225, v[72:73]
K2_G51:
    s_mov_b64 exec, s[62:63]
    s_cbranch_execz K2_G52
    v_lshl_add_u32 v226, v187, 3, v226
    ds_write_b64 v226, v[74:75]
K2_G52:
    s_mov_b64 exec, s[64:65]
    s_cbranch_execz K2_G53
    v_lshl_add_u32 v227, v188, 3, v227
    ds_write_b64 v227, v[76:77]
K2_G53:
    s_mov_b64 exec, s[66:67]
    s_cbranch_execz K2_G54
    v_lshl_add_u32 v228, v189, 3, v228
    ds_write_b64 v228, v[78:79]
K2_G54:
    s_cmp_eq_u32 s97, 0
    s_cbranch_scc1 K2_B3
    s_mov_b64 exec, s[68:69]
    s_cbranch_execz K2_G55
    v_lshrrev_b32 v98, 16, v81
    ds_read_b32 v98, v98 offset:34816
K2_G55:
    s_mov_b64 exec, s[70:71]
    s_cbranch_execz K2_G56
    v_lshrrev_b32 v99, 16, v83
    ds_read_b32 v99, v99 offset:34816
K2_G56:
    s_mov_b64 exec, s[72:73]
    s_cbranch_execz K2_G57
    v_lshrrev_b32 v100, 16, v85
    ds_read_b32 v100, v100 offset:34816
K2_G57:
    s_mov_b64 exec, s[74:75]
    s_cbranch_execz K2_G58
    v_lshrrev_b32 v101, 16, v87
    ds_read_b32 v101, v101 offset:34816
K2_G58:
    s_mov_b64 exec, s[76:77]
    s_cbranch_execz K2_G59
    v_lshrrev_b32 v102, 16, v89
    ds_read_b32 v102, v102 offset:34816
K2_G59:
    s_mov_b64 exec, s[78:79]
    s_cbranch_execz K2_G60
    v_lshrrev_b32 v103, 16, v91
    ds_read_b32 v103, v103 offset:34816
K2_G60:
    s_mov_b64 exec, s[80:81]
    s_cbranch_execz K2_G61
    v_lshrrev_b32 v104, 16, v93
    ds_read_b32 v104, v104 offset:34816
K2_G61:
    s_mov_b64 exec, s[82:83]
    s_cbranch_execz K2_G62
    v_lshrrev_b32 v105, 16, v95
    ds_read_b32 v105, v105 offset:34816
K2_G62:
    s_mov_b64 exec, s[84:85]
    s_cbranch_execz K2_G63
    v_lshrrev_b32 v106, 16, v97
    ds_read_b32 v106, v106 offset:34816
K2_G63:
    s_waitcnt lgkmcnt(0)
    s_mov_b64 exec, s[68:69]
    s_cbranch_execz K2_G64
    v_lshl_add_u32 v98, v190, 3, v98
    ds_write_b64 v98, v[80:81]
K2_G64:
    s_mov_b64 exec, s[70:71]
    s_cbranch_execz K2_G65
    v_lshl_add_u32 v99, v191, 3, v99
    ds_write_b64 v99, v[82:83]
K2_G65:
    s_mov_b64 exec, s[72:73]
    s_cbranch_execz K2_G66
    v_lshl_add_u32 v100, v192, 3, v100
    ds_write_b64 v100, v[84:85]
K2_G66:
    s_mov_b64 exec, s[74:75]
    s_cbranch_execz K2_G67
    v_lshl_add_u32 v101, v193, 3, v101
    ds_write_b64 v101, v[86:87]
K2_G67:
    s_mov_b64 exec, s[76:77]
    s_cbranch_execz K2_G68
    v_lshl_add_u32 v102, v194, 3, v102
    ds_write_b64 v102, v[88:89]
K2_G68:
    s_mov_b64 exec, s[78:79]
    s_cbranch_execz K2_G69
    v_lshl_add_u32 v103, v195, 3, v103
    ds_write_b64 v103, v[90:91]
K2_G69:
    s_mov_b64 exec, s[80:81]
    s_cbranch_execz K2_G70
    v_lshl_add_u32 v104, v196, 3, v104
    ds_write_b64 v104, v[92:93]
K2_G70:
    s_mov_b64 exec, s[82:83]
    s_cbranch_execz K2_G71
    v_lshl_add_u32 v105, v197, 3, v105
    ds_write_b64 v105, v[94:95]
K2_G71:
    s_mov_b64 exec, s[84:85]
    s_cbranch_execz K2_G72
    v_lshl_add_u32 v106, v198, 3, v106
    ds_write_b64 v106, v[96:97]
K2_G72:
    s_branch K2_B3
K2_PLAN:
    s_mul_i32 s99, s98, 3
    s_lshr_b32 s99, s99, 9
    s_max_u32 s99, s99, 1
    v_cvt_f32_u32 v84, v76
    v_add_f32 v84, -0.5, v84
    v_max_f32 v104, v104, v84
    v_cvt_f32_u32 v85, v77
    v_add_f32 v85, -0.5, v85
    v_max_f32 v105, v105, v85
    v_cvt_f32_u32 v86, v78
    v_add_f32 v86, -0.5, v86
    v_max_f32 v106, v106, v86
    v_cvt_f32_u32 v87, v79
    v_add_f32 v87, -0.5, v87
    v_max_f32 v107, v107, v87
K2_DLOOP:
    v_cvt_f32_u32 v220, s99
    v_rcp_f32 v221, v220
    v_add_f32 v88, v104, v220
    v_add_f32 v89, v105, v220
    v_add_f32 v90, v106, v220
    v_add_f32 v91, v107, v220
    v_mul_f32 v88, v88, v221
    v_cvt_u32_f32 v88, v88
    v_mul_f32 v89, v89, v221
    v_cvt_u32_f32 v89, v89
    v_mul_f32 v90, v90, v221
    v_cvt_u32_f32 v90, v90
    v_mul_f32 v91, v91, v221
    v_cvt_u32_f32 v91, v91
    v_add_u32 v222, v88, v89
    v_add3_u32 v222, v222, v90, v91
    s_nop 1
    v_add_u32_dpp v222, v222, v222 row_shr:1 row_mask:0xf bank_mask:0xf
    s_nop 1
    v_add_u32_dpp v222, v222, v222 row_shr:2 row_mask:0xf bank_mask:0xf
    s_nop 1
    v_add_u32_dpp v222, v222, v222 row_shr:4 row_mask:0xf bank_mask:0xf
    s_nop 1
    v_add_u32_dpp v222, v222, v222 row_shr:8 row_mask:0xf bank_mask:0xf
    s_nop 1
    v_add_u32_dpp v222, v222, v222 row_bcast:15 row_mask:0xa bank_mask:0xf
    s_nop 1
    v_add_u32_dpp v222, v222, v222 row_bcast:31 row_mask:0xc bank_mask:0xf
    s_nop 0
    v_readlane_b32 s95, v222, 63
    s_add_u32 s99, s99, 1
    s_cmp_gt_u32 s95, 255
    s_cbranch_scc1 K2_DLOOP
    v_cvt_f32_u32 v92, v88
    v_rcp_f32 v96, v92
    v_add_f32 v92, v92, v84
    v_cmp_eq_u32_e64 s[48:49], 1, v88
    v_lshlrev_b32 v44, 16, v88
    v_cvt_f32_u32 v93, v89
    v_rcp_f32 v97, v93
    v_add_f32 v93, v93, v85
    v_cmp_eq_u32_e64 s[50:51], 1, v89
    v_lshlrev_b32 v45, 16, v89
    v_cvt_f32_u32 v94, v90
    v_rcp_f32 v98, v94
    v_add_f32 v94, v94, v86
    v_cmp_eq_u32_e64 s[52:53], 1, v90
    v_lshlrev_b32 v46, 16, v90
    v_cvt_f32_u32 v95, v91
    v_rcp_f32 v99, v95
    v_add_f32 v95, v95, v87
    v_cmp_eq_u32_e64 s[54:55], 1, v91
    v_lshlrev_b32 v47, 16, v91
    v_cndmask_b32_e64 v44, v44, 1, s[48:49]
    v_cndmask_b32_e64 v45, v45, 1, s[50:51]
    v_cndmask_b32_e64 v46, v46, 1, s[52:53]
    v_cndmask_b32_e64 v47, v47, 1, s[54:55]
    v_mul_f32 v92, v92, v96
    v_cvt_u32_f32 v92, v92
    v_sub_u32 v96, 63, v92
    v_lshlrev_b32 v96, 2, v96
    ds_add_rtn_u32 v100, v96, v44 offset:128
    v_mul_f32 v93, v93, v97
    v_cvt_u32_f32 v93, v93
    v_sub_u32 v97, 63, v93
    v_lshlrev_b32 v97, 2, v97
    ds_add_rtn_u32 v101, v97, v45 offset:128
    v_mul_f32 v94, v94, v98
    v_cvt_u32_f32 v94, v94
    v_sub_u32 v98, 63, v94
    v_lshlrev_b32 v98, 2, v98
    ds_add_rtn_u32 v102, v98, v46 offset:128
    v_mul_f32 v95, v95, v99
    v_cvt_u32_f32 v95, v95
    v_sub_u32 v99, 63, v95
    v_lshlrev_b32 v99, 2, v99
    ds_add_rtn_u32 v103, v99, v47 offset:128
    v_lshrrev_b32 v220, 2, v203
    ds_read_b32 v221, v220 offset:128
    v_add_u32 v222, 0, v250
    v_lshl_or_b32 v172, v222, 24, v140
    v_lshl_or_b32 v172, v92, 18, v172
    v_lshlrev_b32 v173, 3, v88
    v_sub_u32 v222, 1, v92
    v_mad_i32_i24 v76, v222, v88, v76
    v_add_u32 v222, 64, v250
    v_lshl_or_b32 v174, v222, 24, v148
    v_lshl_or_b32 v174, v93, 18, v174
    v_lshlrev_b32 v175, 3, v89
    v_sub_u32 v222, 1, v93
    v_mad_i32_i24 v77, v222, v89, v77
    v_add_u32 v222, 128, v250
    v_lshl_or_b32 v176, v222, 24, v156
    v_lshl_or_b32 v176, v94, 18, v176
    v_lshlrev_b32 v177, 3, v90
    v_sub_u32 v222, 1, v94
    v_mad_i32_i24 v78, v222, v90, v78
    v_add_u32 v222, 192, v250
    v_lshl_or_b32 v178, v222, 24, v164
    v_lshl_or_b32 v178, v95, 18, v178
    v_lshlrev_b32 v179, 3, v91
    v_sub_u32 v222, 1, v95
    v_mad_i32_i24 v79, v222, v91, v79
    v_max3_u32 v224, v88, v89, v90
    v_max_u32 v224, v224, v91
    v_mov_b32 v225, -262136
    s_mov_b32 s99, 0
    s_waitcnt lgkmcnt(0)
    v_mov_b32 v222, v221
    v_and_b32 v57, 0xffff, v221
    v_cmp_ne_u32 vcc, 0, v57
    v_and_b32 v52, 0xffff, v100
    v_lshrrev_b32 v100, 16, v100
    v_add_u32_dpp v222, v222, v222 row_shr:1 row_mask:0xf bank_mask:0xf
    v_min_u32 v48, 1, v52
    v_cndmask_b32_e64 v100, v100, v52, s[48:49]
    v_add_u32_dpp v222, v222, v222 row_shr:2 row_mask:0xf bank_mask:0xf
    v_mad_i32_i24 v48, v48, -10, 20
    v_cndmask_b32_e64 v48, 0, v48, s[48:49]
    v_add_u32_dpp v222, v222, v222 row_shr:4 row_mask:0xf bank_mask:0xf
    v_and_b32 v53, 0xffff, v101
    v_lshrrev_b32 v101, 16, v101
    v_add_u32_dpp v222, v222, v222 row_shr:8 row_mask:0xf bank_mask:0xf
    v_min_u32 v49, 1, v53
    v_cndmask_b32_e64 v101, v101, v53, s[50:51]
    v_add_u32_dpp v222, v222, v222 row_bcast:15 row_mask:0xa bank_mask:0xf
    v_mad_i32_i24 v49, v49, -10, 20
    v_cndmask_b32_e64 v49, 0, v49, s[50:51]
    v_add_u32_dpp v222, v222, v222 row_bcast:31 row_mask:0xc bank_mask:0xf
    v_lshrrev_b32 v58, 16, v222
    v_cndmask_b32 v56, 0, v58, vcc
    v_sub_u32 v222, v222, v221
    v_and_b32 v54, 0xffff, v102
    v_lshrrev_b32 v102, 16, v102
    v_max_u32_dpp v56, v56, v56 row_shr:1 row_mask:0xf bank_mask:0xf
    v_min_u32 v50, 1, v54
    v_cndmask_b32_e64 v102, v102, v54, s[52:53]
    v_max_u32_dpp v56, v56, v56 row_shr:2 row_mask:0xf bank_mask:0xf
    v_mad_i32_i24 v50, v50, -10, 20
    v_cndmask_b32_e64 v50, 0, v50, s[52:53]
    v_max_u32_dpp v56, v56, v56 row_shr:4 row_mask:0xf bank_mask:0xf
    v_and_b32 v55, 0xffff, v103
    v_lshrrev_b32 v103, 16, v103
    v_max_u32_dpp v56, v56, v56 row_shr:8 row_mask:0xf bank_mask:0xf
    v_min_u32 v51, 1, v55
    v_cndmask_b32_e64 v103, v103, v55, s[54:55]
    v_max_u32_dpp v56, v56, v56 row_bcast:15 row_mask:0xa bank_mask:0xf
    v_mad_i32_i24 v51, v51, -10, 20
    v_cndmask_b32_e64 v51, 0, v51, s[54:55]
    v_max_u32_dpp v56, v56, v56 row_bcast:31 row_mask:0xc bank_mask:0xf
    v_and_b32 v57, 0xffff, v222
    v_and_b32 v221, 1, v222
    v_mov_b32_dpp v56, v56 wave_shr:1 row_mask:0xf bank_mask:0xf
    v_cmp_eq_u32 vcc, 1, v221
    v_lshrrev_b32 v222, 16, v222
    v_add3_u32 v222, v222, v57, v221
    v_cndmask_b32 v56, v58, v56, vcc
    v_add_u32 v58, v58, v57
    v_add_u32 v56, v56, v57
    v_lshl_or_b32 v222, v58, 10, v222
    v_lshl_or_b32 v222, v56, 20, v222
    ds_bpermute_b32 v96, v96, v222
    ds_bpermute_b32 v97, v97, v222
    ds_bpermute_b32 v98, v98, v222
    ds_bpermute_b32 v99, v99, v222
    s_waitcnt lgkmcnt(3)
    v_bfe_u32 v96, v96, v48, 10
    v_add_lshl_u32 v96, v96, v100, 2
    v_lshl_or_b32 v222, v88, 16, v96
    v_lshlrev_b32 v96, 1, v96
    ds_write_b32 v220, v222 offset:32768
    s_waitcnt lgkmcnt(3)
    v_bfe_u32 v97, v97, v49, 10
    v_add_lshl_u32 v97, v97, v101, 2
    v_lshl_or_b32 v222, v89, 16, v97
    v_lshlrev_b32 v97, 1, v97
    ds_write_b32 v220, v222 offset:33024
    s_waitcnt lgkmcnt(3)
    v_bfe_u32 v98, v98, v50, 10
    v_add_lshl_u32 v98, v98, v102, 2
    v_lshl_or_b32 v222, v90, 16, v98
    v_lshlrev_b32 v98, 1, v98
    ds_write_b32 v220, v222 offset:33280
    s_waitcnt lgkmcnt(3)
    v_bfe_u32 v99, v99, v51, 10
    v_add_lshl_u32 v99, v99, v103, 2
    v_lshl_or_b32 v222, v91, 16, v99
    v_lshlrev_b32 v99, 1, v99
    ds_write_b32 v220, v222 offset:33536
K2_PLOOP:
    v_cmp_lt_u32_e64 s[32:33], s99, v88
    v_cmp_lt_u32_e64 s[34:35], s99, v89
    v_cmp_lt_u32_e64 s[36:37], s99, v90
    v_cmp_lt_u32_e64 s[38:39], s99, v91
    s_add_u32 s99, s99, 1
    v_cmp_eq_u32_e64 s[40:41], s99, v76
    v_cmp_eq_u32_e64 s[42:43], s99, v77
    v_cmp_eq_u32_e64 s[44:45], s99, v78
    v_cmp_eq_u32_e64 s[46:47], s99, v79
    s_mov_b64 exec, s[32:33]
    ds_write_b64 v96, v[172:173] offset:512
    s_mov_b64 exec, s[34:35]
    ds_write_b64 v97, v[174:175] offset:512
    s_mov_b64 exec, s[36:37]
    ds_write_b64 v98, v[176:177] offset:512
    s_mov_b64 exec, s[38:39]
    ds_write_b64 v99, v[178:179] offset:512
    s_mov_b64 exec, -1
    v_cmp_lt_u32 vcc, s99, v224
    v_cndmask_b32_e64 v222, 8, v225, s[40:41]
    v_add_u32 v172, v172, v222
    v_add_u32 v96, 8, v96
    v_cndmask_b32_e64 v222, 8, v225, s[42:43]
    v_add_u32 v174, v174, v222
    v_add_u32 v97, 8, v97
    v_cndmask_b32_e64 v222, 8, v225, s[44:45]
    v_add_u32 v176, v176, v222
    v_add_u32 v98, 8, v98
    v_cndmask_b32_e64 v222, 8, v225, s[46:47]
    v_add_u32 v178, v178, v222
    v_add_u32 v99, 8, v99
    s_cbranch_vccnz K2_PLOOP
    v_mov_b32 v222, s99
    ds_write_b32 v228, v222 offset:104
    s_waitcnt vmcnt(0)
K2_B3:
    s_mov_b64 exec, -1
    s_lshl_b32 s95, s100, 8
    v_and_b32 v220, 31, v250
    v_lshl_add_u32 v220, v220, 3, s95
    s_mov_b32 s6, 0
    s_waitcnt vmcnt(3) lgkmcnt(0)
    s_barrier
    ds_read_b64 v[220:221], v220 offset:512
    ds_read_b32 v222, v229 offset:104
    s_waitcnt lgkmcnt(0)
    v_bfe_u32 v235, v220, 18, 6
    v_and_b32 v207, 0x3ffff, v220
    v_lshrrev_b32 v249, 24, v220
    v_mov_b32 v206, v221
    v_readfirstlane_b32 s97, v222
    v_cmp_lt_u32_e64 s[28:29], s6, v235
    s_add_u32 s6, s6, 1
    v_add_u32 v221, s4, v249
    buffer_load_dwordx2 v[240:241], v221, s[16:19], 0 idxen sc1
    v_cndmask_b32_e64 v203, 0, v207, s[28:29]
    v_add_u32 v207, v207, v206
    ds_read_b32 v218, v203
    ds_read_u16 v203, v203 offset:4
    v_bfe_u32 v220, v249, 1, 3
    v_lshlrev_b32 v220, 4, v220
    v_lshlrev_b32 v221, 2, v219
    v_xor_b32 v220, v220, v221
    v_lshl_add_u32 v220, v249, 7, v220
    v_add_u32 v220, 100352, v220
    v_xor_b32 v221, 16, v220
    v_xor_b32 v222, 32, v220
    v_xor_b32 v223, 48, v220
    s_waitcnt lgkmcnt(0)
    ds_bpermute_b32 v210, v239, v203 offset:0
    ds_bpermute_b32 v212, v239, v203 offset:32
    ds_bpermute_b32 v214, v239, v203 offset:64
    ds_bpermute_b32 v216, v239, v203 offset:96
    ds_read_b128 v[172:175], v220
    ds_read_b128 v[176:179], v221
    ds_read_b128 v[180:183], v222
    ds_read_b128 v[184:187], v223
    buffer_load_dwordx4 v[188:191], v[218:219], s[12:15], 0 idxen offen
    buffer_load_dwordx2 v[200:201], v203, s[16:19], 0 idxen sc1
    v_cmp_lt_u32_e64 s[30:31], s6, v235
    s_add_u32 s6, s6, 1
    s_cmp_eq_u64 s[28:29], 0
    s_cbranch_scc1 K2_EMPTY
    s_waitcnt lgkmcnt(4)
    s_add_u32 m0, s94, 0
    s_nop 0
    buffer_load_dwordx4 v[210:211], s[8:11], 0 idxen offen lds
    s_add_u32 m0, s94, 1024
    s_nop 0
    buffer_load_dwordx4 v[212:213], s[8:11], 0 idxen offen lds
    s_add_u32 m0, s94, 2048
    s_nop 0
    buffer_load_dwordx4 v[214:215], s[8:11], 0 idxen offen lds
    s_add_u32 m0, s94, 3072
    s_nop 0
    buffer_load_dwordx4 v[216:217], s[8:11], 0 idxen offen lds
    v_cndmask_b32_e64 v203, 0, v207, s[30:31]
    v_add_u32 v207, v207, v206
    ds_read_b32 v218, v203
    ds_read_u16 v203, v203 offset:4
    s_waitcnt lgkmcnt(0)
    ds_bpermute_b32 v210, v239, v203 offset:0
    ds_bpermute_b32 v212, v239, v203 offset:32
    ds_bpermute_b32 v214, v239, v203 offset:64
    ds_bpermute_b32 v216, v239, v203 offset:96
    buffer_load_dwordx4 v[192:195], v[218:219], s[12:15], 0 idxen offen
    buffer_load_dwordx2 v[204:205], v203, s[16:19], 0 idxen sc1
    v_cmp_lt_u32_e64 s[32:33], s6, v235
    s_add_u32 s6, s6, 1
    s_waitcnt lgkmcnt(0)
    s_add_u32 m0, s94, 32768
    s_nop 0
    buffer_load_dwordx4 v[210:211], s[8:11], 0 idxen offen lds
    s_add_u32 m0, s94, 33792
    s_nop 0
    buffer_load_dwordx4 v[212:213], s[8:11], 0 idxen offen lds
    s_add_u32 m0, s94, 34816
    s_nop 0
    buffer_load_dwordx4 v[214:215], s[8:11], 0 idxen offen lds
    s_add_u32 m0, s94, 35840
    s_nop 0
    buffer_load_dwordx4 v[216:217], s[8:11], 0 idxen offen lds
    v_cndmask_b32_e64 v203, 0, v207, s[32:33]
    v_add_u32 v207, v207, v206
    ds_read_b32 v218, v203
    ds_read_u16 v203, v203 offset:4
    s_waitcnt lgkmcnt(0)
    ds_bpermute_b32 v210, v239, v203 offset:0
    ds_bpermute_b32 v212, v239, v203 offset:32
    ds_bpermute_b32 v214, v239, v203 offset:64
    ds_bpermute_b32 v216, v239, v203 offset:96
    v_and_b32 v221, 63, v250
    v_lshlrev_b32 v220, 4, v221
    v_lshlrev_b32 v221, 2, v221
    v_add_u32 v220, 138240, v220
    v_lshlrev_b32 v222, 3, v219
    v_add_u32 v221, 156672, v221
    v_add_u32 v222, 157696, v222
    ds_read_b128 v[140:143], v220 offset:0
    ds_read_b128 v[144:147], v220 offset:1024
    ds_read_b128 v[148:151], v220 offset:2048
    ds_read_b128 v[152:155], v220 offset:3072
    ds_read_b128 v[156:159], v220 offset:4096
    ds_read_b128 v[160:163], v220 offset:5120
    ds_read_b128 v[164:167], v220 offset:6144
    ds_read_b128 v[168:171], v220 offset:7168
    ds_read_b128 v[0:3], v220 offset:8192
    ds_read_b128 v[4:7], v220 offset:9216
    ds_read_b128 v[8:11], v220 offset:10240
    ds_read_b128 v[12:15], v220 offset:11264
    ds_read_b128 v[16:19], v220 offset:12288
    ds_read_b128 v[20:23], v220 offset:13312
    ds_read_b128 v[24:27], v220 offset:14336
    ds_read_b128 v[28:31], v220 offset:15360
    ds_read_b128 v[32:35], v220 offset:16384
    ds_read_b128 v[36:39], v220 offset:17408
    ds_read_b32 v40, v221
    ds_read_b32 v42, v221 offset:256
    ds_read_b128 v[108:111], v222 offset:0
    ds_read_b128 v[112:115], v222 offset:16
    ds_read_b128 v[116:119], v222 offset:32
    ds_read_b128 v[120:123], v222 offset:48
    ds_read_b128 v[124:127], v222 offset:64
    ds_read_b128 v[128:131], v222 offset:80
    ds_read_b128 v[132:135], v222 offset:96
    ds_read_b128 v[136:139], v222 offset:112
    v_mov_b32 v76, 0
    v_mov_b32 v77, 0
    v_mov_b32 v78, 0
    v_mov_b32 v79, 0
    v_mov_b32 v80, 0
    v_mov_b32 v81, 0
    v_mov_b32 v82, 0
    v_mov_b32 v83, 0
    v_mov_b32 v84, 0
    v_mov_b32 v85, 0
    v_mov_b32 v86, 0
    v_mov_b32 v87, 0
    v_mov_b32 v88, 0
    v_mov_b32 v89, 0
    v_mov_b32 v90, 0
    v_mov_b32 v91, 0
    v_mov_b32 v92, 0
    v_mov_b32 v93, 0
    v_mov_b32 v94, 0
    v_mov_b32 v95, 0
    v_mov_b32 v96, 0
    v_mov_b32 v97, 0
    v_mov_b32 v98, 0
    v_mov_b32 v99, 0
    v_mov_b32 v100, 0
    v_mov_b32 v101, 0
    v_mov_b32 v102, 0
    v_mov_b32 v103, 0
    v_mov_b32 v104, 0
    v_mov_b32 v105, 0
    v_mov_b32 v106, 0
    v_mov_b32 v107, 0
    v_mov_b32 v244, 0
    v_mov_b32 v245, 0
    v_mov_b32 v246, 0
    v_mov_b32 v247, 0
    s_waitcnt lgkmcnt(0)
    v_mfma_f32_32x32x16_bf16 v[44:59], v[140:143], v[172:175], 0
    v_mfma_f32_32x32x16_bf16 v[60:75], v[156:159], v[172:175], 0
    v_mfma_f32_32x32x16_bf16 v[44:59], v[144:147], v[176:179], v[44:59]
    v_mfma_f32_32x32x16_bf16 v[60:75], v[160:163], v[176:179], v[60:75]
    v_mfma_f32_32x32x16_bf16 v[44:59], v[148:151], v[180:183], v[44:59]
    v_mfma_f32_32x32x16_bf16 v[60:75], v[164:167], v[180:183], v[60:75]
    v_mfma_f32_32x32x16_bf16 v[44:59], v[152:155], v[184:187], v[44:59]
    v_mfma_f32_32x32x16_bf16 v[60:75], v[168:171], v[184:187], v[60:75]
    s_waitcnt vmcnt(6)
    ds_read_b128 v[172:175], v251 offset:0
    ds_read_b128 v[176:179], v252 offset:0
    ds_read_b128 v[180:183], v253 offset:0
    ds_read_b128 v[184:187], v254 offset:0
    v_mov_b32 v242, v241
    v_and_b32 v241, 0xffff0000, v240
    v_lshlrev_b32 v240, 16, v240
    v_lshlrev_b32 v232, 16, v200
    v_and_b32 v233, 0xffff0000, v200
    v_sub_f32 v234, v242, v201
    v_pk_add_f32 v[232:233], v[240:241], v[232:233] neg_lo:[0,1] neg_hi:[0,1]
    v_mul_f32 v208, v232, v232
    v_fmac_f32 v208, v233, v233
    v_fmac_f32 v208, v234, v234
    v_cvt_pk_bf16_f32 v208, v208, v208
    s_waitcnt lgkmcnt(0)
    s_nop 0
    v_mfma_f32_32x32x8_bf16 v[140:155], v[40:41], v[208:209], v[44:59]
    v_mfma_f32_32x32x16_bf16 v[140:155], v[32:35], v[188:191], v[140:155]
    v_mfma_f32_32x32x16_bf16 v[140:155], v[0:3], v[172:175], v[140:155]
    v_mfma_f32_32x32x16_bf16 v[140:155], v[4:7], v[176:179], v[140:155]
    v_mfma_f32_32x32x16_bf16 v[140:155], v[8:11], v[180:183], v[140:155]
    v_mfma_f32_32x32x16_bf16 v[140:155], v[12:15], v[184:187], v[140:155]
    s_nop 7
K2_LOOP:
    v_mfma_f32_32x32x8_bf16 v[156:171], v[42:43], v[208:209], v[60:75]
    s_mov_b64 exec, s[28:29]
    s_nop 1
    v_exp_f32 v220, v140
    v_exp_f32 v221, v141
    v_exp_f32 v222, v142
    v_exp_f32 v223, v143
    v_mfma_f32_32x32x16_bf16 v[156:171], v[36:39], v[188:191], v[156:171]
    v_exp_f32 v224, v144
    v_exp_f32 v225, v145
    s_bitcmp1_b32 s5, 2
    s_cbranch_scc0 K2_VP1
    s_setprio 1
K2_VP1:
    s_waitcnt lgkmcnt(0)
    s_mov_b64 exec, -1
    s_add_u32 m0, s94, 0
    s_nop 0
    buffer_load_dwordx4 v[210:211], s[8:11], 0 idxen offen lds
    s_add_u32 m0, s94, 1024
    s_nop 0
    buffer_load_dwordx4 v[212:213], s[8:11], 0 idxen offen lds
    s_add_u32 m0, s94, 2048
    s_nop 0
    buffer_load_dwordx4 v[214:215], s[8:11], 0 idxen offen lds
    s_add_u32 m0, s94, 3072
    s_nop 0
    buffer_load_dwordx4 v[216:217], s[8:11], 0 idxen offen lds
    s_mov_b64 exec, s[28:29]
    s_setprio 0
    v_exp_f32 v226, v146
    v_exp_f32 v227, v147
    v_pk_add_f32 v[220:221], v[220:221], 1.0 op_sel_hi:[1,0]
    v_pk_add_f32 v[222:223], v[222:223], 1.0 op_sel_hi:[1,0]
    v_pk_add_f32 v[224:225], v[224:225], 1.0 op_sel_hi:[1,0]
    v_pk_add_f32 v[226:227], v[226:227], 1.0 op_sel_hi:[1,0]
    v_mfma_f32_32x32x16_bf16 v[156:171], v[16:19], v[172:175], v[156:171]
    v_rcp_f32 v220, v220
    v_rcp_f32 v221, v221
    v_rcp_f32 v222, v222
    v_rcp_f32 v223, v223
    v_mfma_f32_32x32x16_bf16 v[156:171], v[20:23], v[176:179], v[156:171]
    v_rcp_f32 v224, v224
    v_rcp_f32 v225, v225
    v_rcp_f32 v226, v226
    v_rcp_f32 v227, v227
    v_pk_fma_f32 v[76:77], v[140:141], v[220:221], v[76:77]
    v_pk_fma_f32 v[78:79], v[142:143], v[222:223], v[78:79]
    v_pk_fma_f32 v[80:81], v[144:145], v[224:225], v[80:81]
    v_pk_fma_f32 v[82:83], v[146:147], v[226:227], v[82:83]
    v_pk_mul_f32 v[228:229], v[76:77], v[108:109]
    v_pk_mul_f32 v[230:231], v[78:79], v[110:111]
    v_pk_fma_f32 v[228:229], v[80:81], v[112:113], v[228:229]
    v_pk_fma_f32 v[230:231], v[82:83], v[114:115], v[230:231]
    v_mfma_f32_32x32x16_bf16 v[156:171], v[24:27], v[180:183], v[156:171]
    v_exp_f32 v220, v148
    v_exp_f32 v221, v149
    v_exp_f32 v222, v150
    v_exp_f32 v223, v151
    v_mfma_f32_32x32x16_bf16 v[156:171], v[28:31], v[184:187], v[156:171]
    v_exp_f32 v224, v152
    v_exp_f32 v225, v153
    v_exp_f32 v226, v154
    buffer_load_dwordx4 v[188:191], v[218:219], s[12:15], 0 idxen offen
    buffer_load_dwordx2 v[200:201], v203, s[16:19], 0 idxen sc1
    v_exp_f32 v227, v155
    s_waitcnt vmcnt(6)
    ds_read_b128 v[172:175], v251 offset:32768
    ds_read_b128 v[176:179], v252 offset:32768
    ds_read_b128 v[180:183], v253 offset:32768
    ds_read_b128 v[184:187], v254 offset:32768
    v_cmp_lt_u32_e64 s[34:35], s6, v235
    s_add_u32 s6, s6, 1
    v_lshlrev_b32 v236, 16, v204
    v_and_b32 v237, 0xffff0000, v204
    v_sub_f32 v238, v242, v205
    v_pk_add_f32 v[236:237], v[240:241], v[236:237] neg_lo:[0,1] neg_hi:[0,1]
    v_mul_f32 v208, v236, v236
    v_fmac_f32 v208, v237, v237
    v_fmac_f32 v208, v238, v238
    v_cvt_pk_bf16_f32 v208, v208, v208
    v_cndmask_b32_e64 v203, 0, v207, s[34:35]
    v_add_u32 v207, v207, v206
    ds_read_b32 v218, v203
    ds_read_u16 v203, v203 offset:4
    v_pk_add_f32 v[220:221], v[220:221], 1.0 op_sel_hi:[1,0]
    v_pk_add_f32 v[222:223], v[222:223], 1.0 op_sel_hi:[1,0]
    v_pk_add_f32 v[224:225], v[224:225], 1.0 op_sel_hi:[1,0]
    v_pk_add_f32 v[226:227], v[226:227], 1.0 op_sel_hi:[1,0]
    v_rcp_f32 v220, v220
    v_rcp_f32 v221, v221
    v_rcp_f32 v222, v222
    v_rcp_f32 v223, v223
    v_rcp_f32 v224, v224
    v_rcp_f32 v225, v225
    v_rcp_f32 v226, v226
    v_rcp_f32 v227, v227
    s_waitcnt lgkmcnt(0)
    s_mov_b64 exec, -1
    ds_bpermute_b32 v210, v239, v203 offset:0
    ds_bpermute_b32 v212, v239, v203 offset:32
    ds_bpermute_b32 v214, v239, v203 offset:64
    ds_bpermute_b32 v216, v239, v203 offset:96
    s_mov_b64 exec, s[28:29]
    v_pk_fma_f32 v[84:85], v[148:149], v[220:221], v[84:85]
    v_pk_fma_f32 v[86:87], v[150:151], v[222:223], v[86:87]
    v_pk_fma_f32 v[88:89], v[152:153], v[224:225], v[88:89]
    v_pk_fma_f32 v[90:91], v[154:155], v[226:227], v[90:91]
    v_pk_fma_f32 v[228:229], v[84:85], v[116:117], v[228:229]
    v_pk_fma_f32 v[230:231], v[86:87], v[118:119], v[230:231]
    v_pk_fma_f32 v[228:229], v[88:89], v[120:121], v[228:229]
    v_pk_fma_f32 v[230:231], v[90:91], v[122:123], v[230:231]
    v_mfma_f32_32x32x8_bf16 v[140:155], v[40:41], v[208:209], v[44:59]
    v_exp_f32 v220, v156
    v_exp_f32 v221, v157
    v_exp_f32 v222, v158
    v_exp_f32 v223, v159
    v_mfma_f32_32x32x16_bf16 v[140:155], v[32:35], v[192:195], v[140:155]
    v_exp_f32 v224, v160
    v_exp_f32 v225, v161
    v_exp_f32 v226, v162
    v_exp_f32 v227, v163
    v_pk_add_f32 v[220:221], v[220:221], 1.0 op_sel_hi:[1,0]
    v_pk_add_f32 v[222:223], v[222:223], 1.0 op_sel_hi:[1,0]
    v_pk_add_f32 v[224:225], v[224:225], 1.0 op_sel_hi:[1,0]
    v_pk_add_f32 v[226:227], v[226:227], 1.0 op_sel_hi:[1,0]
    v_mfma_f32_32x32x16_bf16 v[140:155], v[0:3], v[172:175], v[140:155]
    v_rcp_f32 v220, v220
    v_rcp_f32 v221, v221
    v_rcp_f32 v222, v222
    v_rcp_f32 v223, v223
    v_mfma_f32_32x32x16_bf16 v[140:155], v[4:7], v[176:179], v[140:155]
    v_rcp_f32 v224, v224
    v_rcp_f32 v225, v225
    v_rcp_f32 v226, v226
    v_rcp_f32 v227, v227
    v_pk_fma_f32 v[92:93], v[156:157], v[220:221], v[92:93]
    v_pk_fma_f32 v[94:95], v[158:159], v[222:223], v[94:95]
    v_pk_fma_f32 v[96:97], v[160:161], v[224:225], v[96:97]
    v_pk_fma_f32 v[98:99], v[162:163], v[226:227], v[98:99]
    v_pk_fma_f32 v[228:229], v[92:93], v[124:125], v[228:229]
    v_pk_fma_f32 v[230:231], v[94:95], v[126:127], v[230:231]
    v_pk_fma_f32 v[228:229], v[96:97], v[128:129], v[228:229]
    v_pk_fma_f32 v[230:231], v[98:99], v[130:131], v[230:231]
    v_mfma_f32_32x32x16_bf16 v[140:155], v[8:11], v[180:183], v[140:155]
    v_exp_f32 v220, v164
    v_exp_f32 v221, v165
    v_exp_f32 v222, v166
    v_exp_f32 v223, v167
    v_mfma_f32_32x32x16_bf16 v[140:155], v[12:15], v[184:187], v[140:155]
    v_exp_f32 v224, v168
    v_exp_f32 v225, v169
    v_exp_f32 v226, v170
    v_exp_f32 v227, v171
    v_pk_add_f32 v[220:221], v[220:221], 1.0 op_sel_hi:[1,0]
    v_pk_add_f32 v[222:223], v[222:223], 1.0 op_sel_hi:[1,0]
    v_pk_add_f32 v[224:225], v[224:225], 1.0 op_sel_hi:[1,0]
    v_pk_add_f32 v[226:227], v[226:227], 1.0 op_sel_hi:[1,0]
    v_rcp_f32 v220, v220
    v_rcp_f32 v221, v221
    v_rcp_f32 v222, v222
    v_rcp_f32 v223, v223
    v_rcp_f32 v224, v224
    v_rcp_f32 v225, v225
    v_rcp_f32 v226, v226
    v_rcp_f32 v227, v227
    v_pk_fma_f32 v[100:101], v[164:165], v[220:221], v[100:101]
    v_pk_fma_f32 v[102:103], v[166:167], v[222:223], v[102:103]
    v_pk_fma_f32 v[104:105], v[168:169], v[224:225], v[104:105]
    v_pk_fma_f32 v[106:107], v[170:171], v[226:227], v[106:107]
    v_pk_fma_f32 v[228:229], v[100:101], v[132:133], v[228:229]
    v_pk_fma_f32 v[230:231], v[102:103], v[134:135], v[230:231]
    v_pk_fma_f32 v[228:229], v[104:105], v[136:137], v[228:229]
    v_pk_fma_f32 v[230:231], v[106:107], v[138:139], v[230:231]
    v_pk_add_f32 v[228:229], v[228:229], v[230:231]
    s_cmp_eq_u64 s[30:31], 0
    v_add_f32 v243, v228, v229
    v_sub_f32 v248, v243, v247
    v_pk_fma_f32 v[244:245], v[232:233], v[248:249], v[244:245] op_sel_hi:[1,0,1]
    v_fmac_f32 v246, v234, v248
    s_mov_b64 exec, -1
    s_cbranch_scc1 K2_DONE
    v_mfma_f32_32x32x8_bf16 v[156:171], v[42:43], v[208:209], v[60:75]
    s_mov_b64 exec, s[30:31]
    v_exp_f32 v220, v140
    v_exp_f32 v221, v141
    v_exp_f32 v222, v142
    v_exp_f32 v223, v143
    v_mfma_f32_32x32x16_bf16 v[156:171], v[36:39], v[192:195], v[156:171]
    v_exp_f32 v224, v144
    v_exp_f32 v225, v145
    s_bitcmp1_b32 s5, 2
    s_cbranch_scc0 K2_VP3
    s_setprio 1
K2_VP3:
    s_waitcnt lgkmcnt(0)
    s_mov_b64 exec, -1
    s_add_u32 m0, s94, 32768
    s_nop 0
    buffer_load_dwordx4 v[210:211], s[8:11], 0 idxen offen lds
    s_add_u32 m0, s94, 33792
    s_nop 0
    buffer_load_dwordx4 v[212:213], s[8:11], 0 idxen offen lds
    s_add_u32 m0, s94, 34816
    s_nop 0
    buffer_load_dwordx4 v[214:215], s[8:11], 0 idxen offen lds
    s_add_u32 m0, s94, 35840
    s_nop 0
    buffer_load_dwordx4 v[216:217], s[8:11], 0 idxen offen lds
    s_mov_b64 exec, s[30:31]
    s_setprio 0
    v_exp_f32 v226, v146
    v_exp_f32 v227, v147
    v_pk_add_f32 v[220:221], v[220:221], 1.0 op_sel_hi:[1,0]
    v_pk_add_f32 v[222:223], v[222:223], 1.0 op_sel_hi:[1,0]
    v_pk_add_f32 v[224:225], v[224:225], 1.0 op_sel_hi:[1,0]
    v_pk_add_f32 v[226:227], v[226:227], 1.0 op_sel_hi:[1,0]
    v_mfma_f32_32x32x16_bf16 v[156:171], v[16:19], v[172:175], v[156:171]
    v_rcp_f32 v220, v220
    v_rcp_f32 v221, v221
    v_rcp_f32 v222, v222
    v_rcp_f32 v223, v223
    v_mfma_f32_32x32x16_bf16 v[156:171], v[20:23], v[176:179], v[156:171]
    v_rcp_f32 v224, v224
    v_rcp_f32 v225, v225
    v_rcp_f32 v226, v226
    v_rcp_f32 v227, v227
    v_pk_fma_f32 v[76:77], v[140:141], v[220:221], v[76:77]
    v_pk_fma_f32 v[78:79], v[142:143], v[222:223], v[78:79]
    v_pk_fma_f32 v[80:81], v[144:145], v[224:225], v[80:81]
    v_pk_fma_f32 v[82:83], v[146:147], v[226:227], v[82:83]
    v_pk_mul_f32 v[228:229], v[76:77], v[108:109]
    v_pk_mul_f32 v[230:231], v[78:79], v[110:111]
    v_pk_fma_f32 v[228:229], v[80:81], v[112:113], v[228:229]
    v_pk_fma_f32 v[230:231], v[82:83], v[114:115], v[230:231]
    v_mfma_f32_32x32x16_bf16 v[156:171], v[24:27], v[180:183], v[156:171]
    v_exp_f32 v220, v148
    v_exp_f32 v221, v149
    v_exp_f32 v222, v150
    v_exp_f32 v223, v151
    v_mfma_f32_32x32x16_bf16 v[156:171], v[28:31], v[184:187], v[156:171]
    v_exp_f32 v224, v152
    v_exp_f32 v225, v153
    v_exp_f32 v226, v154
    buffer_load_dwordx4 v[192:195], v[218:219], s[12:15], 0 idxen offen
    buffer_load_dwordx2 v[204:205], v203, s[16:19], 0 idxen sc1
    v_exp_f32 v227, v155
    s_waitcnt vmcnt(6)
    ds_read_b128 v[172:175], v251 offset:0
    ds_read_b128 v[176:179], v252 offset:0
    ds_read_b128 v[180:183], v253 offset:0
    ds_read_b128 v[184:187], v254 offset:0
    v_cmp_lt_u32_e64 s[36:37], s6, v235
    s_add_u32 s6, s6, 1
    v_lshlrev_b32 v232, 16, v200
    v_and_b32 v233, 0xffff0000, v200
    v_sub_f32 v234, v242, v201
    v_pk_add_f32 v[232:233], v[240:241], v[232:233] neg_lo:[0,1] neg_hi:[0,1]
    v_mul_f32 v208, v232, v232
    v_fmac_f32 v208, v233, v233
    v_fmac_f32 v208, v234, v234
    v_cvt_pk_bf16_f32 v208, v208, v208
    v_cndmask_b32_e64 v203, 0, v207, s[36:37]
    v_add_u32 v207, v207, v206
    ds_read_b32 v218, v203
    ds_read_u16 v203, v203 offset:4
    v_pk_add_f32 v[220:221], v[220:221], 1.0 op_sel_hi:[1,0]
    v_pk_add_f32 v[222:223], v[222:223], 1.0 op_sel_hi:[1,0]
    v_pk_add_f32 v[224:225], v[224:225], 1.0 op_sel_hi:[1,0]
    v_pk_add_f32 v[226:227], v[226:227], 1.0 op_sel_hi:[1,0]
    v_rcp_f32 v220, v220
    v_rcp_f32 v221, v221
    v_rcp_f32 v222, v222
    v_rcp_f32 v223, v223
    v_rcp_f32 v224, v224
    v_rcp_f32 v225, v225
    v_rcp_f32 v226, v226
    v_rcp_f32 v227, v227
    s_waitcnt lgkmcnt(0)
    s_mov_b64 exec, -1
    ds_bpermute_b32 v210, v239, v203 offset:0
    ds_bpermute_b32 v212, v239, v203 offset:32
    ds_bpermute_b32 v214, v239, v203 offset:64
    ds_bpermute_b32 v216, v239, v203 offset:96
    s_mov_b64 exec, s[30:31]
    v_pk_fma_f32 v[84:85], v[148:149], v[220:221], v[84:85]
    v_pk_fma_f32 v[86:87], v[150:151], v[222:223], v[86:87]
    v_pk_fma_f32 v[88:89], v[152:153], v[224:225], v[88:89]
    v_pk_fma_f32 v[90:91], v[154:155], v[226:227], v[90:91]
    v_pk_fma_f32 v[228:229], v[84:85], v[116:117], v[228:229]
    v_pk_fma_f32 v[230:231], v[86:87], v[118:119], v[230:231]
    v_pk_fma_f32 v[228:229], v[88:89], v[120:121], v[228:229]
    v_pk_fma_f32 v[230:231], v[90:91], v[122:123], v[230:231]
    v_mfma_f32_32x32x8_bf16 v[140:155], v[40:41], v[208:209], v[44:59]
    v_exp_f32 v220, v156
    v_exp_f32 v221, v157
    v_exp_f32 v222, v158
    v_exp_f32 v223, v159
    v_mfma_f32_32x32x16_bf16 v[140:155], v[32:35], v[188:191], v[140:155]
    v_exp_f32 v224, v160
    v_exp_f32 v225, v161
    v_exp_f32 v226, v162
    v_exp_f32 v227, v163
    v_pk_add_f32 v[220:221], v[220:221], 1.0 op_sel_hi:[1,0]
    v_pk_add_f32 v[222:223], v[222:223], 1.0 op_sel_hi:[1,0]
    v_pk_add_f32 v[224:225], v[224:225], 1.0 op_sel_hi:[1,0]
    v_pk_add_f32 v[226:227], v[226:227], 1.0 op_sel_hi:[1,0]
    v_mfma_f32_32x32x16_bf16 v[140:155], v[0:3], v[172:175], v[140:155]
    v_rcp_f32 v220, v220
    v_rcp_f32 v221, v221
    v_rcp_f32 v222, v222
    v_rcp_f32 v223, v223
    v_mfma_f32_32x32x16_bf16 v[140:155], v[4:7], v[176:179], v[140:155]
    v_rcp_f32 v224, v224
    v_rcp_f32 v225, v225
    v_rcp_f32 v226, v226
    v_rcp_f32 v227, v227
    v_pk_fma_f32 v[92:93], v[156:157], v[220:221], v[92:93]
    v_pk_fma_f32 v[94:95], v[158:159], v[222:223], v[94:95]
    v_pk_fma_f32 v[96:97], v[160:161], v[224:225], v[96:97]
    v_pk_fma_f32 v[98:99], v[162:163], v[226:227], v[98:99]
    v_pk_fma_f32 v[228:229], v[92:93], v[124:125], v[228:229]
    v_pk_fma_f32 v[230:231], v[94:95], v[126:127], v[230:231]
    v_pk_fma_f32 v[228:229], v[96:97], v[128:129], v[228:229]
    v_pk_fma_f32 v[230:231], v[98:99], v[130:131], v[230:231]
    v_mfma_f32_32x32x16_bf16 v[140:155], v[8:11], v[180:183], v[140:155]
    v_exp_f32 v220, v164
    v_exp_f32 v221, v165
    v_exp_f32 v222, v166
    v_exp_f32 v223, v167
    v_mfma_f32_32x32x16_bf16 v[140:155], v[12:15], v[184:187], v[140:155]
    v_exp_f32 v224, v168
    v_exp_f32 v225, v169
    v_exp_f32 v226, v170
    v_exp_f32 v227, v171
    v_pk_add_f32 v[220:221], v[220:221], 1.0 op_sel_hi:[1,0]
    v_pk_add_f32 v[222:223], v[222:223], 1.0 op_sel_hi:[1,0]
    v_pk_add_f32 v[224:225], v[224:225], 1.0 op_sel_hi:[1,0]
    v_pk_add_f32 v[226:227], v[226:227], 1.0 op_sel_hi:[1,0]
    v_rcp_f32 v220, v220
    v_rcp_f32 v221, v221
    v_rcp_f32 v222, v222
    v_rcp_f32 v223, v223
    v_rcp_f32 v224, v224
    v_rcp_f32 v225, v225
    v_rcp_f32 v226, v226
    v_rcp_f32 v227, v227
    v_pk_fma_f32 v[100:101], v[164:165], v[220:221], v[100:101]
    v_pk_fma_f32 v[102:103], v[166:167], v[222:223], v[102:103]
    v_pk_fma_f32 v[104:105], v[168:169], v[224:225], v[104:105]
    v_pk_fma_f32 v[106:107], v[170:171], v[226:227], v[106:107]
    v_pk_fma_f32 v[228:229], v[100:101], v[132:133], v[228:229]
    v_pk_fma_f32 v[230:231], v[102:103], v[134:135], v[230:231]
    v_pk_fma_f32 v[228:229], v[104:105], v[136:137], v[228:229]
    v_pk_fma_f32 v[230:231], v[106:107], v[138:139], v[230:231]
    v_pk_add_f32 v[228:229], v[228:229], v[230:231]
    s_cmp_eq_u64 s[32:33], 0
    v_add_f32 v247, v228, v229
    v_sub_f32 v248, v247, v243
    v_pk_fma_f32 v[244:245], v[236:237], v[248:249], v[244:245] op_sel_hi:[1,0,1]
    v_fmac_f32 v246, v238, v248
    s_mov_b64 exec, -1
    s_cbranch_scc1 K2_DONE
    v_mfma_f32_32x32x8_bf16 v[156:171], v[42:43], v[208:209], v[60:75]
    s_mov_b64 exec, s[32:33]
    v_exp_f32 v220, v140
    v_exp_f32 v221, v141
    v_exp_f32 v222, v142
    v_exp_f32 v223, v143
    v_mfma_f32_32x32x16_bf16 v[156:171], v[36:39], v[188:191], v[156:171]
    v_exp_f32 v224, v144
    v_exp_f32 v225, v145
    s_bitcmp1_b32 s5, 2
    s_cbranch_scc0 K2_VP5
    s_setprio 1
K2_VP5:
    s_waitcnt lgkmcnt(0)
    s_mov_b64 exec, -1
    s_add_u32 m0, s94, 0
    s_nop 0
    buffer_load_dwordx4 v[210:211], s[8:11], 0 idxen offen lds
    s_add_u32 m0, s94, 1024
    s_nop 0
    buffer_load_dwordx4 v[212:213], s[8:11], 0 idxen offen lds
    s_add_u32 m0, s94, 2048
    s_nop 0
    buffer_load_dwordx4 v[214:215], s[8:11], 0 idxen offen lds
    s_add_u32 m0, s94, 3072
    s_nop 0
    buffer_load_dwordx4 v[216:217], s[8:11], 0 idxen offen lds
    s_mov_b64 exec, s[32:33]
    s_setprio 0
    v_exp_f32 v226, v146
    v_exp_f32 v227, v147
    v_pk_add_f32 v[220:221], v[220:221], 1.0 op_sel_hi:[1,0]
    v_pk_add_f32 v[222:223], v[222:223], 1.0 op_sel_hi:[1,0]
    v_pk_add_f32 v[224:225], v[224:225], 1.0 op_sel_hi:[1,0]
    v_pk_add_f32 v[226:227], v[226:227], 1.0 op_sel_hi:[1,0]
    v_mfma_f32_32x32x16_bf16 v[156:171], v[16:19], v[172:175], v[156:171]
    v_rcp_f32 v220, v220
    v_rcp_f32 v221, v221
    v_rcp_f32 v222, v222
    v_rcp_f32 v223, v223
    v_mfma_f32_32x32x16_bf16 v[156:171], v[20:23], v[176:179], v[156:171]
    v_rcp_f32 v224, v224
    v_rcp_f32 v225, v225
    v_rcp_f32 v226, v226
    v_rcp_f32 v227, v227
    v_pk_fma_f32 v[76:77], v[140:141], v[220:221], v[76:77]
    v_pk_fma_f32 v[78:79], v[142:143], v[222:223], v[78:79]
    v_pk_fma_f32 v[80:81], v[144:145], v[224:225], v[80:81]
    v_pk_fma_f32 v[82:83], v[146:147], v[226:227], v[82:83]
    v_pk_mul_f32 v[228:229], v[76:77], v[108:109]
    v_pk_mul_f32 v[230:231], v[78:79], v[110:111]
    v_pk_fma_f32 v[228:229], v[80:81], v[112:113], v[228:229]
    v_pk_fma_f32 v[230:231], v[82:83], v[114:115], v[230:231]
    v_mfma_f32_32x32x16_bf16 v[156:171], v[24:27], v[180:183], v[156:171]
    v_exp_f32 v220, v148
    v_exp_f32 v221, v149
    v_exp_f32 v222, v150
    v_exp_f32 v223, v151
    v_mfma_f32_32x32x16_bf16 v[156:171], v[28:31], v[184:187], v[156:171]
    v_exp_f32 v224, v152
    v_exp_f32 v225, v153
    v_exp_f32 v226, v154
    buffer_load_dwordx4 v[188:191], v[218:219], s[12:15], 0 idxen offen
    buffer_load_dwordx2 v[200:201], v203, s[16:19], 0 idxen sc1
    v_exp_f32 v227, v155
    s_waitcnt vmcnt(6)
    ds_read_b128 v[172:175], v251 offset:32768
    ds_read_b128 v[176:179], v252 offset:32768
    ds_read_b128 v[180:183], v253 offset:32768
    ds_read_b128 v[184:187], v254 offset:32768
    v_cmp_lt_u32_e64 s[38:39], s6, v235
    s_add_u32 s6, s6, 1
    v_lshlrev_b32 v236, 16, v204
    v_and_b32 v237, 0xffff0000, v204
    v_sub_f32 v238, v242, v205
    v_pk_add_f32 v[236:237], v[240:241], v[236:237] neg_lo:[0,1] neg_hi:[0,1]
    v_mul_f32 v208, v236, v236
    v_fmac_f32 v208, v237, v237
    v_fmac_f32 v208, v238, v238
    v_cvt_pk_bf16_f32 v208, v208, v208
    v_cndmask_b32_e64 v203, 0, v207, s[38:39]
    v_add_u32 v207, v207, v206
    ds_read_b32 v218, v203
    ds_read_u16 v203, v203 offset:4
    v_pk_add_f32 v[220:221], v[220:221], 1.0 op_sel_hi:[1,0]
    v_pk_add_f32 v[222:223], v[222:223], 1.0 op_sel_hi:[1,0]
    v_pk_add_f32 v[224:225], v[224:225], 1.0 op_sel_hi:[1,0]
    v_pk_add_f32 v[226:227], v[226:227], 1.0 op_sel_hi:[1,0]
    v_rcp_f32 v220, v220
    v_rcp_f32 v221, v221
    v_rcp_f32 v222, v222
    v_rcp_f32 v223, v223
    v_rcp_f32 v224, v224
    v_rcp_f32 v225, v225
    v_rcp_f32 v226, v226
    v_rcp_f32 v227, v227
    s_waitcnt lgkmcnt(0)
    s_mov_b64 exec, -1
    ds_bpermute_b32 v210, v239, v203 offset:0
    ds_bpermute_b32 v212, v239, v203 offset:32
    ds_bpermute_b32 v214, v239, v203 offset:64
    ds_bpermute_b32 v216, v239, v203 offset:96
    s_mov_b64 exec, s[32:33]
    v_pk_fma_f32 v[84:85], v[148:149], v[220:221], v[84:85]
    v_pk_fma_f32 v[86:87], v[150:151], v[222:223], v[86:87]
    v_pk_fma_f32 v[88:89], v[152:153], v[224:225], v[88:89]
    v_pk_fma_f32 v[90:91], v[154:155], v[226:227], v[90:91]
    v_pk_fma_f32 v[228:229], v[84:85], v[116:117], v[228:229]
    v_pk_fma_f32 v[230:231], v[86:87], v[118:119], v[230:231]
    v_pk_fma_f32 v[228:229], v[88:89], v[120:121], v[228:229]
    v_pk_fma_f32 v[230:231], v[90:91], v[122:123], v[230:231]
    v_mfma_f32_32x32x8_bf16 v[140:155], v[40:41], v[208:209], v[44:59]
    v_exp_f32 v220, v156
    v_exp_f32 v221, v157
    v_exp_f32 v222, v158
    v_exp_f32 v223, v159
    v_mfma_f32_32x32x16_bf16 v[140:155], v[32:35], v[192:195], v[140:155]
    v_exp_f32 v224, v160
    v_exp_f32 v225, v161
    v_exp_f32 v226, v162
    v_exp_f32 v227, v163
    v_pk_add_f32 v[220:221], v[220:221], 1.0 op_sel_hi:[1,0]
    v_pk_add_f32 v[222:223], v[222:223], 1.0 op_sel_hi:[1,0]
    v_pk_add_f32 v[224:225], v[224:225], 1.0 op_sel_hi:[1,0]
    v_pk_add_f32 v[226:227], v[226:227], 1.0 op_sel_hi:[1,0]
    v_mfma_f32_32x32x16_bf16 v[140:155], v[0:3], v[172:175], v[140:155]
    v_rcp_f32 v220, v220
    v_rcp_f32 v221, v221
    v_rcp_f32 v222, v222
    v_rcp_f32 v223, v223
    v_mfma_f32_32x32x16_bf16 v[140:155], v[4:7], v[176:179], v[140:155]
    v_rcp_f32 v224, v224
    v_rcp_f32 v225, v225
    v_rcp_f32 v226, v226
    v_rcp_f32 v227, v227
    v_pk_fma_f32 v[92:93], v[156:157], v[220:221], v[92:93]
    v_pk_fma_f32 v[94:95], v[158:159], v[222:223], v[94:95]
    v_pk_fma_f32 v[96:97], v[160:161], v[224:225], v[96:97]
    v_pk_fma_f32 v[98:99], v[162:163], v[226:227], v[98:99]
    v_pk_fma_f32 v[228:229], v[92:93], v[124:125], v[228:229]
    v_pk_fma_f32 v[230:231], v[94:95], v[126:127], v[230:231]
    v_pk_fma_f32 v[228:229], v[96:97], v[128:129], v[228:229]
    v_pk_fma_f32 v[230:231], v[98:99], v[130:131], v[230:231]
    v_mfma_f32_32x32x16_bf16 v[140:155], v[8:11], v[180:183], v[140:155]
    v_exp_f32 v220, v164
    v_exp_f32 v221, v165
    v_exp_f32 v222, v166
    v_exp_f32 v223, v167
    v_mfma_f32_32x32x16_bf16 v[140:155], v[12:15], v[184:187], v[140:155]
    v_exp_f32 v224, v168
    v_exp_f32 v225, v169
    v_exp_f32 v226, v170
    v_exp_f32 v227, v171
    v_pk_add_f32 v[220:221], v[220:221], 1.0 op_sel_hi:[1,0]
    v_pk_add_f32 v[222:223], v[222:223], 1.0 op_sel_hi:[1,0]
    v_pk_add_f32 v[224:225], v[224:225], 1.0 op_sel_hi:[1,0]
    v_pk_add_f32 v[226:227], v[226:227], 1.0 op_sel_hi:[1,0]
    v_rcp_f32 v220, v220
    v_rcp_f32 v221, v221
    v_rcp_f32 v222, v222
    v_rcp_f32 v223, v223
    v_rcp_f32 v224, v224
    v_rcp_f32 v225, v225
    v_rcp_f32 v226, v226
    v_rcp_f32 v227, v227
    v_pk_fma_f32 v[100:101], v[164:165], v[220:221], v[100:101]
    v_pk_fma_f32 v[102:103], v[166:167], v[222:223], v[102:103]
    v_pk_fma_f32 v[104:105], v[168:169], v[224:225], v[104:105]
    v_pk_fma_f32 v[106:107], v[170:171], v[226:227], v[106:107]
    v_pk_fma_f32 v[228:229], v[100:101], v[132:133], v[228:229]
    v_pk_fma_f32 v[230:231], v[102:103], v[134:135], v[230:231]
    v_pk_fma_f32 v[228:229], v[104:105], v[136:137], v[228:229]
    v_pk_fma_f32 v[230:231], v[106:107], v[138:139], v[230:231]
    v_pk_add_f32 v[228:229], v[228:229], v[230:231]
    s_cmp_eq_u64 s[34:35], 0
    v_add_f32 v243, v228, v229
    v_sub_f32 v248, v243, v247
    v_pk_fma_f32 v[244:245], v[232:233], v[248:249], v[244:245] op_sel_hi:[1,0,1]
    v_fmac_f32 v246, v234, v248
    s_mov_b64 exec, -1
    s_cbranch_scc1 K2_DONE
    v_mfma_f32_32x32x8_bf16 v[156:171], v[42:43], v[208:209], v[60:75]
    s_mov_b64 exec, s[34:35]
    v_exp_f32 v220, v140
    v_exp_f32 v221, v141
    v_exp_f32 v222, v142
    v_exp_f32 v223, v143
    v_mfma_f32_32x32x16_bf16 v[156:171], v[36:39], v[192:195], v[156:171]
    v_exp_f32 v224, v144
    v_exp_f32 v225, v145
    s_bitcmp1_b32 s5, 2
    s_cbranch_scc0 K2_VP7
    s_setprio 1
K2_VP7:
    s_waitcnt lgkmcnt(0)
    s_mov_b64 exec, -1
    s_add_u32 m0, s94, 32768
    s_nop 0
    buffer_load_dwordx4 v[210:211], s[8:11], 0 idxen offen lds
    s_add_u32 m0, s94, 33792
    s_nop 0
    buffer_load_dwordx4 v[212:213], s[8:11], 0 idxen offen lds
    s_add_u32 m0, s94, 34816
    s_nop 0
    buffer_load_dwordx4 v[214:215], s[8:11], 0 idxen offen lds
    s_add_u32 m0, s94, 35840
    s_nop 0
    buffer_load_dwordx4 v[216:217], s[8:11], 0 idxen offen lds
    s_mov_b64 exec, s[34:35]
    s_setprio 0
    v_exp_f32 v226, v146
    v_exp_f32 v227, v147
    v_pk_add_f32 v[220:221], v[220:221], 1.0 op_sel_hi:[1,0]
    v_pk_add_f32 v[222:223], v[222:223], 1.0 op_sel_hi:[1,0]
    v_pk_add_f32 v[224:225], v[224:225], 1.0 op_sel_hi:[1,0]
    v_pk_add_f32 v[226:227], v[226:227], 1.0 op_sel_hi:[1,0]
    v_mfma_f32_32x32x16_bf16 v[156:171], v[16:19], v[172:175], v[156:171]
    v_rcp_f32 v220, v220
    v_rcp_f32 v221, v221
    v_rcp_f32 v222, v222
    v_rcp_f32 v223, v223
    v_mfma_f32_32x32x16_bf16 v[156:171], v[20:23], v[176:179], v[156:171]
    v_rcp_f32 v224, v224
    v_rcp_f32 v225, v225
    v_rcp_f32 v226, v226
    v_rcp_f32 v227, v227
    v_pk_fma_f32 v[76:77], v[140:141], v[220:221], v[76:77]
    v_pk_fma_f32 v[78:79], v[142:143], v[222:223], v[78:79]
    v_pk_fma_f32 v[80:81], v[144:145], v[224:225], v[80:81]
    v_pk_fma_f32 v[82:83], v[146:147], v[226:227], v[82:83]
    v_pk_mul_f32 v[228:229], v[76:77], v[108:109]
    v_pk_mul_f32 v[230:231], v[78:79], v[110:111]
    v_pk_fma_f32 v[228:229], v[80:81], v[112:113], v[228:229]
    v_pk_fma_f32 v[230:231], v[82:83], v[114:115], v[230:231]
    v_mfma_f32_32x32x16_bf16 v[156:171], v[24:27], v[180:183], v[156:171]
    v_exp_f32 v220, v148
    v_exp_f32 v221, v149
    v_exp_f32 v222, v150
    v_exp_f32 v223, v151
    v_mfma_f32_32x32x16_bf16 v[156:171], v[28:31], v[184:187], v[156:171]
    v_exp_f32 v224, v152
    v_exp_f32 v225, v153
    v_exp_f32 v226, v154
    buffer_load_dwordx4 v[192:195], v[218:219], s[12:15], 0 idxen offen
    buffer_load_dwordx2 v[204:205], v203, s[16:19], 0 idxen sc1
    v_exp_f32 v227, v155
    s_waitcnt vmcnt(6)
    ds_read_b128 v[172:175], v251 offset:0
    ds_read_b128 v[176:179], v252 offset:0
    ds_read_b128 v[180:183], v253 offset:0
    ds_read_b128 v[184:187], v254 offset:0
    v_cmp_lt_u32_e64 s[28:29], s6, v235
    s_add_u32 s6, s6, 1
    v_lshlrev_b32 v232, 16, v200
    v_and_b32 v233, 0xffff0000, v200
    v_sub_f32 v234, v242, v201
    v_pk_add_f32 v[232:233], v[240:241], v[232:233] neg_lo:[0,1] neg_hi:[0,1]
    v_mul_f32 v208, v232, v232
    v_fmac_f32 v208, v233, v233
    v_fmac_f32 v208, v234, v234
    v_cvt_pk_bf16_f32 v208, v208, v208
    v_cndmask_b32_e64 v203, 0, v207, s[28:29]
    v_add_u32 v207, v207, v206
    ds_read_b32 v218, v203
    ds_read_u16 v203, v203 offset:4
    v_pk_add_f32 v[220:221], v[220:221], 1.0 op_sel_hi:[1,0]
    v_pk_add_f32 v[222:223], v[222:223], 1.0 op_sel_hi:[1,0]
    v_pk_add_f32 v[224:225], v[224:225], 1.0 op_sel_hi:[1,0]
    v_pk_add_f32 v[226:227], v[226:227], 1.0 op_sel_hi:[1,0]
    v_rcp_f32 v220, v220
    v_rcp_f32 v221, v221
    v_rcp_f32 v222, v222
    v_rcp_f32 v223, v223
    v_rcp_f32 v224, v224
    v_rcp_f32 v225, v225
    v_rcp_f32 v226, v226
    v_rcp_f32 v227, v227
    s_waitcnt lgkmcnt(0)
    s_mov_b64 exec, -1
    ds_bpermute_b32 v210, v239, v203 offset:0
    ds_bpermute_b32 v212, v239, v203 offset:32
    ds_bpermute_b32 v214, v239, v203 offset:64
    ds_bpermute_b32 v216, v239, v203 offset:96
    s_mov_b64 exec, s[34:35]
    v_pk_fma_f32 v[84:85], v[148:149], v[220:221], v[84:85]
    v_pk_fma_f32 v[86:87], v[150:151], v[222:223], v[86:87]
    v_pk_fma_f32 v[88:89], v[152:153], v[224:225], v[88:89]
    v_pk_fma_f32 v[90:91], v[154:155], v[226:227], v[90:91]
    v_pk_fma_f32 v[228:229], v[84:85], v[116:117], v[228:229]
    v_pk_fma_f32 v[230:231], v[86:87], v[118:119], v[230:231]
    v_pk_fma_f32 v[228:229], v[88:89], v[120:121], v[228:229]
    v_pk_fma_f32 v[230:231], v[90:91], v[122:123], v[230:231]
    v_mfma_f32_32x32x8_bf16 v[140:155], v[40:41], v[208:209], v[44:59]
    v_exp_f32 v220, v156
    v_exp_f32 v221, v157
    v_exp_f32 v222, v158
    v_exp_f32 v223, v159
    v_mfma_f32_32x32x16_bf16 v[140:155], v[32:35], v[188:191], v[140:155]
    v_exp_f32 v224, v160
    v_exp_f32 v225, v161
    v_exp_f32 v226, v162
    v_exp_f32 v227, v163
    v_pk_add_f32 v[220:221], v[220:221], 1.0 op_sel_hi:[1,0]
    v_pk_add_f32 v[222:223], v[222:223], 1.0 op_sel_hi:[1,0]
    v_pk_add_f32 v[224:225], v[224:225], 1.0 op_sel_hi:[1,0]
    v_pk_add_f32 v[226:227], v[226:227], 1.0 op_sel_hi:[1,0]
    v_mfma_f32_32x32x16_bf16 v[140:155], v[0:3], v[172:175], v[140:155]
    v_rcp_f32 v220, v220
    v_rcp_f32 v221, v221
    v_rcp_f32 v222, v222
    v_rcp_f32 v223, v223
    v_mfma_f32_32x32x16_bf16 v[140:155], v[4:7], v[176:179], v[140:155]
    v_rcp_f32 v224, v224
    v_rcp_f32 v225, v225
    v_rcp_f32 v226, v226
    v_rcp_f32 v227, v227
    v_pk_fma_f32 v[92:93], v[156:157], v[220:221], v[92:93]
    v_pk_fma_f32 v[94:95], v[158:159], v[222:223], v[94:95]
    v_pk_fma_f32 v[96:97], v[160:161], v[224:225], v[96:97]
    v_pk_fma_f32 v[98:99], v[162:163], v[226:227], v[98:99]
    v_pk_fma_f32 v[228:229], v[92:93], v[124:125], v[228:229]
    v_pk_fma_f32 v[230:231], v[94:95], v[126:127], v[230:231]
    v_pk_fma_f32 v[228:229], v[96:97], v[128:129], v[228:229]
    v_pk_fma_f32 v[230:231], v[98:99], v[130:131], v[230:231]
    v_mfma_f32_32x32x16_bf16 v[140:155], v[8:11], v[180:183], v[140:155]
    v_exp_f32 v220, v164
    v_exp_f32 v221, v165
    v_exp_f32 v222, v166
    v_exp_f32 v223, v167
    v_mfma_f32_32x32x16_bf16 v[140:155], v[12:15], v[184:187], v[140:155]
    v_exp_f32 v224, v168
    v_exp_f32 v225, v169
    v_exp_f32 v226, v170
    v_exp_f32 v227, v171
    v_pk_add_f32 v[220:221], v[220:221], 1.0 op_sel_hi:[1,0]
    v_pk_add_f32 v[222:223], v[222:223], 1.0 op_sel_hi:[1,0]
    v_pk_add_f32 v[224:225], v[224:225], 1.0 op_sel_hi:[1,0]
    v_pk_add_f32 v[226:227], v[226:227], 1.0 op_sel_hi:[1,0]
    v_rcp_f32 v220, v220
    v_rcp_f32 v221, v221
    v_rcp_f32 v222, v222
    v_rcp_f32 v223, v223
    v_rcp_f32 v224, v224
    v_rcp_f32 v225, v225
    v_rcp_f32 v226, v226
    v_rcp_f32 v227, v227
    v_pk_fma_f32 v[100:101], v[164:165], v[220:221], v[100:101]
    v_pk_fma_f32 v[102:103], v[166:167], v[222:223], v[102:103]
    v_pk_fma_f32 v[104:105], v[168:169], v[224:225], v[104:105]
    v_pk_fma_f32 v[106:107], v[170:171], v[226:227], v[106:107]
    v_pk_fma_f32 v[228:229], v[100:101], v[132:133], v[228:229]
    v_pk_fma_f32 v[230:231], v[102:103], v[134:135], v[230:231]
    v_pk_fma_f32 v[228:229], v[104:105], v[136:137], v[228:229]
    v_pk_fma_f32 v[230:231], v[106:107], v[138:139], v[230:231]
    v_pk_add_f32 v[228:229], v[228:229], v[230:231]
    s_cmp_eq_u64 s[36:37], 0
    v_add_f32 v247, v228, v229
    v_sub_f32 v248, v247, v243
    v_pk_fma_f32 v[244:245], v[236:237], v[248:249], v[244:245] op_sel_hi:[1,0,1]
    v_fmac_f32 v246, v238, v248
    s_mov_b64 exec, -1
    s_cbranch_scc1 K2_DONE
    v_mfma_f32_32x32x8_bf16 v[156:171], v[42:43], v[208:209], v[60:75]
    s_mov_b64 exec, s[36:37]
    v_exp_f32 v220, v140
    v_exp_f32 v221, v141
    v_exp_f32 v222, v142
    v_exp_f32 v223, v143
    v_mfma_f32_32x32x16_bf16 v[156:171], v[36:39], v[188:191], v[156:171]
    v_exp_f32 v224, v144
    v_exp_f32 v225, v145
    s_bitcmp1_b32 s5, 2
    s_cbranch_scc0 K2_VP9
    s_setprio 1
K2_VP9:
    s_waitcnt lgkmcnt(0)
    s_mov_b64 exec, -1
    s_add_u32 m0, s94, 0
    s_nop 0
    buffer_load_dwordx4 v[210:211], s[8:11], 0 idxen offen lds
    s_add_u32 m0, s94, 1024
    s_nop 0
    buffer_load_dwordx4 v[212:213], s[8:11], 0 idxen offen lds
    s_add_u32 m0, s94, 2048
    s_nop 0
    buffer_load_dwordx4 v[214:215], s[8:11], 0 idxen offen lds
    s_add_u32 m0, s94, 3072
    s_nop 0
    buffer_load_dwordx4 v[216:217], s[8:11], 0 idxen offen lds
    s_mov_b64 exec, s[36:37]
    s_setprio 0
    v_exp_f32 v226, v146
    v_exp_f32 v227, v147
    v_pk_add_f32 v[220:221], v[220:221], 1.0 op_sel_hi:[1,0]
    v_pk_add_f32 v[222:223], v[222:223], 1.0 op_sel_hi:[1,0]
    v_pk_add_f32 v[224:225], v[224:225], 1.0 op_sel_hi:[1,0]
    v_pk_add_f32 v[226:227], v[226:227], 1.0 op_sel_hi:[1,0]
    v_mfma_f32_32x32x16_bf16 v[156:171], v[16:19], v[172:175], v[156:171]
    v_rcp_f32 v220, v220
    v_rcp_f32 v221, v221
    v_rcp_f32 v222, v222
    v_rcp_f32 v223, v223
    v_mfma_f32_32x32x16_bf16 v[156:171], v[20:23], v[176:179], v[156:171]
    v_rcp_f32 v224, v224
    v_rcp_f32 v225, v225
    v_rcp_f32 v226, v226
    v_rcp_f32 v227, v227
    v_pk_fma_f32 v[76:77], v[140:141], v[220:221], v[76:77]
    v_pk_fma_f32 v[78:79], v[142:143], v[222:223], v[78:79]
    v_pk_fma_f32 v[80:81], v[144:145], v[224:225], v[80:81]
    v_pk_fma_f32 v[82:83], v[146:147], v[226:227], v[82:83]
    v_pk_mul_f32 v[228:229], v[76:77], v[108:109]
    v_pk_mul_f32 v[230:231], v[78:79], v[110:111]
    v_pk_fma_f32 v[228:229], v[80:81], v[112:113], v[228:229]
    v_pk_fma_f32 v[230:231], v[82:83], v[114:115], v[230:231]
    v_mfma_f32_32x32x16_bf16 v[156:171], v[24:27], v[180:183], v[156:171]
    v_exp_f32 v220, v148
    v_exp_f32 v221, v149
    v_exp_f32 v222, v150
    v_exp_f32 v223, v151
    v_mfma_f32_32x32x16_bf16 v[156:171], v[28:31], v[184:187], v[156:171]
    v_exp_f32 v224, v152
    v_exp_f32 v225, v153
    v_exp_f32 v226, v154
    buffer_load_dwordx4 v[188:191], v[218:219], s[12:15], 0 idxen offen
    buffer_load_dwordx2 v[200:201], v203, s[16:19], 0 idxen sc1
    v_exp_f32 v227, v155
    s_waitcnt vmcnt(6)
    ds_read_b128 v[172:175], v251 offset:32768
    ds_read_b128 v[176:179], v252 offset:32768
    ds_read_b128 v[180:183], v253 offset:32768
    ds_read_b128 v[184:187], v254 offset:32768
    v_cmp_lt_u32_e64 s[30:31], s6, v235
    s_add_u32 s6, s6, 1
    v_lshlrev_b32 v236, 16, v204
    v_and_b32 v237, 0xffff0000, v204
    v_sub_f32 v238, v242, v205
    v_pk_add_f32 v[236:237], v[240:241], v[236:237] neg_lo:[0,1] neg_hi:[0,1]
    v_mul_f32 v208, v236, v236
    v_fmac_f32 v208, v237, v237
    v_fmac_f32 v208, v238, v238
    v_cvt_pk_bf16_f32 v208, v208, v208
    v_cndmask_b32_e64 v203, 0, v207, s[30:31]
    v_add_u32 v207, v207, v206
    ds_read_b32 v218, v203
    ds_read_u16 v203, v203 offset:4
    v_pk_add_f32 v[220:221], v[220:221], 1.0 op_sel_hi:[1,0]
    v_pk_add_f32 v[222:223], v[222:223], 1.0 op_sel_hi:[1,0]
    v_pk_add_f32 v[224:225], v[224:225], 1.0 op_sel_hi:[1,0]
    v_pk_add_f32 v[226:227], v[226:227], 1.0 op_sel_hi:[1,0]
    v_rcp_f32 v220, v220
    v_rcp_f32 v221, v221
    v_rcp_f32 v222, v222
    v_rcp_f32 v223, v223
    v_rcp_f32 v224, v224
    v_rcp_f32 v225, v225
    v_rcp_f32 v226, v226
    v_rcp_f32 v227, v227
    s_waitcnt lgkmcnt(0)
    s_mov_b64 exec, -1
    ds_bpermute_b32 v210, v239, v203 offset:0
    ds_bpermute_b32 v212, v239, v203 offset:32
    ds_bpermute_b32 v214, v239, v203 offset:64
    ds_bpermute_b32 v216, v239, v203 offset:96
    s_mov_b64 exec, s[36:37]
    v_pk_fma_f32 v[84:85], v[148:149], v[220:221], v[84:85]
    v_pk_fma_f32 v[86:87], v[150:151], v[222:223], v[86:87]
    v_pk_fma_f32 v[88:89], v[152:153], v[224:225], v[88:89]
    v_pk_fma_f32 v[90:91], v[154:155], v[226:227], v[90:91]
    v_pk_fma_f32 v[228:229], v[84:85], v[116:117], v[228:229]
    v_pk_fma_f32 v[230:231], v[86:87], v[118:119], v[230:231]
    v_pk_fma_f32 v[228:229], v[88:89], v[120:121], v[228:229]
    v_pk_fma_f32 v[230:231], v[90:91], v[122:123], v[230:231]
    v_mfma_f32_32x32x8_bf16 v[140:155], v[40:41], v[208:209], v[44:59]
    v_exp_f32 v220, v156
    v_exp_f32 v221, v157
    v_exp_f32 v222, v158
    v_exp_f32 v223, v159
    v_mfma_f32_32x32x16_bf16 v[140:155], v[32:35], v[192:195], v[140:155]
    v_exp_f32 v224, v160
    v_exp_f32 v225, v161
    v_exp_f32 v226, v162
    v_exp_f32 v227, v163
    v_pk_add_f32 v[220:221], v[220:221], 1.0 op_sel_hi:[1,0]
    v_pk_add_f32 v[222:223], v[222:223], 1.0 op_sel_hi:[1,0]
    v_pk_add_f32 v[224:225], v[224:225], 1.0 op_sel_hi:[1,0]
    v_pk_add_f32 v[226:227], v[226:227], 1.0 op_sel_hi:[1,0]
    v_mfma_f32_32x32x16_bf16 v[140:155], v[0:3], v[172:175], v[140:155]
    v_rcp_f32 v220, v220
    v_rcp_f32 v221, v221
    v_rcp_f32 v222, v222
    v_rcp_f32 v223, v223
    v_mfma_f32_32x32x16_bf16 v[140:155], v[4:7], v[176:179], v[140:155]
    v_rcp_f32 v224, v224
    v_rcp_f32 v225, v225
    v_rcp_f32 v226, v226
    v_rcp_f32 v227, v227
    v_pk_fma_f32 v[92:93], v[156:157], v[220:221], v[92:93]
    v_pk_fma_f32 v[94:95], v[158:159], v[222:223], v[94:95]
    v_pk_fma_f32 v[96:97], v[160:161], v[224:225], v[96:97]
    v_pk_fma_f32 v[98:99], v[162:163], v[226:227], v[98:99]
    v_pk_fma_f32 v[228:229], v[92:93], v[124:125], v[228:229]
    v_pk_fma_f32 v[230:231], v[94:95], v[126:127], v[230:231]
    v_pk_fma_f32 v[228:229], v[96:97], v[128:129], v[228:229]
    v_pk_fma_f32 v[230:231], v[98:99], v[130:131], v[230:231]
    v_mfma_f32_32x32x16_bf16 v[140:155], v[8:11], v[180:183], v[140:155]
    v_exp_f32 v220, v164
    v_exp_f32 v221, v165
    v_exp_f32 v222, v166
    v_exp_f32 v223, v167
    v_mfma_f32_32x32x16_bf16 v[140:155], v[12:15], v[184:187], v[140:155]
    v_exp_f32 v224, v168
    v_exp_f32 v225, v169
    v_exp_f32 v226, v170
    v_exp_f32 v227, v171
    v_pk_add_f32 v[220:221], v[220:221], 1.0 op_sel_hi:[1,0]
    v_pk_add_f32 v[222:223], v[222:223], 1.0 op_sel_hi:[1,0]
    v_pk_add_f32 v[224:225], v[224:225], 1.0 op_sel_hi:[1,0]
    v_pk_add_f32 v[226:227], v[226:227], 1.0 op_sel_hi:[1,0]
    v_rcp_f32 v220, v220
    v_rcp_f32 v221, v221
    v_rcp_f32 v222, v222
    v_rcp_f32 v223, v223
    v_rcp_f32 v224, v224
    v_rcp_f32 v225, v225
    v_rcp_f32 v226, v226
    v_rcp_f32 v227, v227
    v_pk_fma_f32 v[100:101], v[164:165], v[220:221], v[100:101]
    v_pk_fma_f32 v[102:103], v[166:167], v[222:223], v[102:103]
    v_pk_fma_f32 v[104:105], v[168:169], v[224:225], v[104:105]
    v_pk_fma_f32 v[106:107], v[170:171], v[226:227], v[106:107]
    v_pk_fma_f32 v[228:229], v[100:101], v[132:133], v[228:229]
    v_pk_fma_f32 v[230:231], v[102:103], v[134:135], v[230:231]
    v_pk_fma_f32 v[228:229], v[104:105], v[136:137], v[228:229]
    v_pk_fma_f32 v[230:231], v[106:107], v[138:139], v[230:231]
    v_pk_add_f32 v[228:229], v[228:229], v[230:231]
    s_cmp_eq_u64 s[38:39], 0
    v_add_f32 v243, v228, v229
    v_sub_f32 v248, v243, v247
    v_pk_fma_f32 v[244:245], v[232:233], v[248:249], v[244:245] op_sel_hi:[1,0,1]
    v_fmac_f32 v246, v234, v248
    s_mov_b64 exec, -1
    s_cbranch_scc1 K2_DONE
    v_mfma_f32_32x32x8_bf16 v[156:171], v[42:43], v[208:209], v[60:75]
    s_mov_b64 exec, s[38:39]
    v_exp_f32 v220, v140
    v_exp_f32 v221, v141
    v_exp_f32 v222, v142
    v_exp_f32 v223, v143
    v_mfma_f32_32x32x16_bf16 v[156:171], v[36:39], v[192:195], v[156:171]
    v_exp_f32 v224, v144
    v_exp_f32 v225, v145
    s_bitcmp1_b32 s5, 2
    s_cbranch_scc0 K2_VP11
    s_setprio 1
K2_VP11:
    s_waitcnt lgkmcnt(0)
    s_mov_b64 exec, -1
    s_add_u32 m0, s94, 32768
    s_nop 0
    buffer_load_dwordx4 v[210:211], s[8:11], 0 idxen offen lds
    s_add_u32 m0, s94, 33792
    s_nop 0
    buffer_load_dwordx4 v[212:213], s[8:11], 0 idxen offen lds
    s_add_u32 m0, s94, 34816
    s_nop 0
    buffer_load_dwordx4 v[214:215], s[8:11], 0 idxen offen lds
    s_add_u32 m0, s94, 35840
    s_nop 0
    buffer_load_dwordx4 v[216:217], s[8:11], 0 idxen offen lds
    s_mov_b64 exec, s[38:39]
    s_setprio 0
    v_exp_f32 v226, v146
    v_exp_f32 v227, v147
    v_pk_add_f32 v[220:221], v[220:221], 1.0 op_sel_hi:[1,0]
    v_pk_add_f32 v[222:223], v[222:223], 1.0 op_sel_hi:[1,0]
    v_pk_add_f32 v[224:225], v[224:225], 1.0 op_sel_hi:[1,0]
    v_pk_add_f32 v[226:227], v[226:227], 1.0 op_sel_hi:[1,0]
    v_mfma_f32_32x32x16_bf16 v[156:171], v[16:19], v[172:175], v[156:171]
    v_rcp_f32 v220, v220
    v_rcp_f32 v221, v221
    v_rcp_f32 v222, v222
    v_rcp_f32 v223, v223
    v_mfma_f32_32x32x16_bf16 v[156:171], v[20:23], v[176:179], v[156:171]
    v_rcp_f32 v224, v224
    v_rcp_f32 v225, v225
    v_rcp_f32 v226, v226
    v_rcp_f32 v227, v227
    v_pk_fma_f32 v[76:77], v[140:141], v[220:221], v[76:77]
    v_pk_fma_f32 v[78:79], v[142:143], v[222:223], v[78:79]
    v_pk_fma_f32 v[80:81], v[144:145], v[224:225], v[80:81]
    v_pk_fma_f32 v[82:83], v[146:147], v[226:227], v[82:83]
    v_pk_mul_f32 v[228:229], v[76:77], v[108:109]
    v_pk_mul_f32 v[230:231], v[78:79], v[110:111]
    v_pk_fma_f32 v[228:229], v[80:81], v[112:113], v[228:229]
    v_pk_fma_f32 v[230:231], v[82:83], v[114:115], v[230:231]
    v_mfma_f32_32x32x16_bf16 v[156:171], v[24:27], v[180:183], v[156:171]
    v_exp_f32 v220, v148
    v_exp_f32 v221, v149
    v_exp_f32 v222, v150
    v_exp_f32 v223, v151
    v_mfma_f32_32x32x16_bf16 v[156:171], v[28:31], v[184:187], v[156:171]
    v_exp_f32 v224, v152
    v_exp_f32 v225, v153
    v_exp_f32 v226, v154
    buffer_load_dwordx4 v[192:195], v[218:219], s[12:15], 0 idxen offen
    buffer_load_dwordx2 v[204:205], v203, s[16:19], 0 idxen sc1
    v_exp_f32 v227, v155
    s_waitcnt vmcnt(6)
    ds_read_b128 v[172:175], v251 offset:0
    ds_read_b128 v[176:179], v252 offset:0
    ds_read_b128 v[180:183], v253 offset:0
    ds_read_b128 v[184:187], v254 offset:0
    v_cmp_lt_u32_e64 s[32:33], s6, v235
    s_add_u32 s6, s6, 1
    v_lshlrev_b32 v232, 16, v200
    v_and_b32 v233, 0xffff0000, v200
    v_sub_f32 v234, v242, v201
    v_pk_add_f32 v[232:233], v[240:241], v[232:233] neg_lo:[0,1] neg_hi:[0,1]
    v_mul_f32 v208, v232, v232
    v_fmac_f32 v208, v233, v233
    v_fmac_f32 v208, v234, v234
    v_cvt_pk_bf16_f32 v208, v208, v208
    v_cndmask_b32_e64 v203, 0, v207, s[32:33]
    v_add_u32 v207, v207, v206
    ds_read_b32 v218, v203
    ds_read_u16 v203, v203 offset:4
    v_pk_add_f32 v[220:221], v[220:221], 1.0 op_sel_hi:[1,0]
    v_pk_add_f32 v[222:223], v[222:223], 1.0 op_sel_hi:[1,0]
    v_pk_add_f32 v[224:225], v[224:225], 1.0 op_sel_hi:[1,0]
    v_pk_add_f32 v[226:227], v[226:227], 1.0 op_sel_hi:[1,0]
    v_rcp_f32 v220, v220
    v_rcp_f32 v221, v221
    v_rcp_f32 v222, v222
    v_rcp_f32 v223, v223
    v_rcp_f32 v224, v224
    v_rcp_f32 v225, v225
    v_rcp_f32 v226, v226
    v_rcp_f32 v227, v227
    s_waitcnt lgkmcnt(0)
    s_mov_b64 exec, -1
    ds_bpermute_b32 v210, v239, v203 offset:0
    ds_bpermute_b32 v212, v239, v203 offset:32
    ds_bpermute_b32 v214, v239, v203 offset:64
    ds_bpermute_b32 v216, v239, v203 offset:96
    s_mov_b64 exec, s[38:39]
    v_pk_fma_f32 v[84:85], v[148:149], v[220:221], v[84:85]
    v_pk_fma_f32 v[86:87], v[150:151], v[222:223], v[86:87]
    v_pk_fma_f32 v[88:89], v[152:153], v[224:225], v[88:89]
    v_pk_fma_f32 v[90:91], v[154:155], v[226:227], v[90:91]
    v_pk_fma_f32 v[228:229], v[84:85], v[116:117], v[228:229]
    v_pk_fma_f32 v[230:231], v[86:87], v[118:119], v[230:231]
    v_pk_fma_f32 v[228:229], v[88:89], v[120:121], v[228:229]
    v_pk_fma_f32 v[230:231], v[90:91], v[122:123], v[230:231]
    v_mfma_f32_32x32x8_bf16 v[140:155], v[40:41], v[208:209], v[44:59]
    v_exp_f32 v220, v156
    v_exp_f32 v221, v157
    v_exp_f32 v222, v158
    v_exp_f32 v223, v159
    v_mfma_f32_32x32x16_bf16 v[140:155], v[32:35], v[188:191], v[140:155]
    v_exp_f32 v224, v160
    v_exp_f32 v225, v161
    v_exp_f32 v226, v162
    v_exp_f32 v227, v163
    v_pk_add_f32 v[220:221], v[220:221], 1.0 op_sel_hi:[1,0]
    v_pk_add_f32 v[222:223], v[222:223], 1.0 op_sel_hi:[1,0]
    v_pk_add_f32 v[224:225], v[224:225], 1.0 op_sel_hi:[1,0]
    v_pk_add_f32 v[226:227], v[226:227], 1.0 op_sel_hi:[1,0]
    v_mfma_f32_32x32x16_bf16 v[140:155], v[0:3], v[172:175], v[140:155]
    v_rcp_f32 v220, v220
    v_rcp_f32 v221, v221
    v_rcp_f32 v222, v222
    v_rcp_f32 v223, v223
    v_mfma_f32_32x32x16_bf16 v[140:155], v[4:7], v[176:179], v[140:155]
    v_rcp_f32 v224, v224
    v_rcp_f32 v225, v225
    v_rcp_f32 v226, v226
    v_rcp_f32 v227, v227
    v_pk_fma_f32 v[92:93], v[156:157], v[220:221], v[92:93]
    v_pk_fma_f32 v[94:95], v[158:159], v[222:223], v[94:95]
    v_pk_fma_f32 v[96:97], v[160:161], v[224:225], v[96:97]
    v_pk_fma_f32 v[98:99], v[162:163], v[226:227], v[98:99]
    v_pk_fma_f32 v[228:229], v[92:93], v[124:125], v[228:229]
    v_pk_fma_f32 v[230:231], v[94:95], v[126:127], v[230:231]
    v_pk_fma_f32 v[228:229], v[96:97], v[128:129], v[228:229]
    v_pk_fma_f32 v[230:231], v[98:99], v[130:131], v[230:231]
    v_mfma_f32_32x32x16_bf16 v[140:155], v[8:11], v[180:183], v[140:155]
    v_exp_f32 v220, v164
    v_exp_f32 v221, v165
    v_exp_f32 v222, v166
    v_exp_f32 v223, v167
    v_mfma_f32_32x32x16_bf16 v[140:155], v[12:15], v[184:187], v[140:155]
    v_exp_f32 v224, v168
    v_exp_f32 v225, v169
    v_exp_f32 v226, v170
    v_exp_f32 v227, v171
    v_pk_add_f32 v[220:221], v[220:221], 1.0 op_sel_hi:[1,0]
    v_pk_add_f32 v[222:223], v[222:223], 1.0 op_sel_hi:[1,0]
    v_pk_add_f32 v[224:225], v[224:225], 1.0 op_sel_hi:[1,0]
    v_pk_add_f32 v[226:227], v[226:227], 1.0 op_sel_hi:[1,0]
    v_rcp_f32 v220, v220
    v_rcp_f32 v221, v221
    v_rcp_f32 v222, v222
    v_rcp_f32 v223, v223
    v_rcp_f32 v224, v224
    v_rcp_f32 v225, v225
    v_rcp_f32 v226, v226
    v_rcp_f32 v227, v227
    v_pk_fma_f32 v[100:101], v[164:165], v[220:221], v[100:101]
    v_pk_fma_f32 v[102:103], v[166:167], v[222:223], v[102:103]
    v_pk_fma_f32 v[104:105], v[168:169], v[224:225], v[104:105]
    v_pk_fma_f32 v[106:107], v[170:171], v[226:227], v[106:107]
    v_pk_fma_f32 v[228:229], v[100:101], v[132:133], v[228:229]
    v_pk_fma_f32 v[230:231], v[102:103], v[134:135], v[230:231]
    v_pk_fma_f32 v[228:229], v[104:105], v[136:137], v[228:229]
    v_pk_fma_f32 v[230:231], v[106:107], v[138:139], v[230:231]
    v_pk_add_f32 v[228:229], v[228:229], v[230:231]
    s_cmp_eq_u64 s[28:29], 0
    v_add_f32 v247, v228, v229
    v_sub_f32 v248, v247, v243
    v_pk_fma_f32 v[244:245], v[236:237], v[248:249], v[244:245] op_sel_hi:[1,0,1]
    v_fmac_f32 v246, v238, v248
    s_mov_b64 exec, -1
    s_cbranch_scc0 K2_LOOP
K2_DONE:
    v_and_b32 v203, 63, v250
    s_or_b32 s95, s7, s93
    s_cselect_b32 s97, 3, s97
    s_cmp_gt_u32 s97, 2
    v_lshlrev_b32 v203, 4, v203
    s_cbranch_scc1 K2_SLOW
    v_bfe_u32 v220, v249, 1, 3
    v_lshlrev_b32 v220, 4, v220
    v_lshlrev_b32 v221, 2, v219
    v_xor_b32 v220, v220, v221
    v_lshl_add_u32 v220, v249, 7, v220
    v_add_u32 v220, 100352, v220
    v_xor_b32 v221, 16, v220
    v_xor_b32 v222, 32, v220
    v_xor_b32 v223, 48, v220
    ds_read_b128 v[172:175], v220
    ds_read_b128 v[176:179], v221
    ds_read_b128 v[180:183], v222
    ds_read_b128 v[184:187], v223
    v_add_u32 v220, 125952, v203
    v_cmp_eq_u32_e64 s[46:47], 16, v206
    v_cmp_eq_u32_e64 s[44:45], 8, v206
    v_add_u32 v218, s4, v249
    ds_read_b128 v[0:3], v220 offset:32768
    ds_read_b128 v[4:7], v220 offset:33792
    ds_read_b128 v[8:11], v220 offset:34816
    ds_read_b128 v[12:15], v220 offset:35840
    ds_read_b128 v[16:19], v220 offset:0
    ds_read_b128 v[20:23], v220 offset:1024
    ds_read_b128 v[24:27], v220 offset:2048
    ds_read_b128 v[28:31], v220 offset:3072
    ds_read_b128 v[44:47], v220 offset:4096
    ds_read_b128 v[48:51], v220 offset:5120
    ds_read_b128 v[52:55], v220 offset:6144
    ds_read_b128 v[56:59], v220 offset:7168
    ds_read_b128 v[60:63], v220 offset:8192
    ds_read_b128 v[64:67], v220 offset:9216
    ds_read_b128 v[68:71], v220 offset:10240
    ds_read_b128 v[72:75], v220 offset:11264
    s_mov_b64 exec, s[46:47]
    s_and_b32 s46, s46, 0x55555555
    s_or_b32 s44, s44, s46
    s_mov_b32 s98, s94
    v_add_f32_dpp v244, v244, v244 quad_perm:[1,0,3,2] row_mask:0xf bank_mask:0xf
    v_add_f32_dpp v245, v245, v245 quad_perm:[1,0,3,2] row_mask:0xf bank_mask:0xf
    v_add_f32_dpp v246, v246, v246 quad_perm:[1,0,3,2] row_mask:0xf bank_mask:0xf
    v_add_f32_dpp v76, v76, v76 quad_perm:[1,0,3,2] row_mask:0xf bank_mask:0xf
    v_add_f32_dpp v77, v77, v77 quad_perm:[1,0,3,2] row_mask:0xf bank_mask:0xf
    v_add_f32_dpp v78, v78, v78 quad_perm:[1,0,3,2] row_mask:0xf bank_mask:0xf
    v_add_f32_dpp v79, v79, v79 quad_perm:[1,0,3,2] row_mask:0xf bank_mask:0xf
    v_add_f32_dpp v80, v80, v80 quad_perm:[1,0,3,2] row_mask:0xf bank_mask:0xf
    v_add_f32_dpp v81, v81, v81 quad_perm:[1,0,3,2] row_mask:0xf bank_mask:0xf
    v_add_f32_dpp v82, v82, v82 quad_perm:[1,0,3,2] row_mask:0xf bank_mask:0xf
    v_add_f32_dpp v83, v83, v83 quad_perm:[1,0,3,2] row_mask:0xf bank_mask:0xf
    v_add_f32_dpp v84, v84, v84 quad_perm:[1,0,3,2] row_mask:0xf bank_mask:0xf
    v_add_f32_dpp v85, v85, v85 quad_perm:[1,0,3,2] row_mask:0xf bank_mask:0xf
    v_add_f32_dpp v86, v86, v86 quad_perm:[1,0,3,2] row_mask:0xf bank_mask:0xf
    v_add_f32_dpp v87, v87, v87 quad_perm:[1,0,3,2] row_mask:0xf bank_mask:0xf
    v_add_f32_dpp v88, v88, v88 quad_perm:[1,0,3,2] row_mask:0xf bank_mask:0xf
    v_add_f32_dpp v89, v89, v89 quad_perm:[1,0,3,2] row_mask:0xf bank_mask:0xf
    v_add_f32_dpp v90, v90, v90 quad_perm:[1,0,3,2] row_mask:0xf bank_mask:0xf
    v_add_f32_dpp v91, v91, v91 quad_perm:[1,0,3,2] row_mask:0xf bank_mask:0xf
    v_add_f32_dpp v92, v92, v92 quad_perm:[1,0,3,2] row_mask:0xf bank_mask:0xf
    v_add_f32_dpp v93, v93, v93 quad_perm:[1,0,3,2] row_mask:0xf bank_mask:0xf
    v_add_f32_dpp v94, v94, v94 quad_perm:[1,0,3,2] row_mask:0xf bank_mask:0xf
    v_add_f32_dpp v95, v95, v95 quad_perm:[1,0,3,2] row_mask:0xf bank_mask:0xf
    v_add_f32_dpp v96, v96, v96 quad_perm:[1,0,3,2] row_mask:0xf bank_mask:0xf
    v_add_f32_dpp v97, v97, v97 quad_perm:[1,0,3,2] row_mask:0xf bank_mask:0xf
    v_add_f32_dpp v98, v98, v98 quad_perm:[1,0,3,2] row_mask:0xf bank_mask:0xf
    v_add_f32_dpp v99, v99, v99 quad_perm:[1,0,3,2] row_mask:0xf bank_mask:0xf
    v_add_f32_dpp v100, v100, v100 quad_perm:[1,0,3,2] row_mask:0xf bank_mask:0xf
    v_add_f32_dpp v101, v101, v101 quad_perm:[1,0,3,2] row_mask:0xf bank_mask:0xf
    v_add_f32_dpp v102, v102, v102 quad_perm:[1,0,3,2] row_mask:0xf bank_mask:0xf
    v_add_f32_dpp v103, v103, v103 quad_perm:[1,0,3,2] row_mask:0xf bank_mask:0xf
    v_add_f32_dpp v104, v104, v104 quad_perm:[1,0,3,2] row_mask:0xf bank_mask:0xf
    v_add_f32_dpp v105, v105, v105 quad_perm:[1,0,3,2] row_mask:0xf bank_mask:0xf
    v_add_f32_dpp v106, v106, v106 quad_perm:[1,0,3,2] row_mask:0xf bank_mask:0xf
    v_add_f32_dpp v107, v107, v107 quad_perm:[1,0,3,2] row_mask:0xf bank_mask:0xf
    s_mov_b64 exec, -1
    v_mov_b32 v224, v244
    v_mov_b32 v225, v245
    v_mov_b32 v226, v246
    s_nop 1
    v_permlane32_swap_b32 v224, v244
    v_permlane32_swap_b32 v225, v245
    v_permlane32_swap_b32 v226, v246
    s_nop 1
    v_add_f32 v244, v244, v224
    v_add_f32 v245, v245, v225
    v_add_f32 v246, v246, v226
    s_branch K2_TAIL
K2_EMPTY:
    s_waitcnt vmcnt(0) lgkmcnt(0)
    v_mov_b32 v244, 0
    v_mov_b32 v245, 0
    v_mov_b32 v246, 0
    v_mov_b32 v76, 0
    v_mov_b32 v77, 0
    v_mov_b32 v78, 0
    v_mov_b32 v79, 0
    v_mov_b32 v80, 0
    v_mov_b32 v81, 0
    v_mov_b32 v82, 0
    v_mov_b32 v83, 0
    v_mov_b32 v84, 0
    v_mov_b32 v85, 0
    v_mov_b32 v86, 0
    v_mov_b32 v87, 0
    v_mov_b32 v88, 0
    v_mov_b32 v89, 0
    v_mov_b32 v90, 0
    v_mov_b32 v91, 0
    v_mov_b32 v92, 0
    v_mov_b32 v93, 0
    v_mov_b32 v94, 0
    v_mov_b32 v95, 0
    v_mov_b32 v96, 0
    v_mov_b32 v97, 0
    v_mov_b32 v98, 0
    v_mov_b32 v99, 0
    v_mov_b32 v100, 0
    v_mov_b32 v101, 0
    v_mov_b32 v102, 0
    v_mov_b32 v103, 0
    v_mov_b32 v104, 0
    v_mov_b32 v105, 0
    v_mov_b32 v106, 0
    v_mov_b32 v107, 0
    v_mov_b32 v242, v241
    v_and_b32 v241, 0xffff0000, v240
    v_lshlrev_b32 v240, 16, v240
    s_branch K2_DONE
K2_SLOW:
    v_and_b32 v223, 31, v250
    v_lshlrev_b32 v220, 2, v219
    v_xor_b32 v220, v220, v251
    v_lshl_add_u32 v220, v219, 11, v220
    s_lshl_b32 s95, s100, 10
    s_add_u32 s95, s95, 129024
    v_lshl_add_u32 v221, v223, 5, v219
    v_add_u32 v221, s95, v221
    s_lshl_b32 s95, s5, 5
    v_add_u32 v223, s95, v223
    v_add_u32 v218, s4, v223
    v_min_u32 v222, 49999, v218
    s_waitcnt vmcnt(0)
    buffer_load_dwordx2 v[240:241], v222, s[16:19], 0 idxen sc1
    v_xor_b32 v222, 0, v220
    ds_write_b128 v222, v[76:79]
    v_xor_b32 v222, 16, v220
    ds_write_b128 v222, v[80:83]
    v_xor_b32 v222, 32, v220
    ds_write_b128 v222, v[84:87]
    v_xor_b32 v222, 48, v220
    ds_write_b128 v222, v[88:91]
    v_xor_b32 v222, 64, v220
    ds_write_b128 v222, v[92:95]
    v_xor_b32 v222, 80, v220
    ds_write_b128 v222, v[96:99]
    v_xor_b32 v222, 96, v220
    ds_write_b128 v222, v[100:103]
    v_xor_b32 v222, 112, v220
    ds_write_b128 v222, v[104:107]
    ds_write_b128 v221, v[244:247]
    v_lshlrev_b32 v220, 2, v223
    ds_read_b32 v235, v220 offset:32768
    s_sub_u32 s99, s101, s94
    v_add_u32 v251, s99, v251
    v_add_u32 v252, s99, v252
    v_add_u32 v253, s99, v253
    v_add_u32 v254, s99, v254
    ds_read_b128 v[172:175], v251 offset:0
    ds_read_b128 v[176:179], v252 offset:0
    ds_read_b128 v[180:183], v253 offset:0
    ds_read_b128 v[184:187], v254 offset:0
    v_mov_b32 v76, 0
    v_mov_b32 v77, 0
    v_mov_b32 v78, 0
    v_mov_b32 v79, 0
    v_mov_b32 v80, 0
    v_mov_b32 v81, 0
    v_mov_b32 v82, 0
    v_mov_b32 v83, 0
    v_mov_b32 v84, 0
    v_mov_b32 v85, 0
    v_mov_b32 v86, 0
    v_mov_b32 v87, 0
    v_mov_b32 v88, 0
    v_mov_b32 v89, 0
    v_mov_b32 v90, 0
    v_mov_b32 v91, 0
    v_mov_b32 v92, 0
    v_mov_b32 v93, 0
    v_mov_b32 v94, 0
    v_mov_b32 v95, 0
    v_mov_b32 v96, 0
    v_mov_b32 v97, 0
    v_mov_b32 v98, 0
    v_mov_b32 v99, 0
    v_mov_b32 v100, 0
    v_mov_b32 v101, 0
    v_mov_b32 v102, 0
    v_mov_b32 v103, 0
    v_mov_b32 v104, 0
    v_mov_b32 v105, 0
    v_mov_b32 v106, 0
    v_mov_b32 v107, 0
    v_mov_b32 v244, 0
    v_mov_b32 v245, 0
    v_mov_b32 v246, 0
    s_lshl_b32 s99, s3, 8
    v_add_u32 v249, s99, v223
    v_mul_u32_u24 v249, 272, v249
    v_lshl_add_u32 v243, v219, 3, v249
    s_mov_b32 s99, 7602176
    s_cmp_eq_u32 s7, 0
    s_cbranch_scc1 K2_NOLD
    buffer_load_dwordx4 v[76:79], v243, s[20:23], s99 offen offset:0 sc0 sc1
    buffer_load_dwordx4 v[80:83], v243, s[20:23], s99 offen offset:16 sc0 sc1
    buffer_load_dwordx4 v[84:87], v243, s[20:23], s99 offen offset:32 sc0 sc1
    buffer_load_dwordx4 v[88:91], v243, s[20:23], s99 offen offset:48 sc0 sc1
    buffer_load_dwordx4 v[92:95], v243, s[20:23], s99 offen offset:64 sc0 sc1
    buffer_load_dwordx4 v[96:99], v243, s[20:23], s99 offen offset:80 sc0 sc1
    buffer_load_dwordx4 v[100:103], v243, s[20:23], s99 offen offset:96 sc0 sc1
    buffer_load_dwordx4 v[104:107], v243, s[20:23], s99 offen offset:112 sc0 sc1
    buffer_load_dwordx3 v[244:246], v249, s[20:23], s99 offen offset:256 sc0 sc1
    s_waitcnt vmcnt(0)
K2_NOLD:
    s_waitcnt lgkmcnt(0)
    v_and_b32 v207, 0xffff, v235
    v_lshrrev_b32 v235, 16, v235
    v_lshlrev_b32 v247, 11, v219
    v_add_u32 v247, 34816, v247
    v_add_u32 v220, 138240, v203
    v_cmp_lt_u32 vcc, 0, v235
    s_barrier
    s_cbranch_vccz K2_GDONE
K2_GLOOP:
    s_mov_b64 exec, vcc
    v_bfe_u32 v221, v207, 3, 3
    v_lshlrev_b32 v221, 4, v221
    v_lshl_add_u32 v221, v207, 5, v221
    v_add_u32 v221, v247, v221
    v_xor_b32 v222, 0, v221
    ds_read_b128 v[140:143], v222
    v_xor_b32 v222, 16, v221
    ds_read_b128 v[144:147], v222
    v_xor_b32 v222, 32, v221
    ds_read_b128 v[148:151], v222
    v_xor_b32 v222, 48, v221
    ds_read_b128 v[152:155], v222
    v_xor_b32 v222, 64, v221
    ds_read_b128 v[156:159], v222
    v_xor_b32 v222, 80, v221
    ds_read_b128 v[160:163], v222
    v_xor_b32 v222, 96, v221
    ds_read_b128 v[164:167], v222
    v_xor_b32 v222, 112, v221
    ds_read_b128 v[168:171], v222
    v_lshlrev_b32 v222, 3, v207
    v_add_u32 v222, 129024, v222
    ds_read_b128 v[188:191], v222
    ds_read_b128 v[192:195], v222 offset:16
    v_add_u32 v207, 4, v207
    v_subrev_u32 v235, 1, v235
    v_cmp_lt_u32 vcc, 0, v235
    s_waitcnt lgkmcnt(9)
    v_pk_add_f32 v[76:77], v[76:77], v[140:141]
    v_pk_add_f32 v[78:79], v[78:79], v[142:143]
    s_waitcnt lgkmcnt(8)
    v_pk_add_f32 v[80:81], v[80:81], v[144:145]
    v_pk_add_f32 v[82:83], v[82:83], v[146:147]
    s_waitcnt lgkmcnt(7)
    v_pk_add_f32 v[84:85], v[84:85], v[148:149]
    v_pk_add_f32 v[86:87], v[86:87], v[150:151]
    s_waitcnt lgkmcnt(6)
    v_pk_add_f32 v[88:89], v[88:89], v[152:153]
    v_pk_add_f32 v[90:91], v[90:91], v[154:155]
    s_waitcnt lgkmcnt(5)
    v_pk_add_f32 v[92:93], v[92:93], v[156:157]
    v_pk_add_f32 v[94:95], v[94:95], v[158:159]
    s_waitcnt lgkmcnt(4)
    v_pk_add_f32 v[96:97], v[96:97], v[160:161]
    v_pk_add_f32 v[98:99], v[98:99], v[162:163]
    s_waitcnt lgkmcnt(3)
    v_pk_add_f32 v[100:101], v[100:101], v[164:165]
    v_pk_add_f32 v[102:103], v[102:103], v[166:167]
    s_waitcnt lgkmcnt(2)
    v_pk_add_f32 v[104:105], v[104:105], v[168:169]
    v_pk_add_f32 v[106:107], v[106:107], v[170:171]
    s_waitcnt lgkmcnt(0)
    v_pk_add_f32 v[244:245], v[244:245], v[188:189]
    v_add_f32 v246, v246, v190
    v_pk_add_f32 v[244:245], v[244:245], v[192:193]
    v_add_f32 v246, v246, v194
    s_cbranch_vccnz K2_GLOOP
    s_mov_b64 exec, -1
K2_GDONE:
    s_cmp_eq_u32 s93, 0
    s_cbranch_scc1 K2_EPI
    buffer_store_dwordx4 v[76:79], v243, s[20:23], s99 offen offset:0
    buffer_store_dwordx4 v[80:83], v243, s[20:23], s99 offen offset:16
    buffer_store_dwordx4 v[84:87], v243, s[20:23], s99 offen offset:32
    buffer_store_dwordx4 v[88:91], v243, s[20:23], s99 offen offset:48
    buffer_store_dwordx4 v[92:95], v243, s[20:23], s99 offen offset:64
    buffer_store_dwordx4 v[96:99], v243, s[20:23], s99 offen offset:80
    buffer_store_dwordx4 v[100:103], v243, s[20:23], s99 offen offset:96
    buffer_store_dwordx4 v[104:107], v243, s[20:23], s99 offen offset:112
    buffer_store_dwordx3 v[244:246], v249, s[20:23], s99 offen offset:256
    s_add_u32 s7, s7, s92
    s_waitcnt vmcnt(0)
    s_barrier
    s_branch K2_TOP
K2_EPI:
    s_cmp_ge_u32 s5, 6
    s_cbranch_scc1 K2_NWH2
    s_mul_i32 s95, s5, 2048
    s_add_u32 m0, s95, 138240
    s_add_u32 s95, s95, 7561216
    buffer_load_dwordx4 v203, s[20:23], s95 offen offset:0 sc1 lds
    buffer_load_dwordx4 v203, s[20:23], s95 offen offset:1024 sc1 lds
K2_NWH2:
    s_lshl_b32 s95, s5, 5
    s_cmp_ge_u32 s95, s96
    s_waitcnt vmcnt(0)
    s_barrier
    s_cbranch_scc1 K2_END0
    ds_read_b128 v[0:3], v220 offset:20480
    ds_read_b128 v[4:7], v220 offset:21504
    ds_read_b128 v[8:11], v220 offset:22528
    ds_read_b128 v[12:15], v220 offset:23552
    ds_read_b128 v[16:19], v220 offset:0
    ds_read_b128 v[20:23], v220 offset:1024
    ds_read_b128 v[24:27], v220 offset:2048
    ds_read_b128 v[28:31], v220 offset:3072
    ds_read_b128 v[44:47], v220 offset:4096
    ds_read_b128 v[48:51], v220 offset:5120
    ds_read_b128 v[52:55], v220 offset:6144
    ds_read_b128 v[56:59], v220 offset:7168
    ds_read_b128 v[60:63], v220 offset:8192
    ds_read_b128 v[64:67], v220 offset:9216
    ds_read_b128 v[68:71], v220 offset:10240
    ds_read_b128 v[72:75], v220 offset:11264
    v_cmp_gt_u32_e64 s[44:45], s96, v223
    s_mov_b32 s98, s101
    s_waitcnt vmcnt(0)
    v_mov_b32 v242, v241
    v_and_b32 v241, 0xffff0000, v240
    v_lshlrev_b32 v240, 16, v240
K2_TAIL:
    v_add_u32 v235, s98, v203
    v_lshlrev_b32 v203, 7, v218
    v_cndmask_b32_e64 v203, 2.0, v203, s[44:45]
    s_waitcnt lgkmcnt(8)
    v_mfma_f32_32x32x16_bf16 v[140:155], v[0:3], v[172:175], 0
    v_cvt_pk_bf16_f32 v108, v76, v77
    v_cvt_pk_bf16_f32 v109, v78, v79
    v_mfma_f32_32x32x16_bf16 v[156:171], v[16:19], v[172:175], 0
    v_cvt_pk_bf16_f32 v110, v80, v81
    v_cvt_pk_bf16_f32 v111, v82, v83
    v_mfma_f32_32x32x16_bf16 v[140:155], v[4:7], v[176:179], v[140:155]
    v_cvt_pk_bf16_f32 v112, v84, v85
    v_cvt_pk_bf16_f32 v113, v86, v87
    v_mfma_f32_32x32x16_bf16 v[156:171], v[20:23], v[176:179], v[156:171]
    v_cvt_pk_bf16_f32 v114, v88, v89
    v_cvt_pk_bf16_f32 v115, v90, v91
    v_mfma_f32_32x32x16_bf16 v[140:155], v[8:11], v[180:183], v[140:155]
    v_cvt_pk_bf16_f32 v116, v92, v93
    v_cvt_pk_bf16_f32 v117, v94, v95
    v_mfma_f32_32x32x16_bf16 v[156:171], v[24:27], v[180:183], v[156:171]
    v_cvt_pk_bf16_f32 v118, v96, v97
    v_cvt_pk_bf16_f32 v119, v98, v99
    v_mfma_f32_32x32x16_bf16 v[140:155], v[12:15], v[184:187], v[140:155]
    v_cvt_pk_bf16_f32 v120, v100, v101
    v_cvt_pk_bf16_f32 v121, v102, v103
    v_mfma_f32_32x32x16_bf16 v[156:171], v[28:31], v[184:187], v[156:171]
    v_cvt_pk_bf16_f32 v122, v104, v105
    v_cvt_pk_bf16_f32 v123, v106, v107
    s_waitcnt lgkmcnt(0)
    ds_bpermute_b32 v210, v239, v203 offset:0
    ds_bpermute_b32 v212, v239, v203 offset:32
    ds_bpermute_b32 v214, v239, v203 offset:64
    ds_bpermute_b32 v216, v239, v203 offset:96
    v_mfma_f32_32x32x16_bf16 v[140:155], v[44:47], v[108:111], v[140:155]
    v_lshlrev_b32 v76, 16, v172
    v_and_b32 v77, 0xffff0000, v172
    v_lshlrev_b32 v78, 16, v173
    v_and_b32 v79, 0xffff0000, v173
    v_lshlrev_b32 v80, 16, v174
    v_and_b32 v81, 0xffff0000, v174
    v_lshlrev_b32 v82, 16, v175
    v_and_b32 v83, 0xffff0000, v175
    v_mfma_f32_32x32x16_bf16 v[140:155], v[48:51], v[112:115], v[140:155]
    v_lshlrev_b32 v84, 16, v176
    v_and_b32 v85, 0xffff0000, v176
    v_lshlrev_b32 v86, 16, v177
    v_and_b32 v87, 0xffff0000, v177
    v_lshlrev_b32 v88, 16, v178
    v_and_b32 v89, 0xffff0000, v178
    v_lshlrev_b32 v90, 16, v179
    v_and_b32 v91, 0xffff0000, v179
    v_mfma_f32_32x32x16_bf16 v[140:155], v[52:55], v[116:119], v[140:155]
    v_lshlrev_b32 v92, 16, v180
    v_and_b32 v93, 0xffff0000, v180
    v_lshlrev_b32 v94, 16, v181
    v_and_b32 v95, 0xffff0000, v181
    v_lshlrev_b32 v96, 16, v182
    v_and_b32 v97, 0xffff0000, v182
    v_lshlrev_b32 v98, 16, v183
    v_and_b32 v99, 0xffff0000, v183
    v_mfma_f32_32x32x16_bf16 v[140:155], v[56:59], v[120:123], v[140:155]
    v_lshlrev_b32 v100, 16, v184
    v_and_b32 v101, 0xffff0000, v184
    v_lshlrev_b32 v102, 16, v185
    v_and_b32 v103, 0xffff0000, v185
    v_lshlrev_b32 v104, 16, v186
    v_and_b32 v105, 0xffff0000, v186
    v_lshlrev_b32 v106, 16, v187
    v_and_b32 v107, 0xffff0000, v187
    v_mfma_f32_32x32x16_bf16 v[156:171], v[60:63], v[108:111], v[156:171]
    v_mov_b32 v243, 0
    v_pk_add_f32 v[244:245], v[244:245], v[240:241]
    v_add_f32 v246, v246, v242
    v_cvt_pk_bf16_f32 v244, v244, v245
    v_cvt_pk_bf16_f32 v246, v246, v246
    s_mov_b32 exec_lo, s44
    s_mov_b32 exec_hi, 0
    s_cmp_eq_u32 s98, s94
    s_cbranch_scc1 K2_PF
    v_mul_u32_u24 v220, 6, v218
    s_mov_b32 s99, 6400000
    buffer_store_short v244, v220, s[24:27], s99 offen
    buffer_store_short_d16_hi v244, v220, s[24:27], s99 offen offset:2
    buffer_store_short v246, v220, s[24:27], s99 offen offset:4
    s_branch K2_PD
K2_PF:
    s_mov_b32 s99, 32768
    v_mad_u32_u24 v220, v249, 6, s99
    ds_write_b16 v220, v244
    ds_write_b16_d16_hi v220, v244 offset:2
    ds_write_b16 v220, v246 offset:4
    s_mov_b64 exec, 1
    v_mov_b32 v220, 108
    v_mov_b32 v221, 1
    ds_add_rtn_u32 v243, v220, v221
K2_PD:
    s_mov_b64 exec, -1
    s_mov_b32 s40, 0xbf317218
    s_mov_b32 s41, 0xbf317218
    v_mfma_f32_32x32x16_bf16 v[156:171], v[64:67], v[112:115], v[156:171]
    v_exp_f32 v220, v140
    v_exp_f32 v221, v141
    v_exp_f32 v222, v142
    v_exp_f32 v223, v143
    v_mfma_f32_32x32x16_bf16 v[156:171], v[68:71], v[116:119], v[156:171]
    v_exp_f32 v224, v144
    v_exp_f32 v225, v145
    v_exp_f32 v226, v146
    v_exp_f32 v227, v147
    v_pk_add_f32 v[220:221], v[220:221], 1.0 op_sel_hi:[1,0]
    v_pk_add_f32 v[222:223], v[222:223], 1.0 op_sel_hi:[1,0]
    v_mfma_f32_32x32x16_bf16 v[156:171], v[72:75], v[120:123], v[156:171]
    v_pk_add_f32 v[224:225], v[224:225], 1.0 op_sel_hi:[1,0]
    v_pk_add_f32 v[226:227], v[226:227], 1.0 op_sel_hi:[1,0]
    v_rcp_f32 v220, v220
    v_rcp_f32 v221, v221
    v_rcp_f32 v222, v222
    v_rcp_f32 v223, v223
    v_rcp_f32 v224, v224
    v_rcp_f32 v225, v225
    v_rcp_f32 v226, v226
    v_rcp_f32 v227, v227
    s_waitcnt lgkmcnt(0)
    v_add_u32 v210, v210, v211
    v_add_u32 v212, v212, v213
    v_add_u32 v214, v214, v215
    v_add_u32 v216, v216, v217
    v_pk_mul_f32 v[220:221], v[220:221], v[140:141]
    v_pk_mul_f32 v[222:223], v[222:223], v[142:143]
    v_pk_mul_f32 v[224:225], v[224:225], v[144:145]
    v_pk_mul_f32 v[226:227], v[226:227], v[146:147]
    v_pk_fma_f32 v[220:221], v[220:221], s[40:41], v[76:77]
    v_pk_fma_f32 v[222:223], v[222:223], s[40:41], v[78:79]
    v_pk_fma_f32 v[224:225], v[224:225], s[40:41], v[80:81]
    v_pk_fma_f32 v[226:227], v[226:227], s[40:41], v[82:83]
    v_cvt_pk_bf16_f32 v172, v220, v221
    v_cvt_pk_bf16_f32 v173, v222, v223
    v_cvt_pk_bf16_f32 v174, v224, v225
    v_cvt_pk_bf16_f32 v175, v226, v227
    s_waitcnt vmcnt(0)
    ds_write_b128 v251, v[172:175]
    v_exp_f32 v220, v148
    v_exp_f32 v221, v149
    v_exp_f32 v222, v150
    v_exp_f32 v223, v151
    v_exp_f32 v224, v152
    v_exp_f32 v225, v153
    v_exp_f32 v226, v154
    v_exp_f32 v227, v155
    v_pk_add_f32 v[220:221], v[220:221], 1.0 op_sel_hi:[1,0]
    v_pk_add_f32 v[222:223], v[222:223], 1.0 op_sel_hi:[1,0]
    v_pk_add_f32 v[224:225], v[224:225], 1.0 op_sel_hi:[1,0]
    v_pk_add_f32 v[226:227], v[226:227], 1.0 op_sel_hi:[1,0]
    v_rcp_f32 v220, v220
    v_rcp_f32 v221, v221
    v_rcp_f32 v222, v222
    v_rcp_f32 v223, v223
    v_rcp_f32 v224, v224
    v_rcp_f32 v225, v225
    v_rcp_f32 v226, v226
    v_rcp_f32 v227, v227
    v_pk_mul_f32 v[220:221], v[220:221], v[148:149]
    v_pk_mul_f32 v[222:223], v[222:223], v[150:151]
    v_pk_mul_f32 v[224:225], v[224:225], v[152:153]
    v_pk_mul_f32 v[226:227], v[226:227], v[154:155]
    v_pk_fma_f32 v[220:221], v[220:221], s[40:41], v[84:85]
    v_pk_fma_f32 v[222:223], v[222:223], s[40:41], v[86:87]
    v_pk_fma_f32 v[224:225], v[224:225], s[40:41], v[88:89]
    v_pk_fma_f32 v[226:227], v[226:227], s[40:41], v[90:91]
    v_cvt_pk_bf16_f32 v176, v220, v221
    v_cvt_pk_bf16_f32 v177, v222, v223
    v_cvt_pk_bf16_f32 v178, v224, v225
    v_cvt_pk_bf16_f32 v179, v226, v227
    ds_write_b128 v252, v[176:179]
    v_exp_f32 v220, v156
    v_exp_f32 v221, v157
    v_exp_f32 v222, v158
    v_exp_f32 v223, v159
    v_exp_f32 v224, v160
    v_exp_f32 v225, v161
    v_exp_f32 v226, v162
    v_exp_f32 v227, v163
    v_pk_add_f32 v[220:221], v[220:221], 1.0 op_sel_hi:[1,0]
    v_pk_add_f32 v[222:223], v[222:223], 1.0 op_sel_hi:[1,0]
    v_pk_add_f32 v[224:225], v[224:225], 1.0 op_sel_hi:[1,0]
    v_pk_add_f32 v[226:227], v[226:227], 1.0 op_sel_hi:[1,0]
    v_rcp_f32 v220, v220
    v_rcp_f32 v221, v221
    v_rcp_f32 v222, v222
    v_rcp_f32 v223, v223
    v_rcp_f32 v224, v224
    v_rcp_f32 v225, v225
    v_rcp_f32 v226, v226
    v_rcp_f32 v227, v227
    v_pk_mul_f32 v[220:221], v[220:221], v[156:157]
    v_pk_mul_f32 v[222:223], v[222:223], v[158:159]
    v_pk_mul_f32 v[224:225], v[224:225], v[160:161]
    v_pk_mul_f32 v[226:227], v[226:227], v[162:163]
    v_pk_fma_f32 v[220:221], v[220:221], s[40:41], v[92:93]
    v_pk_fma_f32 v[222:223], v[222:223], s[40:41], v[94:95]
    v_pk_fma_f32 v[224:225], v[224:225], s[40:41], v[96:97]
    v_pk_fma_f32 v[226:227], v[226:227], s[40:41], v[98:99]
    v_cvt_pk_bf16_f32 v180, v220, v221
    v_cvt_pk_bf16_f32 v181, v222, v223
    v_cvt_pk_bf16_f32 v182, v224, v225
    v_cvt_pk_bf16_f32 v183, v226, v227
    ds_write_b128 v253, v[180:183]
    v_exp_f32 v220, v164
    v_exp_f32 v221, v165
    v_exp_f32 v222, v166
    v_exp_f32 v223, v167
    v_exp_f32 v224, v168
    v_exp_f32 v225, v169
    v_exp_f32 v226, v170
    v_exp_f32 v227, v171
    v_pk_add_f32 v[220:221], v[220:221], 1.0 op_sel_hi:[1,0]
    v_pk_add_f32 v[222:223], v[222:223], 1.0 op_sel_hi:[1,0]
    v_pk_add_f32 v[224:225], v[224:225], 1.0 op_sel_hi:[1,0]
    v_pk_add_f32 v[226:227], v[226:227], 1.0 op_sel_hi:[1,0]
    v_rcp_f32 v220, v220
    v_rcp_f32 v221, v221
    v_rcp_f32 v222, v222
    v_rcp_f32 v223, v223
    v_rcp_f32 v224, v224
    v_rcp_f32 v225, v225
    v_rcp_f32 v226, v226
    v_rcp_f32 v227, v227
    v_pk_mul_f32 v[220:221], v[220:221], v[164:165]
    v_pk_mul_f32 v[222:223], v[222:223], v[166:167]
    v_pk_mul_f32 v[224:225], v[224:225], v[168:169]
    v_pk_mul_f32 v[226:227], v[226:227], v[170:171]
    v_pk_fma_f32 v[220:221], v[220:221], s[40:41], v[100:101]
    v_pk_fma_f32 v[222:223], v[222:223], s[40:41], v[102:103]
    v_pk_fma_f32 v[224:225], v[224:225], s[40:41], v[104:105]
    v_pk_fma_f32 v[226:227], v[226:227], s[40:41], v[106:107]
    v_cvt_pk_bf16_f32 v184, v220, v221
    v_cvt_pk_bf16_f32 v185, v222, v223
    v_cvt_pk_bf16_f32 v186, v224, v225
    v_cvt_pk_bf16_f32 v187, v226, v227
    ds_write_b128 v254, v[184:187]
    ds_read_b128 v[140:143], v235 offset:0
    ds_read_b128 v[144:147], v235 offset:1024
    ds_read_b128 v[148:151], v235 offset:2048
    ds_read_b128 v[152:155], v235 offset:3072
    s_waitcnt lgkmcnt(3)
    buffer_store_dwordx4 v[140:143], v210, s[24:27], 0 offen sc1
    s_waitcnt lgkmcnt(2)
    buffer_store_dwordx4 v[144:147], v212, s[24:27], 0 offen sc1
    s_waitcnt lgkmcnt(1)
    buffer_store_dwordx4 v[148:151], v214, s[24:27], 0 offen sc1
    s_waitcnt lgkmcnt(0)
    buffer_store_dwordx4 v[152:155], v216, s[24:27], 0 offen sc1
    v_readfirstlane_b32 s95, v243
    v_and_b32 v220, 63, v250
    v_lshlrev_b32 v220, 3, v220
    s_cmp_lg_u32 s95, 7
    s_cbranch_scc1 K2_PE
    ds_read_b64 v[188:189], v220 offset:32768
    ds_read_b64 v[190:191], v220 offset:33280
    ds_read_b64 v[192:193], v220 offset:33792
    s_mul_i32 s99, s4, 6
    s_add_u32 s99, s99, 6400000
    s_mul_i32 s95, s96, 6
    v_cmp_gt_i32 vcc, s95, v220
    s_sub_i32 s95, s95, 512
    s_waitcnt lgkmcnt(2)
    s_mov_b64 exec, vcc
    buffer_store_dwordx2 v[188:189], v220, s[24:27], s99 offen offset:0 sc1
    v_cmp_gt_i32 vcc, s95, v220
    s_sub_i32 s95, s95, 512
    s_waitcnt lgkmcnt(1)
    s_mov_b64 exec, vcc
    buffer_store_dwordx2 v[190:191], v220, s[24:27], s99 offen offset:512 sc1
    v_cmp_gt_i32 vcc, s95, v220
    s_sub_i32 s95, s95, 512
    s_waitcnt lgkmcnt(0)
    s_mov_b64 exec, vcc
    buffer_store_dwordx2 v[192:193], v220, s[24:27], s99 offen offset:1024 sc1
    s_mov_b64 exec, -1
K2_PE:
    s_endpgm
K2_END0:
    s_waitcnt vmcnt(0)
K2_END:
    s_endpgm
.section .rodata,"a"
.p2align 6
.amdhsa_kernel egnn_fused_kernel
  .amdhsa_next_free_vgpr 256
  .amdhsa_next_free_sgpr 102
  .amdhsa_accum_offset 256
  .amdhsa_group_segment_fixed_size 0
  .amdhsa_kernarg_size 88
  .amdhsa_user_sgpr_count 2
  .amdhsa_user_sgpr_kernarg_segment_ptr 1
  .amdhsa_system_sgpr_workgroup_id_x 1
.end_amdhsa_kernel
```
